```python
import torch

def _softmax(x, axis=-1):
    return torch.softmax(x, dim=axis)
def _gelu(x):
    return torch.nn.functional.gelu(x, approximate="tanh")
def _silu(x):
    return torch.nn.functional.silu(x)
def _sigmoid(x):
    return torch.sigmoid(x)
def _layernorm(x, axis=-1, eps=1e-5):
    m = x.mean(dim=axis, keepdim=True)
    v = x.var(dim=axis, keepdim=True, unbiased=False)
    return (x - m) / torch.sqrt(v + eps)
def _scatter_add(tgt, idx, src, axis=0):
    return tgt.clone().index_add_(axis, idx, src)
def _segment_sum(src, seg, n):
    out = torch.zeros((n,) + src.shape[1:], dtype=src.dtype)
    return out.index_add_(0, seg, src)
def _pad(x, pw):
    flat = tuple(v for pair in reversed(pw) for v in pair)
    return torch.nn.functional.pad(x, flat)

kernel_name = 'sequential_preLN__compressed_kv_cla__glu_gated_reglu__prompt'

def setup_inputs():

    _w = (lambda a: (lambda t: t.to(torch.bfloat16) if t.is_floating_point() else t)(torch.as_tensor(a)))
    def _A_setup():
        B, H, Sq, Sk, D, M = 1, 32, 2048, 2048, 128, 576
        Dc = 4 * D
        return {
            "x": _w((lambda *s: torch.randn(*s, dtype=torch.bfloat16) * 0.05)(B, Sq, M)),
            "c_kv": _w((lambda *s: torch.randn(*s, dtype=torch.bfloat16) * 0.4)(B, Sk, Dc)),
            "w_q": _w((lambda *s: torch.randn(*s, dtype=torch.bfloat16) * 1.6)(M, H, D) * (M ** -0.5)),
            "w_uk": _w((lambda *s: torch.randn(*s, dtype=torch.bfloat16) * 1.6)(Dc, H, D) * (Dc ** -0.5)),
            "w_uv": _w((lambda *s: torch.randn(*s, dtype=torch.bfloat16) * 0.4)(Dc, H, D) * (Dc ** -0.5)),
            "w_o": _w((lambda *s: torch.randn(*s, dtype=torch.bfloat16) * 0.4)(H, D, M) * ((H * D) ** -0.5)),
        }
    _A_in = _A_setup()

    def _B_setup():
        B, S, D, F = 1, 2048, 576, 4608
        return {
            "x": _w((lambda *s: torch.randn(*s, dtype=torch.bfloat16) * 0.05)(B, S, D)),
            "W_gate": _w((lambda *s: torch.randn(*s, dtype=torch.bfloat16) * 0.2)(D, F) * (2.0 / D) ** 0.5),
            "W_up": _w((lambda *s: torch.randn(*s, dtype=torch.bfloat16) * 0.2)(D, F) * (2.0 / D) ** 0.5),
            "W_down": _w((lambda *s: torch.randn(*s, dtype=torch.bfloat16) * 0.2)(F, D) * (1.0 / F) ** 0.5),
        }
    _B_in = _B_setup()

    return {
        "A_x": _A_in["x"],
        "A_c_kv": _A_in["c_kv"],
        "A_w_q": _A_in["w_q"],
        "A_w_uk": _A_in["w_uk"],
        "A_w_uv": _A_in["w_uv"],
        "A_w_o": _A_in["w_o"],
        "B_x": _B_in["x"],
        "B_W_gate": _B_in["W_gate"],
        "B_W_up": _B_in["W_up"],
        "B_W_down": _B_in["W_down"],
    }

def reference(A_x, A_c_kv, A_w_q, A_w_uk, A_w_uv, A_w_o, B_x, B_W_gate, B_W_up, B_W_down):
    def _A_ref(x, c_kv, w_q, w_uk, w_uv, w_o):
        B, Sq, M = x.shape[0], x.shape[1], x.shape[2]
        Sk = c_kv.shape[1]
        H, D = w_q.shape[1], w_q.shape[2]
        q = torch.einsum("bqm,mhd->bhqd", x, w_q)
        k = torch.einsum("bkc,chd->bhkd", c_kv, w_uk)
        v = torch.einsum("bkc,chd->bhkd", c_kv, w_uv)
        scores = torch.einsum("bhqd,bhkd->bhqk", q, k) * (D ** -0.5)
        off = Sk - Sq
        qi = torch.arange(Sq)[:, None]
        kj = torch.arange(Sk)[None, :]
        cmask = kj <= (qi + off)
        scores = torch.where(cmask[None, None], scores, -1e9)
        p = _softmax(scores, axis=-1)
        ctx = torch.einsum("bhqk,bhkd->bhqd", p, v)
        return torch.einsum("bhqd,hdm->bqm", ctx, w_o)

    def _B_ref(x, W_gate, W_up, W_down):
        gate = torch.einsum("bsd,df->bsf", x, W_gate)
        up = torch.einsum("bsd,df->bsf", x, W_up)
        gate = gate * (lambda x, dt: x.to(dt))(gate > 0, gate.dtype)
        h = gate * up
        return torch.einsum("bsf,fd->bsd", h, W_down)

    x = A_x
    h = x + _A_ref(_layernorm(x, axis=-1), A_c_kv, A_w_q, A_w_uk, A_w_uv, A_w_o)
    h2 = h + _B_ref(_layernorm(h, axis=-1), B_W_gate, B_W_up, B_W_down)
    return h2
```

```asm
; @launch kernel=k12_kernel grid=(256,1,1) block=(256,1,1) lds=163840
; @launch kernel=k3_kernel grid=(256,1,1) block=(256,1,1) lds=65536
; @launch kernel=k4_kernel grid=(256,1,1) block=(256,1,1) lds=149632
; @launch kernel=sequential_preLN__compressed_kv_cla__glu_gated_reglu__prompt_kernel grid=(256,1,1) block=(256,1,1) lds=65536
.amdgcn_target "amdgcn-amd-amdhsa--gfx950"
.text
.globl k12_kernel
.p2align 8
.type k12_kernel,@function
k12_kernel:
s_cmp_ge_u32 s2, 256
s_cbranch_scc1 k12_kernel_end
s_load_dwordx8 s[40:47], s[0:1], 0
s_load_dwordx4 s[48:51], s[0:1], 32
s_load_dwordx4 s[72:75], s[0:1], 88
s_load_dwordx4 s[52:55], s[0:1], 56
s_load_dwordx2 s[56:57], s[0:1], 72
v_and_b32 v1, 63, v0
v_lshrrev_b32 v2, 6, v0
s_and_b32 s25, s2, 7
s_lshl_b32 s25, s25, 2
s_bfe_u32 s26, s2, 0x20003
s_add_u32 s25, s25, s26
s_lshr_b32 s26, s2, 5
v_readfirstlane_b32 s24, v2
v_lshrrev_b32 v48, 4, v1
v_and_b32 v49, 15, v1
s_lshl_b32 s58, s24, 12
s_and_b32 s76, s24, 1
s_lshr_b32 s77, s24, 1
s_lshl_b32 s100, s2, 2
s_add_u32 s100, s100, s24
s_lshl_b32 s100, s100, 1
v_lshrrev_b32 v55, 5, v1
v_add_u32 v50, s100, v55
v_and_b32 v56, 31, v1
v_mul_u32_u24 v28, 1152, v50
v_lshl_add_u32 v28, v56, 4, v28
v_mov_b32 v52, 0x40000000
v_cmp_gt_u32 vcc, 8, v56
s_nop 1
v_cndmask_b32 v29, v52, v28, vcc
s_lshl_b32 s100, s76, 4
v_add_u32 v50, s100, v48
v_lshlrev_b32 v50, 13, v50
v_bfe_u32 v51, v1, 1, 3
v_xor_b32 v51, v51, v48
v_lshl_add_u32 v50, v51, 5, v50
v_and_b32 v51, 1, v1
v_lshl_add_u32 v50, v51, 4, v50
v_xor_b32 v51, 128, v50
v_add_u32 v20, 0, v50
v_add_u32 v21, 31744, v50
v_add_u32 v22, 63488, v51
v_add_u32 v23, 95232, v51
v_lshrrev_b32 v50, 3, v1
v_lshlrev_b32 v50, 10, v50
v_and_b32 v51, 7, v1
v_xor_b32 v51, v51, v48
v_lshl_add_u32 v50, v51, 4, v50
v_xor_b32 v51, 64, v50
v_add_u32 v40, 0, v50
v_add_u32 v41, 7168, v51
v_add_u32 v42, 14336, v51
v_add_u32 v43, 21504, v50
v_add_u32 v44, 524288, v50
v_add_u32 v45, 531456, v51
v_add_u32 v46, 538624, v51
v_add_u32 v47, 545792, v50
s_lshl_b32 s100, s26, 1
s_add_u32 s100, s100, s76
s_lshl_b32 s100, s100, 14
s_lshl_b32 s101, s25, 8
s_add_u32 s100, s100, s101
v_lshrrev_b32 v50, 2, v1
v_lshlrev_b32 v50, 18, v50
v_bfe_u32 v51, v1, 1, 1
v_lshl_add_u32 v50, v51, 13, v50
v_and_b32 v51, 1, v1
v_lshl_add_u32 v50, v51, 7, v50
v_add_u32 v50, s100, v50
v_mov_b32 v57, v50
s_and_b32 s100, s25, 3
s_lshl_b32 s100, s100, 2
s_add_u32 s100, s100, s24
s_lshr_b32 s101, s100, 1
s_lshl_b32 s101, s101, 18
s_and_b32 s100, s100, 1
s_lshl_b32 s100, s100, 14
s_add_u32 s100, s100, s101
s_lshl_b32 s101, s26, 15
s_add_u32 s100, s100, s101
v_lshlrev_b32 v50, 10, v49
v_lshl_add_u32 v50, v48, 7, v50
v_add_u32 v59, s100, v50
s_lshl_b32 s31, s25, 8
s_lshl_b32 s33, s26, 15
s_lshl_b32 s100, s77, 18
s_add_u32 s33, s33, s100
s_lshl_b32 s100, s76, 20
s_add_u32 s33, s33, s100
s_lshl_b32 s35, s24, 13
s_add_u32 s35, s35, 65536
s_waitcnt lgkmcnt(0)
s_mov_b32 s68, s40
s_mov_b32 s69, s41
s_mov_b32 s70, 2359296
s_mov_b32 s71, 0x20000
s_mov_b32 s4, s42
s_mov_b32 s5, s43
s_mov_b32 s6, 2097152
s_mov_b32 s7, 0x20000
s_cmp_eq_u32 s77, 0
s_cselect_b32 s8, s46, s48
s_cselect_b32 s9, s47, s49
s_mov_b32 s10, 4194304
s_mov_b32 s11, 0x20000
buffer_load_dwordx4 v[192:195], v28, s[68:71], 0 offen
v_and_b32 v50, 7, v49
v_lshlrev_b32 v50, 7, v50
v_lshrrev_b32 v51, 3, v49
s_lshl_b32 s100, 1024, s77
v_mul_u32_u24 v53, s100, v51
v_add_u32 v50, v50, v53
s_lshl_b32 s100, s76, 14
v_add_u32 v50, s100, v50
buffer_load_dwordx4 v[196:199], v28, s[68:71], 0 offen offset:512
v_bfe_u32 v53, v49, 1, 2
v_lshl_or_b32 v53, v51, 2, v53
v_xor_b32 v53, v53, v48
v_lshl_add_u32 v50, v53, 4, v50
v_xor_b32 v51, 64, v50
v_add_u32 v24, 65536, v50
v_add_u32 v25, 65536, v51
v_add_u32 v26, 131072, v50
buffer_load_dwordx4 v[200:203], v29, s[68:71], 0 offen offset:1024
v_add_u32 v27, 131072, v51
v_bfe_u32 v50, v1, 2, 2
v_lshl_add_u32 v51, v48, 3, v50
v_lshlrev_b32 v51, 8, v51
v_and_b32 v53, 1, v48
v_lshl_or_b32 v53, v53, 2, v50
v_lshl_add_u32 v51, v53, 5, v51
s_mov_b32 s40, 0xffff
s_mov_b32 s41, 0x0
v_cndmask_b32 v60, v52, v57, s[40:41]
s_nop 0
buffer_load_dword v39, v60, s[8:11], 0 offen
v_and_b32 v53, 3, v1
v_lshl_add_u32 v51, v53, 3, v51
s_lshl_b32 s100, s77, 13
v_add_u32 v51, s100, v51
v_xor_b32 v8, 0, v51
v_xor_b32 v9, 32, v51
v_xor_b32 v10, 64, v51
v_xor_b32 v11, 96, v51
s_mov_b32 s40, 0xffffffff
s_mov_b32 s41, 0x0
v_cndmask_b32 v60, v52, v59, s[40:41]
s_nop 0
buffer_load_dword v39, v60, s[4:7], 0 offen
v_xor_b32 v12, 128, v51
v_xor_b32 v13, 160, v51
v_xor_b32 v14, 192, v51
v_xor_b32 v15, 224, v51
s_lshl_b32 s100, s24, 1
v_add_u32 v50, s100, v55
v_and_b32 v51, 7, v56
v_xor_b32 v50, v50, v51
s_add_u32 m0, s58, 0
s_add_u32 s30, s31, 0
s_nop 0
buffer_load_dwordx4 v20, s[8:11], s30 offen offset:0 lds
v_lshlrev_b32 v50, 4, v50
v_lshl_add_u32 v50, v56, 7, v50
v_add_u32 v32, 102400, v50
v_lshrrev_b32 v50, 3, v1
v_and_b32 v51, 7, v1
v_xor_b32 v53, v51, v50
v_lshlrev_b32 v53, 4, v53
buffer_load_dwordx4 v21, s[8:11], s30 offen offset:1024 lds
v_lshl_add_u32 v53, v50, 7, v53
s_lshl_b32 s100, s24, 10
s_add_u32 s100, s100, 102400
v_add_u32 v33, s100, v53
v_lshlrev_b32 v53, 8, v50
v_lshl_add_u32 v53, v51, 4, v53
s_lshr_b32 s100, s2, 1
s_mul_i32 s100, s100, 18432
buffer_load_dwordx4 v22, s[8:11], s30 offen offset:2048 lds
s_and_b32 s101, s2, 1
s_lshl_b32 s101, s101, 7
s_add_u32 s100, s100, s101
s_lshl_b32 s101, s24, 11
s_add_u32 s100, s100, s101
v_add_u32 v30, s100, v53
s_add_u32 s64, s74, 58458112
s_addc_u32 s65, s75, 0
buffer_load_dwordx4 v23, s[8:11], s30 offen offset:3072 lds
s_mov_b32 s66, 32768
s_mov_b32 s67, 0x20000
v_cmp_eq_u32 vcc, 0, v1
s_lshl_b32 s100, s25, 3
s_add_u32 s100, s100, s26
s_lshl_b32 s100, s100, 7
v_cndmask_b32 v0, v52, v1, vcc
s_cmp_eq_u32 s24, 0
s_cselect_b32 s59, s100, 0x40000000
s_cselect_b32 s38, 0, 0x40000000
s_cselect_b32 s29, 16384, 0x40000000
s_add_u32 m0, s35, 0
s_add_u32 s30, s33, 0
s_nop 0
buffer_load_dwordx4 v40, s[4:7], s30 offen offset:0 lds
s_mov_b32 s16, s74
s_mov_b32 s17, s75
s_mov_b32 s18, 2359296
s_mov_b32 s19, 0x20000
s_mov_b32 s20, s72
s_mov_b32 s21, s73
s_mov_b32 s22, 256
s_mov_b32 s23, 0x20000
buffer_load_dwordx4 v41, s[4:7], s30 offen offset:1024 lds
s_lshl_b32 s100, s25, 20
s_add_u32 s100, s100, 4194304
s_add_u32 s12, s74, s100
s_addc_u32 s13, s75, 0
s_mov_b32 s14, 1048576
s_mov_b32 s15, 0x20000
s_mov_b32 s60, s44
s_mov_b32 s61, s45
buffer_load_dwordx4 v42, s[4:7], s30 offen offset:2048 lds
s_mov_b32 s62, 4718592
s_mov_b32 s63, 0x20000
s_lshl_b32 s27, s26, 2
s_add_u32 s27, s27, s24
s_sub_u32 s28, 63, s27
s_lshl_b32 s39, s25, 8
s_lshl_b32 s100, s77, 18
s_add_u32 s39, s39, s100
s_lshr_b32 s3, s2, 3
s_and_b32 s3, s3, 3
s_lshl_b32 s3, s3, 2
s_add_u32 s3, s3, s24
s_mov_b32 s98, 4
s_mov_b64 exec, 0
tp0_ret:
s_cmp_eq_u32 s98, 0
s_cbranch_scc1 tp0_done
s_sub_u32 s98, s98, 1
s_mov_b32 s99, s3
s_add_u32 s3, s3, 4
s_cmp_ge_u32 s3, 16
s_cselect_b32 s3, s24, s3
s_cmp_eq_u32 s99, 0
s_cbranch_scc1 tp0_p0
s_cmp_eq_u32 s99, 1
s_cbranch_scc1 tp0_p1
s_cmp_eq_u32 s99, 2
s_cbranch_scc1 tp0_p2
s_cmp_eq_u32 s99, 3
s_cbranch_scc1 tp0_p3
s_cmp_eq_u32 s99, 4
s_cbranch_scc1 tp0_p4
s_cmp_eq_u32 s99, 5
s_cbranch_scc1 tp0_p5
s_cmp_eq_u32 s99, 6
s_cbranch_scc1 tp0_p6
s_cmp_eq_u32 s99, 7
s_cbranch_scc1 tp0_p7
s_cmp_eq_u32 s99, 8
s_cbranch_scc1 tp0_p8
s_cmp_eq_u32 s99, 9
s_cbranch_scc1 tp0_p9
s_cmp_eq_u32 s99, 10
s_cbranch_scc1 tp0_p10
s_cmp_eq_u32 s99, 11
s_cbranch_scc1 tp0_p11
s_cmp_eq_u32 s99, 12
s_cbranch_scc1 tp0_p12
s_branch tp0_ret
tp0_done:
s_mov_b64 exec, -1
buffer_load_dwordx4 v43, s[4:7], s30 offen offset:3072 lds
s_lshr_b32 s100, 1024, s77
s_lshl_b32 s101, 512, s77
v_and_b32 v50, 1, v48
v_lshrrev_b32 v51, 1, v48
v_mul_u32_u24 v50, s100, v50
v_mul_u32_u24 v51, s101, v51
v_add_u32 v50, v50, v51
v_lshl_add_u32 v7, v49, 4, v50
s_add_u32 m0, s35, 4096
s_add_u32 s30, s33, 0
s_nop 0
buffer_load_dwordx4 v44, s[4:7], s30 offen offset:0 lds
v_lshlrev_b32 v3, 4, v1
v_subrev_u32 v2, s58, v3
s_lshl_b32 s100, s27, 1
s_mul_i32 s100, s100, 18432
v_add_u32 v16, s100, v3
s_lshl_b32 s100, s27, 1
s_add_u32 s100, s100, 1
buffer_load_dwordx4 v45, s[4:7], s30 offen offset:1024 lds
s_mul_i32 s100, s100, 18432
v_add_u32 v17, s100, v3
s_lshl_b32 s100, s28, 1
s_mul_i32 s100, s100, 18432
v_add_u32 v18, s100, v3
s_lshl_b32 s100, s28, 1
s_add_u32 s100, s100, 1
s_mul_i32 s100, s100, 18432
buffer_load_dwordx4 v46, s[4:7], s30 offen offset:2048 lds
v_add_u32 v19, s100, v3
s_and_b32 s100, s2, 1
s_lshl_b32 s100, s100, 7
v_add_u32 v31, s100, v0
v_and_b32 v50, 1, v1
v_lshlrev_b32 v38, 7, v50
s_getreg_b32 s100, hwreg(HW_REG_XCC_ID, 0, 4)
buffer_load_dwordx4 v47, s[4:7], s30 offen offset:3072 lds
s_lshl_b32 s97, s100, 2
s_lshl_b32 s97, 1, s97
s_lshl_b32 s96, s97, 3
s_cmp_lt_u32 s100, 8
s_cselect_b32 s97, s97, 0
s_cselect_b32 s96, s96, -1
s_add_u32 s100, s25, 1
s_cmp_eq_u32 s25, 31
s_cselect_b32 s100, 33, s100
s_lshl_b32 s100, s100, 2
v_add_u32 v62, s100, v0
s_add_u32 m0, s58, 16384
s_add_u32 s30, s31, 262144
s_nop 0
buffer_load_dwordx4 v20, s[8:11], s30 offen offset:0 lds
v_mov_b32 v61, s97
v_and_b32 v50, 7, v1
v_lshlrev_b32 v37, 7, v50
s_lshl_b32 s100, s26, 2
s_add_u32 s100, s100, s24
s_lshl_b32 s100, s100, 14
s_lshl_b32 s101, s25, 8
s_add_u32 s100, s100, s101
buffer_load_dwordx4 v21, s[8:11], s30 offen offset:1024 lds
v_lshrrev_b32 v50, 2, v1
v_lshlrev_b32 v50, 19, v50
v_bfe_u32 v51, v1, 1, 1
v_lshl_add_u32 v50, v51, 13, v50
v_and_b32 v51, 1, v1
v_lshl_add_u32 v50, v51, 7, v50
v_add_u32 v35, s100, v50
buffer_load_dwordx4 v22, s[8:11], s30 offen offset:2048 lds
v_and_b32 v50, 31, v1
v_and_b32 v50, 31, v1
v_lshrrev_b32 v51, 5, v1
v_lshlrev_b32 v53, 2, v51
v_sub_u32 v5, v50, v53
v_mov_b32 v4, 0x4b800000
v_and_b32 v50, 1, v48
v_lshlrev_b32 v6, 10, v50
buffer_load_dwordx4 v23, s[8:11], s30 offen offset:3072 lds
v_lshl_add_u32 v6, v51, 8, v6
v_lshl_add_u32 v6, v49, 4, v6
s_mov_b32 s76, 8192
s_mov_b32 s42, 0xff
s_mov_b32 s43, 0xff
v_mov_b32 v1, 1
v_mov_b32 v34, 0
s_add_u32 m0, s58, 32768
s_add_u32 s30, s31, 524288
s_nop 0
buffer_load_dwordx4 v20, s[8:11], s30 offen offset:0 lds
buffer_load_dwordx4 v21, s[8:11], s30 offen offset:1024 lds
buffer_load_dwordx4 v22, s[8:11], s30 offen offset:2048 lds
buffer_load_dwordx4 v23, s[8:11], s30 offen offset:3072 lds
s_add_u32 m0, s35, 32768
s_add_u32 s30, s33, 128
s_nop 0
buffer_load_dwordx4 v40, s[4:7], s30 offen offset:0 lds
buffer_load_dwordx4 v41, s[4:7], s30 offen offset:1024 lds
buffer_load_dwordx4 v42, s[4:7], s30 offen offset:2048 lds
buffer_load_dwordx4 v43, s[4:7], s30 offen offset:3072 lds
s_add_u32 m0, s35, 36864
s_add_u32 s30, s33, 128
s_nop 0
buffer_load_dwordx4 v44, s[4:7], s30 offen offset:0 lds
buffer_load_dwordx4 v45, s[4:7], s30 offen offset:1024 lds
buffer_load_dwordx4 v46, s[4:7], s30 offen offset:2048 lds
buffer_load_dwordx4 v47, s[4:7], s30 offen offset:3072 lds
s_mov_b32 s40, 0xff0000
s_mov_b32 s41, 0x0
v_cndmask_b32 v60, v52, v57, s[40:41]
s_nop 0
buffer_load_dword v39, v60, s[8:11], 0 offen
s_mov_b32 s40, 0x0
s_mov_b32 s41, 0xffff
v_cndmask_b32 v60, v52, v59, s[40:41]
s_nop 0
buffer_load_dword v39, v60, s[4:7], 0 offen
s_waitcnt vmcnt(14) lgkmcnt(0)
s_barrier
s_cmp_lt_u32 s24, 2
s_cbranch_scc0 k12_kernel_V0
k12_kernel_K0:
ds_read_b64_tr_b16 v[64:65], v8 offset:0
ds_read_b64_tr_b16 v[66:67], v8 offset:1024
ds_read_b128 v[96:99], v24 offset:0
ds_read_b64_tr_b16 v[68:69], v9 offset:0
ds_read_b64_tr_b16 v[70:71], v9 offset:1024
ds_read_b128 v[100:103], v25 offset:2048
ds_read_b64_tr_b16 v[72:73], v10 offset:0
ds_read_b64_tr_b16 v[74:75], v10 offset:1024
ds_read_b128 v[104:107], v24 offset:4096
ds_read_b64_tr_b16 v[76:77], v11 offset:0
ds_read_b64_tr_b16 v[78:79], v11 offset:1024
ds_read_b128 v[108:111], v25 offset:6144
ds_read_b64_tr_b16 v[80:81], v12 offset:0
ds_read_b64_tr_b16 v[82:83], v12 offset:1024
ds_read_b128 v[112:115], v24 offset:8192
s_waitcnt lgkmcnt(8)
ds_read_b64_tr_b16 v[84:85], v13 offset:0
ds_read_b64_tr_b16 v[86:87], v13 offset:1024
ds_read_b128 v[116:119], v25 offset:10240
ds_read_b64_tr_b16 v[88:89], v14 offset:0
ds_read_b64_tr_b16 v[90:91], v14 offset:1024
ds_read_b128 v[120:123], v24 offset:12288
ds_read_b64_tr_b16 v[92:93], v15 offset:0
ds_read_b64_tr_b16 v[94:95], v15 offset:1024
ds_read_b128 v[124:127], v25 offset:14336
s_waitcnt lgkmcnt(0)
v_mfma_f32_16x16x32_bf16 a[0:3], v[64:67], v[96:99], 0
s_add_u32 m0, s58, 49152
v_lshlrev_b32 v208, 16, v192
v_mfma_f32_16x16x32_bf16 a[8:11], v[64:67], v[100:103], 0
ds_read_b64_tr_b16 v[128:129], v8 offset:16384
v_and_b32 v209, 0xffff0000, v192
v_mfma_f32_16x16x32_bf16 a[64:67], v[64:67], v[104:107], 0
ds_read_b64_tr_b16 v[130:131], v8 offset:17408
s_add_u32 s30, s31, 786432
v_mfma_f32_16x16x32_bf16 a[72:75], v[64:67], v[108:111], 0
v_lshlrev_b32 v210, 16, v193
v_and_b32 v211, 0xffff0000, v193
v_mfma_f32_16x16x32_bf16 a[128:131], v[64:67], v[112:115], 0
ds_read_b128 v[160:163], v25 offset:0
v_lshlrev_b32 v212, 16, v194
v_mfma_f32_16x16x32_bf16 a[136:139], v[64:67], v[116:119], 0
buffer_load_dwordx4 v20, s[8:11], s30 offen offset:0 lds
v_mfma_f32_16x16x32_bf16 a[192:195], v[64:67], v[120:123], 0
v_and_b32 v213, 0xffff0000, v194
v_lshlrev_b32 v214, 16, v195
v_mfma_f32_16x16x32_bf16 a[200:203], v[64:67], v[124:127], 0
ds_read_b64_tr_b16 v[132:133], v9 offset:16384
v_and_b32 v215, 0xffff0000, v195
v_mfma_f32_16x16x32_bf16 a[4:7], v[68:71], v[96:99], 0
ds_read_b64_tr_b16 v[134:135], v9 offset:17408
v_lshlrev_b32 v216, 16, v196
v_mfma_f32_16x16x32_bf16 a[12:15], v[68:71], v[100:103], 0
buffer_load_dwordx4 v21, s[8:11], s30 offen offset:1024 lds
v_mfma_f32_16x16x32_bf16 a[68:71], v[68:71], v[104:107], 0
ds_read_b128 v[164:167], v24 offset:2048
v_and_b32 v217, 0xffff0000, v196
v_mfma_f32_16x16x32_bf16 a[76:79], v[68:71], v[108:111], 0
buffer_load_dwordx4 v22, s[8:11], s30 offen offset:2048 lds
v_mfma_f32_16x16x32_bf16 a[132:135], v[68:71], v[112:115], 0
v_lshlrev_b32 v218, 16, v197
v_and_b32 v219, 0xffff0000, v197
v_mfma_f32_16x16x32_bf16 a[140:143], v[68:71], v[116:119], 0
ds_read_b64_tr_b16 v[136:137], v10 offset:16384
v_lshlrev_b32 v220, 16, v198
v_mfma_f32_16x16x32_bf16 a[196:199], v[68:71], v[120:123], 0
ds_read_b64_tr_b16 v[138:139], v10 offset:17408
v_and_b32 v221, 0xffff0000, v198
v_mfma_f32_16x16x32_bf16 a[204:207], v[68:71], v[124:127], 0
buffer_load_dwordx4 v23, s[8:11], s30 offen offset:3072 lds
v_mfma_f32_16x16x32_bf16 a[16:19], v[72:75], v[96:99], 0
ds_read_b128 v[168:171], v25 offset:4096
s_add_u32 m0, s35, 65536
v_mfma_f32_16x16x32_bf16 a[24:27], v[72:75], v[100:103], 0
v_lshlrev_b32 v222, 16, v199
v_and_b32 v223, 0xffff0000, v199
v_mfma_f32_16x16x32_bf16 a[80:83], v[72:75], v[104:107], 0
s_add_u32 s30, s33, 256
v_lshlrev_b32 v224, 16, v200
v_mfma_f32_16x16x32_bf16 a[88:91], v[72:75], v[108:111], 0
ds_read_b64_tr_b16 v[140:141], v11 offset:16384
v_and_b32 v225, 0xffff0000, v200
v_mfma_f32_16x16x32_bf16 a[144:147], v[72:75], v[112:115], 0
ds_read_b64_tr_b16 v[142:143], v11 offset:17408
v_lshlrev_b32 v226, 16, v201
v_mfma_f32_16x16x32_bf16 a[152:155], v[72:75], v[116:119], 0
buffer_load_dwordx4 v40, s[4:7], s30 offen offset:0 lds
v_mfma_f32_16x16x32_bf16 a[208:211], v[72:75], v[120:123], 0
ds_read_b128 v[172:175], v24 offset:6144
v_and_b32 v227, 0xffff0000, v201
v_mfma_f32_16x16x32_bf16 a[216:219], v[72:75], v[124:127], 0
v_lshlrev_b32 v228, 16, v202
v_and_b32 v229, 0xffff0000, v202
v_mfma_f32_16x16x32_bf16 a[20:23], v[76:79], v[96:99], 0
buffer_load_dwordx4 v41, s[4:7], s30 offen offset:1024 lds
v_mfma_f32_16x16x32_bf16 a[28:31], v[76:79], v[100:103], 0
ds_read_b64_tr_b16 v[144:145], v12 offset:16384
v_lshlrev_b32 v230, 16, v203
v_mfma_f32_16x16x32_bf16 a[84:87], v[76:79], v[104:107], 0
ds_read_b64_tr_b16 v[146:147], v12 offset:17408
v_and_b32 v231, 0xffff0000, v203
v_mfma_f32_16x16x32_bf16 a[92:95], v[76:79], v[108:111], 0
buffer_load_dwordx4 v42, s[4:7], s30 offen offset:2048 lds
v_mfma_f32_16x16x32_bf16 a[148:151], v[76:79], v[112:115], 0
ds_read_b128 v[176:179], v25 offset:8192
v_add_f32 v232, v208, v209
v_mfma_f32_16x16x32_bf16 a[156:159], v[76:79], v[116:119], 0
buffer_load_dwordx4 v43, s[4:7], s30 offen offset:3072 lds
v_mfma_f32_16x16x32_bf16 a[212:215], v[76:79], v[120:123], 0
v_add_f32 v233, v210, v211
v_add_f32 v232, v232, v212
v_mfma_f32_16x16x32_bf16 a[220:223], v[76:79], v[124:127], 0
ds_read_b64_tr_b16 v[148:149], v13 offset:16384
v_add_f32 v233, v233, v213
v_mfma_f32_16x16x32_bf16 a[32:35], v[80:83], v[96:99], 0
ds_read_b64_tr_b16 v[150:151], v13 offset:17408
v_add_f32 v232, v232, v214
v_mfma_f32_16x16x32_bf16 a[40:43], v[80:83], v[100:103], 0
s_mov_b32 s40, 0x0
s_mov_b32 s41, 0xffff0000
v_mfma_f32_16x16x32_bf16 a[96:99], v[80:83], v[104:107], 0
ds_read_b128 v[180:183], v24 offset:10240
v_cndmask_b32 v60, v52, v59, s[40:41]
v_mfma_f32_16x16x32_bf16 a[104:107], v[80:83], v[108:111], 0
v_add_f32 v233, v233, v215
v_add_f32 v232, v232, v216
v_mfma_f32_16x16x32_bf16 a[160:163], v[80:83], v[112:115], 0
v_add_f32 v233, v233, v217
v_add_f32 v232, v232, v218
v_mfma_f32_16x16x32_bf16 a[168:171], v[80:83], v[116:119], 0
ds_read_b64_tr_b16 v[152:153], v14 offset:16384
v_add_f32 v233, v233, v219
v_mfma_f32_16x16x32_bf16 a[224:227], v[80:83], v[120:123], 0
ds_read_b64_tr_b16 v[154:155], v14 offset:17408
v_add_f32 v232, v232, v220
v_mfma_f32_16x16x32_bf16 a[232:235], v[80:83], v[124:127], 0
buffer_load_dword v39, v60, s[4:7], 0 offen
v_mfma_f32_16x16x32_bf16 a[36:39], v[84:87], v[96:99], 0
ds_read_b128 v[184:187], v25 offset:12288
v_add_f32 v233, v233, v221
v_mfma_f32_16x16x32_bf16 a[44:47], v[84:87], v[100:103], 0
v_add_f32 v232, v232, v222
v_add_f32 v233, v233, v223
v_mfma_f32_16x16x32_bf16 a[100:103], v[84:87], v[104:107], 0
v_add_f32 v232, v232, v224
v_add_f32 v233, v233, v225
v_mfma_f32_16x16x32_bf16 a[108:111], v[84:87], v[108:111], 0
ds_read_b64_tr_b16 v[156:157], v15 offset:16384
v_add_f32 v232, v232, v226
v_mfma_f32_16x16x32_bf16 a[164:167], v[84:87], v[112:115], 0
ds_read_b64_tr_b16 v[158:159], v15 offset:17408
v_add_f32 v233, v233, v227
v_mfma_f32_16x16x32_bf16 a[172:175], v[84:87], v[116:119], 0
v_add_f32 v232, v232, v228
v_add_f32 v233, v233, v229
v_mfma_f32_16x16x32_bf16 a[228:231], v[84:87], v[120:123], 0
ds_read_b128 v[188:191], v24 offset:14336
v_add_f32 v232, v232, v230
v_mfma_f32_16x16x32_bf16 a[236:239], v[84:87], v[124:127], 0
v_add_f32 v233, v233, v231
v_add_f32 v232, v232, v233
v_mfma_f32_16x16x32_bf16 a[48:51], v[88:91], v[96:99], 0
s_nop 0
v_add_f32_dpp v232, v232, v232 row_ror:8 row_mask:0xf bank_mask:0xf
v_mfma_f32_16x16x32_bf16 a[56:59], v[88:91], v[100:103], 0
s_nop 0
v_add_f32_dpp v232, v232, v232 row_ror:4 row_mask:0xf bank_mask:0xf
v_mfma_f32_16x16x32_bf16 a[112:115], v[88:91], v[104:107], 0
s_nop 0
v_add_f32_dpp v232, v232, v232 row_ror:2 row_mask:0xf bank_mask:0xf
v_mfma_f32_16x16x32_bf16 a[120:123], v[88:91], v[108:111], 0
s_nop 0
v_add_f32_dpp v232, v232, v232 row_ror:1 row_mask:0xf bank_mask:0xf
v_mfma_f32_16x16x32_bf16 a[176:179], v[88:91], v[112:115], 0
v_mov_b32 v234, v232
v_mfma_f32_16x16x32_bf16 a[184:187], v[88:91], v[116:119], 0
s_nop 0
v_permlane16_swap_b32 v232, v234
v_mfma_f32_16x16x32_bf16 a[240:243], v[88:91], v[120:123], 0
v_add_f32 v232, v232, v234
v_mul_f32 v232, 0x3ae38e39, v232
v_mfma_f32_16x16x32_bf16 a[248:251], v[88:91], v[124:127], 0
v_sub_f32 v208, v208, v232
v_sub_f32 v209, v209, v232
v_mfma_f32_16x16x32_bf16 a[52:55], v[92:95], v[96:99], 0
v_sub_f32 v210, v210, v232
v_sub_f32 v211, v211, v232
v_mfma_f32_16x16x32_bf16 a[60:63], v[92:95], v[100:103], 0
v_sub_f32 v212, v212, v232
v_sub_f32 v213, v213, v232
v_mfma_f32_16x16x32_bf16 a[116:119], v[92:95], v[104:107], 0
v_sub_f32 v214, v214, v232
v_sub_f32 v215, v215, v232
v_mfma_f32_16x16x32_bf16 a[124:127], v[92:95], v[108:111], 0
v_sub_f32 v216, v216, v232
v_sub_f32 v217, v217, v232
v_mfma_f32_16x16x32_bf16 a[180:183], v[92:95], v[112:115], 0
v_sub_f32 v218, v218, v232
v_sub_f32 v219, v219, v232
v_mfma_f32_16x16x32_bf16 a[188:191], v[92:95], v[116:119], 0
v_sub_f32 v220, v220, v232
v_sub_f32 v221, v221, v232
v_mfma_f32_16x16x32_bf16 a[244:247], v[92:95], v[120:123], 0
v_sub_f32 v222, v222, v232
v_sub_f32 v223, v223, v232
v_mfma_f32_16x16x32_bf16 a[252:255], v[92:95], v[124:127], 0
s_waitcnt vmcnt(11) lgkmcnt(0)
s_barrier
v_mfma_f32_16x16x32_bf16 a[0:3], v[128:131], v[160:163], a[0:3]
s_add_u32 m0, s58, 0
v_sub_f32 v224, v224, v232
v_mfma_f32_16x16x32_bf16 a[8:11], v[128:131], v[164:167], a[8:11]
ds_read_b64_tr_b16 v[64:65], v8 offset:32768
v_sub_f32 v225, v225, v232
v_mfma_f32_16x16x32_bf16 a[64:67], v[128:131], v[168:171], a[64:67]
ds_read_b64_tr_b16 v[66:67], v8 offset:33792
v_sub_f32 v226, v226, v232
v_mfma_f32_16x16x32_bf16 a[72:75], v[128:131], v[172:175], a[72:75]
v_sub_f32 v227, v227, v232
v_sub_f32 v228, v228, v232
v_mfma_f32_16x16x32_bf16 a[128:131], v[128:131], v[176:179], a[128:131]
ds_read_b128 v[96:99], v24 offset:32768
s_add_u32 s30, s31, 1048576
v_mfma_f32_16x16x32_bf16 a[136:139], v[128:131], v[180:183], a[136:139]
v_sub_f32 v229, v229, v232
v_sub_f32 v230, v230, v232
v_mfma_f32_16x16x32_bf16 a[192:195], v[128:131], v[184:187], a[192:195]
v_sub_f32 v231, v231, v232
v_mul_f32 v232, v208, v208
v_mfma_f32_16x16x32_bf16 a[200:203], v[128:131], v[188:191], a[200:203]
ds_read_b64_tr_b16 v[68:69], v9 offset:32768
v_mul_f32 v233, v224, v224
v_mfma_f32_16x16x32_bf16 a[4:7], v[132:135], v[160:163], a[4:7]
ds_read_b64_tr_b16 v[70:71], v9 offset:33792
v_fmac_f32 v232, v209, v209
v_mfma_f32_16x16x32_bf16 a[12:15], v[132:135], v[164:167], a[12:15]
buffer_load_dwordx4 v20, s[8:11], s30 offen offset:0 lds
v_mfma_f32_16x16x32_bf16 a[68:71], v[132:135], v[168:171], a[68:71]
ds_read_b128 v[100:103], v25 offset:34816
v_fmac_f32 v233, v225, v225
v_mfma_f32_16x16x32_bf16 a[76:79], v[132:135], v[172:175], a[76:79]
v_fmac_f32 v232, v210, v210
v_fmac_f32 v233, v226, v226
v_mfma_f32_16x16x32_bf16 a[132:135], v[132:135], v[176:179], a[132:135]
buffer_load_dwordx4 v21, s[8:11], s30 offen offset:1024 lds
v_mfma_f32_16x16x32_bf16 a[140:143], v[132:135], v[180:183], a[140:143]
ds_read_b64_tr_b16 v[72:73], v10 offset:32768
v_fmac_f32 v232, v211, v211
v_mfma_f32_16x16x32_bf16 a[196:199], v[132:135], v[184:187], a[196:199]
ds_read_b64_tr_b16 v[74:75], v10 offset:33792
v_fmac_f32 v233, v227, v227
v_mfma_f32_16x16x32_bf16 a[204:207], v[132:135], v[188:191], a[204:207]
v_fmac_f32 v232, v212, v212
v_fmac_f32 v233, v228, v228
v_mfma_f32_16x16x32_bf16 a[16:19], v[136:139], v[160:163], a[16:19]
ds_read_b128 v[104:107], v24 offset:36864
v_fmac_f32 v232, v213, v213
v_mfma_f32_16x16x32_bf16 a[24:27], v[136:139], v[164:167], a[24:27]
buffer_load_dwordx4 v22, s[8:11], s30 offen offset:2048 lds
v_mfma_f32_16x16x32_bf16 a[80:83], v[136:139], v[168:171], a[80:83]
v_fmac_f32 v233, v229, v229
v_fmac_f32 v232, v214, v214
v_mfma_f32_16x16x32_bf16 a[88:91], v[136:139], v[172:175], a[88:91]
ds_read_b64_tr_b16 v[76:77], v11 offset:32768
v_fmac_f32 v233, v230, v230
v_mfma_f32_16x16x32_bf16 a[144:147], v[136:139], v[176:179], a[144:147]
ds_read_b64_tr_b16 v[78:79], v11 offset:33792
v_fmac_f32 v232, v215, v215
v_mfma_f32_16x16x32_bf16 a[152:155], v[136:139], v[180:183], a[152:155]
buffer_load_dwordx4 v23, s[8:11], s30 offen offset:3072 lds
v_mfma_f32_16x16x32_bf16 a[208:211], v[136:139], v[184:187], a[208:211]
ds_read_b128 v[108:111], v25 offset:38912
v_fmac_f32 v233, v231, v231
v_mfma_f32_16x16x32_bf16 a[216:219], v[136:139], v[188:191], a[216:219]
v_fmac_f32 v232, v216, v216
v_fmac_f32 v232, v217, v217
v_mfma_f32_16x16x32_bf16 a[20:23], v[140:143], v[160:163], a[20:23]
s_add_u32 m0, s35, 69632
v_fmac_f32 v232, v218, v218
v_mfma_f32_16x16x32_bf16 a[28:31], v[140:143], v[164:167], a[28:31]
ds_read_b64_tr_b16 v[80:81], v12 offset:32768
v_fmac_f32 v232, v219, v219
v_mfma_f32_16x16x32_bf16 a[84:87], v[140:143], v[168:171], a[84:87]
ds_read_b64_tr_b16 v[82:83], v12 offset:33792
v_fmac_f32 v232, v220, v220
v_mfma_f32_16x16x32_bf16 a[92:95], v[140:143], v[172:175], a[92:95]
v_fmac_f32 v232, v221, v221
v_fmac_f32 v232, v222, v222
v_mfma_f32_16x16x32_bf16 a[148:151], v[140:143], v[176:179], a[148:151]
ds_read_b128 v[112:115], v24 offset:40960
s_add_u32 s30, s33, 256
v_mfma_f32_16x16x32_bf16 a[156:159], v[140:143], v[180:183], a[156:159]
v_fmac_f32 v232, v223, v223
v_cndmask_b32 v233, 0, v233, s[42:43]
v_mfma_f32_16x16x32_bf16 a[212:215], v[140:143], v[184:187], a[212:215]
tp0_p0:
s_cbranch_execz tp0_ret
v_add_f32 v232, v232, v233
v_mfma_f32_16x16x32_bf16 a[220:223], v[140:143], v[188:191], a[220:223]
ds_read_b64_tr_b16 v[84:85], v13 offset:32768
v_mfma_f32_16x16x32_bf16 a[32:35], v[144:147], v[160:163], a[32:35]
ds_read_b64_tr_b16 v[86:87], v13 offset:33792
v_mfma_f32_16x16x32_bf16 a[40:43], v[144:147], v[164:167], a[40:43]
buffer_load_dwordx4 v44, s[4:7], s30 offen offset:0 lds
v_mfma_f32_16x16x32_bf16 a[96:99], v[144:147], v[168:171], a[96:99]
ds_read_b128 v[116:119], v25 offset:43008
v_mfma_f32_16x16x32_bf16 a[104:107], v[144:147], v[172:175], a[104:107]
s_nop 0
v_add_f32_dpp v232, v232, v232 row_ror:8 row_mask:0xf bank_mask:0xf
v_mfma_f32_16x16x32_bf16 a[160:163], v[144:147], v[176:179], a[160:163]
buffer_load_dwordx4 v45, s[4:7], s30 offen offset:1024 lds
v_mfma_f32_16x16x32_bf16 a[168:171], v[144:147], v[180:183], a[168:171]
ds_read_b64_tr_b16 v[88:89], v14 offset:32768
v_mfma_f32_16x16x32_bf16 a[224:227], v[144:147], v[184:187], a[224:227]
ds_read_b64_tr_b16 v[90:91], v14 offset:33792
v_mfma_f32_16x16x32_bf16 a[232:235], v[144:147], v[188:191], a[232:235]
s_nop 0
v_add_f32_dpp v232, v232, v232 row_ror:4 row_mask:0xf bank_mask:0xf
v_mfma_f32_16x16x32_bf16 a[36:39], v[148:151], v[160:163], a[36:39]
ds_read_b128 v[120:123], v24 offset:45056
v_mfma_f32_16x16x32_bf16 a[44:47], v[148:151], v[164:167], a[44:47]
buffer_load_dwordx4 v46, s[4:7], s30 offen offset:2048 lds
v_mfma_f32_16x16x32_bf16 a[100:103], v[148:151], v[168:171], a[100:103]
s_nop 0
v_add_f32_dpp v232, v232, v232 row_ror:2 row_mask:0xf bank_mask:0xf
v_mfma_f32_16x16x32_bf16 a[108:111], v[148:151], v[172:175], a[108:111]
ds_read_b64_tr_b16 v[92:93], v15 offset:32768
v_mfma_f32_16x16x32_bf16 a[164:167], v[148:151], v[176:179], a[164:167]
ds_read_b64_tr_b16 v[94:95], v15 offset:33792
v_mfma_f32_16x16x32_bf16 a[172:175], v[148:151], v[180:183], a[172:175]
buffer_load_dwordx4 v47, s[4:7], s30 offen offset:3072 lds
v_mfma_f32_16x16x32_bf16 a[228:231], v[148:151], v[184:187], a[228:231]
ds_read_b128 v[124:127], v25 offset:47104
v_mfma_f32_16x16x32_bf16 a[236:239], v[148:151], v[188:191], a[236:239]
s_nop 0
v_add_f32_dpp v232, v232, v232 row_ror:1 row_mask:0xf bank_mask:0xf
v_mfma_f32_16x16x32_bf16 a[48:51], v[152:155], v[160:163], a[48:51]
s_mov_b32 s40, 0xff000000
s_mov_b32 s41, 0x0
v_mfma_f32_16x16x32_bf16 a[56:59], v[152:155], v[164:167], a[56:59]
v_mov_b32 v234, v232
v_mfma_f32_16x16x32_bf16 a[112:115], v[152:155], v[168:171], a[112:115]
s_nop 0
v_permlane16_swap_b32 v232, v234
v_mfma_f32_16x16x32_bf16 a[120:123], v[152:155], v[172:175], a[120:123]
v_add_f32 v232, v232, v234
v_mov_b32 v233, 0x3727c5ac
v_mfma_f32_16x16x32_bf16 a[176:179], v[152:155], v[176:179], a[176:179]
v_cndmask_b32 v60, v52, v57, s[40:41]
v_fmac_f32 v233, 0x3ae38e39, v232
v_mfma_f32_16x16x32_bf16 a[184:187], v[152:155], v[180:183], a[184:187]
v_rsq_f32 v233, v233
v_mfma_f32_16x16x32_bf16 a[240:243], v[152:155], v[184:187], a[240:243]
v_mul_f32 v233, 0x3e0293ee, v233
v_mul_f32 v208, v208, v233
v_mfma_f32_16x16x32_bf16 a[248:251], v[152:155], v[188:191], a[248:251]
v_mul_f32 v209, v209, v233
v_mul_f32 v210, v210, v233
v_mfma_f32_16x16x32_bf16 a[52:55], v[156:159], v[160:163], a[52:55]
buffer_load_dword v39, v60, s[8:11], 0 offen
v_mfma_f32_16x16x32_bf16 a[60:63], v[156:159], v[164:167], a[60:63]
v_mul_f32 v211, v211, v233
v_mul_f32 v212, v212, v233
v_mfma_f32_16x16x32_bf16 a[116:119], v[156:159], v[168:171], a[116:119]
v_mul_f32 v213, v213, v233
v_mul_f32 v214, v214, v233
v_mfma_f32_16x16x32_bf16 a[124:127], v[156:159], v[172:175], a[124:127]
v_mul_f32 v215, v215, v233
v_mul_f32 v216, v216, v233
v_mfma_f32_16x16x32_bf16 a[180:183], v[156:159], v[176:179], a[180:183]
v_mul_f32 v217, v217, v233
v_mul_f32 v218, v218, v233
v_mfma_f32_16x16x32_bf16 a[188:191], v[156:159], v[180:183], a[188:191]
v_mul_f32 v219, v219, v233
v_mul_f32 v220, v220, v233
v_mfma_f32_16x16x32_bf16 a[244:247], v[156:159], v[184:187], a[244:247]
v_mul_f32 v221, v221, v233
v_mul_f32 v222, v222, v233
v_mfma_f32_16x16x32_bf16 a[252:255], v[156:159], v[188:191], a[252:255]
s_waitcnt vmcnt(14) lgkmcnt(0)
s_barrier
v_mfma_f32_16x16x32_bf16 a[0:3], v[64:67], v[96:99], a[0:3]
s_add_u32 m0, s58, 16384
v_mul_f32 v223, v223, v233
v_mfma_f32_16x16x32_bf16 a[8:11], v[64:67], v[100:103], a[8:11]
ds_read_b64_tr_b16 v[128:129], v8 offset:49152
v_mul_f32 v224, v224, v233
v_mfma_f32_16x16x32_bf16 a[64:67], v[64:67], v[104:107], a[64:67]
ds_read_b64_tr_b16 v[130:131], v8 offset:50176
v_mul_f32 v225, v225, v233
v_mfma_f32_16x16x32_bf16 a[72:75], v[64:67], v[108:111], a[72:75]
s_add_u32 s30, s31, 1310720
v_mul_f32 v226, v226, v233
v_mfma_f32_16x16x32_bf16 a[128:131], v[64:67], v[112:115], a[128:131]
ds_read_b128 v[160:163], v25 offset:32768
v_mul_f32 v227, v227, v233
v_mfma_f32_16x16x32_bf16 a[136:139], v[64:67], v[116:119], a[136:139]
v_mul_f32 v228, v228, v233
v_mul_f32 v229, v229, v233
v_mfma_f32_16x16x32_bf16 a[192:195], v[64:67], v[120:123], a[192:195]
v_mul_f32 v230, v230, v233
v_mul_f32 v231, v231, v233
v_mfma_f32_16x16x32_bf16 a[200:203], v[64:67], v[124:127], a[200:203]
ds_read_b64_tr_b16 v[132:133], v9 offset:49152
v_cvt_pk_bf16_f32 v192, v208, v209
v_mfma_f32_16x16x32_bf16 a[4:7], v[68:71], v[96:99], a[4:7]
ds_read_b64_tr_b16 v[134:135], v9 offset:50176
v_cvt_pk_bf16_f32 v193, v210, v211
v_mfma_f32_16x16x32_bf16 a[12:15], v[68:71], v[100:103], a[12:15]
buffer_load_dwordx4 v20, s[8:11], s30 offen offset:0 lds
v_mfma_f32_16x16x32_bf16 a[68:71], v[68:71], v[104:107], a[68:71]
ds_read_b128 v[164:167], v24 offset:34816
v_cvt_pk_bf16_f32 v194, v212, v213
v_mfma_f32_16x16x32_bf16 a[76:79], v[68:71], v[108:111], a[76:79]
buffer_load_dwordx4 v21, s[8:11], s30 offen offset:1024 lds
v_mfma_f32_16x16x32_bf16 a[132:135], v[68:71], v[112:115], a[132:135]
v_cvt_pk_bf16_f32 v195, v214, v215
v_cvt_pk_bf16_f32 v196, v216, v217
v_mfma_f32_16x16x32_bf16 a[140:143], v[68:71], v[116:119], a[140:143]
ds_read_b64_tr_b16 v[136:137], v10 offset:49152
v_cvt_pk_bf16_f32 v197, v218, v219
v_mfma_f32_16x16x32_bf16 a[196:199], v[68:71], v[120:123], a[196:199]
ds_read_b64_tr_b16 v[138:139], v10 offset:50176
v_cvt_pk_bf16_f32 v198, v220, v221
v_mfma_f32_16x16x32_bf16 a[204:207], v[68:71], v[124:127], a[204:207]
buffer_load_dwordx4 v22, s[8:11], s30 offen offset:2048 lds
v_mfma_f32_16x16x32_bf16 a[16:19], v[72:75], v[96:99], a[16:19]
ds_read_b128 v[168:171], v25 offset:36864
v_cvt_pk_bf16_f32 v199, v222, v223
v_mfma_f32_16x16x32_bf16 a[24:27], v[72:75], v[100:103], a[24:27]
v_cvt_pk_bf16_f32 v200, v224, v225
v_cvt_pk_bf16_f32 v201, v226, v227
v_mfma_f32_16x16x32_bf16 a[80:83], v[72:75], v[104:107], a[80:83]
buffer_load_dwordx4 v23, s[8:11], s30 offen offset:3072 lds
v_mfma_f32_16x16x32_bf16 a[88:91], v[72:75], v[108:111], a[88:91]
ds_read_b64_tr_b16 v[140:141], v11 offset:49152
v_cvt_pk_bf16_f32 v202, v228, v229
v_mfma_f32_16x16x32_bf16 a[144:147], v[72:75], v[112:115], a[144:147]
ds_read_b64_tr_b16 v[142:143], v11 offset:50176
v_cvt_pk_bf16_f32 v203, v230, v231
v_mfma_f32_16x16x32_bf16 a[152:155], v[72:75], v[116:119], a[152:155]
v_mfma_f32_16x16x32_bf16 a[208:211], v[72:75], v[120:123], a[208:211]
ds_read_b128 v[172:175], v24 offset:38912
s_add_u32 m0, s35, 0
v_mfma_f32_16x16x32_bf16 a[216:219], v[72:75], v[124:127], a[216:219]
v_mfma_f32_16x16x32_bf16 a[20:23], v[76:79], v[96:99], a[20:23]
v_mfma_f32_16x16x32_bf16 a[28:31], v[76:79], v[100:103], a[28:31]
ds_read_b64_tr_b16 v[144:145], v12 offset:49152
v_mfma_f32_16x16x32_bf16 a[84:87], v[76:79], v[104:107], a[84:87]
ds_read_b64_tr_b16 v[146:147], v12 offset:50176
s_add_u32 s30, s33, 384
v_mfma_f32_16x16x32_bf16 a[92:95], v[76:79], v[108:111], a[92:95]
v_mfma_f32_16x16x32_bf16 a[148:151], v[76:79], v[112:115], a[148:151]
ds_read_b128 v[176:179], v25 offset:40960
v_mfma_f32_16x16x32_bf16 a[156:159], v[76:79], v[116:119], a[156:159]
v_mfma_f32_16x16x32_bf16 a[212:215], v[76:79], v[120:123], a[212:215]
buffer_load_dwordx4 v40, s[4:7], s30 offen offset:0 lds
v_mfma_f32_16x16x32_bf16 a[220:223], v[76:79], v[124:127], a[220:223]
ds_read_b64_tr_b16 v[148:149], v13 offset:49152
v_mfma_f32_16x16x32_bf16 a[32:35], v[80:83], v[96:99], a[32:35]
ds_read_b64_tr_b16 v[150:151], v13 offset:50176
v_mfma_f32_16x16x32_bf16 a[40:43], v[80:83], v[100:103], a[40:43]
buffer_load_dwordx4 v41, s[4:7], s30 offen offset:1024 lds
v_mfma_f32_16x16x32_bf16 a[96:99], v[80:83], v[104:107], a[96:99]
ds_read_b128 v[180:183], v24 offset:43008
v_mfma_f32_16x16x32_bf16 a[104:107], v[80:83], v[108:111], a[104:107]
v_mfma_f32_16x16x32_bf16 a[160:163], v[80:83], v[112:115], a[160:163]
v_mfma_f32_16x16x32_bf16 a[168:171], v[80:83], v[116:119], a[168:171]
ds_read_b64_tr_b16 v[152:153], v14 offset:49152
v_mfma_f32_16x16x32_bf16 a[224:227], v[80:83], v[120:123], a[224:227]
ds_read_b64_tr_b16 v[154:155], v14 offset:50176
v_mfma_f32_16x16x32_bf16 a[232:235], v[80:83], v[124:127], a[232:235]
buffer_load_dwordx4 v42, s[4:7], s30 offen offset:2048 lds
v_mfma_f32_16x16x32_bf16 a[36:39], v[84:87], v[96:99], a[36:39]
ds_read_b128 v[184:187], v25 offset:45056
v_mfma_f32_16x16x32_bf16 a[44:47], v[84:87], v[100:103], a[44:47]
buffer_load_dwordx4 v43, s[4:7], s30 offen offset:3072 lds
v_mfma_f32_16x16x32_bf16 a[100:103], v[84:87], v[104:107], a[100:103]
v_mfma_f32_16x16x32_bf16 a[108:111], v[84:87], v[108:111], a[108:111]
ds_read_b64_tr_b16 v[156:157], v15 offset:49152
v_mfma_f32_16x16x32_bf16 a[164:167], v[84:87], v[112:115], a[164:167]
ds_read_b64_tr_b16 v[158:159], v15 offset:50176
v_mfma_f32_16x16x32_bf16 a[172:175], v[84:87], v[116:119], a[172:175]
s_mov_b32 s40, 0xffff
s_mov_b32 s41, 0x0
v_mfma_f32_16x16x32_bf16 a[228:231], v[84:87], v[120:123], a[228:231]
ds_read_b128 v[188:191], v24 offset:47104
v_mfma_f32_16x16x32_bf16 a[236:239], v[84:87], v[124:127], a[236:239]
v_mfma_f32_16x16x32_bf16 a[48:51], v[88:91], v[96:99], a[48:51]
v_cndmask_b32 v60, v52, v59, s[40:41]
v_mfma_f32_16x16x32_bf16 a[56:59], v[88:91], v[100:103], a[56:59]
v_mfma_f32_16x16x32_bf16 a[112:115], v[88:91], v[104:107], a[112:115]
v_mfma_f32_16x16x32_bf16 a[120:123], v[88:91], v[108:111], a[120:123]
v_mfma_f32_16x16x32_bf16 a[176:179], v[88:91], v[112:115], a[176:179]
buffer_load_dword v39, v60, s[4:7], 0 offen offset:512
v_mfma_f32_16x16x32_bf16 a[184:187], v[88:91], v[116:119], a[184:187]
v_mfma_f32_16x16x32_bf16 a[240:243], v[88:91], v[120:123], a[240:243]
v_mfma_f32_16x16x32_bf16 a[248:251], v[88:91], v[124:127], a[248:251]
v_mfma_f32_16x16x32_bf16 a[52:55], v[92:95], v[96:99], a[52:55]
buffer_atomic_add v61, v62, s[20:23], s38 offen
v_mfma_f32_16x16x32_bf16 a[60:63], v[92:95], v[100:103], a[60:63]
v_mfma_f32_16x16x32_bf16 a[116:119], v[92:95], v[104:107], a[116:119]
v_mfma_f32_16x16x32_bf16 a[124:127], v[92:95], v[108:111], a[124:127]
v_mfma_f32_16x16x32_bf16 a[180:183], v[92:95], v[112:115], a[180:183]
v_mfma_f32_16x16x32_bf16 a[188:191], v[92:95], v[116:119], a[188:191]
v_mfma_f32_16x16x32_bf16 a[244:247], v[92:95], v[120:123], a[244:247]
v_mfma_f32_16x16x32_bf16 a[252:255], v[92:95], v[124:127], a[252:255]
s_waitcnt vmcnt(11) lgkmcnt(0)
s_barrier
v_mfma_f32_16x16x32_bf16 a[0:3], v[128:131], v[160:163], a[0:3]
s_add_u32 m0, s58, 32768
ds_write_b128 v32, v[192:195] offset:0
v_mfma_f32_16x16x32_bf16 a[8:11], v[128:131], v[164:167], a[8:11]
ds_read_b64_tr_b16 v[64:65], v8 offset:0
ds_write_b128 v32, v[196:199] offset:8192
v_mfma_f32_16x16x32_bf16 a[64:67], v[128:131], v[168:171], a[64:67]
ds_read_b64_tr_b16 v[66:67], v8 offset:1024
ds_write_b128 v32, v[200:203] offset:16384
v_mfma_f32_16x16x32_bf16 a[72:75], v[128:131], v[172:175], a[72:75]
v_mfma_f32_16x16x32_bf16 a[128:131], v[128:131], v[176:179], a[128:131]
ds_read_b128 v[96:99], v26 offset:0
s_add_u32 s30, s31, 1572864
v_mfma_f32_16x16x32_bf16 a[136:139], v[128:131], v[180:183], a[136:139]
v_mfma_f32_16x16x32_bf16 a[192:195], v[128:131], v[184:187], a[192:195]
v_mfma_f32_16x16x32_bf16 a[200:203], v[128:131], v[188:191], a[200:203]
ds_read_b64_tr_b16 v[68:69], v9 offset:0
v_mfma_f32_16x16x32_bf16 a[4:7], v[132:135], v[160:163], a[4:7]
ds_read_b64_tr_b16 v[70:71], v9 offset:1024
v_mfma_f32_16x16x32_bf16 a[12:15], v[132:135], v[164:167], a[12:15]
buffer_load_dwordx4 v20, s[8:11], s30 offen offset:0 lds
v_mfma_f32_16x16x32_bf16 a[68:71], v[132:135], v[168:171], a[68:71]
ds_read_b128 v[100:103], v27 offset:2048
v_mfma_f32_16x16x32_bf16 a[76:79], v[132:135], v[172:175], a[76:79]
v_mfma_f32_16x16x32_bf16 a[132:135], v[132:135], v[176:179], a[132:135]
buffer_load_dwordx4 v21, s[8:11], s30 offen offset:1024 lds
v_mfma_f32_16x16x32_bf16 a[140:143], v[132:135], v[180:183], a[140:143]
ds_read_b64_tr_b16 v[72:73], v10 offset:0
v_mfma_f32_16x16x32_bf16 a[196:199], v[132:135], v[184:187], a[196:199]
ds_read_b64_tr_b16 v[74:75], v10 offset:1024
v_mfma_f32_16x16x32_bf16 a[204:207], v[132:135], v[188:191], a[204:207]
v_mfma_f32_16x16x32_bf16 a[16:19], v[136:139], v[160:163], a[16:19]
ds_read_b128 v[104:107], v26 offset:4096
v_mfma_f32_16x16x32_bf16 a[24:27], v[136:139], v[164:167], a[24:27]
buffer_load_dwordx4 v22, s[8:11], s30 offen offset:2048 lds
v_mfma_f32_16x16x32_bf16 a[80:83], v[136:139], v[168:171], a[80:83]
v_mfma_f32_16x16x32_bf16 a[88:91], v[136:139], v[172:175], a[88:91]
ds_read_b64_tr_b16 v[76:77], v11 offset:0
v_mfma_f32_16x16x32_bf16 a[144:147], v[136:139], v[176:179], a[144:147]
ds_read_b64_tr_b16 v[78:79], v11 offset:1024
v_mfma_f32_16x16x32_bf16 a[152:155], v[136:139], v[180:183], a[152:155]
buffer_load_dwordx4 v23, s[8:11], s30 offen offset:3072 lds
v_mfma_f32_16x16x32_bf16 a[208:211], v[136:139], v[184:187], a[208:211]
ds_read_b128 v[108:111], v27 offset:6144
v_mfma_f32_16x16x32_bf16 a[216:219], v[136:139], v[188:191], a[216:219]
v_mfma_f32_16x16x32_bf16 a[20:23], v[140:143], v[160:163], a[20:23]
s_add_u32 m0, s35, 4096
v_mfma_f32_16x16x32_bf16 a[28:31], v[140:143], v[164:167], a[28:31]
ds_read_b64_tr_b16 v[80:81], v12 offset:0
v_mfma_f32_16x16x32_bf16 a[84:87], v[140:143], v[168:171], a[84:87]
ds_read_b64_tr_b16 v[82:83], v12 offset:1024
v_mfma_f32_16x16x32_bf16 a[92:95], v[140:143], v[172:175], a[92:95]
v_mfma_f32_16x16x32_bf16 a[148:151], v[140:143], v[176:179], a[148:151]
ds_read_b128 v[112:115], v26 offset:8192
s_add_u32 s30, s33, 384
v_mfma_f32_16x16x32_bf16 a[156:159], v[140:143], v[180:183], a[156:159]
v_mfma_f32_16x16x32_bf16 a[212:215], v[140:143], v[184:187], a[212:215]
v_mfma_f32_16x16x32_bf16 a[220:223], v[140:143], v[188:191], a[220:223]
ds_read_b64_tr_b16 v[84:85], v13 offset:0
v_mfma_f32_16x16x32_bf16 a[32:35], v[144:147], v[160:163], a[32:35]
ds_read_b64_tr_b16 v[86:87], v13 offset:1024
v_mfma_f32_16x16x32_bf16 a[40:43], v[144:147], v[164:167], a[40:43]
buffer_load_dwordx4 v44, s[4:7], s30 offen offset:0 lds
v_mfma_f32_16x16x32_bf16 a[96:99], v[144:147], v[168:171], a[96:99]
ds_read_b128 v[116:119], v27 offset:10240
v_mfma_f32_16x16x32_bf16 a[104:107], v[144:147], v[172:175], a[104:107]
v_mfma_f32_16x16x32_bf16 a[160:163], v[144:147], v[176:179], a[160:163]
buffer_load_dwordx4 v45, s[4:7], s30 offen offset:1024 lds
v_mfma_f32_16x16x32_bf16 a[168:171], v[144:147], v[180:183], a[168:171]
ds_read_b64_tr_b16 v[88:89], v14 offset:0
v_mfma_f32_16x16x32_bf16 a[224:227], v[144:147], v[184:187], a[224:227]
ds_read_b64_tr_b16 v[90:91], v14 offset:1024
v_mfma_f32_16x16x32_bf16 a[232:235], v[144:147], v[188:191], a[232:235]
v_mfma_f32_16x16x32_bf16 a[36:39], v[148:151], v[160:163], a[36:39]
ds_read_b128 v[120:123], v26 offset:12288
v_mfma_f32_16x16x32_bf16 a[44:47], v[148:151], v[164:167], a[44:47]
buffer_load_dwordx4 v46, s[4:7], s30 offen offset:2048 lds
v_mfma_f32_16x16x32_bf16 a[100:103], v[148:151], v[168:171], a[100:103]
v_mfma_f32_16x16x32_bf16 a[108:111], v[148:151], v[172:175], a[108:111]
ds_read_b64_tr_b16 v[92:93], v15 offset:0
v_mfma_f32_16x16x32_bf16 a[164:167], v[148:151], v[176:179], a[164:167]
ds_read_b64_tr_b16 v[94:95], v15 offset:1024
v_mfma_f32_16x16x32_bf16 a[172:175], v[148:151], v[180:183], a[172:175]
buffer_load_dwordx4 v47, s[4:7], s30 offen offset:3072 lds
v_mfma_f32_16x16x32_bf16 a[228:231], v[148:151], v[184:187], a[228:231]
ds_read_b128 v[124:127], v27 offset:14336
v_mfma_f32_16x16x32_bf16 a[236:239], v[148:151], v[188:191], a[236:239]
v_mfma_f32_16x16x32_bf16 a[48:51], v[152:155], v[160:163], a[48:51]
s_mov_b32 s40, 0x0
s_mov_b32 s41, 0xff
v_mfma_f32_16x16x32_bf16 a[56:59], v[152:155], v[164:167], a[56:59]
v_mfma_f32_16x16x32_bf16 a[112:115], v[152:155], v[168:171], a[112:115]
v_mfma_f32_16x16x32_bf16 a[120:123], v[152:155], v[172:175], a[120:123]
v_mfma_f32_16x16x32_bf16 a[176:179], v[152:155], v[176:179], a[176:179]
v_cndmask_b32 v60, v52, v57, s[40:41]
v_mfma_f32_16x16x32_bf16 a[184:187], v[152:155], v[180:183], a[184:187]
v_mfma_f32_16x16x32_bf16 a[240:243], v[152:155], v[184:187], a[240:243]
v_mfma_f32_16x16x32_bf16 a[248:251], v[152:155], v[188:191], a[248:251]
v_mfma_f32_16x16x32_bf16 a[52:55], v[156:159], v[160:163], a[52:55]
buffer_load_dword v39, v60, s[8:11], 0 offen
v_mfma_f32_16x16x32_bf16 a[60:63], v[156:159], v[164:167], a[60:63]
v_mfma_f32_16x16x32_bf16 a[116:119], v[156:159], v[168:171], a[116:119]
v_mfma_f32_16x16x32_bf16 a[124:127], v[156:159], v[172:175], a[124:127]
v_mfma_f32_16x16x32_bf16 a[180:183], v[156:159], v[176:179], a[180:183]
v_mfma_f32_16x16x32_bf16 a[188:191], v[156:159], v[180:183], a[188:191]
v_mfma_f32_16x16x32_bf16 a[244:247], v[156:159], v[184:187], a[244:247]
v_mfma_f32_16x16x32_bf16 a[252:255], v[156:159], v[188:191], a[252:255]
s_waitcnt vmcnt(15) lgkmcnt(0)
s_barrier
v_mfma_f32_16x16x32_bf16 a[0:3], v[64:67], v[96:99], a[0:3]
ds_read_b128 v[192:195], v33 offset:0
v_mfma_f32_16x16x32_bf16 a[8:11], v[64:67], v[100:103], a[8:11]
ds_read_b64_tr_b16 v[128:129], v8 offset:16384
v_mfma_f32_16x16x32_bf16 a[64:67], v[64:67], v[104:107], a[64:67]
ds_read_b64_tr_b16 v[130:131], v8 offset:17408
v_mfma_f32_16x16x32_bf16 a[72:75], v[64:67], v[108:111], a[72:75]
ds_read_b128 v[196:199], v33 offset:8192
v_mfma_f32_16x16x32_bf16 a[128:131], v[64:67], v[112:115], a[128:131]
ds_read_b128 v[160:163], v27 offset:0
v_mfma_f32_16x16x32_bf16 a[136:139], v[64:67], v[116:119], a[136:139]
v_mfma_f32_16x16x32_bf16 a[192:195], v[64:67], v[120:123], a[192:195]
ds_read_b128 v[200:203], v33 offset:16384
v_mfma_f32_16x16x32_bf16 a[200:203], v[64:67], v[124:127], a[200:203]
ds_read_b64_tr_b16 v[132:133], v9 offset:16384
v_mfma_f32_16x16x32_bf16 a[4:7], v[68:71], v[96:99], a[4:7]
ds_read_b64_tr_b16 v[134:135], v9 offset:17408
v_mfma_f32_16x16x32_bf16 a[12:15], v[68:71], v[100:103], a[12:15]
v_mfma_f32_16x16x32_bf16 a[68:71], v[68:71], v[104:107], a[68:71]
ds_read_b128 v[164:167], v26 offset:2048
s_add_u32 m0, s58, 49152
v_mfma_f32_16x16x32_bf16 a[76:79], v[68:71], v[108:111], a[76:79]
v_mfma_f32_16x16x32_bf16 a[132:135], v[68:71], v[112:115], a[132:135]
v_mfma_f32_16x16x32_bf16 a[140:143], v[68:71], v[116:119], a[140:143]
ds_read_b64_tr_b16 v[136:137], v10 offset:16384
s_add_u32 s30, s31, 1835008
v_mfma_f32_16x16x32_bf16 a[196:199], v[68:71], v[120:123], a[196:199]
ds_read_b64_tr_b16 v[138:139], v10 offset:17408
v_mfma_f32_16x16x32_bf16 a[204:207], v[68:71], v[124:127], a[204:207]
v_mfma_f32_16x16x32_bf16 a[16:19], v[72:75], v[96:99], a[16:19]
ds_read_b128 v[168:171], v27 offset:4096
v_mfma_f32_16x16x32_bf16 a[24:27], v[72:75], v[100:103], a[24:27]
buffer_load_dwordx4 v20, s[8:11], s30 offen offset:0 lds
v_mfma_f32_16x16x32_bf16 a[80:83], v[72:75], v[104:107], a[80:83]
v_mfma_f32_16x16x32_bf16 a[88:91], v[72:75], v[108:111], a[88:91]
ds_read_b64_tr_b16 v[140:141], v11 offset:16384
v_mfma_f32_16x16x32_bf16 a[144:147], v[72:75], v[112:115], a[144:147]
ds_read_b64_tr_b16 v[142:143], v11 offset:17408
v_mfma_f32_16x16x32_bf16 a[152:155], v[72:75], v[116:119], a[152:155]
buffer_load_dwordx4 v21, s[8:11], s30 offen offset:1024 lds
v_mfma_f32_16x16x32_bf16 a[208:211], v[72:75], v[120:123], a[208:211]
ds_read_b128 v[172:175], v26 offset:6144
v_mfma_f32_16x16x32_bf16 a[216:219], v[72:75], v[124:127], a[216:219]
buffer_load_dwordx4 v22, s[8:11], s30 offen offset:2048 lds
v_mfma_f32_16x16x32_bf16 a[20:23], v[76:79], v[96:99], a[20:23]
v_mfma_f32_16x16x32_bf16 a[28:31], v[76:79], v[100:103], a[28:31]
ds_read_b64_tr_b16 v[144:145], v12 offset:16384
v_mfma_f32_16x16x32_bf16 a[84:87], v[76:79], v[104:107], a[84:87]
ds_read_b64_tr_b16 v[146:147], v12 offset:17408
v_mfma_f32_16x16x32_bf16 a[92:95], v[76:79], v[108:111], a[92:95]
buffer_load_dwordx4 v23, s[8:11], s30 offen offset:3072 lds
v_mfma_f32_16x16x32_bf16 a[148:151], v[76:79], v[112:115], a[148:151]
ds_read_b128 v[176:179], v27 offset:8192
v_mfma_f32_16x16x32_bf16 a[156:159], v[76:79], v[116:119], a[156:159]
v_mfma_f32_16x16x32_bf16 a[212:215], v[76:79], v[120:123], a[212:215]
s_add_u32 m0, s35, 32768
v_mfma_f32_16x16x32_bf16 a[220:223], v[76:79], v[124:127], a[220:223]
ds_read_b64_tr_b16 v[148:149], v13 offset:16384
v_mfma_f32_16x16x32_bf16 a[32:35], v[80:83], v[96:99], a[32:35]
ds_read_b64_tr_b16 v[150:151], v13 offset:17408
v_mfma_f32_16x16x32_bf16 a[40:43], v[80:83], v[100:103], a[40:43]
s_add_u32 s30, s33, 512
v_mfma_f32_16x16x32_bf16 a[96:99], v[80:83], v[104:107], a[96:99]
ds_read_b128 v[180:183], v26 offset:10240
v_mfma_f32_16x16x32_bf16 a[104:107], v[80:83], v[108:111], a[104:107]
v_mfma_f32_16x16x32_bf16 a[160:163], v[80:83], v[112:115], a[160:163]
buffer_load_dwordx4 v40, s[4:7], s30 offen offset:0 lds
v_mfma_f32_16x16x32_bf16 a[168:171], v[80:83], v[116:119], a[168:171]
ds_read_b64_tr_b16 v[152:153], v14 offset:16384
v_mfma_f32_16x16x32_bf16 a[224:227], v[80:83], v[120:123], a[224:227]
ds_read_b64_tr_b16 v[154:155], v14 offset:17408
v_mfma_f32_16x16x32_bf16 a[232:235], v[80:83], v[124:127], a[232:235]
v_mfma_f32_16x16x32_bf16 a[36:39], v[84:87], v[96:99], a[36:39]
ds_read_b128 v[184:187], v27 offset:12288
v_mfma_f32_16x16x32_bf16 a[44:47], v[84:87], v[100:103], a[44:47]
buffer_load_dwordx4 v41, s[4:7], s30 offen offset:1024 lds
v_mfma_f32_16x16x32_bf16 a[100:103], v[84:87], v[104:107], a[100:103]
v_mfma_f32_16x16x32_bf16 a[108:111], v[84:87], v[108:111], a[108:111]
ds_read_b64_tr_b16 v[156:157], v15 offset:16384
v_mfma_f32_16x16x32_bf16 a[164:167], v[84:87], v[112:115], a[164:167]
ds_read_b64_tr_b16 v[158:159], v15 offset:17408
v_mfma_f32_16x16x32_bf16 a[172:175], v[84:87], v[116:119], a[172:175]
buffer_load_dwordx4 v42, s[4:7], s30 offen offset:2048 lds
v_mfma_f32_16x16x32_bf16 a[228:231], v[84:87], v[120:123], a[228:231]
ds_read_b128 v[188:191], v26 offset:14336
v_mfma_f32_16x16x32_bf16 a[236:239], v[84:87], v[124:127], a[236:239]
buffer_load_dwordx4 v43, s[4:7], s30 offen offset:3072 lds
v_mfma_f32_16x16x32_bf16 a[48:51], v[88:91], v[96:99], a[48:51]
v_mfma_f32_16x16x32_bf16 a[56:59], v[88:91], v[100:103], a[56:59]
v_mfma_f32_16x16x32_bf16 a[112:115], v[88:91], v[104:107], a[112:115]
s_mov_b32 s40, 0xffff0000
s_mov_b32 s41, 0x0
v_mfma_f32_16x16x32_bf16 a[120:123], v[88:91], v[108:111], a[120:123]
v_mfma_f32_16x16x32_bf16 a[176:179], v[88:91], v[112:115], a[176:179]
v_mfma_f32_16x16x32_bf16 a[184:187], v[88:91], v[116:119], a[184:187]
v_cndmask_b32 v60, v52, v59, s[40:41]
v_mfma_f32_16x16x32_bf16 a[240:243], v[88:91], v[120:123], a[240:243]
v_mfma_f32_16x16x32_bf16 a[248:251], v[88:91], v[124:127], a[248:251]
v_mfma_f32_16x16x32_bf16 a[52:55], v[92:95], v[96:99], a[52:55]
buffer_load_dword v39, v60, s[4:7], 0 offen offset:512
v_mfma_f32_16x16x32_bf16 a[60:63], v[92:95], v[100:103], a[60:63]
v_mfma_f32_16x16x32_bf16 a[116:119], v[92:95], v[104:107], a[116:119]
v_mfma_f32_16x16x32_bf16 a[124:127], v[92:95], v[108:111], a[124:127]
v_mfma_f32_16x16x32_bf16 a[180:183], v[92:95], v[112:115], a[180:183]
v_mfma_f32_16x16x32_bf16 a[188:191], v[92:95], v[116:119], a[188:191]
v_mfma_f32_16x16x32_bf16 a[244:247], v[92:95], v[120:123], a[244:247]
v_mfma_f32_16x16x32_bf16 a[252:255], v[92:95], v[124:127], a[252:255]
s_waitcnt vmcnt(10) lgkmcnt(0)
s_barrier
v_mfma_f32_16x16x32_bf16 a[0:3], v[128:131], v[160:163], a[0:3]
buffer_store_dword v34, v0, s[64:67], s59 offen sc1
v_mfma_f32_16x16x32_bf16 a[8:11], v[128:131], v[164:167], a[8:11]
ds_read_b64_tr_b16 v[64:65], v8 offset:32768
v_mfma_f32_16x16x32_bf16 a[64:67], v[128:131], v[168:171], a[64:67]
ds_read_b64_tr_b16 v[66:67], v8 offset:33792
v_mfma_f32_16x16x32_bf16 a[72:75], v[128:131], v[172:175], a[72:75]
buffer_store_dwordx4 v[192:195], v30, s[16:19], 0 offen sc1
v_mfma_f32_16x16x32_bf16 a[128:131], v[128:131], v[176:179], a[128:131]
ds_read_b128 v[96:99], v24 offset:0
v_mfma_f32_16x16x32_bf16 a[136:139], v[128:131], v[180:183], a[136:139]
v_mfma_f32_16x16x32_bf16 a[192:195], v[128:131], v[184:187], a[192:195]
buffer_store_dwordx4 v[196:199], v30, s[16:19], s76 offen sc1
v_mfma_f32_16x16x32_bf16 a[200:203], v[128:131], v[188:191], a[200:203]
ds_read_b64_tr_b16 v[68:69], v9 offset:32768
v_mfma_f32_16x16x32_bf16 a[4:7], v[132:135], v[160:163], a[4:7]
ds_read_b64_tr_b16 v[70:71], v9 offset:33792
v_mfma_f32_16x16x32_bf16 a[12:15], v[132:135], v[164:167], a[12:15]
buffer_store_dwordx4 v[200:203], v30, s[16:19], s29 offen sc1
v_mfma_f32_16x16x32_bf16 a[68:71], v[132:135], v[168:171], a[68:71]
ds_read_b128 v[100:103], v25 offset:2048
v_mfma_f32_16x16x32_bf16 a[76:79], v[132:135], v[172:175], a[76:79]
v_mfma_f32_16x16x32_bf16 a[132:135], v[132:135], v[176:179], a[132:135]
s_add_u32 m0, s58, 0
v_mfma_f32_16x16x32_bf16 a[140:143], v[132:135], v[180:183], a[140:143]
ds_read_b64_tr_b16 v[72:73], v10 offset:32768
v_mfma_f32_16x16x32_bf16 a[196:199], v[132:135], v[184:187], a[196:199]
ds_read_b64_tr_b16 v[74:75], v10 offset:33792
v_mfma_f32_16x16x32_bf16 a[204:207], v[132:135], v[188:191], a[204:207]
s_add_u32 s30, s31, 2097152
v_mfma_f32_16x16x32_bf16 a[16:19], v[136:139], v[160:163], a[16:19]
ds_read_b128 v[104:107], v24 offset:4096
v_mfma_f32_16x16x32_bf16 a[24:27], v[136:139], v[164:167], a[24:27]
v_mfma_f32_16x16x32_bf16 a[80:83], v[136:139], v[168:171], a[80:83]
buffer_load_dwordx4 v20, s[8:11], s30 offen offset:0 lds
v_mfma_f32_16x16x32_bf16 a[88:91], v[136:139], v[172:175], a[88:91]
ds_read_b64_tr_b16 v[76:77], v11 offset:32768
v_mfma_f32_16x16x32_bf16 a[144:147], v[136:139], v[176:179], a[144:147]
ds_read_b64_tr_b16 v[78:79], v11 offset:33792
v_mfma_f32_16x16x32_bf16 a[152:155], v[136:139], v[180:183], a[152:155]
v_mfma_f32_16x16x32_bf16 a[208:211], v[136:139], v[184:187], a[208:211]
ds_read_b128 v[108:111], v25 offset:6144
v_mfma_f32_16x16x32_bf16 a[216:219], v[136:139], v[188:191], a[216:219]
buffer_load_dwordx4 v21, s[8:11], s30 offen offset:1024 lds
v_mfma_f32_16x16x32_bf16 a[20:23], v[140:143], v[160:163], a[20:23]
v_mfma_f32_16x16x32_bf16 a[28:31], v[140:143], v[164:167], a[28:31]
ds_read_b64_tr_b16 v[80:81], v12 offset:32768
v_mfma_f32_16x16x32_bf16 a[84:87], v[140:143], v[168:171], a[84:87]
ds_read_b64_tr_b16 v[82:83], v12 offset:33792
v_mfma_f32_16x16x32_bf16 a[92:95], v[140:143], v[172:175], a[92:95]
buffer_load_dwordx4 v22, s[8:11], s30 offen offset:2048 lds
v_mfma_f32_16x16x32_bf16 a[148:151], v[140:143], v[176:179], a[148:151]
ds_read_b128 v[112:115], v24 offset:8192
v_mfma_f32_16x16x32_bf16 a[156:159], v[140:143], v[180:183], a[156:159]
buffer_load_dwordx4 v23, s[8:11], s30 offen offset:3072 lds
v_mfma_f32_16x16x32_bf16 a[212:215], v[140:143], v[184:187], a[212:215]
v_mfma_f32_16x16x32_bf16 a[220:223], v[140:143], v[188:191], a[220:223]
ds_read_b64_tr_b16 v[84:85], v13 offset:32768
s_add_u32 m0, s35, 36864
v_mfma_f32_16x16x32_bf16 a[32:35], v[144:147], v[160:163], a[32:35]
ds_read_b64_tr_b16 v[86:87], v13 offset:33792
v_mfma_f32_16x16x32_bf16 a[40:43], v[144:147], v[164:167], a[40:43]
v_mfma_f32_16x16x32_bf16 a[96:99], v[144:147], v[168:171], a[96:99]
ds_read_b128 v[116:119], v25 offset:10240
s_add_u32 s30, s33, 512
v_mfma_f32_16x16x32_bf16 a[104:107], v[144:147], v[172:175], a[104:107]
v_mfma_f32_16x16x32_bf16 a[160:163], v[144:147], v[176:179], a[160:163]
v_mfma_f32_16x16x32_bf16 a[168:171], v[144:147], v[180:183], a[168:171]
ds_read_b64_tr_b16 v[88:89], v14 offset:32768
v_mfma_f32_16x16x32_bf16 a[224:227], v[144:147], v[184:187], a[224:227]
ds_read_b64_tr_b16 v[90:91], v14 offset:33792
v_mfma_f32_16x16x32_bf16 a[232:235], v[144:147], v[188:191], a[232:235]
buffer_load_dwordx4 v44, s[4:7], s30 offen offset:0 lds
v_mfma_f32_16x16x32_bf16 a[36:39], v[148:151], v[160:163], a[36:39]
ds_read_b128 v[120:123], v24 offset:12288
v_mfma_f32_16x16x32_bf16 a[44:47], v[148:151], v[164:167], a[44:47]
buffer_load_dwordx4 v45, s[4:7], s30 offen offset:1024 lds
v_mfma_f32_16x16x32_bf16 a[100:103], v[148:151], v[168:171], a[100:103]
v_mfma_f32_16x16x32_bf16 a[108:111], v[148:151], v[172:175], a[108:111]
ds_read_b64_tr_b16 v[92:93], v15 offset:32768
v_mfma_f32_16x16x32_bf16 a[164:167], v[148:151], v[176:179], a[164:167]
ds_read_b64_tr_b16 v[94:95], v15 offset:33792
v_mfma_f32_16x16x32_bf16 a[172:175], v[148:151], v[180:183], a[172:175]
buffer_load_dwordx4 v46, s[4:7], s30 offen offset:2048 lds
v_mfma_f32_16x16x32_bf16 a[228:231], v[148:151], v[184:187], a[228:231]
ds_read_b128 v[124:127], v25 offset:14336
v_mfma_f32_16x16x32_bf16 a[236:239], v[148:151], v[188:191], a[236:239]
buffer_load_dwordx4 v47, s[4:7], s30 offen offset:3072 lds
v_mfma_f32_16x16x32_bf16 a[48:51], v[152:155], v[160:163], a[48:51]
v_mfma_f32_16x16x32_bf16 a[56:59], v[152:155], v[164:167], a[56:59]
v_mfma_f32_16x16x32_bf16 a[112:115], v[152:155], v[168:171], a[112:115]
s_mov_b32 s40, 0x0
s_mov_b32 s41, 0xff00
v_mfma_f32_16x16x32_bf16 a[120:123], v[152:155], v[172:175], a[120:123]
v_mfma_f32_16x16x32_bf16 a[176:179], v[152:155], v[176:179], a[176:179]
v_mfma_f32_16x16x32_bf16 a[184:187], v[152:155], v[180:183], a[184:187]
v_cndmask_b32 v60, v52, v57, s[40:41]
v_mfma_f32_16x16x32_bf16 a[240:243], v[152:155], v[184:187], a[240:243]
v_mfma_f32_16x16x32_bf16 a[248:251], v[152:155], v[188:191], a[248:251]
v_mfma_f32_16x16x32_bf16 a[52:55], v[156:159], v[160:163], a[52:55]
buffer_load_dword v39, v60, s[8:11], 0 offen
v_mfma_f32_16x16x32_bf16 a[60:63], v[156:159], v[164:167], a[60:63]
v_mfma_f32_16x16x32_bf16 a[116:119], v[156:159], v[168:171], a[116:119]
v_mfma_f32_16x16x32_bf16 a[124:127], v[156:159], v[172:175], a[124:127]
v_mfma_f32_16x16x32_bf16 a[180:183], v[156:159], v[176:179], a[180:183]
v_mfma_f32_16x16x32_bf16 a[188:191], v[156:159], v[180:183], a[188:191]
tp0_p1:
s_cbranch_execz tp0_ret
v_mfma_f32_16x16x32_bf16 a[244:247], v[156:159], v[184:187], a[244:247]
v_mfma_f32_16x16x32_bf16 a[252:255], v[156:159], v[188:191], a[252:255]
s_waitcnt vmcnt(18) lgkmcnt(0)
s_barrier
v_mfma_f32_16x16x32_bf16 a[0:3], v[64:67], v[96:99], a[0:3]
s_add_u32 m0, s58, 16384
v_mfma_f32_16x16x32_bf16 a[8:11], v[64:67], v[100:103], a[8:11]
ds_read_b64_tr_b16 v[128:129], v8 offset:49152
v_mfma_f32_16x16x32_bf16 a[64:67], v[64:67], v[104:107], a[64:67]
ds_read_b64_tr_b16 v[130:131], v8 offset:50176
v_mfma_f32_16x16x32_bf16 a[72:75], v[64:67], v[108:111], a[72:75]
v_mfma_f32_16x16x32_bf16 a[128:131], v[64:67], v[112:115], a[128:131]
ds_read_b128 v[160:163], v25 offset:0
s_add_u32 s30, s31, 2359296
v_mfma_f32_16x16x32_bf16 a[136:139], v[64:67], v[116:119], a[136:139]
v_mfma_f32_16x16x32_bf16 a[192:195], v[64:67], v[120:123], a[192:195]
v_mfma_f32_16x16x32_bf16 a[200:203], v[64:67], v[124:127], a[200:203]
ds_read_b64_tr_b16 v[132:133], v9 offset:49152
v_mfma_f32_16x16x32_bf16 a[4:7], v[68:71], v[96:99], a[4:7]
ds_read_b64_tr_b16 v[134:135], v9 offset:50176
v_mfma_f32_16x16x32_bf16 a[12:15], v[68:71], v[100:103], a[12:15]
buffer_load_dwordx4 v20, s[8:11], s30 offen offset:0 lds
v_mfma_f32_16x16x32_bf16 a[68:71], v[68:71], v[104:107], a[68:71]
ds_read_b128 v[164:167], v24 offset:2048
v_mfma_f32_16x16x32_bf16 a[76:79], v[68:71], v[108:111], a[76:79]
v_mfma_f32_16x16x32_bf16 a[132:135], v[68:71], v[112:115], a[132:135]
buffer_load_dwordx4 v21, s[8:11], s30 offen offset:1024 lds
v_mfma_f32_16x16x32_bf16 a[140:143], v[68:71], v[116:119], a[140:143]
ds_read_b64_tr_b16 v[136:137], v10 offset:49152
v_mfma_f32_16x16x32_bf16 a[196:199], v[68:71], v[120:123], a[196:199]
ds_read_b64_tr_b16 v[138:139], v10 offset:50176
v_mfma_f32_16x16x32_bf16 a[204:207], v[68:71], v[124:127], a[204:207]
v_mfma_f32_16x16x32_bf16 a[16:19], v[72:75], v[96:99], a[16:19]
ds_read_b128 v[168:171], v25 offset:4096
v_mfma_f32_16x16x32_bf16 a[24:27], v[72:75], v[100:103], a[24:27]
buffer_load_dwordx4 v22, s[8:11], s30 offen offset:2048 lds
v_mfma_f32_16x16x32_bf16 a[80:83], v[72:75], v[104:107], a[80:83]
v_mfma_f32_16x16x32_bf16 a[88:91], v[72:75], v[108:111], a[88:91]
ds_read_b64_tr_b16 v[140:141], v11 offset:49152
v_mfma_f32_16x16x32_bf16 a[144:147], v[72:75], v[112:115], a[144:147]
ds_read_b64_tr_b16 v[142:143], v11 offset:50176
v_mfma_f32_16x16x32_bf16 a[152:155], v[72:75], v[116:119], a[152:155]
buffer_load_dwordx4 v23, s[8:11], s30 offen offset:3072 lds
v_mfma_f32_16x16x32_bf16 a[208:211], v[72:75], v[120:123], a[208:211]
ds_read_b128 v[172:175], v24 offset:6144
v_mfma_f32_16x16x32_bf16 a[216:219], v[72:75], v[124:127], a[216:219]
v_mfma_f32_16x16x32_bf16 a[20:23], v[76:79], v[96:99], a[20:23]
s_add_u32 m0, s35, 65536
v_mfma_f32_16x16x32_bf16 a[28:31], v[76:79], v[100:103], a[28:31]
ds_read_b64_tr_b16 v[144:145], v12 offset:49152
v_mfma_f32_16x16x32_bf16 a[84:87], v[76:79], v[104:107], a[84:87]
ds_read_b64_tr_b16 v[146:147], v12 offset:50176
v_mfma_f32_16x16x32_bf16 a[92:95], v[76:79], v[108:111], a[92:95]
v_mfma_f32_16x16x32_bf16 a[148:151], v[76:79], v[112:115], a[148:151]
ds_read_b128 v[176:179], v25 offset:8192
s_add_u32 s30, s33, 640
v_mfma_f32_16x16x32_bf16 a[156:159], v[76:79], v[116:119], a[156:159]
v_mfma_f32_16x16x32_bf16 a[212:215], v[76:79], v[120:123], a[212:215]
v_mfma_f32_16x16x32_bf16 a[220:223], v[76:79], v[124:127], a[220:223]
ds_read_b64_tr_b16 v[148:149], v13 offset:49152
v_mfma_f32_16x16x32_bf16 a[32:35], v[80:83], v[96:99], a[32:35]
ds_read_b64_tr_b16 v[150:151], v13 offset:50176
v_mfma_f32_16x16x32_bf16 a[40:43], v[80:83], v[100:103], a[40:43]
buffer_load_dwordx4 v40, s[4:7], s30 offen offset:0 lds
v_mfma_f32_16x16x32_bf16 a[96:99], v[80:83], v[104:107], a[96:99]
ds_read_b128 v[180:183], v24 offset:10240
v_mfma_f32_16x16x32_bf16 a[104:107], v[80:83], v[108:111], a[104:107]
v_mfma_f32_16x16x32_bf16 a[160:163], v[80:83], v[112:115], a[160:163]
buffer_load_dwordx4 v41, s[4:7], s30 offen offset:1024 lds
v_mfma_f32_16x16x32_bf16 a[168:171], v[80:83], v[116:119], a[168:171]
ds_read_b64_tr_b16 v[152:153], v14 offset:49152
v_mfma_f32_16x16x32_bf16 a[224:227], v[80:83], v[120:123], a[224:227]
ds_read_b64_tr_b16 v[154:155], v14 offset:50176
v_mfma_f32_16x16x32_bf16 a[232:235], v[80:83], v[124:127], a[232:235]
v_mfma_f32_16x16x32_bf16 a[36:39], v[84:87], v[96:99], a[36:39]
ds_read_b128 v[184:187], v25 offset:12288
v_mfma_f32_16x16x32_bf16 a[44:47], v[84:87], v[100:103], a[44:47]
buffer_load_dwordx4 v42, s[4:7], s30 offen offset:2048 lds
v_mfma_f32_16x16x32_bf16 a[100:103], v[84:87], v[104:107], a[100:103]
v_mfma_f32_16x16x32_bf16 a[108:111], v[84:87], v[108:111], a[108:111]
ds_read_b64_tr_b16 v[156:157], v15 offset:49152
v_mfma_f32_16x16x32_bf16 a[164:167], v[84:87], v[112:115], a[164:167]
ds_read_b64_tr_b16 v[158:159], v15 offset:50176
v_mfma_f32_16x16x32_bf16 a[172:175], v[84:87], v[116:119], a[172:175]
buffer_load_dwordx4 v43, s[4:7], s30 offen offset:3072 lds
v_mfma_f32_16x16x32_bf16 a[228:231], v[84:87], v[120:123], a[228:231]
ds_read_b128 v[188:191], v24 offset:14336
v_mfma_f32_16x16x32_bf16 a[236:239], v[84:87], v[124:127], a[236:239]
v_mfma_f32_16x16x32_bf16 a[48:51], v[88:91], v[96:99], a[48:51]
s_mov_b32 s40, 0x0
s_mov_b32 s41, 0xffff
v_mfma_f32_16x16x32_bf16 a[56:59], v[88:91], v[100:103], a[56:59]
v_mfma_f32_16x16x32_bf16 a[112:115], v[88:91], v[104:107], a[112:115]
v_mfma_f32_16x16x32_bf16 a[120:123], v[88:91], v[108:111], a[120:123]
v_mfma_f32_16x16x32_bf16 a[176:179], v[88:91], v[112:115], a[176:179]
v_cndmask_b32 v60, v52, v59, s[40:41]
v_mfma_f32_16x16x32_bf16 a[184:187], v[88:91], v[116:119], a[184:187]
v_mfma_f32_16x16x32_bf16 a[240:243], v[88:91], v[120:123], a[240:243]
v_mfma_f32_16x16x32_bf16 a[248:251], v[88:91], v[124:127], a[248:251]
v_mfma_f32_16x16x32_bf16 a[52:55], v[92:95], v[96:99], a[52:55]
buffer_load_dword v39, v60, s[4:7], 0 offen offset:512
v_mfma_f32_16x16x32_bf16 a[60:63], v[92:95], v[100:103], a[60:63]
v_mfma_f32_16x16x32_bf16 a[116:119], v[92:95], v[104:107], a[116:119]
v_mfma_f32_16x16x32_bf16 a[124:127], v[92:95], v[108:111], a[124:127]
v_mfma_f32_16x16x32_bf16 a[180:183], v[92:95], v[112:115], a[180:183]
v_mfma_f32_16x16x32_bf16 a[188:191], v[92:95], v[116:119], a[188:191]
v_mfma_f32_16x16x32_bf16 a[244:247], v[92:95], v[120:123], a[244:247]
v_mfma_f32_16x16x32_bf16 a[252:255], v[92:95], v[124:127], a[252:255]
s_waitcnt vmcnt(10) lgkmcnt(0)
s_barrier
v_mfma_f32_16x16x32_bf16 a[0:3], v[128:131], v[160:163], a[0:3]
s_add_u32 m0, s58, 32768
v_mfma_f32_16x16x32_bf16 a[8:11], v[128:131], v[164:167], a[8:11]
ds_read_b64_tr_b16 v[64:65], v8 offset:0
v_mfma_f32_16x16x32_bf16 a[64:67], v[128:131], v[168:171], a[64:67]
ds_read_b64_tr_b16 v[66:67], v8 offset:1024
v_mfma_f32_16x16x32_bf16 a[72:75], v[128:131], v[172:175], a[72:75]
v_mfma_f32_16x16x32_bf16 a[128:131], v[128:131], v[176:179], a[128:131]
ds_read_b128 v[96:99], v24 offset:32768
s_add_u32 s30, s31, 2621440
v_mfma_f32_16x16x32_bf16 a[136:139], v[128:131], v[180:183], a[136:139]
v_mfma_f32_16x16x32_bf16 a[192:195], v[128:131], v[184:187], a[192:195]
v_mfma_f32_16x16x32_bf16 a[200:203], v[128:131], v[188:191], a[200:203]
ds_read_b64_tr_b16 v[68:69], v9 offset:0
v_mfma_f32_16x16x32_bf16 a[4:7], v[132:135], v[160:163], a[4:7]
ds_read_b64_tr_b16 v[70:71], v9 offset:1024
v_mfma_f32_16x16x32_bf16 a[12:15], v[132:135], v[164:167], a[12:15]
buffer_load_dwordx4 v20, s[8:11], s30 offen offset:0 lds
v_mfma_f32_16x16x32_bf16 a[68:71], v[132:135], v[168:171], a[68:71]
ds_read_b128 v[100:103], v25 offset:34816
v_mfma_f32_16x16x32_bf16 a[76:79], v[132:135], v[172:175], a[76:79]
v_mfma_f32_16x16x32_bf16 a[132:135], v[132:135], v[176:179], a[132:135]
buffer_load_dwordx4 v21, s[8:11], s30 offen offset:1024 lds
v_mfma_f32_16x16x32_bf16 a[140:143], v[132:135], v[180:183], a[140:143]
ds_read_b64_tr_b16 v[72:73], v10 offset:0
v_mfma_f32_16x16x32_bf16 a[196:199], v[132:135], v[184:187], a[196:199]
ds_read_b64_tr_b16 v[74:75], v10 offset:1024
v_mfma_f32_16x16x32_bf16 a[204:207], v[132:135], v[188:191], a[204:207]
v_mfma_f32_16x16x32_bf16 a[16:19], v[136:139], v[160:163], a[16:19]
ds_read_b128 v[104:107], v24 offset:36864
v_mfma_f32_16x16x32_bf16 a[24:27], v[136:139], v[164:167], a[24:27]
buffer_load_dwordx4 v22, s[8:11], s30 offen offset:2048 lds
v_mfma_f32_16x16x32_bf16 a[80:83], v[136:139], v[168:171], a[80:83]
v_mfma_f32_16x16x32_bf16 a[88:91], v[136:139], v[172:175], a[88:91]
ds_read_b64_tr_b16 v[76:77], v11 offset:0
v_mfma_f32_16x16x32_bf16 a[144:147], v[136:139], v[176:179], a[144:147]
ds_read_b64_tr_b16 v[78:79], v11 offset:1024
v_mfma_f32_16x16x32_bf16 a[152:155], v[136:139], v[180:183], a[152:155]
buffer_load_dwordx4 v23, s[8:11], s30 offen offset:3072 lds
v_mfma_f32_16x16x32_bf16 a[208:211], v[136:139], v[184:187], a[208:211]
ds_read_b128 v[108:111], v25 offset:38912
v_mfma_f32_16x16x32_bf16 a[216:219], v[136:139], v[188:191], a[216:219]
v_mfma_f32_16x16x32_bf16 a[20:23], v[140:143], v[160:163], a[20:23]
s_add_u32 m0, s35, 69632
v_mfma_f32_16x16x32_bf16 a[28:31], v[140:143], v[164:167], a[28:31]
ds_read_b64_tr_b16 v[80:81], v12 offset:0
v_mfma_f32_16x16x32_bf16 a[84:87], v[140:143], v[168:171], a[84:87]
ds_read_b64_tr_b16 v[82:83], v12 offset:1024
v_mfma_f32_16x16x32_bf16 a[92:95], v[140:143], v[172:175], a[92:95]
v_mfma_f32_16x16x32_bf16 a[148:151], v[140:143], v[176:179], a[148:151]
ds_read_b128 v[112:115], v24 offset:40960
s_add_u32 s30, s33, 640
v_mfma_f32_16x16x32_bf16 a[156:159], v[140:143], v[180:183], a[156:159]
v_mfma_f32_16x16x32_bf16 a[212:215], v[140:143], v[184:187], a[212:215]
v_mfma_f32_16x16x32_bf16 a[220:223], v[140:143], v[188:191], a[220:223]
ds_read_b64_tr_b16 v[84:85], v13 offset:0
v_mfma_f32_16x16x32_bf16 a[32:35], v[144:147], v[160:163], a[32:35]
ds_read_b64_tr_b16 v[86:87], v13 offset:1024
v_mfma_f32_16x16x32_bf16 a[40:43], v[144:147], v[164:167], a[40:43]
buffer_load_dwordx4 v44, s[4:7], s30 offen offset:0 lds
v_mfma_f32_16x16x32_bf16 a[96:99], v[144:147], v[168:171], a[96:99]
ds_read_b128 v[116:119], v25 offset:43008
v_mfma_f32_16x16x32_bf16 a[104:107], v[144:147], v[172:175], a[104:107]
v_mfma_f32_16x16x32_bf16 a[160:163], v[144:147], v[176:179], a[160:163]
buffer_load_dwordx4 v45, s[4:7], s30 offen offset:1024 lds
v_mfma_f32_16x16x32_bf16 a[168:171], v[144:147], v[180:183], a[168:171]
ds_read_b64_tr_b16 v[88:89], v14 offset:0
v_mfma_f32_16x16x32_bf16 a[224:227], v[144:147], v[184:187], a[224:227]
ds_read_b64_tr_b16 v[90:91], v14 offset:1024
v_mfma_f32_16x16x32_bf16 a[232:235], v[144:147], v[188:191], a[232:235]
v_mfma_f32_16x16x32_bf16 a[36:39], v[148:151], v[160:163], a[36:39]
ds_read_b128 v[120:123], v24 offset:45056
v_mfma_f32_16x16x32_bf16 a[44:47], v[148:151], v[164:167], a[44:47]
buffer_load_dwordx4 v46, s[4:7], s30 offen offset:2048 lds
v_mfma_f32_16x16x32_bf16 a[100:103], v[148:151], v[168:171], a[100:103]
v_mfma_f32_16x16x32_bf16 a[108:111], v[148:151], v[172:175], a[108:111]
ds_read_b64_tr_b16 v[92:93], v15 offset:0
v_mfma_f32_16x16x32_bf16 a[164:167], v[148:151], v[176:179], a[164:167]
ds_read_b64_tr_b16 v[94:95], v15 offset:1024
v_mfma_f32_16x16x32_bf16 a[172:175], v[148:151], v[180:183], a[172:175]
buffer_load_dwordx4 v47, s[4:7], s30 offen offset:3072 lds
v_mfma_f32_16x16x32_bf16 a[228:231], v[148:151], v[184:187], a[228:231]
ds_read_b128 v[124:127], v25 offset:47104
v_mfma_f32_16x16x32_bf16 a[236:239], v[148:151], v[188:191], a[236:239]
v_mfma_f32_16x16x32_bf16 a[48:51], v[152:155], v[160:163], a[48:51]
s_mov_b32 s40, 0x0
s_mov_b32 s41, 0xff0000
v_mfma_f32_16x16x32_bf16 a[56:59], v[152:155], v[164:167], a[56:59]
v_mfma_f32_16x16x32_bf16 a[112:115], v[152:155], v[168:171], a[112:115]
v_mfma_f32_16x16x32_bf16 a[120:123], v[152:155], v[172:175], a[120:123]
v_mfma_f32_16x16x32_bf16 a[176:179], v[152:155], v[176:179], a[176:179]
v_cndmask_b32 v60, v52, v57, s[40:41]
v_mfma_f32_16x16x32_bf16 a[184:187], v[152:155], v[180:183], a[184:187]
v_mfma_f32_16x16x32_bf16 a[240:243], v[152:155], v[184:187], a[240:243]
v_mfma_f32_16x16x32_bf16 a[248:251], v[152:155], v[188:191], a[248:251]
v_mfma_f32_16x16x32_bf16 a[52:55], v[156:159], v[160:163], a[52:55]
buffer_load_dword v39, v60, s[8:11], 0 offen
v_mfma_f32_16x16x32_bf16 a[60:63], v[156:159], v[164:167], a[60:63]
v_mfma_f32_16x16x32_bf16 a[116:119], v[156:159], v[168:171], a[116:119]
v_mfma_f32_16x16x32_bf16 a[124:127], v[156:159], v[172:175], a[124:127]
v_mfma_f32_16x16x32_bf16 a[180:183], v[156:159], v[176:179], a[180:183]
v_mfma_f32_16x16x32_bf16 a[188:191], v[156:159], v[180:183], a[188:191]
v_mfma_f32_16x16x32_bf16 a[244:247], v[156:159], v[184:187], a[244:247]
v_mfma_f32_16x16x32_bf16 a[252:255], v[156:159], v[188:191], a[252:255]
s_waitcnt vmcnt(14) lgkmcnt(0)
s_barrier
v_mfma_f32_16x16x32_bf16 a[0:3], v[64:67], v[96:99], a[0:3]
buffer_atomic_add v1, v31, s[20:23], s38 offen
v_mfma_f32_16x16x32_bf16 a[8:11], v[64:67], v[100:103], a[8:11]
ds_read_b64_tr_b16 v[128:129], v8 offset:16384
v_mfma_f32_16x16x32_bf16 a[64:67], v[64:67], v[104:107], a[64:67]
ds_read_b64_tr_b16 v[130:131], v8 offset:17408
v_mfma_f32_16x16x32_bf16 a[72:75], v[64:67], v[108:111], a[72:75]
s_add_u32 m0, s58, 49152
v_mfma_f32_16x16x32_bf16 a[128:131], v[64:67], v[112:115], a[128:131]
ds_read_b128 v[160:163], v25 offset:32768
v_mfma_f32_16x16x32_bf16 a[136:139], v[64:67], v[116:119], a[136:139]
v_mfma_f32_16x16x32_bf16 a[192:195], v[64:67], v[120:123], a[192:195]
s_add_u32 s30, s31, 2883584
v_mfma_f32_16x16x32_bf16 a[200:203], v[64:67], v[124:127], a[200:203]
ds_read_b64_tr_b16 v[132:133], v9 offset:16384
v_mfma_f32_16x16x32_bf16 a[4:7], v[68:71], v[96:99], a[4:7]
ds_read_b64_tr_b16 v[134:135], v9 offset:17408
v_mfma_f32_16x16x32_bf16 a[12:15], v[68:71], v[100:103], a[12:15]
buffer_load_dwordx4 v20, s[8:11], s30 offen offset:0 lds
v_mfma_f32_16x16x32_bf16 a[68:71], v[68:71], v[104:107], a[68:71]
ds_read_b128 v[164:167], v24 offset:34816
v_mfma_f32_16x16x32_bf16 a[76:79], v[68:71], v[108:111], a[76:79]
v_mfma_f32_16x16x32_bf16 a[132:135], v[68:71], v[112:115], a[132:135]
buffer_load_dwordx4 v21, s[8:11], s30 offen offset:1024 lds
v_mfma_f32_16x16x32_bf16 a[140:143], v[68:71], v[116:119], a[140:143]
ds_read_b64_tr_b16 v[136:137], v10 offset:16384
v_mfma_f32_16x16x32_bf16 a[196:199], v[68:71], v[120:123], a[196:199]
ds_read_b64_tr_b16 v[138:139], v10 offset:17408
v_mfma_f32_16x16x32_bf16 a[204:207], v[68:71], v[124:127], a[204:207]
buffer_load_dwordx4 v22, s[8:11], s30 offen offset:2048 lds
v_mfma_f32_16x16x32_bf16 a[16:19], v[72:75], v[96:99], a[16:19]
ds_read_b128 v[168:171], v25 offset:36864
v_mfma_f32_16x16x32_bf16 a[24:27], v[72:75], v[100:103], a[24:27]
v_mfma_f32_16x16x32_bf16 a[80:83], v[72:75], v[104:107], a[80:83]
buffer_load_dwordx4 v23, s[8:11], s30 offen offset:3072 lds
v_mfma_f32_16x16x32_bf16 a[88:91], v[72:75], v[108:111], a[88:91]
ds_read_b64_tr_b16 v[140:141], v11 offset:16384
v_mfma_f32_16x16x32_bf16 a[144:147], v[72:75], v[112:115], a[144:147]
ds_read_b64_tr_b16 v[142:143], v11 offset:17408
v_mfma_f32_16x16x32_bf16 a[152:155], v[72:75], v[116:119], a[152:155]
v_mfma_f32_16x16x32_bf16 a[208:211], v[72:75], v[120:123], a[208:211]
ds_read_b128 v[172:175], v24 offset:38912
s_add_u32 m0, s35, 0
v_mfma_f32_16x16x32_bf16 a[216:219], v[72:75], v[124:127], a[216:219]
v_mfma_f32_16x16x32_bf16 a[20:23], v[76:79], v[96:99], a[20:23]
v_mfma_f32_16x16x32_bf16 a[28:31], v[76:79], v[100:103], a[28:31]
ds_read_b64_tr_b16 v[144:145], v12 offset:16384
s_add_u32 s30, s33, 768
v_mfma_f32_16x16x32_bf16 a[84:87], v[76:79], v[104:107], a[84:87]
ds_read_b64_tr_b16 v[146:147], v12 offset:17408
v_mfma_f32_16x16x32_bf16 a[92:95], v[76:79], v[108:111], a[92:95]
v_mfma_f32_16x16x32_bf16 a[148:151], v[76:79], v[112:115], a[148:151]
ds_read_b128 v[176:179], v25 offset:40960
v_mfma_f32_16x16x32_bf16 a[156:159], v[76:79], v[116:119], a[156:159]
buffer_load_dwordx4 v40, s[4:7], s30 offen offset:0 lds
v_mfma_f32_16x16x32_bf16 a[212:215], v[76:79], v[120:123], a[212:215]
v_mfma_f32_16x16x32_bf16 a[220:223], v[76:79], v[124:127], a[220:223]
ds_read_b64_tr_b16 v[148:149], v13 offset:16384
v_mfma_f32_16x16x32_bf16 a[32:35], v[80:83], v[96:99], a[32:35]
ds_read_b64_tr_b16 v[150:151], v13 offset:17408
v_mfma_f32_16x16x32_bf16 a[40:43], v[80:83], v[100:103], a[40:43]
buffer_load_dwordx4 v41, s[4:7], s30 offen offset:1024 lds
v_mfma_f32_16x16x32_bf16 a[96:99], v[80:83], v[104:107], a[96:99]
ds_read_b128 v[180:183], v24 offset:43008
v_mfma_f32_16x16x32_bf16 a[104:107], v[80:83], v[108:111], a[104:107]
buffer_load_dwordx4 v42, s[4:7], s30 offen offset:2048 lds
v_mfma_f32_16x16x32_bf16 a[160:163], v[80:83], v[112:115], a[160:163]
v_mfma_f32_16x16x32_bf16 a[168:171], v[80:83], v[116:119], a[168:171]
ds_read_b64_tr_b16 v[152:153], v14 offset:16384
v_mfma_f32_16x16x32_bf16 a[224:227], v[80:83], v[120:123], a[224:227]
ds_read_b64_tr_b16 v[154:155], v14 offset:17408
v_mfma_f32_16x16x32_bf16 a[232:235], v[80:83], v[124:127], a[232:235]
buffer_load_dwordx4 v43, s[4:7], s30 offen offset:3072 lds
v_mfma_f32_16x16x32_bf16 a[36:39], v[84:87], v[96:99], a[36:39]
ds_read_b128 v[184:187], v25 offset:45056
v_mfma_f32_16x16x32_bf16 a[44:47], v[84:87], v[100:103], a[44:47]
s_mov_b32 s40, 0x0
s_mov_b32 s41, 0xffff0000
v_mfma_f32_16x16x32_bf16 a[100:103], v[84:87], v[104:107], a[100:103]
v_mfma_f32_16x16x32_bf16 a[108:111], v[84:87], v[108:111], a[108:111]
ds_read_b64_tr_b16 v[156:157], v15 offset:16384
v_mfma_f32_16x16x32_bf16 a[164:167], v[84:87], v[112:115], a[164:167]
ds_read_b64_tr_b16 v[158:159], v15 offset:17408
v_cndmask_b32 v60, v52, v59, s[40:41]
v_mfma_f32_16x16x32_bf16 a[172:175], v[84:87], v[116:119], a[172:175]
v_mfma_f32_16x16x32_bf16 a[228:231], v[84:87], v[120:123], a[228:231]
ds_read_b128 v[188:191], v24 offset:47104
v_mfma_f32_16x16x32_bf16 a[236:239], v[84:87], v[124:127], a[236:239]
buffer_load_dword v39, v60, s[4:7], 0 offen offset:512
v_mfma_f32_16x16x32_bf16 a[48:51], v[88:91], v[96:99], a[48:51]
v_mfma_f32_16x16x32_bf16 a[56:59], v[88:91], v[100:103], a[56:59]
v_mfma_f32_16x16x32_bf16 a[112:115], v[88:91], v[104:107], a[112:115]
s_mov_b32 s40, 0xf
s_mov_b32 s41, 0xf
v_mfma_f32_16x16x32_bf16 a[120:123], v[88:91], v[108:111], a[120:123]
v_mfma_f32_16x16x32_bf16 a[176:179], v[88:91], v[112:115], a[176:179]
v_mfma_f32_16x16x32_bf16 a[184:187], v[88:91], v[116:119], a[184:187]
v_cndmask_b32 v60, v52, v35, s[40:41]
v_mfma_f32_16x16x32_bf16 a[240:243], v[88:91], v[120:123], a[240:243]
v_mfma_f32_16x16x32_bf16 a[248:251], v[88:91], v[124:127], a[248:251]
v_mfma_f32_16x16x32_bf16 a[52:55], v[92:95], v[96:99], a[52:55]
buffer_load_dword v39, v60, s[60:63], 0 offen
v_mfma_f32_16x16x32_bf16 a[60:63], v[92:95], v[100:103], a[60:63]
v_mfma_f32_16x16x32_bf16 a[116:119], v[92:95], v[104:107], a[116:119]
v_mfma_f32_16x16x32_bf16 a[124:127], v[92:95], v[108:111], a[124:127]
v_mfma_f32_16x16x32_bf16 a[180:183], v[92:95], v[112:115], a[180:183]
v_mfma_f32_16x16x32_bf16 a[188:191], v[92:95], v[116:119], a[188:191]
v_mfma_f32_16x16x32_bf16 a[244:247], v[92:95], v[120:123], a[244:247]
v_mfma_f32_16x16x32_bf16 a[252:255], v[92:95], v[124:127], a[252:255]
s_waitcnt vmcnt(12) lgkmcnt(0)
s_barrier
v_mfma_f32_16x16x32_bf16 a[0:3], v[128:131], v[160:163], a[0:3]
s_add_u32 m0, s58, 0
v_mfma_f32_16x16x32_bf16 a[8:11], v[128:131], v[164:167], a[8:11]
ds_read_b64_tr_b16 v[64:65], v8 offset:32768
v_mfma_f32_16x16x32_bf16 a[64:67], v[128:131], v[168:171], a[64:67]
ds_read_b64_tr_b16 v[66:67], v8 offset:33792
v_mfma_f32_16x16x32_bf16 a[72:75], v[128:131], v[172:175], a[72:75]
v_mfma_f32_16x16x32_bf16 a[128:131], v[128:131], v[176:179], a[128:131]
ds_read_b128 v[96:99], v26 offset:0
s_add_u32 s30, s31, 3145728
v_mfma_f32_16x16x32_bf16 a[136:139], v[128:131], v[180:183], a[136:139]
v_mfma_f32_16x16x32_bf16 a[192:195], v[128:131], v[184:187], a[192:195]
v_mfma_f32_16x16x32_bf16 a[200:203], v[128:131], v[188:191], a[200:203]
ds_read_b64_tr_b16 v[68:69], v9 offset:32768
v_mfma_f32_16x16x32_bf16 a[4:7], v[132:135], v[160:163], a[4:7]
ds_read_b64_tr_b16 v[70:71], v9 offset:33792
v_mfma_f32_16x16x32_bf16 a[12:15], v[132:135], v[164:167], a[12:15]
buffer_load_dwordx4 v20, s[8:11], s30 offen offset:0 lds
v_mfma_f32_16x16x32_bf16 a[68:71], v[132:135], v[168:171], a[68:71]
ds_read_b128 v[100:103], v27 offset:2048
v_mfma_f32_16x16x32_bf16 a[76:79], v[132:135], v[172:175], a[76:79]
v_mfma_f32_16x16x32_bf16 a[132:135], v[132:135], v[176:179], a[132:135]
buffer_load_dwordx4 v21, s[8:11], s30 offen offset:1024 lds
v_mfma_f32_16x16x32_bf16 a[140:143], v[132:135], v[180:183], a[140:143]
ds_read_b64_tr_b16 v[72:73], v10 offset:32768
v_mfma_f32_16x16x32_bf16 a[196:199], v[132:135], v[184:187], a[196:199]
ds_read_b64_tr_b16 v[74:75], v10 offset:33792
v_mfma_f32_16x16x32_bf16 a[204:207], v[132:135], v[188:191], a[204:207]
v_mfma_f32_16x16x32_bf16 a[16:19], v[136:139], v[160:163], a[16:19]
ds_read_b128 v[104:107], v26 offset:4096
v_mfma_f32_16x16x32_bf16 a[24:27], v[136:139], v[164:167], a[24:27]
buffer_load_dwordx4 v22, s[8:11], s30 offen offset:2048 lds
v_mfma_f32_16x16x32_bf16 a[80:83], v[136:139], v[168:171], a[80:83]
v_mfma_f32_16x16x32_bf16 a[88:91], v[136:139], v[172:175], a[88:91]
ds_read_b64_tr_b16 v[76:77], v11 offset:32768
v_mfma_f32_16x16x32_bf16 a[144:147], v[136:139], v[176:179], a[144:147]
ds_read_b64_tr_b16 v[78:79], v11 offset:33792
v_mfma_f32_16x16x32_bf16 a[152:155], v[136:139], v[180:183], a[152:155]
buffer_load_dwordx4 v23, s[8:11], s30 offen offset:3072 lds
v_mfma_f32_16x16x32_bf16 a[208:211], v[136:139], v[184:187], a[208:211]
ds_read_b128 v[108:111], v27 offset:6144
v_mfma_f32_16x16x32_bf16 a[216:219], v[136:139], v[188:191], a[216:219]
v_mfma_f32_16x16x32_bf16 a[20:23], v[140:143], v[160:163], a[20:23]
s_add_u32 m0, s35, 4096
v_mfma_f32_16x16x32_bf16 a[28:31], v[140:143], v[164:167], a[28:31]
ds_read_b64_tr_b16 v[80:81], v12 offset:32768
v_mfma_f32_16x16x32_bf16 a[84:87], v[140:143], v[168:171], a[84:87]
ds_read_b64_tr_b16 v[82:83], v12 offset:33792
v_mfma_f32_16x16x32_bf16 a[92:95], v[140:143], v[172:175], a[92:95]
v_mfma_f32_16x16x32_bf16 a[148:151], v[140:143], v[176:179], a[148:151]
ds_read_b128 v[112:115], v26 offset:8192
s_add_u32 s30, s33, 768
v_mfma_f32_16x16x32_bf16 a[156:159], v[140:143], v[180:183], a[156:159]
v_mfma_f32_16x16x32_bf16 a[212:215], v[140:143], v[184:187], a[212:215]
v_mfma_f32_16x16x32_bf16 a[220:223], v[140:143], v[188:191], a[220:223]
ds_read_b64_tr_b16 v[84:85], v13 offset:32768
v_mfma_f32_16x16x32_bf16 a[32:35], v[144:147], v[160:163], a[32:35]
ds_read_b64_tr_b16 v[86:87], v13 offset:33792
v_mfma_f32_16x16x32_bf16 a[40:43], v[144:147], v[164:167], a[40:43]
buffer_load_dwordx4 v44, s[4:7], s30 offen offset:0 lds
v_mfma_f32_16x16x32_bf16 a[96:99], v[144:147], v[168:171], a[96:99]
ds_read_b128 v[116:119], v27 offset:10240
v_mfma_f32_16x16x32_bf16 a[104:107], v[144:147], v[172:175], a[104:107]
v_mfma_f32_16x16x32_bf16 a[160:163], v[144:147], v[176:179], a[160:163]
buffer_load_dwordx4 v45, s[4:7], s30 offen offset:1024 lds
v_mfma_f32_16x16x32_bf16 a[168:171], v[144:147], v[180:183], a[168:171]
ds_read_b64_tr_b16 v[88:89], v14 offset:32768
v_mfma_f32_16x16x32_bf16 a[224:227], v[144:147], v[184:187], a[224:227]
ds_read_b64_tr_b16 v[90:91], v14 offset:33792
v_mfma_f32_16x16x32_bf16 a[232:235], v[144:147], v[188:191], a[232:235]
v_mfma_f32_16x16x32_bf16 a[36:39], v[148:151], v[160:163], a[36:39]
ds_read_b128 v[120:123], v26 offset:12288
v_mfma_f32_16x16x32_bf16 a[44:47], v[148:151], v[164:167], a[44:47]
buffer_load_dwordx4 v46, s[4:7], s30 offen offset:2048 lds
v_mfma_f32_16x16x32_bf16 a[100:103], v[148:151], v[168:171], a[100:103]
v_mfma_f32_16x16x32_bf16 a[108:111], v[148:151], v[172:175], a[108:111]
ds_read_b64_tr_b16 v[92:93], v15 offset:32768
v_mfma_f32_16x16x32_bf16 a[164:167], v[148:151], v[176:179], a[164:167]
ds_read_b64_tr_b16 v[94:95], v15 offset:33792
v_mfma_f32_16x16x32_bf16 a[172:175], v[148:151], v[180:183], a[172:175]
buffer_load_dwordx4 v47, s[4:7], s30 offen offset:3072 lds
v_mfma_f32_16x16x32_bf16 a[228:231], v[148:151], v[184:187], a[228:231]
ds_read_b128 v[124:127], v27 offset:14336
v_mfma_f32_16x16x32_bf16 a[236:239], v[148:151], v[188:191], a[236:239]
v_mfma_f32_16x16x32_bf16 a[48:51], v[152:155], v[160:163], a[48:51]
s_mov_b32 s40, 0x0
s_mov_b32 s41, 0xff000000
v_mfma_f32_16x16x32_bf16 a[56:59], v[152:155], v[164:167], a[56:59]
v_mfma_f32_16x16x32_bf16 a[112:115], v[152:155], v[168:171], a[112:115]
v_mfma_f32_16x16x32_bf16 a[120:123], v[152:155], v[172:175], a[120:123]
v_mfma_f32_16x16x32_bf16 a[176:179], v[152:155], v[176:179], a[176:179]
v_cndmask_b32 v60, v52, v57, s[40:41]
v_mfma_f32_16x16x32_bf16 a[184:187], v[152:155], v[180:183], a[184:187]
v_mfma_f32_16x16x32_bf16 a[240:243], v[152:155], v[184:187], a[240:243]
v_mfma_f32_16x16x32_bf16 a[248:251], v[152:155], v[188:191], a[248:251]
v_mfma_f32_16x16x32_bf16 a[52:55], v[156:159], v[160:163], a[52:55]
buffer_load_dword v39, v60, s[8:11], 0 offen
v_mfma_f32_16x16x32_bf16 a[60:63], v[156:159], v[164:167], a[60:63]
v_mfma_f32_16x16x32_bf16 a[116:119], v[156:159], v[168:171], a[116:119]
v_mfma_f32_16x16x32_bf16 a[124:127], v[156:159], v[172:175], a[124:127]
v_mfma_f32_16x16x32_bf16 a[180:183], v[156:159], v[176:179], a[180:183]
v_mfma_f32_16x16x32_bf16 a[188:191], v[156:159], v[180:183], a[188:191]
v_mfma_f32_16x16x32_bf16 a[244:247], v[156:159], v[184:187], a[244:247]
v_mfma_f32_16x16x32_bf16 a[252:255], v[156:159], v[188:191], a[252:255]
s_waitcnt vmcnt(15) lgkmcnt(0)
s_barrier
v_mfma_f32_16x16x32_bf16 a[0:3], v[64:67], v[96:99], a[0:3]
s_add_u32 m0, s58, 16384
v_mfma_f32_16x16x32_bf16 a[8:11], v[64:67], v[100:103], a[8:11]
ds_read_b64_tr_b16 v[128:129], v8 offset:49152
v_mfma_f32_16x16x32_bf16 a[64:67], v[64:67], v[104:107], a[64:67]
ds_read_b64_tr_b16 v[130:131], v8 offset:50176
v_mfma_f32_16x16x32_bf16 a[72:75], v[64:67], v[108:111], a[72:75]
v_mfma_f32_16x16x32_bf16 a[128:131], v[64:67], v[112:115], a[128:131]
ds_read_b128 v[160:163], v27 offset:0
s_add_u32 s30, s31, 3407872
v_mfma_f32_16x16x32_bf16 a[136:139], v[64:67], v[116:119], a[136:139]
v_mfma_f32_16x16x32_bf16 a[192:195], v[64:67], v[120:123], a[192:195]
v_mfma_f32_16x16x32_bf16 a[200:203], v[64:67], v[124:127], a[200:203]
ds_read_b64_tr_b16 v[132:133], v9 offset:49152
v_mfma_f32_16x16x32_bf16 a[4:7], v[68:71], v[96:99], a[4:7]
ds_read_b64_tr_b16 v[134:135], v9 offset:50176
v_mfma_f32_16x16x32_bf16 a[12:15], v[68:71], v[100:103], a[12:15]
buffer_load_dwordx4 v20, s[8:11], s30 offen offset:0 lds
v_mfma_f32_16x16x32_bf16 a[68:71], v[68:71], v[104:107], a[68:71]
ds_read_b128 v[164:167], v26 offset:2048
v_mfma_f32_16x16x32_bf16 a[76:79], v[68:71], v[108:111], a[76:79]
v_mfma_f32_16x16x32_bf16 a[132:135], v[68:71], v[112:115], a[132:135]
buffer_load_dwordx4 v21, s[8:11], s30 offen offset:1024 lds
v_mfma_f32_16x16x32_bf16 a[140:143], v[68:71], v[116:119], a[140:143]
ds_read_b64_tr_b16 v[136:137], v10 offset:49152
v_mfma_f32_16x16x32_bf16 a[196:199], v[68:71], v[120:123], a[196:199]
ds_read_b64_tr_b16 v[138:139], v10 offset:50176
v_mfma_f32_16x16x32_bf16 a[204:207], v[68:71], v[124:127], a[204:207]
v_mfma_f32_16x16x32_bf16 a[16:19], v[72:75], v[96:99], a[16:19]
ds_read_b128 v[168:171], v27 offset:4096
v_mfma_f32_16x16x32_bf16 a[24:27], v[72:75], v[100:103], a[24:27]
buffer_load_dwordx4 v22, s[8:11], s30 offen offset:2048 lds
v_mfma_f32_16x16x32_bf16 a[80:83], v[72:75], v[104:107], a[80:83]
v_mfma_f32_16x16x32_bf16 a[88:91], v[72:75], v[108:111], a[88:91]
ds_read_b64_tr_b16 v[140:141], v11 offset:49152
v_mfma_f32_16x16x32_bf16 a[144:147], v[72:75], v[112:115], a[144:147]
ds_read_b64_tr_b16 v[142:143], v11 offset:50176
v_mfma_f32_16x16x32_bf16 a[152:155], v[72:75], v[116:119], a[152:155]
buffer_load_dwordx4 v23, s[8:11], s30 offen offset:3072 lds
v_mfma_f32_16x16x32_bf16 a[208:211], v[72:75], v[120:123], a[208:211]
ds_read_b128 v[172:175], v26 offset:6144
v_mfma_f32_16x16x32_bf16 a[216:219], v[72:75], v[124:127], a[216:219]
v_mfma_f32_16x16x32_bf16 a[20:23], v[76:79], v[96:99], a[20:23]
s_add_u32 m0, s35, 32768
v_mfma_f32_16x16x32_bf16 a[28:31], v[76:79], v[100:103], a[28:31]
ds_read_b64_tr_b16 v[144:145], v12 offset:49152
v_mfma_f32_16x16x32_bf16 a[84:87], v[76:79], v[104:107], a[84:87]
ds_read_b64_tr_b16 v[146:147], v12 offset:50176
v_mfma_f32_16x16x32_bf16 a[92:95], v[76:79], v[108:111], a[92:95]
v_mfma_f32_16x16x32_bf16 a[148:151], v[76:79], v[112:115], a[148:151]
ds_read_b128 v[176:179], v27 offset:8192
s_add_u32 s30, s33, 896
v_mfma_f32_16x16x32_bf16 a[156:159], v[76:79], v[116:119], a[156:159]
v_mfma_f32_16x16x32_bf16 a[212:215], v[76:79], v[120:123], a[212:215]
v_mfma_f32_16x16x32_bf16 a[220:223], v[76:79], v[124:127], a[220:223]
ds_read_b64_tr_b16 v[148:149], v13 offset:49152
v_mfma_f32_16x16x32_bf16 a[32:35], v[80:83], v[96:99], a[32:35]
ds_read_b64_tr_b16 v[150:151], v13 offset:50176
v_mfma_f32_16x16x32_bf16 a[40:43], v[80:83], v[100:103], a[40:43]
buffer_load_dwordx4 v40, s[4:7], s30 offen offset:0 lds
v_mfma_f32_16x16x32_bf16 a[96:99], v[80:83], v[104:107], a[96:99]
ds_read_b128 v[180:183], v26 offset:10240
v_mfma_f32_16x16x32_bf16 a[104:107], v[80:83], v[108:111], a[104:107]
v_mfma_f32_16x16x32_bf16 a[160:163], v[80:83], v[112:115], a[160:163]
buffer_load_dwordx4 v41, s[4:7], s30 offen offset:1024 lds
v_mfma_f32_16x16x32_bf16 a[168:171], v[80:83], v[116:119], a[168:171]
ds_read_b64_tr_b16 v[152:153], v14 offset:49152
v_mfma_f32_16x16x32_bf16 a[224:227], v[80:83], v[120:123], a[224:227]
ds_read_b64_tr_b16 v[154:155], v14 offset:50176
v_mfma_f32_16x16x32_bf16 a[232:235], v[80:83], v[124:127], a[232:235]
v_mfma_f32_16x16x32_bf16 a[36:39], v[84:87], v[96:99], a[36:39]
ds_read_b128 v[184:187], v27 offset:12288
v_mfma_f32_16x16x32_bf16 a[44:47], v[84:87], v[100:103], a[44:47]
buffer_load_dwordx4 v42, s[4:7], s30 offen offset:2048 lds
v_mfma_f32_16x16x32_bf16 a[100:103], v[84:87], v[104:107], a[100:103]
v_mfma_f32_16x16x32_bf16 a[108:111], v[84:87], v[108:111], a[108:111]
ds_read_b64_tr_b16 v[156:157], v15 offset:49152
v_mfma_f32_16x16x32_bf16 a[164:167], v[84:87], v[112:115], a[164:167]
ds_read_b64_tr_b16 v[158:159], v15 offset:50176
v_mfma_f32_16x16x32_bf16 a[172:175], v[84:87], v[116:119], a[172:175]
buffer_load_dwordx4 v43, s[4:7], s30 offen offset:3072 lds
v_mfma_f32_16x16x32_bf16 a[228:231], v[84:87], v[120:123], a[228:231]
ds_read_b128 v[188:191], v26 offset:14336
v_mfma_f32_16x16x32_bf16 a[236:239], v[84:87], v[124:127], a[236:239]
v_mfma_f32_16x16x32_bf16 a[48:51], v[88:91], v[96:99], a[48:51]
s_mov_b32 s40, 0xff00f0
s_mov_b32 s41, 0x0
v_mfma_f32_16x16x32_bf16 a[56:59], v[88:91], v[100:103], a[56:59]
tp0_p2:
s_cbranch_execz tp0_ret
v_mfma_f32_16x16x32_bf16 a[112:115], v[88:91], v[104:107], a[112:115]
v_mfma_f32_16x16x32_bf16 a[120:123], v[88:91], v[108:111], a[120:123]
v_mfma_f32_16x16x32_bf16 a[176:179], v[88:91], v[112:115], a[176:179]
v_cndmask_b32 v60, v52, v35, s[40:41]
v_mfma_f32_16x16x32_bf16 a[184:187], v[88:91], v[116:119], a[184:187]
v_mfma_f32_16x16x32_bf16 a[240:243], v[88:91], v[120:123], a[240:243]
v_mfma_f32_16x16x32_bf16 a[248:251], v[88:91], v[124:127], a[248:251]
v_mfma_f32_16x16x32_bf16 a[52:55], v[92:95], v[96:99], a[52:55]
buffer_load_dword v39, v60, s[60:63], 0 offen
v_mfma_f32_16x16x32_bf16 a[60:63], v[92:95], v[100:103], a[60:63]
v_mfma_f32_16x16x32_bf16 a[116:119], v[92:95], v[104:107], a[116:119]
v_mfma_f32_16x16x32_bf16 a[124:127], v[92:95], v[108:111], a[124:127]
v_mfma_f32_16x16x32_bf16 a[180:183], v[92:95], v[112:115], a[180:183]
v_mfma_f32_16x16x32_bf16 a[188:191], v[92:95], v[116:119], a[188:191]
v_mfma_f32_16x16x32_bf16 a[244:247], v[92:95], v[120:123], a[244:247]
v_mfma_f32_16x16x32_bf16 a[252:255], v[92:95], v[124:127], a[252:255]
s_waitcnt vmcnt(10) lgkmcnt(0)
s_barrier
v_mfma_f32_16x16x32_bf16 a[0:3], v[128:131], v[160:163], a[0:3]
s_add_u32 m0, s58, 32768
v_mfma_f32_16x16x32_bf16 a[8:11], v[128:131], v[164:167], a[8:11]
ds_read_b64_tr_b16 v[64:65], v8 offset:0
v_mfma_f32_16x16x32_bf16 a[64:67], v[128:131], v[168:171], a[64:67]
ds_read_b64_tr_b16 v[66:67], v8 offset:1024
s_add_u32 s30, s31, 3670016
v_mfma_f32_16x16x32_bf16 a[72:75], v[128:131], v[172:175], a[72:75]
v_mfma_f32_16x16x32_bf16 a[128:131], v[128:131], v[176:179], a[128:131]
ds_read_b128 v[96:99], v24 offset:0
v_mfma_f32_16x16x32_bf16 a[136:139], v[128:131], v[180:183], a[136:139]
buffer_load_dwordx4 v20, s[8:11], s30 offen offset:0 lds
v_mfma_f32_16x16x32_bf16 a[192:195], v[128:131], v[184:187], a[192:195]
v_mfma_f32_16x16x32_bf16 a[200:203], v[128:131], v[188:191], a[200:203]
ds_read_b64_tr_b16 v[68:69], v9 offset:0
v_mfma_f32_16x16x32_bf16 a[4:7], v[132:135], v[160:163], a[4:7]
ds_read_b64_tr_b16 v[70:71], v9 offset:1024
v_mfma_f32_16x16x32_bf16 a[12:15], v[132:135], v[164:167], a[12:15]
buffer_load_dwordx4 v21, s[8:11], s30 offen offset:1024 lds
v_mfma_f32_16x16x32_bf16 a[68:71], v[132:135], v[168:171], a[68:71]
ds_read_b128 v[100:103], v25 offset:2048
v_mfma_f32_16x16x32_bf16 a[76:79], v[132:135], v[172:175], a[76:79]
buffer_load_dwordx4 v22, s[8:11], s30 offen offset:2048 lds
v_mfma_f32_16x16x32_bf16 a[132:135], v[132:135], v[176:179], a[132:135]
v_mfma_f32_16x16x32_bf16 a[140:143], v[132:135], v[180:183], a[140:143]
ds_read_b64_tr_b16 v[72:73], v10 offset:0
v_mfma_f32_16x16x32_bf16 a[196:199], v[132:135], v[184:187], a[196:199]
ds_read_b64_tr_b16 v[74:75], v10 offset:1024
v_mfma_f32_16x16x32_bf16 a[204:207], v[132:135], v[188:191], a[204:207]
buffer_load_dwordx4 v23, s[8:11], s30 offen offset:3072 lds
v_mfma_f32_16x16x32_bf16 a[16:19], v[136:139], v[160:163], a[16:19]
ds_read_b128 v[104:107], v24 offset:4096
v_mfma_f32_16x16x32_bf16 a[24:27], v[136:139], v[164:167], a[24:27]
s_add_u32 m0, s35, 36864
v_mfma_f32_16x16x32_bf16 a[80:83], v[136:139], v[168:171], a[80:83]
v_mfma_f32_16x16x32_bf16 a[88:91], v[136:139], v[172:175], a[88:91]
ds_read_b64_tr_b16 v[76:77], v11 offset:0
v_mfma_f32_16x16x32_bf16 a[144:147], v[136:139], v[176:179], a[144:147]
ds_read_b64_tr_b16 v[78:79], v11 offset:1024
s_add_u32 s30, s33, 896
v_mfma_f32_16x16x32_bf16 a[152:155], v[136:139], v[180:183], a[152:155]
v_mfma_f32_16x16x32_bf16 a[208:211], v[136:139], v[184:187], a[208:211]
ds_read_b128 v[108:111], v25 offset:6144
v_mfma_f32_16x16x32_bf16 a[216:219], v[136:139], v[188:191], a[216:219]
buffer_load_dwordx4 v44, s[4:7], s30 offen offset:0 lds
v_mfma_f32_16x16x32_bf16 a[20:23], v[140:143], v[160:163], a[20:23]
v_mfma_f32_16x16x32_bf16 a[28:31], v[140:143], v[164:167], a[28:31]
ds_read_b64_tr_b16 v[80:81], v12 offset:0
v_mfma_f32_16x16x32_bf16 a[84:87], v[140:143], v[168:171], a[84:87]
ds_read_b64_tr_b16 v[82:83], v12 offset:1024
v_mfma_f32_16x16x32_bf16 a[92:95], v[140:143], v[172:175], a[92:95]
buffer_load_dwordx4 v45, s[4:7], s30 offen offset:1024 lds
v_mfma_f32_16x16x32_bf16 a[148:151], v[140:143], v[176:179], a[148:151]
ds_read_b128 v[112:115], v24 offset:8192
v_mfma_f32_16x16x32_bf16 a[156:159], v[140:143], v[180:183], a[156:159]
buffer_load_dwordx4 v46, s[4:7], s30 offen offset:2048 lds
v_mfma_f32_16x16x32_bf16 a[212:215], v[140:143], v[184:187], a[212:215]
v_mfma_f32_16x16x32_bf16 a[220:223], v[140:143], v[188:191], a[220:223]
ds_read_b64_tr_b16 v[84:85], v13 offset:0
v_mfma_f32_16x16x32_bf16 a[32:35], v[144:147], v[160:163], a[32:35]
ds_read_b64_tr_b16 v[86:87], v13 offset:1024
v_mfma_f32_16x16x32_bf16 a[40:43], v[144:147], v[164:167], a[40:43]
buffer_load_dwordx4 v47, s[4:7], s30 offen offset:3072 lds
v_mfma_f32_16x16x32_bf16 a[96:99], v[144:147], v[168:171], a[96:99]
ds_read_b128 v[116:119], v25 offset:10240
s_add_u32 m0, s58, 131072
v_mfma_f32_16x16x32_bf16 a[104:107], v[144:147], v[172:175], a[104:107]
v_mfma_f32_16x16x32_bf16 a[160:163], v[144:147], v[176:179], a[160:163]
v_mfma_f32_16x16x32_bf16 a[168:171], v[144:147], v[180:183], a[168:171]
ds_read_b64_tr_b16 v[88:89], v14 offset:0
s_add_u32 s30, s39, 4194304
v_mfma_f32_16x16x32_bf16 a[224:227], v[144:147], v[184:187], a[224:227]
ds_read_b64_tr_b16 v[90:91], v14 offset:1024
v_mfma_f32_16x16x32_bf16 a[232:235], v[144:147], v[188:191], a[232:235]
v_mfma_f32_16x16x32_bf16 a[36:39], v[148:151], v[160:163], a[36:39]
ds_read_b128 v[120:123], v24 offset:12288
v_mfma_f32_16x16x32_bf16 a[44:47], v[148:151], v[164:167], a[44:47]
buffer_load_dwordx4 v20, s[60:63], s30 offen offset:0 lds
v_mfma_f32_16x16x32_bf16 a[100:103], v[148:151], v[168:171], a[100:103]
buffer_load_dwordx4 v21, s[60:63], s30 offen offset:1024 lds
v_mfma_f32_16x16x32_bf16 a[108:111], v[148:151], v[172:175], a[108:111]
ds_read_b64_tr_b16 v[92:93], v15 offset:0
v_mfma_f32_16x16x32_bf16 a[164:167], v[148:151], v[176:179], a[164:167]
ds_read_b64_tr_b16 v[94:95], v15 offset:1024
v_mfma_f32_16x16x32_bf16 a[172:175], v[148:151], v[180:183], a[172:175]
buffer_load_dwordx4 v22, s[60:63], s30 offen offset:2048 lds
v_mfma_f32_16x16x32_bf16 a[228:231], v[148:151], v[184:187], a[228:231]
ds_read_b128 v[124:127], v25 offset:14336
v_mfma_f32_16x16x32_bf16 a[236:239], v[148:151], v[188:191], a[236:239]
v_mfma_f32_16x16x32_bf16 a[48:51], v[152:155], v[160:163], a[48:51]
buffer_load_dwordx4 v23, s[60:63], s30 offen offset:3072 lds
v_mfma_f32_16x16x32_bf16 a[56:59], v[152:155], v[164:167], a[56:59]
v_mfma_f32_16x16x32_bf16 a[112:115], v[152:155], v[168:171], a[112:115]
v_mfma_f32_16x16x32_bf16 a[120:123], v[152:155], v[172:175], a[120:123]
s_mov_b32 s40, 0xf00
s_mov_b32 s41, 0x0
v_mfma_f32_16x16x32_bf16 a[176:179], v[152:155], v[176:179], a[176:179]
v_mfma_f32_16x16x32_bf16 a[184:187], v[152:155], v[180:183], a[184:187]
v_mfma_f32_16x16x32_bf16 a[240:243], v[152:155], v[184:187], a[240:243]
v_cndmask_b32 v60, v52, v35, s[40:41]
v_mfma_f32_16x16x32_bf16 a[248:251], v[152:155], v[188:191], a[248:251]
v_mfma_f32_16x16x32_bf16 a[52:55], v[156:159], v[160:163], a[52:55]
v_mfma_f32_16x16x32_bf16 a[60:63], v[156:159], v[164:167], a[60:63]
buffer_load_dword v39, v60, s[60:63], 0 offen
v_mfma_f32_16x16x32_bf16 a[116:119], v[156:159], v[168:171], a[116:119]
v_mfma_f32_16x16x32_bf16 a[124:127], v[156:159], v[172:175], a[124:127]
v_mfma_f32_16x16x32_bf16 a[180:183], v[156:159], v[176:179], a[180:183]
v_mfma_f32_16x16x32_bf16 a[188:191], v[156:159], v[180:183], a[188:191]
v_mfma_f32_16x16x32_bf16 a[244:247], v[156:159], v[184:187], a[244:247]
v_mfma_f32_16x16x32_bf16 a[252:255], v[156:159], v[188:191], a[252:255]
s_waitcnt vmcnt(18) lgkmcnt(0)
s_barrier
v_mfma_f32_16x16x32_bf16 a[0:3], v[64:67], v[96:99], a[0:3]
s_add_u32 m0, s58, 49152
v_mfma_f32_16x16x32_bf16 a[8:11], v[64:67], v[100:103], a[8:11]
ds_read_b64_tr_b16 v[128:129], v8 offset:16384
v_mfma_f32_16x16x32_bf16 a[64:67], v[64:67], v[104:107], a[64:67]
ds_read_b64_tr_b16 v[130:131], v8 offset:17408
v_mfma_f32_16x16x32_bf16 a[72:75], v[64:67], v[108:111], a[72:75]
v_mfma_f32_16x16x32_bf16 a[128:131], v[64:67], v[112:115], a[128:131]
ds_read_b128 v[160:163], v25 offset:0
s_add_u32 s30, s31, 3932160
v_mfma_f32_16x16x32_bf16 a[136:139], v[64:67], v[116:119], a[136:139]
v_mfma_f32_16x16x32_bf16 a[192:195], v[64:67], v[120:123], a[192:195]
v_mfma_f32_16x16x32_bf16 a[200:203], v[64:67], v[124:127], a[200:203]
ds_read_b64_tr_b16 v[132:133], v9 offset:16384
v_mfma_f32_16x16x32_bf16 a[4:7], v[68:71], v[96:99], a[4:7]
ds_read_b64_tr_b16 v[134:135], v9 offset:17408
v_mfma_f32_16x16x32_bf16 a[12:15], v[68:71], v[100:103], a[12:15]
buffer_load_dwordx4 v20, s[8:11], s30 offen offset:0 lds
v_mfma_f32_16x16x32_bf16 a[68:71], v[68:71], v[104:107], a[68:71]
ds_read_b128 v[164:167], v24 offset:2048
v_mfma_f32_16x16x32_bf16 a[76:79], v[68:71], v[108:111], a[76:79]
v_mfma_f32_16x16x32_bf16 a[132:135], v[68:71], v[112:115], a[132:135]
buffer_load_dwordx4 v21, s[8:11], s30 offen offset:1024 lds
v_mfma_f32_16x16x32_bf16 a[140:143], v[68:71], v[116:119], a[140:143]
ds_read_b64_tr_b16 v[136:137], v10 offset:16384
v_mfma_f32_16x16x32_bf16 a[196:199], v[68:71], v[120:123], a[196:199]
ds_read_b64_tr_b16 v[138:139], v10 offset:17408
v_mfma_f32_16x16x32_bf16 a[204:207], v[68:71], v[124:127], a[204:207]
v_mfma_f32_16x16x32_bf16 a[16:19], v[72:75], v[96:99], a[16:19]
ds_read_b128 v[168:171], v25 offset:4096
v_mfma_f32_16x16x32_bf16 a[24:27], v[72:75], v[100:103], a[24:27]
buffer_load_dwordx4 v22, s[8:11], s30 offen offset:2048 lds
v_mfma_f32_16x16x32_bf16 a[80:83], v[72:75], v[104:107], a[80:83]
v_mfma_f32_16x16x32_bf16 a[88:91], v[72:75], v[108:111], a[88:91]
ds_read_b64_tr_b16 v[140:141], v11 offset:16384
v_mfma_f32_16x16x32_bf16 a[144:147], v[72:75], v[112:115], a[144:147]
ds_read_b64_tr_b16 v[142:143], v11 offset:17408
v_mfma_f32_16x16x32_bf16 a[152:155], v[72:75], v[116:119], a[152:155]
buffer_load_dwordx4 v23, s[8:11], s30 offen offset:3072 lds
v_mfma_f32_16x16x32_bf16 a[208:211], v[72:75], v[120:123], a[208:211]
ds_read_b128 v[172:175], v24 offset:6144
v_mfma_f32_16x16x32_bf16 a[216:219], v[72:75], v[124:127], a[216:219]
v_mfma_f32_16x16x32_bf16 a[20:23], v[76:79], v[96:99], a[20:23]
s_add_u32 m0, s58, 0
v_mfma_f32_16x16x32_bf16 a[28:31], v[76:79], v[100:103], a[28:31]
ds_read_b64_tr_b16 v[144:145], v12 offset:16384
v_mfma_f32_16x16x32_bf16 a[84:87], v[76:79], v[104:107], a[84:87]
ds_read_b64_tr_b16 v[146:147], v12 offset:17408
v_mfma_f32_16x16x32_bf16 a[92:95], v[76:79], v[108:111], a[92:95]
v_mfma_f32_16x16x32_bf16 a[148:151], v[76:79], v[112:115], a[148:151]
ds_read_b128 v[176:179], v25 offset:8192
s_add_u32 s30, s39, 0
v_mfma_f32_16x16x32_bf16 a[156:159], v[76:79], v[116:119], a[156:159]
v_mfma_f32_16x16x32_bf16 a[212:215], v[76:79], v[120:123], a[212:215]
v_mfma_f32_16x16x32_bf16 a[220:223], v[76:79], v[124:127], a[220:223]
ds_read_b64_tr_b16 v[148:149], v13 offset:16384
v_mfma_f32_16x16x32_bf16 a[32:35], v[80:83], v[96:99], a[32:35]
ds_read_b64_tr_b16 v[150:151], v13 offset:17408
v_mfma_f32_16x16x32_bf16 a[40:43], v[80:83], v[100:103], a[40:43]
buffer_load_dwordx4 v20, s[60:63], s30 offen offset:0 lds
v_mfma_f32_16x16x32_bf16 a[96:99], v[80:83], v[104:107], a[96:99]
ds_read_b128 v[180:183], v24 offset:10240
v_mfma_f32_16x16x32_bf16 a[104:107], v[80:83], v[108:111], a[104:107]
v_mfma_f32_16x16x32_bf16 a[160:163], v[80:83], v[112:115], a[160:163]
buffer_load_dwordx4 v21, s[60:63], s30 offen offset:1024 lds
v_mfma_f32_16x16x32_bf16 a[168:171], v[80:83], v[116:119], a[168:171]
ds_read_b64_tr_b16 v[152:153], v14 offset:16384
v_mfma_f32_16x16x32_bf16 a[224:227], v[80:83], v[120:123], a[224:227]
ds_read_b64_tr_b16 v[154:155], v14 offset:17408
v_mfma_f32_16x16x32_bf16 a[232:235], v[80:83], v[124:127], a[232:235]
v_mfma_f32_16x16x32_bf16 a[36:39], v[84:87], v[96:99], a[36:39]
ds_read_b128 v[184:187], v25 offset:12288
v_mfma_f32_16x16x32_bf16 a[44:47], v[84:87], v[100:103], a[44:47]
buffer_load_dwordx4 v22, s[60:63], s30 offen offset:2048 lds
v_mfma_f32_16x16x32_bf16 a[100:103], v[84:87], v[104:107], a[100:103]
v_mfma_f32_16x16x32_bf16 a[108:111], v[84:87], v[108:111], a[108:111]
ds_read_b64_tr_b16 v[156:157], v15 offset:16384
v_mfma_f32_16x16x32_bf16 a[164:167], v[84:87], v[112:115], a[164:167]
ds_read_b64_tr_b16 v[158:159], v15 offset:17408
v_mfma_f32_16x16x32_bf16 a[172:175], v[84:87], v[116:119], a[172:175]
buffer_load_dwordx4 v23, s[60:63], s30 offen offset:3072 lds
v_mfma_f32_16x16x32_bf16 a[228:231], v[84:87], v[120:123], a[228:231]
ds_read_b128 v[188:191], v24 offset:14336
v_mfma_f32_16x16x32_bf16 a[236:239], v[84:87], v[124:127], a[236:239]
v_mfma_f32_16x16x32_bf16 a[48:51], v[88:91], v[96:99], a[48:51]
s_mov_b32 s40, 0xff00f000
s_mov_b32 s41, 0x0
v_mfma_f32_16x16x32_bf16 a[56:59], v[88:91], v[100:103], a[56:59]
v_mfma_f32_16x16x32_bf16 a[112:115], v[88:91], v[104:107], a[112:115]
v_mfma_f32_16x16x32_bf16 a[120:123], v[88:91], v[108:111], a[120:123]
v_mfma_f32_16x16x32_bf16 a[176:179], v[88:91], v[112:115], a[176:179]
v_cndmask_b32 v60, v52, v35, s[40:41]
v_mfma_f32_16x16x32_bf16 a[184:187], v[88:91], v[116:119], a[184:187]
v_mfma_f32_16x16x32_bf16 a[240:243], v[88:91], v[120:123], a[240:243]
v_mfma_f32_16x16x32_bf16 a[248:251], v[88:91], v[124:127], a[248:251]
v_mfma_f32_16x16x32_bf16 a[52:55], v[92:95], v[96:99], a[52:55]
buffer_load_dword v39, v60, s[60:63], 0 offen
v_mfma_f32_16x16x32_bf16 a[60:63], v[92:95], v[100:103], a[60:63]
v_mfma_f32_16x16x32_bf16 a[116:119], v[92:95], v[104:107], a[116:119]
v_mfma_f32_16x16x32_bf16 a[124:127], v[92:95], v[108:111], a[124:127]
v_mfma_f32_16x16x32_bf16 a[180:183], v[92:95], v[112:115], a[180:183]
v_mfma_f32_16x16x32_bf16 a[188:191], v[92:95], v[116:119], a[188:191]
v_mfma_f32_16x16x32_bf16 a[244:247], v[92:95], v[120:123], a[244:247]
v_mfma_f32_16x16x32_bf16 a[252:255], v[92:95], v[124:127], a[252:255]
s_waitcnt vmcnt(14) lgkmcnt(0)
s_barrier
v_mfma_f32_16x16x32_bf16 a[0:3], v[128:131], v[160:163], a[0:3]
buffer_load_dword v63, v62, s[20:23], 0 offen sc1
v_mfma_f32_16x16x32_bf16 a[8:11], v[128:131], v[164:167], a[8:11]
ds_read_b64_tr_b16 v[64:65], v8 offset:32768
v_mfma_f32_16x16x32_bf16 a[64:67], v[128:131], v[168:171], a[64:67]
ds_read_b64_tr_b16 v[66:67], v8 offset:33792
v_mfma_f32_16x16x32_bf16 a[72:75], v[128:131], v[172:175], a[72:75]
buffer_load_dword v36, v38, s[20:23], 0 offen sc1
v_mfma_f32_16x16x32_bf16 a[128:131], v[128:131], v[176:179], a[128:131]
ds_read_b128 v[96:99], v24 offset:32768
v_mfma_f32_16x16x32_bf16 a[136:139], v[128:131], v[180:183], a[136:139]
v_mfma_f32_16x16x32_bf16 a[192:195], v[128:131], v[184:187], a[192:195]
s_add_u32 m0, s58, 16384
v_mfma_f32_16x16x32_bf16 a[200:203], v[128:131], v[188:191], a[200:203]
ds_read_b64_tr_b16 v[68:69], v9 offset:32768
v_mfma_f32_16x16x32_bf16 a[4:7], v[132:135], v[160:163], a[4:7]
ds_read_b64_tr_b16 v[70:71], v9 offset:33792
v_mfma_f32_16x16x32_bf16 a[12:15], v[132:135], v[164:167], a[12:15]
s_add_u32 s30, s39, 524288
v_mfma_f32_16x16x32_bf16 a[68:71], v[132:135], v[168:171], a[68:71]
ds_read_b128 v[100:103], v25 offset:34816
v_mfma_f32_16x16x32_bf16 a[76:79], v[132:135], v[172:175], a[76:79]
v_mfma_f32_16x16x32_bf16 a[132:135], v[132:135], v[176:179], a[132:135]
buffer_load_dwordx4 v20, s[60:63], s30 offen offset:0 lds
v_mfma_f32_16x16x32_bf16 a[140:143], v[132:135], v[180:183], a[140:143]
ds_read_b64_tr_b16 v[72:73], v10 offset:32768
v_mfma_f32_16x16x32_bf16 a[196:199], v[132:135], v[184:187], a[196:199]
ds_read_b64_tr_b16 v[74:75], v10 offset:33792
v_mfma_f32_16x16x32_bf16 a[204:207], v[132:135], v[188:191], a[204:207]
buffer_load_dwordx4 v21, s[60:63], s30 offen offset:1024 lds
v_mfma_f32_16x16x32_bf16 a[16:19], v[136:139], v[160:163], a[16:19]
ds_read_b128 v[104:107], v24 offset:36864
v_mfma_f32_16x16x32_bf16 a[24:27], v[136:139], v[164:167], a[24:27]
v_mfma_f32_16x16x32_bf16 a[80:83], v[136:139], v[168:171], a[80:83]
buffer_load_dwordx4 v22, s[60:63], s30 offen offset:2048 lds
v_mfma_f32_16x16x32_bf16 a[88:91], v[136:139], v[172:175], a[88:91]
ds_read_b64_tr_b16 v[76:77], v11 offset:32768
v_mfma_f32_16x16x32_bf16 a[144:147], v[136:139], v[176:179], a[144:147]
ds_read_b64_tr_b16 v[78:79], v11 offset:33792
v_mfma_f32_16x16x32_bf16 a[152:155], v[136:139], v[180:183], a[152:155]
buffer_load_dwordx4 v23, s[60:63], s30 offen offset:3072 lds
v_mfma_f32_16x16x32_bf16 a[208:211], v[136:139], v[184:187], a[208:211]
ds_read_b128 v[108:111], v25 offset:38912
v_mfma_f32_16x16x32_bf16 a[216:219], v[136:139], v[188:191], a[216:219]
v_mfma_f32_16x16x32_bf16 a[20:23], v[140:143], v[160:163], a[20:23]
s_add_u32 m0, s58, 65536
v_mfma_f32_16x16x32_bf16 a[28:31], v[140:143], v[164:167], a[28:31]
ds_read_b64_tr_b16 v[80:81], v12 offset:32768
v_mfma_f32_16x16x32_bf16 a[84:87], v[140:143], v[168:171], a[84:87]
ds_read_b64_tr_b16 v[82:83], v12 offset:33792
v_mfma_f32_16x16x32_bf16 a[92:95], v[140:143], v[172:175], a[92:95]
s_add_u32 s30, s39, 2097152
v_mfma_f32_16x16x32_bf16 a[148:151], v[140:143], v[176:179], a[148:151]
ds_read_b128 v[112:115], v24 offset:40960
v_mfma_f32_16x16x32_bf16 a[156:159], v[140:143], v[180:183], a[156:159]
v_mfma_f32_16x16x32_bf16 a[212:215], v[140:143], v[184:187], a[212:215]
buffer_load_dwordx4 v20, s[60:63], s30 offen offset:0 lds
v_mfma_f32_16x16x32_bf16 a[220:223], v[140:143], v[188:191], a[220:223]
ds_read_b64_tr_b16 v[84:85], v13 offset:32768
v_mfma_f32_16x16x32_bf16 a[32:35], v[144:147], v[160:163], a[32:35]
ds_read_b64_tr_b16 v[86:87], v13 offset:33792
v_mfma_f32_16x16x32_bf16 a[40:43], v[144:147], v[164:167], a[40:43]
buffer_load_dwordx4 v21, s[60:63], s30 offen offset:1024 lds
v_mfma_f32_16x16x32_bf16 a[96:99], v[144:147], v[168:171], a[96:99]
ds_read_b128 v[116:119], v25 offset:43008
v_mfma_f32_16x16x32_bf16 a[104:107], v[144:147], v[172:175], a[104:107]
v_mfma_f32_16x16x32_bf16 a[160:163], v[144:147], v[176:179], a[160:163]
buffer_load_dwordx4 v22, s[60:63], s30 offen offset:2048 lds
v_mfma_f32_16x16x32_bf16 a[168:171], v[144:147], v[180:183], a[168:171]
ds_read_b64_tr_b16 v[88:89], v14 offset:32768
v_mfma_f32_16x16x32_bf16 a[224:227], v[144:147], v[184:187], a[224:227]
ds_read_b64_tr_b16 v[90:91], v14 offset:33792
v_mfma_f32_16x16x32_bf16 a[232:235], v[144:147], v[188:191], a[232:235]
buffer_load_dwordx4 v23, s[60:63], s30 offen offset:3072 lds
v_mfma_f32_16x16x32_bf16 a[36:39], v[148:151], v[160:163], a[36:39]
ds_read_b128 v[120:123], v24 offset:45056
v_mfma_f32_16x16x32_bf16 a[44:47], v[148:151], v[164:167], a[44:47]
v_mfma_f32_16x16x32_bf16 a[100:103], v[148:151], v[168:171], a[100:103]
s_add_u32 m0, s58, 81920
v_mfma_f32_16x16x32_bf16 a[108:111], v[148:151], v[172:175], a[108:111]
ds_read_b64_tr_b16 v[92:93], v15 offset:32768
v_mfma_f32_16x16x32_bf16 a[164:167], v[148:151], v[176:179], a[164:167]
ds_read_b64_tr_b16 v[94:95], v15 offset:33792
v_mfma_f32_16x16x32_bf16 a[172:175], v[148:151], v[180:183], a[172:175]
s_add_u32 s30, s39, 2621440
v_mfma_f32_16x16x32_bf16 a[228:231], v[148:151], v[184:187], a[228:231]
ds_read_b128 v[124:127], v25 offset:47104
v_mfma_f32_16x16x32_bf16 a[236:239], v[148:151], v[188:191], a[236:239]
v_mfma_f32_16x16x32_bf16 a[48:51], v[152:155], v[160:163], a[48:51]
buffer_load_dwordx4 v20, s[60:63], s30 offen offset:0 lds
v_mfma_f32_16x16x32_bf16 a[56:59], v[152:155], v[164:167], a[56:59]
v_mfma_f32_16x16x32_bf16 a[112:115], v[152:155], v[168:171], a[112:115]
v_mfma_f32_16x16x32_bf16 a[120:123], v[152:155], v[172:175], a[120:123]
buffer_load_dwordx4 v21, s[60:63], s30 offen offset:1024 lds
v_mfma_f32_16x16x32_bf16 a[176:179], v[152:155], v[176:179], a[176:179]
v_mfma_f32_16x16x32_bf16 a[184:187], v[152:155], v[180:183], a[184:187]
v_mfma_f32_16x16x32_bf16 a[240:243], v[152:155], v[184:187], a[240:243]
buffer_load_dwordx4 v22, s[60:63], s30 offen offset:2048 lds
v_mfma_f32_16x16x32_bf16 a[248:251], v[152:155], v[188:191], a[248:251]
v_mfma_f32_16x16x32_bf16 a[52:55], v[156:159], v[160:163], a[52:55]
v_mfma_f32_16x16x32_bf16 a[60:63], v[156:159], v[164:167], a[60:63]
buffer_load_dwordx4 v23, s[60:63], s30 offen offset:3072 lds
v_mfma_f32_16x16x32_bf16 a[116:119], v[156:159], v[168:171], a[116:119]
v_mfma_f32_16x16x32_bf16 a[124:127], v[156:159], v[172:175], a[124:127]
v_mfma_f32_16x16x32_bf16 a[180:183], v[156:159], v[176:179], a[180:183]
v_mfma_f32_16x16x32_bf16 a[188:191], v[156:159], v[180:183], a[188:191]
v_mfma_f32_16x16x32_bf16 a[244:247], v[156:159], v[184:187], a[244:247]
v_mfma_f32_16x16x32_bf16 a[252:255], v[156:159], v[188:191], a[252:255]
s_waitcnt vmcnt(19) lgkmcnt(0)
s_barrier
v_mfma_f32_16x16x32_bf16 a[0:3], v[64:67], v[96:99], a[0:3]
s_mov_b32 s76, 128
s_waitcnt vmcnt(12)
v_mfma_f32_16x16x32_bf16 a[8:11], v[64:67], v[100:103], a[8:11]
ds_read_b64_tr_b16 v[128:129], v8 offset:49152
v_readfirstlane_b32 s97, v63
s_cmp_eq_u32 s97, s96
s_cselect_b32 s96, 0, 0x40000000
s_cselect_b32 s97, 0x40000000, 0
v_mfma_f32_16x16x32_bf16 a[64:67], v[64:67], v[104:107], a[64:67]
ds_read_b64_tr_b16 v[130:131], v8 offset:50176
v_cmp_ne_u32 vcc, s76, v36
v_mfma_f32_16x16x32_bf16 a[72:75], v[64:67], v[108:111], a[72:75]
s_cbranch_vccnz k12_kernel_gspinK
k12_kernel_gbackK:
v_mfma_f32_16x16x32_bf16 a[128:131], v[64:67], v[112:115], a[128:131]
ds_read_b128 v[160:163], v25 offset:32768
s_mov_b32 s77, 0
v_mfma_f32_16x16x32_bf16 a[136:139], v[64:67], v[116:119], a[136:139]
buffer_load_dwordx4 v[192:195], v16, s[16:19], s77 offen offset:0 sc1
v_mfma_f32_16x16x32_bf16 a[192:195], v[64:67], v[120:123], a[192:195]
buffer_load_dwordx4 v[196:199], v17, s[16:19], s77 offen offset:0 sc1
v_mfma_f32_16x16x32_bf16 a[200:203], v[64:67], v[124:127], a[200:203]
ds_read_b64_tr_b16 v[132:133], v9 offset:49152
v_mfma_f32_16x16x32_bf16 a[4:7], v[68:71], v[96:99], a[4:7]
ds_read_b64_tr_b16 v[134:135], v9 offset:50176
v_mfma_f32_16x16x32_bf16 a[12:15], v[68:71], v[100:103], a[12:15]
buffer_load_dwordx4 v[200:203], v18, s[16:19], s77 offen offset:0 sc1
v_mfma_f32_16x16x32_bf16 a[68:71], v[68:71], v[104:107], a[68:71]
ds_read_b128 v[164:167], v24 offset:34816
v_mfma_f32_16x16x32_bf16 a[76:79], v[68:71], v[108:111], a[76:79]
buffer_load_dwordx4 v[204:207], v19, s[16:19], s77 offen offset:0 sc1
v_mfma_f32_16x16x32_bf16 a[132:135], v[68:71], v[112:115], a[132:135]
buffer_load_dwordx4 v[208:211], v16, s[16:19], s77 offen offset:1024 sc1
v_mfma_f32_16x16x32_bf16 a[140:143], v[68:71], v[116:119], a[140:143]
ds_read_b64_tr_b16 v[136:137], v10 offset:49152
v_mfma_f32_16x16x32_bf16 a[196:199], v[68:71], v[120:123], a[196:199]
ds_read_b64_tr_b16 v[138:139], v10 offset:50176
v_mfma_f32_16x16x32_bf16 a[204:207], v[68:71], v[124:127], a[204:207]
buffer_load_dwordx4 v[212:215], v17, s[16:19], s77 offen offset:1024 sc1
v_mfma_f32_16x16x32_bf16 a[16:19], v[72:75], v[96:99], a[16:19]
ds_read_b128 v[168:171], v25 offset:36864
v_mfma_f32_16x16x32_bf16 a[24:27], v[72:75], v[100:103], a[24:27]
buffer_load_dwordx4 v[216:219], v18, s[16:19], s77 offen offset:1024 sc1
v_mfma_f32_16x16x32_bf16 a[80:83], v[72:75], v[104:107], a[80:83]
buffer_load_dwordx4 v[220:223], v19, s[16:19], s77 offen offset:1024 sc1
v_mfma_f32_16x16x32_bf16 a[88:91], v[72:75], v[108:111], a[88:91]
ds_read_b64_tr_b16 v[140:141], v11 offset:49152
s_add_u32 m0, s58, 32768
v_mfma_f32_16x16x32_bf16 a[144:147], v[72:75], v[112:115], a[144:147]
ds_read_b64_tr_b16 v[142:143], v11 offset:50176
s_add_u32 s30, s39, 1048576
v_mfma_f32_16x16x32_bf16 a[152:155], v[72:75], v[116:119], a[152:155]
buffer_load_dwordx4 v20, s[60:63], s30 offen offset:0 lds
v_mfma_f32_16x16x32_bf16 a[208:211], v[72:75], v[120:123], a[208:211]
ds_read_b128 v[172:175], v24 offset:38912
v_mfma_f32_16x16x32_bf16 a[216:219], v[72:75], v[124:127], a[216:219]
buffer_load_dwordx4 v21, s[60:63], s30 offen offset:1024 lds
v_mfma_f32_16x16x32_bf16 a[20:23], v[76:79], v[96:99], a[20:23]
buffer_load_dwordx4 v22, s[60:63], s30 offen offset:2048 lds
v_mfma_f32_16x16x32_bf16 a[28:31], v[76:79], v[100:103], a[28:31]
ds_read_b64_tr_b16 v[144:145], v12 offset:49152
v_mfma_f32_16x16x32_bf16 a[84:87], v[76:79], v[104:107], a[84:87]
ds_read_b64_tr_b16 v[146:147], v12 offset:50176
v_mfma_f32_16x16x32_bf16 a[92:95], v[76:79], v[108:111], a[92:95]
buffer_load_dwordx4 v23, s[60:63], s30 offen offset:3072 lds
v_mfma_f32_16x16x32_bf16 a[148:151], v[76:79], v[112:115], a[148:151]
ds_read_b128 v[176:179], v25 offset:40960
v_mfma_f32_16x16x32_bf16 a[156:159], v[76:79], v[116:119], a[156:159]
v_mfma_f32_16x16x32_bf16 a[212:215], v[76:79], v[120:123], a[212:215]
v_mfma_f32_16x16x32_bf16 a[220:223], v[76:79], v[124:127], a[220:223]
ds_read_b64_tr_b16 v[148:149], v13 offset:49152
v_mfma_f32_16x16x32_bf16 a[32:35], v[80:83], v[96:99], a[32:35]
ds_read_b64_tr_b16 v[150:151], v13 offset:50176
v_mfma_f32_16x16x32_bf16 a[40:43], v[80:83], v[100:103], a[40:43]
v_mfma_f32_16x16x32_bf16 a[96:99], v[80:83], v[104:107], a[96:99]
ds_read_b128 v[180:183], v24 offset:43008
v_mfma_f32_16x16x32_bf16 a[104:107], v[80:83], v[108:111], a[104:107]
v_mfma_f32_16x16x32_bf16 a[160:163], v[80:83], v[112:115], a[160:163]
v_mfma_f32_16x16x32_bf16 a[168:171], v[80:83], v[116:119], a[168:171]
ds_read_b64_tr_b16 v[152:153], v14 offset:49152
v_mfma_f32_16x16x32_bf16 a[224:227], v[80:83], v[120:123], a[224:227]
ds_read_b64_tr_b16 v[154:155], v14 offset:50176
v_mfma_f32_16x16x32_bf16 a[232:235], v[80:83], v[124:127], a[232:235]
v_mfma_f32_16x16x32_bf16 a[36:39], v[84:87], v[96:99], a[36:39]
ds_read_b128 v[184:187], v25 offset:45056
v_mfma_f32_16x16x32_bf16 a[44:47], v[84:87], v[100:103], a[44:47]
v_mfma_f32_16x16x32_bf16 a[100:103], v[84:87], v[104:107], a[100:103]
v_mfma_f32_16x16x32_bf16 a[108:111], v[84:87], v[108:111], a[108:111]
ds_read_b64_tr_b16 v[156:157], v15 offset:49152
v_mfma_f32_16x16x32_bf16 a[164:167], v[84:87], v[112:115], a[164:167]
ds_read_b64_tr_b16 v[158:159], v15 offset:50176
v_mfma_f32_16x16x32_bf16 a[172:175], v[84:87], v[116:119], a[172:175]
v_mfma_f32_16x16x32_bf16 a[228:231], v[84:87], v[120:123], a[228:231]
ds_read_b128 v[188:191], v24 offset:47104
v_mfma_f32_16x16x32_bf16 a[236:239], v[84:87], v[124:127], a[236:239]
v_mfma_f32_16x16x32_bf16 a[48:51], v[88:91], v[96:99], a[48:51]
v_mfma_f32_16x16x32_bf16 a[56:59], v[88:91], v[100:103], a[56:59]
v_mfma_f32_16x16x32_bf16 a[112:115], v[88:91], v[104:107], a[112:115]
v_mfma_f32_16x16x32_bf16 a[120:123], v[88:91], v[108:111], a[120:123]
v_mfma_f32_16x16x32_bf16 a[176:179], v[88:91], v[112:115], a[176:179]
v_mfma_f32_16x16x32_bf16 a[184:187], v[88:91], v[116:119], a[184:187]
v_mfma_f32_16x16x32_bf16 a[240:243], v[88:91], v[120:123], a[240:243]
v_mfma_f32_16x16x32_bf16 a[248:251], v[88:91], v[124:127], a[248:251]
v_mfma_f32_16x16x32_bf16 a[52:55], v[92:95], v[96:99], a[52:55]
v_mfma_f32_16x16x32_bf16 a[60:63], v[92:95], v[100:103], a[60:63]
v_mfma_f32_16x16x32_bf16 a[116:119], v[92:95], v[104:107], a[116:119]
v_mfma_f32_16x16x32_bf16 a[124:127], v[92:95], v[108:111], a[124:127]
v_mfma_f32_16x16x32_bf16 a[180:183], v[92:95], v[112:115], a[180:183]
v_mfma_f32_16x16x32_bf16 a[188:191], v[92:95], v[116:119], a[188:191]
v_mfma_f32_16x16x32_bf16 a[244:247], v[92:95], v[120:123], a[244:247]
v_mfma_f32_16x16x32_bf16 a[252:255], v[92:95], v[124:127], a[252:255]
s_waitcnt vmcnt(27) lgkmcnt(0)
s_barrier
v_mfma_f32_16x16x32_bf16 a[0:3], v[128:131], v[160:163], a[0:3]
v_and_b32 v8, 0x1fff, v8
v_mfma_f32_16x16x32_bf16 a[8:11], v[128:131], v[164:167], a[8:11]
v_and_b32 v9, 0x1fff, v9
v_mfma_f32_16x16x32_bf16 a[64:67], v[128:131], v[168:171], a[64:67]
v_and_b32 v10, 0x1fff, v10
v_mfma_f32_16x16x32_bf16 a[72:75], v[128:131], v[172:175], a[72:75]
v_and_b32 v11, 0x1fff, v11
v_mfma_f32_16x16x32_bf16 a[128:131], v[128:131], v[176:179], a[128:131]
v_and_b32 v12, 0x1fff, v12
v_mfma_f32_16x16x32_bf16 a[136:139], v[128:131], v[180:183], a[136:139]
v_and_b32 v13, 0x1fff, v13
v_mfma_f32_16x16x32_bf16 a[192:195], v[128:131], v[184:187], a[192:195]
v_and_b32 v14, 0x1fff, v14
v_mfma_f32_16x16x32_bf16 a[200:203], v[128:131], v[188:191], a[200:203]
v_and_b32 v15, 0x1fff, v15
v_mfma_f32_16x16x32_bf16 a[4:7], v[132:135], v[160:163], a[4:7]
buffer_load_dwordx4 v[224:227], v16, s[16:19], s77 offen offset:2048 sc1
v_mfma_f32_16x16x32_bf16 a[12:15], v[132:135], v[164:167], a[12:15]
buffer_load_dwordx4 v[228:231], v17, s[16:19], s77 offen offset:2048 sc1
v_mfma_f32_16x16x32_bf16 a[68:71], v[132:135], v[168:171], a[68:71]
ds_read_b64_tr_b16 v[40:41], v8 offset:0
ds_read_b64_tr_b16 v[42:43], v8 offset:1024
v_mfma_f32_16x16x32_bf16 a[76:79], v[132:135], v[172:175], a[76:79]
buffer_load_dwordx4 v[232:235], v18, s[16:19], s77 offen offset:2048 sc1
v_mfma_f32_16x16x32_bf16 a[132:135], v[132:135], v[176:179], a[132:135]
ds_read_b64_tr_b16 v[44:45], v9 offset:0
ds_read_b64_tr_b16 v[46:47], v9 offset:1024
v_mfma_f32_16x16x32_bf16 a[140:143], v[132:135], v[180:183], a[140:143]
buffer_load_dwordx4 v[236:239], v19, s[16:19], s77 offen offset:2048 sc1
v_mfma_f32_16x16x32_bf16 a[196:199], v[132:135], v[184:187], a[196:199]
ds_read_b64_tr_b16 v[48:49], v10 offset:0
ds_read_b64_tr_b16 v[50:51], v10 offset:1024
v_mfma_f32_16x16x32_bf16 a[204:207], v[132:135], v[188:191], a[204:207]
buffer_load_dwordx4 v[240:243], v16, s[16:19], s77 offen offset:3072 sc1
v_mfma_f32_16x16x32_bf16 a[16:19], v[136:139], v[160:163], a[16:19]
ds_read_b64_tr_b16 v[52:53], v11 offset:0
ds_read_b64_tr_b16 v[54:55], v11 offset:1024
v_mfma_f32_16x16x32_bf16 a[24:27], v[136:139], v[164:167], a[24:27]
buffer_load_dwordx4 v[244:247], v17, s[16:19], s77 offen offset:3072 sc1
v_mfma_f32_16x16x32_bf16 a[80:83], v[136:139], v[168:171], a[80:83]
buffer_load_dwordx4 v[248:251], v18, s[16:19], s77 offen offset:3072 sc1
v_mfma_f32_16x16x32_bf16 a[88:91], v[136:139], v[172:175], a[88:91]
v_mfma_f32_16x16x32_bf16 a[144:147], v[136:139], v[176:179], a[144:147]
buffer_load_dwordx4 v[252:255], v19, s[16:19], s77 offen offset:3072 sc1
v_mfma_f32_16x16x32_bf16 a[152:155], v[136:139], v[180:183], a[152:155]
v_mfma_f32_16x16x32_bf16 a[208:211], v[136:139], v[184:187], a[208:211]
s_add_u32 s77, s77, 4096
v_mfma_f32_16x16x32_bf16 a[216:219], v[136:139], v[188:191], a[216:219]
v_mfma_f32_16x16x32_bf16 a[20:23], v[140:143], v[160:163], a[20:23]
v_mfma_f32_16x16x32_bf16 a[28:31], v[140:143], v[164:167], a[28:31]
s_add_u32 m0, s58, 49152
v_mfma_f32_16x16x32_bf16 a[84:87], v[140:143], v[168:171], a[84:87]
v_mfma_f32_16x16x32_bf16 a[92:95], v[140:143], v[172:175], a[92:95]
v_mfma_f32_16x16x32_bf16 a[148:151], v[140:143], v[176:179], a[148:151]
s_add_u32 s30, s39, 1572864
v_mfma_f32_16x16x32_bf16 a[156:159], v[140:143], v[180:183], a[156:159]
v_mfma_f32_16x16x32_bf16 a[212:215], v[140:143], v[184:187], a[212:215]
v_mfma_f32_16x16x32_bf16 a[220:223], v[140:143], v[188:191], a[220:223]
buffer_load_dwordx4 v20, s[60:63], s30 offen offset:0 lds
v_mfma_f32_16x16x32_bf16 a[32:35], v[144:147], v[160:163], a[32:35]
v_mfma_f32_16x16x32_bf16 a[40:43], v[144:147], v[164:167], a[40:43]
v_mfma_f32_16x16x32_bf16 a[96:99], v[144:147], v[168:171], a[96:99]
buffer_load_dwordx4 v21, s[60:63], s30 offen offset:1024 lds
tp0_p3:
s_cbranch_execz tp0_ret
v_mfma_f32_16x16x32_bf16 a[104:107], v[144:147], v[172:175], a[104:107]
v_mfma_f32_16x16x32_bf16 a[160:163], v[144:147], v[176:179], a[160:163]
v_mfma_f32_16x16x32_bf16 a[168:171], v[144:147], v[180:183], a[168:171]
buffer_load_dwordx4 v22, s[60:63], s30 offen offset:2048 lds
v_mfma_f32_16x16x32_bf16 a[224:227], v[144:147], v[184:187], a[224:227]
v_mfma_f32_16x16x32_bf16 a[232:235], v[144:147], v[188:191], a[232:235]
v_mfma_f32_16x16x32_bf16 a[36:39], v[148:151], v[160:163], a[36:39]
buffer_load_dwordx4 v23, s[60:63], s30 offen offset:3072 lds
v_mfma_f32_16x16x32_bf16 a[44:47], v[148:151], v[164:167], a[44:47]
v_mfma_f32_16x16x32_bf16 a[100:103], v[148:151], v[168:171], a[100:103]
s_add_u32 m0, s58, 98304
v_mfma_f32_16x16x32_bf16 a[108:111], v[148:151], v[172:175], a[108:111]
v_mfma_f32_16x16x32_bf16 a[164:167], v[148:151], v[176:179], a[164:167]
v_mfma_f32_16x16x32_bf16 a[172:175], v[148:151], v[180:183], a[172:175]
s_add_u32 s30, s39, 3145728
v_mfma_f32_16x16x32_bf16 a[228:231], v[148:151], v[184:187], a[228:231]
v_mfma_f32_16x16x32_bf16 a[236:239], v[148:151], v[188:191], a[236:239]
v_mfma_f32_16x16x32_bf16 a[48:51], v[152:155], v[160:163], a[48:51]
buffer_load_dwordx4 v20, s[60:63], s30 offen offset:0 lds
v_mfma_f32_16x16x32_bf16 a[56:59], v[152:155], v[164:167], a[56:59]
v_mfma_f32_16x16x32_bf16 a[112:115], v[152:155], v[168:171], a[112:115]
v_mfma_f32_16x16x32_bf16 a[120:123], v[152:155], v[172:175], a[120:123]
buffer_load_dwordx4 v21, s[60:63], s30 offen offset:1024 lds
v_mfma_f32_16x16x32_bf16 a[176:179], v[152:155], v[176:179], a[176:179]
v_mfma_f32_16x16x32_bf16 a[184:187], v[152:155], v[180:183], a[184:187]
v_mfma_f32_16x16x32_bf16 a[240:243], v[152:155], v[184:187], a[240:243]
buffer_load_dwordx4 v22, s[60:63], s30 offen offset:2048 lds
v_mfma_f32_16x16x32_bf16 a[248:251], v[152:155], v[188:191], a[248:251]
v_mfma_f32_16x16x32_bf16 a[52:55], v[156:159], v[160:163], a[52:55]
v_mfma_f32_16x16x32_bf16 a[60:63], v[156:159], v[164:167], a[60:63]
buffer_load_dwordx4 v23, s[60:63], s30 offen offset:3072 lds
v_mfma_f32_16x16x32_bf16 a[116:119], v[156:159], v[168:171], a[116:119]
v_mfma_f32_16x16x32_bf16 a[124:127], v[156:159], v[172:175], a[124:127]
v_mfma_f32_16x16x32_bf16 a[180:183], v[156:159], v[176:179], a[180:183]
v_mfma_f32_16x16x32_bf16 a[188:191], v[156:159], v[180:183], a[188:191]
v_mfma_f32_16x16x32_bf16 a[244:247], v[156:159], v[184:187], a[244:247]
v_mfma_f32_16x16x32_bf16 a[252:255], v[156:159], v[188:191], a[252:255]
s_waitcnt vmcnt(24) lgkmcnt(4)
s_barrier
s_branch k12_kernel_Q
k12_kernel_V0:
ds_read_b64_tr_b16 v[64:65], v8 offset:0
ds_read_b64_tr_b16 v[66:67], v8 offset:1024
ds_read_b128 v[96:99], v24 offset:0
ds_read_b64_tr_b16 v[68:69], v9 offset:0
ds_read_b64_tr_b16 v[70:71], v9 offset:1024
ds_read_b128 v[100:103], v25 offset:1024
ds_read_b64_tr_b16 v[72:73], v10 offset:0
ds_read_b64_tr_b16 v[74:75], v10 offset:1024
ds_read_b128 v[104:107], v24 offset:4096
ds_read_b64_tr_b16 v[76:77], v11 offset:0
ds_read_b64_tr_b16 v[78:79], v11 offset:1024
ds_read_b128 v[108:111], v25 offset:5120
ds_read_b64_tr_b16 v[80:81], v12 offset:0
ds_read_b64_tr_b16 v[82:83], v12 offset:1024
ds_read_b128 v[112:115], v24 offset:8192
s_waitcnt lgkmcnt(8)
ds_read_b64_tr_b16 v[84:85], v13 offset:0
ds_read_b64_tr_b16 v[86:87], v13 offset:1024
ds_read_b128 v[116:119], v25 offset:9216
ds_read_b64_tr_b16 v[88:89], v14 offset:0
ds_read_b64_tr_b16 v[90:91], v14 offset:1024
ds_read_b128 v[120:123], v24 offset:12288
ds_read_b64_tr_b16 v[92:93], v15 offset:0
ds_read_b64_tr_b16 v[94:95], v15 offset:1024
ds_read_b128 v[124:127], v25 offset:13312
s_waitcnt lgkmcnt(0)
v_mfma_f32_16x16x32_bf16 a[0:3], v[96:99], v[64:67], 0
s_add_u32 m0, s58, 49152
v_lshlrev_b32 v208, 16, v192
v_mfma_f32_16x16x32_bf16 a[4:7], v[100:103], v[64:67], 0
ds_read_b64_tr_b16 v[128:129], v8 offset:16384
v_and_b32 v209, 0xffff0000, v192
v_mfma_f32_16x16x32_bf16 a[64:67], v[104:107], v[64:67], 0
ds_read_b64_tr_b16 v[130:131], v8 offset:17408
s_add_u32 s30, s31, 786432
v_mfma_f32_16x16x32_bf16 a[68:71], v[108:111], v[64:67], 0
v_lshlrev_b32 v210, 16, v193
v_and_b32 v211, 0xffff0000, v193
v_mfma_f32_16x16x32_bf16 a[128:131], v[112:115], v[64:67], 0
ds_read_b128 v[160:163], v25 offset:0
v_lshlrev_b32 v212, 16, v194
v_mfma_f32_16x16x32_bf16 a[132:135], v[116:119], v[64:67], 0
buffer_load_dwordx4 v20, s[8:11], s30 offen offset:0 lds
v_mfma_f32_16x16x32_bf16 a[192:195], v[120:123], v[64:67], 0
v_and_b32 v213, 0xffff0000, v194
v_lshlrev_b32 v214, 16, v195
v_mfma_f32_16x16x32_bf16 a[196:199], v[124:127], v[64:67], 0
ds_read_b64_tr_b16 v[132:133], v9 offset:16384
v_and_b32 v215, 0xffff0000, v195
v_mfma_f32_16x16x32_bf16 a[8:11], v[96:99], v[68:71], 0
ds_read_b64_tr_b16 v[134:135], v9 offset:17408
v_lshlrev_b32 v216, 16, v196
v_mfma_f32_16x16x32_bf16 a[12:15], v[100:103], v[68:71], 0
buffer_load_dwordx4 v21, s[8:11], s30 offen offset:1024 lds
v_mfma_f32_16x16x32_bf16 a[72:75], v[104:107], v[68:71], 0
ds_read_b128 v[164:167], v24 offset:1024
v_and_b32 v217, 0xffff0000, v196
v_mfma_f32_16x16x32_bf16 a[76:79], v[108:111], v[68:71], 0
buffer_load_dwordx4 v22, s[8:11], s30 offen offset:2048 lds
v_mfma_f32_16x16x32_bf16 a[136:139], v[112:115], v[68:71], 0
v_lshlrev_b32 v218, 16, v197
v_and_b32 v219, 0xffff0000, v197
v_mfma_f32_16x16x32_bf16 a[140:143], v[116:119], v[68:71], 0
ds_read_b64_tr_b16 v[136:137], v10 offset:16384
v_lshlrev_b32 v220, 16, v198
v_mfma_f32_16x16x32_bf16 a[200:203], v[120:123], v[68:71], 0
ds_read_b64_tr_b16 v[138:139], v10 offset:17408
v_and_b32 v221, 0xffff0000, v198
v_mfma_f32_16x16x32_bf16 a[204:207], v[124:127], v[68:71], 0
buffer_load_dwordx4 v23, s[8:11], s30 offen offset:3072 lds
v_mfma_f32_16x16x32_bf16 a[16:19], v[96:99], v[72:75], 0
ds_read_b128 v[168:171], v25 offset:4096
s_add_u32 m0, s35, 65536
v_mfma_f32_16x16x32_bf16 a[20:23], v[100:103], v[72:75], 0
v_lshlrev_b32 v222, 16, v199
v_and_b32 v223, 0xffff0000, v199
v_mfma_f32_16x16x32_bf16 a[80:83], v[104:107], v[72:75], 0
s_add_u32 s30, s33, 256
v_lshlrev_b32 v224, 16, v200
v_mfma_f32_16x16x32_bf16 a[84:87], v[108:111], v[72:75], 0
ds_read_b64_tr_b16 v[140:141], v11 offset:16384
v_and_b32 v225, 0xffff0000, v200
v_mfma_f32_16x16x32_bf16 a[144:147], v[112:115], v[72:75], 0
ds_read_b64_tr_b16 v[142:143], v11 offset:17408
v_lshlrev_b32 v226, 16, v201
v_mfma_f32_16x16x32_bf16 a[148:151], v[116:119], v[72:75], 0
buffer_load_dwordx4 v40, s[4:7], s30 offen offset:0 lds
v_mfma_f32_16x16x32_bf16 a[208:211], v[120:123], v[72:75], 0
ds_read_b128 v[172:175], v24 offset:5120
v_and_b32 v227, 0xffff0000, v201
v_mfma_f32_16x16x32_bf16 a[212:215], v[124:127], v[72:75], 0
v_lshlrev_b32 v228, 16, v202
v_and_b32 v229, 0xffff0000, v202
v_mfma_f32_16x16x32_bf16 a[24:27], v[96:99], v[76:79], 0
buffer_load_dwordx4 v41, s[4:7], s30 offen offset:1024 lds
v_mfma_f32_16x16x32_bf16 a[28:31], v[100:103], v[76:79], 0
ds_read_b64_tr_b16 v[144:145], v12 offset:16384
v_lshlrev_b32 v230, 16, v203
v_mfma_f32_16x16x32_bf16 a[88:91], v[104:107], v[76:79], 0
ds_read_b64_tr_b16 v[146:147], v12 offset:17408
v_and_b32 v231, 0xffff0000, v203
v_mfma_f32_16x16x32_bf16 a[92:95], v[108:111], v[76:79], 0
buffer_load_dwordx4 v42, s[4:7], s30 offen offset:2048 lds
v_mfma_f32_16x16x32_bf16 a[152:155], v[112:115], v[76:79], 0
ds_read_b128 v[176:179], v25 offset:8192
v_add_f32 v232, v208, v209
v_mfma_f32_16x16x32_bf16 a[156:159], v[116:119], v[76:79], 0
buffer_load_dwordx4 v43, s[4:7], s30 offen offset:3072 lds
v_mfma_f32_16x16x32_bf16 a[216:219], v[120:123], v[76:79], 0
v_add_f32 v233, v210, v211
v_add_f32 v232, v232, v212
v_mfma_f32_16x16x32_bf16 a[220:223], v[124:127], v[76:79], 0
ds_read_b64_tr_b16 v[148:149], v13 offset:16384
v_add_f32 v233, v233, v213
v_mfma_f32_16x16x32_bf16 a[32:35], v[96:99], v[80:83], 0
ds_read_b64_tr_b16 v[150:151], v13 offset:17408
v_add_f32 v232, v232, v214
v_mfma_f32_16x16x32_bf16 a[36:39], v[100:103], v[80:83], 0
s_mov_b32 s40, 0x0
s_mov_b32 s41, 0xffff0000
v_mfma_f32_16x16x32_bf16 a[96:99], v[104:107], v[80:83], 0
ds_read_b128 v[180:183], v24 offset:9216
v_cndmask_b32 v60, v52, v59, s[40:41]
v_mfma_f32_16x16x32_bf16 a[100:103], v[108:111], v[80:83], 0
v_add_f32 v233, v233, v215
v_add_f32 v232, v232, v216
v_mfma_f32_16x16x32_bf16 a[160:163], v[112:115], v[80:83], 0
v_add_f32 v233, v233, v217
v_add_f32 v232, v232, v218
v_mfma_f32_16x16x32_bf16 a[164:167], v[116:119], v[80:83], 0
ds_read_b64_tr_b16 v[152:153], v14 offset:16384
v_add_f32 v233, v233, v219
v_mfma_f32_16x16x32_bf16 a[224:227], v[120:123], v[80:83], 0
ds_read_b64_tr_b16 v[154:155], v14 offset:17408
v_add_f32 v232, v232, v220
v_mfma_f32_16x16x32_bf16 a[228:231], v[124:127], v[80:83], 0
buffer_load_dword v39, v60, s[4:7], 0 offen
v_mfma_f32_16x16x32_bf16 a[40:43], v[96:99], v[84:87], 0
ds_read_b128 v[184:187], v25 offset:12288
v_add_f32 v233, v233, v221
v_mfma_f32_16x16x32_bf16 a[44:47], v[100:103], v[84:87], 0
v_add_f32 v232, v232, v222
v_add_f32 v233, v233, v223
v_mfma_f32_16x16x32_bf16 a[104:107], v[104:107], v[84:87], 0
v_add_f32 v232, v232, v224
v_add_f32 v233, v233, v225
v_mfma_f32_16x16x32_bf16 a[108:111], v[108:111], v[84:87], 0
ds_read_b64_tr_b16 v[156:157], v15 offset:16384
v_add_f32 v232, v232, v226
v_mfma_f32_16x16x32_bf16 a[168:171], v[112:115], v[84:87], 0
ds_read_b64_tr_b16 v[158:159], v15 offset:17408
v_add_f32 v233, v233, v227
v_mfma_f32_16x16x32_bf16 a[172:175], v[116:119], v[84:87], 0
v_add_f32 v232, v232, v228
v_add_f32 v233, v233, v229
v_mfma_f32_16x16x32_bf16 a[232:235], v[120:123], v[84:87], 0
ds_read_b128 v[188:191], v24 offset:13312
v_add_f32 v232, v232, v230
v_mfma_f32_16x16x32_bf16 a[236:239], v[124:127], v[84:87], 0
v_add_f32 v233, v233, v231
v_add_f32 v232, v232, v233
v_mfma_f32_16x16x32_bf16 a[48:51], v[96:99], v[88:91], 0
s_nop 0
v_add_f32_dpp v232, v232, v232 row_ror:8 row_mask:0xf bank_mask:0xf
v_mfma_f32_16x16x32_bf16 a[52:55], v[100:103], v[88:91], 0
s_nop 0
v_add_f32_dpp v232, v232, v232 row_ror:4 row_mask:0xf bank_mask:0xf
v_mfma_f32_16x16x32_bf16 a[112:115], v[104:107], v[88:91], 0
s_nop 0
v_add_f32_dpp v232, v232, v232 row_ror:2 row_mask:0xf bank_mask:0xf
v_mfma_f32_16x16x32_bf16 a[116:119], v[108:111], v[88:91], 0
s_nop 0
v_add_f32_dpp v232, v232, v232 row_ror:1 row_mask:0xf bank_mask:0xf
v_mfma_f32_16x16x32_bf16 a[176:179], v[112:115], v[88:91], 0
v_mov_b32 v234, v232
v_mfma_f32_16x16x32_bf16 a[180:183], v[116:119], v[88:91], 0
s_nop 0
v_permlane16_swap_b32 v232, v234
v_mfma_f32_16x16x32_bf16 a[240:243], v[120:123], v[88:91], 0
v_add_f32 v232, v232, v234
v_mul_f32 v232, 0x3ae38e39, v232
v_mfma_f32_16x16x32_bf16 a[244:247], v[124:127], v[88:91], 0
v_sub_f32 v208, v208, v232
v_sub_f32 v209, v209, v232
v_mfma_f32_16x16x32_bf16 a[56:59], v[96:99], v[92:95], 0
v_sub_f32 v210, v210, v232
v_sub_f32 v211, v211, v232
v_mfma_f32_16x16x32_bf16 a[60:63], v[100:103], v[92:95], 0
v_sub_f32 v212, v212, v232
v_sub_f32 v213, v213, v232
v_mfma_f32_16x16x32_bf16 a[120:123], v[104:107], v[92:95], 0
v_sub_f32 v214, v214, v232
v_sub_f32 v215, v215, v232
v_mfma_f32_16x16x32_bf16 a[124:127], v[108:111], v[92:95], 0
v_sub_f32 v216, v216, v232
v_sub_f32 v217, v217, v232
v_mfma_f32_16x16x32_bf16 a[184:187], v[112:115], v[92:95], 0
v_sub_f32 v218, v218, v232
v_sub_f32 v219, v219, v232
v_mfma_f32_16x16x32_bf16 a[188:191], v[116:119], v[92:95], 0
v_sub_f32 v220, v220, v232
v_sub_f32 v221, v221, v232
v_mfma_f32_16x16x32_bf16 a[248:251], v[120:123], v[92:95], 0
v_sub_f32 v222, v222, v232
v_sub_f32 v223, v223, v232
v_mfma_f32_16x16x32_bf16 a[252:255], v[124:127], v[92:95], 0
s_waitcnt vmcnt(11) lgkmcnt(0)
s_barrier
v_mfma_f32_16x16x32_bf16 a[0:3], v[160:163], v[128:131], a[0:3]
s_add_u32 m0, s58, 0
v_sub_f32 v224, v224, v232
v_mfma_f32_16x16x32_bf16 a[4:7], v[164:167], v[128:131], a[4:7]
ds_read_b64_tr_b16 v[64:65], v8 offset:32768
v_sub_f32 v225, v225, v232
v_mfma_f32_16x16x32_bf16 a[64:67], v[168:171], v[128:131], a[64:67]
ds_read_b64_tr_b16 v[66:67], v8 offset:33792
v_sub_f32 v226, v226, v232
v_mfma_f32_16x16x32_bf16 a[68:71], v[172:175], v[128:131], a[68:71]
v_sub_f32 v227, v227, v232
v_sub_f32 v228, v228, v232
v_mfma_f32_16x16x32_bf16 a[128:131], v[176:179], v[128:131], a[128:131]
ds_read_b128 v[96:99], v24 offset:32768
s_add_u32 s30, s31, 1048576
v_mfma_f32_16x16x32_bf16 a[132:135], v[180:183], v[128:131], a[132:135]
v_sub_f32 v229, v229, v232
v_sub_f32 v230, v230, v232
v_mfma_f32_16x16x32_bf16 a[192:195], v[184:187], v[128:131], a[192:195]
v_sub_f32 v231, v231, v232
v_mul_f32 v232, v208, v208
v_mfma_f32_16x16x32_bf16 a[196:199], v[188:191], v[128:131], a[196:199]
ds_read_b64_tr_b16 v[68:69], v9 offset:32768
v_mul_f32 v233, v224, v224
v_mfma_f32_16x16x32_bf16 a[8:11], v[160:163], v[132:135], a[8:11]
ds_read_b64_tr_b16 v[70:71], v9 offset:33792
v_fmac_f32 v232, v209, v209
v_mfma_f32_16x16x32_bf16 a[12:15], v[164:167], v[132:135], a[12:15]
buffer_load_dwordx4 v20, s[8:11], s30 offen offset:0 lds
v_mfma_f32_16x16x32_bf16 a[72:75], v[168:171], v[132:135], a[72:75]
ds_read_b128 v[100:103], v25 offset:33792
v_fmac_f32 v233, v225, v225
v_mfma_f32_16x16x32_bf16 a[76:79], v[172:175], v[132:135], a[76:79]
v_fmac_f32 v232, v210, v210
v_fmac_f32 v233, v226, v226
v_mfma_f32_16x16x32_bf16 a[136:139], v[176:179], v[132:135], a[136:139]
buffer_load_dwordx4 v21, s[8:11], s30 offen offset:1024 lds
v_mfma_f32_16x16x32_bf16 a[140:143], v[180:183], v[132:135], a[140:143]
ds_read_b64_tr_b16 v[72:73], v10 offset:32768
v_fmac_f32 v232, v211, v211
v_mfma_f32_16x16x32_bf16 a[200:203], v[184:187], v[132:135], a[200:203]
ds_read_b64_tr_b16 v[74:75], v10 offset:33792
v_fmac_f32 v233, v227, v227
v_mfma_f32_16x16x32_bf16 a[204:207], v[188:191], v[132:135], a[204:207]
v_fmac_f32 v232, v212, v212
v_fmac_f32 v233, v228, v228
v_mfma_f32_16x16x32_bf16 a[16:19], v[160:163], v[136:139], a[16:19]
ds_read_b128 v[104:107], v24 offset:36864
v_fmac_f32 v232, v213, v213
v_mfma_f32_16x16x32_bf16 a[20:23], v[164:167], v[136:139], a[20:23]
buffer_load_dwordx4 v22, s[8:11], s30 offen offset:2048 lds
v_mfma_f32_16x16x32_bf16 a[80:83], v[168:171], v[136:139], a[80:83]
v_fmac_f32 v233, v229, v229
v_fmac_f32 v232, v214, v214
v_mfma_f32_16x16x32_bf16 a[84:87], v[172:175], v[136:139], a[84:87]
ds_read_b64_tr_b16 v[76:77], v11 offset:32768
v_fmac_f32 v233, v230, v230
v_mfma_f32_16x16x32_bf16 a[144:147], v[176:179], v[136:139], a[144:147]
ds_read_b64_tr_b16 v[78:79], v11 offset:33792
v_fmac_f32 v232, v215, v215
v_mfma_f32_16x16x32_bf16 a[148:151], v[180:183], v[136:139], a[148:151]
buffer_load_dwordx4 v23, s[8:11], s30 offen offset:3072 lds
v_mfma_f32_16x16x32_bf16 a[208:211], v[184:187], v[136:139], a[208:211]
ds_read_b128 v[108:111], v25 offset:37888
v_fmac_f32 v233, v231, v231
v_mfma_f32_16x16x32_bf16 a[212:215], v[188:191], v[136:139], a[212:215]
v_fmac_f32 v232, v216, v216
v_fmac_f32 v232, v217, v217
v_mfma_f32_16x16x32_bf16 a[24:27], v[160:163], v[140:143], a[24:27]
s_add_u32 m0, s35, 69632
v_fmac_f32 v232, v218, v218
v_mfma_f32_16x16x32_bf16 a[28:31], v[164:167], v[140:143], a[28:31]
ds_read_b64_tr_b16 v[80:81], v12 offset:32768
v_fmac_f32 v232, v219, v219
v_mfma_f32_16x16x32_bf16 a[88:91], v[168:171], v[140:143], a[88:91]
ds_read_b64_tr_b16 v[82:83], v12 offset:33792
v_fmac_f32 v232, v220, v220
v_mfma_f32_16x16x32_bf16 a[92:95], v[172:175], v[140:143], a[92:95]
v_fmac_f32 v232, v221, v221
v_fmac_f32 v232, v222, v222
v_mfma_f32_16x16x32_bf16 a[152:155], v[176:179], v[140:143], a[152:155]
ds_read_b128 v[112:115], v24 offset:40960
s_add_u32 s30, s33, 256
v_mfma_f32_16x16x32_bf16 a[156:159], v[180:183], v[140:143], a[156:159]
v_fmac_f32 v232, v223, v223
v_cndmask_b32 v233, 0, v233, s[42:43]
v_mfma_f32_16x16x32_bf16 a[216:219], v[184:187], v[140:143], a[216:219]
v_add_f32 v232, v232, v233
v_mfma_f32_16x16x32_bf16 a[220:223], v[188:191], v[140:143], a[220:223]
ds_read_b64_tr_b16 v[84:85], v13 offset:32768
v_mfma_f32_16x16x32_bf16 a[32:35], v[160:163], v[144:147], a[32:35]
ds_read_b64_tr_b16 v[86:87], v13 offset:33792
v_mfma_f32_16x16x32_bf16 a[36:39], v[164:167], v[144:147], a[36:39]
buffer_load_dwordx4 v44, s[4:7], s30 offen offset:0 lds
v_mfma_f32_16x16x32_bf16 a[96:99], v[168:171], v[144:147], a[96:99]
ds_read_b128 v[116:119], v25 offset:41984
v_mfma_f32_16x16x32_bf16 a[100:103], v[172:175], v[144:147], a[100:103]
s_nop 0
v_add_f32_dpp v232, v232, v232 row_ror:8 row_mask:0xf bank_mask:0xf
v_mfma_f32_16x16x32_bf16 a[160:163], v[176:179], v[144:147], a[160:163]
buffer_load_dwordx4 v45, s[4:7], s30 offen offset:1024 lds
v_mfma_f32_16x16x32_bf16 a[164:167], v[180:183], v[144:147], a[164:167]
ds_read_b64_tr_b16 v[88:89], v14 offset:32768
v_mfma_f32_16x16x32_bf16 a[224:227], v[184:187], v[144:147], a[224:227]
ds_read_b64_tr_b16 v[90:91], v14 offset:33792
v_mfma_f32_16x16x32_bf16 a[228:231], v[188:191], v[144:147], a[228:231]
s_nop 0
v_add_f32_dpp v232, v232, v232 row_ror:4 row_mask:0xf bank_mask:0xf
v_mfma_f32_16x16x32_bf16 a[40:43], v[160:163], v[148:151], a[40:43]
ds_read_b128 v[120:123], v24 offset:45056
v_mfma_f32_16x16x32_bf16 a[44:47], v[164:167], v[148:151], a[44:47]
buffer_load_dwordx4 v46, s[4:7], s30 offen offset:2048 lds
v_mfma_f32_16x16x32_bf16 a[104:107], v[168:171], v[148:151], a[104:107]
s_nop 0
v_add_f32_dpp v232, v232, v232 row_ror:2 row_mask:0xf bank_mask:0xf
v_mfma_f32_16x16x32_bf16 a[108:111], v[172:175], v[148:151], a[108:111]
ds_read_b64_tr_b16 v[92:93], v15 offset:32768
v_mfma_f32_16x16x32_bf16 a[168:171], v[176:179], v[148:151], a[168:171]
ds_read_b64_tr_b16 v[94:95], v15 offset:33792
v_mfma_f32_16x16x32_bf16 a[172:175], v[180:183], v[148:151], a[172:175]
buffer_load_dwordx4 v47, s[4:7], s30 offen offset:3072 lds
v_mfma_f32_16x16x32_bf16 a[232:235], v[184:187], v[148:151], a[232:235]
ds_read_b128 v[124:127], v25 offset:46080
v_mfma_f32_16x16x32_bf16 a[236:239], v[188:191], v[148:151], a[236:239]
s_nop 0
v_add_f32_dpp v232, v232, v232 row_ror:1 row_mask:0xf bank_mask:0xf
v_mfma_f32_16x16x32_bf16 a[48:51], v[160:163], v[152:155], a[48:51]
s_mov_b32 s40, 0xff000000
s_mov_b32 s41, 0x0
v_mfma_f32_16x16x32_bf16 a[52:55], v[164:167], v[152:155], a[52:55]
v_mov_b32 v234, v232
v_mfma_f32_16x16x32_bf16 a[112:115], v[168:171], v[152:155], a[112:115]
s_nop 0
v_permlane16_swap_b32 v232, v234
v_mfma_f32_16x16x32_bf16 a[116:119], v[172:175], v[152:155], a[116:119]
v_add_f32 v232, v232, v234
v_mov_b32 v233, 0x3727c5ac
v_mfma_f32_16x16x32_bf16 a[176:179], v[176:179], v[152:155], a[176:179]
v_cndmask_b32 v60, v52, v57, s[40:41]
v_fmac_f32 v233, 0x3ae38e39, v232
v_mfma_f32_16x16x32_bf16 a[180:183], v[180:183], v[152:155], a[180:183]
v_rsq_f32 v233, v233
v_mfma_f32_16x16x32_bf16 a[240:243], v[184:187], v[152:155], a[240:243]
v_mul_f32 v233, 0x3e0293ee, v233
v_mul_f32 v208, v208, v233
v_mfma_f32_16x16x32_bf16 a[244:247], v[188:191], v[152:155], a[244:247]
v_mul_f32 v209, v209, v233
v_mul_f32 v210, v210, v233
v_mfma_f32_16x16x32_bf16 a[56:59], v[160:163], v[156:159], a[56:59]
buffer_load_dword v39, v60, s[8:11], 0 offen
v_mfma_f32_16x16x32_bf16 a[60:63], v[164:167], v[156:159], a[60:63]
v_mul_f32 v211, v211, v233
v_mul_f32 v212, v212, v233
v_mfma_f32_16x16x32_bf16 a[120:123], v[168:171], v[156:159], a[120:123]
v_mul_f32 v213, v213, v233
v_mul_f32 v214, v214, v233
v_mfma_f32_16x16x32_bf16 a[124:127], v[172:175], v[156:159], a[124:127]
v_mul_f32 v215, v215, v233
v_mul_f32 v216, v216, v233
v_mfma_f32_16x16x32_bf16 a[184:187], v[176:179], v[156:159], a[184:187]
v_mul_f32 v217, v217, v233
v_mul_f32 v218, v218, v233
v_mfma_f32_16x16x32_bf16 a[188:191], v[180:183], v[156:159], a[188:191]
v_mul_f32 v219, v219, v233
v_mul_f32 v220, v220, v233
v_mfma_f32_16x16x32_bf16 a[248:251], v[184:187], v[156:159], a[248:251]
v_mul_f32 v221, v221, v233
v_mul_f32 v222, v222, v233
v_mfma_f32_16x16x32_bf16 a[252:255], v[188:191], v[156:159], a[252:255]
s_waitcnt vmcnt(14) lgkmcnt(0)
s_barrier
v_mfma_f32_16x16x32_bf16 a[0:3], v[96:99], v[64:67], a[0:3]
s_add_u32 m0, s58, 16384
v_mul_f32 v223, v223, v233
v_mfma_f32_16x16x32_bf16 a[4:7], v[100:103], v[64:67], a[4:7]
ds_read_b64_tr_b16 v[128:129], v8 offset:49152
v_mul_f32 v224, v224, v233
v_mfma_f32_16x16x32_bf16 a[64:67], v[104:107], v[64:67], a[64:67]
ds_read_b64_tr_b16 v[130:131], v8 offset:50176
v_mul_f32 v225, v225, v233
v_mfma_f32_16x16x32_bf16 a[68:71], v[108:111], v[64:67], a[68:71]
s_add_u32 s30, s31, 1310720
v_mul_f32 v226, v226, v233
v_mfma_f32_16x16x32_bf16 a[128:131], v[112:115], v[64:67], a[128:131]
ds_read_b128 v[160:163], v25 offset:32768
v_mul_f32 v227, v227, v233
v_mfma_f32_16x16x32_bf16 a[132:135], v[116:119], v[64:67], a[132:135]
v_mul_f32 v228, v228, v233
v_mul_f32 v229, v229, v233
v_mfma_f32_16x16x32_bf16 a[192:195], v[120:123], v[64:67], a[192:195]
v_mul_f32 v230, v230, v233
v_mul_f32 v231, v231, v233
v_mfma_f32_16x16x32_bf16 a[196:199], v[124:127], v[64:67], a[196:199]
ds_read_b64_tr_b16 v[132:133], v9 offset:49152
v_cvt_pk_bf16_f32 v192, v208, v209
v_mfma_f32_16x16x32_bf16 a[8:11], v[96:99], v[68:71], a[8:11]
ds_read_b64_tr_b16 v[134:135], v9 offset:50176
v_cvt_pk_bf16_f32 v193, v210, v211
v_mfma_f32_16x16x32_bf16 a[12:15], v[100:103], v[68:71], a[12:15]
buffer_load_dwordx4 v20, s[8:11], s30 offen offset:0 lds
v_mfma_f32_16x16x32_bf16 a[72:75], v[104:107], v[68:71], a[72:75]
ds_read_b128 v[164:167], v24 offset:33792
v_cvt_pk_bf16_f32 v194, v212, v213
v_mfma_f32_16x16x32_bf16 a[76:79], v[108:111], v[68:71], a[76:79]
buffer_load_dwordx4 v21, s[8:11], s30 offen offset:1024 lds
v_mfma_f32_16x16x32_bf16 a[136:139], v[112:115], v[68:71], a[136:139]
v_cvt_pk_bf16_f32 v195, v214, v215
v_cvt_pk_bf16_f32 v196, v216, v217
v_mfma_f32_16x16x32_bf16 a[140:143], v[116:119], v[68:71], a[140:143]
ds_read_b64_tr_b16 v[136:137], v10 offset:49152
v_cvt_pk_bf16_f32 v197, v218, v219
v_mfma_f32_16x16x32_bf16 a[200:203], v[120:123], v[68:71], a[200:203]
ds_read_b64_tr_b16 v[138:139], v10 offset:50176
v_cvt_pk_bf16_f32 v198, v220, v221
v_mfma_f32_16x16x32_bf16 a[204:207], v[124:127], v[68:71], a[204:207]
buffer_load_dwordx4 v22, s[8:11], s30 offen offset:2048 lds
v_mfma_f32_16x16x32_bf16 a[16:19], v[96:99], v[72:75], a[16:19]
ds_read_b128 v[168:171], v25 offset:36864
v_cvt_pk_bf16_f32 v199, v222, v223
v_mfma_f32_16x16x32_bf16 a[20:23], v[100:103], v[72:75], a[20:23]
v_cvt_pk_bf16_f32 v200, v224, v225
v_cvt_pk_bf16_f32 v201, v226, v227
v_mfma_f32_16x16x32_bf16 a[80:83], v[104:107], v[72:75], a[80:83]
buffer_load_dwordx4 v23, s[8:11], s30 offen offset:3072 lds
v_mfma_f32_16x16x32_bf16 a[84:87], v[108:111], v[72:75], a[84:87]
ds_read_b64_tr_b16 v[140:141], v11 offset:49152
v_cvt_pk_bf16_f32 v202, v228, v229
v_mfma_f32_16x16x32_bf16 a[144:147], v[112:115], v[72:75], a[144:147]
ds_read_b64_tr_b16 v[142:143], v11 offset:50176
v_cvt_pk_bf16_f32 v203, v230, v231
v_mfma_f32_16x16x32_bf16 a[148:151], v[116:119], v[72:75], a[148:151]
v_mfma_f32_16x16x32_bf16 a[208:211], v[120:123], v[72:75], a[208:211]
ds_read_b128 v[172:175], v24 offset:37888
s_add_u32 m0, s35, 0
v_mfma_f32_16x16x32_bf16 a[212:215], v[124:127], v[72:75], a[212:215]
v_mfma_f32_16x16x32_bf16 a[24:27], v[96:99], v[76:79], a[24:27]
v_mfma_f32_16x16x32_bf16 a[28:31], v[100:103], v[76:79], a[28:31]
ds_read_b64_tr_b16 v[144:145], v12 offset:49152
v_mfma_f32_16x16x32_bf16 a[88:91], v[104:107], v[76:79], a[88:91]
ds_read_b64_tr_b16 v[146:147], v12 offset:50176
s_add_u32 s30, s33, 384
v_mfma_f32_16x16x32_bf16 a[92:95], v[108:111], v[76:79], a[92:95]
v_mfma_f32_16x16x32_bf16 a[152:155], v[112:115], v[76:79], a[152:155]
ds_read_b128 v[176:179], v25 offset:40960
v_mfma_f32_16x16x32_bf16 a[156:159], v[116:119], v[76:79], a[156:159]
v_mfma_f32_16x16x32_bf16 a[216:219], v[120:123], v[76:79], a[216:219]
buffer_load_dwordx4 v40, s[4:7], s30 offen offset:0 lds
v_mfma_f32_16x16x32_bf16 a[220:223], v[124:127], v[76:79], a[220:223]
ds_read_b64_tr_b16 v[148:149], v13 offset:49152
v_mfma_f32_16x16x32_bf16 a[32:35], v[96:99], v[80:83], a[32:35]
ds_read_b64_tr_b16 v[150:151], v13 offset:50176
v_mfma_f32_16x16x32_bf16 a[36:39], v[100:103], v[80:83], a[36:39]
buffer_load_dwordx4 v41, s[4:7], s30 offen offset:1024 lds
v_mfma_f32_16x16x32_bf16 a[96:99], v[104:107], v[80:83], a[96:99]
ds_read_b128 v[180:183], v24 offset:41984
v_mfma_f32_16x16x32_bf16 a[100:103], v[108:111], v[80:83], a[100:103]
v_mfma_f32_16x16x32_bf16 a[160:163], v[112:115], v[80:83], a[160:163]
v_mfma_f32_16x16x32_bf16 a[164:167], v[116:119], v[80:83], a[164:167]
ds_read_b64_tr_b16 v[152:153], v14 offset:49152
v_mfma_f32_16x16x32_bf16 a[224:227], v[120:123], v[80:83], a[224:227]
ds_read_b64_tr_b16 v[154:155], v14 offset:50176
v_mfma_f32_16x16x32_bf16 a[228:231], v[124:127], v[80:83], a[228:231]
buffer_load_dwordx4 v42, s[4:7], s30 offen offset:2048 lds
v_mfma_f32_16x16x32_bf16 a[40:43], v[96:99], v[84:87], a[40:43]
ds_read_b128 v[184:187], v25 offset:45056
v_mfma_f32_16x16x32_bf16 a[44:47], v[100:103], v[84:87], a[44:47]
buffer_load_dwordx4 v43, s[4:7], s30 offen offset:3072 lds
v_mfma_f32_16x16x32_bf16 a[104:107], v[104:107], v[84:87], a[104:107]
v_mfma_f32_16x16x32_bf16 a[108:111], v[108:111], v[84:87], a[108:111]
ds_read_b64_tr_b16 v[156:157], v15 offset:49152
v_mfma_f32_16x16x32_bf16 a[168:171], v[112:115], v[84:87], a[168:171]
ds_read_b64_tr_b16 v[158:159], v15 offset:50176
v_mfma_f32_16x16x32_bf16 a[172:175], v[116:119], v[84:87], a[172:175]
s_mov_b32 s40, 0xffff
s_mov_b32 s41, 0x0
v_mfma_f32_16x16x32_bf16 a[232:235], v[120:123], v[84:87], a[232:235]
ds_read_b128 v[188:191], v24 offset:46080
v_mfma_f32_16x16x32_bf16 a[236:239], v[124:127], v[84:87], a[236:239]
v_mfma_f32_16x16x32_bf16 a[48:51], v[96:99], v[88:91], a[48:51]
v_cndmask_b32 v60, v52, v59, s[40:41]
v_mfma_f32_16x16x32_bf16 a[52:55], v[100:103], v[88:91], a[52:55]
v_mfma_f32_16x16x32_bf16 a[112:115], v[104:107], v[88:91], a[112:115]
v_mfma_f32_16x16x32_bf16 a[116:119], v[108:111], v[88:91], a[116:119]
v_mfma_f32_16x16x32_bf16 a[176:179], v[112:115], v[88:91], a[176:179]
buffer_load_dword v39, v60, s[4:7], 0 offen offset:512
v_mfma_f32_16x16x32_bf16 a[180:183], v[116:119], v[88:91], a[180:183]
v_mfma_f32_16x16x32_bf16 a[240:243], v[120:123], v[88:91], a[240:243]
v_mfma_f32_16x16x32_bf16 a[244:247], v[124:127], v[88:91], a[244:247]
v_mfma_f32_16x16x32_bf16 a[56:59], v[96:99], v[92:95], a[56:59]
buffer_atomic_add v61, v62, s[20:23], s38 offen
v_mfma_f32_16x16x32_bf16 a[60:63], v[100:103], v[92:95], a[60:63]
v_mfma_f32_16x16x32_bf16 a[120:123], v[104:107], v[92:95], a[120:123]
v_mfma_f32_16x16x32_bf16 a[124:127], v[108:111], v[92:95], a[124:127]
v_mfma_f32_16x16x32_bf16 a[184:187], v[112:115], v[92:95], a[184:187]
v_mfma_f32_16x16x32_bf16 a[188:191], v[116:119], v[92:95], a[188:191]
v_mfma_f32_16x16x32_bf16 a[248:251], v[120:123], v[92:95], a[248:251]
v_mfma_f32_16x16x32_bf16 a[252:255], v[124:127], v[92:95], a[252:255]
s_waitcnt vmcnt(11) lgkmcnt(0)
s_barrier
v_mfma_f32_16x16x32_bf16 a[0:3], v[160:163], v[128:131], a[0:3]
s_add_u32 m0, s58, 32768
ds_write_b128 v32, v[192:195] offset:0
v_mfma_f32_16x16x32_bf16 a[4:7], v[164:167], v[128:131], a[4:7]
ds_read_b64_tr_b16 v[64:65], v8 offset:0
ds_write_b128 v32, v[196:199] offset:8192
v_mfma_f32_16x16x32_bf16 a[64:67], v[168:171], v[128:131], a[64:67]
ds_read_b64_tr_b16 v[66:67], v8 offset:1024
ds_write_b128 v32, v[200:203] offset:16384
v_mfma_f32_16x16x32_bf16 a[68:71], v[172:175], v[128:131], a[68:71]
v_mfma_f32_16x16x32_bf16 a[128:131], v[176:179], v[128:131], a[128:131]
ds_read_b128 v[96:99], v26 offset:0
s_add_u32 s30, s31, 1572864
v_mfma_f32_16x16x32_bf16 a[132:135], v[180:183], v[128:131], a[132:135]
v_mfma_f32_16x16x32_bf16 a[192:195], v[184:187], v[128:131], a[192:195]
v_mfma_f32_16x16x32_bf16 a[196:199], v[188:191], v[128:131], a[196:199]
ds_read_b64_tr_b16 v[68:69], v9 offset:0
v_mfma_f32_16x16x32_bf16 a[8:11], v[160:163], v[132:135], a[8:11]
ds_read_b64_tr_b16 v[70:71], v9 offset:1024
v_mfma_f32_16x16x32_bf16 a[12:15], v[164:167], v[132:135], a[12:15]
buffer_load_dwordx4 v20, s[8:11], s30 offen offset:0 lds
v_mfma_f32_16x16x32_bf16 a[72:75], v[168:171], v[132:135], a[72:75]
ds_read_b128 v[100:103], v27 offset:1024
v_mfma_f32_16x16x32_bf16 a[76:79], v[172:175], v[132:135], a[76:79]
v_mfma_f32_16x16x32_bf16 a[136:139], v[176:179], v[132:135], a[136:139]
buffer_load_dwordx4 v21, s[8:11], s30 offen offset:1024 lds
v_mfma_f32_16x16x32_bf16 a[140:143], v[180:183], v[132:135], a[140:143]
ds_read_b64_tr_b16 v[72:73], v10 offset:0
v_mfma_f32_16x16x32_bf16 a[200:203], v[184:187], v[132:135], a[200:203]
ds_read_b64_tr_b16 v[74:75], v10 offset:1024
v_mfma_f32_16x16x32_bf16 a[204:207], v[188:191], v[132:135], a[204:207]
v_mfma_f32_16x16x32_bf16 a[16:19], v[160:163], v[136:139], a[16:19]
ds_read_b128 v[104:107], v26 offset:4096
v_mfma_f32_16x16x32_bf16 a[20:23], v[164:167], v[136:139], a[20:23]
buffer_load_dwordx4 v22, s[8:11], s30 offen offset:2048 lds
tp0_p4:
s_cbranch_execz tp0_ret
v_mfma_f32_16x16x32_bf16 a[80:83], v[168:171], v[136:139], a[80:83]
v_mfma_f32_16x16x32_bf16 a[84:87], v[172:175], v[136:139], a[84:87]
ds_read_b64_tr_b16 v[76:77], v11 offset:0
v_mfma_f32_16x16x32_bf16 a[144:147], v[176:179], v[136:139], a[144:147]
ds_read_b64_tr_b16 v[78:79], v11 offset:1024
v_mfma_f32_16x16x32_bf16 a[148:151], v[180:183], v[136:139], a[148:151]
buffer_load_dwordx4 v23, s[8:11], s30 offen offset:3072 lds
v_mfma_f32_16x16x32_bf16 a[208:211], v[184:187], v[136:139], a[208:211]
ds_read_b128 v[108:111], v27 offset:5120
v_mfma_f32_16x16x32_bf16 a[212:215], v[188:191], v[136:139], a[212:215]
v_mfma_f32_16x16x32_bf16 a[24:27], v[160:163], v[140:143], a[24:27]
s_add_u32 m0, s35, 4096
v_mfma_f32_16x16x32_bf16 a[28:31], v[164:167], v[140:143], a[28:31]
ds_read_b64_tr_b16 v[80:81], v12 offset:0
v_mfma_f32_16x16x32_bf16 a[88:91], v[168:171], v[140:143], a[88:91]
ds_read_b64_tr_b16 v[82:83], v12 offset:1024
v_mfma_f32_16x16x32_bf16 a[92:95], v[172:175], v[140:143], a[92:95]
v_mfma_f32_16x16x32_bf16 a[152:155], v[176:179], v[140:143], a[152:155]
ds_read_b128 v[112:115], v26 offset:8192
s_add_u32 s30, s33, 384
v_mfma_f32_16x16x32_bf16 a[156:159], v[180:183], v[140:143], a[156:159]
v_mfma_f32_16x16x32_bf16 a[216:219], v[184:187], v[140:143], a[216:219]
v_mfma_f32_16x16x32_bf16 a[220:223], v[188:191], v[140:143], a[220:223]
ds_read_b64_tr_b16 v[84:85], v13 offset:0
v_mfma_f32_16x16x32_bf16 a[32:35], v[160:163], v[144:147], a[32:35]
ds_read_b64_tr_b16 v[86:87], v13 offset:1024
v_mfma_f32_16x16x32_bf16 a[36:39], v[164:167], v[144:147], a[36:39]
buffer_load_dwordx4 v44, s[4:7], s30 offen offset:0 lds
v_mfma_f32_16x16x32_bf16 a[96:99], v[168:171], v[144:147], a[96:99]
ds_read_b128 v[116:119], v27 offset:9216
v_mfma_f32_16x16x32_bf16 a[100:103], v[172:175], v[144:147], a[100:103]
v_mfma_f32_16x16x32_bf16 a[160:163], v[176:179], v[144:147], a[160:163]
buffer_load_dwordx4 v45, s[4:7], s30 offen offset:1024 lds
v_mfma_f32_16x16x32_bf16 a[164:167], v[180:183], v[144:147], a[164:167]
ds_read_b64_tr_b16 v[88:89], v14 offset:0
v_mfma_f32_16x16x32_bf16 a[224:227], v[184:187], v[144:147], a[224:227]
ds_read_b64_tr_b16 v[90:91], v14 offset:1024
v_mfma_f32_16x16x32_bf16 a[228:231], v[188:191], v[144:147], a[228:231]
v_mfma_f32_16x16x32_bf16 a[40:43], v[160:163], v[148:151], a[40:43]
ds_read_b128 v[120:123], v26 offset:12288
v_mfma_f32_16x16x32_bf16 a[44:47], v[164:167], v[148:151], a[44:47]
buffer_load_dwordx4 v46, s[4:7], s30 offen offset:2048 lds
v_mfma_f32_16x16x32_bf16 a[104:107], v[168:171], v[148:151], a[104:107]
v_mfma_f32_16x16x32_bf16 a[108:111], v[172:175], v[148:151], a[108:111]
ds_read_b64_tr_b16 v[92:93], v15 offset:0
v_mfma_f32_16x16x32_bf16 a[168:171], v[176:179], v[148:151], a[168:171]
ds_read_b64_tr_b16 v[94:95], v15 offset:1024
v_mfma_f32_16x16x32_bf16 a[172:175], v[180:183], v[148:151], a[172:175]
buffer_load_dwordx4 v47, s[4:7], s30 offen offset:3072 lds
v_mfma_f32_16x16x32_bf16 a[232:235], v[184:187], v[148:151], a[232:235]
ds_read_b128 v[124:127], v27 offset:13312
v_mfma_f32_16x16x32_bf16 a[236:239], v[188:191], v[148:151], a[236:239]
v_mfma_f32_16x16x32_bf16 a[48:51], v[160:163], v[152:155], a[48:51]
s_mov_b32 s40, 0x0
s_mov_b32 s41, 0xff
v_mfma_f32_16x16x32_bf16 a[52:55], v[164:167], v[152:155], a[52:55]
v_mfma_f32_16x16x32_bf16 a[112:115], v[168:171], v[152:155], a[112:115]
v_mfma_f32_16x16x32_bf16 a[116:119], v[172:175], v[152:155], a[116:119]
v_mfma_f32_16x16x32_bf16 a[176:179], v[176:179], v[152:155], a[176:179]
v_cndmask_b32 v60, v52, v57, s[40:41]
v_mfma_f32_16x16x32_bf16 a[180:183], v[180:183], v[152:155], a[180:183]
v_mfma_f32_16x16x32_bf16 a[240:243], v[184:187], v[152:155], a[240:243]
v_mfma_f32_16x16x32_bf16 a[244:247], v[188:191], v[152:155], a[244:247]
v_mfma_f32_16x16x32_bf16 a[56:59], v[160:163], v[156:159], a[56:59]
buffer_load_dword v39, v60, s[8:11], 0 offen
v_mfma_f32_16x16x32_bf16 a[60:63], v[164:167], v[156:159], a[60:63]
v_mfma_f32_16x16x32_bf16 a[120:123], v[168:171], v[156:159], a[120:123]
v_mfma_f32_16x16x32_bf16 a[124:127], v[172:175], v[156:159], a[124:127]
v_mfma_f32_16x16x32_bf16 a[184:187], v[176:179], v[156:159], a[184:187]
v_mfma_f32_16x16x32_bf16 a[188:191], v[180:183], v[156:159], a[188:191]
v_mfma_f32_16x16x32_bf16 a[248:251], v[184:187], v[156:159], a[248:251]
v_mfma_f32_16x16x32_bf16 a[252:255], v[188:191], v[156:159], a[252:255]
s_waitcnt vmcnt(15) lgkmcnt(0)
s_barrier
v_mfma_f32_16x16x32_bf16 a[0:3], v[96:99], v[64:67], a[0:3]
ds_read_b128 v[192:195], v33 offset:0
v_mfma_f32_16x16x32_bf16 a[4:7], v[100:103], v[64:67], a[4:7]
ds_read_b64_tr_b16 v[128:129], v8 offset:16384
v_mfma_f32_16x16x32_bf16 a[64:67], v[104:107], v[64:67], a[64:67]
ds_read_b64_tr_b16 v[130:131], v8 offset:17408
v_mfma_f32_16x16x32_bf16 a[68:71], v[108:111], v[64:67], a[68:71]
ds_read_b128 v[196:199], v33 offset:8192
v_mfma_f32_16x16x32_bf16 a[128:131], v[112:115], v[64:67], a[128:131]
ds_read_b128 v[160:163], v27 offset:0
v_mfma_f32_16x16x32_bf16 a[132:135], v[116:119], v[64:67], a[132:135]
v_mfma_f32_16x16x32_bf16 a[192:195], v[120:123], v[64:67], a[192:195]
ds_read_b128 v[200:203], v33 offset:16384
v_mfma_f32_16x16x32_bf16 a[196:199], v[124:127], v[64:67], a[196:199]
ds_read_b64_tr_b16 v[132:133], v9 offset:16384
v_mfma_f32_16x16x32_bf16 a[8:11], v[96:99], v[68:71], a[8:11]
ds_read_b64_tr_b16 v[134:135], v9 offset:17408
v_mfma_f32_16x16x32_bf16 a[12:15], v[100:103], v[68:71], a[12:15]
v_mfma_f32_16x16x32_bf16 a[72:75], v[104:107], v[68:71], a[72:75]
ds_read_b128 v[164:167], v26 offset:1024
s_add_u32 m0, s58, 49152
v_mfma_f32_16x16x32_bf16 a[76:79], v[108:111], v[68:71], a[76:79]
v_mfma_f32_16x16x32_bf16 a[136:139], v[112:115], v[68:71], a[136:139]
v_mfma_f32_16x16x32_bf16 a[140:143], v[116:119], v[68:71], a[140:143]
ds_read_b64_tr_b16 v[136:137], v10 offset:16384
s_add_u32 s30, s31, 1835008
v_mfma_f32_16x16x32_bf16 a[200:203], v[120:123], v[68:71], a[200:203]
ds_read_b64_tr_b16 v[138:139], v10 offset:17408
v_mfma_f32_16x16x32_bf16 a[204:207], v[124:127], v[68:71], a[204:207]
v_mfma_f32_16x16x32_bf16 a[16:19], v[96:99], v[72:75], a[16:19]
ds_read_b128 v[168:171], v27 offset:4096
v_mfma_f32_16x16x32_bf16 a[20:23], v[100:103], v[72:75], a[20:23]
buffer_load_dwordx4 v20, s[8:11], s30 offen offset:0 lds
v_mfma_f32_16x16x32_bf16 a[80:83], v[104:107], v[72:75], a[80:83]
v_mfma_f32_16x16x32_bf16 a[84:87], v[108:111], v[72:75], a[84:87]
ds_read_b64_tr_b16 v[140:141], v11 offset:16384
v_mfma_f32_16x16x32_bf16 a[144:147], v[112:115], v[72:75], a[144:147]
ds_read_b64_tr_b16 v[142:143], v11 offset:17408
v_mfma_f32_16x16x32_bf16 a[148:151], v[116:119], v[72:75], a[148:151]
buffer_load_dwordx4 v21, s[8:11], s30 offen offset:1024 lds
v_mfma_f32_16x16x32_bf16 a[208:211], v[120:123], v[72:75], a[208:211]
ds_read_b128 v[172:175], v26 offset:5120
v_mfma_f32_16x16x32_bf16 a[212:215], v[124:127], v[72:75], a[212:215]
buffer_load_dwordx4 v22, s[8:11], s30 offen offset:2048 lds
v_mfma_f32_16x16x32_bf16 a[24:27], v[96:99], v[76:79], a[24:27]
v_mfma_f32_16x16x32_bf16 a[28:31], v[100:103], v[76:79], a[28:31]
ds_read_b64_tr_b16 v[144:145], v12 offset:16384
v_mfma_f32_16x16x32_bf16 a[88:91], v[104:107], v[76:79], a[88:91]
ds_read_b64_tr_b16 v[146:147], v12 offset:17408
v_mfma_f32_16x16x32_bf16 a[92:95], v[108:111], v[76:79], a[92:95]
buffer_load_dwordx4 v23, s[8:11], s30 offen offset:3072 lds
v_mfma_f32_16x16x32_bf16 a[152:155], v[112:115], v[76:79], a[152:155]
ds_read_b128 v[176:179], v27 offset:8192
v_mfma_f32_16x16x32_bf16 a[156:159], v[116:119], v[76:79], a[156:159]
v_mfma_f32_16x16x32_bf16 a[216:219], v[120:123], v[76:79], a[216:219]
s_add_u32 m0, s35, 32768
v_mfma_f32_16x16x32_bf16 a[220:223], v[124:127], v[76:79], a[220:223]
ds_read_b64_tr_b16 v[148:149], v13 offset:16384
v_mfma_f32_16x16x32_bf16 a[32:35], v[96:99], v[80:83], a[32:35]
ds_read_b64_tr_b16 v[150:151], v13 offset:17408
v_mfma_f32_16x16x32_bf16 a[36:39], v[100:103], v[80:83], a[36:39]
s_add_u32 s30, s33, 512
v_mfma_f32_16x16x32_bf16 a[96:99], v[104:107], v[80:83], a[96:99]
ds_read_b128 v[180:183], v26 offset:9216
v_mfma_f32_16x16x32_bf16 a[100:103], v[108:111], v[80:83], a[100:103]
v_mfma_f32_16x16x32_bf16 a[160:163], v[112:115], v[80:83], a[160:163]
buffer_load_dwordx4 v40, s[4:7], s30 offen offset:0 lds
v_mfma_f32_16x16x32_bf16 a[164:167], v[116:119], v[80:83], a[164:167]
ds_read_b64_tr_b16 v[152:153], v14 offset:16384
v_mfma_f32_16x16x32_bf16 a[224:227], v[120:123], v[80:83], a[224:227]
ds_read_b64_tr_b16 v[154:155], v14 offset:17408
v_mfma_f32_16x16x32_bf16 a[228:231], v[124:127], v[80:83], a[228:231]
v_mfma_f32_16x16x32_bf16 a[40:43], v[96:99], v[84:87], a[40:43]
ds_read_b128 v[184:187], v27 offset:12288
v_mfma_f32_16x16x32_bf16 a[44:47], v[100:103], v[84:87], a[44:47]
buffer_load_dwordx4 v41, s[4:7], s30 offen offset:1024 lds
v_mfma_f32_16x16x32_bf16 a[104:107], v[104:107], v[84:87], a[104:107]
v_mfma_f32_16x16x32_bf16 a[108:111], v[108:111], v[84:87], a[108:111]
ds_read_b64_tr_b16 v[156:157], v15 offset:16384
v_mfma_f32_16x16x32_bf16 a[168:171], v[112:115], v[84:87], a[168:171]
ds_read_b64_tr_b16 v[158:159], v15 offset:17408
v_mfma_f32_16x16x32_bf16 a[172:175], v[116:119], v[84:87], a[172:175]
buffer_load_dwordx4 v42, s[4:7], s30 offen offset:2048 lds
v_mfma_f32_16x16x32_bf16 a[232:235], v[120:123], v[84:87], a[232:235]
ds_read_b128 v[188:191], v26 offset:13312
v_mfma_f32_16x16x32_bf16 a[236:239], v[124:127], v[84:87], a[236:239]
buffer_load_dwordx4 v43, s[4:7], s30 offen offset:3072 lds
v_mfma_f32_16x16x32_bf16 a[48:51], v[96:99], v[88:91], a[48:51]
v_mfma_f32_16x16x32_bf16 a[52:55], v[100:103], v[88:91], a[52:55]
v_mfma_f32_16x16x32_bf16 a[112:115], v[104:107], v[88:91], a[112:115]
s_mov_b32 s40, 0xffff0000
s_mov_b32 s41, 0x0
v_mfma_f32_16x16x32_bf16 a[116:119], v[108:111], v[88:91], a[116:119]
v_mfma_f32_16x16x32_bf16 a[176:179], v[112:115], v[88:91], a[176:179]
v_mfma_f32_16x16x32_bf16 a[180:183], v[116:119], v[88:91], a[180:183]
v_cndmask_b32 v60, v52, v59, s[40:41]
v_mfma_f32_16x16x32_bf16 a[240:243], v[120:123], v[88:91], a[240:243]
v_mfma_f32_16x16x32_bf16 a[244:247], v[124:127], v[88:91], a[244:247]
v_mfma_f32_16x16x32_bf16 a[56:59], v[96:99], v[92:95], a[56:59]
buffer_load_dword v39, v60, s[4:7], 0 offen offset:512
v_mfma_f32_16x16x32_bf16 a[60:63], v[100:103], v[92:95], a[60:63]
v_mfma_f32_16x16x32_bf16 a[120:123], v[104:107], v[92:95], a[120:123]
v_mfma_f32_16x16x32_bf16 a[124:127], v[108:111], v[92:95], a[124:127]
v_mfma_f32_16x16x32_bf16 a[184:187], v[112:115], v[92:95], a[184:187]
v_mfma_f32_16x16x32_bf16 a[188:191], v[116:119], v[92:95], a[188:191]
v_mfma_f32_16x16x32_bf16 a[248:251], v[120:123], v[92:95], a[248:251]
v_mfma_f32_16x16x32_bf16 a[252:255], v[124:127], v[92:95], a[252:255]
s_waitcnt vmcnt(10) lgkmcnt(0)
s_barrier
v_mfma_f32_16x16x32_bf16 a[0:3], v[160:163], v[128:131], a[0:3]
buffer_store_dword v34, v0, s[64:67], s59 offen sc1
v_mfma_f32_16x16x32_bf16 a[4:7], v[164:167], v[128:131], a[4:7]
ds_read_b64_tr_b16 v[64:65], v8 offset:32768
v_mfma_f32_16x16x32_bf16 a[64:67], v[168:171], v[128:131], a[64:67]
ds_read_b64_tr_b16 v[66:67], v8 offset:33792
v_mfma_f32_16x16x32_bf16 a[68:71], v[172:175], v[128:131], a[68:71]
buffer_store_dwordx4 v[192:195], v30, s[16:19], 0 offen sc1
v_mfma_f32_16x16x32_bf16 a[128:131], v[176:179], v[128:131], a[128:131]
ds_read_b128 v[96:99], v24 offset:0
v_mfma_f32_16x16x32_bf16 a[132:135], v[180:183], v[128:131], a[132:135]
v_mfma_f32_16x16x32_bf16 a[192:195], v[184:187], v[128:131], a[192:195]
buffer_store_dwordx4 v[196:199], v30, s[16:19], s76 offen sc1
v_mfma_f32_16x16x32_bf16 a[196:199], v[188:191], v[128:131], a[196:199]
ds_read_b64_tr_b16 v[68:69], v9 offset:32768
v_mfma_f32_16x16x32_bf16 a[8:11], v[160:163], v[132:135], a[8:11]
ds_read_b64_tr_b16 v[70:71], v9 offset:33792
v_mfma_f32_16x16x32_bf16 a[12:15], v[164:167], v[132:135], a[12:15]
buffer_store_dwordx4 v[200:203], v30, s[16:19], s29 offen sc1
v_mfma_f32_16x16x32_bf16 a[72:75], v[168:171], v[132:135], a[72:75]
ds_read_b128 v[100:103], v25 offset:1024
v_mfma_f32_16x16x32_bf16 a[76:79], v[172:175], v[132:135], a[76:79]
v_mfma_f32_16x16x32_bf16 a[136:139], v[176:179], v[132:135], a[136:139]
s_add_u32 m0, s58, 0
v_mfma_f32_16x16x32_bf16 a[140:143], v[180:183], v[132:135], a[140:143]
ds_read_b64_tr_b16 v[72:73], v10 offset:32768
v_mfma_f32_16x16x32_bf16 a[200:203], v[184:187], v[132:135], a[200:203]
ds_read_b64_tr_b16 v[74:75], v10 offset:33792
v_mfma_f32_16x16x32_bf16 a[204:207], v[188:191], v[132:135], a[204:207]
s_add_u32 s30, s31, 2097152
v_mfma_f32_16x16x32_bf16 a[16:19], v[160:163], v[136:139], a[16:19]
ds_read_b128 v[104:107], v24 offset:4096
v_mfma_f32_16x16x32_bf16 a[20:23], v[164:167], v[136:139], a[20:23]
v_mfma_f32_16x16x32_bf16 a[80:83], v[168:171], v[136:139], a[80:83]
buffer_load_dwordx4 v20, s[8:11], s30 offen offset:0 lds
v_mfma_f32_16x16x32_bf16 a[84:87], v[172:175], v[136:139], a[84:87]
ds_read_b64_tr_b16 v[76:77], v11 offset:32768
v_mfma_f32_16x16x32_bf16 a[144:147], v[176:179], v[136:139], a[144:147]
ds_read_b64_tr_b16 v[78:79], v11 offset:33792
v_mfma_f32_16x16x32_bf16 a[148:151], v[180:183], v[136:139], a[148:151]
v_mfma_f32_16x16x32_bf16 a[208:211], v[184:187], v[136:139], a[208:211]
ds_read_b128 v[108:111], v25 offset:5120
v_mfma_f32_16x16x32_bf16 a[212:215], v[188:191], v[136:139], a[212:215]
buffer_load_dwordx4 v21, s[8:11], s30 offen offset:1024 lds
v_mfma_f32_16x16x32_bf16 a[24:27], v[160:163], v[140:143], a[24:27]
v_mfma_f32_16x16x32_bf16 a[28:31], v[164:167], v[140:143], a[28:31]
ds_read_b64_tr_b16 v[80:81], v12 offset:32768
v_mfma_f32_16x16x32_bf16 a[88:91], v[168:171], v[140:143], a[88:91]
ds_read_b64_tr_b16 v[82:83], v12 offset:33792
v_mfma_f32_16x16x32_bf16 a[92:95], v[172:175], v[140:143], a[92:95]
buffer_load_dwordx4 v22, s[8:11], s30 offen offset:2048 lds
v_mfma_f32_16x16x32_bf16 a[152:155], v[176:179], v[140:143], a[152:155]
ds_read_b128 v[112:115], v24 offset:8192
v_mfma_f32_16x16x32_bf16 a[156:159], v[180:183], v[140:143], a[156:159]
buffer_load_dwordx4 v23, s[8:11], s30 offen offset:3072 lds
v_mfma_f32_16x16x32_bf16 a[216:219], v[184:187], v[140:143], a[216:219]
v_mfma_f32_16x16x32_bf16 a[220:223], v[188:191], v[140:143], a[220:223]
ds_read_b64_tr_b16 v[84:85], v13 offset:32768
s_add_u32 m0, s35, 36864
v_mfma_f32_16x16x32_bf16 a[32:35], v[160:163], v[144:147], a[32:35]
ds_read_b64_tr_b16 v[86:87], v13 offset:33792
v_mfma_f32_16x16x32_bf16 a[36:39], v[164:167], v[144:147], a[36:39]
v_mfma_f32_16x16x32_bf16 a[96:99], v[168:171], v[144:147], a[96:99]
ds_read_b128 v[116:119], v25 offset:9216
s_add_u32 s30, s33, 512
v_mfma_f32_16x16x32_bf16 a[100:103], v[172:175], v[144:147], a[100:103]
v_mfma_f32_16x16x32_bf16 a[160:163], v[176:179], v[144:147], a[160:163]
v_mfma_f32_16x16x32_bf16 a[164:167], v[180:183], v[144:147], a[164:167]
ds_read_b64_tr_b16 v[88:89], v14 offset:32768
v_mfma_f32_16x16x32_bf16 a[224:227], v[184:187], v[144:147], a[224:227]
ds_read_b64_tr_b16 v[90:91], v14 offset:33792
v_mfma_f32_16x16x32_bf16 a[228:231], v[188:191], v[144:147], a[228:231]
buffer_load_dwordx4 v44, s[4:7], s30 offen offset:0 lds
v_mfma_f32_16x16x32_bf16 a[40:43], v[160:163], v[148:151], a[40:43]
ds_read_b128 v[120:123], v24 offset:12288
v_mfma_f32_16x16x32_bf16 a[44:47], v[164:167], v[148:151], a[44:47]
buffer_load_dwordx4 v45, s[4:7], s30 offen offset:1024 lds
v_mfma_f32_16x16x32_bf16 a[104:107], v[168:171], v[148:151], a[104:107]
v_mfma_f32_16x16x32_bf16 a[108:111], v[172:175], v[148:151], a[108:111]
ds_read_b64_tr_b16 v[92:93], v15 offset:32768
v_mfma_f32_16x16x32_bf16 a[168:171], v[176:179], v[148:151], a[168:171]
ds_read_b64_tr_b16 v[94:95], v15 offset:33792
v_mfma_f32_16x16x32_bf16 a[172:175], v[180:183], v[148:151], a[172:175]
buffer_load_dwordx4 v46, s[4:7], s30 offen offset:2048 lds
v_mfma_f32_16x16x32_bf16 a[232:235], v[184:187], v[148:151], a[232:235]
ds_read_b128 v[124:127], v25 offset:13312
v_mfma_f32_16x16x32_bf16 a[236:239], v[188:191], v[148:151], a[236:239]
buffer_load_dwordx4 v47, s[4:7], s30 offen offset:3072 lds
v_mfma_f32_16x16x32_bf16 a[48:51], v[160:163], v[152:155], a[48:51]
v_mfma_f32_16x16x32_bf16 a[52:55], v[164:167], v[152:155], a[52:55]
v_mfma_f32_16x16x32_bf16 a[112:115], v[168:171], v[152:155], a[112:115]
s_mov_b32 s40, 0x0
s_mov_b32 s41, 0xff00
v_mfma_f32_16x16x32_bf16 a[116:119], v[172:175], v[152:155], a[116:119]
v_mfma_f32_16x16x32_bf16 a[176:179], v[176:179], v[152:155], a[176:179]
v_mfma_f32_16x16x32_bf16 a[180:183], v[180:183], v[152:155], a[180:183]
v_cndmask_b32 v60, v52, v57, s[40:41]
v_mfma_f32_16x16x32_bf16 a[240:243], v[184:187], v[152:155], a[240:243]
v_mfma_f32_16x16x32_bf16 a[244:247], v[188:191], v[152:155], a[244:247]
v_mfma_f32_16x16x32_bf16 a[56:59], v[160:163], v[156:159], a[56:59]
buffer_load_dword v39, v60, s[8:11], 0 offen
v_mfma_f32_16x16x32_bf16 a[60:63], v[164:167], v[156:159], a[60:63]
v_mfma_f32_16x16x32_bf16 a[120:123], v[168:171], v[156:159], a[120:123]
v_mfma_f32_16x16x32_bf16 a[124:127], v[172:175], v[156:159], a[124:127]
v_mfma_f32_16x16x32_bf16 a[184:187], v[176:179], v[156:159], a[184:187]
v_mfma_f32_16x16x32_bf16 a[188:191], v[180:183], v[156:159], a[188:191]
v_mfma_f32_16x16x32_bf16 a[248:251], v[184:187], v[156:159], a[248:251]
v_mfma_f32_16x16x32_bf16 a[252:255], v[188:191], v[156:159], a[252:255]
s_waitcnt vmcnt(18) lgkmcnt(0)
s_barrier
v_mfma_f32_16x16x32_bf16 a[0:3], v[96:99], v[64:67], a[0:3]
s_add_u32 m0, s58, 16384
v_mfma_f32_16x16x32_bf16 a[4:7], v[100:103], v[64:67], a[4:7]
ds_read_b64_tr_b16 v[128:129], v8 offset:49152
v_mfma_f32_16x16x32_bf16 a[64:67], v[104:107], v[64:67], a[64:67]
ds_read_b64_tr_b16 v[130:131], v8 offset:50176
v_mfma_f32_16x16x32_bf16 a[68:71], v[108:111], v[64:67], a[68:71]
v_mfma_f32_16x16x32_bf16 a[128:131], v[112:115], v[64:67], a[128:131]
ds_read_b128 v[160:163], v25 offset:0
s_add_u32 s30, s31, 2359296
v_mfma_f32_16x16x32_bf16 a[132:135], v[116:119], v[64:67], a[132:135]
v_mfma_f32_16x16x32_bf16 a[192:195], v[120:123], v[64:67], a[192:195]
v_mfma_f32_16x16x32_bf16 a[196:199], v[124:127], v[64:67], a[196:199]
ds_read_b64_tr_b16 v[132:133], v9 offset:49152
v_mfma_f32_16x16x32_bf16 a[8:11], v[96:99], v[68:71], a[8:11]
ds_read_b64_tr_b16 v[134:135], v9 offset:50176
v_mfma_f32_16x16x32_bf16 a[12:15], v[100:103], v[68:71], a[12:15]
buffer_load_dwordx4 v20, s[8:11], s30 offen offset:0 lds
v_mfma_f32_16x16x32_bf16 a[72:75], v[104:107], v[68:71], a[72:75]
ds_read_b128 v[164:167], v24 offset:1024
v_mfma_f32_16x16x32_bf16 a[76:79], v[108:111], v[68:71], a[76:79]
v_mfma_f32_16x16x32_bf16 a[136:139], v[112:115], v[68:71], a[136:139]
buffer_load_dwordx4 v21, s[8:11], s30 offen offset:1024 lds
v_mfma_f32_16x16x32_bf16 a[140:143], v[116:119], v[68:71], a[140:143]
ds_read_b64_tr_b16 v[136:137], v10 offset:49152
v_mfma_f32_16x16x32_bf16 a[200:203], v[120:123], v[68:71], a[200:203]
ds_read_b64_tr_b16 v[138:139], v10 offset:50176
v_mfma_f32_16x16x32_bf16 a[204:207], v[124:127], v[68:71], a[204:207]
v_mfma_f32_16x16x32_bf16 a[16:19], v[96:99], v[72:75], a[16:19]
ds_read_b128 v[168:171], v25 offset:4096
v_mfma_f32_16x16x32_bf16 a[20:23], v[100:103], v[72:75], a[20:23]
buffer_load_dwordx4 v22, s[8:11], s30 offen offset:2048 lds
v_mfma_f32_16x16x32_bf16 a[80:83], v[104:107], v[72:75], a[80:83]
v_mfma_f32_16x16x32_bf16 a[84:87], v[108:111], v[72:75], a[84:87]
ds_read_b64_tr_b16 v[140:141], v11 offset:49152
v_mfma_f32_16x16x32_bf16 a[144:147], v[112:115], v[72:75], a[144:147]
ds_read_b64_tr_b16 v[142:143], v11 offset:50176
v_mfma_f32_16x16x32_bf16 a[148:151], v[116:119], v[72:75], a[148:151]
buffer_load_dwordx4 v23, s[8:11], s30 offen offset:3072 lds
v_mfma_f32_16x16x32_bf16 a[208:211], v[120:123], v[72:75], a[208:211]
ds_read_b128 v[172:175], v24 offset:5120
v_mfma_f32_16x16x32_bf16 a[212:215], v[124:127], v[72:75], a[212:215]
v_mfma_f32_16x16x32_bf16 a[24:27], v[96:99], v[76:79], a[24:27]
s_add_u32 m0, s35, 65536
v_mfma_f32_16x16x32_bf16 a[28:31], v[100:103], v[76:79], a[28:31]
ds_read_b64_tr_b16 v[144:145], v12 offset:49152
v_mfma_f32_16x16x32_bf16 a[88:91], v[104:107], v[76:79], a[88:91]
ds_read_b64_tr_b16 v[146:147], v12 offset:50176
v_mfma_f32_16x16x32_bf16 a[92:95], v[108:111], v[76:79], a[92:95]
v_mfma_f32_16x16x32_bf16 a[152:155], v[112:115], v[76:79], a[152:155]
ds_read_b128 v[176:179], v25 offset:8192
s_add_u32 s30, s33, 640
v_mfma_f32_16x16x32_bf16 a[156:159], v[116:119], v[76:79], a[156:159]
v_mfma_f32_16x16x32_bf16 a[216:219], v[120:123], v[76:79], a[216:219]
v_mfma_f32_16x16x32_bf16 a[220:223], v[124:127], v[76:79], a[220:223]
ds_read_b64_tr_b16 v[148:149], v13 offset:49152
v_mfma_f32_16x16x32_bf16 a[32:35], v[96:99], v[80:83], a[32:35]
ds_read_b64_tr_b16 v[150:151], v13 offset:50176
v_mfma_f32_16x16x32_bf16 a[36:39], v[100:103], v[80:83], a[36:39]
buffer_load_dwordx4 v40, s[4:7], s30 offen offset:0 lds
v_mfma_f32_16x16x32_bf16 a[96:99], v[104:107], v[80:83], a[96:99]
ds_read_b128 v[180:183], v24 offset:9216
v_mfma_f32_16x16x32_bf16 a[100:103], v[108:111], v[80:83], a[100:103]
v_mfma_f32_16x16x32_bf16 a[160:163], v[112:115], v[80:83], a[160:163]
buffer_load_dwordx4 v41, s[4:7], s30 offen offset:1024 lds
v_mfma_f32_16x16x32_bf16 a[164:167], v[116:119], v[80:83], a[164:167]
ds_read_b64_tr_b16 v[152:153], v14 offset:49152
v_mfma_f32_16x16x32_bf16 a[224:227], v[120:123], v[80:83], a[224:227]
ds_read_b64_tr_b16 v[154:155], v14 offset:50176
v_mfma_f32_16x16x32_bf16 a[228:231], v[124:127], v[80:83], a[228:231]
v_mfma_f32_16x16x32_bf16 a[40:43], v[96:99], v[84:87], a[40:43]
ds_read_b128 v[184:187], v25 offset:12288
v_mfma_f32_16x16x32_bf16 a[44:47], v[100:103], v[84:87], a[44:47]
buffer_load_dwordx4 v42, s[4:7], s30 offen offset:2048 lds
v_mfma_f32_16x16x32_bf16 a[104:107], v[104:107], v[84:87], a[104:107]
v_mfma_f32_16x16x32_bf16 a[108:111], v[108:111], v[84:87], a[108:111]
ds_read_b64_tr_b16 v[156:157], v15 offset:49152
v_mfma_f32_16x16x32_bf16 a[168:171], v[112:115], v[84:87], a[168:171]
ds_read_b64_tr_b16 v[158:159], v15 offset:50176
v_mfma_f32_16x16x32_bf16 a[172:175], v[116:119], v[84:87], a[172:175]
buffer_load_dwordx4 v43, s[4:7], s30 offen offset:3072 lds
v_mfma_f32_16x16x32_bf16 a[232:235], v[120:123], v[84:87], a[232:235]
ds_read_b128 v[188:191], v24 offset:13312
v_mfma_f32_16x16x32_bf16 a[236:239], v[124:127], v[84:87], a[236:239]
v_mfma_f32_16x16x32_bf16 a[48:51], v[96:99], v[88:91], a[48:51]
s_mov_b32 s40, 0x0
s_mov_b32 s41, 0xffff
v_mfma_f32_16x16x32_bf16 a[52:55], v[100:103], v[88:91], a[52:55]
v_mfma_f32_16x16x32_bf16 a[112:115], v[104:107], v[88:91], a[112:115]
v_mfma_f32_16x16x32_bf16 a[116:119], v[108:111], v[88:91], a[116:119]
v_mfma_f32_16x16x32_bf16 a[176:179], v[112:115], v[88:91], a[176:179]
v_cndmask_b32 v60, v52, v59, s[40:41]
v_mfma_f32_16x16x32_bf16 a[180:183], v[116:119], v[88:91], a[180:183]
v_mfma_f32_16x16x32_bf16 a[240:243], v[120:123], v[88:91], a[240:243]
v_mfma_f32_16x16x32_bf16 a[244:247], v[124:127], v[88:91], a[244:247]
v_mfma_f32_16x16x32_bf16 a[56:59], v[96:99], v[92:95], a[56:59]
buffer_load_dword v39, v60, s[4:7], 0 offen offset:512
v_mfma_f32_16x16x32_bf16 a[60:63], v[100:103], v[92:95], a[60:63]
v_mfma_f32_16x16x32_bf16 a[120:123], v[104:107], v[92:95], a[120:123]
v_mfma_f32_16x16x32_bf16 a[124:127], v[108:111], v[92:95], a[124:127]
v_mfma_f32_16x16x32_bf16 a[184:187], v[112:115], v[92:95], a[184:187]
v_mfma_f32_16x16x32_bf16 a[188:191], v[116:119], v[92:95], a[188:191]
v_mfma_f32_16x16x32_bf16 a[248:251], v[120:123], v[92:95], a[248:251]
v_mfma_f32_16x16x32_bf16 a[252:255], v[124:127], v[92:95], a[252:255]
s_waitcnt vmcnt(10) lgkmcnt(0)
s_barrier
v_mfma_f32_16x16x32_bf16 a[0:3], v[160:163], v[128:131], a[0:3]
s_add_u32 m0, s58, 32768
v_mfma_f32_16x16x32_bf16 a[4:7], v[164:167], v[128:131], a[4:7]
ds_read_b64_tr_b16 v[64:65], v8 offset:0
v_mfma_f32_16x16x32_bf16 a[64:67], v[168:171], v[128:131], a[64:67]
ds_read_b64_tr_b16 v[66:67], v8 offset:1024
v_mfma_f32_16x16x32_bf16 a[68:71], v[172:175], v[128:131], a[68:71]
v_mfma_f32_16x16x32_bf16 a[128:131], v[176:179], v[128:131], a[128:131]
ds_read_b128 v[96:99], v24 offset:32768
s_add_u32 s30, s31, 2621440
v_mfma_f32_16x16x32_bf16 a[132:135], v[180:183], v[128:131], a[132:135]
v_mfma_f32_16x16x32_bf16 a[192:195], v[184:187], v[128:131], a[192:195]
v_mfma_f32_16x16x32_bf16 a[196:199], v[188:191], v[128:131], a[196:199]
ds_read_b64_tr_b16 v[68:69], v9 offset:0
v_mfma_f32_16x16x32_bf16 a[8:11], v[160:163], v[132:135], a[8:11]
ds_read_b64_tr_b16 v[70:71], v9 offset:1024
v_mfma_f32_16x16x32_bf16 a[12:15], v[164:167], v[132:135], a[12:15]
buffer_load_dwordx4 v20, s[8:11], s30 offen offset:0 lds
v_mfma_f32_16x16x32_bf16 a[72:75], v[168:171], v[132:135], a[72:75]
ds_read_b128 v[100:103], v25 offset:33792
v_mfma_f32_16x16x32_bf16 a[76:79], v[172:175], v[132:135], a[76:79]
v_mfma_f32_16x16x32_bf16 a[136:139], v[176:179], v[132:135], a[136:139]
buffer_load_dwordx4 v21, s[8:11], s30 offen offset:1024 lds
v_mfma_f32_16x16x32_bf16 a[140:143], v[180:183], v[132:135], a[140:143]
ds_read_b64_tr_b16 v[72:73], v10 offset:0
v_mfma_f32_16x16x32_bf16 a[200:203], v[184:187], v[132:135], a[200:203]
ds_read_b64_tr_b16 v[74:75], v10 offset:1024
v_mfma_f32_16x16x32_bf16 a[204:207], v[188:191], v[132:135], a[204:207]
v_mfma_f32_16x16x32_bf16 a[16:19], v[160:163], v[136:139], a[16:19]
ds_read_b128 v[104:107], v24 offset:36864
v_mfma_f32_16x16x32_bf16 a[20:23], v[164:167], v[136:139], a[20:23]
buffer_load_dwordx4 v22, s[8:11], s30 offen offset:2048 lds
v_mfma_f32_16x16x32_bf16 a[80:83], v[168:171], v[136:139], a[80:83]
v_mfma_f32_16x16x32_bf16 a[84:87], v[172:175], v[136:139], a[84:87]
ds_read_b64_tr_b16 v[76:77], v11 offset:0
v_mfma_f32_16x16x32_bf16 a[144:147], v[176:179], v[136:139], a[144:147]
ds_read_b64_tr_b16 v[78:79], v11 offset:1024
v_mfma_f32_16x16x32_bf16 a[148:151], v[180:183], v[136:139], a[148:151]
buffer_load_dwordx4 v23, s[8:11], s30 offen offset:3072 lds
v_mfma_f32_16x16x32_bf16 a[208:211], v[184:187], v[136:139], a[208:211]
ds_read_b128 v[108:111], v25 offset:37888
v_mfma_f32_16x16x32_bf16 a[212:215], v[188:191], v[136:139], a[212:215]
v_mfma_f32_16x16x32_bf16 a[24:27], v[160:163], v[140:143], a[24:27]
s_add_u32 m0, s35, 69632
v_mfma_f32_16x16x32_bf16 a[28:31], v[164:167], v[140:143], a[28:31]
ds_read_b64_tr_b16 v[80:81], v12 offset:0
v_mfma_f32_16x16x32_bf16 a[88:91], v[168:171], v[140:143], a[88:91]
ds_read_b64_tr_b16 v[82:83], v12 offset:1024
v_mfma_f32_16x16x32_bf16 a[92:95], v[172:175], v[140:143], a[92:95]
v_mfma_f32_16x16x32_bf16 a[152:155], v[176:179], v[140:143], a[152:155]
ds_read_b128 v[112:115], v24 offset:40960
s_add_u32 s30, s33, 640
v_mfma_f32_16x16x32_bf16 a[156:159], v[180:183], v[140:143], a[156:159]
v_mfma_f32_16x16x32_bf16 a[216:219], v[184:187], v[140:143], a[216:219]
v_mfma_f32_16x16x32_bf16 a[220:223], v[188:191], v[140:143], a[220:223]
ds_read_b64_tr_b16 v[84:85], v13 offset:0
v_mfma_f32_16x16x32_bf16 a[32:35], v[160:163], v[144:147], a[32:35]
ds_read_b64_tr_b16 v[86:87], v13 offset:1024
v_mfma_f32_16x16x32_bf16 a[36:39], v[164:167], v[144:147], a[36:39]
buffer_load_dwordx4 v44, s[4:7], s30 offen offset:0 lds
v_mfma_f32_16x16x32_bf16 a[96:99], v[168:171], v[144:147], a[96:99]
ds_read_b128 v[116:119], v25 offset:41984
v_mfma_f32_16x16x32_bf16 a[100:103], v[172:175], v[144:147], a[100:103]
v_mfma_f32_16x16x32_bf16 a[160:163], v[176:179], v[144:147], a[160:163]
buffer_load_dwordx4 v45, s[4:7], s30 offen offset:1024 lds
v_mfma_f32_16x16x32_bf16 a[164:167], v[180:183], v[144:147], a[164:167]
ds_read_b64_tr_b16 v[88:89], v14 offset:0
v_mfma_f32_16x16x32_bf16 a[224:227], v[184:187], v[144:147], a[224:227]
ds_read_b64_tr_b16 v[90:91], v14 offset:1024
v_mfma_f32_16x16x32_bf16 a[228:231], v[188:191], v[144:147], a[228:231]
v_mfma_f32_16x16x32_bf16 a[40:43], v[160:163], v[148:151], a[40:43]
ds_read_b128 v[120:123], v24 offset:45056
v_mfma_f32_16x16x32_bf16 a[44:47], v[164:167], v[148:151], a[44:47]
buffer_load_dwordx4 v46, s[4:7], s30 offen offset:2048 lds
v_mfma_f32_16x16x32_bf16 a[104:107], v[168:171], v[148:151], a[104:107]
v_mfma_f32_16x16x32_bf16 a[108:111], v[172:175], v[148:151], a[108:111]
ds_read_b64_tr_b16 v[92:93], v15 offset:0
v_mfma_f32_16x16x32_bf16 a[168:171], v[176:179], v[148:151], a[168:171]
ds_read_b64_tr_b16 v[94:95], v15 offset:1024
v_mfma_f32_16x16x32_bf16 a[172:175], v[180:183], v[148:151], a[172:175]
buffer_load_dwordx4 v47, s[4:7], s30 offen offset:3072 lds
v_mfma_f32_16x16x32_bf16 a[232:235], v[184:187], v[148:151], a[232:235]
ds_read_b128 v[124:127], v25 offset:46080
v_mfma_f32_16x16x32_bf16 a[236:239], v[188:191], v[148:151], a[236:239]
v_mfma_f32_16x16x32_bf16 a[48:51], v[160:163], v[152:155], a[48:51]
s_mov_b32 s40, 0x0
s_mov_b32 s41, 0xff0000
v_mfma_f32_16x16x32_bf16 a[52:55], v[164:167], v[152:155], a[52:55]
v_mfma_f32_16x16x32_bf16 a[112:115], v[168:171], v[152:155], a[112:115]
v_mfma_f32_16x16x32_bf16 a[116:119], v[172:175], v[152:155], a[116:119]
v_mfma_f32_16x16x32_bf16 a[176:179], v[176:179], v[152:155], a[176:179]
v_cndmask_b32 v60, v52, v57, s[40:41]
v_mfma_f32_16x16x32_bf16 a[180:183], v[180:183], v[152:155], a[180:183]
v_mfma_f32_16x16x32_bf16 a[240:243], v[184:187], v[152:155], a[240:243]
v_mfma_f32_16x16x32_bf16 a[244:247], v[188:191], v[152:155], a[244:247]
v_mfma_f32_16x16x32_bf16 a[56:59], v[160:163], v[156:159], a[56:59]
buffer_load_dword v39, v60, s[8:11], 0 offen
v_mfma_f32_16x16x32_bf16 a[60:63], v[164:167], v[156:159], a[60:63]
v_mfma_f32_16x16x32_bf16 a[120:123], v[168:171], v[156:159], a[120:123]
v_mfma_f32_16x16x32_bf16 a[124:127], v[172:175], v[156:159], a[124:127]
v_mfma_f32_16x16x32_bf16 a[184:187], v[176:179], v[156:159], a[184:187]
v_mfma_f32_16x16x32_bf16 a[188:191], v[180:183], v[156:159], a[188:191]
v_mfma_f32_16x16x32_bf16 a[248:251], v[184:187], v[156:159], a[248:251]
v_mfma_f32_16x16x32_bf16 a[252:255], v[188:191], v[156:159], a[252:255]
s_waitcnt vmcnt(14) lgkmcnt(0)
s_barrier
v_mfma_f32_16x16x32_bf16 a[0:3], v[96:99], v[64:67], a[0:3]
buffer_atomic_add v1, v31, s[20:23], s38 offen
v_mfma_f32_16x16x32_bf16 a[4:7], v[100:103], v[64:67], a[4:7]
ds_read_b64_tr_b16 v[128:129], v8 offset:16384
v_mfma_f32_16x16x32_bf16 a[64:67], v[104:107], v[64:67], a[64:67]
ds_read_b64_tr_b16 v[130:131], v8 offset:17408
v_mfma_f32_16x16x32_bf16 a[68:71], v[108:111], v[64:67], a[68:71]
s_add_u32 m0, s58, 49152
v_mfma_f32_16x16x32_bf16 a[128:131], v[112:115], v[64:67], a[128:131]
ds_read_b128 v[160:163], v25 offset:32768
v_mfma_f32_16x16x32_bf16 a[132:135], v[116:119], v[64:67], a[132:135]
v_mfma_f32_16x16x32_bf16 a[192:195], v[120:123], v[64:67], a[192:195]
s_add_u32 s30, s31, 2883584
v_mfma_f32_16x16x32_bf16 a[196:199], v[124:127], v[64:67], a[196:199]
tp0_p5:
s_cbranch_execz tp0_ret
ds_read_b64_tr_b16 v[132:133], v9 offset:16384
v_mfma_f32_16x16x32_bf16 a[8:11], v[96:99], v[68:71], a[8:11]
ds_read_b64_tr_b16 v[134:135], v9 offset:17408
v_mfma_f32_16x16x32_bf16 a[12:15], v[100:103], v[68:71], a[12:15]
buffer_load_dwordx4 v20, s[8:11], s30 offen offset:0 lds
v_mfma_f32_16x16x32_bf16 a[72:75], v[104:107], v[68:71], a[72:75]
ds_read_b128 v[164:167], v24 offset:33792
v_mfma_f32_16x16x32_bf16 a[76:79], v[108:111], v[68:71], a[76:79]
v_mfma_f32_16x16x32_bf16 a[136:139], v[112:115], v[68:71], a[136:139]
buffer_load_dwordx4 v21, s[8:11], s30 offen offset:1024 lds
v_mfma_f32_16x16x32_bf16 a[140:143], v[116:119], v[68:71], a[140:143]
ds_read_b64_tr_b16 v[136:137], v10 offset:16384
v_mfma_f32_16x16x32_bf16 a[200:203], v[120:123], v[68:71], a[200:203]
ds_read_b64_tr_b16 v[138:139], v10 offset:17408
v_mfma_f32_16x16x32_bf16 a[204:207], v[124:127], v[68:71], a[204:207]
buffer_load_dwordx4 v22, s[8:11], s30 offen offset:2048 lds
v_mfma_f32_16x16x32_bf16 a[16:19], v[96:99], v[72:75], a[16:19]
ds_read_b128 v[168:171], v25 offset:36864
v_mfma_f32_16x16x32_bf16 a[20:23], v[100:103], v[72:75], a[20:23]
v_mfma_f32_16x16x32_bf16 a[80:83], v[104:107], v[72:75], a[80:83]
buffer_load_dwordx4 v23, s[8:11], s30 offen offset:3072 lds
v_mfma_f32_16x16x32_bf16 a[84:87], v[108:111], v[72:75], a[84:87]
ds_read_b64_tr_b16 v[140:141], v11 offset:16384
v_mfma_f32_16x16x32_bf16 a[144:147], v[112:115], v[72:75], a[144:147]
ds_read_b64_tr_b16 v[142:143], v11 offset:17408
v_mfma_f32_16x16x32_bf16 a[148:151], v[116:119], v[72:75], a[148:151]
v_mfma_f32_16x16x32_bf16 a[208:211], v[120:123], v[72:75], a[208:211]
ds_read_b128 v[172:175], v24 offset:37888
s_add_u32 m0, s35, 0
v_mfma_f32_16x16x32_bf16 a[212:215], v[124:127], v[72:75], a[212:215]
v_mfma_f32_16x16x32_bf16 a[24:27], v[96:99], v[76:79], a[24:27]
v_mfma_f32_16x16x32_bf16 a[28:31], v[100:103], v[76:79], a[28:31]
ds_read_b64_tr_b16 v[144:145], v12 offset:16384
s_add_u32 s30, s33, 768
v_mfma_f32_16x16x32_bf16 a[88:91], v[104:107], v[76:79], a[88:91]
ds_read_b64_tr_b16 v[146:147], v12 offset:17408
v_mfma_f32_16x16x32_bf16 a[92:95], v[108:111], v[76:79], a[92:95]
v_mfma_f32_16x16x32_bf16 a[152:155], v[112:115], v[76:79], a[152:155]
ds_read_b128 v[176:179], v25 offset:40960
v_mfma_f32_16x16x32_bf16 a[156:159], v[116:119], v[76:79], a[156:159]
buffer_load_dwordx4 v40, s[4:7], s30 offen offset:0 lds
v_mfma_f32_16x16x32_bf16 a[216:219], v[120:123], v[76:79], a[216:219]
v_mfma_f32_16x16x32_bf16 a[220:223], v[124:127], v[76:79], a[220:223]
ds_read_b64_tr_b16 v[148:149], v13 offset:16384
v_mfma_f32_16x16x32_bf16 a[32:35], v[96:99], v[80:83], a[32:35]
ds_read_b64_tr_b16 v[150:151], v13 offset:17408
v_mfma_f32_16x16x32_bf16 a[36:39], v[100:103], v[80:83], a[36:39]
buffer_load_dwordx4 v41, s[4:7], s30 offen offset:1024 lds
v_mfma_f32_16x16x32_bf16 a[96:99], v[104:107], v[80:83], a[96:99]
ds_read_b128 v[180:183], v24 offset:41984
v_mfma_f32_16x16x32_bf16 a[100:103], v[108:111], v[80:83], a[100:103]
buffer_load_dwordx4 v42, s[4:7], s30 offen offset:2048 lds
v_mfma_f32_16x16x32_bf16 a[160:163], v[112:115], v[80:83], a[160:163]
v_mfma_f32_16x16x32_bf16 a[164:167], v[116:119], v[80:83], a[164:167]
ds_read_b64_tr_b16 v[152:153], v14 offset:16384
v_mfma_f32_16x16x32_bf16 a[224:227], v[120:123], v[80:83], a[224:227]
ds_read_b64_tr_b16 v[154:155], v14 offset:17408
v_mfma_f32_16x16x32_bf16 a[228:231], v[124:127], v[80:83], a[228:231]
buffer_load_dwordx4 v43, s[4:7], s30 offen offset:3072 lds
v_mfma_f32_16x16x32_bf16 a[40:43], v[96:99], v[84:87], a[40:43]
ds_read_b128 v[184:187], v25 offset:45056
v_mfma_f32_16x16x32_bf16 a[44:47], v[100:103], v[84:87], a[44:47]
s_mov_b32 s40, 0x0
s_mov_b32 s41, 0xffff0000
v_mfma_f32_16x16x32_bf16 a[104:107], v[104:107], v[84:87], a[104:107]
v_mfma_f32_16x16x32_bf16 a[108:111], v[108:111], v[84:87], a[108:111]
ds_read_b64_tr_b16 v[156:157], v15 offset:16384
v_mfma_f32_16x16x32_bf16 a[168:171], v[112:115], v[84:87], a[168:171]
ds_read_b64_tr_b16 v[158:159], v15 offset:17408
v_cndmask_b32 v60, v52, v59, s[40:41]
v_mfma_f32_16x16x32_bf16 a[172:175], v[116:119], v[84:87], a[172:175]
v_mfma_f32_16x16x32_bf16 a[232:235], v[120:123], v[84:87], a[232:235]
ds_read_b128 v[188:191], v24 offset:46080
v_mfma_f32_16x16x32_bf16 a[236:239], v[124:127], v[84:87], a[236:239]
buffer_load_dword v39, v60, s[4:7], 0 offen offset:512
v_mfma_f32_16x16x32_bf16 a[48:51], v[96:99], v[88:91], a[48:51]
v_mfma_f32_16x16x32_bf16 a[52:55], v[100:103], v[88:91], a[52:55]
v_mfma_f32_16x16x32_bf16 a[112:115], v[104:107], v[88:91], a[112:115]
s_mov_b32 s40, 0xf
s_mov_b32 s41, 0xf
v_mfma_f32_16x16x32_bf16 a[116:119], v[108:111], v[88:91], a[116:119]
v_mfma_f32_16x16x32_bf16 a[176:179], v[112:115], v[88:91], a[176:179]
v_mfma_f32_16x16x32_bf16 a[180:183], v[116:119], v[88:91], a[180:183]
v_cndmask_b32 v60, v52, v35, s[40:41]
v_mfma_f32_16x16x32_bf16 a[240:243], v[120:123], v[88:91], a[240:243]
v_mfma_f32_16x16x32_bf16 a[244:247], v[124:127], v[88:91], a[244:247]
v_mfma_f32_16x16x32_bf16 a[56:59], v[96:99], v[92:95], a[56:59]
buffer_load_dword v39, v60, s[60:63], 0 offen
v_mfma_f32_16x16x32_bf16 a[60:63], v[100:103], v[92:95], a[60:63]
v_mfma_f32_16x16x32_bf16 a[120:123], v[104:107], v[92:95], a[120:123]
v_mfma_f32_16x16x32_bf16 a[124:127], v[108:111], v[92:95], a[124:127]
v_mfma_f32_16x16x32_bf16 a[184:187], v[112:115], v[92:95], a[184:187]
v_mfma_f32_16x16x32_bf16 a[188:191], v[116:119], v[92:95], a[188:191]
v_mfma_f32_16x16x32_bf16 a[248:251], v[120:123], v[92:95], a[248:251]
v_mfma_f32_16x16x32_bf16 a[252:255], v[124:127], v[92:95], a[252:255]
s_waitcnt vmcnt(12) lgkmcnt(0)
s_barrier
v_mfma_f32_16x16x32_bf16 a[0:3], v[160:163], v[128:131], a[0:3]
s_add_u32 m0, s58, 0
v_mfma_f32_16x16x32_bf16 a[4:7], v[164:167], v[128:131], a[4:7]
ds_read_b64_tr_b16 v[64:65], v8 offset:32768
v_mfma_f32_16x16x32_bf16 a[64:67], v[168:171], v[128:131], a[64:67]
ds_read_b64_tr_b16 v[66:67], v8 offset:33792
v_mfma_f32_16x16x32_bf16 a[68:71], v[172:175], v[128:131], a[68:71]
v_mfma_f32_16x16x32_bf16 a[128:131], v[176:179], v[128:131], a[128:131]
ds_read_b128 v[96:99], v26 offset:0
s_add_u32 s30, s31, 3145728
v_mfma_f32_16x16x32_bf16 a[132:135], v[180:183], v[128:131], a[132:135]
v_mfma_f32_16x16x32_bf16 a[192:195], v[184:187], v[128:131], a[192:195]
v_mfma_f32_16x16x32_bf16 a[196:199], v[188:191], v[128:131], a[196:199]
ds_read_b64_tr_b16 v[68:69], v9 offset:32768
v_mfma_f32_16x16x32_bf16 a[8:11], v[160:163], v[132:135], a[8:11]
ds_read_b64_tr_b16 v[70:71], v9 offset:33792
v_mfma_f32_16x16x32_bf16 a[12:15], v[164:167], v[132:135], a[12:15]
buffer_load_dwordx4 v20, s[8:11], s30 offen offset:0 lds
v_mfma_f32_16x16x32_bf16 a[72:75], v[168:171], v[132:135], a[72:75]
ds_read_b128 v[100:103], v27 offset:1024
v_mfma_f32_16x16x32_bf16 a[76:79], v[172:175], v[132:135], a[76:79]
v_mfma_f32_16x16x32_bf16 a[136:139], v[176:179], v[132:135], a[136:139]
buffer_load_dwordx4 v21, s[8:11], s30 offen offset:1024 lds
v_mfma_f32_16x16x32_bf16 a[140:143], v[180:183], v[132:135], a[140:143]
ds_read_b64_tr_b16 v[72:73], v10 offset:32768
v_mfma_f32_16x16x32_bf16 a[200:203], v[184:187], v[132:135], a[200:203]
ds_read_b64_tr_b16 v[74:75], v10 offset:33792
v_mfma_f32_16x16x32_bf16 a[204:207], v[188:191], v[132:135], a[204:207]
v_mfma_f32_16x16x32_bf16 a[16:19], v[160:163], v[136:139], a[16:19]
ds_read_b128 v[104:107], v26 offset:4096
v_mfma_f32_16x16x32_bf16 a[20:23], v[164:167], v[136:139], a[20:23]
buffer_load_dwordx4 v22, s[8:11], s30 offen offset:2048 lds
v_mfma_f32_16x16x32_bf16 a[80:83], v[168:171], v[136:139], a[80:83]
v_mfma_f32_16x16x32_bf16 a[84:87], v[172:175], v[136:139], a[84:87]
ds_read_b64_tr_b16 v[76:77], v11 offset:32768
v_mfma_f32_16x16x32_bf16 a[144:147], v[176:179], v[136:139], a[144:147]
ds_read_b64_tr_b16 v[78:79], v11 offset:33792
v_mfma_f32_16x16x32_bf16 a[148:151], v[180:183], v[136:139], a[148:151]
buffer_load_dwordx4 v23, s[8:11], s30 offen offset:3072 lds
v_mfma_f32_16x16x32_bf16 a[208:211], v[184:187], v[136:139], a[208:211]
ds_read_b128 v[108:111], v27 offset:5120
v_mfma_f32_16x16x32_bf16 a[212:215], v[188:191], v[136:139], a[212:215]
v_mfma_f32_16x16x32_bf16 a[24:27], v[160:163], v[140:143], a[24:27]
s_add_u32 m0, s35, 4096
v_mfma_f32_16x16x32_bf16 a[28:31], v[164:167], v[140:143], a[28:31]
ds_read_b64_tr_b16 v[80:81], v12 offset:32768
v_mfma_f32_16x16x32_bf16 a[88:91], v[168:171], v[140:143], a[88:91]
ds_read_b64_tr_b16 v[82:83], v12 offset:33792
v_mfma_f32_16x16x32_bf16 a[92:95], v[172:175], v[140:143], a[92:95]
v_mfma_f32_16x16x32_bf16 a[152:155], v[176:179], v[140:143], a[152:155]
ds_read_b128 v[112:115], v26 offset:8192
s_add_u32 s30, s33, 768
v_mfma_f32_16x16x32_bf16 a[156:159], v[180:183], v[140:143], a[156:159]
v_mfma_f32_16x16x32_bf16 a[216:219], v[184:187], v[140:143], a[216:219]
v_mfma_f32_16x16x32_bf16 a[220:223], v[188:191], v[140:143], a[220:223]
ds_read_b64_tr_b16 v[84:85], v13 offset:32768
v_mfma_f32_16x16x32_bf16 a[32:35], v[160:163], v[144:147], a[32:35]
ds_read_b64_tr_b16 v[86:87], v13 offset:33792
v_mfma_f32_16x16x32_bf16 a[36:39], v[164:167], v[144:147], a[36:39]
buffer_load_dwordx4 v44, s[4:7], s30 offen offset:0 lds
v_mfma_f32_16x16x32_bf16 a[96:99], v[168:171], v[144:147], a[96:99]
ds_read_b128 v[116:119], v27 offset:9216
v_mfma_f32_16x16x32_bf16 a[100:103], v[172:175], v[144:147], a[100:103]
v_mfma_f32_16x16x32_bf16 a[160:163], v[176:179], v[144:147], a[160:163]
buffer_load_dwordx4 v45, s[4:7], s30 offen offset:1024 lds
v_mfma_f32_16x16x32_bf16 a[164:167], v[180:183], v[144:147], a[164:167]
ds_read_b64_tr_b16 v[88:89], v14 offset:32768
v_mfma_f32_16x16x32_bf16 a[224:227], v[184:187], v[144:147], a[224:227]
ds_read_b64_tr_b16 v[90:91], v14 offset:33792
v_mfma_f32_16x16x32_bf16 a[228:231], v[188:191], v[144:147], a[228:231]
v_mfma_f32_16x16x32_bf16 a[40:43], v[160:163], v[148:151], a[40:43]
ds_read_b128 v[120:123], v26 offset:12288
v_mfma_f32_16x16x32_bf16 a[44:47], v[164:167], v[148:151], a[44:47]
buffer_load_dwordx4 v46, s[4:7], s30 offen offset:2048 lds
v_mfma_f32_16x16x32_bf16 a[104:107], v[168:171], v[148:151], a[104:107]
v_mfma_f32_16x16x32_bf16 a[108:111], v[172:175], v[148:151], a[108:111]
ds_read_b64_tr_b16 v[92:93], v15 offset:32768
v_mfma_f32_16x16x32_bf16 a[168:171], v[176:179], v[148:151], a[168:171]
ds_read_b64_tr_b16 v[94:95], v15 offset:33792
v_mfma_f32_16x16x32_bf16 a[172:175], v[180:183], v[148:151], a[172:175]
buffer_load_dwordx4 v47, s[4:7], s30 offen offset:3072 lds
v_mfma_f32_16x16x32_bf16 a[232:235], v[184:187], v[148:151], a[232:235]
ds_read_b128 v[124:127], v27 offset:13312
v_mfma_f32_16x16x32_bf16 a[236:239], v[188:191], v[148:151], a[236:239]
v_mfma_f32_16x16x32_bf16 a[48:51], v[160:163], v[152:155], a[48:51]
s_mov_b32 s40, 0x0
s_mov_b32 s41, 0xff000000
v_mfma_f32_16x16x32_bf16 a[52:55], v[164:167], v[152:155], a[52:55]
v_mfma_f32_16x16x32_bf16 a[112:115], v[168:171], v[152:155], a[112:115]
v_mfma_f32_16x16x32_bf16 a[116:119], v[172:175], v[152:155], a[116:119]
v_mfma_f32_16x16x32_bf16 a[176:179], v[176:179], v[152:155], a[176:179]
v_cndmask_b32 v60, v52, v57, s[40:41]
v_mfma_f32_16x16x32_bf16 a[180:183], v[180:183], v[152:155], a[180:183]
v_mfma_f32_16x16x32_bf16 a[240:243], v[184:187], v[152:155], a[240:243]
v_mfma_f32_16x16x32_bf16 a[244:247], v[188:191], v[152:155], a[244:247]
v_mfma_f32_16x16x32_bf16 a[56:59], v[160:163], v[156:159], a[56:59]
buffer_load_dword v39, v60, s[8:11], 0 offen
v_mfma_f32_16x16x32_bf16 a[60:63], v[164:167], v[156:159], a[60:63]
v_mfma_f32_16x16x32_bf16 a[120:123], v[168:171], v[156:159], a[120:123]
v_mfma_f32_16x16x32_bf16 a[124:127], v[172:175], v[156:159], a[124:127]
v_mfma_f32_16x16x32_bf16 a[184:187], v[176:179], v[156:159], a[184:187]
v_mfma_f32_16x16x32_bf16 a[188:191], v[180:183], v[156:159], a[188:191]
v_mfma_f32_16x16x32_bf16 a[248:251], v[184:187], v[156:159], a[248:251]
v_mfma_f32_16x16x32_bf16 a[252:255], v[188:191], v[156:159], a[252:255]
s_waitcnt vmcnt(15) lgkmcnt(0)
s_barrier
v_mfma_f32_16x16x32_bf16 a[0:3], v[96:99], v[64:67], a[0:3]
s_add_u32 m0, s58, 16384
v_mfma_f32_16x16x32_bf16 a[4:7], v[100:103], v[64:67], a[4:7]
ds_read_b64_tr_b16 v[128:129], v8 offset:49152
v_mfma_f32_16x16x32_bf16 a[64:67], v[104:107], v[64:67], a[64:67]
ds_read_b64_tr_b16 v[130:131], v8 offset:50176
v_mfma_f32_16x16x32_bf16 a[68:71], v[108:111], v[64:67], a[68:71]
v_mfma_f32_16x16x32_bf16 a[128:131], v[112:115], v[64:67], a[128:131]
ds_read_b128 v[160:163], v27 offset:0
s_add_u32 s30, s31, 3407872
v_mfma_f32_16x16x32_bf16 a[132:135], v[116:119], v[64:67], a[132:135]
v_mfma_f32_16x16x32_bf16 a[192:195], v[120:123], v[64:67], a[192:195]
v_mfma_f32_16x16x32_bf16 a[196:199], v[124:127], v[64:67], a[196:199]
ds_read_b64_tr_b16 v[132:133], v9 offset:49152
v_mfma_f32_16x16x32_bf16 a[8:11], v[96:99], v[68:71], a[8:11]
ds_read_b64_tr_b16 v[134:135], v9 offset:50176
v_mfma_f32_16x16x32_bf16 a[12:15], v[100:103], v[68:71], a[12:15]
buffer_load_dwordx4 v20, s[8:11], s30 offen offset:0 lds
v_mfma_f32_16x16x32_bf16 a[72:75], v[104:107], v[68:71], a[72:75]
ds_read_b128 v[164:167], v26 offset:1024
v_mfma_f32_16x16x32_bf16 a[76:79], v[108:111], v[68:71], a[76:79]
v_mfma_f32_16x16x32_bf16 a[136:139], v[112:115], v[68:71], a[136:139]
buffer_load_dwordx4 v21, s[8:11], s30 offen offset:1024 lds
v_mfma_f32_16x16x32_bf16 a[140:143], v[116:119], v[68:71], a[140:143]
ds_read_b64_tr_b16 v[136:137], v10 offset:49152
v_mfma_f32_16x16x32_bf16 a[200:203], v[120:123], v[68:71], a[200:203]
ds_read_b64_tr_b16 v[138:139], v10 offset:50176
v_mfma_f32_16x16x32_bf16 a[204:207], v[124:127], v[68:71], a[204:207]
v_mfma_f32_16x16x32_bf16 a[16:19], v[96:99], v[72:75], a[16:19]
ds_read_b128 v[168:171], v27 offset:4096
v_mfma_f32_16x16x32_bf16 a[20:23], v[100:103], v[72:75], a[20:23]
buffer_load_dwordx4 v22, s[8:11], s30 offen offset:2048 lds
v_mfma_f32_16x16x32_bf16 a[80:83], v[104:107], v[72:75], a[80:83]
v_mfma_f32_16x16x32_bf16 a[84:87], v[108:111], v[72:75], a[84:87]
ds_read_b64_tr_b16 v[140:141], v11 offset:49152
v_mfma_f32_16x16x32_bf16 a[144:147], v[112:115], v[72:75], a[144:147]
ds_read_b64_tr_b16 v[142:143], v11 offset:50176
v_mfma_f32_16x16x32_bf16 a[148:151], v[116:119], v[72:75], a[148:151]
buffer_load_dwordx4 v23, s[8:11], s30 offen offset:3072 lds
v_mfma_f32_16x16x32_bf16 a[208:211], v[120:123], v[72:75], a[208:211]
ds_read_b128 v[172:175], v26 offset:5120
v_mfma_f32_16x16x32_bf16 a[212:215], v[124:127], v[72:75], a[212:215]
v_mfma_f32_16x16x32_bf16 a[24:27], v[96:99], v[76:79], a[24:27]
s_add_u32 m0, s35, 32768
v_mfma_f32_16x16x32_bf16 a[28:31], v[100:103], v[76:79], a[28:31]
ds_read_b64_tr_b16 v[144:145], v12 offset:49152
v_mfma_f32_16x16x32_bf16 a[88:91], v[104:107], v[76:79], a[88:91]
ds_read_b64_tr_b16 v[146:147], v12 offset:50176
v_mfma_f32_16x16x32_bf16 a[92:95], v[108:111], v[76:79], a[92:95]
v_mfma_f32_16x16x32_bf16 a[152:155], v[112:115], v[76:79], a[152:155]
ds_read_b128 v[176:179], v27 offset:8192
s_add_u32 s30, s33, 896
v_mfma_f32_16x16x32_bf16 a[156:159], v[116:119], v[76:79], a[156:159]
v_mfma_f32_16x16x32_bf16 a[216:219], v[120:123], v[76:79], a[216:219]
v_mfma_f32_16x16x32_bf16 a[220:223], v[124:127], v[76:79], a[220:223]
ds_read_b64_tr_b16 v[148:149], v13 offset:49152
v_mfma_f32_16x16x32_bf16 a[32:35], v[96:99], v[80:83], a[32:35]
ds_read_b64_tr_b16 v[150:151], v13 offset:50176
v_mfma_f32_16x16x32_bf16 a[36:39], v[100:103], v[80:83], a[36:39]
buffer_load_dwordx4 v40, s[4:7], s30 offen offset:0 lds
v_mfma_f32_16x16x32_bf16 a[96:99], v[104:107], v[80:83], a[96:99]
ds_read_b128 v[180:183], v26 offset:9216
v_mfma_f32_16x16x32_bf16 a[100:103], v[108:111], v[80:83], a[100:103]
v_mfma_f32_16x16x32_bf16 a[160:163], v[112:115], v[80:83], a[160:163]
buffer_load_dwordx4 v41, s[4:7], s30 offen offset:1024 lds
v_mfma_f32_16x16x32_bf16 a[164:167], v[116:119], v[80:83], a[164:167]
ds_read_b64_tr_b16 v[152:153], v14 offset:49152
v_mfma_f32_16x16x32_bf16 a[224:227], v[120:123], v[80:83], a[224:227]
ds_read_b64_tr_b16 v[154:155], v14 offset:50176
v_mfma_f32_16x16x32_bf16 a[228:231], v[124:127], v[80:83], a[228:231]
v_mfma_f32_16x16x32_bf16 a[40:43], v[96:99], v[84:87], a[40:43]
ds_read_b128 v[184:187], v27 offset:12288
v_mfma_f32_16x16x32_bf16 a[44:47], v[100:103], v[84:87], a[44:47]
buffer_load_dwordx4 v42, s[4:7], s30 offen offset:2048 lds
v_mfma_f32_16x16x32_bf16 a[104:107], v[104:107], v[84:87], a[104:107]
v_mfma_f32_16x16x32_bf16 a[108:111], v[108:111], v[84:87], a[108:111]
ds_read_b64_tr_b16 v[156:157], v15 offset:49152
v_mfma_f32_16x16x32_bf16 a[168:171], v[112:115], v[84:87], a[168:171]
ds_read_b64_tr_b16 v[158:159], v15 offset:50176
v_mfma_f32_16x16x32_bf16 a[172:175], v[116:119], v[84:87], a[172:175]
buffer_load_dwordx4 v43, s[4:7], s30 offen offset:3072 lds
v_mfma_f32_16x16x32_bf16 a[232:235], v[120:123], v[84:87], a[232:235]
ds_read_b128 v[188:191], v26 offset:13312
v_mfma_f32_16x16x32_bf16 a[236:239], v[124:127], v[84:87], a[236:239]
v_mfma_f32_16x16x32_bf16 a[48:51], v[96:99], v[88:91], a[48:51]
s_mov_b32 s40, 0xff00f0
s_mov_b32 s41, 0x0
v_mfma_f32_16x16x32_bf16 a[52:55], v[100:103], v[88:91], a[52:55]
v_mfma_f32_16x16x32_bf16 a[112:115], v[104:107], v[88:91], a[112:115]
v_mfma_f32_16x16x32_bf16 a[116:119], v[108:111], v[88:91], a[116:119]
v_mfma_f32_16x16x32_bf16 a[176:179], v[112:115], v[88:91], a[176:179]
v_cndmask_b32 v60, v52, v35, s[40:41]
v_mfma_f32_16x16x32_bf16 a[180:183], v[116:119], v[88:91], a[180:183]
v_mfma_f32_16x16x32_bf16 a[240:243], v[120:123], v[88:91], a[240:243]
v_mfma_f32_16x16x32_bf16 a[244:247], v[124:127], v[88:91], a[244:247]
v_mfma_f32_16x16x32_bf16 a[56:59], v[96:99], v[92:95], a[56:59]
buffer_load_dword v39, v60, s[60:63], 0 offen
v_mfma_f32_16x16x32_bf16 a[60:63], v[100:103], v[92:95], a[60:63]
v_mfma_f32_16x16x32_bf16 a[120:123], v[104:107], v[92:95], a[120:123]
v_mfma_f32_16x16x32_bf16 a[124:127], v[108:111], v[92:95], a[124:127]
v_mfma_f32_16x16x32_bf16 a[184:187], v[112:115], v[92:95], a[184:187]
v_mfma_f32_16x16x32_bf16 a[188:191], v[116:119], v[92:95], a[188:191]
v_mfma_f32_16x16x32_bf16 a[248:251], v[120:123], v[92:95], a[248:251]
v_mfma_f32_16x16x32_bf16 a[252:255], v[124:127], v[92:95], a[252:255]
s_waitcnt vmcnt(10) lgkmcnt(0)
s_barrier
v_mfma_f32_16x16x32_bf16 a[0:3], v[160:163], v[128:131], a[0:3]
s_add_u32 m0, s58, 32768
v_mfma_f32_16x16x32_bf16 a[4:7], v[164:167], v[128:131], a[4:7]
ds_read_b64_tr_b16 v[64:65], v8 offset:0
v_mfma_f32_16x16x32_bf16 a[64:67], v[168:171], v[128:131], a[64:67]
ds_read_b64_tr_b16 v[66:67], v8 offset:1024
s_add_u32 s30, s31, 3670016
v_mfma_f32_16x16x32_bf16 a[68:71], v[172:175], v[128:131], a[68:71]
v_mfma_f32_16x16x32_bf16 a[128:131], v[176:179], v[128:131], a[128:131]
ds_read_b128 v[96:99], v24 offset:0
v_mfma_f32_16x16x32_bf16 a[132:135], v[180:183], v[128:131], a[132:135]
buffer_load_dwordx4 v20, s[8:11], s30 offen offset:0 lds
v_mfma_f32_16x16x32_bf16 a[192:195], v[184:187], v[128:131], a[192:195]
v_mfma_f32_16x16x32_bf16 a[196:199], v[188:191], v[128:131], a[196:199]
ds_read_b64_tr_b16 v[68:69], v9 offset:0
v_mfma_f32_16x16x32_bf16 a[8:11], v[160:163], v[132:135], a[8:11]
ds_read_b64_tr_b16 v[70:71], v9 offset:1024
v_mfma_f32_16x16x32_bf16 a[12:15], v[164:167], v[132:135], a[12:15]
buffer_load_dwordx4 v21, s[8:11], s30 offen offset:1024 lds
v_mfma_f32_16x16x32_bf16 a[72:75], v[168:171], v[132:135], a[72:75]
ds_read_b128 v[100:103], v25 offset:1024
v_mfma_f32_16x16x32_bf16 a[76:79], v[172:175], v[132:135], a[76:79]
buffer_load_dwordx4 v22, s[8:11], s30 offen offset:2048 lds
v_mfma_f32_16x16x32_bf16 a[136:139], v[176:179], v[132:135], a[136:139]
v_mfma_f32_16x16x32_bf16 a[140:143], v[180:183], v[132:135], a[140:143]
ds_read_b64_tr_b16 v[72:73], v10 offset:0
v_mfma_f32_16x16x32_bf16 a[200:203], v[184:187], v[132:135], a[200:203]
ds_read_b64_tr_b16 v[74:75], v10 offset:1024
v_mfma_f32_16x16x32_bf16 a[204:207], v[188:191], v[132:135], a[204:207]
buffer_load_dwordx4 v23, s[8:11], s30 offen offset:3072 lds
v_mfma_f32_16x16x32_bf16 a[16:19], v[160:163], v[136:139], a[16:19]
ds_read_b128 v[104:107], v24 offset:4096
v_mfma_f32_16x16x32_bf16 a[20:23], v[164:167], v[136:139], a[20:23]
s_add_u32 m0, s35, 36864
v_mfma_f32_16x16x32_bf16 a[80:83], v[168:171], v[136:139], a[80:83]
v_mfma_f32_16x16x32_bf16 a[84:87], v[172:175], v[136:139], a[84:87]
ds_read_b64_tr_b16 v[76:77], v11 offset:0
v_mfma_f32_16x16x32_bf16 a[144:147], v[176:179], v[136:139], a[144:147]
ds_read_b64_tr_b16 v[78:79], v11 offset:1024
s_add_u32 s30, s33, 896
v_mfma_f32_16x16x32_bf16 a[148:151], v[180:183], v[136:139], a[148:151]
v_mfma_f32_16x16x32_bf16 a[208:211], v[184:187], v[136:139], a[208:211]
ds_read_b128 v[108:111], v25 offset:5120
v_mfma_f32_16x16x32_bf16 a[212:215], v[188:191], v[136:139], a[212:215]
buffer_load_dwordx4 v44, s[4:7], s30 offen offset:0 lds
v_mfma_f32_16x16x32_bf16 a[24:27], v[160:163], v[140:143], a[24:27]
v_mfma_f32_16x16x32_bf16 a[28:31], v[164:167], v[140:143], a[28:31]
ds_read_b64_tr_b16 v[80:81], v12 offset:0
v_mfma_f32_16x16x32_bf16 a[88:91], v[168:171], v[140:143], a[88:91]
ds_read_b64_tr_b16 v[82:83], v12 offset:1024
v_mfma_f32_16x16x32_bf16 a[92:95], v[172:175], v[140:143], a[92:95]
buffer_load_dwordx4 v45, s[4:7], s30 offen offset:1024 lds
v_mfma_f32_16x16x32_bf16 a[152:155], v[176:179], v[140:143], a[152:155]
ds_read_b128 v[112:115], v24 offset:8192
v_mfma_f32_16x16x32_bf16 a[156:159], v[180:183], v[140:143], a[156:159]
buffer_load_dwordx4 v46, s[4:7], s30 offen offset:2048 lds
v_mfma_f32_16x16x32_bf16 a[216:219], v[184:187], v[140:143], a[216:219]
v_mfma_f32_16x16x32_bf16 a[220:223], v[188:191], v[140:143], a[220:223]
ds_read_b64_tr_b16 v[84:85], v13 offset:0
v_mfma_f32_16x16x32_bf16 a[32:35], v[160:163], v[144:147], a[32:35]
ds_read_b64_tr_b16 v[86:87], v13 offset:1024
v_mfma_f32_16x16x32_bf16 a[36:39], v[164:167], v[144:147], a[36:39]
buffer_load_dwordx4 v47, s[4:7], s30 offen offset:3072 lds
v_mfma_f32_16x16x32_bf16 a[96:99], v[168:171], v[144:147], a[96:99]
ds_read_b128 v[116:119], v25 offset:9216
s_add_u32 m0, s58, 131072
v_mfma_f32_16x16x32_bf16 a[100:103], v[172:175], v[144:147], a[100:103]
v_mfma_f32_16x16x32_bf16 a[160:163], v[176:179], v[144:147], a[160:163]
v_mfma_f32_16x16x32_bf16 a[164:167], v[180:183], v[144:147], a[164:167]
ds_read_b64_tr_b16 v[88:89], v14 offset:0
s_add_u32 s30, s39, 4194304
v_mfma_f32_16x16x32_bf16 a[224:227], v[184:187], v[144:147], a[224:227]
ds_read_b64_tr_b16 v[90:91], v14 offset:1024
v_mfma_f32_16x16x32_bf16 a[228:231], v[188:191], v[144:147], a[228:231]
v_mfma_f32_16x16x32_bf16 a[40:43], v[160:163], v[148:151], a[40:43]
ds_read_b128 v[120:123], v24 offset:12288
v_mfma_f32_16x16x32_bf16 a[44:47], v[164:167], v[148:151], a[44:47]
buffer_load_dwordx4 v20, s[60:63], s30 offen offset:0 lds
v_mfma_f32_16x16x32_bf16 a[104:107], v[168:171], v[148:151], a[104:107]
buffer_load_dwordx4 v21, s[60:63], s30 offen offset:1024 lds
v_mfma_f32_16x16x32_bf16 a[108:111], v[172:175], v[148:151], a[108:111]
ds_read_b64_tr_b16 v[92:93], v15 offset:0
v_mfma_f32_16x16x32_bf16 a[168:171], v[176:179], v[148:151], a[168:171]
ds_read_b64_tr_b16 v[94:95], v15 offset:1024
v_mfma_f32_16x16x32_bf16 a[172:175], v[180:183], v[148:151], a[172:175]
buffer_load_dwordx4 v22, s[60:63], s30 offen offset:2048 lds
v_mfma_f32_16x16x32_bf16 a[232:235], v[184:187], v[148:151], a[232:235]
ds_read_b128 v[124:127], v25 offset:13312
v_mfma_f32_16x16x32_bf16 a[236:239], v[188:191], v[148:151], a[236:239]
v_mfma_f32_16x16x32_bf16 a[48:51], v[160:163], v[152:155], a[48:51]
buffer_load_dwordx4 v23, s[60:63], s30 offen offset:3072 lds
v_mfma_f32_16x16x32_bf16 a[52:55], v[164:167], v[152:155], a[52:55]
v_mfma_f32_16x16x32_bf16 a[112:115], v[168:171], v[152:155], a[112:115]
v_mfma_f32_16x16x32_bf16 a[116:119], v[172:175], v[152:155], a[116:119]
s_mov_b32 s40, 0xf00
s_mov_b32 s41, 0x0
v_mfma_f32_16x16x32_bf16 a[176:179], v[176:179], v[152:155], a[176:179]
v_mfma_f32_16x16x32_bf16 a[180:183], v[180:183], v[152:155], a[180:183]
v_mfma_f32_16x16x32_bf16 a[240:243], v[184:187], v[152:155], a[240:243]
v_cndmask_b32 v60, v52, v35, s[40:41]
v_mfma_f32_16x16x32_bf16 a[244:247], v[188:191], v[152:155], a[244:247]
v_mfma_f32_16x16x32_bf16 a[56:59], v[160:163], v[156:159], a[56:59]
v_mfma_f32_16x16x32_bf16 a[60:63], v[164:167], v[156:159], a[60:63]
buffer_load_dword v39, v60, s[60:63], 0 offen
v_mfma_f32_16x16x32_bf16 a[120:123], v[168:171], v[156:159], a[120:123]
v_mfma_f32_16x16x32_bf16 a[124:127], v[172:175], v[156:159], a[124:127]
v_mfma_f32_16x16x32_bf16 a[184:187], v[176:179], v[156:159], a[184:187]
v_mfma_f32_16x16x32_bf16 a[188:191], v[180:183], v[156:159], a[188:191]
v_mfma_f32_16x16x32_bf16 a[248:251], v[184:187], v[156:159], a[248:251]
v_mfma_f32_16x16x32_bf16 a[252:255], v[188:191], v[156:159], a[252:255]
s_waitcnt vmcnt(18) lgkmcnt(0)
s_barrier
v_mfma_f32_16x16x32_bf16 a[0:3], v[96:99], v[64:67], a[0:3]
s_add_u32 m0, s58, 49152
v_mfma_f32_16x16x32_bf16 a[4:7], v[100:103], v[64:67], a[4:7]
ds_read_b64_tr_b16 v[128:129], v8 offset:16384
v_mfma_f32_16x16x32_bf16 a[64:67], v[104:107], v[64:67], a[64:67]
ds_read_b64_tr_b16 v[130:131], v8 offset:17408
v_mfma_f32_16x16x32_bf16 a[68:71], v[108:111], v[64:67], a[68:71]
v_mfma_f32_16x16x32_bf16 a[128:131], v[112:115], v[64:67], a[128:131]
ds_read_b128 v[160:163], v25 offset:0
s_add_u32 s30, s31, 3932160
v_mfma_f32_16x16x32_bf16 a[132:135], v[116:119], v[64:67], a[132:135]
v_mfma_f32_16x16x32_bf16 a[192:195], v[120:123], v[64:67], a[192:195]
v_mfma_f32_16x16x32_bf16 a[196:199], v[124:127], v[64:67], a[196:199]
ds_read_b64_tr_b16 v[132:133], v9 offset:16384
v_mfma_f32_16x16x32_bf16 a[8:11], v[96:99], v[68:71], a[8:11]
ds_read_b64_tr_b16 v[134:135], v9 offset:17408
v_mfma_f32_16x16x32_bf16 a[12:15], v[100:103], v[68:71], a[12:15]
buffer_load_dwordx4 v20, s[8:11], s30 offen offset:0 lds
v_mfma_f32_16x16x32_bf16 a[72:75], v[104:107], v[68:71], a[72:75]
ds_read_b128 v[164:167], v24 offset:1024
v_mfma_f32_16x16x32_bf16 a[76:79], v[108:111], v[68:71], a[76:79]
v_mfma_f32_16x16x32_bf16 a[136:139], v[112:115], v[68:71], a[136:139]
buffer_load_dwordx4 v21, s[8:11], s30 offen offset:1024 lds
v_mfma_f32_16x16x32_bf16 a[140:143], v[116:119], v[68:71], a[140:143]
ds_read_b64_tr_b16 v[136:137], v10 offset:16384
v_mfma_f32_16x16x32_bf16 a[200:203], v[120:123], v[68:71], a[200:203]
ds_read_b64_tr_b16 v[138:139], v10 offset:17408
v_mfma_f32_16x16x32_bf16 a[204:207], v[124:127], v[68:71], a[204:207]
v_mfma_f32_16x16x32_bf16 a[16:19], v[96:99], v[72:75], a[16:19]
ds_read_b128 v[168:171], v25 offset:4096
v_mfma_f32_16x16x32_bf16 a[20:23], v[100:103], v[72:75], a[20:23]
buffer_load_dwordx4 v22, s[8:11], s30 offen offset:2048 lds
v_mfma_f32_16x16x32_bf16 a[80:83], v[104:107], v[72:75], a[80:83]
v_mfma_f32_16x16x32_bf16 a[84:87], v[108:111], v[72:75], a[84:87]
ds_read_b64_tr_b16 v[140:141], v11 offset:16384
v_mfma_f32_16x16x32_bf16 a[144:147], v[112:115], v[72:75], a[144:147]
ds_read_b64_tr_b16 v[142:143], v11 offset:17408
v_mfma_f32_16x16x32_bf16 a[148:151], v[116:119], v[72:75], a[148:151]
buffer_load_dwordx4 v23, s[8:11], s30 offen offset:3072 lds
v_mfma_f32_16x16x32_bf16 a[208:211], v[120:123], v[72:75], a[208:211]
ds_read_b128 v[172:175], v24 offset:5120
v_mfma_f32_16x16x32_bf16 a[212:215], v[124:127], v[72:75], a[212:215]
v_mfma_f32_16x16x32_bf16 a[24:27], v[96:99], v[76:79], a[24:27]
s_add_u32 m0, s58, 0
v_mfma_f32_16x16x32_bf16 a[28:31], v[100:103], v[76:79], a[28:31]
ds_read_b64_tr_b16 v[144:145], v12 offset:16384
v_mfma_f32_16x16x32_bf16 a[88:91], v[104:107], v[76:79], a[88:91]
ds_read_b64_tr_b16 v[146:147], v12 offset:17408
v_mfma_f32_16x16x32_bf16 a[92:95], v[108:111], v[76:79], a[92:95]
v_mfma_f32_16x16x32_bf16 a[152:155], v[112:115], v[76:79], a[152:155]
ds_read_b128 v[176:179], v25 offset:8192
s_add_u32 s30, s39, 0
v_mfma_f32_16x16x32_bf16 a[156:159], v[116:119], v[76:79], a[156:159]
v_mfma_f32_16x16x32_bf16 a[216:219], v[120:123], v[76:79], a[216:219]
v_mfma_f32_16x16x32_bf16 a[220:223], v[124:127], v[76:79], a[220:223]
ds_read_b64_tr_b16 v[148:149], v13 offset:16384
v_mfma_f32_16x16x32_bf16 a[32:35], v[96:99], v[80:83], a[32:35]
ds_read_b64_tr_b16 v[150:151], v13 offset:17408
v_mfma_f32_16x16x32_bf16 a[36:39], v[100:103], v[80:83], a[36:39]
buffer_load_dwordx4 v20, s[60:63], s30 offen offset:0 lds
v_mfma_f32_16x16x32_bf16 a[96:99], v[104:107], v[80:83], a[96:99]
ds_read_b128 v[180:183], v24 offset:9216
v_mfma_f32_16x16x32_bf16 a[100:103], v[108:111], v[80:83], a[100:103]
v_mfma_f32_16x16x32_bf16 a[160:163], v[112:115], v[80:83], a[160:163]
buffer_load_dwordx4 v21, s[60:63], s30 offen offset:1024 lds
v_mfma_f32_16x16x32_bf16 a[164:167], v[116:119], v[80:83], a[164:167]
ds_read_b64_tr_b16 v[152:153], v14 offset:16384
v_mfma_f32_16x16x32_bf16 a[224:227], v[120:123], v[80:83], a[224:227]
ds_read_b64_tr_b16 v[154:155], v14 offset:17408
v_mfma_f32_16x16x32_bf16 a[228:231], v[124:127], v[80:83], a[228:231]
v_mfma_f32_16x16x32_bf16 a[40:43], v[96:99], v[84:87], a[40:43]
ds_read_b128 v[184:187], v25 offset:12288
v_mfma_f32_16x16x32_bf16 a[44:47], v[100:103], v[84:87], a[44:47]
buffer_load_dwordx4 v22, s[60:63], s30 offen offset:2048 lds
v_mfma_f32_16x16x32_bf16 a[104:107], v[104:107], v[84:87], a[104:107]
v_mfma_f32_16x16x32_bf16 a[108:111], v[108:111], v[84:87], a[108:111]
ds_read_b64_tr_b16 v[156:157], v15 offset:16384
v_mfma_f32_16x16x32_bf16 a[168:171], v[112:115], v[84:87], a[168:171]
ds_read_b64_tr_b16 v[158:159], v15 offset:17408
v_mfma_f32_16x16x32_bf16 a[172:175], v[116:119], v[84:87], a[172:175]
buffer_load_dwordx4 v23, s[60:63], s30 offen offset:3072 lds
v_mfma_f32_16x16x32_bf16 a[232:235], v[120:123], v[84:87], a[232:235]
ds_read_b128 v[188:191], v24 offset:13312
v_mfma_f32_16x16x32_bf16 a[236:239], v[124:127], v[84:87], a[236:239]
v_mfma_f32_16x16x32_bf16 a[48:51], v[96:99], v[88:91], a[48:51]
s_mov_b32 s40, 0xff00f000
s_mov_b32 s41, 0x0
v_mfma_f32_16x16x32_bf16 a[52:55], v[100:103], v[88:91], a[52:55]
v_mfma_f32_16x16x32_bf16 a[112:115], v[104:107], v[88:91], a[112:115]
v_mfma_f32_16x16x32_bf16 a[116:119], v[108:111], v[88:91], a[116:119]
v_mfma_f32_16x16x32_bf16 a[176:179], v[112:115], v[88:91], a[176:179]
v_cndmask_b32 v60, v52, v35, s[40:41]
v_mfma_f32_16x16x32_bf16 a[180:183], v[116:119], v[88:91], a[180:183]
v_mfma_f32_16x16x32_bf16 a[240:243], v[120:123], v[88:91], a[240:243]
v_mfma_f32_16x16x32_bf16 a[244:247], v[124:127], v[88:91], a[244:247]
v_mfma_f32_16x16x32_bf16 a[56:59], v[96:99], v[92:95], a[56:59]
buffer_load_dword v39, v60, s[60:63], 0 offen
v_mfma_f32_16x16x32_bf16 a[60:63], v[100:103], v[92:95], a[60:63]
v_mfma_f32_16x16x32_bf16 a[120:123], v[104:107], v[92:95], a[120:123]
v_mfma_f32_16x16x32_bf16 a[124:127], v[108:111], v[92:95], a[124:127]
tp0_p6:
s_cbranch_execz tp0_ret
v_mfma_f32_16x16x32_bf16 a[184:187], v[112:115], v[92:95], a[184:187]
v_mfma_f32_16x16x32_bf16 a[188:191], v[116:119], v[92:95], a[188:191]
v_mfma_f32_16x16x32_bf16 a[248:251], v[120:123], v[92:95], a[248:251]
v_mfma_f32_16x16x32_bf16 a[252:255], v[124:127], v[92:95], a[252:255]
s_waitcnt vmcnt(14) lgkmcnt(0)
s_barrier
v_mfma_f32_16x16x32_bf16 a[0:3], v[160:163], v[128:131], a[0:3]
buffer_load_dword v63, v62, s[20:23], 0 offen sc1
v_mfma_f32_16x16x32_bf16 a[4:7], v[164:167], v[128:131], a[4:7]
ds_read_b64_tr_b16 v[64:65], v8 offset:32768
v_mfma_f32_16x16x32_bf16 a[64:67], v[168:171], v[128:131], a[64:67]
ds_read_b64_tr_b16 v[66:67], v8 offset:33792
v_mfma_f32_16x16x32_bf16 a[68:71], v[172:175], v[128:131], a[68:71]
buffer_load_dword v36, v38, s[20:23], 0 offen sc1
v_mfma_f32_16x16x32_bf16 a[128:131], v[176:179], v[128:131], a[128:131]
ds_read_b128 v[96:99], v24 offset:32768
v_mfma_f32_16x16x32_bf16 a[132:135], v[180:183], v[128:131], a[132:135]
v_mfma_f32_16x16x32_bf16 a[192:195], v[184:187], v[128:131], a[192:195]
s_add_u32 m0, s58, 16384
v_mfma_f32_16x16x32_bf16 a[196:199], v[188:191], v[128:131], a[196:199]
ds_read_b64_tr_b16 v[68:69], v9 offset:32768
v_mfma_f32_16x16x32_bf16 a[8:11], v[160:163], v[132:135], a[8:11]
ds_read_b64_tr_b16 v[70:71], v9 offset:33792
v_mfma_f32_16x16x32_bf16 a[12:15], v[164:167], v[132:135], a[12:15]
s_add_u32 s30, s39, 524288
v_mfma_f32_16x16x32_bf16 a[72:75], v[168:171], v[132:135], a[72:75]
ds_read_b128 v[100:103], v25 offset:33792
v_mfma_f32_16x16x32_bf16 a[76:79], v[172:175], v[132:135], a[76:79]
v_mfma_f32_16x16x32_bf16 a[136:139], v[176:179], v[132:135], a[136:139]
buffer_load_dwordx4 v20, s[60:63], s30 offen offset:0 lds
v_mfma_f32_16x16x32_bf16 a[140:143], v[180:183], v[132:135], a[140:143]
ds_read_b64_tr_b16 v[72:73], v10 offset:32768
v_mfma_f32_16x16x32_bf16 a[200:203], v[184:187], v[132:135], a[200:203]
ds_read_b64_tr_b16 v[74:75], v10 offset:33792
v_mfma_f32_16x16x32_bf16 a[204:207], v[188:191], v[132:135], a[204:207]
buffer_load_dwordx4 v21, s[60:63], s30 offen offset:1024 lds
v_mfma_f32_16x16x32_bf16 a[16:19], v[160:163], v[136:139], a[16:19]
ds_read_b128 v[104:107], v24 offset:36864
v_mfma_f32_16x16x32_bf16 a[20:23], v[164:167], v[136:139], a[20:23]
v_mfma_f32_16x16x32_bf16 a[80:83], v[168:171], v[136:139], a[80:83]
buffer_load_dwordx4 v22, s[60:63], s30 offen offset:2048 lds
v_mfma_f32_16x16x32_bf16 a[84:87], v[172:175], v[136:139], a[84:87]
ds_read_b64_tr_b16 v[76:77], v11 offset:32768
v_mfma_f32_16x16x32_bf16 a[144:147], v[176:179], v[136:139], a[144:147]
ds_read_b64_tr_b16 v[78:79], v11 offset:33792
v_mfma_f32_16x16x32_bf16 a[148:151], v[180:183], v[136:139], a[148:151]
buffer_load_dwordx4 v23, s[60:63], s30 offen offset:3072 lds
v_mfma_f32_16x16x32_bf16 a[208:211], v[184:187], v[136:139], a[208:211]
ds_read_b128 v[108:111], v25 offset:37888
v_mfma_f32_16x16x32_bf16 a[212:215], v[188:191], v[136:139], a[212:215]
v_mfma_f32_16x16x32_bf16 a[24:27], v[160:163], v[140:143], a[24:27]
s_add_u32 m0, s58, 65536
v_mfma_f32_16x16x32_bf16 a[28:31], v[164:167], v[140:143], a[28:31]
ds_read_b64_tr_b16 v[80:81], v12 offset:32768
v_mfma_f32_16x16x32_bf16 a[88:91], v[168:171], v[140:143], a[88:91]
ds_read_b64_tr_b16 v[82:83], v12 offset:33792
v_mfma_f32_16x16x32_bf16 a[92:95], v[172:175], v[140:143], a[92:95]
s_add_u32 s30, s39, 2097152
v_mfma_f32_16x16x32_bf16 a[152:155], v[176:179], v[140:143], a[152:155]
ds_read_b128 v[112:115], v24 offset:40960
v_mfma_f32_16x16x32_bf16 a[156:159], v[180:183], v[140:143], a[156:159]
v_mfma_f32_16x16x32_bf16 a[216:219], v[184:187], v[140:143], a[216:219]
buffer_load_dwordx4 v20, s[60:63], s30 offen offset:0 lds
v_mfma_f32_16x16x32_bf16 a[220:223], v[188:191], v[140:143], a[220:223]
ds_read_b64_tr_b16 v[84:85], v13 offset:32768
v_mfma_f32_16x16x32_bf16 a[32:35], v[160:163], v[144:147], a[32:35]
ds_read_b64_tr_b16 v[86:87], v13 offset:33792
v_mfma_f32_16x16x32_bf16 a[36:39], v[164:167], v[144:147], a[36:39]
buffer_load_dwordx4 v21, s[60:63], s30 offen offset:1024 lds
v_mfma_f32_16x16x32_bf16 a[96:99], v[168:171], v[144:147], a[96:99]
ds_read_b128 v[116:119], v25 offset:41984
v_mfma_f32_16x16x32_bf16 a[100:103], v[172:175], v[144:147], a[100:103]
v_mfma_f32_16x16x32_bf16 a[160:163], v[176:179], v[144:147], a[160:163]
buffer_load_dwordx4 v22, s[60:63], s30 offen offset:2048 lds
v_mfma_f32_16x16x32_bf16 a[164:167], v[180:183], v[144:147], a[164:167]
ds_read_b64_tr_b16 v[88:89], v14 offset:32768
v_mfma_f32_16x16x32_bf16 a[224:227], v[184:187], v[144:147], a[224:227]
ds_read_b64_tr_b16 v[90:91], v14 offset:33792
v_mfma_f32_16x16x32_bf16 a[228:231], v[188:191], v[144:147], a[228:231]
buffer_load_dwordx4 v23, s[60:63], s30 offen offset:3072 lds
v_mfma_f32_16x16x32_bf16 a[40:43], v[160:163], v[148:151], a[40:43]
ds_read_b128 v[120:123], v24 offset:45056
v_mfma_f32_16x16x32_bf16 a[44:47], v[164:167], v[148:151], a[44:47]
v_mfma_f32_16x16x32_bf16 a[104:107], v[168:171], v[148:151], a[104:107]
s_add_u32 m0, s58, 81920
v_mfma_f32_16x16x32_bf16 a[108:111], v[172:175], v[148:151], a[108:111]
ds_read_b64_tr_b16 v[92:93], v15 offset:32768
v_mfma_f32_16x16x32_bf16 a[168:171], v[176:179], v[148:151], a[168:171]
ds_read_b64_tr_b16 v[94:95], v15 offset:33792
v_mfma_f32_16x16x32_bf16 a[172:175], v[180:183], v[148:151], a[172:175]
s_add_u32 s30, s39, 2621440
v_mfma_f32_16x16x32_bf16 a[232:235], v[184:187], v[148:151], a[232:235]
ds_read_b128 v[124:127], v25 offset:46080
v_mfma_f32_16x16x32_bf16 a[236:239], v[188:191], v[148:151], a[236:239]
v_mfma_f32_16x16x32_bf16 a[48:51], v[160:163], v[152:155], a[48:51]
buffer_load_dwordx4 v20, s[60:63], s30 offen offset:0 lds
v_mfma_f32_16x16x32_bf16 a[52:55], v[164:167], v[152:155], a[52:55]
v_mfma_f32_16x16x32_bf16 a[112:115], v[168:171], v[152:155], a[112:115]
v_mfma_f32_16x16x32_bf16 a[116:119], v[172:175], v[152:155], a[116:119]
buffer_load_dwordx4 v21, s[60:63], s30 offen offset:1024 lds
v_mfma_f32_16x16x32_bf16 a[176:179], v[176:179], v[152:155], a[176:179]
v_mfma_f32_16x16x32_bf16 a[180:183], v[180:183], v[152:155], a[180:183]
v_mfma_f32_16x16x32_bf16 a[240:243], v[184:187], v[152:155], a[240:243]
buffer_load_dwordx4 v22, s[60:63], s30 offen offset:2048 lds
v_mfma_f32_16x16x32_bf16 a[244:247], v[188:191], v[152:155], a[244:247]
v_mfma_f32_16x16x32_bf16 a[56:59], v[160:163], v[156:159], a[56:59]
v_mfma_f32_16x16x32_bf16 a[60:63], v[164:167], v[156:159], a[60:63]
buffer_load_dwordx4 v23, s[60:63], s30 offen offset:3072 lds
v_mfma_f32_16x16x32_bf16 a[120:123], v[168:171], v[156:159], a[120:123]
v_mfma_f32_16x16x32_bf16 a[124:127], v[172:175], v[156:159], a[124:127]
v_mfma_f32_16x16x32_bf16 a[184:187], v[176:179], v[156:159], a[184:187]
v_mfma_f32_16x16x32_bf16 a[188:191], v[180:183], v[156:159], a[188:191]
v_mfma_f32_16x16x32_bf16 a[248:251], v[184:187], v[156:159], a[248:251]
v_mfma_f32_16x16x32_bf16 a[252:255], v[188:191], v[156:159], a[252:255]
s_waitcnt vmcnt(19) lgkmcnt(0)
s_barrier
v_mfma_f32_16x16x32_bf16 a[0:3], v[96:99], v[64:67], a[0:3]
s_mov_b32 s76, 128
s_waitcnt vmcnt(12)
v_mfma_f32_16x16x32_bf16 a[4:7], v[100:103], v[64:67], a[4:7]
ds_read_b64_tr_b16 v[128:129], v8 offset:49152
v_readfirstlane_b32 s97, v63
s_cmp_eq_u32 s97, s96
s_cselect_b32 s96, 0, 0x40000000
s_cselect_b32 s97, 0x40000000, 0
v_mfma_f32_16x16x32_bf16 a[64:67], v[104:107], v[64:67], a[64:67]
ds_read_b64_tr_b16 v[130:131], v8 offset:50176
v_cmp_ne_u32 vcc, s76, v36
v_mfma_f32_16x16x32_bf16 a[68:71], v[108:111], v[64:67], a[68:71]
s_cbranch_vccnz k12_kernel_gspinV
k12_kernel_gbackV:
v_mfma_f32_16x16x32_bf16 a[128:131], v[112:115], v[64:67], a[128:131]
ds_read_b128 v[160:163], v25 offset:32768
s_mov_b32 s77, 0
v_mfma_f32_16x16x32_bf16 a[132:135], v[116:119], v[64:67], a[132:135]
buffer_load_dwordx4 v[192:195], v16, s[16:19], s77 offen offset:0 sc1
v_mfma_f32_16x16x32_bf16 a[192:195], v[120:123], v[64:67], a[192:195]
buffer_load_dwordx4 v[196:199], v17, s[16:19], s77 offen offset:0 sc1
v_mfma_f32_16x16x32_bf16 a[196:199], v[124:127], v[64:67], a[196:199]
ds_read_b64_tr_b16 v[132:133], v9 offset:49152
v_mfma_f32_16x16x32_bf16 a[8:11], v[96:99], v[68:71], a[8:11]
ds_read_b64_tr_b16 v[134:135], v9 offset:50176
v_mfma_f32_16x16x32_bf16 a[12:15], v[100:103], v[68:71], a[12:15]
buffer_load_dwordx4 v[200:203], v18, s[16:19], s77 offen offset:0 sc1
v_mfma_f32_16x16x32_bf16 a[72:75], v[104:107], v[68:71], a[72:75]
ds_read_b128 v[164:167], v24 offset:33792
v_mfma_f32_16x16x32_bf16 a[76:79], v[108:111], v[68:71], a[76:79]
buffer_load_dwordx4 v[204:207], v19, s[16:19], s77 offen offset:0 sc1
v_mfma_f32_16x16x32_bf16 a[136:139], v[112:115], v[68:71], a[136:139]
buffer_load_dwordx4 v[208:211], v16, s[16:19], s77 offen offset:1024 sc1
v_mfma_f32_16x16x32_bf16 a[140:143], v[116:119], v[68:71], a[140:143]
ds_read_b64_tr_b16 v[136:137], v10 offset:49152
v_mfma_f32_16x16x32_bf16 a[200:203], v[120:123], v[68:71], a[200:203]
ds_read_b64_tr_b16 v[138:139], v10 offset:50176
v_mfma_f32_16x16x32_bf16 a[204:207], v[124:127], v[68:71], a[204:207]
buffer_load_dwordx4 v[212:215], v17, s[16:19], s77 offen offset:1024 sc1
v_mfma_f32_16x16x32_bf16 a[16:19], v[96:99], v[72:75], a[16:19]
ds_read_b128 v[168:171], v25 offset:36864
v_mfma_f32_16x16x32_bf16 a[20:23], v[100:103], v[72:75], a[20:23]
buffer_load_dwordx4 v[216:219], v18, s[16:19], s77 offen offset:1024 sc1
v_mfma_f32_16x16x32_bf16 a[80:83], v[104:107], v[72:75], a[80:83]
buffer_load_dwordx4 v[220:223], v19, s[16:19], s77 offen offset:1024 sc1
v_mfma_f32_16x16x32_bf16 a[84:87], v[108:111], v[72:75], a[84:87]
ds_read_b64_tr_b16 v[140:141], v11 offset:49152
s_add_u32 m0, s58, 32768
v_mfma_f32_16x16x32_bf16 a[144:147], v[112:115], v[72:75], a[144:147]
ds_read_b64_tr_b16 v[142:143], v11 offset:50176
s_add_u32 s30, s39, 1048576
v_mfma_f32_16x16x32_bf16 a[148:151], v[116:119], v[72:75], a[148:151]
buffer_load_dwordx4 v20, s[60:63], s30 offen offset:0 lds
v_mfma_f32_16x16x32_bf16 a[208:211], v[120:123], v[72:75], a[208:211]
ds_read_b128 v[172:175], v24 offset:37888
v_mfma_f32_16x16x32_bf16 a[212:215], v[124:127], v[72:75], a[212:215]
buffer_load_dwordx4 v21, s[60:63], s30 offen offset:1024 lds
v_mfma_f32_16x16x32_bf16 a[24:27], v[96:99], v[76:79], a[24:27]
buffer_load_dwordx4 v22, s[60:63], s30 offen offset:2048 lds
v_mfma_f32_16x16x32_bf16 a[28:31], v[100:103], v[76:79], a[28:31]
ds_read_b64_tr_b16 v[144:145], v12 offset:49152
v_mfma_f32_16x16x32_bf16 a[88:91], v[104:107], v[76:79], a[88:91]
ds_read_b64_tr_b16 v[146:147], v12 offset:50176
v_mfma_f32_16x16x32_bf16 a[92:95], v[108:111], v[76:79], a[92:95]
buffer_load_dwordx4 v23, s[60:63], s30 offen offset:3072 lds
v_mfma_f32_16x16x32_bf16 a[152:155], v[112:115], v[76:79], a[152:155]
ds_read_b128 v[176:179], v25 offset:40960
v_mfma_f32_16x16x32_bf16 a[156:159], v[116:119], v[76:79], a[156:159]
v_mfma_f32_16x16x32_bf16 a[216:219], v[120:123], v[76:79], a[216:219]
v_mfma_f32_16x16x32_bf16 a[220:223], v[124:127], v[76:79], a[220:223]
ds_read_b64_tr_b16 v[148:149], v13 offset:49152
v_mfma_f32_16x16x32_bf16 a[32:35], v[96:99], v[80:83], a[32:35]
ds_read_b64_tr_b16 v[150:151], v13 offset:50176
v_mfma_f32_16x16x32_bf16 a[36:39], v[100:103], v[80:83], a[36:39]
v_mfma_f32_16x16x32_bf16 a[96:99], v[104:107], v[80:83], a[96:99]
ds_read_b128 v[180:183], v24 offset:41984
v_mfma_f32_16x16x32_bf16 a[100:103], v[108:111], v[80:83], a[100:103]
v_mfma_f32_16x16x32_bf16 a[160:163], v[112:115], v[80:83], a[160:163]
v_mfma_f32_16x16x32_bf16 a[164:167], v[116:119], v[80:83], a[164:167]
ds_read_b64_tr_b16 v[152:153], v14 offset:49152
v_mfma_f32_16x16x32_bf16 a[224:227], v[120:123], v[80:83], a[224:227]
ds_read_b64_tr_b16 v[154:155], v14 offset:50176
v_mfma_f32_16x16x32_bf16 a[228:231], v[124:127], v[80:83], a[228:231]
v_mfma_f32_16x16x32_bf16 a[40:43], v[96:99], v[84:87], a[40:43]
ds_read_b128 v[184:187], v25 offset:45056
v_mfma_f32_16x16x32_bf16 a[44:47], v[100:103], v[84:87], a[44:47]
v_mfma_f32_16x16x32_bf16 a[104:107], v[104:107], v[84:87], a[104:107]
v_mfma_f32_16x16x32_bf16 a[108:111], v[108:111], v[84:87], a[108:111]
ds_read_b64_tr_b16 v[156:157], v15 offset:49152
v_mfma_f32_16x16x32_bf16 a[168:171], v[112:115], v[84:87], a[168:171]
ds_read_b64_tr_b16 v[158:159], v15 offset:50176
v_mfma_f32_16x16x32_bf16 a[172:175], v[116:119], v[84:87], a[172:175]
v_mfma_f32_16x16x32_bf16 a[232:235], v[120:123], v[84:87], a[232:235]
ds_read_b128 v[188:191], v24 offset:46080
v_mfma_f32_16x16x32_bf16 a[236:239], v[124:127], v[84:87], a[236:239]
v_mfma_f32_16x16x32_bf16 a[48:51], v[96:99], v[88:91], a[48:51]
v_mfma_f32_16x16x32_bf16 a[52:55], v[100:103], v[88:91], a[52:55]
v_mfma_f32_16x16x32_bf16 a[112:115], v[104:107], v[88:91], a[112:115]
v_mfma_f32_16x16x32_bf16 a[116:119], v[108:111], v[88:91], a[116:119]
v_mfma_f32_16x16x32_bf16 a[176:179], v[112:115], v[88:91], a[176:179]
v_mfma_f32_16x16x32_bf16 a[180:183], v[116:119], v[88:91], a[180:183]
v_mfma_f32_16x16x32_bf16 a[240:243], v[120:123], v[88:91], a[240:243]
v_mfma_f32_16x16x32_bf16 a[244:247], v[124:127], v[88:91], a[244:247]
v_mfma_f32_16x16x32_bf16 a[56:59], v[96:99], v[92:95], a[56:59]
v_mfma_f32_16x16x32_bf16 a[60:63], v[100:103], v[92:95], a[60:63]
v_mfma_f32_16x16x32_bf16 a[120:123], v[104:107], v[92:95], a[120:123]
v_mfma_f32_16x16x32_bf16 a[124:127], v[108:111], v[92:95], a[124:127]
v_mfma_f32_16x16x32_bf16 a[184:187], v[112:115], v[92:95], a[184:187]
v_mfma_f32_16x16x32_bf16 a[188:191], v[116:119], v[92:95], a[188:191]
v_mfma_f32_16x16x32_bf16 a[248:251], v[120:123], v[92:95], a[248:251]
v_mfma_f32_16x16x32_bf16 a[252:255], v[124:127], v[92:95], a[252:255]
s_waitcnt vmcnt(27) lgkmcnt(0)
s_barrier
v_mfma_f32_16x16x32_bf16 a[0:3], v[160:163], v[128:131], a[0:3]
v_and_b32 v8, 0x1fff, v8
v_mfma_f32_16x16x32_bf16 a[4:7], v[164:167], v[128:131], a[4:7]
v_and_b32 v9, 0x1fff, v9
v_mfma_f32_16x16x32_bf16 a[64:67], v[168:171], v[128:131], a[64:67]
v_and_b32 v10, 0x1fff, v10
v_mfma_f32_16x16x32_bf16 a[68:71], v[172:175], v[128:131], a[68:71]
v_and_b32 v11, 0x1fff, v11
v_mfma_f32_16x16x32_bf16 a[128:131], v[176:179], v[128:131], a[128:131]
v_and_b32 v12, 0x1fff, v12
v_mfma_f32_16x16x32_bf16 a[132:135], v[180:183], v[128:131], a[132:135]
v_and_b32 v13, 0x1fff, v13
v_mfma_f32_16x16x32_bf16 a[192:195], v[184:187], v[128:131], a[192:195]
v_and_b32 v14, 0x1fff, v14
v_mfma_f32_16x16x32_bf16 a[196:199], v[188:191], v[128:131], a[196:199]
v_and_b32 v15, 0x1fff, v15
v_mfma_f32_16x16x32_bf16 a[8:11], v[160:163], v[132:135], a[8:11]
buffer_load_dwordx4 v[224:227], v16, s[16:19], s77 offen offset:2048 sc1
v_mfma_f32_16x16x32_bf16 a[12:15], v[164:167], v[132:135], a[12:15]
buffer_load_dwordx4 v[228:231], v17, s[16:19], s77 offen offset:2048 sc1
v_mfma_f32_16x16x32_bf16 a[72:75], v[168:171], v[132:135], a[72:75]
ds_read_b64_tr_b16 v[40:41], v8 offset:0
ds_read_b64_tr_b16 v[42:43], v8 offset:1024
v_mfma_f32_16x16x32_bf16 a[76:79], v[172:175], v[132:135], a[76:79]
buffer_load_dwordx4 v[232:235], v18, s[16:19], s77 offen offset:2048 sc1
v_mfma_f32_16x16x32_bf16 a[136:139], v[176:179], v[132:135], a[136:139]
ds_read_b64_tr_b16 v[44:45], v9 offset:0
ds_read_b64_tr_b16 v[46:47], v9 offset:1024
v_mfma_f32_16x16x32_bf16 a[140:143], v[180:183], v[132:135], a[140:143]
buffer_load_dwordx4 v[236:239], v19, s[16:19], s77 offen offset:2048 sc1
v_mfma_f32_16x16x32_bf16 a[200:203], v[184:187], v[132:135], a[200:203]
ds_read_b64_tr_b16 v[48:49], v10 offset:0
ds_read_b64_tr_b16 v[50:51], v10 offset:1024
v_mfma_f32_16x16x32_bf16 a[204:207], v[188:191], v[132:135], a[204:207]
buffer_load_dwordx4 v[240:243], v16, s[16:19], s77 offen offset:3072 sc1
v_mfma_f32_16x16x32_bf16 a[16:19], v[160:163], v[136:139], a[16:19]
ds_read_b64_tr_b16 v[52:53], v11 offset:0
ds_read_b64_tr_b16 v[54:55], v11 offset:1024
v_mfma_f32_16x16x32_bf16 a[20:23], v[164:167], v[136:139], a[20:23]
buffer_load_dwordx4 v[244:247], v17, s[16:19], s77 offen offset:3072 sc1
v_mfma_f32_16x16x32_bf16 a[80:83], v[168:171], v[136:139], a[80:83]
buffer_load_dwordx4 v[248:251], v18, s[16:19], s77 offen offset:3072 sc1
v_mfma_f32_16x16x32_bf16 a[84:87], v[172:175], v[136:139], a[84:87]
v_mfma_f32_16x16x32_bf16 a[144:147], v[176:179], v[136:139], a[144:147]
buffer_load_dwordx4 v[252:255], v19, s[16:19], s77 offen offset:3072 sc1
v_mfma_f32_16x16x32_bf16 a[148:151], v[180:183], v[136:139], a[148:151]
v_mfma_f32_16x16x32_bf16 a[208:211], v[184:187], v[136:139], a[208:211]
s_add_u32 s77, s77, 4096
v_mfma_f32_16x16x32_bf16 a[212:215], v[188:191], v[136:139], a[212:215]
v_mfma_f32_16x16x32_bf16 a[24:27], v[160:163], v[140:143], a[24:27]
v_mfma_f32_16x16x32_bf16 a[28:31], v[164:167], v[140:143], a[28:31]
s_add_u32 m0, s58, 49152
v_mfma_f32_16x16x32_bf16 a[88:91], v[168:171], v[140:143], a[88:91]
v_mfma_f32_16x16x32_bf16 a[92:95], v[172:175], v[140:143], a[92:95]
v_mfma_f32_16x16x32_bf16 a[152:155], v[176:179], v[140:143], a[152:155]
s_add_u32 s30, s39, 1572864
v_mfma_f32_16x16x32_bf16 a[156:159], v[180:183], v[140:143], a[156:159]
v_mfma_f32_16x16x32_bf16 a[216:219], v[184:187], v[140:143], a[216:219]
v_mfma_f32_16x16x32_bf16 a[220:223], v[188:191], v[140:143], a[220:223]
buffer_load_dwordx4 v20, s[60:63], s30 offen offset:0 lds
v_mfma_f32_16x16x32_bf16 a[32:35], v[160:163], v[144:147], a[32:35]
v_mfma_f32_16x16x32_bf16 a[36:39], v[164:167], v[144:147], a[36:39]
v_mfma_f32_16x16x32_bf16 a[96:99], v[168:171], v[144:147], a[96:99]
buffer_load_dwordx4 v21, s[60:63], s30 offen offset:1024 lds
v_mfma_f32_16x16x32_bf16 a[100:103], v[172:175], v[144:147], a[100:103]
v_mfma_f32_16x16x32_bf16 a[160:163], v[176:179], v[144:147], a[160:163]
v_mfma_f32_16x16x32_bf16 a[164:167], v[180:183], v[144:147], a[164:167]
buffer_load_dwordx4 v22, s[60:63], s30 offen offset:2048 lds
v_mfma_f32_16x16x32_bf16 a[224:227], v[184:187], v[144:147], a[224:227]
v_mfma_f32_16x16x32_bf16 a[228:231], v[188:191], v[144:147], a[228:231]
v_mfma_f32_16x16x32_bf16 a[40:43], v[160:163], v[148:151], a[40:43]
buffer_load_dwordx4 v23, s[60:63], s30 offen offset:3072 lds
v_mfma_f32_16x16x32_bf16 a[44:47], v[164:167], v[148:151], a[44:47]
v_mfma_f32_16x16x32_bf16 a[104:107], v[168:171], v[148:151], a[104:107]
s_add_u32 m0, s58, 98304
v_mfma_f32_16x16x32_bf16 a[108:111], v[172:175], v[148:151], a[108:111]
v_mfma_f32_16x16x32_bf16 a[168:171], v[176:179], v[148:151], a[168:171]
v_mfma_f32_16x16x32_bf16 a[172:175], v[180:183], v[148:151], a[172:175]
s_add_u32 s30, s39, 3145728
v_mfma_f32_16x16x32_bf16 a[232:235], v[184:187], v[148:151], a[232:235]
v_mfma_f32_16x16x32_bf16 a[236:239], v[188:191], v[148:151], a[236:239]
v_mfma_f32_16x16x32_bf16 a[48:51], v[160:163], v[152:155], a[48:51]
buffer_load_dwordx4 v20, s[60:63], s30 offen offset:0 lds
v_mfma_f32_16x16x32_bf16 a[52:55], v[164:167], v[152:155], a[52:55]
v_mfma_f32_16x16x32_bf16 a[112:115], v[168:171], v[152:155], a[112:115]
v_mfma_f32_16x16x32_bf16 a[116:119], v[172:175], v[152:155], a[116:119]
buffer_load_dwordx4 v21, s[60:63], s30 offen offset:1024 lds
v_mfma_f32_16x16x32_bf16 a[176:179], v[176:179], v[152:155], a[176:179]
v_mfma_f32_16x16x32_bf16 a[180:183], v[180:183], v[152:155], a[180:183]
v_mfma_f32_16x16x32_bf16 a[240:243], v[184:187], v[152:155], a[240:243]
buffer_load_dwordx4 v22, s[60:63], s30 offen offset:2048 lds
v_mfma_f32_16x16x32_bf16 a[244:247], v[188:191], v[152:155], a[244:247]
v_mfma_f32_16x16x32_bf16 a[56:59], v[160:163], v[156:159], a[56:59]
v_mfma_f32_16x16x32_bf16 a[60:63], v[164:167], v[156:159], a[60:63]
buffer_load_dwordx4 v23, s[60:63], s30 offen offset:3072 lds
v_mfma_f32_16x16x32_bf16 a[120:123], v[168:171], v[156:159], a[120:123]
v_mfma_f32_16x16x32_bf16 a[124:127], v[172:175], v[156:159], a[124:127]
v_mfma_f32_16x16x32_bf16 a[184:187], v[176:179], v[156:159], a[184:187]
v_mfma_f32_16x16x32_bf16 a[188:191], v[180:183], v[156:159], a[188:191]
v_mfma_f32_16x16x32_bf16 a[248:251], v[184:187], v[156:159], a[248:251]
v_mfma_f32_16x16x32_bf16 a[252:255], v[188:191], v[156:159], a[252:255]
s_waitcnt vmcnt(24) lgkmcnt(4)
s_barrier
k12_kernel_Q:
v_mfma_f32_16x16x32_bf16 v[64:67], v[40:43], v[192:195], 0
ds_read_b64_tr_b16 v[56:57], v12 offset:0
ds_read_b64_tr_b16 v[58:59], v12 offset:1024
v_mfma_f32_16x16x32_bf16 v[68:71], v[40:43], v[196:199], 0
s_add_u32 m0, s58, 114688
s_add_u32 s30, s39, 3670016
v_mfma_f32_16x16x32_bf16 v[72:75], v[40:43], v[200:203], 0
buffer_load_dwordx4 v20, s[60:63], s30 offen offset:0 lds
v_mfma_f32_16x16x32_bf16 v[76:79], v[40:43], v[204:207], 0
buffer_load_dwordx4 v21, s[60:63], s30 offen offset:1024 lds
v_mfma_f32_16x16x32_bf16 v[80:83], v[44:47], v[192:195], 0
ds_read_b64_tr_b16 v[60:61], v13 offset:0
ds_read_b64_tr_b16 v[62:63], v13 offset:1024
v_mfma_f32_16x16x32_bf16 v[84:87], v[44:47], v[196:199], 0
buffer_load_dwordx4 v22, s[60:63], s30 offen offset:2048 lds
v_mfma_f32_16x16x32_bf16 v[88:91], v[44:47], v[200:203], 0
buffer_load_dwordx4 v23, s[60:63], s30 offen offset:3072 lds
v_mfma_f32_16x16x32_bf16 v[92:95], v[44:47], v[204:207], 0
s_waitcnt lgkmcnt(4)
s_lshl_b32 s76, s26, 14
v_mfma_f32_16x16x32_bf16 v[96:99], v[48:51], v[192:195], 0
ds_read_b64_tr_b16 v[40:41], v14 offset:0
ds_read_b64_tr_b16 v[42:43], v14 offset:1024
v_mfma_f32_16x16x32_bf16 v[100:103], v[48:51], v[196:199], 0
s_and_b32 s100, s24, 1
s_lshl_b32 s100, s100, 17
v_mfma_f32_16x16x32_bf16 v[104:107], v[48:51], v[200:203], 0
s_add_u32 s76, s76, s100
s_lshr_b32 s100, s24, 1
v_mfma_f32_16x16x32_bf16 v[108:111], v[48:51], v[204:207], 0
s_lshl_b32 s100, s100, 13
s_add_u32 s76, s76, s100
v_mfma_f32_16x16x32_bf16 v[112:115], v[52:55], v[192:195], 0
ds_read_b64_tr_b16 v[44:45], v15 offset:0
ds_read_b64_tr_b16 v[46:47], v15 offset:1024
v_mfma_f32_16x16x32_bf16 v[116:119], v[52:55], v[196:199], 0
s_add_u32 s97, s76, s97
s_add_u32 s76, s76, s96
v_mfma_f32_16x16x32_bf16 v[120:123], v[52:55], v[200:203], 0
v_accvgpr_read_b32 v20, a0
v_accvgpr_read_b32 v21, a1
v_mfma_f32_16x16x32_bf16 v[124:127], v[52:55], v[204:207], 0
s_waitcnt lgkmcnt(4)
v_accvgpr_read_b32 v22, a2
v_mfma_f32_16x16x32_bf16 v[128:131], v[56:59], v[192:195], 0
ds_read_b64_tr_b16 v[48:49], v8 offset:8192
ds_read_b64_tr_b16 v[50:51], v8 offset:9216
v_mfma_f32_16x16x32_bf16 v[132:135], v[56:59], v[196:199], 0
v_accvgpr_read_b32 v23, a3
v_accvgpr_read_b32 v24, a4
v_mfma_f32_16x16x32_bf16 v[136:139], v[56:59], v[200:203], 0
v_accvgpr_read_b32 v25, a5
v_accvgpr_read_b32 v26, a6
v_mfma_f32_16x16x32_bf16 v[140:143], v[56:59], v[204:207], 0
v_accvgpr_read_b32 v27, a7
v_cvt_pk_bf16_f32 v20, v20, v21
v_mfma_f32_16x16x32_bf16 v[144:147], v[60:63], v[192:195], 0
ds_read_b64_tr_b16 v[52:53], v9 offset:8192
ds_read_b64_tr_b16 v[54:55], v9 offset:9216
v_mfma_f32_16x16x32_bf16 v[148:151], v[60:63], v[196:199], 0
v_cvt_pk_bf16_f32 v21, v22, v23
v_cvt_pk_bf16_f32 v22, v24, v25
v_mfma_f32_16x16x32_bf16 v[152:155], v[60:63], v[200:203], 0
v_cvt_pk_bf16_f32 v23, v26, v27
v_mfma_f32_16x16x32_bf16 v[156:159], v[60:63], v[204:207], 0
s_waitcnt lgkmcnt(4)
v_mfma_f32_16x16x32_bf16 v[160:163], v[40:43], v[192:195], 0
ds_read_b64_tr_b16 v[56:57], v10 offset:8192
ds_read_b64_tr_b16 v[58:59], v10 offset:9216
v_mfma_f32_16x16x32_bf16 v[164:167], v[40:43], v[196:199], 0
buffer_store_dwordx4 v[20:23], v7, s[12:15], s76 offen offset:0
v_mfma_f32_16x16x32_bf16 v[168:171], v[40:43], v[200:203], 0
buffer_store_dwordx4 v[20:23], v7, s[12:15], s97 offen offset:0 sc1
v_mfma_f32_16x16x32_bf16 v[172:175], v[40:43], v[204:207], 0
v_accvgpr_read_b32 v28, a8
v_accvgpr_read_b32 v29, a9
v_mfma_f32_16x16x32_bf16 v[176:179], v[44:47], v[192:195], 0
ds_read_b64_tr_b16 v[60:61], v11 offset:8192
ds_read_b64_tr_b16 v[62:63], v11 offset:9216
v_mfma_f32_16x16x32_bf16 v[180:183], v[44:47], v[196:199], 0
v_accvgpr_read_b32 v30, a10
v_accvgpr_read_b32 v31, a11
v_mfma_f32_16x16x32_bf16 v[184:187], v[44:47], v[200:203], 0
v_accvgpr_read_b32 v32, a12
v_accvgpr_read_b32 v33, a13
v_accvgpr_read_b32 v34, a14
v_accvgpr_read_b32 v35, a15
v_cvt_pk_bf16_f32 v28, v28, v29
v_cvt_pk_bf16_f32 v29, v30, v31
v_cvt_pk_bf16_f32 v30, v32, v33
v_cvt_pk_bf16_f32 v31, v34, v35
buffer_store_dwordx4 v[28:31], v7, s[12:15], s76 offen offset:256
buffer_store_dwordx4 v[28:31], v7, s[12:15], s97 offen offset:256 sc1
v_accvgpr_read_b32 v20, a16
v_accvgpr_read_b32 v21, a17
v_accvgpr_read_b32 v22, a18
v_accvgpr_read_b32 v23, a19
v_accvgpr_read_b32 v24, a20
v_accvgpr_read_b32 v25, a21
v_accvgpr_read_b32 v26, a22
v_accvgpr_read_b32 v27, a23
v_cvt_pk_bf16_f32 v20, v20, v21
v_cvt_pk_bf16_f32 v21, v22, v23
v_cvt_pk_bf16_f32 v22, v24, v25
v_cvt_pk_bf16_f32 v23, v26, v27
buffer_store_dwordx4 v[20:23], v7, s[12:15], s76 offen offset:2048
buffer_store_dwordx4 v[20:23], v7, s[12:15], s97 offen offset:2048 sc1
v_mfma_f32_16x16x32_bf16 v[188:191], v[44:47], v[204:207], 0
s_waitcnt lgkmcnt(4)
s_waitcnt vmcnt(30)
v_mfma_f32_16x16x32_bf16 v[64:67], v[48:51], v[208:211], v[64:67]
ds_read_b64_tr_b16 v[40:41], v12 offset:8192
ds_read_b64_tr_b16 v[42:43], v12 offset:9216
v_mfma_f32_16x16x32_bf16 v[68:71], v[48:51], v[212:215], v[68:71]
v_accvgpr_read_b32 v28, a24
v_accvgpr_read_b32 v29, a25
v_mfma_f32_16x16x32_bf16 v[72:75], v[48:51], v[216:219], v[72:75]
v_accvgpr_read_b32 v30, a26
v_accvgpr_read_b32 v31, a27
v_mfma_f32_16x16x32_bf16 v[76:79], v[48:51], v[220:223], v[76:79]
v_accvgpr_read_b32 v32, a28
v_accvgpr_read_b32 v33, a29
v_mfma_f32_16x16x32_bf16 v[80:83], v[52:55], v[208:211], v[80:83]
ds_read_b64_tr_b16 v[44:45], v13 offset:8192
ds_read_b64_tr_b16 v[46:47], v13 offset:9216
v_mfma_f32_16x16x32_bf16 v[84:87], v[52:55], v[212:215], v[84:87]
v_accvgpr_read_b32 v34, a30
v_accvgpr_read_b32 v35, a31
v_mfma_f32_16x16x32_bf16 v[88:91], v[52:55], v[216:219], v[88:91]
v_cvt_pk_bf16_f32 v28, v28, v29
v_cvt_pk_bf16_f32 v29, v30, v31
v_mfma_f32_16x16x32_bf16 v[92:95], v[52:55], v[220:223], v[92:95]
s_waitcnt lgkmcnt(4)
v_cvt_pk_bf16_f32 v30, v32, v33
v_mfma_f32_16x16x32_bf16 v[96:99], v[56:59], v[208:211], v[96:99]
ds_read_b64_tr_b16 v[48:49], v14 offset:8192
ds_read_b64_tr_b16 v[50:51], v14 offset:9216
v_mfma_f32_16x16x32_bf16 v[100:103], v[56:59], v[212:215], v[100:103]
v_cvt_pk_bf16_f32 v31, v34, v35
v_mfma_f32_16x16x32_bf16 v[104:107], v[56:59], v[216:219], v[104:107]
buffer_store_dwordx4 v[28:31], v7, s[12:15], s76 offen offset:2304
v_mfma_f32_16x16x32_bf16 v[108:111], v[56:59], v[220:223], v[108:111]
buffer_store_dwordx4 v[28:31], v7, s[12:15], s97 offen offset:2304 sc1
v_mfma_f32_16x16x32_bf16 v[112:115], v[60:63], v[208:211], v[112:115]
ds_read_b64_tr_b16 v[52:53], v15 offset:8192
ds_read_b64_tr_b16 v[54:55], v15 offset:9216
v_mfma_f32_16x16x32_bf16 v[116:119], v[60:63], v[212:215], v[116:119]
s_add_u32 s76, s76, 4096
s_add_u32 s97, s97, 4096
v_mfma_f32_16x16x32_bf16 v[120:123], v[60:63], v[216:219], v[120:123]
v_accvgpr_read_b32 v20, a32
v_accvgpr_read_b32 v21, a33
v_mfma_f32_16x16x32_bf16 v[124:127], v[60:63], v[220:223], v[124:127]
s_waitcnt lgkmcnt(4)
v_accvgpr_read_b32 v22, a34
v_mfma_f32_16x16x32_bf16 v[128:131], v[40:43], v[208:211], v[128:131]
ds_read_b64_tr_b16 v[56:57], v8 offset:16384
ds_read_b64_tr_b16 v[58:59], v8 offset:17408
v_mfma_f32_16x16x32_bf16 v[132:135], v[40:43], v[212:215], v[132:135]
v_accvgpr_read_b32 v23, a35
v_accvgpr_read_b32 v24, a36
v_mfma_f32_16x16x32_bf16 v[136:139], v[40:43], v[216:219], v[136:139]
v_accvgpr_read_b32 v25, a37
v_accvgpr_read_b32 v26, a38
v_mfma_f32_16x16x32_bf16 v[140:143], v[40:43], v[220:223], v[140:143]
v_accvgpr_read_b32 v27, a39
v_cvt_pk_bf16_f32 v20, v20, v21
v_mfma_f32_16x16x32_bf16 v[144:147], v[44:47], v[208:211], v[144:147]
ds_read_b64_tr_b16 v[60:61], v9 offset:16384
ds_read_b64_tr_b16 v[62:63], v9 offset:17408
v_mfma_f32_16x16x32_bf16 v[148:151], v[44:47], v[212:215], v[148:151]
v_cvt_pk_bf16_f32 v21, v22, v23
v_cvt_pk_bf16_f32 v22, v24, v25
v_mfma_f32_16x16x32_bf16 v[152:155], v[44:47], v[216:219], v[152:155]
v_cvt_pk_bf16_f32 v23, v26, v27
v_mfma_f32_16x16x32_bf16 v[156:159], v[44:47], v[220:223], v[156:159]
s_waitcnt lgkmcnt(4)
v_mfma_f32_16x16x32_bf16 v[160:163], v[48:51], v[208:211], v[160:163]
ds_read_b64_tr_b16 v[40:41], v10 offset:16384
ds_read_b64_tr_b16 v[42:43], v10 offset:17408
v_mfma_f32_16x16x32_bf16 v[164:167], v[48:51], v[212:215], v[164:167]
buffer_store_dwordx4 v[20:23], v7, s[12:15], s76 offen offset:0
v_mfma_f32_16x16x32_bf16 v[168:171], v[48:51], v[216:219], v[168:171]
buffer_store_dwordx4 v[20:23], v7, s[12:15], s97 offen offset:0 sc1
v_mfma_f32_16x16x32_bf16 v[172:175], v[48:51], v[220:223], v[172:175]
v_accvgpr_read_b32 v28, a40
v_accvgpr_read_b32 v29, a41
v_mfma_f32_16x16x32_bf16 v[176:179], v[52:55], v[208:211], v[176:179]
ds_read_b64_tr_b16 v[44:45], v11 offset:16384
ds_read_b64_tr_b16 v[46:47], v11 offset:17408
v_mfma_f32_16x16x32_bf16 v[180:183], v[52:55], v[212:215], v[180:183]
v_accvgpr_read_b32 v30, a42
v_accvgpr_read_b32 v31, a43
v_mfma_f32_16x16x32_bf16 v[184:187], v[52:55], v[216:219], v[184:187]
v_accvgpr_read_b32 v32, a44
v_accvgpr_read_b32 v33, a45
tp0_p7:
s_cbranch_execz tp0_ret
v_accvgpr_read_b32 v34, a46
v_accvgpr_read_b32 v35, a47
v_cvt_pk_bf16_f32 v28, v28, v29
v_cvt_pk_bf16_f32 v29, v30, v31
v_cvt_pk_bf16_f32 v30, v32, v33
v_cvt_pk_bf16_f32 v31, v34, v35
buffer_store_dwordx4 v[28:31], v7, s[12:15], s76 offen offset:256
buffer_store_dwordx4 v[28:31], v7, s[12:15], s97 offen offset:256 sc1
buffer_load_dwordx4 a[0:3], v16, s[16:19], s77 offen offset:0 sc1
buffer_load_dwordx4 a[4:7], v17, s[16:19], s77 offen offset:0 sc1
buffer_load_dwordx4 a[8:11], v18, s[16:19], s77 offen offset:0 sc1
buffer_load_dwordx4 a[12:15], v19, s[16:19], s77 offen offset:0 sc1
v_mfma_f32_16x16x32_bf16 v[188:191], v[52:55], v[220:223], v[188:191]
s_waitcnt lgkmcnt(4)
s_waitcnt vmcnt(32)
v_mfma_f32_16x16x32_bf16 v[64:67], v[56:59], v[224:227], v[64:67]
ds_read_b64_tr_b16 v[48:49], v12 offset:16384
ds_read_b64_tr_b16 v[50:51], v12 offset:17408
v_mfma_f32_16x16x32_bf16 v[68:71], v[56:59], v[228:231], v[68:71]
v_accvgpr_read_b32 v20, a48
v_accvgpr_read_b32 v21, a49
v_mfma_f32_16x16x32_bf16 v[72:75], v[56:59], v[232:235], v[72:75]
v_accvgpr_read_b32 v22, a50
v_accvgpr_read_b32 v23, a51
v_mfma_f32_16x16x32_bf16 v[76:79], v[56:59], v[236:239], v[76:79]
v_accvgpr_read_b32 v24, a52
v_accvgpr_read_b32 v25, a53
v_mfma_f32_16x16x32_bf16 v[80:83], v[60:63], v[224:227], v[80:83]
ds_read_b64_tr_b16 v[52:53], v13 offset:16384
ds_read_b64_tr_b16 v[54:55], v13 offset:17408
v_mfma_f32_16x16x32_bf16 v[84:87], v[60:63], v[228:231], v[84:87]
v_accvgpr_read_b32 v26, a54
v_accvgpr_read_b32 v27, a55
v_mfma_f32_16x16x32_bf16 v[88:91], v[60:63], v[232:235], v[88:91]
v_cvt_pk_bf16_f32 v20, v20, v21
v_cvt_pk_bf16_f32 v21, v22, v23
v_mfma_f32_16x16x32_bf16 v[92:95], v[60:63], v[236:239], v[92:95]
s_waitcnt lgkmcnt(4)
v_cvt_pk_bf16_f32 v22, v24, v25
v_mfma_f32_16x16x32_bf16 v[96:99], v[40:43], v[224:227], v[96:99]
ds_read_b64_tr_b16 v[56:57], v14 offset:16384
ds_read_b64_tr_b16 v[58:59], v14 offset:17408
v_mfma_f32_16x16x32_bf16 v[100:103], v[40:43], v[228:231], v[100:103]
v_cvt_pk_bf16_f32 v23, v26, v27
v_mfma_f32_16x16x32_bf16 v[104:107], v[40:43], v[232:235], v[104:107]
buffer_store_dwordx4 v[20:23], v7, s[12:15], s76 offen offset:2048
v_mfma_f32_16x16x32_bf16 v[108:111], v[40:43], v[236:239], v[108:111]
buffer_store_dwordx4 v[20:23], v7, s[12:15], s97 offen offset:2048 sc1
v_mfma_f32_16x16x32_bf16 v[112:115], v[44:47], v[224:227], v[112:115]
ds_read_b64_tr_b16 v[60:61], v15 offset:16384
ds_read_b64_tr_b16 v[62:63], v15 offset:17408
v_mfma_f32_16x16x32_bf16 v[116:119], v[44:47], v[228:231], v[116:119]
v_accvgpr_read_b32 v28, a56
v_accvgpr_read_b32 v29, a57
v_mfma_f32_16x16x32_bf16 v[120:123], v[44:47], v[232:235], v[120:123]
v_accvgpr_read_b32 v30, a58
v_accvgpr_read_b32 v31, a59
v_mfma_f32_16x16x32_bf16 v[124:127], v[44:47], v[236:239], v[124:127]
s_waitcnt lgkmcnt(4)
v_accvgpr_read_b32 v32, a60
v_mfma_f32_16x16x32_bf16 v[128:131], v[48:51], v[224:227], v[128:131]
ds_read_b64_tr_b16 v[40:41], v8 offset:24576
ds_read_b64_tr_b16 v[42:43], v8 offset:25600
v_mfma_f32_16x16x32_bf16 v[132:135], v[48:51], v[228:231], v[132:135]
v_accvgpr_read_b32 v33, a61
v_accvgpr_read_b32 v34, a62
v_mfma_f32_16x16x32_bf16 v[136:139], v[48:51], v[232:235], v[136:139]
v_accvgpr_read_b32 v35, a63
v_cvt_pk_bf16_f32 v28, v28, v29
v_mfma_f32_16x16x32_bf16 v[140:143], v[48:51], v[236:239], v[140:143]
v_cvt_pk_bf16_f32 v29, v30, v31
v_cvt_pk_bf16_f32 v30, v32, v33
v_mfma_f32_16x16x32_bf16 v[144:147], v[52:55], v[224:227], v[144:147]
ds_read_b64_tr_b16 v[44:45], v9 offset:24576
ds_read_b64_tr_b16 v[46:47], v9 offset:25600
v_mfma_f32_16x16x32_bf16 v[148:151], v[52:55], v[228:231], v[148:151]
v_cvt_pk_bf16_f32 v31, v34, v35
v_mfma_f32_16x16x32_bf16 v[152:155], v[52:55], v[232:235], v[152:155]
buffer_store_dwordx4 v[28:31], v7, s[12:15], s76 offen offset:2304
v_mfma_f32_16x16x32_bf16 v[156:159], v[52:55], v[236:239], v[156:159]
s_waitcnt lgkmcnt(4)
v_mfma_f32_16x16x32_bf16 v[160:163], v[56:59], v[224:227], v[160:163]
ds_read_b64_tr_b16 v[48:49], v10 offset:24576
ds_read_b64_tr_b16 v[50:51], v10 offset:25600
v_mfma_f32_16x16x32_bf16 v[164:167], v[56:59], v[228:231], v[164:167]
buffer_store_dwordx4 v[28:31], v7, s[12:15], s97 offen offset:2304 sc1
v_mfma_f32_16x16x32_bf16 v[168:171], v[56:59], v[232:235], v[168:171]
buffer_load_dwordx4 a[16:19], v16, s[16:19], s77 offen offset:1024 sc1
v_mfma_f32_16x16x32_bf16 v[172:175], v[56:59], v[236:239], v[172:175]
buffer_load_dwordx4 a[20:23], v17, s[16:19], s77 offen offset:1024 sc1
v_mfma_f32_16x16x32_bf16 v[176:179], v[60:63], v[224:227], v[176:179]
ds_read_b64_tr_b16 v[52:53], v11 offset:24576
ds_read_b64_tr_b16 v[54:55], v11 offset:25600
v_mfma_f32_16x16x32_bf16 v[180:183], v[60:63], v[228:231], v[180:183]
buffer_load_dwordx4 a[24:27], v18, s[16:19], s77 offen offset:1024 sc1
v_mfma_f32_16x16x32_bf16 v[184:187], v[60:63], v[232:235], v[184:187]
buffer_load_dwordx4 a[28:31], v19, s[16:19], s77 offen offset:1024 sc1
buffer_load_dwordx4 v[192:195], v16, s[16:19], s77 offen offset:2048 sc1
buffer_load_dwordx4 v[196:199], v17, s[16:19], s77 offen offset:2048 sc1
buffer_load_dwordx4 v[200:203], v18, s[16:19], s77 offen offset:2048 sc1
buffer_load_dwordx4 v[204:207], v19, s[16:19], s77 offen offset:2048 sc1
v_mfma_f32_16x16x32_bf16 v[188:191], v[60:63], v[236:239], v[188:191]
s_waitcnt lgkmcnt(4)
s_waitcnt vmcnt(36)
s_barrier
v_mfma_f32_16x16x32_bf16 v[64:67], v[40:43], v[240:243], v[64:67]
ds_read_b64_tr_b16 v[56:57], v12 offset:24576
ds_read_b64_tr_b16 v[58:59], v12 offset:25600
v_mfma_f32_16x16x32_bf16 v[68:71], v[40:43], v[244:247], v[68:71]
s_add_u32 s76, s76, 258048
s_add_u32 s97, s97, 258048
v_mfma_f32_16x16x32_bf16 v[72:75], v[40:43], v[248:251], v[72:75]
v_accvgpr_read_b32 v20, a64
v_accvgpr_read_b32 v21, a65
v_mfma_f32_16x16x32_bf16 v[76:79], v[40:43], v[252:255], v[76:79]
v_accvgpr_read_b32 v22, a66
v_accvgpr_read_b32 v23, a67
v_mfma_f32_16x16x32_bf16 v[80:83], v[44:47], v[240:243], v[80:83]
ds_read_b64_tr_b16 v[60:61], v13 offset:24576
ds_read_b64_tr_b16 v[62:63], v13 offset:25600
v_mfma_f32_16x16x32_bf16 v[84:87], v[44:47], v[244:247], v[84:87]
v_accvgpr_read_b32 v24, a68
v_accvgpr_read_b32 v25, a69
v_mfma_f32_16x16x32_bf16 v[88:91], v[44:47], v[248:251], v[88:91]
v_accvgpr_read_b32 v26, a70
v_accvgpr_read_b32 v27, a71
v_mfma_f32_16x16x32_bf16 v[92:95], v[44:47], v[252:255], v[92:95]
s_waitcnt lgkmcnt(4)
v_cvt_pk_bf16_f32 v20, v20, v21
v_mfma_f32_16x16x32_bf16 v[96:99], v[48:51], v[240:243], v[96:99]
ds_read_b64_tr_b16 v[40:41], v14 offset:24576
ds_read_b64_tr_b16 v[42:43], v14 offset:25600
v_mfma_f32_16x16x32_bf16 v[100:103], v[48:51], v[244:247], v[100:103]
v_cvt_pk_bf16_f32 v21, v22, v23
v_cvt_pk_bf16_f32 v22, v24, v25
v_mfma_f32_16x16x32_bf16 v[104:107], v[48:51], v[248:251], v[104:107]
v_cvt_pk_bf16_f32 v23, v26, v27
v_mfma_f32_16x16x32_bf16 v[108:111], v[48:51], v[252:255], v[108:111]
buffer_store_dwordx4 v[20:23], v7, s[12:15], s76 offen offset:0
v_mfma_f32_16x16x32_bf16 v[112:115], v[52:55], v[240:243], v[112:115]
ds_read_b64_tr_b16 v[44:45], v15 offset:24576
ds_read_b64_tr_b16 v[46:47], v15 offset:25600
v_mfma_f32_16x16x32_bf16 v[116:119], v[52:55], v[244:247], v[116:119]
buffer_store_dwordx4 v[20:23], v7, s[12:15], s97 offen offset:0 sc1
v_mfma_f32_16x16x32_bf16 v[120:123], v[52:55], v[248:251], v[120:123]
v_accvgpr_read_b32 v28, a72
v_accvgpr_read_b32 v29, a73
v_mfma_f32_16x16x32_bf16 v[124:127], v[52:55], v[252:255], v[124:127]
s_waitcnt lgkmcnt(4)
v_accvgpr_read_b32 v30, a74
v_mfma_f32_16x16x32_bf16 v[128:131], v[56:59], v[240:243], v[128:131]
ds_read_b64_tr_b16 v[48:49], v8 offset:32768
ds_read_b64_tr_b16 v[50:51], v8 offset:33792
v_mfma_f32_16x16x32_bf16 v[132:135], v[56:59], v[244:247], v[132:135]
v_accvgpr_read_b32 v31, a75
v_accvgpr_read_b32 v32, a76
v_mfma_f32_16x16x32_bf16 v[136:139], v[56:59], v[248:251], v[136:139]
v_accvgpr_read_b32 v33, a77
v_accvgpr_read_b32 v34, a78
v_mfma_f32_16x16x32_bf16 v[140:143], v[56:59], v[252:255], v[140:143]
v_accvgpr_read_b32 v35, a79
v_cvt_pk_bf16_f32 v28, v28, v29
v_mfma_f32_16x16x32_bf16 v[144:147], v[60:63], v[240:243], v[144:147]
ds_read_b64_tr_b16 v[52:53], v9 offset:32768
ds_read_b64_tr_b16 v[54:55], v9 offset:33792
v_mfma_f32_16x16x32_bf16 v[148:151], v[60:63], v[244:247], v[148:151]
v_cvt_pk_bf16_f32 v29, v30, v31
v_cvt_pk_bf16_f32 v30, v32, v33
v_mfma_f32_16x16x32_bf16 v[152:155], v[60:63], v[248:251], v[152:155]
v_cvt_pk_bf16_f32 v31, v34, v35
v_mfma_f32_16x16x32_bf16 v[156:159], v[60:63], v[252:255], v[156:159]
s_waitcnt lgkmcnt(4)
v_mfma_f32_16x16x32_bf16 v[160:163], v[40:43], v[240:243], v[160:163]
ds_read_b64_tr_b16 v[56:57], v10 offset:32768
ds_read_b64_tr_b16 v[58:59], v10 offset:33792
v_mfma_f32_16x16x32_bf16 v[164:167], v[40:43], v[244:247], v[164:167]
buffer_store_dwordx4 v[28:31], v7, s[12:15], s76 offen offset:256
v_mfma_f32_16x16x32_bf16 v[168:171], v[40:43], v[248:251], v[168:171]
buffer_store_dwordx4 v[28:31], v7, s[12:15], s97 offen offset:256 sc1
v_mfma_f32_16x16x32_bf16 v[172:175], v[40:43], v[252:255], v[172:175]
buffer_load_dwordx4 v[208:211], v16, s[16:19], s77 offen offset:3072 sc1
v_mfma_f32_16x16x32_bf16 v[176:179], v[44:47], v[240:243], v[176:179]
ds_read_b64_tr_b16 v[60:61], v11 offset:32768
ds_read_b64_tr_b16 v[62:63], v11 offset:33792
v_mfma_f32_16x16x32_bf16 v[180:183], v[44:47], v[244:247], v[180:183]
buffer_load_dwordx4 v[212:215], v17, s[16:19], s77 offen offset:3072 sc1
v_mfma_f32_16x16x32_bf16 v[184:187], v[44:47], v[248:251], v[184:187]
buffer_load_dwordx4 v[216:219], v18, s[16:19], s77 offen offset:3072 sc1
buffer_load_dwordx4 v[220:223], v19, s[16:19], s77 offen offset:3072 sc1
s_add_u32 s77, s77, 4096
buffer_load_dwordx4 v[224:227], v16, s[16:19], s77 offen offset:0 sc1
buffer_load_dwordx4 v[228:231], v17, s[16:19], s77 offen offset:0 sc1
buffer_load_dwordx4 v[232:235], v18, s[16:19], s77 offen offset:0 sc1
buffer_load_dwordx4 v[236:239], v19, s[16:19], s77 offen offset:0 sc1
v_mfma_f32_16x16x32_bf16 v[188:191], v[44:47], v[252:255], v[188:191]
s_waitcnt lgkmcnt(4)
s_waitcnt vmcnt(24)
v_mfma_f32_16x16x32_bf16 v[64:67], v[48:51], a[0:3], v[64:67]
ds_read_b64_tr_b16 v[40:41], v12 offset:32768
ds_read_b64_tr_b16 v[42:43], v12 offset:33792
v_mfma_f32_16x16x32_bf16 v[68:71], v[48:51], a[4:7], v[68:71]
s_mov_b32 s4, s12
s_mov_b32 s5, s13
v_mfma_f32_16x16x32_bf16 v[72:75], v[48:51], a[8:11], v[72:75]
s_lshl_b32 s100, s26, 2
s_sub_u32 s100, 64, s100
v_mfma_f32_16x16x32_bf16 v[76:79], v[48:51], a[12:15], v[76:79]
s_lshl_b32 s6, s100, 14
s_mov_b32 s7, 0x20000
v_mfma_f32_16x16x32_bf16 v[80:83], v[52:55], a[0:3], v[80:83]
ds_read_b64_tr_b16 v[44:45], v13 offset:32768
ds_read_b64_tr_b16 v[46:47], v13 offset:33792
v_mfma_f32_16x16x32_bf16 v[84:87], v[52:55], a[4:7], v[84:87]
s_mov_b32 s29, 0
v_add_u32 v38, s58, v3
v_mfma_f32_16x16x32_bf16 v[88:91], v[52:55], a[8:11], v[88:91]
s_mov_b32 s60, s64
s_mov_b32 s61, s65
v_mfma_f32_16x16x32_bf16 v[92:95], v[52:55], a[12:15], v[92:95]
s_waitcnt lgkmcnt(4)
s_mov_b32 s62, s66
v_mfma_f32_16x16x32_bf16 v[96:99], v[56:59], a[0:3], v[96:99]
ds_read_b64_tr_b16 v[48:49], v14 offset:32768
ds_read_b64_tr_b16 v[50:51], v14 offset:33792
v_mfma_f32_16x16x32_bf16 v[100:103], v[56:59], a[4:7], v[100:103]
s_mov_b32 s63, s67
s_lshl_b32 s36, s25, 10
v_mfma_f32_16x16x32_bf16 v[104:107], v[56:59], a[8:11], v[104:107]
s_mov_b32 s37, 0
v_accvgpr_read_b32 v20, a80
v_mfma_f32_16x16x32_bf16 v[108:111], v[56:59], a[12:15], v[108:111]
v_accvgpr_read_b32 v21, a81
v_accvgpr_read_b32 v22, a82
v_mfma_f32_16x16x32_bf16 v[112:115], v[60:63], a[0:3], v[112:115]
ds_read_b64_tr_b16 v[52:53], v15 offset:32768
ds_read_b64_tr_b16 v[54:55], v15 offset:33792
v_mfma_f32_16x16x32_bf16 v[116:119], v[60:63], a[4:7], v[116:119]
v_accvgpr_read_b32 v23, a83
v_accvgpr_read_b32 v24, a84
v_mfma_f32_16x16x32_bf16 v[120:123], v[60:63], a[8:11], v[120:123]
v_accvgpr_read_b32 v25, a85
v_accvgpr_read_b32 v26, a86
v_mfma_f32_16x16x32_bf16 v[124:127], v[60:63], a[12:15], v[124:127]
s_waitcnt lgkmcnt(4)
v_accvgpr_read_b32 v27, a87
v_mfma_f32_16x16x32_bf16 v[128:131], v[40:43], a[0:3], v[128:131]
ds_read_b64_tr_b16 v[56:57], v8 offset:40960
ds_read_b64_tr_b16 v[58:59], v8 offset:41984
v_mfma_f32_16x16x32_bf16 v[132:135], v[40:43], a[4:7], v[132:135]
v_cvt_pk_bf16_f32 v20, v20, v21
v_cvt_pk_bf16_f32 v21, v22, v23
v_mfma_f32_16x16x32_bf16 v[136:139], v[40:43], a[8:11], v[136:139]
v_cvt_pk_bf16_f32 v22, v24, v25
v_cvt_pk_bf16_f32 v23, v26, v27
v_mfma_f32_16x16x32_bf16 v[140:143], v[40:43], a[12:15], v[140:143]
buffer_store_dwordx4 v[20:23], v7, s[12:15], s76 offen offset:2048
v_mfma_f32_16x16x32_bf16 v[144:147], v[44:47], a[0:3], v[144:147]
ds_read_b64_tr_b16 v[60:61], v9 offset:40960
ds_read_b64_tr_b16 v[62:63], v9 offset:41984
v_mfma_f32_16x16x32_bf16 v[148:151], v[44:47], a[4:7], v[148:151]
buffer_store_dwordx4 v[20:23], v7, s[12:15], s97 offen offset:2048 sc1
v_mfma_f32_16x16x32_bf16 v[152:155], v[44:47], a[8:11], v[152:155]
v_accvgpr_read_b32 v28, a88
v_accvgpr_read_b32 v29, a89
v_mfma_f32_16x16x32_bf16 v[156:159], v[44:47], a[12:15], v[156:159]
s_waitcnt lgkmcnt(4)
v_accvgpr_read_b32 v30, a90
v_mfma_f32_16x16x32_bf16 v[160:163], v[48:51], a[0:3], v[160:163]
ds_read_b64_tr_b16 v[40:41], v10 offset:40960
ds_read_b64_tr_b16 v[42:43], v10 offset:41984
v_mfma_f32_16x16x32_bf16 v[164:167], v[48:51], a[4:7], v[164:167]
v_accvgpr_read_b32 v31, a91
v_accvgpr_read_b32 v32, a92
v_mfma_f32_16x16x32_bf16 v[168:171], v[48:51], a[8:11], v[168:171]
v_accvgpr_read_b32 v33, a93
v_accvgpr_read_b32 v34, a94
v_mfma_f32_16x16x32_bf16 v[172:175], v[48:51], a[12:15], v[172:175]
v_accvgpr_read_b32 v35, a95
v_cvt_pk_bf16_f32 v28, v28, v29
v_mfma_f32_16x16x32_bf16 v[176:179], v[52:55], a[0:3], v[176:179]
ds_read_b64_tr_b16 v[44:45], v11 offset:40960
ds_read_b64_tr_b16 v[46:47], v11 offset:41984
v_mfma_f32_16x16x32_bf16 v[180:183], v[52:55], a[4:7], v[180:183]
v_cvt_pk_bf16_f32 v29, v30, v31
v_cvt_pk_bf16_f32 v30, v32, v33
v_mfma_f32_16x16x32_bf16 v[184:187], v[52:55], a[8:11], v[184:187]
v_cvt_pk_bf16_f32 v31, v34, v35
buffer_store_dwordx4 v[28:31], v7, s[12:15], s76 offen offset:2304
buffer_store_dwordx4 v[28:31], v7, s[12:15], s97 offen offset:2304 sc1
buffer_load_dwordx4 v[240:243], v16, s[16:19], s77 offen offset:1024 sc1
buffer_load_dwordx4 v[244:247], v17, s[16:19], s77 offen offset:1024 sc1
buffer_load_dwordx4 v[248:251], v18, s[16:19], s77 offen offset:1024 sc1
buffer_load_dwordx4 v[252:255], v19, s[16:19], s77 offen offset:1024 sc1
v_mfma_f32_16x16x32_bf16 v[188:191], v[52:55], a[12:15], v[188:191]
s_waitcnt lgkmcnt(4)
s_waitcnt vmcnt(24)
v_mfma_f32_16x16x32_bf16 v[64:67], v[56:59], a[16:19], v[64:67]
ds_read_b64_tr_b16 v[48:49], v12 offset:40960
ds_read_b64_tr_b16 v[50:51], v12 offset:41984
v_mfma_f32_16x16x32_bf16 v[68:71], v[56:59], a[20:23], v[68:71]
s_cmp_eq_u32 s24, 1
s_cselect_b32 s50, s52, s50
v_mfma_f32_16x16x32_bf16 v[72:75], v[56:59], a[24:27], v[72:75]
s_cselect_b32 s51, s53, s51
s_cmp_eq_u32 s24, 2
v_mfma_f32_16x16x32_bf16 v[76:79], v[56:59], a[28:31], v[76:79]
s_cselect_b32 s50, s54, s50
s_cselect_b32 s51, s55, s51
v_mfma_f32_16x16x32_bf16 v[80:83], v[60:63], a[16:19], v[80:83]
ds_read_b64_tr_b16 v[52:53], v13 offset:40960
ds_read_b64_tr_b16 v[54:55], v13 offset:41984
v_mfma_f32_16x16x32_bf16 v[84:87], v[60:63], a[20:23], v[84:87]
s_cmp_eq_u32 s24, 3
s_cselect_b32 s50, s56, s50
v_mfma_f32_16x16x32_bf16 v[88:91], v[60:63], a[24:27], v[88:91]
s_cselect_b32 s51, s57, s51
s_mov_b32 s10, 165888
v_mfma_f32_16x16x32_bf16 v[92:95], v[60:63], a[28:31], v[92:95]
s_waitcnt lgkmcnt(4)
s_cmp_eq_u32 s24, 0
v_mfma_f32_16x16x32_bf16 v[96:99], v[40:43], a[16:19], v[96:99]
ds_read_b64_tr_b16 v[56:57], v14 offset:40960
ds_read_b64_tr_b16 v[58:59], v14 offset:41984
v_mfma_f32_16x16x32_bf16 v[100:103], v[40:43], a[20:23], v[100:103]
s_cselect_b32 s10, 147456, s10
s_mul_i32 s100, s25, s10
v_mfma_f32_16x16x32_bf16 v[104:107], v[40:43], a[24:27], v[104:107]
s_add_u32 s8, s50, s100
s_addc_u32 s9, s51, 0
v_mfma_f32_16x16x32_bf16 v[108:111], v[40:43], a[28:31], v[108:111]
s_mov_b32 s11, 0x20000
s_mul_i32 s54, s26, s26
v_mfma_f32_16x16x32_bf16 v[112:115], v[44:47], a[16:19], v[112:115]
ds_read_b64_tr_b16 v[60:61], v15 offset:40960
ds_read_b64_tr_b16 v[62:63], v15 offset:41984
v_mfma_f32_16x16x32_bf16 v[116:119], v[44:47], a[20:23], v[116:119]
s_sub_u32 s54, s54, s26
s_lshl_b32 s54, s54, 1
v_mfma_f32_16x16x32_bf16 v[120:123], v[44:47], a[24:27], v[120:123]
s_sub_u32 s54, s54, 12
s_sub_u32 s55, s24, 9
v_mfma_f32_16x16x32_bf16 v[124:127], v[44:47], a[28:31], v[124:127]
s_waitcnt lgkmcnt(4)
s_sub_u32 s56, s26, 3
v_mfma_f32_16x16x32_bf16 v[128:131], v[48:51], a[16:19], v[128:131]
ds_read_b64_tr_b16 v[40:41], v8 offset:49152
ds_read_b64_tr_b16 v[42:43], v8 offset:50176
v_mfma_f32_16x16x32_bf16 v[132:135], v[48:51], a[20:23], v[132:135]
s_mul_i32 s55, s55, s56
s_add_u32 s54, s54, s55
v_mfma_f32_16x16x32_bf16 v[136:139], v[48:51], a[24:27], v[136:139]
s_mul_i32 s54, s54, 2816
s_cmp_lt_u32 s26, 3
v_mfma_f32_16x16x32_bf16 v[140:143], v[48:51], a[28:31], v[140:143]
s_cselect_b32 s54, 0x40000000, s54
s_add_u32 s76, s76, 4096
v_mfma_f32_16x16x32_bf16 v[144:147], v[52:55], a[16:19], v[144:147]
ds_read_b64_tr_b16 v[44:45], v9 offset:49152
ds_read_b64_tr_b16 v[46:47], v9 offset:50176
v_mfma_f32_16x16x32_bf16 v[148:151], v[52:55], a[20:23], v[148:151]
s_add_u32 s97, s97, 4096
v_accvgpr_read_b32 v20, a96
v_mfma_f32_16x16x32_bf16 v[152:155], v[52:55], a[24:27], v[152:155]
v_accvgpr_read_b32 v21, a97
v_accvgpr_read_b32 v22, a98
v_mfma_f32_16x16x32_bf16 v[156:159], v[52:55], a[28:31], v[156:159]
s_waitcnt lgkmcnt(4)
v_accvgpr_read_b32 v23, a99
v_mfma_f32_16x16x32_bf16 v[160:163], v[56:59], a[16:19], v[160:163]
ds_read_b64_tr_b16 v[48:49], v10 offset:49152
ds_read_b64_tr_b16 v[50:51], v10 offset:50176
v_mfma_f32_16x16x32_bf16 v[164:167], v[56:59], a[20:23], v[164:167]
v_accvgpr_read_b32 v24, a100
v_accvgpr_read_b32 v25, a101
v_mfma_f32_16x16x32_bf16 v[168:171], v[56:59], a[24:27], v[168:171]
v_accvgpr_read_b32 v26, a102
v_accvgpr_read_b32 v27, a103
v_mfma_f32_16x16x32_bf16 v[172:175], v[56:59], a[28:31], v[172:175]
v_cvt_pk_bf16_f32 v20, v20, v21
v_cvt_pk_bf16_f32 v21, v22, v23
v_mfma_f32_16x16x32_bf16 v[176:179], v[60:63], a[16:19], v[176:179]
ds_read_b64_tr_b16 v[52:53], v11 offset:49152
ds_read_b64_tr_b16 v[54:55], v11 offset:50176
v_mfma_f32_16x16x32_bf16 v[180:183], v[60:63], a[20:23], v[180:183]
v_cvt_pk_bf16_f32 v22, v24, v25
v_cvt_pk_bf16_f32 v23, v26, v27
v_mfma_f32_16x16x32_bf16 v[184:187], v[60:63], a[24:27], v[184:187]
buffer_store_dwordx4 v[20:23], v7, s[12:15], s76 offen offset:0
buffer_store_dwordx4 v[20:23], v7, s[12:15], s97 offen offset:0 sc1
v_accvgpr_read_b32 v28, a104
v_accvgpr_read_b32 v29, a105
v_accvgpr_read_b32 v30, a106
v_accvgpr_read_b32 v31, a107
v_accvgpr_read_b32 v32, a108
v_accvgpr_read_b32 v33, a109
v_accvgpr_read_b32 v34, a110
v_accvgpr_read_b32 v35, a111
v_cvt_pk_bf16_f32 v28, v28, v29
v_cvt_pk_bf16_f32 v29, v30, v31
v_cvt_pk_bf16_f32 v30, v32, v33
v_cvt_pk_bf16_f32 v31, v34, v35
buffer_store_dwordx4 v[28:31], v7, s[12:15], s76 offen offset:256
buffer_store_dwordx4 v[28:31], v7, s[12:15], s97 offen offset:256 sc1
buffer_load_dwordx4 a[0:3], v16, s[16:19], s77 offen offset:2048 sc1
buffer_load_dwordx4 a[4:7], v17, s[16:19], s77 offen offset:2048 sc1
buffer_load_dwordx4 a[8:11], v18, s[16:19], s77 offen offset:2048 sc1
buffer_load_dwordx4 a[12:15], v19, s[16:19], s77 offen offset:2048 sc1
v_mfma_f32_16x16x32_bf16 v[188:191], v[60:63], a[28:31], v[188:191]
s_waitcnt lgkmcnt(4)
s_waitcnt vmcnt(28)
v_mfma_f32_16x16x32_bf16 v[64:67], v[40:43], v[192:195], v[64:67]
ds_read_b64_tr_b16 v[56:57], v12 offset:49152
ds_read_b64_tr_b16 v[58:59], v12 offset:50176
v_mfma_f32_16x16x32_bf16 v[68:71], v[40:43], v[196:199], v[68:71]
s_mov_b32 s48, 0x01010101
s_mov_b32 s49, 0x01010101
v_mfma_f32_16x16x32_bf16 v[72:75], v[40:43], v[200:203], v[72:75]
v_accvgpr_read_b32 v20, a112
v_accvgpr_read_b32 v21, a113
v_mfma_f32_16x16x32_bf16 v[76:79], v[40:43], v[204:207], v[76:79]
v_accvgpr_read_b32 v22, a114
v_accvgpr_read_b32 v23, a115
v_mfma_f32_16x16x32_bf16 v[80:83], v[44:47], v[192:195], v[80:83]
ds_read_b64_tr_b16 v[60:61], v13 offset:49152
ds_read_b64_tr_b16 v[62:63], v13 offset:50176
v_mfma_f32_16x16x32_bf16 v[84:87], v[44:47], v[196:199], v[84:87]
v_accvgpr_read_b32 v24, a116
v_accvgpr_read_b32 v25, a117
v_mfma_f32_16x16x32_bf16 v[88:91], v[44:47], v[200:203], v[88:91]
v_accvgpr_read_b32 v26, a118
v_accvgpr_read_b32 v27, a119
v_mfma_f32_16x16x32_bf16 v[92:95], v[44:47], v[204:207], v[92:95]
s_waitcnt lgkmcnt(4)
v_cvt_pk_bf16_f32 v20, v20, v21
v_mfma_f32_16x16x32_bf16 v[96:99], v[48:51], v[192:195], v[96:99]
ds_read_b64_tr_b16 v[40:41], v14 offset:49152
ds_read_b64_tr_b16 v[42:43], v14 offset:50176
v_mfma_f32_16x16x32_bf16 v[100:103], v[48:51], v[196:199], v[100:103]
v_cvt_pk_bf16_f32 v21, v22, v23
v_cvt_pk_bf16_f32 v22, v24, v25
v_mfma_f32_16x16x32_bf16 v[104:107], v[48:51], v[200:203], v[104:107]
v_cvt_pk_bf16_f32 v23, v26, v27
v_mfma_f32_16x16x32_bf16 v[108:111], v[48:51], v[204:207], v[108:111]
buffer_store_dwordx4 v[20:23], v7, s[12:15], s76 offen offset:2048
v_mfma_f32_16x16x32_bf16 v[112:115], v[52:55], v[192:195], v[112:115]
ds_read_b64_tr_b16 v[44:45], v15 offset:49152
ds_read_b64_tr_b16 v[46:47], v15 offset:50176
v_mfma_f32_16x16x32_bf16 v[116:119], v[52:55], v[196:199], v[116:119]
buffer_store_dwordx4 v[20:23], v7, s[12:15], s97 offen offset:2048 sc1
v_mfma_f32_16x16x32_bf16 v[120:123], v[52:55], v[200:203], v[120:123]
v_accvgpr_read_b32 v28, a120
v_accvgpr_read_b32 v29, a121
v_mfma_f32_16x16x32_bf16 v[124:127], v[52:55], v[204:207], v[124:127]
s_waitcnt lgkmcnt(4)
v_accvgpr_read_b32 v30, a122
v_mfma_f32_16x16x32_bf16 v[128:131], v[56:59], v[192:195], v[128:131]
ds_read_b64_tr_b16 v[48:49], v8 offset:57344
ds_read_b64_tr_b16 v[50:51], v8 offset:58368
v_mfma_f32_16x16x32_bf16 v[132:135], v[56:59], v[196:199], v[132:135]
v_accvgpr_read_b32 v31, a123
v_accvgpr_read_b32 v32, a124
v_mfma_f32_16x16x32_bf16 v[136:139], v[56:59], v[200:203], v[136:139]
v_accvgpr_read_b32 v33, a125
v_accvgpr_read_b32 v34, a126
v_mfma_f32_16x16x32_bf16 v[140:143], v[56:59], v[204:207], v[140:143]
v_accvgpr_read_b32 v35, a127
v_cvt_pk_bf16_f32 v28, v28, v29
v_mfma_f32_16x16x32_bf16 v[144:147], v[60:63], v[192:195], v[144:147]
ds_read_b64_tr_b16 v[52:53], v9 offset:57344
ds_read_b64_tr_b16 v[54:55], v9 offset:58368
v_mfma_f32_16x16x32_bf16 v[148:151], v[60:63], v[196:199], v[148:151]
v_cvt_pk_bf16_f32 v29, v30, v31
v_cvt_pk_bf16_f32 v30, v32, v33
v_mfma_f32_16x16x32_bf16 v[152:155], v[60:63], v[200:203], v[152:155]
v_cvt_pk_bf16_f32 v31, v34, v35
v_mfma_f32_16x16x32_bf16 v[156:159], v[60:63], v[204:207], v[156:159]
s_waitcnt lgkmcnt(4)
v_mfma_f32_16x16x32_bf16 v[160:163], v[40:43], v[192:195], v[160:163]
ds_read_b64_tr_b16 v[56:57], v10 offset:57344
ds_read_b64_tr_b16 v[58:59], v10 offset:58368
v_mfma_f32_16x16x32_bf16 v[164:167], v[40:43], v[196:199], v[164:167]
buffer_store_dwordx4 v[28:31], v7, s[12:15], s76 offen offset:2304
v_mfma_f32_16x16x32_bf16 v[168:171], v[40:43], v[200:203], v[168:171]
buffer_store_dwordx4 v[28:31], v7, s[12:15], s97 offen offset:2304 sc1
v_mfma_f32_16x16x32_bf16 v[172:175], v[40:43], v[204:207], v[172:175]
buffer_load_dwordx4 a[16:19], v16, s[16:19], s77 offen offset:3072 sc1
v_mfma_f32_16x16x32_bf16 v[176:179], v[44:47], v[192:195], v[176:179]
ds_read_b64_tr_b16 v[60:61], v11 offset:57344
ds_read_b64_tr_b16 v[62:63], v11 offset:58368
v_mfma_f32_16x16x32_bf16 v[180:183], v[44:47], v[196:199], v[180:183]
buffer_load_dwordx4 a[20:23], v17, s[16:19], s77 offen offset:3072 sc1
v_mfma_f32_16x16x32_bf16 v[184:187], v[44:47], v[200:203], v[184:187]
buffer_load_dwordx4 a[24:27], v18, s[16:19], s77 offen offset:3072 sc1
buffer_load_dwordx4 a[28:31], v19, s[16:19], s77 offen offset:3072 sc1
s_add_u32 s77, s77, 4096
v_mfma_f32_16x16x32_bf16 v[188:191], v[44:47], v[204:207], v[188:191]
s_waitcnt lgkmcnt(4)
s_waitcnt vmcnt(28)
s_barrier
v_mfma_f32_16x16x32_bf16 v[64:67], v[48:51], v[208:211], v[64:67]
ds_read_b64_tr_b16 v[40:41], v12 offset:57344
ds_read_b64_tr_b16 v[42:43], v12 offset:58368
v_mfma_f32_16x16x32_bf16 v[68:71], v[48:51], v[212:215], v[68:71]
buffer_store_dword v1, v0, s[64:67], s59 offen sc1
v_mfma_f32_16x16x32_bf16 v[72:75], v[48:51], v[216:219], v[72:75]
s_add_u32 s76, s76, 258048
s_add_u32 s97, s97, 258048
v_mfma_f32_16x16x32_bf16 v[76:79], v[48:51], v[220:223], v[76:79]
v_accvgpr_read_b32 v20, a128
v_accvgpr_read_b32 v21, a129
v_mfma_f32_16x16x32_bf16 v[80:83], v[52:55], v[208:211], v[80:83]
ds_read_b64_tr_b16 v[44:45], v13 offset:57344
ds_read_b64_tr_b16 v[46:47], v13 offset:58368
v_mfma_f32_16x16x32_bf16 v[84:87], v[52:55], v[212:215], v[84:87]
v_accvgpr_read_b32 v22, a130
v_accvgpr_read_b32 v23, a131
v_mfma_f32_16x16x32_bf16 v[88:91], v[52:55], v[216:219], v[88:91]
v_accvgpr_read_b32 v24, a132
v_accvgpr_read_b32 v25, a133
v_mfma_f32_16x16x32_bf16 v[92:95], v[52:55], v[220:223], v[92:95]
s_waitcnt lgkmcnt(4)
v_accvgpr_read_b32 v26, a134
v_mfma_f32_16x16x32_bf16 v[96:99], v[56:59], v[208:211], v[96:99]
ds_read_b64_tr_b16 v[48:49], v14 offset:57344
ds_read_b64_tr_b16 v[50:51], v14 offset:58368
v_mfma_f32_16x16x32_bf16 v[100:103], v[56:59], v[212:215], v[100:103]
v_accvgpr_read_b32 v27, a135
v_cvt_pk_bf16_f32 v20, v20, v21
v_mfma_f32_16x16x32_bf16 v[104:107], v[56:59], v[216:219], v[104:107]
v_cvt_pk_bf16_f32 v21, v22, v23
v_cvt_pk_bf16_f32 v22, v24, v25
v_mfma_f32_16x16x32_bf16 v[108:111], v[56:59], v[220:223], v[108:111]
v_cvt_pk_bf16_f32 v23, v26, v27
v_mfma_f32_16x16x32_bf16 v[112:115], v[60:63], v[208:211], v[112:115]
ds_read_b64_tr_b16 v[52:53], v15 offset:57344
ds_read_b64_tr_b16 v[54:55], v15 offset:58368
v_mfma_f32_16x16x32_bf16 v[116:119], v[60:63], v[212:215], v[116:119]
buffer_store_dwordx4 v[20:23], v7, s[12:15], s76 offen offset:0
v_mfma_f32_16x16x32_bf16 v[120:123], v[60:63], v[216:219], v[120:123]
buffer_store_dwordx4 v[20:23], v7, s[12:15], s97 offen offset:0 sc1
v_mfma_f32_16x16x32_bf16 v[124:127], v[60:63], v[220:223], v[124:127]
s_waitcnt lgkmcnt(4)
v_accvgpr_read_b32 v28, a136
v_mfma_f32_16x16x32_bf16 v[128:131], v[40:43], v[208:211], v[128:131]
v_add_u32 v8, 0x10000, v8
tp0_p8:
s_cbranch_execz tp0_ret
ds_read_b64_tr_b16 v[56:57], v8 offset:0
ds_read_b64_tr_b16 v[58:59], v8 offset:1024
v_mfma_f32_16x16x32_bf16 v[132:135], v[40:43], v[212:215], v[132:135]
v_accvgpr_read_b32 v29, a137
v_accvgpr_read_b32 v30, a138
v_mfma_f32_16x16x32_bf16 v[136:139], v[40:43], v[216:219], v[136:139]
v_accvgpr_read_b32 v31, a139
v_accvgpr_read_b32 v32, a140
v_mfma_f32_16x16x32_bf16 v[140:143], v[40:43], v[220:223], v[140:143]
v_accvgpr_read_b32 v33, a141
v_accvgpr_read_b32 v34, a142
v_mfma_f32_16x16x32_bf16 v[144:147], v[44:47], v[208:211], v[144:147]
v_add_u32 v9, 0x10000, v9
ds_read_b64_tr_b16 v[60:61], v9 offset:0
ds_read_b64_tr_b16 v[62:63], v9 offset:1024
v_mfma_f32_16x16x32_bf16 v[148:151], v[44:47], v[212:215], v[148:151]
v_accvgpr_read_b32 v35, a143
v_cvt_pk_bf16_f32 v28, v28, v29
v_mfma_f32_16x16x32_bf16 v[152:155], v[44:47], v[216:219], v[152:155]
v_cvt_pk_bf16_f32 v29, v30, v31
v_cvt_pk_bf16_f32 v30, v32, v33
v_mfma_f32_16x16x32_bf16 v[156:159], v[44:47], v[220:223], v[156:159]
s_waitcnt lgkmcnt(4)
v_cvt_pk_bf16_f32 v31, v34, v35
v_mfma_f32_16x16x32_bf16 v[160:163], v[48:51], v[208:211], v[160:163]
v_add_u32 v10, 0x10000, v10
ds_read_b64_tr_b16 v[40:41], v10 offset:0
ds_read_b64_tr_b16 v[42:43], v10 offset:1024
v_mfma_f32_16x16x32_bf16 v[164:167], v[48:51], v[212:215], v[164:167]
buffer_store_dwordx4 v[28:31], v7, s[12:15], s76 offen offset:256
v_mfma_f32_16x16x32_bf16 v[168:171], v[48:51], v[216:219], v[168:171]
buffer_store_dwordx4 v[28:31], v7, s[12:15], s97 offen offset:256 sc1
v_mfma_f32_16x16x32_bf16 v[172:175], v[48:51], v[220:223], v[172:175]
buffer_load_dwordx4 v[192:195], v16, s[16:19], s77 offen offset:0 sc1
v_mfma_f32_16x16x32_bf16 v[176:179], v[52:55], v[208:211], v[176:179]
v_add_u32 v11, 0x10000, v11
ds_read_b64_tr_b16 v[44:45], v11 offset:0
ds_read_b64_tr_b16 v[46:47], v11 offset:1024
v_mfma_f32_16x16x32_bf16 v[180:183], v[52:55], v[212:215], v[180:183]
buffer_load_dwordx4 v[196:199], v17, s[16:19], s77 offen offset:0 sc1
v_mfma_f32_16x16x32_bf16 v[184:187], v[52:55], v[216:219], v[184:187]
buffer_load_dwordx4 v[200:203], v18, s[16:19], s77 offen offset:0 sc1
buffer_load_dwordx4 v[204:207], v19, s[16:19], s77 offen offset:0 sc1
v_mfma_f32_16x16x32_bf16 v[188:191], v[52:55], v[220:223], v[188:191]
s_waitcnt lgkmcnt(4)
s_waitcnt vmcnt(33)
v_mfma_f32_16x16x32_bf16 v[64:67], v[56:59], v[224:227], v[64:67]
v_add_u32 v12, 0x10000, v12
ds_read_b64_tr_b16 v[48:49], v12 offset:0
ds_read_b64_tr_b16 v[50:51], v12 offset:1024
v_mfma_f32_16x16x32_bf16 v[68:71], v[56:59], v[228:231], v[68:71]
v_accvgpr_read_b32 v20, a144
v_accvgpr_read_b32 v21, a145
v_mfma_f32_16x16x32_bf16 v[72:75], v[56:59], v[232:235], v[72:75]
v_accvgpr_read_b32 v22, a146
v_accvgpr_read_b32 v23, a147
v_mfma_f32_16x16x32_bf16 v[76:79], v[56:59], v[236:239], v[76:79]
v_accvgpr_read_b32 v24, a148
v_accvgpr_read_b32 v25, a149
v_mfma_f32_16x16x32_bf16 v[80:83], v[60:63], v[224:227], v[80:83]
v_add_u32 v13, 0x10000, v13
ds_read_b64_tr_b16 v[52:53], v13 offset:0
ds_read_b64_tr_b16 v[54:55], v13 offset:1024
v_mfma_f32_16x16x32_bf16 v[84:87], v[60:63], v[228:231], v[84:87]
v_accvgpr_read_b32 v26, a150
v_accvgpr_read_b32 v27, a151
v_mfma_f32_16x16x32_bf16 v[88:91], v[60:63], v[232:235], v[88:91]
v_cvt_pk_bf16_f32 v20, v20, v21
v_cvt_pk_bf16_f32 v21, v22, v23
v_mfma_f32_16x16x32_bf16 v[92:95], v[60:63], v[236:239], v[92:95]
s_waitcnt lgkmcnt(4)
v_cvt_pk_bf16_f32 v22, v24, v25
v_mfma_f32_16x16x32_bf16 v[96:99], v[40:43], v[224:227], v[96:99]
v_add_u32 v14, 0x10000, v14
ds_read_b64_tr_b16 v[56:57], v14 offset:0
ds_read_b64_tr_b16 v[58:59], v14 offset:1024
v_mfma_f32_16x16x32_bf16 v[100:103], v[40:43], v[228:231], v[100:103]
v_cvt_pk_bf16_f32 v23, v26, v27
v_mfma_f32_16x16x32_bf16 v[104:107], v[40:43], v[232:235], v[104:107]
buffer_store_dwordx4 v[20:23], v7, s[12:15], s76 offen offset:2048
v_mfma_f32_16x16x32_bf16 v[108:111], v[40:43], v[236:239], v[108:111]
buffer_store_dwordx4 v[20:23], v7, s[12:15], s97 offen offset:2048 sc1
v_mfma_f32_16x16x32_bf16 v[112:115], v[44:47], v[224:227], v[112:115]
v_add_u32 v15, 0x10000, v15
ds_read_b64_tr_b16 v[60:61], v15 offset:0
ds_read_b64_tr_b16 v[62:63], v15 offset:1024
v_mfma_f32_16x16x32_bf16 v[116:119], v[44:47], v[228:231], v[116:119]
v_accvgpr_read_b32 v28, a152
v_accvgpr_read_b32 v29, a153
v_mfma_f32_16x16x32_bf16 v[120:123], v[44:47], v[232:235], v[120:123]
v_accvgpr_read_b32 v30, a154
v_accvgpr_read_b32 v31, a155
v_mfma_f32_16x16x32_bf16 v[124:127], v[44:47], v[236:239], v[124:127]
s_waitcnt lgkmcnt(4)
v_accvgpr_read_b32 v32, a156
v_mfma_f32_16x16x32_bf16 v[128:131], v[48:51], v[224:227], v[128:131]
ds_read_b64_tr_b16 v[40:41], v8 offset:8192
ds_read_b64_tr_b16 v[42:43], v8 offset:9216
v_mfma_f32_16x16x32_bf16 v[132:135], v[48:51], v[228:231], v[132:135]
v_accvgpr_read_b32 v33, a157
v_accvgpr_read_b32 v34, a158
v_mfma_f32_16x16x32_bf16 v[136:139], v[48:51], v[232:235], v[136:139]
v_accvgpr_read_b32 v35, a159
v_cvt_pk_bf16_f32 v28, v28, v29
v_mfma_f32_16x16x32_bf16 v[140:143], v[48:51], v[236:239], v[140:143]
v_cvt_pk_bf16_f32 v29, v30, v31
v_cvt_pk_bf16_f32 v30, v32, v33
v_mfma_f32_16x16x32_bf16 v[144:147], v[52:55], v[224:227], v[144:147]
ds_read_b64_tr_b16 v[44:45], v9 offset:8192
ds_read_b64_tr_b16 v[46:47], v9 offset:9216
v_mfma_f32_16x16x32_bf16 v[148:151], v[52:55], v[228:231], v[148:151]
v_cvt_pk_bf16_f32 v31, v34, v35
v_mfma_f32_16x16x32_bf16 v[152:155], v[52:55], v[232:235], v[152:155]
buffer_store_dwordx4 v[28:31], v7, s[12:15], s76 offen offset:2304
v_mfma_f32_16x16x32_bf16 v[156:159], v[52:55], v[236:239], v[156:159]
s_waitcnt lgkmcnt(4)
v_mfma_f32_16x16x32_bf16 v[160:163], v[56:59], v[224:227], v[160:163]
ds_read_b64_tr_b16 v[48:49], v10 offset:8192
ds_read_b64_tr_b16 v[50:51], v10 offset:9216
v_mfma_f32_16x16x32_bf16 v[164:167], v[56:59], v[228:231], v[164:167]
buffer_store_dwordx4 v[28:31], v7, s[12:15], s97 offen offset:2304 sc1
v_mfma_f32_16x16x32_bf16 v[168:171], v[56:59], v[232:235], v[168:171]
buffer_load_dwordx4 v[208:211], v16, s[16:19], s77 offen offset:1024 sc1
v_mfma_f32_16x16x32_bf16 v[172:175], v[56:59], v[236:239], v[172:175]
buffer_load_dwordx4 v[212:215], v17, s[16:19], s77 offen offset:1024 sc1
v_mfma_f32_16x16x32_bf16 v[176:179], v[60:63], v[224:227], v[176:179]
ds_read_b64_tr_b16 v[52:53], v11 offset:8192
ds_read_b64_tr_b16 v[54:55], v11 offset:9216
v_mfma_f32_16x16x32_bf16 v[180:183], v[60:63], v[228:231], v[180:183]
buffer_load_dwordx4 v[216:219], v18, s[16:19], s77 offen offset:1024 sc1
v_mfma_f32_16x16x32_bf16 v[184:187], v[60:63], v[232:235], v[184:187]
buffer_load_dwordx4 v[220:223], v19, s[16:19], s77 offen offset:1024 sc1
v_mfma_f32_16x16x32_bf16 v[188:191], v[60:63], v[236:239], v[188:191]
s_waitcnt lgkmcnt(4)
s_waitcnt vmcnt(33)
v_mfma_f32_16x16x32_bf16 v[64:67], v[40:43], v[240:243], v[64:67]
ds_read_b64_tr_b16 v[56:57], v12 offset:8192
ds_read_b64_tr_b16 v[58:59], v12 offset:9216
v_mfma_f32_16x16x32_bf16 v[68:71], v[40:43], v[244:247], v[68:71]
s_add_u32 s76, s76, 4096
s_add_u32 s97, s97, 4096
v_mfma_f32_16x16x32_bf16 v[72:75], v[40:43], v[248:251], v[72:75]
v_accvgpr_read_b32 v20, a160
v_accvgpr_read_b32 v21, a161
v_mfma_f32_16x16x32_bf16 v[76:79], v[40:43], v[252:255], v[76:79]
v_accvgpr_read_b32 v22, a162
v_accvgpr_read_b32 v23, a163
v_mfma_f32_16x16x32_bf16 v[80:83], v[44:47], v[240:243], v[80:83]
ds_read_b64_tr_b16 v[60:61], v13 offset:8192
ds_read_b64_tr_b16 v[62:63], v13 offset:9216
v_mfma_f32_16x16x32_bf16 v[84:87], v[44:47], v[244:247], v[84:87]
v_accvgpr_read_b32 v24, a164
v_accvgpr_read_b32 v25, a165
v_mfma_f32_16x16x32_bf16 v[88:91], v[44:47], v[248:251], v[88:91]
v_accvgpr_read_b32 v26, a166
v_accvgpr_read_b32 v27, a167
v_mfma_f32_16x16x32_bf16 v[92:95], v[44:47], v[252:255], v[92:95]
s_waitcnt lgkmcnt(4)
v_cvt_pk_bf16_f32 v20, v20, v21
v_mfma_f32_16x16x32_bf16 v[96:99], v[48:51], v[240:243], v[96:99]
ds_read_b64_tr_b16 v[40:41], v14 offset:8192
ds_read_b64_tr_b16 v[42:43], v14 offset:9216
v_mfma_f32_16x16x32_bf16 v[100:103], v[48:51], v[244:247], v[100:103]
v_cvt_pk_bf16_f32 v21, v22, v23
v_cvt_pk_bf16_f32 v22, v24, v25
v_mfma_f32_16x16x32_bf16 v[104:107], v[48:51], v[248:251], v[104:107]
v_cvt_pk_bf16_f32 v23, v26, v27
v_mfma_f32_16x16x32_bf16 v[108:111], v[48:51], v[252:255], v[108:111]
buffer_store_dwordx4 v[20:23], v7, s[12:15], s76 offen offset:0
v_mfma_f32_16x16x32_bf16 v[112:115], v[52:55], v[240:243], v[112:115]
ds_read_b64_tr_b16 v[44:45], v15 offset:8192
ds_read_b64_tr_b16 v[46:47], v15 offset:9216
v_mfma_f32_16x16x32_bf16 v[116:119], v[52:55], v[244:247], v[116:119]
buffer_store_dwordx4 v[20:23], v7, s[12:15], s97 offen offset:0 sc1
v_mfma_f32_16x16x32_bf16 v[120:123], v[52:55], v[248:251], v[120:123]
v_accvgpr_read_b32 v28, a168
v_accvgpr_read_b32 v29, a169
v_mfma_f32_16x16x32_bf16 v[124:127], v[52:55], v[252:255], v[124:127]
s_waitcnt lgkmcnt(4)
v_accvgpr_read_b32 v30, a170
v_mfma_f32_16x16x32_bf16 v[128:131], v[56:59], v[240:243], v[128:131]
ds_read_b64_tr_b16 v[48:49], v8 offset:16384
ds_read_b64_tr_b16 v[50:51], v8 offset:17408
v_mfma_f32_16x16x32_bf16 v[132:135], v[56:59], v[244:247], v[132:135]
v_accvgpr_read_b32 v31, a171
v_accvgpr_read_b32 v32, a172
v_mfma_f32_16x16x32_bf16 v[136:139], v[56:59], v[248:251], v[136:139]
v_accvgpr_read_b32 v33, a173
v_accvgpr_read_b32 v34, a174
v_mfma_f32_16x16x32_bf16 v[140:143], v[56:59], v[252:255], v[140:143]
v_accvgpr_read_b32 v35, a175
v_cvt_pk_bf16_f32 v28, v28, v29
v_mfma_f32_16x16x32_bf16 v[144:147], v[60:63], v[240:243], v[144:147]
ds_read_b64_tr_b16 v[52:53], v9 offset:16384
ds_read_b64_tr_b16 v[54:55], v9 offset:17408
v_mfma_f32_16x16x32_bf16 v[148:151], v[60:63], v[244:247], v[148:151]
v_cvt_pk_bf16_f32 v29, v30, v31
v_cvt_pk_bf16_f32 v30, v32, v33
v_mfma_f32_16x16x32_bf16 v[152:155], v[60:63], v[248:251], v[152:155]
v_cvt_pk_bf16_f32 v31, v34, v35
v_mfma_f32_16x16x32_bf16 v[156:159], v[60:63], v[252:255], v[156:159]
s_waitcnt lgkmcnt(4)
v_mfma_f32_16x16x32_bf16 v[160:163], v[40:43], v[240:243], v[160:163]
ds_read_b64_tr_b16 v[56:57], v10 offset:16384
ds_read_b64_tr_b16 v[58:59], v10 offset:17408
v_mfma_f32_16x16x32_bf16 v[164:167], v[40:43], v[244:247], v[164:167]
buffer_store_dwordx4 v[28:31], v7, s[12:15], s76 offen offset:256
v_mfma_f32_16x16x32_bf16 v[168:171], v[40:43], v[248:251], v[168:171]
buffer_store_dwordx4 v[28:31], v7, s[12:15], s97 offen offset:256 sc1
v_mfma_f32_16x16x32_bf16 v[172:175], v[40:43], v[252:255], v[172:175]
buffer_load_dwordx4 v[224:227], v16, s[16:19], s77 offen offset:2048 sc1
v_mfma_f32_16x16x32_bf16 v[176:179], v[44:47], v[240:243], v[176:179]
ds_read_b64_tr_b16 v[60:61], v11 offset:16384
ds_read_b64_tr_b16 v[62:63], v11 offset:17408
v_mfma_f32_16x16x32_bf16 v[180:183], v[44:47], v[244:247], v[180:183]
buffer_load_dwordx4 v[228:231], v17, s[16:19], s77 offen offset:2048 sc1
v_mfma_f32_16x16x32_bf16 v[184:187], v[44:47], v[248:251], v[184:187]
buffer_load_dwordx4 v[232:235], v18, s[16:19], s77 offen offset:2048 sc1
buffer_load_dwordx4 v[236:239], v19, s[16:19], s77 offen offset:2048 sc1
v_mfma_f32_16x16x32_bf16 v[188:191], v[44:47], v[252:255], v[188:191]
s_waitcnt lgkmcnt(4)
s_waitcnt vmcnt(33)
v_mfma_f32_16x16x32_bf16 v[64:67], v[48:51], a[0:3], v[64:67]
ds_read_b64_tr_b16 v[40:41], v12 offset:16384
ds_read_b64_tr_b16 v[42:43], v12 offset:17408
v_mfma_f32_16x16x32_bf16 v[68:71], v[48:51], a[4:7], v[68:71]
s_lshl_b32 s100, s25, 10
v_mfma_f32_16x16x32_bf16 v[72:75], v[48:51], a[8:11], v[72:75]
buffer_load_dword v36, v37, s[64:67], s100 offen sc1
v_mfma_f32_16x16x32_bf16 v[76:79], v[48:51], a[12:15], v[76:79]
v_accvgpr_read_b32 v20, a176
v_accvgpr_read_b32 v21, a177
v_mfma_f32_16x16x32_bf16 v[80:83], v[52:55], a[0:3], v[80:83]
ds_read_b64_tr_b16 v[44:45], v13 offset:16384
ds_read_b64_tr_b16 v[46:47], v13 offset:17408
v_mfma_f32_16x16x32_bf16 v[84:87], v[52:55], a[4:7], v[84:87]
v_accvgpr_read_b32 v22, a178
v_accvgpr_read_b32 v23, a179
v_mfma_f32_16x16x32_bf16 v[88:91], v[52:55], a[8:11], v[88:91]
v_accvgpr_read_b32 v24, a180
v_accvgpr_read_b32 v25, a181
v_mfma_f32_16x16x32_bf16 v[92:95], v[52:55], a[12:15], v[92:95]
s_waitcnt lgkmcnt(4)
v_accvgpr_read_b32 v26, a182
v_mfma_f32_16x16x32_bf16 v[96:99], v[56:59], a[0:3], v[96:99]
ds_read_b64_tr_b16 v[48:49], v14 offset:16384
ds_read_b64_tr_b16 v[50:51], v14 offset:17408
v_mfma_f32_16x16x32_bf16 v[100:103], v[56:59], a[4:7], v[100:103]
v_accvgpr_read_b32 v27, a183
v_cvt_pk_bf16_f32 v20, v20, v21
v_mfma_f32_16x16x32_bf16 v[104:107], v[56:59], a[8:11], v[104:107]
v_cvt_pk_bf16_f32 v21, v22, v23
v_cvt_pk_bf16_f32 v22, v24, v25
v_mfma_f32_16x16x32_bf16 v[108:111], v[56:59], a[12:15], v[108:111]
v_cvt_pk_bf16_f32 v23, v26, v27
v_mfma_f32_16x16x32_bf16 v[112:115], v[60:63], a[0:3], v[112:115]
ds_read_b64_tr_b16 v[52:53], v15 offset:16384
ds_read_b64_tr_b16 v[54:55], v15 offset:17408
v_mfma_f32_16x16x32_bf16 v[116:119], v[60:63], a[4:7], v[116:119]
buffer_store_dwordx4 v[20:23], v7, s[12:15], s76 offen offset:2048
v_mfma_f32_16x16x32_bf16 v[120:123], v[60:63], a[8:11], v[120:123]
buffer_store_dwordx4 v[20:23], v7, s[12:15], s97 offen offset:2048 sc1
v_mfma_f32_16x16x32_bf16 v[124:127], v[60:63], a[12:15], v[124:127]
s_waitcnt lgkmcnt(4)
v_accvgpr_read_b32 v28, a184
v_mfma_f32_16x16x32_bf16 v[128:131], v[40:43], a[0:3], v[128:131]
ds_read_b64_tr_b16 v[56:57], v8 offset:24576
ds_read_b64_tr_b16 v[58:59], v8 offset:25600
v_mfma_f32_16x16x32_bf16 v[132:135], v[40:43], a[4:7], v[132:135]
v_accvgpr_read_b32 v29, a185
v_accvgpr_read_b32 v30, a186
v_mfma_f32_16x16x32_bf16 v[136:139], v[40:43], a[8:11], v[136:139]
v_accvgpr_read_b32 v31, a187
v_accvgpr_read_b32 v32, a188
v_mfma_f32_16x16x32_bf16 v[140:143], v[40:43], a[12:15], v[140:143]
v_accvgpr_read_b32 v33, a189
v_accvgpr_read_b32 v34, a190
v_mfma_f32_16x16x32_bf16 v[144:147], v[44:47], a[0:3], v[144:147]
ds_read_b64_tr_b16 v[60:61], v9 offset:24576
ds_read_b64_tr_b16 v[62:63], v9 offset:25600
v_mfma_f32_16x16x32_bf16 v[148:151], v[44:47], a[4:7], v[148:151]
v_accvgpr_read_b32 v35, a191
v_cvt_pk_bf16_f32 v28, v28, v29
v_mfma_f32_16x16x32_bf16 v[152:155], v[44:47], a[8:11], v[152:155]
v_cvt_pk_bf16_f32 v29, v30, v31
v_cvt_pk_bf16_f32 v30, v32, v33
v_mfma_f32_16x16x32_bf16 v[156:159], v[44:47], a[12:15], v[156:159]
s_waitcnt lgkmcnt(4)
v_cvt_pk_bf16_f32 v31, v34, v35
v_mfma_f32_16x16x32_bf16 v[160:163], v[48:51], a[0:3], v[160:163]
ds_read_b64_tr_b16 v[40:41], v10 offset:24576
ds_read_b64_tr_b16 v[42:43], v10 offset:25600
v_mfma_f32_16x16x32_bf16 v[164:167], v[48:51], a[4:7], v[164:167]
buffer_store_dwordx4 v[28:31], v7, s[12:15], s76 offen offset:2304
v_mfma_f32_16x16x32_bf16 v[168:171], v[48:51], a[8:11], v[168:171]
buffer_store_dwordx4 v[28:31], v7, s[12:15], s97 offen offset:2304 sc1
v_mfma_f32_16x16x32_bf16 v[172:175], v[48:51], a[12:15], v[172:175]
buffer_load_dwordx4 v[240:243], v16, s[16:19], s77 offen offset:3072 sc1
v_mfma_f32_16x16x32_bf16 v[176:179], v[52:55], a[0:3], v[176:179]
ds_read_b64_tr_b16 v[44:45], v11 offset:24576
ds_read_b64_tr_b16 v[46:47], v11 offset:25600
v_mfma_f32_16x16x32_bf16 v[180:183], v[52:55], a[4:7], v[180:183]
buffer_load_dwordx4 v[244:247], v17, s[16:19], s77 offen offset:3072 sc1
v_mfma_f32_16x16x32_bf16 v[184:187], v[52:55], a[8:11], v[184:187]
buffer_load_dwordx4 v[248:251], v18, s[16:19], s77 offen offset:3072 sc1
buffer_load_dwordx4 v[252:255], v19, s[16:19], s77 offen offset:3072 sc1
s_add_u32 s77, s77, 4096
v_mfma_f32_16x16x32_bf16 v[188:191], v[52:55], a[12:15], v[188:191]
s_waitcnt lgkmcnt(4)
s_waitcnt vmcnt(34)
v_mfma_f32_16x16x32_bf16 v[64:67], v[56:59], a[16:19], v[64:67]
ds_read_b64_tr_b16 v[48:49], v12 offset:24576
ds_read_b64_tr_b16 v[50:51], v12 offset:25600
v_mfma_f32_16x16x32_bf16 v[68:71], v[56:59], a[20:23], v[68:71]
s_add_u32 s76, s76, 258048
s_add_u32 s97, s97, 258048
v_mfma_f32_16x16x32_bf16 v[72:75], v[56:59], a[24:27], v[72:75]
v_accvgpr_read_b32 v20, a192
v_accvgpr_read_b32 v21, a193
v_mfma_f32_16x16x32_bf16 v[76:79], v[56:59], a[28:31], v[76:79]
v_accvgpr_read_b32 v22, a194
v_accvgpr_read_b32 v23, a195
v_mfma_f32_16x16x32_bf16 v[80:83], v[60:63], a[16:19], v[80:83]
ds_read_b64_tr_b16 v[52:53], v13 offset:24576
ds_read_b64_tr_b16 v[54:55], v13 offset:25600
v_mfma_f32_16x16x32_bf16 v[84:87], v[60:63], a[20:23], v[84:87]
v_accvgpr_read_b32 v24, a196
v_accvgpr_read_b32 v25, a197
v_mfma_f32_16x16x32_bf16 v[88:91], v[60:63], a[24:27], v[88:91]
v_accvgpr_read_b32 v26, a198
v_accvgpr_read_b32 v27, a199
v_mfma_f32_16x16x32_bf16 v[92:95], v[60:63], a[28:31], v[92:95]
s_waitcnt lgkmcnt(4)
v_cvt_pk_bf16_f32 v20, v20, v21
v_mfma_f32_16x16x32_bf16 v[96:99], v[40:43], a[16:19], v[96:99]
ds_read_b64_tr_b16 v[56:57], v14 offset:24576
ds_read_b64_tr_b16 v[58:59], v14 offset:25600
v_mfma_f32_16x16x32_bf16 v[100:103], v[40:43], a[20:23], v[100:103]
v_cvt_pk_bf16_f32 v21, v22, v23
v_cvt_pk_bf16_f32 v22, v24, v25
v_mfma_f32_16x16x32_bf16 v[104:107], v[40:43], a[24:27], v[104:107]
v_cvt_pk_bf16_f32 v23, v26, v27
v_mfma_f32_16x16x32_bf16 v[108:111], v[40:43], a[28:31], v[108:111]
buffer_store_dwordx4 v[20:23], v7, s[12:15], s76 offen offset:0
v_mfma_f32_16x16x32_bf16 v[112:115], v[44:47], a[16:19], v[112:115]
ds_read_b64_tr_b16 v[60:61], v15 offset:24576
ds_read_b64_tr_b16 v[62:63], v15 offset:25600
v_mfma_f32_16x16x32_bf16 v[116:119], v[44:47], a[20:23], v[116:119]
buffer_store_dwordx4 v[20:23], v7, s[12:15], s97 offen offset:0 sc1
v_mfma_f32_16x16x32_bf16 v[120:123], v[44:47], a[24:27], v[120:123]
v_accvgpr_read_b32 v28, a200
v_accvgpr_read_b32 v29, a201
v_mfma_f32_16x16x32_bf16 v[124:127], v[44:47], a[28:31], v[124:127]
s_waitcnt lgkmcnt(4)
v_accvgpr_read_b32 v30, a202
v_mfma_f32_16x16x32_bf16 v[128:131], v[48:51], a[16:19], v[128:131]
ds_read_b64_tr_b16 v[40:41], v8 offset:32768
ds_read_b64_tr_b16 v[42:43], v8 offset:33792
v_mfma_f32_16x16x32_bf16 v[132:135], v[48:51], a[20:23], v[132:135]
v_accvgpr_read_b32 v31, a203
v_accvgpr_read_b32 v32, a204
v_mfma_f32_16x16x32_bf16 v[136:139], v[48:51], a[24:27], v[136:139]
v_accvgpr_read_b32 v33, a205
v_accvgpr_read_b32 v34, a206
v_mfma_f32_16x16x32_bf16 v[140:143], v[48:51], a[28:31], v[140:143]
v_accvgpr_read_b32 v35, a207
v_cvt_pk_bf16_f32 v28, v28, v29
v_mfma_f32_16x16x32_bf16 v[144:147], v[52:55], a[16:19], v[144:147]
ds_read_b64_tr_b16 v[44:45], v9 offset:32768
ds_read_b64_tr_b16 v[46:47], v9 offset:33792
v_mfma_f32_16x16x32_bf16 v[148:151], v[52:55], a[20:23], v[148:151]
v_cvt_pk_bf16_f32 v29, v30, v31
v_cvt_pk_bf16_f32 v30, v32, v33
v_mfma_f32_16x16x32_bf16 v[152:155], v[52:55], a[24:27], v[152:155]
v_cvt_pk_bf16_f32 v31, v34, v35
v_mfma_f32_16x16x32_bf16 v[156:159], v[52:55], a[28:31], v[156:159]
s_waitcnt lgkmcnt(4)
v_mfma_f32_16x16x32_bf16 v[160:163], v[56:59], a[16:19], v[160:163]
ds_read_b64_tr_b16 v[48:49], v10 offset:32768
ds_read_b64_tr_b16 v[50:51], v10 offset:33792
v_mfma_f32_16x16x32_bf16 v[164:167], v[56:59], a[20:23], v[164:167]
buffer_store_dwordx4 v[28:31], v7, s[12:15], s76 offen offset:256
v_mfma_f32_16x16x32_bf16 v[168:171], v[56:59], a[24:27], v[168:171]
buffer_store_dwordx4 v[28:31], v7, s[12:15], s97 offen offset:256 sc1
v_mfma_f32_16x16x32_bf16 v[172:175], v[56:59], a[28:31], v[172:175]
buffer_load_dwordx4 a[0:3], v16, s[16:19], s77 offen offset:0 sc1
v_mfma_f32_16x16x32_bf16 v[176:179], v[60:63], a[16:19], v[176:179]
ds_read_b64_tr_b16 v[52:53], v11 offset:32768
ds_read_b64_tr_b16 v[54:55], v11 offset:33792
v_mfma_f32_16x16x32_bf16 v[180:183], v[60:63], a[20:23], v[180:183]
buffer_load_dwordx4 a[4:7], v17, s[16:19], s77 offen offset:0 sc1
v_mfma_f32_16x16x32_bf16 v[184:187], v[60:63], a[24:27], v[184:187]
buffer_load_dwordx4 a[8:11], v18, s[16:19], s77 offen offset:0 sc1
buffer_load_dwordx4 a[12:15], v19, s[16:19], s77 offen offset:0 sc1
v_mfma_f32_16x16x32_bf16 v[188:191], v[60:63], a[28:31], v[188:191]
s_waitcnt lgkmcnt(4)
s_waitcnt vmcnt(33)
s_barrier
v_mfma_f32_16x16x32_bf16 v[64:67], v[40:43], v[192:195], v[64:67]
ds_read_b64_tr_b16 v[56:57], v12 offset:32768
ds_read_b64_tr_b16 v[58:59], v12 offset:33792
v_mfma_f32_16x16x32_bf16 v[68:71], v[40:43], v[196:199], v[68:71]
s_waitcnt vmcnt(16)
v_cmp_gt_u32 vcc, 1, v36
v_mfma_f32_16x16x32_bf16 v[72:75], v[40:43], v[200:203], v[72:75]
s_cbranch_vccnz k12_kernel_fspin
k12_kernel_fback:
v_mfma_f32_16x16x32_bf16 v[76:79], v[40:43], v[204:207], v[76:79]
v_accvgpr_read_b32 v20, a208
v_accvgpr_read_b32 v21, a209
v_mfma_f32_16x16x32_bf16 v[80:83], v[44:47], v[192:195], v[80:83]
ds_read_b64_tr_b16 v[60:61], v13 offset:32768
ds_read_b64_tr_b16 v[62:63], v13 offset:33792
v_mfma_f32_16x16x32_bf16 v[84:87], v[44:47], v[196:199], v[84:87]
v_accvgpr_read_b32 v22, a210
v_accvgpr_read_b32 v23, a211
v_mfma_f32_16x16x32_bf16 v[88:91], v[44:47], v[200:203], v[88:91]
v_accvgpr_read_b32 v24, a212
v_accvgpr_read_b32 v25, a213
v_mfma_f32_16x16x32_bf16 v[92:95], v[44:47], v[204:207], v[92:95]
s_waitcnt lgkmcnt(4)
v_accvgpr_read_b32 v26, a214
v_mfma_f32_16x16x32_bf16 v[96:99], v[48:51], v[192:195], v[96:99]
ds_read_b64_tr_b16 v[40:41], v14 offset:32768
ds_read_b64_tr_b16 v[42:43], v14 offset:33792
v_mfma_f32_16x16x32_bf16 v[100:103], v[48:51], v[196:199], v[100:103]
v_accvgpr_read_b32 v27, a215
v_cvt_pk_bf16_f32 v20, v20, v21
v_mfma_f32_16x16x32_bf16 v[104:107], v[48:51], v[200:203], v[104:107]
v_cvt_pk_bf16_f32 v21, v22, v23
v_cvt_pk_bf16_f32 v22, v24, v25
v_mfma_f32_16x16x32_bf16 v[108:111], v[48:51], v[204:207], v[108:111]
v_cvt_pk_bf16_f32 v23, v26, v27
v_mfma_f32_16x16x32_bf16 v[112:115], v[52:55], v[192:195], v[112:115]
ds_read_b64_tr_b16 v[44:45], v15 offset:32768
ds_read_b64_tr_b16 v[46:47], v15 offset:33792
v_mfma_f32_16x16x32_bf16 v[116:119], v[52:55], v[196:199], v[116:119]
buffer_store_dwordx4 v[20:23], v7, s[12:15], s76 offen offset:2048
v_mfma_f32_16x16x32_bf16 v[120:123], v[52:55], v[200:203], v[120:123]
buffer_store_dwordx4 v[20:23], v7, s[12:15], s97 offen offset:2048 sc1
v_mfma_f32_16x16x32_bf16 v[124:127], v[52:55], v[204:207], v[124:127]
s_waitcnt lgkmcnt(4)
v_accvgpr_read_b32 v28, a216
v_mfma_f32_16x16x32_bf16 v[128:131], v[56:59], v[192:195], v[128:131]
ds_read_b64_tr_b16 v[48:49], v8 offset:40960
ds_read_b64_tr_b16 v[50:51], v8 offset:41984
v_mfma_f32_16x16x32_bf16 v[132:135], v[56:59], v[196:199], v[132:135]
v_accvgpr_read_b32 v29, a217
v_accvgpr_read_b32 v30, a218
v_mfma_f32_16x16x32_bf16 v[136:139], v[56:59], v[200:203], v[136:139]
v_accvgpr_read_b32 v31, a219
v_accvgpr_read_b32 v32, a220
v_mfma_f32_16x16x32_bf16 v[140:143], v[56:59], v[204:207], v[140:143]
v_accvgpr_read_b32 v33, a221
v_accvgpr_read_b32 v34, a222
v_mfma_f32_16x16x32_bf16 v[144:147], v[60:63], v[192:195], v[144:147]
ds_read_b64_tr_b16 v[52:53], v9 offset:40960
ds_read_b64_tr_b16 v[54:55], v9 offset:41984
v_mfma_f32_16x16x32_bf16 v[148:151], v[60:63], v[196:199], v[148:151]
v_accvgpr_read_b32 v35, a223
v_cvt_pk_bf16_f32 v28, v28, v29
v_mfma_f32_16x16x32_bf16 v[152:155], v[60:63], v[200:203], v[152:155]
v_cvt_pk_bf16_f32 v29, v30, v31
v_cvt_pk_bf16_f32 v30, v32, v33
v_mfma_f32_16x16x32_bf16 v[156:159], v[60:63], v[204:207], v[156:159]
s_waitcnt lgkmcnt(4)
v_cvt_pk_bf16_f32 v31, v34, v35
v_mfma_f32_16x16x32_bf16 v[160:163], v[40:43], v[192:195], v[160:163]
ds_read_b64_tr_b16 v[56:57], v10 offset:40960
ds_read_b64_tr_b16 v[58:59], v10 offset:41984
v_mfma_f32_16x16x32_bf16 v[164:167], v[40:43], v[196:199], v[164:167]
buffer_store_dwordx4 v[28:31], v7, s[12:15], s76 offen offset:2304
v_mfma_f32_16x16x32_bf16 v[168:171], v[40:43], v[200:203], v[168:171]
buffer_store_dwordx4 v[28:31], v7, s[12:15], s97 offen offset:2304 sc1
v_mfma_f32_16x16x32_bf16 v[172:175], v[40:43], v[204:207], v[172:175]
buffer_load_dwordx4 a[16:19], v16, s[16:19], s77 offen offset:1024 sc1
v_mfma_f32_16x16x32_bf16 v[176:179], v[44:47], v[192:195], v[176:179]
ds_read_b64_tr_b16 v[60:61], v11 offset:40960
ds_read_b64_tr_b16 v[62:63], v11 offset:41984
v_mfma_f32_16x16x32_bf16 v[180:183], v[44:47], v[196:199], v[180:183]
buffer_load_dwordx4 a[20:23], v17, s[16:19], s77 offen offset:1024 sc1
v_mfma_f32_16x16x32_bf16 v[184:187], v[44:47], v[200:203], v[184:187]
buffer_load_dwordx4 a[24:27], v18, s[16:19], s77 offen offset:1024 sc1
buffer_load_dwordx4 a[28:31], v19, s[16:19], s77 offen offset:1024 sc1
s_add_u32 m0, s58, 16384
s_nop 0
buffer_load_dwordx4 v38, s[4:7], s29 offen offset:0 sc1 lds
buffer_load_dwordx4 v38, s[4:7], s29 offen offset:1024 sc1 lds
buffer_load_dwordx4 v38, s[4:7], s29 offen offset:2048 sc1 lds
buffer_load_dwordx4 v38, s[4:7], s29 offen offset:3072 sc1 lds
s_add_u32 s29, s29, 16384
v_mfma_f32_16x16x32_bf16 v[188:191], v[44:47], v[204:207], v[188:191]
s_waitcnt lgkmcnt(4)
s_waitcnt vmcnt(37)
v_mfma_f32_16x16x32_bf16 v[64:67], v[48:51], v[208:211], v[64:67]
ds_read_b64_tr_b16 v[40:41], v12 offset:40960
ds_read_b64_tr_b16 v[42:43], v12 offset:41984
v_mfma_f32_16x16x32_bf16 v[68:71], v[48:51], v[212:215], v[68:71]
s_add_u32 s76, s76, 4096
s_add_u32 s97, s97, 4096
v_mfma_f32_16x16x32_bf16 v[72:75], v[48:51], v[216:219], v[72:75]
v_accvgpr_read_b32 v20, a224
v_accvgpr_read_b32 v21, a225
v_mfma_f32_16x16x32_bf16 v[76:79], v[48:51], v[220:223], v[76:79]
v_accvgpr_read_b32 v22, a226
v_accvgpr_read_b32 v23, a227
v_mfma_f32_16x16x32_bf16 v[80:83], v[52:55], v[208:211], v[80:83]
ds_read_b64_tr_b16 v[44:45], v13 offset:40960
ds_read_b64_tr_b16 v[46:47], v13 offset:41984
v_mfma_f32_16x16x32_bf16 v[84:87], v[52:55], v[212:215], v[84:87]
v_accvgpr_read_b32 v24, a228
v_accvgpr_read_b32 v25, a229
v_mfma_f32_16x16x32_bf16 v[88:91], v[52:55], v[216:219], v[88:91]
v_accvgpr_read_b32 v26, a230
v_accvgpr_read_b32 v27, a231
v_mfma_f32_16x16x32_bf16 v[92:95], v[52:55], v[220:223], v[92:95]
s_waitcnt lgkmcnt(4)
v_cvt_pk_bf16_f32 v20, v20, v21
v_mfma_f32_16x16x32_bf16 v[96:99], v[56:59], v[208:211], v[96:99]
ds_read_b64_tr_b16 v[48:49], v14 offset:40960
ds_read_b64_tr_b16 v[50:51], v14 offset:41984
v_mfma_f32_16x16x32_bf16 v[100:103], v[56:59], v[212:215], v[100:103]
v_cvt_pk_bf16_f32 v21, v22, v23
v_cvt_pk_bf16_f32 v22, v24, v25
v_mfma_f32_16x16x32_bf16 v[104:107], v[56:59], v[216:219], v[104:107]
v_cvt_pk_bf16_f32 v23, v26, v27
v_mfma_f32_16x16x32_bf16 v[108:111], v[56:59], v[220:223], v[108:111]
buffer_store_dwordx4 v[20:23], v7, s[12:15], s76 offen offset:0
v_mfma_f32_16x16x32_bf16 v[112:115], v[60:63], v[208:211], v[112:115]
ds_read_b64_tr_b16 v[52:53], v15 offset:40960
tp0_p9:
s_cbranch_execz tp0_ret
ds_read_b64_tr_b16 v[54:55], v15 offset:41984
v_mfma_f32_16x16x32_bf16 v[116:119], v[60:63], v[212:215], v[116:119]
buffer_store_dwordx4 v[20:23], v7, s[12:15], s97 offen offset:0 sc1
v_mfma_f32_16x16x32_bf16 v[120:123], v[60:63], v[216:219], v[120:123]
v_accvgpr_read_b32 v28, a232
v_accvgpr_read_b32 v29, a233
v_mfma_f32_16x16x32_bf16 v[124:127], v[60:63], v[220:223], v[124:127]
s_waitcnt lgkmcnt(4)
v_accvgpr_read_b32 v30, a234
v_mfma_f32_16x16x32_bf16 v[128:131], v[40:43], v[208:211], v[128:131]
ds_read_b64_tr_b16 v[56:57], v8 offset:49152
ds_read_b64_tr_b16 v[58:59], v8 offset:50176
v_mfma_f32_16x16x32_bf16 v[132:135], v[40:43], v[212:215], v[132:135]
v_accvgpr_read_b32 v31, a235
v_accvgpr_read_b32 v32, a236
v_mfma_f32_16x16x32_bf16 v[136:139], v[40:43], v[216:219], v[136:139]
v_accvgpr_read_b32 v33, a237
v_accvgpr_read_b32 v34, a238
v_mfma_f32_16x16x32_bf16 v[140:143], v[40:43], v[220:223], v[140:143]
v_accvgpr_read_b32 v35, a239
v_cvt_pk_bf16_f32 v28, v28, v29
v_mfma_f32_16x16x32_bf16 v[144:147], v[44:47], v[208:211], v[144:147]
ds_read_b64_tr_b16 v[60:61], v9 offset:49152
ds_read_b64_tr_b16 v[62:63], v9 offset:50176
v_mfma_f32_16x16x32_bf16 v[148:151], v[44:47], v[212:215], v[148:151]
v_cvt_pk_bf16_f32 v29, v30, v31
v_cvt_pk_bf16_f32 v30, v32, v33
v_mfma_f32_16x16x32_bf16 v[152:155], v[44:47], v[216:219], v[152:155]
v_cvt_pk_bf16_f32 v31, v34, v35
v_mfma_f32_16x16x32_bf16 v[156:159], v[44:47], v[220:223], v[156:159]
s_waitcnt lgkmcnt(4)
v_mfma_f32_16x16x32_bf16 v[160:163], v[48:51], v[208:211], v[160:163]
ds_read_b64_tr_b16 v[40:41], v10 offset:49152
ds_read_b64_tr_b16 v[42:43], v10 offset:50176
v_mfma_f32_16x16x32_bf16 v[164:167], v[48:51], v[212:215], v[164:167]
buffer_store_dwordx4 v[28:31], v7, s[12:15], s76 offen offset:256
v_mfma_f32_16x16x32_bf16 v[168:171], v[48:51], v[216:219], v[168:171]
buffer_store_dwordx4 v[28:31], v7, s[12:15], s97 offen offset:256 sc1
v_mfma_f32_16x16x32_bf16 v[172:175], v[48:51], v[220:223], v[172:175]
s_add_u32 m0, s58, 32768
v_mfma_f32_16x16x32_bf16 v[176:179], v[52:55], v[208:211], v[176:179]
ds_read_b64_tr_b16 v[44:45], v11 offset:49152
ds_read_b64_tr_b16 v[46:47], v11 offset:50176
v_mfma_f32_16x16x32_bf16 v[180:183], v[52:55], v[212:215], v[180:183]
buffer_load_dwordx4 v38, s[4:7], s29 offen offset:0 sc1 lds
v_mfma_f32_16x16x32_bf16 v[184:187], v[52:55], v[216:219], v[184:187]
buffer_load_dwordx4 v38, s[4:7], s29 offen offset:1024 sc1 lds
buffer_load_dwordx4 v38, s[4:7], s29 offen offset:2048 sc1 lds
buffer_load_dwordx4 v38, s[4:7], s29 offen offset:3072 sc1 lds
s_add_u32 s29, s29, 16384
v_mfma_f32_16x16x32_bf16 v[188:191], v[52:55], v[220:223], v[188:191]
s_waitcnt lgkmcnt(4)
s_waitcnt vmcnt(37)
v_mfma_f32_16x16x32_bf16 v[64:67], v[56:59], v[224:227], v[64:67]
ds_read_b64_tr_b16 v[48:49], v12 offset:49152
ds_read_b64_tr_b16 v[50:51], v12 offset:50176
v_mfma_f32_16x16x32_bf16 v[68:71], v[56:59], v[228:231], v[68:71]
v_accvgpr_read_b32 v20, a240
v_accvgpr_read_b32 v21, a241
v_mfma_f32_16x16x32_bf16 v[72:75], v[56:59], v[232:235], v[72:75]
v_accvgpr_read_b32 v22, a242
v_accvgpr_read_b32 v23, a243
v_mfma_f32_16x16x32_bf16 v[76:79], v[56:59], v[236:239], v[76:79]
v_accvgpr_read_b32 v24, a244
v_accvgpr_read_b32 v25, a245
v_mfma_f32_16x16x32_bf16 v[80:83], v[60:63], v[224:227], v[80:83]
ds_read_b64_tr_b16 v[52:53], v13 offset:49152
ds_read_b64_tr_b16 v[54:55], v13 offset:50176
v_mfma_f32_16x16x32_bf16 v[84:87], v[60:63], v[228:231], v[84:87]
v_accvgpr_read_b32 v26, a246
v_accvgpr_read_b32 v27, a247
v_mfma_f32_16x16x32_bf16 v[88:91], v[60:63], v[232:235], v[88:91]
v_cvt_pk_bf16_f32 v20, v20, v21
v_cvt_pk_bf16_f32 v21, v22, v23
v_mfma_f32_16x16x32_bf16 v[92:95], v[60:63], v[236:239], v[92:95]
s_waitcnt lgkmcnt(4)
v_cvt_pk_bf16_f32 v22, v24, v25
v_mfma_f32_16x16x32_bf16 v[96:99], v[40:43], v[224:227], v[96:99]
ds_read_b64_tr_b16 v[56:57], v14 offset:49152
ds_read_b64_tr_b16 v[58:59], v14 offset:50176
v_mfma_f32_16x16x32_bf16 v[100:103], v[40:43], v[228:231], v[100:103]
v_cvt_pk_bf16_f32 v23, v26, v27
v_mfma_f32_16x16x32_bf16 v[104:107], v[40:43], v[232:235], v[104:107]
buffer_store_dwordx4 v[20:23], v7, s[12:15], s76 offen offset:2048
v_mfma_f32_16x16x32_bf16 v[108:111], v[40:43], v[236:239], v[108:111]
buffer_store_dwordx4 v[20:23], v7, s[12:15], s97 offen offset:2048 sc1
v_mfma_f32_16x16x32_bf16 v[112:115], v[44:47], v[224:227], v[112:115]
ds_read_b64_tr_b16 v[60:61], v15 offset:49152
ds_read_b64_tr_b16 v[62:63], v15 offset:50176
v_mfma_f32_16x16x32_bf16 v[116:119], v[44:47], v[228:231], v[116:119]
v_accvgpr_read_b32 v28, a248
v_accvgpr_read_b32 v29, a249
v_mfma_f32_16x16x32_bf16 v[120:123], v[44:47], v[232:235], v[120:123]
v_accvgpr_read_b32 v30, a250
v_accvgpr_read_b32 v31, a251
v_mfma_f32_16x16x32_bf16 v[124:127], v[44:47], v[236:239], v[124:127]
s_waitcnt lgkmcnt(4)
v_accvgpr_read_b32 v32, a252
v_mfma_f32_16x16x32_bf16 v[128:131], v[48:51], v[224:227], v[128:131]
ds_read_b64_tr_b16 v[40:41], v8 offset:57344
ds_read_b64_tr_b16 v[42:43], v8 offset:58368
v_mfma_f32_16x16x32_bf16 v[132:135], v[48:51], v[228:231], v[132:135]
v_accvgpr_read_b32 v33, a253
v_accvgpr_read_b32 v34, a254
v_mfma_f32_16x16x32_bf16 v[136:139], v[48:51], v[232:235], v[136:139]
v_accvgpr_read_b32 v35, a255
v_cvt_pk_bf16_f32 v28, v28, v29
v_mfma_f32_16x16x32_bf16 v[140:143], v[48:51], v[236:239], v[140:143]
v_cvt_pk_bf16_f32 v29, v30, v31
v_cvt_pk_bf16_f32 v30, v32, v33
v_mfma_f32_16x16x32_bf16 v[144:147], v[52:55], v[224:227], v[144:147]
ds_read_b64_tr_b16 v[44:45], v9 offset:57344
ds_read_b64_tr_b16 v[46:47], v9 offset:58368
v_mfma_f32_16x16x32_bf16 v[148:151], v[52:55], v[228:231], v[148:151]
v_cvt_pk_bf16_f32 v31, v34, v35
v_mfma_f32_16x16x32_bf16 v[152:155], v[52:55], v[232:235], v[152:155]
buffer_store_dwordx4 v[28:31], v7, s[12:15], s76 offen offset:2304
v_mfma_f32_16x16x32_bf16 v[156:159], v[52:55], v[236:239], v[156:159]
s_waitcnt lgkmcnt(4)
v_mfma_f32_16x16x32_bf16 v[160:163], v[56:59], v[224:227], v[160:163]
ds_read_b64_tr_b16 v[48:49], v10 offset:57344
ds_read_b64_tr_b16 v[50:51], v10 offset:58368
v_mfma_f32_16x16x32_bf16 v[164:167], v[56:59], v[228:231], v[164:167]
buffer_store_dwordx4 v[28:31], v7, s[12:15], s97 offen offset:2304 sc1
v_mfma_f32_16x16x32_bf16 v[168:171], v[56:59], v[232:235], v[168:171]
s_add_u32 m0, s58, 49152
v_mfma_f32_16x16x32_bf16 v[172:175], v[56:59], v[236:239], v[172:175]
buffer_load_dwordx4 v38, s[4:7], s29 offen offset:0 sc1 lds
v_mfma_f32_16x16x32_bf16 v[176:179], v[60:63], v[224:227], v[176:179]
ds_read_b64_tr_b16 v[52:53], v11 offset:57344
ds_read_b64_tr_b16 v[54:55], v11 offset:58368
v_mfma_f32_16x16x32_bf16 v[180:183], v[60:63], v[228:231], v[180:183]
buffer_load_dwordx4 v38, s[4:7], s29 offen offset:1024 sc1 lds
v_mfma_f32_16x16x32_bf16 v[184:187], v[60:63], v[232:235], v[184:187]
buffer_load_dwordx4 v38, s[4:7], s29 offen offset:2048 sc1 lds
buffer_load_dwordx4 v38, s[4:7], s29 offen offset:3072 sc1 lds
s_add_u32 s29, s29, 16384
buffer_load_dword v39, v3, s[60:63], s36 offen sc1
v_mfma_f32_16x16x32_bf16 v[188:191], v[60:63], v[236:239], v[188:191]
s_waitcnt lgkmcnt(4)
s_waitcnt vmcnt(37)
v_mfma_f32_16x16x32_bf16 v[64:67], v[40:43], v[240:243], v[64:67]
ds_read_b64_tr_b16 v[56:57], v12 offset:57344
ds_read_b64_tr_b16 v[58:59], v12 offset:58368
v_mfma_f32_16x16x32_bf16 v[68:71], v[40:43], v[244:247], v[68:71]
s_add_u32 m0, s58, 65536
v_mfma_f32_16x16x32_bf16 v[72:75], v[40:43], v[248:251], v[72:75]
buffer_load_dwordx4 v38, s[4:7], s29 offen offset:0 sc1 lds
v_mfma_f32_16x16x32_bf16 v[76:79], v[40:43], v[252:255], v[76:79]
buffer_load_dwordx4 v38, s[4:7], s29 offen offset:1024 sc1 lds
v_mfma_f32_16x16x32_bf16 v[80:83], v[44:47], v[240:243], v[80:83]
ds_read_b64_tr_b16 v[60:61], v13 offset:57344
ds_read_b64_tr_b16 v[62:63], v13 offset:58368
v_mfma_f32_16x16x32_bf16 v[84:87], v[44:47], v[244:247], v[84:87]
buffer_load_dwordx4 v38, s[4:7], s29 offen offset:2048 sc1 lds
v_mfma_f32_16x16x32_bf16 v[88:91], v[44:47], v[248:251], v[88:91]
buffer_load_dwordx4 v38, s[4:7], s29 offen offset:3072 sc1 lds
v_mfma_f32_16x16x32_bf16 v[92:95], v[44:47], v[252:255], v[92:95]
s_waitcnt lgkmcnt(4)
s_add_u32 s29, s29, 16384
v_mfma_f32_16x16x32_bf16 v[96:99], v[48:51], v[240:243], v[96:99]
ds_read_b64_tr_b16 v[40:41], v14 offset:57344
ds_read_b64_tr_b16 v[42:43], v14 offset:58368
v_mfma_f32_16x16x32_bf16 v[100:103], v[48:51], v[244:247], v[100:103]
buffer_load_dword v39, v3, s[60:63], s36 offen sc1
v_mfma_f32_16x16x32_bf16 v[104:107], v[48:51], v[248:251], v[104:107]
v_mfma_f32_16x16x32_bf16 v[108:111], v[48:51], v[252:255], v[108:111]
v_mfma_f32_16x16x32_bf16 v[112:115], v[52:55], v[240:243], v[112:115]
ds_read_b64_tr_b16 v[44:45], v15 offset:57344
ds_read_b64_tr_b16 v[46:47], v15 offset:58368
v_mfma_f32_16x16x32_bf16 v[116:119], v[52:55], v[244:247], v[116:119]
v_mfma_f32_16x16x32_bf16 v[120:123], v[52:55], v[248:251], v[120:123]
v_mfma_f32_16x16x32_bf16 v[124:127], v[52:55], v[252:255], v[124:127]
s_waitcnt lgkmcnt(4)
v_mfma_f32_16x16x32_bf16 v[128:131], v[56:59], v[240:243], v[128:131]
v_add_u32 v8, 0x10000, v8
ds_read_b64_tr_b16 v[48:49], v8 offset:0
ds_read_b64_tr_b16 v[50:51], v8 offset:1024
v_mfma_f32_16x16x32_bf16 v[132:135], v[56:59], v[244:247], v[132:135]
v_mfma_f32_16x16x32_bf16 v[136:139], v[56:59], v[248:251], v[136:139]
v_mfma_f32_16x16x32_bf16 v[140:143], v[56:59], v[252:255], v[140:143]
v_mfma_f32_16x16x32_bf16 v[144:147], v[60:63], v[240:243], v[144:147]
v_add_u32 v9, 0x10000, v9
ds_read_b64_tr_b16 v[52:53], v9 offset:0
ds_read_b64_tr_b16 v[54:55], v9 offset:1024
v_mfma_f32_16x16x32_bf16 v[148:151], v[60:63], v[244:247], v[148:151]
v_mfma_f32_16x16x32_bf16 v[152:155], v[60:63], v[248:251], v[152:155]
v_mfma_f32_16x16x32_bf16 v[156:159], v[60:63], v[252:255], v[156:159]
s_waitcnt lgkmcnt(4)
v_mfma_f32_16x16x32_bf16 v[160:163], v[40:43], v[240:243], v[160:163]
v_add_u32 v10, 0x10000, v10
ds_read_b64_tr_b16 v[56:57], v10 offset:0
ds_read_b64_tr_b16 v[58:59], v10 offset:1024
v_mfma_f32_16x16x32_bf16 v[164:167], v[40:43], v[244:247], v[164:167]
v_mfma_f32_16x16x32_bf16 v[168:171], v[40:43], v[248:251], v[168:171]
v_mfma_f32_16x16x32_bf16 v[172:175], v[40:43], v[252:255], v[172:175]
v_mfma_f32_16x16x32_bf16 v[176:179], v[44:47], v[240:243], v[176:179]
v_add_u32 v11, 0x10000, v11
ds_read_b64_tr_b16 v[60:61], v11 offset:0
ds_read_b64_tr_b16 v[62:63], v11 offset:1024
v_mfma_f32_16x16x32_bf16 v[180:183], v[44:47], v[244:247], v[180:183]
v_mfma_f32_16x16x32_bf16 v[184:187], v[44:47], v[248:251], v[184:187]
v_mfma_f32_16x16x32_bf16 v[188:191], v[44:47], v[252:255], v[188:191]
s_waitcnt lgkmcnt(4)
s_waitcnt vmcnt(34)
v_mfma_f32_16x16x32_bf16 v[64:67], v[48:51], a[0:3], v[64:67]
v_add_u32 v12, 0x10000, v12
ds_read_b64_tr_b16 v[40:41], v12 offset:0
ds_read_b64_tr_b16 v[42:43], v12 offset:1024
v_mfma_f32_16x16x32_bf16 v[68:71], v[48:51], a[4:7], v[68:71]
s_add_u32 m0, s58, 81920
v_mfma_f32_16x16x32_bf16 v[72:75], v[48:51], a[8:11], v[72:75]
buffer_load_dwordx4 v38, s[4:7], s29 offen offset:0 sc1 lds
v_mfma_f32_16x16x32_bf16 v[76:79], v[48:51], a[12:15], v[76:79]
buffer_load_dwordx4 v38, s[4:7], s29 offen offset:1024 sc1 lds
v_mfma_f32_16x16x32_bf16 v[80:83], v[52:55], a[0:3], v[80:83]
v_add_u32 v13, 0x10000, v13
ds_read_b64_tr_b16 v[44:45], v13 offset:0
ds_read_b64_tr_b16 v[46:47], v13 offset:1024
v_mfma_f32_16x16x32_bf16 v[84:87], v[52:55], a[4:7], v[84:87]
buffer_load_dwordx4 v38, s[4:7], s29 offen offset:2048 sc1 lds
v_mfma_f32_16x16x32_bf16 v[88:91], v[52:55], a[8:11], v[88:91]
buffer_load_dwordx4 v38, s[4:7], s29 offen offset:3072 sc1 lds
v_mfma_f32_16x16x32_bf16 v[92:95], v[52:55], a[12:15], v[92:95]
s_waitcnt lgkmcnt(4)
s_add_u32 s29, s29, 16384
v_mfma_f32_16x16x32_bf16 v[96:99], v[56:59], a[0:3], v[96:99]
v_add_u32 v14, 0x10000, v14
ds_read_b64_tr_b16 v[48:49], v14 offset:0
ds_read_b64_tr_b16 v[50:51], v14 offset:1024
v_mfma_f32_16x16x32_bf16 v[100:103], v[56:59], a[4:7], v[100:103]
buffer_load_dword v39, v3, s[60:63], s36 offen sc1
v_mfma_f32_16x16x32_bf16 v[104:107], v[56:59], a[8:11], v[104:107]
v_mfma_f32_16x16x32_bf16 v[108:111], v[56:59], a[12:15], v[108:111]
v_mfma_f32_16x16x32_bf16 v[112:115], v[60:63], a[0:3], v[112:115]
v_add_u32 v15, 0x10000, v15
ds_read_b64_tr_b16 v[52:53], v15 offset:0
ds_read_b64_tr_b16 v[54:55], v15 offset:1024
v_mfma_f32_16x16x32_bf16 v[116:119], v[60:63], a[4:7], v[116:119]
v_mfma_f32_16x16x32_bf16 v[120:123], v[60:63], a[8:11], v[120:123]
v_mfma_f32_16x16x32_bf16 v[124:127], v[60:63], a[12:15], v[124:127]
s_waitcnt lgkmcnt(4)
v_mfma_f32_16x16x32_bf16 v[128:131], v[40:43], a[0:3], v[128:131]
ds_read_b64_tr_b16 v[56:57], v8 offset:8192
ds_read_b64_tr_b16 v[58:59], v8 offset:9216
v_mfma_f32_16x16x32_bf16 v[132:135], v[40:43], a[4:7], v[132:135]
v_mfma_f32_16x16x32_bf16 v[136:139], v[40:43], a[8:11], v[136:139]
v_mfma_f32_16x16x32_bf16 v[140:143], v[40:43], a[12:15], v[140:143]
v_mfma_f32_16x16x32_bf16 v[144:147], v[44:47], a[0:3], v[144:147]
ds_read_b64_tr_b16 v[60:61], v9 offset:8192
ds_read_b64_tr_b16 v[62:63], v9 offset:9216
v_mfma_f32_16x16x32_bf16 v[148:151], v[44:47], a[4:7], v[148:151]
v_mfma_f32_16x16x32_bf16 v[152:155], v[44:47], a[8:11], v[152:155]
v_mfma_f32_16x16x32_bf16 v[156:159], v[44:47], a[12:15], v[156:159]
s_waitcnt lgkmcnt(4)
v_mfma_f32_16x16x32_bf16 v[160:163], v[48:51], a[0:3], v[160:163]
ds_read_b64_tr_b16 v[40:41], v10 offset:8192
ds_read_b64_tr_b16 v[42:43], v10 offset:9216
v_mfma_f32_16x16x32_bf16 v[164:167], v[48:51], a[4:7], v[164:167]
v_mfma_f32_16x16x32_bf16 v[168:171], v[48:51], a[8:11], v[168:171]
v_mfma_f32_16x16x32_bf16 v[172:175], v[48:51], a[12:15], v[172:175]
v_mfma_f32_16x16x32_bf16 v[176:179], v[52:55], a[0:3], v[176:179]
ds_read_b64_tr_b16 v[44:45], v11 offset:8192
ds_read_b64_tr_b16 v[46:47], v11 offset:9216
v_mfma_f32_16x16x32_bf16 v[180:183], v[52:55], a[4:7], v[180:183]
v_mfma_f32_16x16x32_bf16 v[184:187], v[52:55], a[8:11], v[184:187]
v_mfma_f32_16x16x32_bf16 v[188:191], v[52:55], a[12:15], v[188:191]
s_waitcnt lgkmcnt(4)
s_waitcnt vmcnt(31)
v_mfma_f32_16x16x32_bf16 v[64:67], v[56:59], a[16:19], v[64:67]
ds_read_b64_tr_b16 v[48:49], v12 offset:8192
ds_read_b64_tr_b16 v[50:51], v12 offset:9216
v_mfma_f32_16x16x32_bf16 v[68:71], v[56:59], a[20:23], v[68:71]
v_mfma_f32_16x16x32_bf16 v[72:75], v[56:59], a[24:27], v[72:75]
v_mfma_f32_16x16x32_bf16 v[76:79], v[56:59], a[28:31], v[76:79]
v_mfma_f32_16x16x32_bf16 v[80:83], v[60:63], a[16:19], v[80:83]
ds_read_b64_tr_b16 v[52:53], v13 offset:8192
ds_read_b64_tr_b16 v[54:55], v13 offset:9216
v_mfma_f32_16x16x32_bf16 v[84:87], v[60:63], a[20:23], v[84:87]
v_mfma_f32_16x16x32_bf16 v[88:91], v[60:63], a[24:27], v[88:91]
v_mfma_f32_16x16x32_bf16 v[92:95], v[60:63], a[28:31], v[92:95]
s_waitcnt lgkmcnt(4)
v_mfma_f32_16x16x32_bf16 v[96:99], v[40:43], a[16:19], v[96:99]
ds_read_b64_tr_b16 v[56:57], v14 offset:8192
ds_read_b64_tr_b16 v[58:59], v14 offset:9216
v_mfma_f32_16x16x32_bf16 v[100:103], v[40:43], a[20:23], v[100:103]
v_mfma_f32_16x16x32_bf16 v[104:107], v[40:43], a[24:27], v[104:107]
v_mfma_f32_16x16x32_bf16 v[108:111], v[40:43], a[28:31], v[108:111]
v_cvt_pk_bf16_f32 v192, v64, v65
v_cvt_pk_bf16_f32 v193, v66, v67
v_mfma_f32_16x16x32_bf16 v[112:115], v[44:47], a[16:19], v[112:115]
ds_read_b64_tr_b16 v[60:61], v15 offset:8192
ds_read_b64_tr_b16 v[62:63], v15 offset:9216
v_mfma_f32_16x16x32_bf16 v[116:119], v[44:47], a[20:23], v[116:119]
v_cvt_pk_bf16_f32 v194, v80, v81
v_cvt_pk_bf16_f32 v195, v82, v83
v_mfma_f32_16x16x32_bf16 v[120:123], v[44:47], a[24:27], v[120:123]
v_cvt_pk_bf16_f32 v196, v68, v69
v_cvt_pk_bf16_f32 v197, v70, v71
v_mfma_f32_16x16x32_bf16 v[124:127], v[44:47], a[28:31], v[124:127]
s_waitcnt lgkmcnt(4)
v_cvt_pk_bf16_f32 v198, v84, v85
v_mfma_f32_16x16x32_bf16 v[128:131], v[48:51], a[16:19], v[128:131]
v_cvt_pk_bf16_f32 v199, v86, v87
v_cvt_pk_bf16_f32 v224, v72, v73
v_mfma_f32_16x16x32_bf16 v[132:135], v[48:51], a[20:23], v[132:135]
v_cvt_pk_bf16_f32 v225, v74, v75
v_cvt_pk_bf16_f32 v226, v88, v89
v_mfma_f32_16x16x32_bf16 v[136:139], v[48:51], a[24:27], v[136:139]
v_cvt_pk_bf16_f32 v227, v90, v91
v_cvt_pk_bf16_f32 v228, v76, v77
v_mfma_f32_16x16x32_bf16 v[140:143], v[48:51], a[28:31], v[140:143]
v_cvt_pk_bf16_f32 v229, v78, v79
v_cvt_pk_bf16_f32 v230, v92, v93
v_mfma_f32_16x16x32_bf16 v[144:147], v[52:55], a[16:19], v[144:147]
v_cvt_pk_bf16_f32 v231, v94, v95
v_permlane16_swap_b32 v192, v196
v_mfma_f32_16x16x32_bf16 v[148:151], v[52:55], a[20:23], v[148:151]
v_permlane16_swap_b32 v193, v197
v_permlane16_swap_b32 v194, v198
v_mfma_f32_16x16x32_bf16 v[152:155], v[52:55], a[24:27], v[152:155]
v_permlane16_swap_b32 v195, v199
v_permlane16_swap_b32 v224, v228
v_mfma_f32_16x16x32_bf16 v[156:159], v[52:55], a[28:31], v[156:159]
s_waitcnt lgkmcnt(0)
v_permlane16_swap_b32 v225, v229
v_mfma_f32_16x16x32_bf16 v[160:163], v[56:59], a[16:19], v[160:163]
v_permlane16_swap_b32 v226, v230
v_permlane16_swap_b32 v227, v231
v_mfma_f32_16x16x32_bf16 v[164:167], v[56:59], a[20:23], v[164:167]
v_cvt_pk_bf16_f32 v200, v96, v97
v_cvt_pk_bf16_f32 v201, v98, v99
v_mfma_f32_16x16x32_bf16 v[168:171], v[56:59], a[24:27], v[168:171]
v_cvt_pk_bf16_f32 v202, v112, v113
v_cvt_pk_bf16_f32 v203, v114, v115
v_mfma_f32_16x16x32_bf16 v[172:175], v[56:59], a[28:31], v[172:175]
v_cvt_pk_bf16_f32 v204, v100, v101
v_cvt_pk_bf16_f32 v205, v102, v103
v_mfma_f32_16x16x32_bf16 v[176:179], v[60:63], a[16:19], v[176:179]
v_cvt_pk_bf16_f32 v206, v116, v117
v_cvt_pk_bf16_f32 v207, v118, v119
v_mfma_f32_16x16x32_bf16 v[180:183], v[60:63], a[20:23], v[180:183]
v_cvt_pk_bf16_f32 v232, v104, v105
v_cvt_pk_bf16_f32 v233, v106, v107
v_mfma_f32_16x16x32_bf16 v[184:187], v[60:63], a[24:27], v[184:187]
v_cvt_pk_bf16_f32 v234, v120, v121
v_cvt_pk_bf16_f32 v235, v122, v123
v_mfma_f32_16x16x32_bf16 v[188:191], v[60:63], a[28:31], v[188:191]
v_cvt_pk_bf16_f32 v236, v108, v109
v_cvt_pk_bf16_f32 v237, v110, v111
v_cvt_pk_bf16_f32 v238, v124, v125
v_cvt_pk_bf16_f32 v239, v126, v127
v_permlane16_swap_b32 v200, v204
v_permlane16_swap_b32 v201, v205
v_permlane16_swap_b32 v202, v206
v_permlane16_swap_b32 v203, v207
v_permlane16_swap_b32 v232, v236
v_permlane16_swap_b32 v233, v237
v_permlane16_swap_b32 v234, v238
v_permlane16_swap_b32 v235, v239
v_cvt_pk_bf16_f32 v208, v128, v129
v_cvt_pk_bf16_f32 v209, v130, v131
v_cvt_pk_bf16_f32 v210, v144, v145
v_cvt_pk_bf16_f32 v211, v146, v147
v_cvt_pk_bf16_f32 v212, v132, v133
v_cvt_pk_bf16_f32 v213, v134, v135
v_cvt_pk_bf16_f32 v214, v148, v149
v_cvt_pk_bf16_f32 v215, v150, v151
v_cvt_pk_bf16_f32 v240, v136, v137
v_cvt_pk_bf16_f32 v241, v138, v139
v_cvt_pk_bf16_f32 v242, v152, v153
v_cvt_pk_bf16_f32 v243, v154, v155
v_cvt_pk_bf16_f32 v244, v140, v141
v_cvt_pk_bf16_f32 v245, v142, v143
v_cvt_pk_bf16_f32 v246, v156, v157
v_cvt_pk_bf16_f32 v247, v158, v159
v_permlane16_swap_b32 v208, v212
v_permlane16_swap_b32 v209, v213
v_permlane16_swap_b32 v210, v214
v_permlane16_swap_b32 v211, v215
v_permlane16_swap_b32 v240, v244
v_permlane16_swap_b32 v241, v245
v_permlane16_swap_b32 v242, v246
v_permlane16_swap_b32 v243, v247
v_mov_b32 v28, 0
v_mov_b32 v29, 0
v_mov_b32 v30, 0
v_mov_b32 v31, 0
s_mov_b32 s30, 16384
v_add_u32 v21, s30, v3
s_add_u32 s30, s30, s58
v_mfma_f32_32x32x16_bf16 a[0:15], v[28:31], v[28:31], 0
v_mov_b32 v1, 2
s_mov_b32 s38, 0x2f800000
s_mov_b32 s39, 0x2f800000
s_mov_b32 s31, 0
s_min_u32 s34, s27, 9
v_mfma_f32_32x32x16_bf16 a[16:31], v[28:31], v[28:31], 0
v_cvt_pk_bf16_f32 v216, v160, v161
v_cvt_pk_bf16_f32 v217, v162, v163
v_cvt_pk_bf16_f32 v218, v176, v177
v_cvt_pk_bf16_f32 v219, v178, v179
v_cvt_pk_bf16_f32 v220, v164, v165
v_cvt_pk_bf16_f32 v221, v166, v167
v_mfma_f32_32x32x16_bf16 a[32:47], v[28:31], v[28:31], 0
v_cvt_pk_bf16_f32 v222, v180, v181
v_cvt_pk_bf16_f32 v223, v182, v183
v_cvt_pk_bf16_f32 v248, v168, v169
v_cvt_pk_bf16_f32 v249, v170, v171
v_cvt_pk_bf16_f32 v250, v184, v185
v_cvt_pk_bf16_f32 v251, v186, v187
v_mfma_f32_32x32x16_bf16 a[48:63], v[28:31], v[28:31], 0
v_cvt_pk_bf16_f32 v252, v172, v173
v_cvt_pk_bf16_f32 v253, v174, v175
v_cvt_pk_bf16_f32 v254, v188, v189
v_cvt_pk_bf16_f32 v255, v190, v191
v_permlane16_swap_b32 v216, v220
v_permlane16_swap_b32 v217, v221
v_mfma_f32_32x32x16_bf16 a[64:79], v[28:31], v[28:31], 0
v_permlane16_swap_b32 v218, v222
v_permlane16_swap_b32 v219, v223
v_permlane16_swap_b32 v248, v252
v_permlane16_swap_b32 v249, v253
v_permlane16_swap_b32 v250, v254
v_permlane16_swap_b32 v251, v255
v_mfma_f32_32x32x16_bf16 a[80:95], v[28:31], v[28:31], 0
s_waitcnt vmcnt(15)
s_barrier
buffer_store_dword v1, v0, s[64:67], s59 offen sc1
v_mfma_f32_32x32x16_bf16 a[96:111], v[28:31], v[28:31], 0
ds_read_b128 a[128:131], v21 offset:0
ds_read_b128 a[132:135], v21 offset:1024
ds_read_b128 a[136:139], v21 offset:2048
ds_read_b128 a[140:143], v21 offset:3072
ds_read_b128 a[144:147], v21 offset:4096
ds_read_b128 a[148:151], v21 offset:5120
v_mfma_f32_32x32x16_bf16 a[112:127], v[28:31], v[28:31], 0
ds_read_b128 a[152:155], v21 offset:6144
ds_read_b128 a[156:159], v21 offset:7168
v_mfma_f32_32x32x16_bf16 v[96:111], v[28:31], v[28:31], 0
ds_read_b128 a[160:163], v21 offset:8192
ds_read_b128 a[164:167], v21 offset:9216
ds_read_b128 a[168:171], v21 offset:10240
ds_read_b128 a[172:175], v21 offset:11264
ds_read_b128 a[176:179], v21 offset:12288
ds_read_b128 a[180:183], v21 offset:13312
v_mfma_f32_32x32x16_bf16 v[112:127], v[28:31], v[28:31], 0
ds_read_b128 a[184:187], v21 offset:14336
ds_read_b128 a[188:191], v21 offset:15360
v_mov_b32 v160, 0
v_mov_b32 v161, 0
v_mov_b32 v170, v3
v_lshl_add_u32 v171, v3, 3, s54
v_cmp_gt_u32 vcc, 352, v3
v_mov_b32 v172, 0x40000000
s_nop 0
v_cndmask_b32 v171, v172, v171, vcc
s_add_u32 s68, s74, 37748736
s_addc_u32 s69, s75, 0
s_mov_b32 s70, 16777216
s_mov_b32 s71, 0x20000
s_cmp_lg_u32 s27, 0
s_cbranch_scc1 k12_kernel_nm0
s_nop 7
s_nop 3
v_mov_b32 v24, 0xff800000
v_cmp_gt_i32 s[40:41], 0, v5
v_cmp_gt_i32 s[42:43], 1, v5
v_cmp_gt_i32 s[44:45], 2, v5
v_cmp_gt_i32 s[46:47], 3, v5
v_cndmask_b32 v96, v96, v24, s[40:41]
v_cndmask_b32 v97, v97, v24, s[42:43]
v_cndmask_b32 v98, v98, v24, s[44:45]
v_cndmask_b32 v99, v99, v24, s[46:47]
v_cmp_gt_i32 s[40:41], 8, v5
v_cmp_gt_i32 s[42:43], 9, v5
v_cmp_gt_i32 s[44:45], 10, v5
v_cmp_gt_i32 s[46:47], 11, v5
v_cndmask_b32 v100, v100, v24, s[40:41]
v_cndmask_b32 v101, v101, v24, s[42:43]
v_cndmask_b32 v102, v102, v24, s[44:45]
v_cndmask_b32 v103, v103, v24, s[46:47]
v_cmp_gt_i32 s[40:41], 16, v5
v_cmp_gt_i32 s[42:43], 17, v5
v_cmp_gt_i32 s[44:45], 18, v5
v_cmp_gt_i32 s[46:47], 19, v5
v_cndmask_b32 v104, v104, v24, s[40:41]
v_cndmask_b32 v105, v105, v24, s[42:43]
v_cndmask_b32 v106, v106, v24, s[44:45]
v_cndmask_b32 v107, v107, v24, s[46:47]
v_cmp_gt_i32 s[40:41], 24, v5
v_cmp_gt_i32 s[42:43], 25, v5
v_cmp_gt_i32 s[44:45], 26, v5
v_cmp_gt_i32 s[46:47], 27, v5
v_cndmask_b32 v108, v108, v24, s[40:41]
v_cndmask_b32 v109, v109, v24, s[42:43]
v_cndmask_b32 v110, v110, v24, s[44:45]
v_cndmask_b32 v111, v111, v24, s[46:47]
s_nop 1
k12_kernel_nm0:
s_waitcnt lgkmcnt(8)
s_nop 7
v_mfma_f32_32x32x16_bf16 v[64:79], a[128:131], v[192:195], v[96:111]
v_mfma_f32_32x32x16_bf16 v[64:79], a[132:135], v[196:199], v[64:79]
v_mfma_f32_32x32x16_bf16 v[64:79], a[136:139], v[200:203], v[64:79]
v_mfma_f32_32x32x16_bf16 v[64:79], a[140:143], v[204:207], v[64:79]
v_mfma_f32_32x32x16_bf16 v[64:79], a[144:147], v[208:211], v[64:79]
v_mfma_f32_32x32x16_bf16 v[64:79], a[148:151], v[212:215], v[64:79]
v_mfma_f32_32x32x16_bf16 v[64:79], a[152:155], v[216:219], v[64:79]
v_mfma_f32_32x32x16_bf16 v[64:79], a[156:159], v[220:223], v[64:79]
s_nop 7
s_nop 3
v_exp_f32 v128, v64
v_exp_f32 v129, v65
v_exp_f32 v130, v66
v_exp_f32 v131, v67
v_exp_f32 v132, v68
v_exp_f32 v133, v69
v_exp_f32 v134, v70
v_exp_f32 v135, v71
v_add_f32 v162, v128, v129
v_add_f32 v162, v162, v130
v_add_f32 v162, v162, v131
v_add_f32 v162, v162, v132
v_add_f32 v162, v162, v133
v_add_f32 v162, v162, v134
v_add_f32 v162, v162, v135
v_cvt_pk_bf16_f32 v144, v128, v129
v_cvt_pk_bf16_f32 v145, v130, v131
v_cvt_pk_bf16_f32 v146, v132, v133
v_cvt_pk_bf16_f32 v147, v134, v135
s_waitcnt lgkmcnt(0)
s_branch k12_kernel_LB
.p2align 6
k12_kernel_LA:
s_cmp_eq_u32 s31, s27
s_cbranch_scc1 k12_kernel_maskA
k12_kernel_maskA_bk:
s_waitcnt lgkmcnt(0)
v_mfma_f32_32x32x16_bf16 v[64:79], a[128:131], v[192:195], v[96:111]
v_exp_f32 v136, v88
v_mfma_f32_32x32x16_bf16 v[64:79], a[132:135], v[196:199], v[64:79]
v_exp_f32 v137, v89
v_exp_f32 v138, v90
v_mfma_f32_32x32x16_bf16 v[64:79], a[136:139], v[200:203], v[64:79]
v_exp_f32 v139, v91
v_exp_f32 v140, v92
v_add_f32 v162, v162, v136
v_mfma_f32_32x32x16_bf16 v[64:79], a[140:143], v[204:207], v[64:79]
v_exp_f32 v141, v93
v_add_f32 v162, v162, v137
v_add_f32 v162, v162, v138
v_cvt_pk_bf16_f32 v156, v136, v137
v_mfma_f32_32x32x16_bf16 v[64:79], a[144:147], v[208:211], v[64:79]
v_exp_f32 v142, v94
v_add_f32 v162, v162, v139
v_add_f32 v162, v162, v140
v_cvt_pk_bf16_f32 v157, v138, v139
v_mfma_f32_32x32x16_bf16 v[64:79], a[148:151], v[212:215], v[64:79]
v_exp_f32 v143, v95
v_add_f32 v162, v162, v141
v_add_f32 v162, v162, v142
v_cvt_pk_bf16_f32 v158, v140, v141
v_mfma_f32_32x32x16_bf16 v[64:79], a[152:155], v[216:219], v[64:79]
v_add_f32 v162, v162, v143
v_cvt_pk_bf16_f32 v159, v142, v143
v_med3_f32 v163, v162, s38, v4
v_cmp_neq_f32 vcc, v163, v162
v_mfma_f32_32x32x16_bf16 v[64:79], a[156:159], v[220:223], v[64:79]
s_cbranch_vccnz k12_kernel_fb_dA
k12_kernel_bk_dA:
s_lshr_b64 s[38:39], s[38:39], 32
tp0_p10:
s_cbranch_execz tp0_ret
v_add_f32 v161, v161, v162
v_mfma_f32_32x32x16_bf16 a[64:79], a[160:163], v[152:155], a[64:79]
ds_read_b128 a[160:163], v21 offset:8192
v_mfma_f32_32x32x16_bf16 a[80:95], a[168:171], v[152:155], a[80:95]
ds_read_b128 a[168:171], v21 offset:10240
v_exp_f32 v128, v64
v_exp_f32 v129, v65
v_mfma_f32_32x32x16_bf16 a[96:111], a[176:179], v[152:155], a[96:111]
ds_read_b128 a[176:179], v21 offset:12288
v_exp_f32 v130, v66
v_add_f32 v162, v128, v129
v_cvt_pk_bf16_f32 v144, v128, v129
v_mfma_f32_32x32x16_bf16 a[112:127], a[184:187], v[152:155], a[112:127]
ds_read_b128 a[184:187], v21 offset:14336
v_exp_f32 v131, v67
v_exp_f32 v132, v68
v_mfma_f32_32x32x16_bf16 a[64:79], a[164:167], v[156:159], a[64:79]
ds_read_b128 a[164:167], v21 offset:9216
v_exp_f32 v133, v69
v_add_f32 v162, v162, v130
v_add_f32 v162, v162, v131
v_cvt_pk_bf16_f32 v145, v130, v131
v_mfma_f32_32x32x16_bf16 a[80:95], a[172:175], v[156:159], a[80:95]
ds_read_b128 a[172:175], v21 offset:11264
v_exp_f32 v134, v70
v_add_f32 v162, v162, v132
v_mfma_f32_32x32x16_bf16 a[96:111], a[180:183], v[156:159], a[96:111]
ds_read_b128 a[180:183], v21 offset:13312
v_exp_f32 v135, v71
v_add_f32 v162, v162, v133
v_cvt_pk_bf16_f32 v146, v132, v133
v_mfma_f32_32x32x16_bf16 a[112:127], a[188:191], v[156:159], a[112:127]
ds_read_b128 a[188:191], v21 offset:15360
v_add_f32 v162, v162, v134
v_add_f32 v162, v162, v135
v_cvt_pk_bf16_f32 v147, v134, v135
k12_kernel_LB:
v_mfma_f32_32x32x16_bf16 v[80:95], a[128:131], v[224:227], v[112:127]
s_add_u32 s30, s30, 16384
s_and_b32 s30, s30, 0x1ffff
v_add_u32 v21, s30, v2
s_waitcnt vmcnt(10)
s_barrier
v_exp_f32 v136, v72
v_mfma_f32_32x32x16_bf16 v[80:95], a[132:135], v[228:231], v[80:95]
ds_read_b128 a[132:135], v21 offset:1024
s_waitcnt lgkmcnt(6)
ds_read_b128 a[128:131], v21 offset:0
v_exp_f32 v137, v73
v_exp_f32 v138, v74
v_mfma_f32_32x32x16_bf16 v[80:95], a[136:139], v[232:235], v[80:95]
ds_read_b128 a[136:139], v21 offset:2048
v_exp_f32 v139, v75
v_exp_f32 v140, v76
v_add_f32 v162, v162, v136
v_mfma_f32_32x32x16_bf16 v[80:95], a[140:143], v[236:239], v[80:95]
ds_read_b128 a[140:143], v21 offset:3072
v_exp_f32 v141, v77
v_add_f32 v162, v162, v137
v_add_f32 v162, v162, v138
v_cvt_pk_bf16_f32 v148, v136, v137
v_mfma_f32_32x32x16_bf16 v[80:95], a[144:147], v[240:243], v[80:95]
ds_read_b128 a[144:147], v21 offset:4096
v_exp_f32 v142, v78
v_add_f32 v162, v162, v139
v_add_f32 v162, v162, v140
v_cvt_pk_bf16_f32 v149, v138, v139
v_mfma_f32_32x32x16_bf16 v[80:95], a[148:151], v[244:247], v[80:95]
ds_read_b128 a[148:151], v21 offset:5120
v_exp_f32 v143, v79
v_add_f32 v162, v162, v141
v_add_f32 v162, v162, v142
v_cvt_pk_bf16_f32 v150, v140, v141
v_mfma_f32_32x32x16_bf16 v[80:95], a[152:155], v[248:251], v[80:95]
ds_read_b128 a[152:155], v21 offset:6144
v_add_f32 v162, v162, v143
v_cvt_pk_bf16_f32 v151, v142, v143
v_med3_f32 v163, v162, s38, v4
v_cmp_neq_f32 vcc, v163, v162
v_mfma_f32_32x32x16_bf16 v[80:95], a[156:159], v[252:255], v[80:95]
ds_read_b128 a[156:159], v21 offset:7168
s_cbranch_vccnz k12_kernel_fb_dB
k12_kernel_bk_dB:
s_lshr_b64 s[38:39], s[38:39], 32
v_add_f32 v160, v160, v162
s_waitcnt lgkmcnt(7)
v_mfma_f32_32x32x16_bf16 a[0:15], a[160:163], v[144:147], a[0:15]
s_xor_b32 m0, s30, 0x10000
s_nop 0
buffer_load_dwordx4 v38, s[4:7], s29 offen offset:0 sc1 lds
v_mfma_f32_32x32x16_bf16 a[16:31], a[168:171], v[144:147], a[16:31]
buffer_load_dwordx4 v38, s[4:7], s29 offen offset:1024 sc1 lds
v_exp_f32 v128, v80
v_exp_f32 v129, v81
v_mfma_f32_32x32x16_bf16 a[32:47], a[176:179], v[144:147], a[32:47]
buffer_load_dwordx4 v38, s[4:7], s29 offen offset:2048 sc1 lds
v_exp_f32 v130, v82
v_add_f32 v162, v128, v129
v_cvt_pk_bf16_f32 v152, v128, v129
v_mfma_f32_32x32x16_bf16 a[48:63], a[184:187], v[144:147], a[48:63]
buffer_load_dwordx4 v38, s[4:7], s29 offen offset:3072 sc1 lds
v_exp_f32 v131, v83
v_exp_f32 v132, v84
v_mfma_f32_32x32x16_bf16 a[0:15], a[164:167], v[148:151], a[0:15]
v_exp_f32 v133, v85
v_add_f32 v162, v162, v130
v_add_f32 v162, v162, v131
v_cvt_pk_bf16_f32 v153, v130, v131
v_mfma_f32_32x32x16_bf16 a[16:31], a[172:175], v[148:151], a[16:31]
v_exp_f32 v134, v86
v_add_f32 v162, v162, v132
buffer_load_dword v39, v170, s[60:63], s36 offen sc1
s_add_u32 s29, s29, 16384
v_mfma_f32_32x32x16_bf16 a[32:47], a[180:183], v[148:151], a[32:47]
v_exp_f32 v135, v87
v_add_f32 v162, v162, v133
v_cvt_pk_bf16_f32 v154, v132, v133
v_add_u32 v170, s37, v170
v_mfma_f32_32x32x16_bf16 a[48:63], a[188:191], v[148:151], a[48:63]
v_add_f32 v162, v162, v134
v_add_f32 v162, v162, v135
v_cvt_pk_bf16_f32 v155, v134, v135
s_add_u32 s31, s31, 1
s_cmp_le_u32 s31, s34
s_cbranch_scc1 k12_kernel_LA
s_cmp_eq_u32 s34, s27
s_cbranch_scc1 k12_kernel_dualdone
v_cmp_gt_u32 vcc, 2, v39
s_and_b64 vcc, vcc, s[48:49]
s_cbranch_vccnz k12_kernel_f2spind
k12_kernel_f2backd:
s_mov_b32 s60, s8
s_mov_b32 s61, s9
s_mov_b32 s62, s10
s_mov_b32 s63, s11
s_mov_b32 s36, 0
s_mov_b32 s37, 2816
v_mov_b32 v170, v171
s_mov_b32 s34, s27
s_branch k12_kernel_LA
k12_kernel_maskA:
v_mov_b32 v24, 0xff800000
v_cmp_gt_i32 s[40:41], 0, v5
v_cmp_gt_i32 s[42:43], 1, v5
v_cmp_gt_i32 s[44:45], 2, v5
v_cmp_gt_i32 s[46:47], 3, v5
v_cndmask_b32 v96, v96, v24, s[40:41]
v_cndmask_b32 v97, v97, v24, s[42:43]
v_cndmask_b32 v98, v98, v24, s[44:45]
v_cndmask_b32 v99, v99, v24, s[46:47]
v_cmp_gt_i32 s[40:41], 8, v5
v_cmp_gt_i32 s[42:43], 9, v5
v_cmp_gt_i32 s[44:45], 10, v5
v_cmp_gt_i32 s[46:47], 11, v5
v_cndmask_b32 v100, v100, v24, s[40:41]
v_cndmask_b32 v101, v101, v24, s[42:43]
v_cndmask_b32 v102, v102, v24, s[44:45]
v_cndmask_b32 v103, v103, v24, s[46:47]
v_cmp_gt_i32 s[40:41], 16, v5
v_cmp_gt_i32 s[42:43], 17, v5
v_cmp_gt_i32 s[44:45], 18, v5
v_cmp_gt_i32 s[46:47], 19, v5
v_cndmask_b32 v104, v104, v24, s[40:41]
v_cndmask_b32 v105, v105, v24, s[42:43]
v_cndmask_b32 v106, v106, v24, s[44:45]
v_cndmask_b32 v107, v107, v24, s[46:47]
v_cmp_gt_i32 s[40:41], 24, v5
v_cmp_gt_i32 s[42:43], 25, v5
v_cmp_gt_i32 s[44:45], 26, v5
v_cmp_gt_i32 s[46:47], 27, v5
v_cndmask_b32 v108, v108, v24, s[40:41]
v_cndmask_b32 v109, v109, v24, s[42:43]
v_cndmask_b32 v110, v110, v24, s[44:45]
v_cndmask_b32 v111, v111, v24, s[46:47]
s_nop 1
s_branch k12_kernel_maskA_bk
k12_kernel_dualdone:
s_waitcnt lgkmcnt(0)
s_sub_u32 s32, 31, s27
s_mov_b32 s33, 0
s_cmp_gt_u32 s27, 9
s_cselect_b32 s62, 0, s62
s_cbranch_scc1 k12_kernel_solo
s_sub_u32 s100, 10, s27
s_lshr_b32 s100, s100, 1
s_sub_u32 s33, s32, s100
s_mov_b32 s32, s100
k12_kernel_solo:
s_cmp_lt_u32 s24, 2
s_cselect_b32 s53, 1, 0
s_cmp_lt_u32 s24, 3
s_cbranch_scc0 k12_kernel_aepi_bk
v_mov_b32 v163, v160
v_mov_b32 v164, v160
s_lshl_b32 s50, s25, 19
s_lshl_b32 s51, s27, 11
v_permlane32_swap_b32 v163, v164
s_add_u32 s51, s51, s50
s_nop 0
v_add_f32 v163, v163, v164
v_rcp_f32 v166, v163
s_nop 7
v_accvgpr_read_b32 v64, a0
v_accvgpr_read_b32 v65, a1
v_accvgpr_read_b32 v66, a2
v_accvgpr_read_b32 v67, a3
v_accvgpr_read_b32 v68, a4
v_accvgpr_read_b32 v69, a5
v_accvgpr_read_b32 v70, a6
v_accvgpr_read_b32 v71, a7
v_pk_mul_f32 v[64:65], v[64:65], v[166:167] op_sel_hi:[1,0]
v_pk_mul_f32 v[66:67], v[66:67], v[166:167] op_sel_hi:[1,0]
v_pk_mul_f32 v[68:69], v[68:69], v[166:167] op_sel_hi:[1,0]
v_pk_mul_f32 v[70:71], v[70:71], v[166:167] op_sel_hi:[1,0]
v_cvt_pk_bf16_f32 v72, v64, v65
v_cvt_pk_bf16_f32 v73, v66, v67
v_cvt_pk_bf16_f32 v74, v68, v69
v_cvt_pk_bf16_f32 v75, v70, v71
buffer_store_dwordx4 v[72:75], v6, s[68:71], s51 offen offset:0 sc1
v_accvgpr_read_b32 v96, a8
v_accvgpr_read_b32 v97, a9
v_accvgpr_read_b32 v98, a10
v_accvgpr_read_b32 v99, a11
v_accvgpr_read_b32 v100, a12
v_accvgpr_read_b32 v101, a13
v_accvgpr_read_b32 v102, a14
v_accvgpr_read_b32 v103, a15
v_pk_mul_f32 v[96:97], v[96:97], v[166:167] op_sel_hi:[1,0]
v_pk_mul_f32 v[98:99], v[98:99], v[166:167] op_sel_hi:[1,0]
v_pk_mul_f32 v[100:101], v[100:101], v[166:167] op_sel_hi:[1,0]
v_pk_mul_f32 v[102:103], v[102:103], v[166:167] op_sel_hi:[1,0]
v_cvt_pk_bf16_f32 v104, v96, v97
v_cvt_pk_bf16_f32 v105, v98, v99
v_cvt_pk_bf16_f32 v106, v100, v101
v_cvt_pk_bf16_f32 v107, v102, v103
buffer_store_dwordx4 v[104:107], v6, s[68:71], s51 offen offset:512 sc1
s_add_u32 s51, s51, 131072
v_accvgpr_read_b32 v64, a16
v_accvgpr_read_b32 v65, a17
v_accvgpr_read_b32 v66, a18
v_accvgpr_read_b32 v67, a19
v_accvgpr_read_b32 v68, a20
v_accvgpr_read_b32 v69, a21
v_accvgpr_read_b32 v70, a22
v_accvgpr_read_b32 v71, a23
v_pk_mul_f32 v[64:65], v[64:65], v[166:167] op_sel_hi:[1,0]
v_pk_mul_f32 v[66:67], v[66:67], v[166:167] op_sel_hi:[1,0]
v_pk_mul_f32 v[68:69], v[68:69], v[166:167] op_sel_hi:[1,0]
v_pk_mul_f32 v[70:71], v[70:71], v[166:167] op_sel_hi:[1,0]
v_cvt_pk_bf16_f32 v72, v64, v65
v_cvt_pk_bf16_f32 v73, v66, v67
v_cvt_pk_bf16_f32 v74, v68, v69
v_cvt_pk_bf16_f32 v75, v70, v71
buffer_store_dwordx4 v[72:75], v6, s[68:71], s51 offen offset:0 sc1
v_accvgpr_read_b32 v96, a24
v_accvgpr_read_b32 v97, a25
v_accvgpr_read_b32 v98, a26
v_accvgpr_read_b32 v99, a27
v_accvgpr_read_b32 v100, a28
v_accvgpr_read_b32 v101, a29
v_accvgpr_read_b32 v102, a30
v_accvgpr_read_b32 v103, a31
v_pk_mul_f32 v[96:97], v[96:97], v[166:167] op_sel_hi:[1,0]
v_pk_mul_f32 v[98:99], v[98:99], v[166:167] op_sel_hi:[1,0]
v_pk_mul_f32 v[100:101], v[100:101], v[166:167] op_sel_hi:[1,0]
v_pk_mul_f32 v[102:103], v[102:103], v[166:167] op_sel_hi:[1,0]
v_cvt_pk_bf16_f32 v104, v96, v97
v_cvt_pk_bf16_f32 v105, v98, v99
v_cvt_pk_bf16_f32 v106, v100, v101
v_cvt_pk_bf16_f32 v107, v102, v103
buffer_store_dwordx4 v[104:107], v6, s[68:71], s51 offen offset:512 sc1
k12_kernel_aepi_bk:
s_cmp_eq_u32 s32, 0
s_cbranch_scc1 k12_kernel_soloexit
k12_kernel_disp:
buffer_load_dword v39, v170, s[60:63], s36 offen sc1
s_cmp_lg_u32 s53, 0
s_cbranch_scc1 k12_kernel_LS0
s_sub_u32 s32, s32, 1
s_bitcmp1_b32 s24, 0
s_cbranch_scc1 k12_kernel_LSO
s_branch k12_kernel_LS
k12_kernel_LS0:
s_waitcnt vmcnt(8) lgkmcnt(7)
v_mfma_f32_32x32x16_bf16 v[64:79], a[128:131], v[224:227], v[112:127]
s_add_u32 s30, s30, 16384
s_and_b32 s30, s30, 0x1ffff
v_add_u32 v20, s30, v2
s_barrier
v_exp_f32 v136, v88
v_mfma_f32_32x32x16_bf16 v[64:79], a[132:135], v[228:231], v[64:79]
ds_read_b128 a[132:135], v20 offset:1024
ds_read_b128 a[128:131], v20 offset:0
v_exp_f32 v137, v89
v_exp_f32 v138, v90
v_mfma_f32_32x32x16_bf16 v[64:79], a[136:139], v[232:235], v[64:79]
ds_read_b128 a[136:139], v20 offset:2048
v_exp_f32 v139, v91
v_exp_f32 v140, v92
v_add_f32 v162, v162, v136
v_mfma_f32_32x32x16_bf16 v[64:79], a[140:143], v[236:239], v[64:79]
ds_read_b128 a[140:143], v20 offset:3072
v_exp_f32 v141, v93
v_add_f32 v162, v162, v137
v_add_f32 v162, v162, v138
v_cvt_pk_bf16_f32 v156, v136, v137
v_mfma_f32_32x32x16_bf16 v[64:79], a[144:147], v[240:243], v[64:79]
ds_read_b128 a[144:147], v20 offset:4096
v_exp_f32 v142, v94
v_add_f32 v162, v162, v139
v_add_f32 v162, v162, v140
v_cvt_pk_bf16_f32 v157, v138, v139
v_mfma_f32_32x32x16_bf16 v[64:79], a[148:151], v[244:247], v[64:79]
ds_read_b128 a[148:151], v20 offset:5120
v_exp_f32 v143, v95
v_add_f32 v162, v162, v141
v_add_f32 v162, v162, v142
v_cvt_pk_bf16_f32 v158, v140, v141
v_mfma_f32_32x32x16_bf16 v[64:79], a[152:155], v[248:251], v[64:79]
ds_read_b128 a[152:155], v20 offset:6144
v_add_f32 v162, v162, v143
v_cvt_pk_bf16_f32 v159, v142, v143
v_med3_f32 v163, v162, s38, v4
v_cmp_neq_f32 vcc, v163, v162
v_mfma_f32_32x32x16_bf16 v[64:79], a[156:159], v[252:255], v[64:79]
ds_read_b128 a[156:159], v20 offset:7168
s_cbranch_vccnz k12_kernel_fb_s0
k12_kernel_bk_s0:
s_lshr_b64 s[38:39], s[38:39], 32
v_add_f32 v161, v161, v162
s_waitcnt lgkmcnt(7)
v_mfma_f32_32x32x16_bf16 a[64:79], a[160:163], v[152:155], a[64:79]
s_xor_b32 m0, s30, 0x10000
ds_read_b128 a[160:163], v21 offset:8192
buffer_load_dwordx4 v38, s[4:7], s29 offen offset:0 sc1 lds
v_mfma_f32_32x32x16_bf16 a[80:95], a[168:171], v[152:155], a[80:95]
ds_read_b128 a[168:171], v21 offset:10240
buffer_load_dwordx4 v38, s[4:7], s29 offen offset:1024 sc1 lds
v_exp_f32 v128, v64
v_exp_f32 v129, v65
v_mfma_f32_32x32x16_bf16 a[96:111], a[176:179], v[152:155], a[96:111]
ds_read_b128 a[176:179], v21 offset:12288
buffer_load_dwordx4 v38, s[4:7], s29 offen offset:2048 sc1 lds
v_exp_f32 v130, v66
v_add_f32 v162, v128, v129
v_cvt_pk_bf16_f32 v144, v128, v129
v_mfma_f32_32x32x16_bf16 a[112:127], a[184:187], v[152:155], a[112:127]
ds_read_b128 a[184:187], v21 offset:14336
buffer_load_dwordx4 v38, s[4:7], s29 offen offset:3072 sc1 lds
v_exp_f32 v131, v67
v_exp_f32 v132, v68
v_mfma_f32_32x32x16_bf16 a[64:79], a[164:167], v[156:159], a[64:79]
ds_read_b128 a[164:167], v21 offset:9216
v_exp_f32 v133, v69
v_add_f32 v162, v162, v130
v_add_f32 v162, v162, v131
v_cvt_pk_bf16_f32 v145, v130, v131
v_mfma_f32_32x32x16_bf16 a[80:95], a[172:175], v[156:159], a[80:95]
ds_read_b128 a[172:175], v21 offset:11264
v_exp_f32 v134, v70
v_add_f32 v162, v162, v132
s_add_u32 s29, s29, 16384
v_mfma_f32_32x32x16_bf16 a[96:111], a[180:183], v[156:159], a[96:111]
ds_read_b128 a[180:183], v21 offset:13312
v_exp_f32 v135, v71
v_add_f32 v162, v162, v133
v_cvt_pk_bf16_f32 v146, v132, v133
v_mfma_f32_32x32x16_bf16 a[112:127], a[188:191], v[156:159], a[112:127]
ds_read_b128 a[188:191], v21 offset:15360
v_add_f32 v162, v162, v134
v_add_f32 v162, v162, v135
v_cvt_pk_bf16_f32 v147, v134, v135
s_waitcnt vmcnt(8) lgkmcnt(7)
v_mfma_f32_32x32x16_bf16 v[80:95], a[128:131], v[224:227], v[112:127]
s_add_u32 s30, s30, 16384
s_and_b32 s30, s30, 0x1ffff
v_add_u32 v21, s30, v2
s_barrier
v_exp_f32 v136, v72
v_mfma_f32_32x32x16_bf16 v[80:95], a[132:135], v[228:231], v[80:95]
ds_read_b128 a[132:135], v21 offset:1024
ds_read_b128 a[128:131], v21 offset:0
v_exp_f32 v137, v73
v_exp_f32 v138, v74
v_mfma_f32_32x32x16_bf16 v[80:95], a[136:139], v[232:235], v[80:95]
ds_read_b128 a[136:139], v21 offset:2048
v_exp_f32 v139, v75
v_exp_f32 v140, v76
v_add_f32 v162, v162, v136
v_mfma_f32_32x32x16_bf16 v[80:95], a[140:143], v[236:239], v[80:95]
ds_read_b128 a[140:143], v21 offset:3072
v_exp_f32 v141, v77
v_add_f32 v162, v162, v137
v_add_f32 v162, v162, v138
v_cvt_pk_bf16_f32 v148, v136, v137
v_mfma_f32_32x32x16_bf16 v[80:95], a[144:147], v[240:243], v[80:95]
ds_read_b128 a[144:147], v21 offset:4096
v_exp_f32 v142, v78
v_add_f32 v162, v162, v139
v_add_f32 v162, v162, v140
v_cvt_pk_bf16_f32 v149, v138, v139
v_mfma_f32_32x32x16_bf16 v[80:95], a[148:151], v[244:247], v[80:95]
ds_read_b128 a[148:151], v21 offset:5120
v_exp_f32 v143, v79
v_add_f32 v162, v162, v141
v_add_f32 v162, v162, v142
v_cvt_pk_bf16_f32 v150, v140, v141
v_mfma_f32_32x32x16_bf16 v[80:95], a[152:155], v[248:251], v[80:95]
ds_read_b128 a[152:155], v21 offset:6144
v_add_f32 v162, v162, v143
v_cvt_pk_bf16_f32 v151, v142, v143
v_med3_f32 v163, v162, s38, v4
v_cmp_neq_f32 vcc, v163, v162
v_mfma_f32_32x32x16_bf16 v[80:95], a[156:159], v[252:255], v[80:95]
ds_read_b128 a[156:159], v21 offset:7168
s_cbranch_vccnz k12_kernel_fb_s1
k12_kernel_bk_s1:
s_lshr_b64 s[38:39], s[38:39], 32
v_add_f32 v161, v161, v162
s_waitcnt lgkmcnt(7)
v_mfma_f32_32x32x16_bf16 a[64:79], a[160:163], v[144:147], a[64:79]
s_xor_b32 m0, s30, 0x10000
ds_read_b128 a[160:163], v20 offset:8192
buffer_load_dwordx4 v38, s[4:7], s29 offen offset:0 sc1 lds
v_mfma_f32_32x32x16_bf16 a[80:95], a[168:171], v[144:147], a[80:95]
ds_read_b128 a[168:171], v20 offset:10240
buffer_load_dwordx4 v38, s[4:7], s29 offen offset:1024 sc1 lds
v_exp_f32 v128, v80
v_exp_f32 v129, v81
v_mfma_f32_32x32x16_bf16 a[96:111], a[176:179], v[144:147], a[96:111]
ds_read_b128 a[176:179], v20 offset:12288
buffer_load_dwordx4 v38, s[4:7], s29 offen offset:2048 sc1 lds
v_exp_f32 v130, v82
v_add_f32 v162, v128, v129
v_cvt_pk_bf16_f32 v152, v128, v129
v_mfma_f32_32x32x16_bf16 a[112:127], a[184:187], v[144:147], a[112:127]
ds_read_b128 a[184:187], v20 offset:14336
buffer_load_dwordx4 v38, s[4:7], s29 offen offset:3072 sc1 lds
v_exp_f32 v131, v83
v_exp_f32 v132, v84
v_mfma_f32_32x32x16_bf16 a[64:79], a[164:167], v[148:151], a[64:79]
ds_read_b128 a[164:167], v20 offset:9216
v_exp_f32 v133, v85
v_add_f32 v162, v162, v130
v_add_f32 v162, v162, v131
v_cvt_pk_bf16_f32 v153, v130, v131
v_mfma_f32_32x32x16_bf16 a[80:95], a[172:175], v[148:151], a[80:95]
ds_read_b128 a[172:175], v20 offset:11264
v_exp_f32 v134, v86
v_add_f32 v162, v162, v132
s_add_u32 s29, s29, 16384
v_mfma_f32_32x32x16_bf16 a[96:111], a[180:183], v[148:151], a[96:111]
ds_read_b128 a[180:183], v20 offset:13312
v_exp_f32 v135, v87
v_add_f32 v162, v162, v133
v_cvt_pk_bf16_f32 v154, v132, v133
v_mfma_f32_32x32x16_bf16 a[112:127], a[188:191], v[148:151], a[112:127]
ds_read_b128 a[188:191], v20 offset:15360
v_add_f32 v162, v162, v134
v_add_f32 v162, v162, v135
v_cvt_pk_bf16_f32 v155, v134, v135
s_mov_b32 s53, 0
s_cmp_eq_u32 s24, 0
s_cbranch_scc0 k12_kernel_aepi2_bk
s_lshl_b32 s50, s25, 19
s_lshl_b32 s51, s27, 11
s_add_u32 s51, s51, s50
s_add_u32 s51, s51, 262144
v_accvgpr_read_b32 v64, a32
v_accvgpr_read_b32 v65, a33
v_accvgpr_read_b32 v66, a34
v_accvgpr_read_b32 v67, a35
v_accvgpr_read_b32 v68, a36
v_accvgpr_read_b32 v69, a37
v_accvgpr_read_b32 v70, a38
v_accvgpr_read_b32 v71, a39
v_pk_mul_f32 v[64:65], v[64:65], v[166:167] op_sel_hi:[1,0]
v_pk_mul_f32 v[66:67], v[66:67], v[166:167] op_sel_hi:[1,0]
v_pk_mul_f32 v[68:69], v[68:69], v[166:167] op_sel_hi:[1,0]
v_pk_mul_f32 v[70:71], v[70:71], v[166:167] op_sel_hi:[1,0]
v_cvt_pk_bf16_f32 v72, v64, v65
v_cvt_pk_bf16_f32 v73, v66, v67
v_cvt_pk_bf16_f32 v74, v68, v69
v_cvt_pk_bf16_f32 v75, v70, v71
buffer_store_dwordx4 v[72:75], v6, s[68:71], s51 offen offset:0 sc1
v_accvgpr_read_b32 v96, a40
v_accvgpr_read_b32 v97, a41
v_accvgpr_read_b32 v98, a42
v_accvgpr_read_b32 v99, a43
v_accvgpr_read_b32 v100, a44
v_accvgpr_read_b32 v101, a45
v_accvgpr_read_b32 v102, a46
v_accvgpr_read_b32 v103, a47
v_pk_mul_f32 v[96:97], v[96:97], v[166:167] op_sel_hi:[1,0]
v_pk_mul_f32 v[98:99], v[98:99], v[166:167] op_sel_hi:[1,0]
v_pk_mul_f32 v[100:101], v[100:101], v[166:167] op_sel_hi:[1,0]
v_pk_mul_f32 v[102:103], v[102:103], v[166:167] op_sel_hi:[1,0]
v_cvt_pk_bf16_f32 v104, v96, v97
v_cvt_pk_bf16_f32 v105, v98, v99
v_cvt_pk_bf16_f32 v106, v100, v101
v_cvt_pk_bf16_f32 v107, v102, v103
buffer_store_dwordx4 v[104:107], v6, s[68:71], s51 offen offset:512 sc1
s_add_u32 s51, s51, 131072
v_accvgpr_read_b32 v64, a48
v_accvgpr_read_b32 v65, a49
v_accvgpr_read_b32 v66, a50
v_accvgpr_read_b32 v67, a51
v_accvgpr_read_b32 v68, a52
v_accvgpr_read_b32 v69, a53
v_accvgpr_read_b32 v70, a54
v_accvgpr_read_b32 v71, a55
v_pk_mul_f32 v[64:65], v[64:65], v[166:167] op_sel_hi:[1,0]
v_pk_mul_f32 v[66:67], v[66:67], v[166:167] op_sel_hi:[1,0]
v_pk_mul_f32 v[68:69], v[68:69], v[166:167] op_sel_hi:[1,0]
v_pk_mul_f32 v[70:71], v[70:71], v[166:167] op_sel_hi:[1,0]
v_cvt_pk_bf16_f32 v72, v64, v65
v_cvt_pk_bf16_f32 v73, v66, v67
v_cvt_pk_bf16_f32 v74, v68, v69
v_cvt_pk_bf16_f32 v75, v70, v71
buffer_store_dwordx4 v[72:75], v6, s[68:71], s51 offen offset:0 sc1
v_accvgpr_read_b32 v96, a56
v_accvgpr_read_b32 v97, a57
v_accvgpr_read_b32 v98, a58
v_accvgpr_read_b32 v99, a59
v_accvgpr_read_b32 v100, a60
v_accvgpr_read_b32 v101, a61
v_accvgpr_read_b32 v102, a62
v_accvgpr_read_b32 v103, a63
v_pk_mul_f32 v[96:97], v[96:97], v[166:167] op_sel_hi:[1,0]
v_pk_mul_f32 v[98:99], v[98:99], v[166:167] op_sel_hi:[1,0]
v_pk_mul_f32 v[100:101], v[100:101], v[166:167] op_sel_hi:[1,0]
v_pk_mul_f32 v[102:103], v[102:103], v[166:167] op_sel_hi:[1,0]
v_cvt_pk_bf16_f32 v104, v96, v97
v_cvt_pk_bf16_f32 v105, v98, v99
v_cvt_pk_bf16_f32 v106, v100, v101
v_cvt_pk_bf16_f32 v107, v102, v103
buffer_store_dwordx4 v[104:107], v6, s[68:71], s51 offen offset:512 sc1
k12_kernel_aepi2_bk:
s_sub_u32 s32, s32, 1
s_cmp_lg_u32 s32, 0
s_cbranch_scc1 k12_kernel_disp
s_branch k12_kernel_soloexit
.p2align 6
k12_kernel_LSO:
s_waitcnt lgkmcnt(7)
v_mfma_f32_32x32x16_bf16 v[64:79], a[128:131], v[224:227], v[112:127]
s_add_u32 s30, s30, 16384
s_and_b32 s30, s30, 0x1ffff
v_add_u32 v20, s30, v2
v_exp_f32 v136, v88
v_mfma_f32_32x32x16_bf16 v[64:79], a[132:135], v[228:231], v[64:79]
ds_read_b128 a[132:135], v20 offset:1024
ds_read_b128 a[128:131], v20 offset:0
v_exp_f32 v137, v89
v_exp_f32 v138, v90
v_mfma_f32_32x32x16_bf16 v[64:79], a[136:139], v[232:235], v[64:79]
ds_read_b128 a[136:139], v20 offset:2048
v_exp_f32 v139, v91
v_exp_f32 v140, v92
v_add_f32 v162, v162, v136
v_mfma_f32_32x32x16_bf16 v[64:79], a[140:143], v[236:239], v[64:79]
ds_read_b128 a[140:143], v20 offset:3072
v_exp_f32 v141, v93
v_add_f32 v162, v162, v137
v_add_f32 v162, v162, v138
v_cvt_pk_bf16_f32 v156, v136, v137
v_mfma_f32_32x32x16_bf16 v[64:79], a[144:147], v[240:243], v[64:79]
ds_read_b128 a[144:147], v20 offset:4096
v_exp_f32 v142, v94
v_add_f32 v162, v162, v139
v_add_f32 v162, v162, v140
v_cvt_pk_bf16_f32 v157, v138, v139
v_mfma_f32_32x32x16_bf16 v[64:79], a[148:151], v[244:247], v[64:79]
ds_read_b128 a[148:151], v20 offset:5120
v_exp_f32 v143, v95
v_add_f32 v162, v162, v141
v_add_f32 v162, v162, v142
v_cvt_pk_bf16_f32 v158, v140, v141
v_mfma_f32_32x32x16_bf16 v[64:79], a[152:155], v[248:251], v[64:79]
ds_read_b128 a[152:155], v20 offset:6144
v_add_f32 v162, v162, v143
v_cvt_pk_bf16_f32 v159, v142, v143
v_med3_f32 v163, v162, s38, v4
v_cmp_neq_f32 vcc, v163, v162
v_mfma_f32_32x32x16_bf16 v[64:79], a[156:159], v[252:255], v[64:79]
ds_read_b128 a[156:159], v20 offset:7168
s_cbranch_vccnz k12_kernel_fb_o0
k12_kernel_bk_o0:
s_lshr_b64 s[38:39], s[38:39], 32
v_add_f32 v161, v161, v162
s_waitcnt lgkmcnt(7)
v_mfma_f32_32x32x16_bf16 a[64:79], a[160:163], v[152:155], a[64:79]
s_xor_b32 m0, s30, 0x10000
ds_read_b128 a[160:163], v21 offset:8192
buffer_load_dwordx4 v38, s[4:7], s29 offen offset:0 sc1 lds
v_mfma_f32_32x32x16_bf16 a[80:95], a[168:171], v[152:155], a[80:95]
ds_read_b128 a[168:171], v21 offset:10240
buffer_load_dwordx4 v38, s[4:7], s29 offen offset:1024 sc1 lds
v_exp_f32 v128, v64
v_exp_f32 v129, v65
v_mfma_f32_32x32x16_bf16 a[96:111], a[176:179], v[152:155], a[96:111]
ds_read_b128 a[176:179], v21 offset:12288
buffer_load_dwordx4 v38, s[4:7], s29 offen offset:2048 sc1 lds
v_exp_f32 v130, v66
v_add_f32 v162, v128, v129
v_cvt_pk_bf16_f32 v144, v128, v129
v_mfma_f32_32x32x16_bf16 a[112:127], a[184:187], v[152:155], a[112:127]
ds_read_b128 a[184:187], v21 offset:14336
buffer_load_dwordx4 v38, s[4:7], s29 offen offset:3072 sc1 lds
v_exp_f32 v131, v67
v_exp_f32 v132, v68
v_mfma_f32_32x32x16_bf16 a[64:79], a[164:167], v[156:159], a[64:79]
ds_read_b128 a[164:167], v21 offset:9216
v_exp_f32 v133, v69
v_add_f32 v162, v162, v130
v_add_f32 v162, v162, v131
v_cvt_pk_bf16_f32 v145, v130, v131
v_mfma_f32_32x32x16_bf16 a[80:95], a[172:175], v[156:159], a[80:95]
ds_read_b128 a[172:175], v21 offset:11264
v_exp_f32 v134, v70
v_add_f32 v162, v162, v132
s_add_u32 s29, s29, 16384
v_mfma_f32_32x32x16_bf16 a[96:111], a[180:183], v[156:159], a[96:111]
ds_read_b128 a[180:183], v21 offset:13312
v_exp_f32 v135, v71
v_add_f32 v162, v162, v133
v_cvt_pk_bf16_f32 v146, v132, v133
v_mfma_f32_32x32x16_bf16 a[112:127], a[188:191], v[156:159], a[112:127]
ds_read_b128 a[188:191], v21 offset:15360
v_add_f32 v162, v162, v134
v_add_f32 v162, v162, v135
v_cvt_pk_bf16_f32 v147, v134, v135
s_waitcnt vmcnt(8) lgkmcnt(7)
v_mfma_f32_32x32x16_bf16 v[80:95], a[128:131], v[224:227], v[112:127]
s_add_u32 s30, s30, 16384
s_and_b32 s30, s30, 0x1ffff
v_add_u32 v21, s30, v2
tp0_p11:
s_cbranch_execz tp0_ret
s_barrier
v_exp_f32 v136, v72
v_mfma_f32_32x32x16_bf16 v[80:95], a[132:135], v[228:231], v[80:95]
ds_read_b128 a[132:135], v21 offset:1024
ds_read_b128 a[128:131], v21 offset:0
v_exp_f32 v137, v73
v_exp_f32 v138, v74
v_mfma_f32_32x32x16_bf16 v[80:95], a[136:139], v[232:235], v[80:95]
ds_read_b128 a[136:139], v21 offset:2048
v_exp_f32 v139, v75
v_exp_f32 v140, v76
v_add_f32 v162, v162, v136
v_mfma_f32_32x32x16_bf16 v[80:95], a[140:143], v[236:239], v[80:95]
ds_read_b128 a[140:143], v21 offset:3072
v_exp_f32 v141, v77
v_add_f32 v162, v162, v137
v_add_f32 v162, v162, v138
v_cvt_pk_bf16_f32 v148, v136, v137
v_mfma_f32_32x32x16_bf16 v[80:95], a[144:147], v[240:243], v[80:95]
ds_read_b128 a[144:147], v21 offset:4096
v_exp_f32 v142, v78
v_add_f32 v162, v162, v139
v_add_f32 v162, v162, v140
v_cvt_pk_bf16_f32 v149, v138, v139
v_mfma_f32_32x32x16_bf16 v[80:95], a[148:151], v[244:247], v[80:95]
ds_read_b128 a[148:151], v21 offset:5120
v_exp_f32 v143, v79
v_add_f32 v162, v162, v141
v_add_f32 v162, v162, v142
v_cvt_pk_bf16_f32 v150, v140, v141
v_mfma_f32_32x32x16_bf16 v[80:95], a[152:155], v[248:251], v[80:95]
ds_read_b128 a[152:155], v21 offset:6144
v_add_f32 v162, v162, v143
v_cvt_pk_bf16_f32 v151, v142, v143
v_med3_f32 v163, v162, s38, v4
v_cmp_neq_f32 vcc, v163, v162
v_mfma_f32_32x32x16_bf16 v[80:95], a[156:159], v[252:255], v[80:95]
ds_read_b128 a[156:159], v21 offset:7168
s_cbranch_vccnz k12_kernel_fb_o1
k12_kernel_bk_o1:
s_lshr_b64 s[38:39], s[38:39], 32
v_add_f32 v161, v161, v162
s_waitcnt lgkmcnt(7)
v_mfma_f32_32x32x16_bf16 a[64:79], a[160:163], v[144:147], a[64:79]
s_xor_b32 m0, s30, 0x10000
ds_read_b128 a[160:163], v20 offset:8192
buffer_load_dwordx4 v38, s[4:7], s29 offen offset:0 sc1 lds
v_mfma_f32_32x32x16_bf16 a[80:95], a[168:171], v[144:147], a[80:95]
ds_read_b128 a[168:171], v20 offset:10240
buffer_load_dwordx4 v38, s[4:7], s29 offen offset:1024 sc1 lds
v_exp_f32 v128, v80
v_exp_f32 v129, v81
v_mfma_f32_32x32x16_bf16 a[96:111], a[176:179], v[144:147], a[96:111]
ds_read_b128 a[176:179], v20 offset:12288
buffer_load_dwordx4 v38, s[4:7], s29 offen offset:2048 sc1 lds
v_exp_f32 v130, v82
v_add_f32 v162, v128, v129
v_cvt_pk_bf16_f32 v152, v128, v129
v_mfma_f32_32x32x16_bf16 a[112:127], a[184:187], v[144:147], a[112:127]
ds_read_b128 a[184:187], v20 offset:14336
buffer_load_dwordx4 v38, s[4:7], s29 offen offset:3072 sc1 lds
v_exp_f32 v131, v83
v_exp_f32 v132, v84
v_mfma_f32_32x32x16_bf16 a[64:79], a[164:167], v[148:151], a[64:79]
ds_read_b128 a[164:167], v20 offset:9216
v_exp_f32 v133, v85
v_add_f32 v162, v162, v130
v_add_f32 v162, v162, v131
v_cvt_pk_bf16_f32 v153, v130, v131
v_mfma_f32_32x32x16_bf16 a[80:95], a[172:175], v[148:151], a[80:95]
ds_read_b128 a[172:175], v20 offset:11264
v_exp_f32 v134, v86
v_add_f32 v162, v162, v132
s_add_u32 s29, s29, 16384
v_mfma_f32_32x32x16_bf16 a[96:111], a[180:183], v[148:151], a[96:111]
ds_read_b128 a[180:183], v20 offset:13312
v_exp_f32 v135, v87
v_add_f32 v162, v162, v133
v_cvt_pk_bf16_f32 v154, v132, v133
v_mfma_f32_32x32x16_bf16 a[112:127], a[188:191], v[148:151], a[112:127]
ds_read_b128 a[188:191], v20 offset:15360
v_add_f32 v162, v162, v134
v_add_f32 v162, v162, v135
v_cvt_pk_bf16_f32 v155, v134, v135
s_sub_u32 s32, s32, 1
s_cbranch_scc0 k12_kernel_LSO
s_branch k12_kernel_soloexit
.p2align 6
k12_kernel_LS:
s_waitcnt vmcnt(8) lgkmcnt(7)
v_mfma_f32_32x32x16_bf16 v[64:79], a[128:131], v[224:227], v[112:127]
s_add_u32 s30, s30, 16384
s_and_b32 s30, s30, 0x1ffff
v_add_u32 v20, s30, v2
s_barrier
v_exp_f32 v136, v88
v_mfma_f32_32x32x16_bf16 v[64:79], a[132:135], v[228:231], v[64:79]
ds_read_b128 a[132:135], v20 offset:1024
ds_read_b128 a[128:131], v20 offset:0
v_exp_f32 v137, v89
v_exp_f32 v138, v90
v_mfma_f32_32x32x16_bf16 v[64:79], a[136:139], v[232:235], v[64:79]
ds_read_b128 a[136:139], v20 offset:2048
v_exp_f32 v139, v91
v_exp_f32 v140, v92
v_add_f32 v162, v162, v136
v_mfma_f32_32x32x16_bf16 v[64:79], a[140:143], v[236:239], v[64:79]
ds_read_b128 a[140:143], v20 offset:3072
v_exp_f32 v141, v93
v_add_f32 v162, v162, v137
v_add_f32 v162, v162, v138
v_cvt_pk_bf16_f32 v156, v136, v137
v_mfma_f32_32x32x16_bf16 v[64:79], a[144:147], v[240:243], v[64:79]
ds_read_b128 a[144:147], v20 offset:4096
v_exp_f32 v142, v94
v_add_f32 v162, v162, v139
v_add_f32 v162, v162, v140
v_cvt_pk_bf16_f32 v157, v138, v139
v_mfma_f32_32x32x16_bf16 v[64:79], a[148:151], v[244:247], v[64:79]
ds_read_b128 a[148:151], v20 offset:5120
v_exp_f32 v143, v95
v_add_f32 v162, v162, v141
v_add_f32 v162, v162, v142
v_cvt_pk_bf16_f32 v158, v140, v141
v_mfma_f32_32x32x16_bf16 v[64:79], a[152:155], v[248:251], v[64:79]
ds_read_b128 a[152:155], v20 offset:6144
v_add_f32 v162, v162, v143
v_cvt_pk_bf16_f32 v159, v142, v143
v_med3_f32 v163, v162, s38, v4
v_cmp_neq_f32 vcc, v163, v162
v_mfma_f32_32x32x16_bf16 v[64:79], a[156:159], v[252:255], v[64:79]
ds_read_b128 a[156:159], v20 offset:7168
s_cbranch_vccnz k12_kernel_fb_e0
k12_kernel_bk_e0:
s_lshr_b64 s[38:39], s[38:39], 32
v_add_f32 v161, v161, v162
s_waitcnt lgkmcnt(7)
v_mfma_f32_32x32x16_bf16 a[64:79], a[160:163], v[152:155], a[64:79]
s_xor_b32 m0, s30, 0x10000
ds_read_b128 a[160:163], v21 offset:8192
buffer_load_dwordx4 v38, s[4:7], s29 offen offset:0 sc1 lds
v_mfma_f32_32x32x16_bf16 a[80:95], a[168:171], v[152:155], a[80:95]
ds_read_b128 a[168:171], v21 offset:10240
buffer_load_dwordx4 v38, s[4:7], s29 offen offset:1024 sc1 lds
v_exp_f32 v128, v64
v_exp_f32 v129, v65
v_mfma_f32_32x32x16_bf16 a[96:111], a[176:179], v[152:155], a[96:111]
ds_read_b128 a[176:179], v21 offset:12288
buffer_load_dwordx4 v38, s[4:7], s29 offen offset:2048 sc1 lds
v_exp_f32 v130, v66
v_add_f32 v162, v128, v129
v_cvt_pk_bf16_f32 v144, v128, v129
v_mfma_f32_32x32x16_bf16 a[112:127], a[184:187], v[152:155], a[112:127]
ds_read_b128 a[184:187], v21 offset:14336
buffer_load_dwordx4 v38, s[4:7], s29 offen offset:3072 sc1 lds
v_exp_f32 v131, v67
v_exp_f32 v132, v68
v_mfma_f32_32x32x16_bf16 a[64:79], a[164:167], v[156:159], a[64:79]
ds_read_b128 a[164:167], v21 offset:9216
v_exp_f32 v133, v69
v_add_f32 v162, v162, v130
v_add_f32 v162, v162, v131
v_cvt_pk_bf16_f32 v145, v130, v131
v_mfma_f32_32x32x16_bf16 a[80:95], a[172:175], v[156:159], a[80:95]
ds_read_b128 a[172:175], v21 offset:11264
v_exp_f32 v134, v70
v_add_f32 v162, v162, v132
s_add_u32 s29, s29, 16384
v_mfma_f32_32x32x16_bf16 a[96:111], a[180:183], v[156:159], a[96:111]
ds_read_b128 a[180:183], v21 offset:13312
v_exp_f32 v135, v71
v_add_f32 v162, v162, v133
v_cvt_pk_bf16_f32 v146, v132, v133
v_mfma_f32_32x32x16_bf16 a[112:127], a[188:191], v[156:159], a[112:127]
ds_read_b128 a[188:191], v21 offset:15360
v_add_f32 v162, v162, v134
v_add_f32 v162, v162, v135
v_cvt_pk_bf16_f32 v147, v134, v135
s_waitcnt lgkmcnt(7)
v_mfma_f32_32x32x16_bf16 v[80:95], a[128:131], v[224:227], v[112:127]
s_add_u32 s30, s30, 16384
s_and_b32 s30, s30, 0x1ffff
v_add_u32 v21, s30, v2
v_exp_f32 v136, v72
v_mfma_f32_32x32x16_bf16 v[80:95], a[132:135], v[228:231], v[80:95]
ds_read_b128 a[132:135], v21 offset:1024
ds_read_b128 a[128:131], v21 offset:0
v_exp_f32 v137, v73
v_exp_f32 v138, v74
v_mfma_f32_32x32x16_bf16 v[80:95], a[136:139], v[232:235], v[80:95]
ds_read_b128 a[136:139], v21 offset:2048
v_exp_f32 v139, v75
v_exp_f32 v140, v76
v_add_f32 v162, v162, v136
v_mfma_f32_32x32x16_bf16 v[80:95], a[140:143], v[236:239], v[80:95]
ds_read_b128 a[140:143], v21 offset:3072
v_exp_f32 v141, v77
v_add_f32 v162, v162, v137
v_add_f32 v162, v162, v138
v_cvt_pk_bf16_f32 v148, v136, v137
v_mfma_f32_32x32x16_bf16 v[80:95], a[144:147], v[240:243], v[80:95]
ds_read_b128 a[144:147], v21 offset:4096
v_exp_f32 v142, v78
v_add_f32 v162, v162, v139
v_add_f32 v162, v162, v140
v_cvt_pk_bf16_f32 v149, v138, v139
v_mfma_f32_32x32x16_bf16 v[80:95], a[148:151], v[244:247], v[80:95]
ds_read_b128 a[148:151], v21 offset:5120
v_exp_f32 v143, v79
v_add_f32 v162, v162, v141
v_add_f32 v162, v162, v142
v_cvt_pk_bf16_f32 v150, v140, v141
v_mfma_f32_32x32x16_bf16 v[80:95], a[152:155], v[248:251], v[80:95]
ds_read_b128 a[152:155], v21 offset:6144
v_add_f32 v162, v162, v143
v_cvt_pk_bf16_f32 v151, v142, v143
v_med3_f32 v163, v162, s38, v4
v_cmp_neq_f32 vcc, v163, v162
v_mfma_f32_32x32x16_bf16 v[80:95], a[156:159], v[252:255], v[80:95]
ds_read_b128 a[156:159], v21 offset:7168
s_cbranch_vccnz k12_kernel_fb_e1
k12_kernel_bk_e1:
s_lshr_b64 s[38:39], s[38:39], 32
v_add_f32 v161, v161, v162
s_waitcnt lgkmcnt(7)
v_mfma_f32_32x32x16_bf16 a[64:79], a[160:163], v[144:147], a[64:79]
s_xor_b32 m0, s30, 0x10000
ds_read_b128 a[160:163], v20 offset:8192
buffer_load_dwordx4 v38, s[4:7], s29 offen offset:0 sc1 lds
v_mfma_f32_32x32x16_bf16 a[80:95], a[168:171], v[144:147], a[80:95]
ds_read_b128 a[168:171], v20 offset:10240
buffer_load_dwordx4 v38, s[4:7], s29 offen offset:1024 sc1 lds
v_exp_f32 v128, v80
v_exp_f32 v129, v81
v_mfma_f32_32x32x16_bf16 a[96:111], a[176:179], v[144:147], a[96:111]
ds_read_b128 a[176:179], v20 offset:12288
buffer_load_dwordx4 v38, s[4:7], s29 offen offset:2048 sc1 lds
v_exp_f32 v130, v82
v_add_f32 v162, v128, v129
v_cvt_pk_bf16_f32 v152, v128, v129
v_mfma_f32_32x32x16_bf16 a[112:127], a[184:187], v[144:147], a[112:127]
ds_read_b128 a[184:187], v20 offset:14336
buffer_load_dwordx4 v38, s[4:7], s29 offen offset:3072 sc1 lds
v_exp_f32 v131, v83
v_exp_f32 v132, v84
v_mfma_f32_32x32x16_bf16 a[64:79], a[164:167], v[148:151], a[64:79]
ds_read_b128 a[164:167], v20 offset:9216
v_exp_f32 v133, v85
v_add_f32 v162, v162, v130
v_add_f32 v162, v162, v131
v_cvt_pk_bf16_f32 v153, v130, v131
v_mfma_f32_32x32x16_bf16 a[80:95], a[172:175], v[148:151], a[80:95]
ds_read_b128 a[172:175], v20 offset:11264
v_exp_f32 v134, v86
v_add_f32 v162, v162, v132
s_add_u32 s29, s29, 16384
v_mfma_f32_32x32x16_bf16 a[96:111], a[180:183], v[148:151], a[96:111]
ds_read_b128 a[180:183], v20 offset:13312
v_exp_f32 v135, v87
v_add_f32 v162, v162, v133
v_cvt_pk_bf16_f32 v154, v132, v133
v_mfma_f32_32x32x16_bf16 a[112:127], a[188:191], v[148:151], a[112:127]
ds_read_b128 a[188:191], v20 offset:15360
v_add_f32 v162, v162, v134
v_add_f32 v162, v162, v135
v_cvt_pk_bf16_f32 v155, v134, v135
s_sub_u32 s32, s32, 1
s_cbranch_scc0 k12_kernel_LS
k12_kernel_soloexit:
s_cmp_eq_u32 s33, 0
s_cbranch_scc1 k12_kernel_FIN
v_cmp_gt_u32 vcc, 2, v39
s_and_b64 vcc, vcc, s[48:49]
s_cbranch_vccnz k12_kernel_f2spins
k12_kernel_f2backs:
s_mov_b32 s62, 0
s_mov_b32 s32, s33
s_mov_b32 s33, 0
s_branch k12_kernel_disp
k12_kernel_FIN:
s_cmp_lg_u32 s24, 2
s_cbranch_scc1 k12_kernel_xpre_bk
s_waitcnt vmcnt(8)
s_barrier
k12_kernel_xpre_bk:
v_mov_b32 v24, 0xff800000
v_cmp_gt_i32 s[40:41], 0, v5
v_cmp_gt_i32 s[42:43], 1, v5
v_cmp_gt_i32 s[44:45], 2, v5
v_cmp_gt_i32 s[46:47], 3, v5
v_cndmask_b32 v112, v112, v24, s[40:41]
v_cndmask_b32 v113, v113, v24, s[42:43]
v_cndmask_b32 v114, v114, v24, s[44:45]
v_cndmask_b32 v115, v115, v24, s[46:47]
v_cmp_gt_i32 s[40:41], 8, v5
v_cmp_gt_i32 s[42:43], 9, v5
v_cmp_gt_i32 s[44:45], 10, v5
v_cmp_gt_i32 s[46:47], 11, v5
v_cndmask_b32 v116, v116, v24, s[40:41]
v_cndmask_b32 v117, v117, v24, s[42:43]
v_cndmask_b32 v118, v118, v24, s[44:45]
v_cndmask_b32 v119, v119, v24, s[46:47]
v_cmp_gt_i32 s[40:41], 16, v5
v_cmp_gt_i32 s[42:43], 17, v5
v_cmp_gt_i32 s[44:45], 18, v5
v_cmp_gt_i32 s[46:47], 19, v5
v_cndmask_b32 v120, v120, v24, s[40:41]
v_cndmask_b32 v121, v121, v24, s[42:43]
v_cndmask_b32 v122, v122, v24, s[44:45]
v_cndmask_b32 v123, v123, v24, s[46:47]
v_cmp_gt_i32 s[40:41], 24, v5
v_cmp_gt_i32 s[42:43], 25, v5
v_cmp_gt_i32 s[44:45], 26, v5
v_cmp_gt_i32 s[46:47], 27, v5
v_cndmask_b32 v124, v124, v24, s[40:41]
v_cndmask_b32 v125, v125, v24, s[42:43]
v_cndmask_b32 v126, v126, v24, s[44:45]
v_cndmask_b32 v127, v127, v24, s[46:47]
s_nop 1
s_waitcnt lgkmcnt(7)
v_mfma_f32_32x32x16_bf16 v[64:79], a[128:131], v[224:227], v[112:127]
v_exp_f32 v136, v88
v_mfma_f32_32x32x16_bf16 v[64:79], a[132:135], v[228:231], v[64:79]
v_exp_f32 v137, v89
v_exp_f32 v138, v90
v_mfma_f32_32x32x16_bf16 v[64:79], a[136:139], v[232:235], v[64:79]
v_exp_f32 v139, v91
v_exp_f32 v140, v92
v_add_f32 v162, v162, v136
v_mfma_f32_32x32x16_bf16 v[64:79], a[140:143], v[236:239], v[64:79]
v_exp_f32 v141, v93
v_add_f32 v162, v162, v137
v_add_f32 v162, v162, v138
v_cvt_pk_bf16_f32 v156, v136, v137
v_mfma_f32_32x32x16_bf16 v[64:79], a[144:147], v[240:243], v[64:79]
v_exp_f32 v142, v94
v_add_f32 v162, v162, v139
v_add_f32 v162, v162, v140
v_cvt_pk_bf16_f32 v157, v138, v139
v_mfma_f32_32x32x16_bf16 v[64:79], a[148:151], v[244:247], v[64:79]
v_exp_f32 v143, v95
v_add_f32 v162, v162, v141
v_add_f32 v162, v162, v142
v_cvt_pk_bf16_f32 v158, v140, v141
v_mfma_f32_32x32x16_bf16 v[64:79], a[152:155], v[248:251], v[64:79]
v_add_f32 v162, v162, v143
v_cvt_pk_bf16_f32 v159, v142, v143
v_med3_f32 v163, v162, s38, v4
v_cmp_neq_f32 vcc, v163, v162
v_mfma_f32_32x32x16_bf16 v[64:79], a[156:159], v[252:255], v[64:79]
s_cbranch_vccnz k12_kernel_fb_f
k12_kernel_bk_f:
s_lshr_b64 s[38:39], s[38:39], 32
v_add_f32 v161, v161, v162
s_waitcnt lgkmcnt(0)
v_mfma_f32_32x32x16_bf16 a[64:79], a[160:163], v[152:155], a[64:79]
ds_read_b128 a[160:163], v21 offset:8192
v_mfma_f32_32x32x16_bf16 a[80:95], a[168:171], v[152:155], a[80:95]
ds_read_b128 a[168:171], v21 offset:10240
v_exp_f32 v128, v64
v_exp_f32 v129, v65
v_mfma_f32_32x32x16_bf16 a[96:111], a[176:179], v[152:155], a[96:111]
ds_read_b128 a[176:179], v21 offset:12288
v_exp_f32 v130, v66
v_add_f32 v162, v128, v129
v_cvt_pk_bf16_f32 v144, v128, v129
v_mfma_f32_32x32x16_bf16 a[112:127], a[184:187], v[152:155], a[112:127]
ds_read_b128 a[184:187], v21 offset:14336
v_exp_f32 v131, v67
v_exp_f32 v132, v68
s_cmp_lg_u32 s24, 3
s_cbranch_scc1 k12_kernel_xb1_bk
s_waitcnt vmcnt(4)
s_barrier
k12_kernel_xb1_bk:
v_mfma_f32_32x32x16_bf16 a[64:79], a[164:167], v[156:159], a[64:79]
ds_read_b128 a[164:167], v21 offset:9216
v_exp_f32 v133, v69
v_add_f32 v162, v162, v130
v_add_f32 v162, v162, v131
v_cvt_pk_bf16_f32 v145, v130, v131
v_mfma_f32_32x32x16_bf16 a[80:95], a[172:175], v[156:159], a[80:95]
ds_read_b128 a[172:175], v21 offset:11264
v_exp_f32 v134, v70
v_add_f32 v162, v162, v132
v_mfma_f32_32x32x16_bf16 a[96:111], a[180:183], v[156:159], a[96:111]
ds_read_b128 a[180:183], v21 offset:13312
v_exp_f32 v135, v71
v_add_f32 v162, v162, v133
v_cvt_pk_bf16_f32 v146, v132, v133
v_mfma_f32_32x32x16_bf16 a[112:127], a[188:191], v[156:159], a[112:127]
ds_read_b128 a[188:191], v21 offset:15360
v_add_f32 v162, v162, v134
v_add_f32 v162, v162, v135
v_cvt_pk_bf16_f32 v147, v134, v135
v_exp_f32 v136, v72
v_exp_f32 v137, v73
v_exp_f32 v138, v74
v_exp_f32 v139, v75
v_exp_f32 v140, v76
v_exp_f32 v141, v77
v_exp_f32 v142, v78
v_exp_f32 v143, v79
s_nop 0
v_add_f32 v162, v162, v136
v_add_f32 v162, v162, v137
v_add_f32 v162, v162, v138
v_add_f32 v162, v162, v139
v_add_f32 v162, v162, v140
v_add_f32 v162, v162, v141
v_add_f32 v162, v162, v142
v_add_f32 v162, v162, v143
v_cvt_pk_bf16_f32 v148, v136, v137
v_cvt_pk_bf16_f32 v149, v138, v139
v_cvt_pk_bf16_f32 v150, v140, v141
v_cvt_pk_bf16_f32 v151, v142, v143
v_med3_f32 v163, v162, s38, v4
v_cmp_neq_f32 vcc, v163, v162
s_waitcnt lgkmcnt(0)
s_cbranch_vccnz k12_kernel_fb_t
k12_kernel_bk_t:
v_add_f32 v161, v161, v162
s_nop 0
v_mfma_f32_32x32x16_bf16 a[64:79], a[160:163], v[144:147], a[64:79]
v_mfma_f32_32x32x16_bf16 a[80:95], a[168:171], v[144:147], a[80:95]
v_mfma_f32_32x32x16_bf16 a[96:111], a[176:179], v[144:147], a[96:111]
v_mfma_f32_32x32x16_bf16 a[112:127], a[184:187], v[144:147], a[112:127]
v_mfma_f32_32x32x16_bf16 a[64:79], a[164:167], v[148:151], a[64:79]
v_mfma_f32_32x32x16_bf16 a[80:95], a[172:175], v[148:151], a[80:95]
v_mfma_f32_32x32x16_bf16 a[96:111], a[180:183], v[148:151], a[96:111]
v_mfma_f32_32x32x16_bf16 a[112:127], a[188:191], v[148:151], a[112:127]
s_waitcnt vmcnt(0)
k12_kernel_epi:
v_mov_b32 v163, v161
v_mov_b32 v164, v161
s_lshl_b32 s50, s25, 19
s_lshl_b32 s51, s28, 11
v_permlane32_swap_b32 v163, v164
s_add_u32 s51, s51, s50
s_nop 0
v_add_f32 v163, v163, v164
v_rcp_f32 v168, v163
s_nop 7
v_accvgpr_read_b32 v64, a64
v_accvgpr_read_b32 v65, a65
v_accvgpr_read_b32 v66, a66
v_accvgpr_read_b32 v67, a67
v_accvgpr_read_b32 v68, a68
v_accvgpr_read_b32 v69, a69
v_accvgpr_read_b32 v70, a70
v_accvgpr_read_b32 v71, a71
v_pk_mul_f32 v[64:65], v[64:65], v[168:169] op_sel_hi:[1,0]
v_pk_mul_f32 v[66:67], v[66:67], v[168:169] op_sel_hi:[1,0]
v_pk_mul_f32 v[68:69], v[68:69], v[168:169] op_sel_hi:[1,0]
v_pk_mul_f32 v[70:71], v[70:71], v[168:169] op_sel_hi:[1,0]
v_cvt_pk_bf16_f32 v72, v64, v65
v_cvt_pk_bf16_f32 v73, v66, v67
v_cvt_pk_bf16_f32 v74, v68, v69
v_cvt_pk_bf16_f32 v75, v70, v71
buffer_store_dwordx4 v[72:75], v6, s[68:71], s51 offen offset:0 sc1
v_accvgpr_read_b32 v80, a72
v_accvgpr_read_b32 v81, a73
v_accvgpr_read_b32 v82, a74
v_accvgpr_read_b32 v83, a75
v_accvgpr_read_b32 v84, a76
v_accvgpr_read_b32 v85, a77
v_accvgpr_read_b32 v86, a78
v_accvgpr_read_b32 v87, a79
v_pk_mul_f32 v[80:81], v[80:81], v[168:169] op_sel_hi:[1,0]
v_pk_mul_f32 v[82:83], v[82:83], v[168:169] op_sel_hi:[1,0]
v_pk_mul_f32 v[84:85], v[84:85], v[168:169] op_sel_hi:[1,0]
v_pk_mul_f32 v[86:87], v[86:87], v[168:169] op_sel_hi:[1,0]
v_cvt_pk_bf16_f32 v88, v80, v81
v_cvt_pk_bf16_f32 v89, v82, v83
v_cvt_pk_bf16_f32 v90, v84, v85
v_cvt_pk_bf16_f32 v91, v86, v87
buffer_store_dwordx4 v[88:91], v6, s[68:71], s51 offen offset:512 sc1
s_add_u32 s51, s51, 131072
v_accvgpr_read_b32 v96, a80
v_accvgpr_read_b32 v97, a81
v_accvgpr_read_b32 v98, a82
v_accvgpr_read_b32 v99, a83
v_accvgpr_read_b32 v100, a84
v_accvgpr_read_b32 v101, a85
v_accvgpr_read_b32 v102, a86
v_accvgpr_read_b32 v103, a87
v_pk_mul_f32 v[96:97], v[96:97], v[168:169] op_sel_hi:[1,0]
v_pk_mul_f32 v[98:99], v[98:99], v[168:169] op_sel_hi:[1,0]
v_pk_mul_f32 v[100:101], v[100:101], v[168:169] op_sel_hi:[1,0]
v_pk_mul_f32 v[102:103], v[102:103], v[168:169] op_sel_hi:[1,0]
v_cvt_pk_bf16_f32 v104, v96, v97
v_cvt_pk_bf16_f32 v105, v98, v99
v_cvt_pk_bf16_f32 v106, v100, v101
v_cvt_pk_bf16_f32 v107, v102, v103
buffer_store_dwordx4 v[104:107], v6, s[68:71], s51 offen offset:0 sc1
v_accvgpr_read_b32 v112, a88
v_accvgpr_read_b32 v113, a89
v_accvgpr_read_b32 v114, a90
v_accvgpr_read_b32 v115, a91
v_accvgpr_read_b32 v116, a92
v_accvgpr_read_b32 v117, a93
v_accvgpr_read_b32 v118, a94
v_accvgpr_read_b32 v119, a95
v_pk_mul_f32 v[112:113], v[112:113], v[168:169] op_sel_hi:[1,0]
v_pk_mul_f32 v[114:115], v[114:115], v[168:169] op_sel_hi:[1,0]
v_pk_mul_f32 v[116:117], v[116:117], v[168:169] op_sel_hi:[1,0]
v_pk_mul_f32 v[118:119], v[118:119], v[168:169] op_sel_hi:[1,0]
v_cvt_pk_bf16_f32 v120, v112, v113
v_cvt_pk_bf16_f32 v121, v114, v115
v_cvt_pk_bf16_f32 v122, v116, v117
v_cvt_pk_bf16_f32 v123, v118, v119
buffer_store_dwordx4 v[120:123], v6, s[68:71], s51 offen offset:512 sc1
s_add_u32 s51, s51, 131072
v_accvgpr_read_b32 v64, a96
v_accvgpr_read_b32 v65, a97
v_accvgpr_read_b32 v66, a98
v_accvgpr_read_b32 v67, a99
v_accvgpr_read_b32 v68, a100
v_accvgpr_read_b32 v69, a101
v_accvgpr_read_b32 v70, a102
v_accvgpr_read_b32 v71, a103
v_pk_mul_f32 v[64:65], v[64:65], v[168:169] op_sel_hi:[1,0]
v_pk_mul_f32 v[66:67], v[66:67], v[168:169] op_sel_hi:[1,0]
v_pk_mul_f32 v[68:69], v[68:69], v[168:169] op_sel_hi:[1,0]
v_pk_mul_f32 v[70:71], v[70:71], v[168:169] op_sel_hi:[1,0]
v_cvt_pk_bf16_f32 v72, v64, v65
v_cvt_pk_bf16_f32 v73, v66, v67
v_cvt_pk_bf16_f32 v74, v68, v69
v_cvt_pk_bf16_f32 v75, v70, v71
buffer_store_dwordx4 v[72:75], v6, s[68:71], s51 offen offset:0 sc1
v_accvgpr_read_b32 v80, a104
v_accvgpr_read_b32 v81, a105
v_accvgpr_read_b32 v82, a106
v_accvgpr_read_b32 v83, a107
v_accvgpr_read_b32 v84, a108
v_accvgpr_read_b32 v85, a109
v_accvgpr_read_b32 v86, a110
v_accvgpr_read_b32 v87, a111
v_pk_mul_f32 v[80:81], v[80:81], v[168:169] op_sel_hi:[1,0]
v_pk_mul_f32 v[82:83], v[82:83], v[168:169] op_sel_hi:[1,0]
v_pk_mul_f32 v[84:85], v[84:85], v[168:169] op_sel_hi:[1,0]
v_pk_mul_f32 v[86:87], v[86:87], v[168:169] op_sel_hi:[1,0]
v_cvt_pk_bf16_f32 v88, v80, v81
v_cvt_pk_bf16_f32 v89, v82, v83
v_cvt_pk_bf16_f32 v90, v84, v85
v_cvt_pk_bf16_f32 v91, v86, v87
buffer_store_dwordx4 v[88:91], v6, s[68:71], s51 offen offset:512 sc1
s_add_u32 s51, s51, 131072
v_accvgpr_read_b32 v96, a112
v_accvgpr_read_b32 v97, a113
v_accvgpr_read_b32 v98, a114
v_accvgpr_read_b32 v99, a115
v_accvgpr_read_b32 v100, a116
v_accvgpr_read_b32 v101, a117
v_accvgpr_read_b32 v102, a118
v_accvgpr_read_b32 v103, a119
v_pk_mul_f32 v[96:97], v[96:97], v[168:169] op_sel_hi:[1,0]
v_pk_mul_f32 v[98:99], v[98:99], v[168:169] op_sel_hi:[1,0]
v_pk_mul_f32 v[100:101], v[100:101], v[168:169] op_sel_hi:[1,0]
v_pk_mul_f32 v[102:103], v[102:103], v[168:169] op_sel_hi:[1,0]
v_cvt_pk_bf16_f32 v104, v96, v97
v_cvt_pk_bf16_f32 v105, v98, v99
v_cvt_pk_bf16_f32 v106, v100, v101
v_cvt_pk_bf16_f32 v107, v102, v103
buffer_store_dwordx4 v[104:107], v6, s[68:71], s51 offen offset:0 sc1
v_accvgpr_read_b32 v112, a120
v_accvgpr_read_b32 v113, a121
v_accvgpr_read_b32 v114, a122
v_accvgpr_read_b32 v115, a123
v_accvgpr_read_b32 v116, a124
v_accvgpr_read_b32 v117, a125
v_accvgpr_read_b32 v118, a126
v_accvgpr_read_b32 v119, a127
v_pk_mul_f32 v[112:113], v[112:113], v[168:169] op_sel_hi:[1,0]
v_pk_mul_f32 v[114:115], v[114:115], v[168:169] op_sel_hi:[1,0]
v_pk_mul_f32 v[116:117], v[116:117], v[168:169] op_sel_hi:[1,0]
v_pk_mul_f32 v[118:119], v[118:119], v[168:169] op_sel_hi:[1,0]
v_cvt_pk_bf16_f32 v120, v112, v113
v_cvt_pk_bf16_f32 v121, v114, v115
v_cvt_pk_bf16_f32 v122, v116, v117
v_cvt_pk_bf16_f32 v123, v118, v119
buffer_store_dwordx4 v[120:123], v6, s[68:71], s51 offen offset:512 sc1
s_cmp_eq_u32 s24, 0
s_cbranch_scc1 k12_kernel_epid
s_cmp_lt_u32 s24, 3
s_cbranch_scc1 k12_kernel_epih
v_mov_b32 v163, v160
v_mov_b32 v164, v160
s_lshl_b32 s50, s25, 19
s_lshl_b32 s51, s27, 11
v_permlane32_swap_b32 v163, v164
s_add_u32 s51, s51, s50
s_nop 0
v_add_f32 v163, v163, v164
v_rcp_f32 v166, v163
s_nop 7
v_accvgpr_read_b32 v64, a0
v_accvgpr_read_b32 v65, a1
v_accvgpr_read_b32 v66, a2
v_accvgpr_read_b32 v67, a3
v_accvgpr_read_b32 v68, a4
v_accvgpr_read_b32 v69, a5
v_accvgpr_read_b32 v70, a6
v_accvgpr_read_b32 v71, a7
v_pk_mul_f32 v[64:65], v[64:65], v[166:167] op_sel_hi:[1,0]
v_pk_mul_f32 v[66:67], v[66:67], v[166:167] op_sel_hi:[1,0]
v_pk_mul_f32 v[68:69], v[68:69], v[166:167] op_sel_hi:[1,0]
v_pk_mul_f32 v[70:71], v[70:71], v[166:167] op_sel_hi:[1,0]
v_cvt_pk_bf16_f32 v72, v64, v65
v_cvt_pk_bf16_f32 v73, v66, v67
v_cvt_pk_bf16_f32 v74, v68, v69
v_cvt_pk_bf16_f32 v75, v70, v71
buffer_store_dwordx4 v[72:75], v6, s[68:71], s51 offen offset:0 sc1
v_accvgpr_read_b32 v80, a8
v_accvgpr_read_b32 v81, a9
v_accvgpr_read_b32 v82, a10
v_accvgpr_read_b32 v83, a11
v_accvgpr_read_b32 v84, a12
v_accvgpr_read_b32 v85, a13
v_accvgpr_read_b32 v86, a14
v_accvgpr_read_b32 v87, a15
v_pk_mul_f32 v[80:81], v[80:81], v[166:167] op_sel_hi:[1,0]
v_pk_mul_f32 v[82:83], v[82:83], v[166:167] op_sel_hi:[1,0]
v_pk_mul_f32 v[84:85], v[84:85], v[166:167] op_sel_hi:[1,0]
v_pk_mul_f32 v[86:87], v[86:87], v[166:167] op_sel_hi:[1,0]
v_cvt_pk_bf16_f32 v88, v80, v81
v_cvt_pk_bf16_f32 v89, v82, v83
v_cvt_pk_bf16_f32 v90, v84, v85
v_cvt_pk_bf16_f32 v91, v86, v87
buffer_store_dwordx4 v[88:91], v6, s[68:71], s51 offen offset:512 sc1
tp0_p12:
s_cbranch_execz tp0_ret
s_add_u32 s51, s51, 131072
v_accvgpr_read_b32 v96, a16
v_accvgpr_read_b32 v97, a17
v_accvgpr_read_b32 v98, a18
v_accvgpr_read_b32 v99, a19
v_accvgpr_read_b32 v100, a20
v_accvgpr_read_b32 v101, a21
v_accvgpr_read_b32 v102, a22
v_accvgpr_read_b32 v103, a23
v_pk_mul_f32 v[96:97], v[96:97], v[166:167] op_sel_hi:[1,0]
v_pk_mul_f32 v[98:99], v[98:99], v[166:167] op_sel_hi:[1,0]
v_pk_mul_f32 v[100:101], v[100:101], v[166:167] op_sel_hi:[1,0]
v_pk_mul_f32 v[102:103], v[102:103], v[166:167] op_sel_hi:[1,0]
v_cvt_pk_bf16_f32 v104, v96, v97
v_cvt_pk_bf16_f32 v105, v98, v99
v_cvt_pk_bf16_f32 v106, v100, v101
v_cvt_pk_bf16_f32 v107, v102, v103
buffer_store_dwordx4 v[104:107], v6, s[68:71], s51 offen offset:0 sc1
v_accvgpr_read_b32 v112, a24
v_accvgpr_read_b32 v113, a25
v_accvgpr_read_b32 v114, a26
v_accvgpr_read_b32 v115, a27
v_accvgpr_read_b32 v116, a28
v_accvgpr_read_b32 v117, a29
v_accvgpr_read_b32 v118, a30
v_accvgpr_read_b32 v119, a31
v_pk_mul_f32 v[112:113], v[112:113], v[166:167] op_sel_hi:[1,0]
v_pk_mul_f32 v[114:115], v[114:115], v[166:167] op_sel_hi:[1,0]
v_pk_mul_f32 v[116:117], v[116:117], v[166:167] op_sel_hi:[1,0]
v_pk_mul_f32 v[118:119], v[118:119], v[166:167] op_sel_hi:[1,0]
v_cvt_pk_bf16_f32 v120, v112, v113
v_cvt_pk_bf16_f32 v121, v114, v115
v_cvt_pk_bf16_f32 v122, v116, v117
v_cvt_pk_bf16_f32 v123, v118, v119
buffer_store_dwordx4 v[120:123], v6, s[68:71], s51 offen offset:512 sc1
k12_kernel_epih:
s_lshl_b32 s50, s25, 19
s_lshl_b32 s51, s27, 11
s_add_u32 s51, s51, s50
s_add_u32 s51, s51, 262144
v_accvgpr_read_b32 v64, a32
v_accvgpr_read_b32 v65, a33
v_accvgpr_read_b32 v66, a34
v_accvgpr_read_b32 v67, a35
v_accvgpr_read_b32 v68, a36
v_accvgpr_read_b32 v69, a37
v_accvgpr_read_b32 v70, a38
v_accvgpr_read_b32 v71, a39
v_pk_mul_f32 v[64:65], v[64:65], v[166:167] op_sel_hi:[1,0]
v_pk_mul_f32 v[66:67], v[66:67], v[166:167] op_sel_hi:[1,0]
v_pk_mul_f32 v[68:69], v[68:69], v[166:167] op_sel_hi:[1,0]
v_pk_mul_f32 v[70:71], v[70:71], v[166:167] op_sel_hi:[1,0]
v_cvt_pk_bf16_f32 v72, v64, v65
v_cvt_pk_bf16_f32 v73, v66, v67
v_cvt_pk_bf16_f32 v74, v68, v69
v_cvt_pk_bf16_f32 v75, v70, v71
buffer_store_dwordx4 v[72:75], v6, s[68:71], s51 offen offset:0 sc1
v_accvgpr_read_b32 v80, a40
v_accvgpr_read_b32 v81, a41
v_accvgpr_read_b32 v82, a42
v_accvgpr_read_b32 v83, a43
v_accvgpr_read_b32 v84, a44
v_accvgpr_read_b32 v85, a45
v_accvgpr_read_b32 v86, a46
v_accvgpr_read_b32 v87, a47
v_pk_mul_f32 v[80:81], v[80:81], v[166:167] op_sel_hi:[1,0]
v_pk_mul_f32 v[82:83], v[82:83], v[166:167] op_sel_hi:[1,0]
v_pk_mul_f32 v[84:85], v[84:85], v[166:167] op_sel_hi:[1,0]
v_pk_mul_f32 v[86:87], v[86:87], v[166:167] op_sel_hi:[1,0]
v_cvt_pk_bf16_f32 v88, v80, v81
v_cvt_pk_bf16_f32 v89, v82, v83
v_cvt_pk_bf16_f32 v90, v84, v85
v_cvt_pk_bf16_f32 v91, v86, v87
buffer_store_dwordx4 v[88:91], v6, s[68:71], s51 offen offset:512 sc1
s_add_u32 s51, s51, 131072
v_accvgpr_read_b32 v96, a48
v_accvgpr_read_b32 v97, a49
v_accvgpr_read_b32 v98, a50
v_accvgpr_read_b32 v99, a51
v_accvgpr_read_b32 v100, a52
v_accvgpr_read_b32 v101, a53
v_accvgpr_read_b32 v102, a54
v_accvgpr_read_b32 v103, a55
v_pk_mul_f32 v[96:97], v[96:97], v[166:167] op_sel_hi:[1,0]
v_pk_mul_f32 v[98:99], v[98:99], v[166:167] op_sel_hi:[1,0]
v_pk_mul_f32 v[100:101], v[100:101], v[166:167] op_sel_hi:[1,0]
v_pk_mul_f32 v[102:103], v[102:103], v[166:167] op_sel_hi:[1,0]
v_cvt_pk_bf16_f32 v104, v96, v97
v_cvt_pk_bf16_f32 v105, v98, v99
v_cvt_pk_bf16_f32 v106, v100, v101
v_cvt_pk_bf16_f32 v107, v102, v103
buffer_store_dwordx4 v[104:107], v6, s[68:71], s51 offen offset:0 sc1
v_accvgpr_read_b32 v112, a56
v_accvgpr_read_b32 v113, a57
v_accvgpr_read_b32 v114, a58
v_accvgpr_read_b32 v115, a59
v_accvgpr_read_b32 v116, a60
v_accvgpr_read_b32 v117, a61
v_accvgpr_read_b32 v118, a62
v_accvgpr_read_b32 v119, a63
v_pk_mul_f32 v[112:113], v[112:113], v[166:167] op_sel_hi:[1,0]
v_pk_mul_f32 v[114:115], v[114:115], v[166:167] op_sel_hi:[1,0]
v_pk_mul_f32 v[116:117], v[116:117], v[166:167] op_sel_hi:[1,0]
v_pk_mul_f32 v[118:119], v[118:119], v[166:167] op_sel_hi:[1,0]
v_cvt_pk_bf16_f32 v120, v112, v113
v_cvt_pk_bf16_f32 v121, v114, v115
v_cvt_pk_bf16_f32 v122, v116, v117
v_cvt_pk_bf16_f32 v123, v118, v119
buffer_store_dwordx4 v[120:123], v6, s[68:71], s51 offen offset:512 sc1
k12_kernel_epid:
s_sub_u32 s3, s2, 128
s_cmp_ge_u32 s3, 32
s_cbranch_scc1 k12_kernel_end
s_lshr_b32 s3, s3, 3
s_lshl_b32 s3, s3, 2
s_add_u32 s3, s3, s24
s_mov_b64 exec, 0
s_cmp_eq_u32 s3, 0
s_cbranch_scc1 tf_p0
s_cmp_eq_u32 s3, 1
s_cbranch_scc1 tf_p1
s_cmp_eq_u32 s3, 2
s_cbranch_scc1 tf_p2
s_cmp_eq_u32 s3, 3
s_cbranch_scc1 tf_p3
s_cmp_eq_u32 s3, 4
s_cbranch_scc1 tf_p4
s_cmp_eq_u32 s3, 5
s_cbranch_scc1 tf_p5
s_cmp_eq_u32 s3, 6
s_cbranch_scc1 tf_p6
s_cmp_eq_u32 s3, 7
s_cbranch_scc1 tf_p7
s_cmp_eq_u32 s3, 8
s_cbranch_scc1 tf_p8
s_cmp_eq_u32 s3, 9
s_cbranch_scc1 tf_p9
s_cmp_eq_u32 s3, 10
s_cbranch_scc1 tf_p10
s_cmp_eq_u32 s3, 11
s_cbranch_scc1 tf_p11
s_cmp_eq_u32 s3, 12
s_cbranch_scc1 tf_p12
s_cmp_eq_u32 s3, 13
s_cbranch_scc1 tf_p13
s_cmp_eq_u32 s3, 14
s_cbranch_scc1 tf_p14
k12_kernel_end:
s_endpgm
k12_kernel_gspinK:
s_mov_b32 s101, 200000
k12_kernel_gspK:
buffer_load_dword v36, v38, s[20:23], 0 offen sc1
s_waitcnt vmcnt(0)
v_cmp_ne_u32 vcc, s76, v36
s_cbranch_vccz k12_kernel_gbackK
s_sub_u32 s101, s101, 1
s_cmp_lg_u32 s101, 0
s_cbranch_scc1 k12_kernel_gspK
s_branch k12_kernel_gbackK
k12_kernel_gspinV:
s_mov_b32 s101, 200000
k12_kernel_gspV:
buffer_load_dword v36, v38, s[20:23], 0 offen sc1
s_waitcnt vmcnt(0)
v_cmp_ne_u32 vcc, s76, v36
s_cbranch_vccz k12_kernel_gbackV
s_sub_u32 s101, s101, 1
s_cmp_lg_u32 s101, 0
s_cbranch_scc1 k12_kernel_gspV
s_branch k12_kernel_gbackV
k12_kernel_fspin:
s_mov_b32 s101, 200000
s_lshl_b32 s100, s25, 10
k12_kernel_fsp:
buffer_load_dword v36, v37, s[64:67], s100 offen sc1
s_waitcnt vmcnt(0)
v_cmp_gt_u32 vcc, 1, v36
s_cbranch_vccz k12_kernel_fback
s_sub_u32 s101, s101, 1
s_cmp_lg_u32 s101, 0
s_cbranch_scc1 k12_kernel_fsp
s_branch k12_kernel_fback
k12_kernel_fb_dA:
v_max3_f32 v163, v80, v81, v82
v_max3_f32 v163, v163, v83, v84
v_max3_f32 v163, v163, v85, v86
v_max3_f32 v163, v163, v87, v88
v_max3_f32 v163, v163, v89, v90
v_max3_f32 v163, v163, v91, v92
v_max3_f32 v163, v163, v93, v94
v_max_f32 v163, v163, v95
v_mov_b32 v164, v163
s_cmp_lg_u32 s38, 0
s_cselect_b32 s35, 0xff800000, 0
v_permlane32_swap_b32 v163, v164
v_max_f32 v163, v163, v164
v_max_f32 v163, s35, v163
v_exp_f32 v164, -v163
s_nop 0
v_min_f32 v164, 1.0, v164
v_sub_f32 v80, v80, v163
v_sub_f32 v81, v81, v163
v_sub_f32 v82, v82, v163
v_sub_f32 v83, v83, v163
v_sub_f32 v84, v84, v163
v_sub_f32 v85, v85, v163
v_sub_f32 v86, v86, v163
v_sub_f32 v87, v87, v163
v_sub_f32 v88, v88, v163
v_sub_f32 v89, v89, v163
v_sub_f32 v90, v90, v163
v_sub_f32 v91, v91, v163
v_sub_f32 v92, v92, v163
v_sub_f32 v93, v93, v163
v_sub_f32 v94, v94, v163
v_sub_f32 v95, v95, v163
v_sub_f32 v112, v112, v163
v_sub_f32 v113, v113, v163
v_sub_f32 v114, v114, v163
v_sub_f32 v115, v115, v163
v_sub_f32 v116, v116, v163
v_sub_f32 v117, v117, v163
v_sub_f32 v118, v118, v163
v_sub_f32 v119, v119, v163
v_sub_f32 v120, v120, v163
v_sub_f32 v121, v121, v163
v_sub_f32 v122, v122, v163
v_sub_f32 v123, v123, v163
v_sub_f32 v124, v124, v163
v_sub_f32 v125, v125, v163
v_sub_f32 v126, v126, v163
v_sub_f32 v127, v127, v163
v_mul_f32 v161, v161, v164
v_accvgpr_read_b32 v24, a64
v_accvgpr_read_b32 v25, a65
v_accvgpr_read_b32 v26, a66
v_accvgpr_read_b32 v27, a67
v_mul_f32 v24, v24, v164
v_mul_f32 v25, v25, v164
v_mul_f32 v26, v26, v164
v_mul_f32 v27, v27, v164
v_accvgpr_write_b32 a64, v24
v_accvgpr_write_b32 a65, v25
v_accvgpr_write_b32 a66, v26
v_accvgpr_write_b32 a67, v27
v_accvgpr_read_b32 v24, a68
v_accvgpr_read_b32 v25, a69
v_accvgpr_read_b32 v26, a70
v_accvgpr_read_b32 v27, a71
v_mul_f32 v24, v24, v164
v_mul_f32 v25, v25, v164
v_mul_f32 v26, v26, v164
v_mul_f32 v27, v27, v164
v_accvgpr_write_b32 a68, v24
v_accvgpr_write_b32 a69, v25
v_accvgpr_write_b32 a70, v26
v_accvgpr_write_b32 a71, v27
v_accvgpr_read_b32 v24, a72
v_accvgpr_read_b32 v25, a73
v_accvgpr_read_b32 v26, a74
v_accvgpr_read_b32 v27, a75
v_mul_f32 v24, v24, v164
v_mul_f32 v25, v25, v164
v_mul_f32 v26, v26, v164
v_mul_f32 v27, v27, v164
v_accvgpr_write_b32 a72, v24
v_accvgpr_write_b32 a73, v25
v_accvgpr_write_b32 a74, v26
v_accvgpr_write_b32 a75, v27
v_accvgpr_read_b32 v24, a76
v_accvgpr_read_b32 v25, a77
v_accvgpr_read_b32 v26, a78
v_accvgpr_read_b32 v27, a79
v_mul_f32 v24, v24, v164
v_mul_f32 v25, v25, v164
v_mul_f32 v26, v26, v164
v_mul_f32 v27, v27, v164
v_accvgpr_write_b32 a76, v24
v_accvgpr_write_b32 a77, v25
v_accvgpr_write_b32 a78, v26
v_accvgpr_write_b32 a79, v27
v_accvgpr_read_b32 v24, a80
v_accvgpr_read_b32 v25, a81
v_accvgpr_read_b32 v26, a82
v_accvgpr_read_b32 v27, a83
v_mul_f32 v24, v24, v164
v_mul_f32 v25, v25, v164
v_mul_f32 v26, v26, v164
v_mul_f32 v27, v27, v164
v_accvgpr_write_b32 a80, v24
v_accvgpr_write_b32 a81, v25
v_accvgpr_write_b32 a82, v26
v_accvgpr_write_b32 a83, v27
v_accvgpr_read_b32 v24, a84
v_accvgpr_read_b32 v25, a85
v_accvgpr_read_b32 v26, a86
v_accvgpr_read_b32 v27, a87
v_mul_f32 v24, v24, v164
v_mul_f32 v25, v25, v164
v_mul_f32 v26, v26, v164
v_mul_f32 v27, v27, v164
v_accvgpr_write_b32 a84, v24
v_accvgpr_write_b32 a85, v25
v_accvgpr_write_b32 a86, v26
v_accvgpr_write_b32 a87, v27
v_accvgpr_read_b32 v24, a88
v_accvgpr_read_b32 v25, a89
v_accvgpr_read_b32 v26, a90
v_accvgpr_read_b32 v27, a91
v_mul_f32 v24, v24, v164
v_mul_f32 v25, v25, v164
v_mul_f32 v26, v26, v164
v_mul_f32 v27, v27, v164
v_accvgpr_write_b32 a88, v24
v_accvgpr_write_b32 a89, v25
v_accvgpr_write_b32 a90, v26
v_accvgpr_write_b32 a91, v27
v_accvgpr_read_b32 v24, a92
v_accvgpr_read_b32 v25, a93
v_accvgpr_read_b32 v26, a94
v_accvgpr_read_b32 v27, a95
v_mul_f32 v24, v24, v164
v_mul_f32 v25, v25, v164
v_mul_f32 v26, v26, v164
v_mul_f32 v27, v27, v164
v_accvgpr_write_b32 a92, v24
v_accvgpr_write_b32 a93, v25
v_accvgpr_write_b32 a94, v26
v_accvgpr_write_b32 a95, v27
v_accvgpr_read_b32 v24, a96
v_accvgpr_read_b32 v25, a97
v_accvgpr_read_b32 v26, a98
v_accvgpr_read_b32 v27, a99
v_mul_f32 v24, v24, v164
v_mul_f32 v25, v25, v164
v_mul_f32 v26, v26, v164
v_mul_f32 v27, v27, v164
v_accvgpr_write_b32 a96, v24
v_accvgpr_write_b32 a97, v25
v_accvgpr_write_b32 a98, v26
v_accvgpr_write_b32 a99, v27
v_accvgpr_read_b32 v24, a100
v_accvgpr_read_b32 v25, a101
v_accvgpr_read_b32 v26, a102
v_accvgpr_read_b32 v27, a103
v_mul_f32 v24, v24, v164
v_mul_f32 v25, v25, v164
v_mul_f32 v26, v26, v164
v_mul_f32 v27, v27, v164
v_accvgpr_write_b32 a100, v24
v_accvgpr_write_b32 a101, v25
v_accvgpr_write_b32 a102, v26
v_accvgpr_write_b32 a103, v27
v_accvgpr_read_b32 v24, a104
v_accvgpr_read_b32 v25, a105
v_accvgpr_read_b32 v26, a106
v_accvgpr_read_b32 v27, a107
v_mul_f32 v24, v24, v164
v_mul_f32 v25, v25, v164
v_mul_f32 v26, v26, v164
v_mul_f32 v27, v27, v164
v_accvgpr_write_b32 a104, v24
v_accvgpr_write_b32 a105, v25
v_accvgpr_write_b32 a106, v26
v_accvgpr_write_b32 a107, v27
v_accvgpr_read_b32 v24, a108
v_accvgpr_read_b32 v25, a109
v_accvgpr_read_b32 v26, a110
v_accvgpr_read_b32 v27, a111
v_mul_f32 v24, v24, v164
v_mul_f32 v25, v25, v164
v_mul_f32 v26, v26, v164
v_mul_f32 v27, v27, v164
v_accvgpr_write_b32 a108, v24
v_accvgpr_write_b32 a109, v25
v_accvgpr_write_b32 a110, v26
v_accvgpr_write_b32 a111, v27
v_accvgpr_read_b32 v24, a112
v_accvgpr_read_b32 v25, a113
v_accvgpr_read_b32 v26, a114
v_accvgpr_read_b32 v27, a115
v_mul_f32 v24, v24, v164
v_mul_f32 v25, v25, v164
v_mul_f32 v26, v26, v164
v_mul_f32 v27, v27, v164
v_accvgpr_write_b32 a112, v24
v_accvgpr_write_b32 a113, v25
v_accvgpr_write_b32 a114, v26
v_accvgpr_write_b32 a115, v27
v_accvgpr_read_b32 v24, a116
v_accvgpr_read_b32 v25, a117
v_accvgpr_read_b32 v26, a118
v_accvgpr_read_b32 v27, a119
v_mul_f32 v24, v24, v164
v_mul_f32 v25, v25, v164
v_mul_f32 v26, v26, v164
v_mul_f32 v27, v27, v164
v_accvgpr_write_b32 a116, v24
v_accvgpr_write_b32 a117, v25
v_accvgpr_write_b32 a118, v26
v_accvgpr_write_b32 a119, v27
v_accvgpr_read_b32 v24, a120
v_accvgpr_read_b32 v25, a121
v_accvgpr_read_b32 v26, a122
v_accvgpr_read_b32 v27, a123
v_mul_f32 v24, v24, v164
v_mul_f32 v25, v25, v164
v_mul_f32 v26, v26, v164
v_mul_f32 v27, v27, v164
v_accvgpr_write_b32 a120, v24
v_accvgpr_write_b32 a121, v25
v_accvgpr_write_b32 a122, v26
v_accvgpr_write_b32 a123, v27
v_accvgpr_read_b32 v24, a124
v_accvgpr_read_b32 v25, a125
v_accvgpr_read_b32 v26, a126
v_accvgpr_read_b32 v27, a127
v_mul_f32 v24, v24, v164
v_mul_f32 v25, v25, v164
v_mul_f32 v26, v26, v164
v_mul_f32 v27, v27, v164
v_accvgpr_write_b32 a124, v24
v_accvgpr_write_b32 a125, v25
v_accvgpr_write_b32 a126, v26
v_accvgpr_write_b32 a127, v27
v_exp_f32 v128, v80
v_exp_f32 v129, v81
v_exp_f32 v130, v82
v_exp_f32 v131, v83
v_exp_f32 v132, v84
v_exp_f32 v133, v85
v_exp_f32 v134, v86
v_exp_f32 v135, v87
v_exp_f32 v136, v88
v_exp_f32 v137, v89
v_exp_f32 v138, v90
v_exp_f32 v139, v91
v_exp_f32 v140, v92
v_exp_f32 v141, v93
v_exp_f32 v142, v94
v_exp_f32 v143, v95
s_nop 0
v_add_f32 v162, v128, v129
v_add_f32 v162, v162, v130
v_add_f32 v162, v162, v131
v_add_f32 v162, v162, v132
v_add_f32 v162, v162, v133
v_add_f32 v162, v162, v134
v_add_f32 v162, v162, v135
v_add_f32 v162, v162, v136
v_add_f32 v162, v162, v137
v_add_f32 v162, v162, v138
v_add_f32 v162, v162, v139
v_add_f32 v162, v162, v140
v_add_f32 v162, v162, v141
v_add_f32 v162, v162, v142
v_add_f32 v162, v162, v143
v_cvt_pk_bf16_f32 v152, v128, v129
v_cvt_pk_bf16_f32 v153, v130, v131
v_cvt_pk_bf16_f32 v154, v132, v133
v_cvt_pk_bf16_f32 v155, v134, v135
v_cvt_pk_bf16_f32 v156, v136, v137
v_cvt_pk_bf16_f32 v157, v138, v139
v_cvt_pk_bf16_f32 v158, v140, v141
v_cvt_pk_bf16_f32 v159, v142, v143
s_nop 1
s_branch k12_kernel_bk_dA
k12_kernel_fb_dB:
v_max3_f32 v163, v64, v65, v66
v_max3_f32 v163, v163, v67, v68
v_max3_f32 v163, v163, v69, v70
v_max3_f32 v163, v163, v71, v72
v_max3_f32 v163, v163, v73, v74
v_max3_f32 v163, v163, v75, v76
v_max3_f32 v163, v163, v77, v78
v_max_f32 v163, v163, v79
v_mov_b32 v164, v163
s_cmp_lg_u32 s38, 0
s_cselect_b32 s35, 0xff800000, 0
v_permlane32_swap_b32 v163, v164
v_max_f32 v163, v163, v164
v_max_f32 v163, s35, v163
v_exp_f32 v164, -v163
s_nop 0
v_min_f32 v164, 1.0, v164
v_sub_f32 v64, v64, v163
v_sub_f32 v65, v65, v163
v_sub_f32 v66, v66, v163
v_sub_f32 v67, v67, v163
v_sub_f32 v68, v68, v163
v_sub_f32 v69, v69, v163
v_sub_f32 v70, v70, v163
v_sub_f32 v71, v71, v163
v_sub_f32 v72, v72, v163
v_sub_f32 v73, v73, v163
v_sub_f32 v74, v74, v163
v_sub_f32 v75, v75, v163
v_sub_f32 v76, v76, v163
v_sub_f32 v77, v77, v163
v_sub_f32 v78, v78, v163
v_sub_f32 v79, v79, v163
v_sub_f32 v96, v96, v163
v_sub_f32 v97, v97, v163
v_sub_f32 v98, v98, v163
v_sub_f32 v99, v99, v163
v_sub_f32 v100, v100, v163
v_sub_f32 v101, v101, v163
v_sub_f32 v102, v102, v163
v_sub_f32 v103, v103, v163
v_sub_f32 v104, v104, v163
v_sub_f32 v105, v105, v163
v_sub_f32 v106, v106, v163
v_sub_f32 v107, v107, v163
v_sub_f32 v108, v108, v163
v_sub_f32 v109, v109, v163
v_sub_f32 v110, v110, v163
v_sub_f32 v111, v111, v163
v_mul_f32 v160, v160, v164
v_accvgpr_read_b32 v24, a0
v_accvgpr_read_b32 v25, a1
v_accvgpr_read_b32 v26, a2
v_accvgpr_read_b32 v27, a3
v_mul_f32 v24, v24, v164
v_mul_f32 v25, v25, v164
v_mul_f32 v26, v26, v164
v_mul_f32 v27, v27, v164
v_accvgpr_write_b32 a0, v24
v_accvgpr_write_b32 a1, v25
v_accvgpr_write_b32 a2, v26
v_accvgpr_write_b32 a3, v27
v_accvgpr_read_b32 v24, a4
v_accvgpr_read_b32 v25, a5
v_accvgpr_read_b32 v26, a6
v_accvgpr_read_b32 v27, a7
v_mul_f32 v24, v24, v164
v_mul_f32 v25, v25, v164
v_mul_f32 v26, v26, v164
v_mul_f32 v27, v27, v164
v_accvgpr_write_b32 a4, v24
v_accvgpr_write_b32 a5, v25
v_accvgpr_write_b32 a6, v26
v_accvgpr_write_b32 a7, v27
v_accvgpr_read_b32 v24, a8
v_accvgpr_read_b32 v25, a9
v_accvgpr_read_b32 v26, a10
v_accvgpr_read_b32 v27, a11
v_mul_f32 v24, v24, v164
v_mul_f32 v25, v25, v164
v_mul_f32 v26, v26, v164
v_mul_f32 v27, v27, v164
v_accvgpr_write_b32 a8, v24
v_accvgpr_write_b32 a9, v25
v_accvgpr_write_b32 a10, v26
v_accvgpr_write_b32 a11, v27
v_accvgpr_read_b32 v24, a12
v_accvgpr_read_b32 v25, a13
v_accvgpr_read_b32 v26, a14
v_accvgpr_read_b32 v27, a15
v_mul_f32 v24, v24, v164
v_mul_f32 v25, v25, v164
v_mul_f32 v26, v26, v164
v_mul_f32 v27, v27, v164
v_accvgpr_write_b32 a12, v24
v_accvgpr_write_b32 a13, v25
v_accvgpr_write_b32 a14, v26
v_accvgpr_write_b32 a15, v27
v_accvgpr_read_b32 v24, a16
v_accvgpr_read_b32 v25, a17
v_accvgpr_read_b32 v26, a18
v_accvgpr_read_b32 v27, a19
v_mul_f32 v24, v24, v164
v_mul_f32 v25, v25, v164
v_mul_f32 v26, v26, v164
v_mul_f32 v27, v27, v164
v_accvgpr_write_b32 a16, v24
v_accvgpr_write_b32 a17, v25
v_accvgpr_write_b32 a18, v26
v_accvgpr_write_b32 a19, v27
v_accvgpr_read_b32 v24, a20
v_accvgpr_read_b32 v25, a21
v_accvgpr_read_b32 v26, a22
v_accvgpr_read_b32 v27, a23
v_mul_f32 v24, v24, v164
v_mul_f32 v25, v25, v164
v_mul_f32 v26, v26, v164
v_mul_f32 v27, v27, v164
v_accvgpr_write_b32 a20, v24
v_accvgpr_write_b32 a21, v25
v_accvgpr_write_b32 a22, v26
v_accvgpr_write_b32 a23, v27
v_accvgpr_read_b32 v24, a24
v_accvgpr_read_b32 v25, a25
v_accvgpr_read_b32 v26, a26
v_accvgpr_read_b32 v27, a27
v_mul_f32 v24, v24, v164
v_mul_f32 v25, v25, v164
v_mul_f32 v26, v26, v164
v_mul_f32 v27, v27, v164
v_accvgpr_write_b32 a24, v24
v_accvgpr_write_b32 a25, v25
v_accvgpr_write_b32 a26, v26
v_accvgpr_write_b32 a27, v27
v_accvgpr_read_b32 v24, a28
v_accvgpr_read_b32 v25, a29
v_accvgpr_read_b32 v26, a30
v_accvgpr_read_b32 v27, a31
v_mul_f32 v24, v24, v164
v_mul_f32 v25, v25, v164
v_mul_f32 v26, v26, v164
v_mul_f32 v27, v27, v164
v_accvgpr_write_b32 a28, v24
v_accvgpr_write_b32 a29, v25
v_accvgpr_write_b32 a30, v26
v_accvgpr_write_b32 a31, v27
v_accvgpr_read_b32 v24, a32
v_accvgpr_read_b32 v25, a33
v_accvgpr_read_b32 v26, a34
v_accvgpr_read_b32 v27, a35
v_mul_f32 v24, v24, v164
v_mul_f32 v25, v25, v164
v_mul_f32 v26, v26, v164
v_mul_f32 v27, v27, v164
v_accvgpr_write_b32 a32, v24
v_accvgpr_write_b32 a33, v25
v_accvgpr_write_b32 a34, v26
v_accvgpr_write_b32 a35, v27
v_accvgpr_read_b32 v24, a36
v_accvgpr_read_b32 v25, a37
v_accvgpr_read_b32 v26, a38
v_accvgpr_read_b32 v27, a39
v_mul_f32 v24, v24, v164
v_mul_f32 v25, v25, v164
v_mul_f32 v26, v26, v164
v_mul_f32 v27, v27, v164
v_accvgpr_write_b32 a36, v24
v_accvgpr_write_b32 a37, v25
v_accvgpr_write_b32 a38, v26
v_accvgpr_write_b32 a39, v27
v_accvgpr_read_b32 v24, a40
v_accvgpr_read_b32 v25, a41
v_accvgpr_read_b32 v26, a42
v_accvgpr_read_b32 v27, a43
v_mul_f32 v24, v24, v164
v_mul_f32 v25, v25, v164
v_mul_f32 v26, v26, v164
v_mul_f32 v27, v27, v164
v_accvgpr_write_b32 a40, v24
v_accvgpr_write_b32 a41, v25
v_accvgpr_write_b32 a42, v26
v_accvgpr_write_b32 a43, v27
v_accvgpr_read_b32 v24, a44
v_accvgpr_read_b32 v25, a45
v_accvgpr_read_b32 v26, a46
v_accvgpr_read_b32 v27, a47
v_mul_f32 v24, v24, v164
v_mul_f32 v25, v25, v164
v_mul_f32 v26, v26, v164
v_mul_f32 v27, v27, v164
v_accvgpr_write_b32 a44, v24
v_accvgpr_write_b32 a45, v25
v_accvgpr_write_b32 a46, v26
v_accvgpr_write_b32 a47, v27
v_accvgpr_read_b32 v24, a48
v_accvgpr_read_b32 v25, a49
v_accvgpr_read_b32 v26, a50
v_accvgpr_read_b32 v27, a51
v_mul_f32 v24, v24, v164
v_mul_f32 v25, v25, v164
v_mul_f32 v26, v26, v164
v_mul_f32 v27, v27, v164
v_accvgpr_write_b32 a48, v24
v_accvgpr_write_b32 a49, v25
v_accvgpr_write_b32 a50, v26
v_accvgpr_write_b32 a51, v27
v_accvgpr_read_b32 v24, a52
v_accvgpr_read_b32 v25, a53
v_accvgpr_read_b32 v26, a54
v_accvgpr_read_b32 v27, a55
v_mul_f32 v24, v24, v164
v_mul_f32 v25, v25, v164
v_mul_f32 v26, v26, v164
v_mul_f32 v27, v27, v164
v_accvgpr_write_b32 a52, v24
v_accvgpr_write_b32 a53, v25
v_accvgpr_write_b32 a54, v26
v_accvgpr_write_b32 a55, v27
v_accvgpr_read_b32 v24, a56
v_accvgpr_read_b32 v25, a57
v_accvgpr_read_b32 v26, a58
v_accvgpr_read_b32 v27, a59
v_mul_f32 v24, v24, v164
v_mul_f32 v25, v25, v164
v_mul_f32 v26, v26, v164
v_mul_f32 v27, v27, v164
v_accvgpr_write_b32 a56, v24
v_accvgpr_write_b32 a57, v25
v_accvgpr_write_b32 a58, v26
v_accvgpr_write_b32 a59, v27
v_accvgpr_read_b32 v24, a60
v_accvgpr_read_b32 v25, a61
v_accvgpr_read_b32 v26, a62
v_accvgpr_read_b32 v27, a63
v_mul_f32 v24, v24, v164
v_mul_f32 v25, v25, v164
v_mul_f32 v26, v26, v164
v_mul_f32 v27, v27, v164
v_accvgpr_write_b32 a60, v24
v_accvgpr_write_b32 a61, v25
v_accvgpr_write_b32 a62, v26
v_accvgpr_write_b32 a63, v27
v_exp_f32 v128, v64
v_exp_f32 v129, v65
v_exp_f32 v130, v66
v_exp_f32 v131, v67
v_exp_f32 v132, v68
v_exp_f32 v133, v69
v_exp_f32 v134, v70
v_exp_f32 v135, v71
v_exp_f32 v136, v72
v_exp_f32 v137, v73
v_exp_f32 v138, v74
v_exp_f32 v139, v75
v_exp_f32 v140, v76
v_exp_f32 v141, v77
v_exp_f32 v142, v78
v_exp_f32 v143, v79
s_nop 0
v_add_f32 v162, v128, v129
v_add_f32 v162, v162, v130
v_add_f32 v162, v162, v131
v_add_f32 v162, v162, v132
v_add_f32 v162, v162, v133
v_add_f32 v162, v162, v134
v_add_f32 v162, v162, v135
v_add_f32 v162, v162, v136
v_add_f32 v162, v162, v137
v_add_f32 v162, v162, v138
v_add_f32 v162, v162, v139
v_add_f32 v162, v162, v140
v_add_f32 v162, v162, v141
v_add_f32 v162, v162, v142
v_add_f32 v162, v162, v143
v_cvt_pk_bf16_f32 v144, v128, v129
v_cvt_pk_bf16_f32 v145, v130, v131
v_cvt_pk_bf16_f32 v146, v132, v133
v_cvt_pk_bf16_f32 v147, v134, v135
v_cvt_pk_bf16_f32 v148, v136, v137
v_cvt_pk_bf16_f32 v149, v138, v139
v_cvt_pk_bf16_f32 v150, v140, v141
v_cvt_pk_bf16_f32 v151, v142, v143
s_nop 1
s_branch k12_kernel_bk_dB
k12_kernel_f2spind:
s_mov_b32 s101, 200000
k12_kernel_f2spd:
buffer_load_dword v39, v3, s[60:63], s36 offen sc1
s_waitcnt vmcnt(0)
v_cmp_gt_u32 vcc, 2, v39
s_and_b64 vcc, vcc, s[48:49]
s_cbranch_vccz k12_kernel_f2backd
s_sub_u32 s101, s101, 1
s_cmp_lg_u32 s101, 0
s_cbranch_scc1 k12_kernel_f2spd
s_branch k12_kernel_f2backd
k12_kernel_fb_s0:
v_max3_f32 v163, v80, v81, v82
v_max3_f32 v163, v163, v83, v84
v_max3_f32 v163, v163, v85, v86
v_max3_f32 v163, v163, v87, v88
v_max3_f32 v163, v163, v89, v90
v_max3_f32 v163, v163, v91, v92
v_max3_f32 v163, v163, v93, v94
v_max_f32 v163, v163, v95
v_mov_b32 v164, v163
s_cmp_lg_u32 s38, 0
s_cselect_b32 s35, 0xff800000, 0
v_permlane32_swap_b32 v163, v164
v_max_f32 v163, v163, v164
v_max_f32 v163, s35, v163
v_exp_f32 v164, -v163
s_nop 0
v_min_f32 v164, 1.0, v164
v_sub_f32 v80, v80, v163
v_sub_f32 v81, v81, v163
v_sub_f32 v82, v82, v163
v_sub_f32 v83, v83, v163
v_sub_f32 v84, v84, v163
v_sub_f32 v85, v85, v163
v_sub_f32 v86, v86, v163
v_sub_f32 v87, v87, v163
v_sub_f32 v88, v88, v163
v_sub_f32 v89, v89, v163
v_sub_f32 v90, v90, v163
v_sub_f32 v91, v91, v163
v_sub_f32 v92, v92, v163
v_sub_f32 v93, v93, v163
v_sub_f32 v94, v94, v163
v_sub_f32 v95, v95, v163
v_sub_f32 v112, v112, v163
v_sub_f32 v113, v113, v163
v_sub_f32 v114, v114, v163
v_sub_f32 v115, v115, v163
v_sub_f32 v116, v116, v163
v_sub_f32 v117, v117, v163
v_sub_f32 v118, v118, v163
v_sub_f32 v119, v119, v163
v_sub_f32 v120, v120, v163
v_sub_f32 v121, v121, v163
v_sub_f32 v122, v122, v163
v_sub_f32 v123, v123, v163
v_sub_f32 v124, v124, v163
v_sub_f32 v125, v125, v163
v_sub_f32 v126, v126, v163
v_sub_f32 v127, v127, v163
v_mul_f32 v161, v161, v164
v_sub_f32 v64, v64, v163
v_sub_f32 v65, v65, v163
v_sub_f32 v66, v66, v163
v_sub_f32 v67, v67, v163
v_sub_f32 v68, v68, v163
v_sub_f32 v69, v69, v163
v_sub_f32 v70, v70, v163
v_sub_f32 v71, v71, v163
v_sub_f32 v72, v72, v163
v_sub_f32 v73, v73, v163
v_sub_f32 v74, v74, v163
v_sub_f32 v75, v75, v163
v_sub_f32 v76, v76, v163
v_sub_f32 v77, v77, v163
v_sub_f32 v78, v78, v163
v_sub_f32 v79, v79, v163
v_accvgpr_read_b32 v24, a64
v_accvgpr_read_b32 v25, a65
v_accvgpr_read_b32 v26, a66
v_accvgpr_read_b32 v27, a67
v_mul_f32 v24, v24, v164
v_mul_f32 v25, v25, v164
v_mul_f32 v26, v26, v164
v_mul_f32 v27, v27, v164
v_accvgpr_write_b32 a64, v24
v_accvgpr_write_b32 a65, v25
v_accvgpr_write_b32 a66, v26
v_accvgpr_write_b32 a67, v27
v_accvgpr_read_b32 v24, a68
v_accvgpr_read_b32 v25, a69
v_accvgpr_read_b32 v26, a70
v_accvgpr_read_b32 v27, a71
v_mul_f32 v24, v24, v164
v_mul_f32 v25, v25, v164
v_mul_f32 v26, v26, v164
v_mul_f32 v27, v27, v164
v_accvgpr_write_b32 a68, v24
v_accvgpr_write_b32 a69, v25
v_accvgpr_write_b32 a70, v26
v_accvgpr_write_b32 a71, v27
v_accvgpr_read_b32 v24, a72
v_accvgpr_read_b32 v25, a73
v_accvgpr_read_b32 v26, a74
v_accvgpr_read_b32 v27, a75
v_mul_f32 v24, v24, v164
v_mul_f32 v25, v25, v164
v_mul_f32 v26, v26, v164
v_mul_f32 v27, v27, v164
v_accvgpr_write_b32 a72, v24
v_accvgpr_write_b32 a73, v25
v_accvgpr_write_b32 a74, v26
v_accvgpr_write_b32 a75, v27
v_accvgpr_read_b32 v24, a76
v_accvgpr_read_b32 v25, a77
v_accvgpr_read_b32 v26, a78
v_accvgpr_read_b32 v27, a79
v_mul_f32 v24, v24, v164
v_mul_f32 v25, v25, v164
v_mul_f32 v26, v26, v164
v_mul_f32 v27, v27, v164
v_accvgpr_write_b32 a76, v24
v_accvgpr_write_b32 a77, v25
v_accvgpr_write_b32 a78, v26
v_accvgpr_write_b32 a79, v27
v_accvgpr_read_b32 v24, a80
v_accvgpr_read_b32 v25, a81
v_accvgpr_read_b32 v26, a82
v_accvgpr_read_b32 v27, a83
v_mul_f32 v24, v24, v164
v_mul_f32 v25, v25, v164
v_mul_f32 v26, v26, v164
v_mul_f32 v27, v27, v164
v_accvgpr_write_b32 a80, v24
v_accvgpr_write_b32 a81, v25
v_accvgpr_write_b32 a82, v26
v_accvgpr_write_b32 a83, v27
v_accvgpr_read_b32 v24, a84
v_accvgpr_read_b32 v25, a85
v_accvgpr_read_b32 v26, a86
v_accvgpr_read_b32 v27, a87
v_mul_f32 v24, v24, v164
v_mul_f32 v25, v25, v164
v_mul_f32 v26, v26, v164
v_mul_f32 v27, v27, v164
v_accvgpr_write_b32 a84, v24
v_accvgpr_write_b32 a85, v25
v_accvgpr_write_b32 a86, v26
v_accvgpr_write_b32 a87, v27
v_accvgpr_read_b32 v24, a88
v_accvgpr_read_b32 v25, a89
v_accvgpr_read_b32 v26, a90
v_accvgpr_read_b32 v27, a91
v_mul_f32 v24, v24, v164
v_mul_f32 v25, v25, v164
v_mul_f32 v26, v26, v164
v_mul_f32 v27, v27, v164
v_accvgpr_write_b32 a88, v24
v_accvgpr_write_b32 a89, v25
v_accvgpr_write_b32 a90, v26
v_accvgpr_write_b32 a91, v27
v_accvgpr_read_b32 v24, a92
v_accvgpr_read_b32 v25, a93
v_accvgpr_read_b32 v26, a94
v_accvgpr_read_b32 v27, a95
v_mul_f32 v24, v24, v164
v_mul_f32 v25, v25, v164
v_mul_f32 v26, v26, v164
v_mul_f32 v27, v27, v164
v_accvgpr_write_b32 a92, v24
v_accvgpr_write_b32 a93, v25
v_accvgpr_write_b32 a94, v26
v_accvgpr_write_b32 a95, v27
v_accvgpr_read_b32 v24, a96
v_accvgpr_read_b32 v25, a97
v_accvgpr_read_b32 v26, a98
v_accvgpr_read_b32 v27, a99
v_mul_f32 v24, v24, v164
v_mul_f32 v25, v25, v164
v_mul_f32 v26, v26, v164
v_mul_f32 v27, v27, v164
v_accvgpr_write_b32 a96, v24
v_accvgpr_write_b32 a97, v25
v_accvgpr_write_b32 a98, v26
v_accvgpr_write_b32 a99, v27
v_accvgpr_read_b32 v24, a100
v_accvgpr_read_b32 v25, a101
v_accvgpr_read_b32 v26, a102
v_accvgpr_read_b32 v27, a103
v_mul_f32 v24, v24, v164
v_mul_f32 v25, v25, v164
v_mul_f32 v26, v26, v164
v_mul_f32 v27, v27, v164
v_accvgpr_write_b32 a100, v24
v_accvgpr_write_b32 a101, v25
v_accvgpr_write_b32 a102, v26
v_accvgpr_write_b32 a103, v27
v_accvgpr_read_b32 v24, a104
v_accvgpr_read_b32 v25, a105
v_accvgpr_read_b32 v26, a106
v_accvgpr_read_b32 v27, a107
v_mul_f32 v24, v24, v164
v_mul_f32 v25, v25, v164
v_mul_f32 v26, v26, v164
v_mul_f32 v27, v27, v164
v_accvgpr_write_b32 a104, v24
v_accvgpr_write_b32 a105, v25
v_accvgpr_write_b32 a106, v26
v_accvgpr_write_b32 a107, v27
v_accvgpr_read_b32 v24, a108
v_accvgpr_read_b32 v25, a109
v_accvgpr_read_b32 v26, a110
v_accvgpr_read_b32 v27, a111
v_mul_f32 v24, v24, v164
v_mul_f32 v25, v25, v164
v_mul_f32 v26, v26, v164
v_mul_f32 v27, v27, v164
v_accvgpr_write_b32 a108, v24
v_accvgpr_write_b32 a109, v25
v_accvgpr_write_b32 a110, v26
v_accvgpr_write_b32 a111, v27
v_accvgpr_read_b32 v24, a112
v_accvgpr_read_b32 v25, a113
v_accvgpr_read_b32 v26, a114
v_accvgpr_read_b32 v27, a115
v_mul_f32 v24, v24, v164
v_mul_f32 v25, v25, v164
v_mul_f32 v26, v26, v164
v_mul_f32 v27, v27, v164
v_accvgpr_write_b32 a112, v24
v_accvgpr_write_b32 a113, v25
v_accvgpr_write_b32 a114, v26
v_accvgpr_write_b32 a115, v27
v_accvgpr_read_b32 v24, a116
v_accvgpr_read_b32 v25, a117
v_accvgpr_read_b32 v26, a118
v_accvgpr_read_b32 v27, a119
v_mul_f32 v24, v24, v164
v_mul_f32 v25, v25, v164
v_mul_f32 v26, v26, v164
v_mul_f32 v27, v27, v164
v_accvgpr_write_b32 a116, v24
v_accvgpr_write_b32 a117, v25
v_accvgpr_write_b32 a118, v26
v_accvgpr_write_b32 a119, v27
v_accvgpr_read_b32 v24, a120
v_accvgpr_read_b32 v25, a121
v_accvgpr_read_b32 v26, a122
v_accvgpr_read_b32 v27, a123
v_mul_f32 v24, v24, v164
v_mul_f32 v25, v25, v164
v_mul_f32 v26, v26, v164
v_mul_f32 v27, v27, v164
v_accvgpr_write_b32 a120, v24
v_accvgpr_write_b32 a121, v25
v_accvgpr_write_b32 a122, v26
v_accvgpr_write_b32 a123, v27
v_accvgpr_read_b32 v24, a124
v_accvgpr_read_b32 v25, a125
v_accvgpr_read_b32 v26, a126
v_accvgpr_read_b32 v27, a127
v_mul_f32 v24, v24, v164
v_mul_f32 v25, v25, v164
v_mul_f32 v26, v26, v164
v_mul_f32 v27, v27, v164
v_accvgpr_write_b32 a124, v24
v_accvgpr_write_b32 a125, v25
v_accvgpr_write_b32 a126, v26
v_accvgpr_write_b32 a127, v27
v_exp_f32 v128, v80
v_exp_f32 v129, v81
v_exp_f32 v130, v82
v_exp_f32 v131, v83
v_exp_f32 v132, v84
v_exp_f32 v133, v85
v_exp_f32 v134, v86
v_exp_f32 v135, v87
v_exp_f32 v136, v88
v_exp_f32 v137, v89
v_exp_f32 v138, v90
v_exp_f32 v139, v91
v_exp_f32 v140, v92
v_exp_f32 v141, v93
v_exp_f32 v142, v94
v_exp_f32 v143, v95
s_nop 0
v_add_f32 v162, v128, v129
v_add_f32 v162, v162, v130
v_add_f32 v162, v162, v131
v_add_f32 v162, v162, v132
v_add_f32 v162, v162, v133
v_add_f32 v162, v162, v134
v_add_f32 v162, v162, v135
v_add_f32 v162, v162, v136
v_add_f32 v162, v162, v137
v_add_f32 v162, v162, v138
v_add_f32 v162, v162, v139
v_add_f32 v162, v162, v140
v_add_f32 v162, v162, v141
v_add_f32 v162, v162, v142
v_add_f32 v162, v162, v143
v_cvt_pk_bf16_f32 v152, v128, v129
v_cvt_pk_bf16_f32 v153, v130, v131
v_cvt_pk_bf16_f32 v154, v132, v133
v_cvt_pk_bf16_f32 v155, v134, v135
v_cvt_pk_bf16_f32 v156, v136, v137
v_cvt_pk_bf16_f32 v157, v138, v139
v_cvt_pk_bf16_f32 v158, v140, v141
v_cvt_pk_bf16_f32 v159, v142, v143
s_nop 1
s_branch k12_kernel_bk_s0
k12_kernel_fb_s1:
v_max3_f32 v163, v64, v65, v66
v_max3_f32 v163, v163, v67, v68
v_max3_f32 v163, v163, v69, v70
v_max3_f32 v163, v163, v71, v72
v_max3_f32 v163, v163, v73, v74
v_max3_f32 v163, v163, v75, v76
v_max3_f32 v163, v163, v77, v78
v_max_f32 v163, v163, v79
v_mov_b32 v164, v163
s_cmp_lg_u32 s38, 0
s_cselect_b32 s35, 0xff800000, 0
v_permlane32_swap_b32 v163, v164
v_max_f32 v163, v163, v164
v_max_f32 v163, s35, v163
v_exp_f32 v164, -v163
s_nop 0
v_min_f32 v164, 1.0, v164
v_sub_f32 v64, v64, v163
v_sub_f32 v65, v65, v163
v_sub_f32 v66, v66, v163
v_sub_f32 v67, v67, v163
v_sub_f32 v68, v68, v163
v_sub_f32 v69, v69, v163
v_sub_f32 v70, v70, v163
v_sub_f32 v71, v71, v163
v_sub_f32 v72, v72, v163
v_sub_f32 v73, v73, v163
v_sub_f32 v74, v74, v163
v_sub_f32 v75, v75, v163
v_sub_f32 v76, v76, v163
v_sub_f32 v77, v77, v163
v_sub_f32 v78, v78, v163
v_sub_f32 v79, v79, v163
v_sub_f32 v112, v112, v163
v_sub_f32 v113, v113, v163
v_sub_f32 v114, v114, v163
v_sub_f32 v115, v115, v163
v_sub_f32 v116, v116, v163
v_sub_f32 v117, v117, v163
v_sub_f32 v118, v118, v163
v_sub_f32 v119, v119, v163
v_sub_f32 v120, v120, v163
v_sub_f32 v121, v121, v163
v_sub_f32 v122, v122, v163
v_sub_f32 v123, v123, v163
v_sub_f32 v124, v124, v163
v_sub_f32 v125, v125, v163
v_sub_f32 v126, v126, v163
v_sub_f32 v127, v127, v163
v_mul_f32 v161, v161, v164
v_sub_f32 v80, v80, v163
v_sub_f32 v81, v81, v163
v_sub_f32 v82, v82, v163
v_sub_f32 v83, v83, v163
v_sub_f32 v84, v84, v163
v_sub_f32 v85, v85, v163
v_sub_f32 v86, v86, v163
v_sub_f32 v87, v87, v163
v_sub_f32 v88, v88, v163
v_sub_f32 v89, v89, v163
v_sub_f32 v90, v90, v163
v_sub_f32 v91, v91, v163
v_sub_f32 v92, v92, v163
v_sub_f32 v93, v93, v163
v_sub_f32 v94, v94, v163
v_sub_f32 v95, v95, v163
v_accvgpr_read_b32 v24, a64
v_accvgpr_read_b32 v25, a65
v_accvgpr_read_b32 v26, a66
v_accvgpr_read_b32 v27, a67
v_mul_f32 v24, v24, v164
v_mul_f32 v25, v25, v164
v_mul_f32 v26, v26, v164
v_mul_f32 v27, v27, v164
v_accvgpr_write_b32 a64, v24
v_accvgpr_write_b32 a65, v25
v_accvgpr_write_b32 a66, v26
v_accvgpr_write_b32 a67, v27
v_accvgpr_read_b32 v24, a68
v_accvgpr_read_b32 v25, a69
v_accvgpr_read_b32 v26, a70
v_accvgpr_read_b32 v27, a71
v_mul_f32 v24, v24, v164
v_mul_f32 v25, v25, v164
v_mul_f32 v26, v26, v164
v_mul_f32 v27, v27, v164
v_accvgpr_write_b32 a68, v24
v_accvgpr_write_b32 a69, v25
v_accvgpr_write_b32 a70, v26
v_accvgpr_write_b32 a71, v27
v_accvgpr_read_b32 v24, a72
v_accvgpr_read_b32 v25, a73
v_accvgpr_read_b32 v26, a74
v_accvgpr_read_b32 v27, a75
v_mul_f32 v24, v24, v164
v_mul_f32 v25, v25, v164
v_mul_f32 v26, v26, v164
v_mul_f32 v27, v27, v164
v_accvgpr_write_b32 a72, v24
v_accvgpr_write_b32 a73, v25
v_accvgpr_write_b32 a74, v26
v_accvgpr_write_b32 a75, v27
v_accvgpr_read_b32 v24, a76
v_accvgpr_read_b32 v25, a77
v_accvgpr_read_b32 v26, a78
v_accvgpr_read_b32 v27, a79
v_mul_f32 v24, v24, v164
v_mul_f32 v25, v25, v164
v_mul_f32 v26, v26, v164
v_mul_f32 v27, v27, v164
v_accvgpr_write_b32 a76, v24
v_accvgpr_write_b32 a77, v25
v_accvgpr_write_b32 a78, v26
v_accvgpr_write_b32 a79, v27
v_accvgpr_read_b32 v24, a80
v_accvgpr_read_b32 v25, a81
v_accvgpr_read_b32 v26, a82
v_accvgpr_read_b32 v27, a83
v_mul_f32 v24, v24, v164
v_mul_f32 v25, v25, v164
v_mul_f32 v26, v26, v164
v_mul_f32 v27, v27, v164
v_accvgpr_write_b32 a80, v24
v_accvgpr_write_b32 a81, v25
v_accvgpr_write_b32 a82, v26
v_accvgpr_write_b32 a83, v27
v_accvgpr_read_b32 v24, a84
v_accvgpr_read_b32 v25, a85
v_accvgpr_read_b32 v26, a86
v_accvgpr_read_b32 v27, a87
v_mul_f32 v24, v24, v164
v_mul_f32 v25, v25, v164
v_mul_f32 v26, v26, v164
v_mul_f32 v27, v27, v164
v_accvgpr_write_b32 a84, v24
v_accvgpr_write_b32 a85, v25
v_accvgpr_write_b32 a86, v26
v_accvgpr_write_b32 a87, v27
v_accvgpr_read_b32 v24, a88
v_accvgpr_read_b32 v25, a89
v_accvgpr_read_b32 v26, a90
v_accvgpr_read_b32 v27, a91
v_mul_f32 v24, v24, v164
v_mul_f32 v25, v25, v164
v_mul_f32 v26, v26, v164
v_mul_f32 v27, v27, v164
v_accvgpr_write_b32 a88, v24
v_accvgpr_write_b32 a89, v25
v_accvgpr_write_b32 a90, v26
v_accvgpr_write_b32 a91, v27
v_accvgpr_read_b32 v24, a92
v_accvgpr_read_b32 v25, a93
v_accvgpr_read_b32 v26, a94
v_accvgpr_read_b32 v27, a95
v_mul_f32 v24, v24, v164
v_mul_f32 v25, v25, v164
v_mul_f32 v26, v26, v164
v_mul_f32 v27, v27, v164
v_accvgpr_write_b32 a92, v24
v_accvgpr_write_b32 a93, v25
v_accvgpr_write_b32 a94, v26
v_accvgpr_write_b32 a95, v27
v_accvgpr_read_b32 v24, a96
v_accvgpr_read_b32 v25, a97
v_accvgpr_read_b32 v26, a98
v_accvgpr_read_b32 v27, a99
v_mul_f32 v24, v24, v164
v_mul_f32 v25, v25, v164
v_mul_f32 v26, v26, v164
v_mul_f32 v27, v27, v164
v_accvgpr_write_b32 a96, v24
v_accvgpr_write_b32 a97, v25
v_accvgpr_write_b32 a98, v26
v_accvgpr_write_b32 a99, v27
v_accvgpr_read_b32 v24, a100
v_accvgpr_read_b32 v25, a101
v_accvgpr_read_b32 v26, a102
v_accvgpr_read_b32 v27, a103
v_mul_f32 v24, v24, v164
v_mul_f32 v25, v25, v164
v_mul_f32 v26, v26, v164
v_mul_f32 v27, v27, v164
v_accvgpr_write_b32 a100, v24
v_accvgpr_write_b32 a101, v25
v_accvgpr_write_b32 a102, v26
v_accvgpr_write_b32 a103, v27
v_accvgpr_read_b32 v24, a104
v_accvgpr_read_b32 v25, a105
v_accvgpr_read_b32 v26, a106
v_accvgpr_read_b32 v27, a107
v_mul_f32 v24, v24, v164
v_mul_f32 v25, v25, v164
v_mul_f32 v26, v26, v164
v_mul_f32 v27, v27, v164
v_accvgpr_write_b32 a104, v24
v_accvgpr_write_b32 a105, v25
v_accvgpr_write_b32 a106, v26
v_accvgpr_write_b32 a107, v27
v_accvgpr_read_b32 v24, a108
v_accvgpr_read_b32 v25, a109
v_accvgpr_read_b32 v26, a110
v_accvgpr_read_b32 v27, a111
v_mul_f32 v24, v24, v164
v_mul_f32 v25, v25, v164
v_mul_f32 v26, v26, v164
v_mul_f32 v27, v27, v164
v_accvgpr_write_b32 a108, v24
v_accvgpr_write_b32 a109, v25
v_accvgpr_write_b32 a110, v26
v_accvgpr_write_b32 a111, v27
v_accvgpr_read_b32 v24, a112
v_accvgpr_read_b32 v25, a113
v_accvgpr_read_b32 v26, a114
v_accvgpr_read_b32 v27, a115
v_mul_f32 v24, v24, v164
v_mul_f32 v25, v25, v164
v_mul_f32 v26, v26, v164
v_mul_f32 v27, v27, v164
v_accvgpr_write_b32 a112, v24
v_accvgpr_write_b32 a113, v25
v_accvgpr_write_b32 a114, v26
v_accvgpr_write_b32 a115, v27
v_accvgpr_read_b32 v24, a116
v_accvgpr_read_b32 v25, a117
v_accvgpr_read_b32 v26, a118
v_accvgpr_read_b32 v27, a119
v_mul_f32 v24, v24, v164
v_mul_f32 v25, v25, v164
v_mul_f32 v26, v26, v164
v_mul_f32 v27, v27, v164
v_accvgpr_write_b32 a116, v24
v_accvgpr_write_b32 a117, v25
v_accvgpr_write_b32 a118, v26
v_accvgpr_write_b32 a119, v27
v_accvgpr_read_b32 v24, a120
v_accvgpr_read_b32 v25, a121
v_accvgpr_read_b32 v26, a122
v_accvgpr_read_b32 v27, a123
v_mul_f32 v24, v24, v164
v_mul_f32 v25, v25, v164
v_mul_f32 v26, v26, v164
v_mul_f32 v27, v27, v164
v_accvgpr_write_b32 a120, v24
v_accvgpr_write_b32 a121, v25
v_accvgpr_write_b32 a122, v26
v_accvgpr_write_b32 a123, v27
v_accvgpr_read_b32 v24, a124
v_accvgpr_read_b32 v25, a125
v_accvgpr_read_b32 v26, a126
v_accvgpr_read_b32 v27, a127
v_mul_f32 v24, v24, v164
v_mul_f32 v25, v25, v164
v_mul_f32 v26, v26, v164
v_mul_f32 v27, v27, v164
v_accvgpr_write_b32 a124, v24
v_accvgpr_write_b32 a125, v25
v_accvgpr_write_b32 a126, v26
v_accvgpr_write_b32 a127, v27
v_exp_f32 v128, v64
v_exp_f32 v129, v65
v_exp_f32 v130, v66
v_exp_f32 v131, v67
v_exp_f32 v132, v68
v_exp_f32 v133, v69
v_exp_f32 v134, v70
v_exp_f32 v135, v71
v_exp_f32 v136, v72
v_exp_f32 v137, v73
v_exp_f32 v138, v74
v_exp_f32 v139, v75
v_exp_f32 v140, v76
v_exp_f32 v141, v77
v_exp_f32 v142, v78
v_exp_f32 v143, v79
s_nop 0
v_add_f32 v162, v128, v129
v_add_f32 v162, v162, v130
v_add_f32 v162, v162, v131
v_add_f32 v162, v162, v132
v_add_f32 v162, v162, v133
v_add_f32 v162, v162, v134
v_add_f32 v162, v162, v135
v_add_f32 v162, v162, v136
v_add_f32 v162, v162, v137
v_add_f32 v162, v162, v138
v_add_f32 v162, v162, v139
v_add_f32 v162, v162, v140
v_add_f32 v162, v162, v141
v_add_f32 v162, v162, v142
v_add_f32 v162, v162, v143
v_cvt_pk_bf16_f32 v144, v128, v129
v_cvt_pk_bf16_f32 v145, v130, v131
v_cvt_pk_bf16_f32 v146, v132, v133
v_cvt_pk_bf16_f32 v147, v134, v135
v_cvt_pk_bf16_f32 v148, v136, v137
v_cvt_pk_bf16_f32 v149, v138, v139
v_cvt_pk_bf16_f32 v150, v140, v141
v_cvt_pk_bf16_f32 v151, v142, v143
s_nop 1
s_branch k12_kernel_bk_s1
k12_kernel_fb_o0:
v_max3_f32 v163, v80, v81, v82
v_max3_f32 v163, v163, v83, v84
v_max3_f32 v163, v163, v85, v86
v_max3_f32 v163, v163, v87, v88
v_max3_f32 v163, v163, v89, v90
v_max3_f32 v163, v163, v91, v92
v_max3_f32 v163, v163, v93, v94
v_max_f32 v163, v163, v95
v_mov_b32 v164, v163
s_cmp_lg_u32 s38, 0
s_cselect_b32 s35, 0xff800000, 0
v_permlane32_swap_b32 v163, v164
v_max_f32 v163, v163, v164
v_max_f32 v163, s35, v163
v_exp_f32 v164, -v163
s_nop 0
v_min_f32 v164, 1.0, v164
v_sub_f32 v80, v80, v163
v_sub_f32 v81, v81, v163
v_sub_f32 v82, v82, v163
v_sub_f32 v83, v83, v163
v_sub_f32 v84, v84, v163
v_sub_f32 v85, v85, v163
v_sub_f32 v86, v86, v163
v_sub_f32 v87, v87, v163
v_sub_f32 v88, v88, v163
v_sub_f32 v89, v89, v163
v_sub_f32 v90, v90, v163
v_sub_f32 v91, v91, v163
v_sub_f32 v92, v92, v163
v_sub_f32 v93, v93, v163
v_sub_f32 v94, v94, v163
v_sub_f32 v95, v95, v163
v_sub_f32 v112, v112, v163
v_sub_f32 v113, v113, v163
v_sub_f32 v114, v114, v163
v_sub_f32 v115, v115, v163
v_sub_f32 v116, v116, v163
v_sub_f32 v117, v117, v163
v_sub_f32 v118, v118, v163
v_sub_f32 v119, v119, v163
v_sub_f32 v120, v120, v163
v_sub_f32 v121, v121, v163
v_sub_f32 v122, v122, v163
v_sub_f32 v123, v123, v163
v_sub_f32 v124, v124, v163
v_sub_f32 v125, v125, v163
v_sub_f32 v126, v126, v163
v_sub_f32 v127, v127, v163
v_mul_f32 v161, v161, v164
v_sub_f32 v64, v64, v163
v_sub_f32 v65, v65, v163
v_sub_f32 v66, v66, v163
v_sub_f32 v67, v67, v163
v_sub_f32 v68, v68, v163
v_sub_f32 v69, v69, v163
v_sub_f32 v70, v70, v163
v_sub_f32 v71, v71, v163
v_sub_f32 v72, v72, v163
v_sub_f32 v73, v73, v163
v_sub_f32 v74, v74, v163
v_sub_f32 v75, v75, v163
v_sub_f32 v76, v76, v163
v_sub_f32 v77, v77, v163
v_sub_f32 v78, v78, v163
v_sub_f32 v79, v79, v163
v_accvgpr_read_b32 v24, a64
v_accvgpr_read_b32 v25, a65
v_accvgpr_read_b32 v26, a66
v_accvgpr_read_b32 v27, a67
v_mul_f32 v24, v24, v164
v_mul_f32 v25, v25, v164
v_mul_f32 v26, v26, v164
v_mul_f32 v27, v27, v164
v_accvgpr_write_b32 a64, v24
v_accvgpr_write_b32 a65, v25
v_accvgpr_write_b32 a66, v26
v_accvgpr_write_b32 a67, v27
v_accvgpr_read_b32 v24, a68
v_accvgpr_read_b32 v25, a69
v_accvgpr_read_b32 v26, a70
v_accvgpr_read_b32 v27, a71
v_mul_f32 v24, v24, v164
v_mul_f32 v25, v25, v164
v_mul_f32 v26, v26, v164
v_mul_f32 v27, v27, v164
v_accvgpr_write_b32 a68, v24
v_accvgpr_write_b32 a69, v25
v_accvgpr_write_b32 a70, v26
v_accvgpr_write_b32 a71, v27
v_accvgpr_read_b32 v24, a72
v_accvgpr_read_b32 v25, a73
v_accvgpr_read_b32 v26, a74
v_accvgpr_read_b32 v27, a75
v_mul_f32 v24, v24, v164
v_mul_f32 v25, v25, v164
v_mul_f32 v26, v26, v164
v_mul_f32 v27, v27, v164
v_accvgpr_write_b32 a72, v24
v_accvgpr_write_b32 a73, v25
v_accvgpr_write_b32 a74, v26
v_accvgpr_write_b32 a75, v27
v_accvgpr_read_b32 v24, a76
v_accvgpr_read_b32 v25, a77
v_accvgpr_read_b32 v26, a78
v_accvgpr_read_b32 v27, a79
v_mul_f32 v24, v24, v164
v_mul_f32 v25, v25, v164
v_mul_f32 v26, v26, v164
v_mul_f32 v27, v27, v164
v_accvgpr_write_b32 a76, v24
v_accvgpr_write_b32 a77, v25
v_accvgpr_write_b32 a78, v26
v_accvgpr_write_b32 a79, v27
v_accvgpr_read_b32 v24, a80
v_accvgpr_read_b32 v25, a81
v_accvgpr_read_b32 v26, a82
v_accvgpr_read_b32 v27, a83
v_mul_f32 v24, v24, v164
v_mul_f32 v25, v25, v164
v_mul_f32 v26, v26, v164
v_mul_f32 v27, v27, v164
v_accvgpr_write_b32 a80, v24
v_accvgpr_write_b32 a81, v25
v_accvgpr_write_b32 a82, v26
v_accvgpr_write_b32 a83, v27
v_accvgpr_read_b32 v24, a84
v_accvgpr_read_b32 v25, a85
v_accvgpr_read_b32 v26, a86
v_accvgpr_read_b32 v27, a87
v_mul_f32 v24, v24, v164
v_mul_f32 v25, v25, v164
v_mul_f32 v26, v26, v164
v_mul_f32 v27, v27, v164
v_accvgpr_write_b32 a84, v24
v_accvgpr_write_b32 a85, v25
v_accvgpr_write_b32 a86, v26
v_accvgpr_write_b32 a87, v27
v_accvgpr_read_b32 v24, a88
v_accvgpr_read_b32 v25, a89
v_accvgpr_read_b32 v26, a90
v_accvgpr_read_b32 v27, a91
v_mul_f32 v24, v24, v164
v_mul_f32 v25, v25, v164
v_mul_f32 v26, v26, v164
v_mul_f32 v27, v27, v164
v_accvgpr_write_b32 a88, v24
v_accvgpr_write_b32 a89, v25
v_accvgpr_write_b32 a90, v26
v_accvgpr_write_b32 a91, v27
v_accvgpr_read_b32 v24, a92
v_accvgpr_read_b32 v25, a93
v_accvgpr_read_b32 v26, a94
v_accvgpr_read_b32 v27, a95
v_mul_f32 v24, v24, v164
v_mul_f32 v25, v25, v164
v_mul_f32 v26, v26, v164
v_mul_f32 v27, v27, v164
v_accvgpr_write_b32 a92, v24
v_accvgpr_write_b32 a93, v25
v_accvgpr_write_b32 a94, v26
v_accvgpr_write_b32 a95, v27
v_accvgpr_read_b32 v24, a96
v_accvgpr_read_b32 v25, a97
v_accvgpr_read_b32 v26, a98
v_accvgpr_read_b32 v27, a99
v_mul_f32 v24, v24, v164
v_mul_f32 v25, v25, v164
v_mul_f32 v26, v26, v164
v_mul_f32 v27, v27, v164
v_accvgpr_write_b32 a96, v24
v_accvgpr_write_b32 a97, v25
v_accvgpr_write_b32 a98, v26
v_accvgpr_write_b32 a99, v27
v_accvgpr_read_b32 v24, a100
v_accvgpr_read_b32 v25, a101
v_accvgpr_read_b32 v26, a102
v_accvgpr_read_b32 v27, a103
v_mul_f32 v24, v24, v164
v_mul_f32 v25, v25, v164
v_mul_f32 v26, v26, v164
v_mul_f32 v27, v27, v164
v_accvgpr_write_b32 a100, v24
v_accvgpr_write_b32 a101, v25
v_accvgpr_write_b32 a102, v26
v_accvgpr_write_b32 a103, v27
v_accvgpr_read_b32 v24, a104
v_accvgpr_read_b32 v25, a105
v_accvgpr_read_b32 v26, a106
v_accvgpr_read_b32 v27, a107
v_mul_f32 v24, v24, v164
v_mul_f32 v25, v25, v164
v_mul_f32 v26, v26, v164
v_mul_f32 v27, v27, v164
v_accvgpr_write_b32 a104, v24
v_accvgpr_write_b32 a105, v25
v_accvgpr_write_b32 a106, v26
v_accvgpr_write_b32 a107, v27
v_accvgpr_read_b32 v24, a108
v_accvgpr_read_b32 v25, a109
v_accvgpr_read_b32 v26, a110
v_accvgpr_read_b32 v27, a111
v_mul_f32 v24, v24, v164
v_mul_f32 v25, v25, v164
v_mul_f32 v26, v26, v164
v_mul_f32 v27, v27, v164
v_accvgpr_write_b32 a108, v24
v_accvgpr_write_b32 a109, v25
v_accvgpr_write_b32 a110, v26
v_accvgpr_write_b32 a111, v27
v_accvgpr_read_b32 v24, a112
v_accvgpr_read_b32 v25, a113
v_accvgpr_read_b32 v26, a114
v_accvgpr_read_b32 v27, a115
v_mul_f32 v24, v24, v164
v_mul_f32 v25, v25, v164
v_mul_f32 v26, v26, v164
v_mul_f32 v27, v27, v164
v_accvgpr_write_b32 a112, v24
v_accvgpr_write_b32 a113, v25
v_accvgpr_write_b32 a114, v26
v_accvgpr_write_b32 a115, v27
v_accvgpr_read_b32 v24, a116
v_accvgpr_read_b32 v25, a117
v_accvgpr_read_b32 v26, a118
v_accvgpr_read_b32 v27, a119
v_mul_f32 v24, v24, v164
v_mul_f32 v25, v25, v164
v_mul_f32 v26, v26, v164
v_mul_f32 v27, v27, v164
v_accvgpr_write_b32 a116, v24
v_accvgpr_write_b32 a117, v25
v_accvgpr_write_b32 a118, v26
v_accvgpr_write_b32 a119, v27
v_accvgpr_read_b32 v24, a120
v_accvgpr_read_b32 v25, a121
v_accvgpr_read_b32 v26, a122
v_accvgpr_read_b32 v27, a123
v_mul_f32 v24, v24, v164
v_mul_f32 v25, v25, v164
v_mul_f32 v26, v26, v164
v_mul_f32 v27, v27, v164
v_accvgpr_write_b32 a120, v24
v_accvgpr_write_b32 a121, v25
v_accvgpr_write_b32 a122, v26
v_accvgpr_write_b32 a123, v27
v_accvgpr_read_b32 v24, a124
v_accvgpr_read_b32 v25, a125
v_accvgpr_read_b32 v26, a126
v_accvgpr_read_b32 v27, a127
v_mul_f32 v24, v24, v164
v_mul_f32 v25, v25, v164
v_mul_f32 v26, v26, v164
v_mul_f32 v27, v27, v164
v_accvgpr_write_b32 a124, v24
v_accvgpr_write_b32 a125, v25
v_accvgpr_write_b32 a126, v26
v_accvgpr_write_b32 a127, v27
v_exp_f32 v128, v80
v_exp_f32 v129, v81
v_exp_f32 v130, v82
v_exp_f32 v131, v83
v_exp_f32 v132, v84
v_exp_f32 v133, v85
v_exp_f32 v134, v86
v_exp_f32 v135, v87
v_exp_f32 v136, v88
v_exp_f32 v137, v89
v_exp_f32 v138, v90
v_exp_f32 v139, v91
v_exp_f32 v140, v92
v_exp_f32 v141, v93
v_exp_f32 v142, v94
v_exp_f32 v143, v95
s_nop 0
v_add_f32 v162, v128, v129
v_add_f32 v162, v162, v130
v_add_f32 v162, v162, v131
v_add_f32 v162, v162, v132
v_add_f32 v162, v162, v133
v_add_f32 v162, v162, v134
v_add_f32 v162, v162, v135
v_add_f32 v162, v162, v136
v_add_f32 v162, v162, v137
v_add_f32 v162, v162, v138
v_add_f32 v162, v162, v139
v_add_f32 v162, v162, v140
v_add_f32 v162, v162, v141
v_add_f32 v162, v162, v142
v_add_f32 v162, v162, v143
v_cvt_pk_bf16_f32 v152, v128, v129
v_cvt_pk_bf16_f32 v153, v130, v131
v_cvt_pk_bf16_f32 v154, v132, v133
v_cvt_pk_bf16_f32 v155, v134, v135
v_cvt_pk_bf16_f32 v156, v136, v137
v_cvt_pk_bf16_f32 v157, v138, v139
v_cvt_pk_bf16_f32 v158, v140, v141
v_cvt_pk_bf16_f32 v159, v142, v143
s_nop 1
s_branch k12_kernel_bk_o0
k12_kernel_fb_o1:
v_max3_f32 v163, v64, v65, v66
v_max3_f32 v163, v163, v67, v68
v_max3_f32 v163, v163, v69, v70
v_max3_f32 v163, v163, v71, v72
v_max3_f32 v163, v163, v73, v74
v_max3_f32 v163, v163, v75, v76
v_max3_f32 v163, v163, v77, v78
v_max_f32 v163, v163, v79
v_mov_b32 v164, v163
s_cmp_lg_u32 s38, 0
s_cselect_b32 s35, 0xff800000, 0
v_permlane32_swap_b32 v163, v164
v_max_f32 v163, v163, v164
v_max_f32 v163, s35, v163
v_exp_f32 v164, -v163
s_nop 0
v_min_f32 v164, 1.0, v164
v_sub_f32 v64, v64, v163
v_sub_f32 v65, v65, v163
v_sub_f32 v66, v66, v163
v_sub_f32 v67, v67, v163
v_sub_f32 v68, v68, v163
v_sub_f32 v69, v69, v163
v_sub_f32 v70, v70, v163
v_sub_f32 v71, v71, v163
v_sub_f32 v72, v72, v163
v_sub_f32 v73, v73, v163
v_sub_f32 v74, v74, v163
v_sub_f32 v75, v75, v163
v_sub_f32 v76, v76, v163
v_sub_f32 v77, v77, v163
v_sub_f32 v78, v78, v163
v_sub_f32 v79, v79, v163
v_sub_f32 v112, v112, v163
v_sub_f32 v113, v113, v163
v_sub_f32 v114, v114, v163
v_sub_f32 v115, v115, v163
v_sub_f32 v116, v116, v163
v_sub_f32 v117, v117, v163
v_sub_f32 v118, v118, v163
v_sub_f32 v119, v119, v163
v_sub_f32 v120, v120, v163
v_sub_f32 v121, v121, v163
v_sub_f32 v122, v122, v163
v_sub_f32 v123, v123, v163
v_sub_f32 v124, v124, v163
v_sub_f32 v125, v125, v163
v_sub_f32 v126, v126, v163
v_sub_f32 v127, v127, v163
v_mul_f32 v161, v161, v164
v_sub_f32 v80, v80, v163
v_sub_f32 v81, v81, v163
v_sub_f32 v82, v82, v163
v_sub_f32 v83, v83, v163
v_sub_f32 v84, v84, v163
v_sub_f32 v85, v85, v163
v_sub_f32 v86, v86, v163
v_sub_f32 v87, v87, v163
v_sub_f32 v88, v88, v163
v_sub_f32 v89, v89, v163
v_sub_f32 v90, v90, v163
v_sub_f32 v91, v91, v163
v_sub_f32 v92, v92, v163
v_sub_f32 v93, v93, v163
v_sub_f32 v94, v94, v163
v_sub_f32 v95, v95, v163
v_accvgpr_read_b32 v24, a64
v_accvgpr_read_b32 v25, a65
v_accvgpr_read_b32 v26, a66
v_accvgpr_read_b32 v27, a67
v_mul_f32 v24, v24, v164
v_mul_f32 v25, v25, v164
v_mul_f32 v26, v26, v164
v_mul_f32 v27, v27, v164
v_accvgpr_write_b32 a64, v24
v_accvgpr_write_b32 a65, v25
v_accvgpr_write_b32 a66, v26
v_accvgpr_write_b32 a67, v27
v_accvgpr_read_b32 v24, a68
v_accvgpr_read_b32 v25, a69
v_accvgpr_read_b32 v26, a70
v_accvgpr_read_b32 v27, a71
v_mul_f32 v24, v24, v164
v_mul_f32 v25, v25, v164
v_mul_f32 v26, v26, v164
v_mul_f32 v27, v27, v164
v_accvgpr_write_b32 a68, v24
v_accvgpr_write_b32 a69, v25
v_accvgpr_write_b32 a70, v26
v_accvgpr_write_b32 a71, v27
v_accvgpr_read_b32 v24, a72
v_accvgpr_read_b32 v25, a73
v_accvgpr_read_b32 v26, a74
v_accvgpr_read_b32 v27, a75
v_mul_f32 v24, v24, v164
v_mul_f32 v25, v25, v164
v_mul_f32 v26, v26, v164
v_mul_f32 v27, v27, v164
v_accvgpr_write_b32 a72, v24
v_accvgpr_write_b32 a73, v25
v_accvgpr_write_b32 a74, v26
v_accvgpr_write_b32 a75, v27
v_accvgpr_read_b32 v24, a76
v_accvgpr_read_b32 v25, a77
v_accvgpr_read_b32 v26, a78
v_accvgpr_read_b32 v27, a79
v_mul_f32 v24, v24, v164
v_mul_f32 v25, v25, v164
v_mul_f32 v26, v26, v164
v_mul_f32 v27, v27, v164
v_accvgpr_write_b32 a76, v24
v_accvgpr_write_b32 a77, v25
v_accvgpr_write_b32 a78, v26
v_accvgpr_write_b32 a79, v27
v_accvgpr_read_b32 v24, a80
v_accvgpr_read_b32 v25, a81
v_accvgpr_read_b32 v26, a82
v_accvgpr_read_b32 v27, a83
v_mul_f32 v24, v24, v164
v_mul_f32 v25, v25, v164
v_mul_f32 v26, v26, v164
v_mul_f32 v27, v27, v164
v_accvgpr_write_b32 a80, v24
v_accvgpr_write_b32 a81, v25
v_accvgpr_write_b32 a82, v26
v_accvgpr_write_b32 a83, v27
v_accvgpr_read_b32 v24, a84
v_accvgpr_read_b32 v25, a85
v_accvgpr_read_b32 v26, a86
v_accvgpr_read_b32 v27, a87
v_mul_f32 v24, v24, v164
v_mul_f32 v25, v25, v164
v_mul_f32 v26, v26, v164
v_mul_f32 v27, v27, v164
v_accvgpr_write_b32 a84, v24
v_accvgpr_write_b32 a85, v25
v_accvgpr_write_b32 a86, v26
v_accvgpr_write_b32 a87, v27
v_accvgpr_read_b32 v24, a88
v_accvgpr_read_b32 v25, a89
v_accvgpr_read_b32 v26, a90
v_accvgpr_read_b32 v27, a91
v_mul_f32 v24, v24, v164
v_mul_f32 v25, v25, v164
v_mul_f32 v26, v26, v164
v_mul_f32 v27, v27, v164
v_accvgpr_write_b32 a88, v24
v_accvgpr_write_b32 a89, v25
v_accvgpr_write_b32 a90, v26
v_accvgpr_write_b32 a91, v27
v_accvgpr_read_b32 v24, a92
v_accvgpr_read_b32 v25, a93
v_accvgpr_read_b32 v26, a94
v_accvgpr_read_b32 v27, a95
v_mul_f32 v24, v24, v164
v_mul_f32 v25, v25, v164
v_mul_f32 v26, v26, v164
v_mul_f32 v27, v27, v164
v_accvgpr_write_b32 a92, v24
v_accvgpr_write_b32 a93, v25
v_accvgpr_write_b32 a94, v26
v_accvgpr_write_b32 a95, v27
v_accvgpr_read_b32 v24, a96
v_accvgpr_read_b32 v25, a97
v_accvgpr_read_b32 v26, a98
v_accvgpr_read_b32 v27, a99
v_mul_f32 v24, v24, v164
v_mul_f32 v25, v25, v164
v_mul_f32 v26, v26, v164
v_mul_f32 v27, v27, v164
v_accvgpr_write_b32 a96, v24
v_accvgpr_write_b32 a97, v25
v_accvgpr_write_b32 a98, v26
v_accvgpr_write_b32 a99, v27
v_accvgpr_read_b32 v24, a100
v_accvgpr_read_b32 v25, a101
v_accvgpr_read_b32 v26, a102
v_accvgpr_read_b32 v27, a103
v_mul_f32 v24, v24, v164
v_mul_f32 v25, v25, v164
v_mul_f32 v26, v26, v164
v_mul_f32 v27, v27, v164
v_accvgpr_write_b32 a100, v24
v_accvgpr_write_b32 a101, v25
v_accvgpr_write_b32 a102, v26
v_accvgpr_write_b32 a103, v27
v_accvgpr_read_b32 v24, a104
v_accvgpr_read_b32 v25, a105
v_accvgpr_read_b32 v26, a106
v_accvgpr_read_b32 v27, a107
v_mul_f32 v24, v24, v164
v_mul_f32 v25, v25, v164
v_mul_f32 v26, v26, v164
v_mul_f32 v27, v27, v164
v_accvgpr_write_b32 a104, v24
v_accvgpr_write_b32 a105, v25
v_accvgpr_write_b32 a106, v26
v_accvgpr_write_b32 a107, v27
v_accvgpr_read_b32 v24, a108
v_accvgpr_read_b32 v25, a109
v_accvgpr_read_b32 v26, a110
v_accvgpr_read_b32 v27, a111
v_mul_f32 v24, v24, v164
v_mul_f32 v25, v25, v164
v_mul_f32 v26, v26, v164
v_mul_f32 v27, v27, v164
v_accvgpr_write_b32 a108, v24
v_accvgpr_write_b32 a109, v25
v_accvgpr_write_b32 a110, v26
v_accvgpr_write_b32 a111, v27
v_accvgpr_read_b32 v24, a112
v_accvgpr_read_b32 v25, a113
v_accvgpr_read_b32 v26, a114
v_accvgpr_read_b32 v27, a115
v_mul_f32 v24, v24, v164
v_mul_f32 v25, v25, v164
v_mul_f32 v26, v26, v164
v_mul_f32 v27, v27, v164
v_accvgpr_write_b32 a112, v24
v_accvgpr_write_b32 a113, v25
v_accvgpr_write_b32 a114, v26
v_accvgpr_write_b32 a115, v27
v_accvgpr_read_b32 v24, a116
v_accvgpr_read_b32 v25, a117
v_accvgpr_read_b32 v26, a118
v_accvgpr_read_b32 v27, a119
v_mul_f32 v24, v24, v164
v_mul_f32 v25, v25, v164
v_mul_f32 v26, v26, v164
v_mul_f32 v27, v27, v164
v_accvgpr_write_b32 a116, v24
v_accvgpr_write_b32 a117, v25
v_accvgpr_write_b32 a118, v26
v_accvgpr_write_b32 a119, v27
v_accvgpr_read_b32 v24, a120
v_accvgpr_read_b32 v25, a121
v_accvgpr_read_b32 v26, a122
v_accvgpr_read_b32 v27, a123
v_mul_f32 v24, v24, v164
v_mul_f32 v25, v25, v164
v_mul_f32 v26, v26, v164
v_mul_f32 v27, v27, v164
v_accvgpr_write_b32 a120, v24
v_accvgpr_write_b32 a121, v25
v_accvgpr_write_b32 a122, v26
v_accvgpr_write_b32 a123, v27
v_accvgpr_read_b32 v24, a124
v_accvgpr_read_b32 v25, a125
v_accvgpr_read_b32 v26, a126
v_accvgpr_read_b32 v27, a127
v_mul_f32 v24, v24, v164
v_mul_f32 v25, v25, v164
v_mul_f32 v26, v26, v164
v_mul_f32 v27, v27, v164
v_accvgpr_write_b32 a124, v24
v_accvgpr_write_b32 a125, v25
v_accvgpr_write_b32 a126, v26
v_accvgpr_write_b32 a127, v27
v_exp_f32 v128, v64
v_exp_f32 v129, v65
v_exp_f32 v130, v66
v_exp_f32 v131, v67
v_exp_f32 v132, v68
v_exp_f32 v133, v69
v_exp_f32 v134, v70
v_exp_f32 v135, v71
v_exp_f32 v136, v72
v_exp_f32 v137, v73
v_exp_f32 v138, v74
v_exp_f32 v139, v75
v_exp_f32 v140, v76
v_exp_f32 v141, v77
v_exp_f32 v142, v78
v_exp_f32 v143, v79
s_nop 0
v_add_f32 v162, v128, v129
v_add_f32 v162, v162, v130
v_add_f32 v162, v162, v131
v_add_f32 v162, v162, v132
v_add_f32 v162, v162, v133
v_add_f32 v162, v162, v134
v_add_f32 v162, v162, v135
v_add_f32 v162, v162, v136
v_add_f32 v162, v162, v137
v_add_f32 v162, v162, v138
v_add_f32 v162, v162, v139
v_add_f32 v162, v162, v140
v_add_f32 v162, v162, v141
v_add_f32 v162, v162, v142
v_add_f32 v162, v162, v143
v_cvt_pk_bf16_f32 v144, v128, v129
v_cvt_pk_bf16_f32 v145, v130, v131
v_cvt_pk_bf16_f32 v146, v132, v133
v_cvt_pk_bf16_f32 v147, v134, v135
v_cvt_pk_bf16_f32 v148, v136, v137
v_cvt_pk_bf16_f32 v149, v138, v139
v_cvt_pk_bf16_f32 v150, v140, v141
v_cvt_pk_bf16_f32 v151, v142, v143
s_nop 1
s_branch k12_kernel_bk_o1
k12_kernel_fb_e0:
v_max3_f32 v163, v80, v81, v82
v_max3_f32 v163, v163, v83, v84
v_max3_f32 v163, v163, v85, v86
v_max3_f32 v163, v163, v87, v88
v_max3_f32 v163, v163, v89, v90
v_max3_f32 v163, v163, v91, v92
v_max3_f32 v163, v163, v93, v94
v_max_f32 v163, v163, v95
v_mov_b32 v164, v163
s_cmp_lg_u32 s38, 0
s_cselect_b32 s35, 0xff800000, 0
v_permlane32_swap_b32 v163, v164
v_max_f32 v163, v163, v164
v_max_f32 v163, s35, v163
v_exp_f32 v164, -v163
s_nop 0
v_min_f32 v164, 1.0, v164
v_sub_f32 v80, v80, v163
v_sub_f32 v81, v81, v163
v_sub_f32 v82, v82, v163
v_sub_f32 v83, v83, v163
v_sub_f32 v84, v84, v163
v_sub_f32 v85, v85, v163
v_sub_f32 v86, v86, v163
v_sub_f32 v87, v87, v163
v_sub_f32 v88, v88, v163
v_sub_f32 v89, v89, v163
v_sub_f32 v90, v90, v163
v_sub_f32 v91, v91, v163
v_sub_f32 v92, v92, v163
v_sub_f32 v93, v93, v163
v_sub_f32 v94, v94, v163
v_sub_f32 v95, v95, v163
v_sub_f32 v112, v112, v163
v_sub_f32 v113, v113, v163
v_sub_f32 v114, v114, v163
v_sub_f32 v115, v115, v163
v_sub_f32 v116, v116, v163
v_sub_f32 v117, v117, v163
v_sub_f32 v118, v118, v163
v_sub_f32 v119, v119, v163
v_sub_f32 v120, v120, v163
v_sub_f32 v121, v121, v163
v_sub_f32 v122, v122, v163
v_sub_f32 v123, v123, v163
v_sub_f32 v124, v124, v163
v_sub_f32 v125, v125, v163
v_sub_f32 v126, v126, v163
v_sub_f32 v127, v127, v163
v_mul_f32 v161, v161, v164
v_sub_f32 v64, v64, v163
v_sub_f32 v65, v65, v163
v_sub_f32 v66, v66, v163
v_sub_f32 v67, v67, v163
v_sub_f32 v68, v68, v163
v_sub_f32 v69, v69, v163
v_sub_f32 v70, v70, v163
v_sub_f32 v71, v71, v163
v_sub_f32 v72, v72, v163
v_sub_f32 v73, v73, v163
v_sub_f32 v74, v74, v163
v_sub_f32 v75, v75, v163
v_sub_f32 v76, v76, v163
v_sub_f32 v77, v77, v163
v_sub_f32 v78, v78, v163
v_sub_f32 v79, v79, v163
v_accvgpr_read_b32 v24, a64
v_accvgpr_read_b32 v25, a65
v_accvgpr_read_b32 v26, a66
v_accvgpr_read_b32 v27, a67
v_mul_f32 v24, v24, v164
v_mul_f32 v25, v25, v164
v_mul_f32 v26, v26, v164
v_mul_f32 v27, v27, v164
v_accvgpr_write_b32 a64, v24
v_accvgpr_write_b32 a65, v25
v_accvgpr_write_b32 a66, v26
v_accvgpr_write_b32 a67, v27
v_accvgpr_read_b32 v24, a68
v_accvgpr_read_b32 v25, a69
v_accvgpr_read_b32 v26, a70
v_accvgpr_read_b32 v27, a71
v_mul_f32 v24, v24, v164
v_mul_f32 v25, v25, v164
v_mul_f32 v26, v26, v164
v_mul_f32 v27, v27, v164
v_accvgpr_write_b32 a68, v24
v_accvgpr_write_b32 a69, v25
v_accvgpr_write_b32 a70, v26
v_accvgpr_write_b32 a71, v27
v_accvgpr_read_b32 v24, a72
v_accvgpr_read_b32 v25, a73
v_accvgpr_read_b32 v26, a74
v_accvgpr_read_b32 v27, a75
v_mul_f32 v24, v24, v164
v_mul_f32 v25, v25, v164
v_mul_f32 v26, v26, v164
v_mul_f32 v27, v27, v164
v_accvgpr_write_b32 a72, v24
v_accvgpr_write_b32 a73, v25
v_accvgpr_write_b32 a74, v26
v_accvgpr_write_b32 a75, v27
v_accvgpr_read_b32 v24, a76
v_accvgpr_read_b32 v25, a77
v_accvgpr_read_b32 v26, a78
v_accvgpr_read_b32 v27, a79
v_mul_f32 v24, v24, v164
v_mul_f32 v25, v25, v164
v_mul_f32 v26, v26, v164
v_mul_f32 v27, v27, v164
v_accvgpr_write_b32 a76, v24
v_accvgpr_write_b32 a77, v25
v_accvgpr_write_b32 a78, v26
v_accvgpr_write_b32 a79, v27
v_accvgpr_read_b32 v24, a80
v_accvgpr_read_b32 v25, a81
v_accvgpr_read_b32 v26, a82
v_accvgpr_read_b32 v27, a83
v_mul_f32 v24, v24, v164
v_mul_f32 v25, v25, v164
v_mul_f32 v26, v26, v164
v_mul_f32 v27, v27, v164
v_accvgpr_write_b32 a80, v24
v_accvgpr_write_b32 a81, v25
v_accvgpr_write_b32 a82, v26
v_accvgpr_write_b32 a83, v27
v_accvgpr_read_b32 v24, a84
v_accvgpr_read_b32 v25, a85
v_accvgpr_read_b32 v26, a86
v_accvgpr_read_b32 v27, a87
v_mul_f32 v24, v24, v164
v_mul_f32 v25, v25, v164
v_mul_f32 v26, v26, v164
v_mul_f32 v27, v27, v164
v_accvgpr_write_b32 a84, v24
v_accvgpr_write_b32 a85, v25
v_accvgpr_write_b32 a86, v26
v_accvgpr_write_b32 a87, v27
v_accvgpr_read_b32 v24, a88
v_accvgpr_read_b32 v25, a89
v_accvgpr_read_b32 v26, a90
v_accvgpr_read_b32 v27, a91
v_mul_f32 v24, v24, v164
v_mul_f32 v25, v25, v164
v_mul_f32 v26, v26, v164
v_mul_f32 v27, v27, v164
v_accvgpr_write_b32 a88, v24
v_accvgpr_write_b32 a89, v25
v_accvgpr_write_b32 a90, v26
v_accvgpr_write_b32 a91, v27
v_accvgpr_read_b32 v24, a92
v_accvgpr_read_b32 v25, a93
v_accvgpr_read_b32 v26, a94
v_accvgpr_read_b32 v27, a95
v_mul_f32 v24, v24, v164
v_mul_f32 v25, v25, v164
v_mul_f32 v26, v26, v164
v_mul_f32 v27, v27, v164
v_accvgpr_write_b32 a92, v24
v_accvgpr_write_b32 a93, v25
v_accvgpr_write_b32 a94, v26
v_accvgpr_write_b32 a95, v27
v_accvgpr_read_b32 v24, a96
v_accvgpr_read_b32 v25, a97
v_accvgpr_read_b32 v26, a98
v_accvgpr_read_b32 v27, a99
v_mul_f32 v24, v24, v164
v_mul_f32 v25, v25, v164
v_mul_f32 v26, v26, v164
v_mul_f32 v27, v27, v164
v_accvgpr_write_b32 a96, v24
v_accvgpr_write_b32 a97, v25
v_accvgpr_write_b32 a98, v26
v_accvgpr_write_b32 a99, v27
v_accvgpr_read_b32 v24, a100
v_accvgpr_read_b32 v25, a101
v_accvgpr_read_b32 v26, a102
v_accvgpr_read_b32 v27, a103
v_mul_f32 v24, v24, v164
v_mul_f32 v25, v25, v164
v_mul_f32 v26, v26, v164
v_mul_f32 v27, v27, v164
v_accvgpr_write_b32 a100, v24
v_accvgpr_write_b32 a101, v25
v_accvgpr_write_b32 a102, v26
v_accvgpr_write_b32 a103, v27
v_accvgpr_read_b32 v24, a104
v_accvgpr_read_b32 v25, a105
v_accvgpr_read_b32 v26, a106
v_accvgpr_read_b32 v27, a107
v_mul_f32 v24, v24, v164
v_mul_f32 v25, v25, v164
v_mul_f32 v26, v26, v164
v_mul_f32 v27, v27, v164
v_accvgpr_write_b32 a104, v24
v_accvgpr_write_b32 a105, v25
v_accvgpr_write_b32 a106, v26
v_accvgpr_write_b32 a107, v27
v_accvgpr_read_b32 v24, a108
v_accvgpr_read_b32 v25, a109
v_accvgpr_read_b32 v26, a110
v_accvgpr_read_b32 v27, a111
v_mul_f32 v24, v24, v164
v_mul_f32 v25, v25, v164
v_mul_f32 v26, v26, v164
v_mul_f32 v27, v27, v164
v_accvgpr_write_b32 a108, v24
v_accvgpr_write_b32 a109, v25
v_accvgpr_write_b32 a110, v26
v_accvgpr_write_b32 a111, v27
v_accvgpr_read_b32 v24, a112
v_accvgpr_read_b32 v25, a113
v_accvgpr_read_b32 v26, a114
v_accvgpr_read_b32 v27, a115
v_mul_f32 v24, v24, v164
v_mul_f32 v25, v25, v164
v_mul_f32 v26, v26, v164
v_mul_f32 v27, v27, v164
v_accvgpr_write_b32 a112, v24
v_accvgpr_write_b32 a113, v25
v_accvgpr_write_b32 a114, v26
v_accvgpr_write_b32 a115, v27
v_accvgpr_read_b32 v24, a116
v_accvgpr_read_b32 v25, a117
v_accvgpr_read_b32 v26, a118
v_accvgpr_read_b32 v27, a119
v_mul_f32 v24, v24, v164
v_mul_f32 v25, v25, v164
v_mul_f32 v26, v26, v164
v_mul_f32 v27, v27, v164
v_accvgpr_write_b32 a116, v24
v_accvgpr_write_b32 a117, v25
v_accvgpr_write_b32 a118, v26
v_accvgpr_write_b32 a119, v27
v_accvgpr_read_b32 v24, a120
v_accvgpr_read_b32 v25, a121
v_accvgpr_read_b32 v26, a122
v_accvgpr_read_b32 v27, a123
v_mul_f32 v24, v24, v164
v_mul_f32 v25, v25, v164
v_mul_f32 v26, v26, v164
v_mul_f32 v27, v27, v164
v_accvgpr_write_b32 a120, v24
v_accvgpr_write_b32 a121, v25
v_accvgpr_write_b32 a122, v26
v_accvgpr_write_b32 a123, v27
v_accvgpr_read_b32 v24, a124
v_accvgpr_read_b32 v25, a125
v_accvgpr_read_b32 v26, a126
v_accvgpr_read_b32 v27, a127
v_mul_f32 v24, v24, v164
v_mul_f32 v25, v25, v164
v_mul_f32 v26, v26, v164
v_mul_f32 v27, v27, v164
v_accvgpr_write_b32 a124, v24
v_accvgpr_write_b32 a125, v25
v_accvgpr_write_b32 a126, v26
v_accvgpr_write_b32 a127, v27
v_exp_f32 v128, v80
v_exp_f32 v129, v81
v_exp_f32 v130, v82
v_exp_f32 v131, v83
v_exp_f32 v132, v84
v_exp_f32 v133, v85
v_exp_f32 v134, v86
v_exp_f32 v135, v87
v_exp_f32 v136, v88
v_exp_f32 v137, v89
v_exp_f32 v138, v90
v_exp_f32 v139, v91
v_exp_f32 v140, v92
v_exp_f32 v141, v93
v_exp_f32 v142, v94
v_exp_f32 v143, v95
s_nop 0
v_add_f32 v162, v128, v129
v_add_f32 v162, v162, v130
v_add_f32 v162, v162, v131
v_add_f32 v162, v162, v132
v_add_f32 v162, v162, v133
v_add_f32 v162, v162, v134
v_add_f32 v162, v162, v135
v_add_f32 v162, v162, v136
v_add_f32 v162, v162, v137
v_add_f32 v162, v162, v138
v_add_f32 v162, v162, v139
v_add_f32 v162, v162, v140
v_add_f32 v162, v162, v141
v_add_f32 v162, v162, v142
v_add_f32 v162, v162, v143
v_cvt_pk_bf16_f32 v152, v128, v129
v_cvt_pk_bf16_f32 v153, v130, v131
v_cvt_pk_bf16_f32 v154, v132, v133
v_cvt_pk_bf16_f32 v155, v134, v135
v_cvt_pk_bf16_f32 v156, v136, v137
v_cvt_pk_bf16_f32 v157, v138, v139
v_cvt_pk_bf16_f32 v158, v140, v141
v_cvt_pk_bf16_f32 v159, v142, v143
s_nop 1
s_branch k12_kernel_bk_e0
k12_kernel_fb_e1:
v_max3_f32 v163, v64, v65, v66
v_max3_f32 v163, v163, v67, v68
v_max3_f32 v163, v163, v69, v70
v_max3_f32 v163, v163, v71, v72
v_max3_f32 v163, v163, v73, v74
v_max3_f32 v163, v163, v75, v76
v_max3_f32 v163, v163, v77, v78
v_max_f32 v163, v163, v79
v_mov_b32 v164, v163
s_cmp_lg_u32 s38, 0
s_cselect_b32 s35, 0xff800000, 0
v_permlane32_swap_b32 v163, v164
v_max_f32 v163, v163, v164
v_max_f32 v163, s35, v163
v_exp_f32 v164, -v163
s_nop 0
v_min_f32 v164, 1.0, v164
v_sub_f32 v64, v64, v163
v_sub_f32 v65, v65, v163
v_sub_f32 v66, v66, v163
v_sub_f32 v67, v67, v163
v_sub_f32 v68, v68, v163
v_sub_f32 v69, v69, v163
v_sub_f32 v70, v70, v163
v_sub_f32 v71, v71, v163
v_sub_f32 v72, v72, v163
v_sub_f32 v73, v73, v163
v_sub_f32 v74, v74, v163
v_sub_f32 v75, v75, v163
v_sub_f32 v76, v76, v163
v_sub_f32 v77, v77, v163
v_sub_f32 v78, v78, v163
v_sub_f32 v79, v79, v163
v_sub_f32 v112, v112, v163
v_sub_f32 v113, v113, v163
v_sub_f32 v114, v114, v163
v_sub_f32 v115, v115, v163
v_sub_f32 v116, v116, v163
v_sub_f32 v117, v117, v163
v_sub_f32 v118, v118, v163
v_sub_f32 v119, v119, v163
v_sub_f32 v120, v120, v163
v_sub_f32 v121, v121, v163
v_sub_f32 v122, v122, v163
v_sub_f32 v123, v123, v163
v_sub_f32 v124, v124, v163
v_sub_f32 v125, v125, v163
v_sub_f32 v126, v126, v163
v_sub_f32 v127, v127, v163
v_mul_f32 v161, v161, v164
v_sub_f32 v80, v80, v163
v_sub_f32 v81, v81, v163
v_sub_f32 v82, v82, v163
v_sub_f32 v83, v83, v163
v_sub_f32 v84, v84, v163
v_sub_f32 v85, v85, v163
v_sub_f32 v86, v86, v163
v_sub_f32 v87, v87, v163
v_sub_f32 v88, v88, v163
v_sub_f32 v89, v89, v163
v_sub_f32 v90, v90, v163
v_sub_f32 v91, v91, v163
v_sub_f32 v92, v92, v163
v_sub_f32 v93, v93, v163
v_sub_f32 v94, v94, v163
v_sub_f32 v95, v95, v163
v_accvgpr_read_b32 v24, a64
v_accvgpr_read_b32 v25, a65
v_accvgpr_read_b32 v26, a66
v_accvgpr_read_b32 v27, a67
v_mul_f32 v24, v24, v164
v_mul_f32 v25, v25, v164
v_mul_f32 v26, v26, v164
v_mul_f32 v27, v27, v164
v_accvgpr_write_b32 a64, v24
v_accvgpr_write_b32 a65, v25
v_accvgpr_write_b32 a66, v26
v_accvgpr_write_b32 a67, v27
v_accvgpr_read_b32 v24, a68
v_accvgpr_read_b32 v25, a69
v_accvgpr_read_b32 v26, a70
v_accvgpr_read_b32 v27, a71
v_mul_f32 v24, v24, v164
v_mul_f32 v25, v25, v164
v_mul_f32 v26, v26, v164
v_mul_f32 v27, v27, v164
v_accvgpr_write_b32 a68, v24
v_accvgpr_write_b32 a69, v25
v_accvgpr_write_b32 a70, v26
v_accvgpr_write_b32 a71, v27
v_accvgpr_read_b32 v24, a72
v_accvgpr_read_b32 v25, a73
v_accvgpr_read_b32 v26, a74
v_accvgpr_read_b32 v27, a75
v_mul_f32 v24, v24, v164
v_mul_f32 v25, v25, v164
v_mul_f32 v26, v26, v164
v_mul_f32 v27, v27, v164
v_accvgpr_write_b32 a72, v24
v_accvgpr_write_b32 a73, v25
v_accvgpr_write_b32 a74, v26
v_accvgpr_write_b32 a75, v27
v_accvgpr_read_b32 v24, a76
v_accvgpr_read_b32 v25, a77
v_accvgpr_read_b32 v26, a78
v_accvgpr_read_b32 v27, a79
v_mul_f32 v24, v24, v164
v_mul_f32 v25, v25, v164
v_mul_f32 v26, v26, v164
v_mul_f32 v27, v27, v164
v_accvgpr_write_b32 a76, v24
v_accvgpr_write_b32 a77, v25
v_accvgpr_write_b32 a78, v26
v_accvgpr_write_b32 a79, v27
v_accvgpr_read_b32 v24, a80
v_accvgpr_read_b32 v25, a81
v_accvgpr_read_b32 v26, a82
v_accvgpr_read_b32 v27, a83
v_mul_f32 v24, v24, v164
v_mul_f32 v25, v25, v164
v_mul_f32 v26, v26, v164
v_mul_f32 v27, v27, v164
v_accvgpr_write_b32 a80, v24
v_accvgpr_write_b32 a81, v25
v_accvgpr_write_b32 a82, v26
v_accvgpr_write_b32 a83, v27
v_accvgpr_read_b32 v24, a84
v_accvgpr_read_b32 v25, a85
v_accvgpr_read_b32 v26, a86
v_accvgpr_read_b32 v27, a87
v_mul_f32 v24, v24, v164
v_mul_f32 v25, v25, v164
v_mul_f32 v26, v26, v164
v_mul_f32 v27, v27, v164
v_accvgpr_write_b32 a84, v24
v_accvgpr_write_b32 a85, v25
v_accvgpr_write_b32 a86, v26
v_accvgpr_write_b32 a87, v27
v_accvgpr_read_b32 v24, a88
v_accvgpr_read_b32 v25, a89
v_accvgpr_read_b32 v26, a90
v_accvgpr_read_b32 v27, a91
v_mul_f32 v24, v24, v164
v_mul_f32 v25, v25, v164
v_mul_f32 v26, v26, v164
v_mul_f32 v27, v27, v164
v_accvgpr_write_b32 a88, v24
v_accvgpr_write_b32 a89, v25
v_accvgpr_write_b32 a90, v26
v_accvgpr_write_b32 a91, v27
v_accvgpr_read_b32 v24, a92
v_accvgpr_read_b32 v25, a93
v_accvgpr_read_b32 v26, a94
v_accvgpr_read_b32 v27, a95
v_mul_f32 v24, v24, v164
v_mul_f32 v25, v25, v164
v_mul_f32 v26, v26, v164
v_mul_f32 v27, v27, v164
v_accvgpr_write_b32 a92, v24
v_accvgpr_write_b32 a93, v25
v_accvgpr_write_b32 a94, v26
v_accvgpr_write_b32 a95, v27
v_accvgpr_read_b32 v24, a96
v_accvgpr_read_b32 v25, a97
v_accvgpr_read_b32 v26, a98
v_accvgpr_read_b32 v27, a99
v_mul_f32 v24, v24, v164
v_mul_f32 v25, v25, v164
v_mul_f32 v26, v26, v164
v_mul_f32 v27, v27, v164
v_accvgpr_write_b32 a96, v24
v_accvgpr_write_b32 a97, v25
v_accvgpr_write_b32 a98, v26
v_accvgpr_write_b32 a99, v27
v_accvgpr_read_b32 v24, a100
v_accvgpr_read_b32 v25, a101
v_accvgpr_read_b32 v26, a102
v_accvgpr_read_b32 v27, a103
v_mul_f32 v24, v24, v164
v_mul_f32 v25, v25, v164
v_mul_f32 v26, v26, v164
v_mul_f32 v27, v27, v164
v_accvgpr_write_b32 a100, v24
v_accvgpr_write_b32 a101, v25
v_accvgpr_write_b32 a102, v26
v_accvgpr_write_b32 a103, v27
v_accvgpr_read_b32 v24, a104
v_accvgpr_read_b32 v25, a105
v_accvgpr_read_b32 v26, a106
v_accvgpr_read_b32 v27, a107
v_mul_f32 v24, v24, v164
v_mul_f32 v25, v25, v164
v_mul_f32 v26, v26, v164
v_mul_f32 v27, v27, v164
v_accvgpr_write_b32 a104, v24
v_accvgpr_write_b32 a105, v25
v_accvgpr_write_b32 a106, v26
v_accvgpr_write_b32 a107, v27
v_accvgpr_read_b32 v24, a108
v_accvgpr_read_b32 v25, a109
v_accvgpr_read_b32 v26, a110
v_accvgpr_read_b32 v27, a111
v_mul_f32 v24, v24, v164
v_mul_f32 v25, v25, v164
v_mul_f32 v26, v26, v164
v_mul_f32 v27, v27, v164
v_accvgpr_write_b32 a108, v24
v_accvgpr_write_b32 a109, v25
v_accvgpr_write_b32 a110, v26
v_accvgpr_write_b32 a111, v27
v_accvgpr_read_b32 v24, a112
v_accvgpr_read_b32 v25, a113
v_accvgpr_read_b32 v26, a114
v_accvgpr_read_b32 v27, a115
v_mul_f32 v24, v24, v164
v_mul_f32 v25, v25, v164
v_mul_f32 v26, v26, v164
v_mul_f32 v27, v27, v164
v_accvgpr_write_b32 a112, v24
v_accvgpr_write_b32 a113, v25
v_accvgpr_write_b32 a114, v26
v_accvgpr_write_b32 a115, v27
v_accvgpr_read_b32 v24, a116
v_accvgpr_read_b32 v25, a117
v_accvgpr_read_b32 v26, a118
v_accvgpr_read_b32 v27, a119
v_mul_f32 v24, v24, v164
v_mul_f32 v25, v25, v164
v_mul_f32 v26, v26, v164
v_mul_f32 v27, v27, v164
v_accvgpr_write_b32 a116, v24
v_accvgpr_write_b32 a117, v25
v_accvgpr_write_b32 a118, v26
v_accvgpr_write_b32 a119, v27
v_accvgpr_read_b32 v24, a120
v_accvgpr_read_b32 v25, a121
v_accvgpr_read_b32 v26, a122
v_accvgpr_read_b32 v27, a123
v_mul_f32 v24, v24, v164
v_mul_f32 v25, v25, v164
v_mul_f32 v26, v26, v164
v_mul_f32 v27, v27, v164
v_accvgpr_write_b32 a120, v24
v_accvgpr_write_b32 a121, v25
v_accvgpr_write_b32 a122, v26
v_accvgpr_write_b32 a123, v27
v_accvgpr_read_b32 v24, a124
v_accvgpr_read_b32 v25, a125
v_accvgpr_read_b32 v26, a126
v_accvgpr_read_b32 v27, a127
v_mul_f32 v24, v24, v164
v_mul_f32 v25, v25, v164
v_mul_f32 v26, v26, v164
v_mul_f32 v27, v27, v164
v_accvgpr_write_b32 a124, v24
v_accvgpr_write_b32 a125, v25
v_accvgpr_write_b32 a126, v26
v_accvgpr_write_b32 a127, v27
v_exp_f32 v128, v64
v_exp_f32 v129, v65
v_exp_f32 v130, v66
v_exp_f32 v131, v67
v_exp_f32 v132, v68
v_exp_f32 v133, v69
v_exp_f32 v134, v70
v_exp_f32 v135, v71
v_exp_f32 v136, v72
v_exp_f32 v137, v73
v_exp_f32 v138, v74
v_exp_f32 v139, v75
v_exp_f32 v140, v76
v_exp_f32 v141, v77
v_exp_f32 v142, v78
v_exp_f32 v143, v79
s_nop 0
v_add_f32 v162, v128, v129
v_add_f32 v162, v162, v130
v_add_f32 v162, v162, v131
v_add_f32 v162, v162, v132
v_add_f32 v162, v162, v133
v_add_f32 v162, v162, v134
v_add_f32 v162, v162, v135
v_add_f32 v162, v162, v136
v_add_f32 v162, v162, v137
v_add_f32 v162, v162, v138
v_add_f32 v162, v162, v139
v_add_f32 v162, v162, v140
v_add_f32 v162, v162, v141
v_add_f32 v162, v162, v142
v_add_f32 v162, v162, v143
v_cvt_pk_bf16_f32 v144, v128, v129
v_cvt_pk_bf16_f32 v145, v130, v131
v_cvt_pk_bf16_f32 v146, v132, v133
v_cvt_pk_bf16_f32 v147, v134, v135
v_cvt_pk_bf16_f32 v148, v136, v137
v_cvt_pk_bf16_f32 v149, v138, v139
v_cvt_pk_bf16_f32 v150, v140, v141
v_cvt_pk_bf16_f32 v151, v142, v143
s_nop 1
s_branch k12_kernel_bk_e1
k12_kernel_f2spins:
s_mov_b32 s101, 200000
k12_kernel_f2sps:
buffer_load_dword v39, v3, s[60:63], s36 offen sc1
s_waitcnt vmcnt(0)
v_cmp_gt_u32 vcc, 2, v39
s_and_b64 vcc, vcc, s[48:49]
s_cbranch_vccz k12_kernel_f2backs
s_sub_u32 s101, s101, 1
s_cmp_lg_u32 s101, 0
s_cbranch_scc1 k12_kernel_f2sps
s_branch k12_kernel_f2backs
k12_kernel_fb_f:
v_max3_f32 v163, v80, v81, v82
v_max3_f32 v163, v163, v83, v84
v_max3_f32 v163, v163, v85, v86
v_max3_f32 v163, v163, v87, v88
v_max3_f32 v163, v163, v89, v90
v_max3_f32 v163, v163, v91, v92
v_max3_f32 v163, v163, v93, v94
v_max_f32 v163, v163, v95
v_mov_b32 v164, v163
s_cmp_lg_u32 s38, 0
s_cselect_b32 s35, 0xff800000, 0
v_permlane32_swap_b32 v163, v164
v_max_f32 v163, v163, v164
v_max_f32 v163, s35, v163
v_exp_f32 v164, -v163
s_nop 0
v_min_f32 v164, 1.0, v164
v_sub_f32 v80, v80, v163
v_sub_f32 v81, v81, v163
v_sub_f32 v82, v82, v163
v_sub_f32 v83, v83, v163
v_sub_f32 v84, v84, v163
v_sub_f32 v85, v85, v163
v_sub_f32 v86, v86, v163
v_sub_f32 v87, v87, v163
v_sub_f32 v88, v88, v163
v_sub_f32 v89, v89, v163
v_sub_f32 v90, v90, v163
v_sub_f32 v91, v91, v163
v_sub_f32 v92, v92, v163
v_sub_f32 v93, v93, v163
v_sub_f32 v94, v94, v163
v_sub_f32 v95, v95, v163
v_sub_f32 v112, v112, v163
v_sub_f32 v113, v113, v163
v_sub_f32 v114, v114, v163
v_sub_f32 v115, v115, v163
v_sub_f32 v116, v116, v163
v_sub_f32 v117, v117, v163
v_sub_f32 v118, v118, v163
v_sub_f32 v119, v119, v163
v_sub_f32 v120, v120, v163
v_sub_f32 v121, v121, v163
v_sub_f32 v122, v122, v163
v_sub_f32 v123, v123, v163
v_sub_f32 v124, v124, v163
v_sub_f32 v125, v125, v163
v_sub_f32 v126, v126, v163
v_sub_f32 v127, v127, v163
v_mul_f32 v161, v161, v164
v_sub_f32 v64, v64, v163
v_sub_f32 v65, v65, v163
v_sub_f32 v66, v66, v163
v_sub_f32 v67, v67, v163
v_sub_f32 v68, v68, v163
v_sub_f32 v69, v69, v163
v_sub_f32 v70, v70, v163
v_sub_f32 v71, v71, v163
v_sub_f32 v72, v72, v163
v_sub_f32 v73, v73, v163
v_sub_f32 v74, v74, v163
v_sub_f32 v75, v75, v163
v_sub_f32 v76, v76, v163
v_sub_f32 v77, v77, v163
v_sub_f32 v78, v78, v163
v_sub_f32 v79, v79, v163
v_accvgpr_read_b32 v24, a64
v_accvgpr_read_b32 v25, a65
v_accvgpr_read_b32 v26, a66
v_accvgpr_read_b32 v27, a67
v_mul_f32 v24, v24, v164
v_mul_f32 v25, v25, v164
v_mul_f32 v26, v26, v164
v_mul_f32 v27, v27, v164
v_accvgpr_write_b32 a64, v24
v_accvgpr_write_b32 a65, v25
v_accvgpr_write_b32 a66, v26
v_accvgpr_write_b32 a67, v27
v_accvgpr_read_b32 v24, a68
v_accvgpr_read_b32 v25, a69
v_accvgpr_read_b32 v26, a70
v_accvgpr_read_b32 v27, a71
v_mul_f32 v24, v24, v164
v_mul_f32 v25, v25, v164
v_mul_f32 v26, v26, v164
v_mul_f32 v27, v27, v164
v_accvgpr_write_b32 a68, v24
v_accvgpr_write_b32 a69, v25
v_accvgpr_write_b32 a70, v26
v_accvgpr_write_b32 a71, v27
v_accvgpr_read_b32 v24, a72
v_accvgpr_read_b32 v25, a73
v_accvgpr_read_b32 v26, a74
v_accvgpr_read_b32 v27, a75
v_mul_f32 v24, v24, v164
v_mul_f32 v25, v25, v164
v_mul_f32 v26, v26, v164
v_mul_f32 v27, v27, v164
v_accvgpr_write_b32 a72, v24
v_accvgpr_write_b32 a73, v25
v_accvgpr_write_b32 a74, v26
v_accvgpr_write_b32 a75, v27
v_accvgpr_read_b32 v24, a76
v_accvgpr_read_b32 v25, a77
v_accvgpr_read_b32 v26, a78
v_accvgpr_read_b32 v27, a79
v_mul_f32 v24, v24, v164
v_mul_f32 v25, v25, v164
v_mul_f32 v26, v26, v164
v_mul_f32 v27, v27, v164
v_accvgpr_write_b32 a76, v24
v_accvgpr_write_b32 a77, v25
v_accvgpr_write_b32 a78, v26
v_accvgpr_write_b32 a79, v27
v_accvgpr_read_b32 v24, a80
v_accvgpr_read_b32 v25, a81
v_accvgpr_read_b32 v26, a82
v_accvgpr_read_b32 v27, a83
v_mul_f32 v24, v24, v164
v_mul_f32 v25, v25, v164
v_mul_f32 v26, v26, v164
v_mul_f32 v27, v27, v164
v_accvgpr_write_b32 a80, v24
v_accvgpr_write_b32 a81, v25
v_accvgpr_write_b32 a82, v26
v_accvgpr_write_b32 a83, v27
v_accvgpr_read_b32 v24, a84
v_accvgpr_read_b32 v25, a85
v_accvgpr_read_b32 v26, a86
v_accvgpr_read_b32 v27, a87
v_mul_f32 v24, v24, v164
v_mul_f32 v25, v25, v164
v_mul_f32 v26, v26, v164
v_mul_f32 v27, v27, v164
v_accvgpr_write_b32 a84, v24
v_accvgpr_write_b32 a85, v25
v_accvgpr_write_b32 a86, v26
v_accvgpr_write_b32 a87, v27
v_accvgpr_read_b32 v24, a88
v_accvgpr_read_b32 v25, a89
v_accvgpr_read_b32 v26, a90
v_accvgpr_read_b32 v27, a91
v_mul_f32 v24, v24, v164
v_mul_f32 v25, v25, v164
v_mul_f32 v26, v26, v164
v_mul_f32 v27, v27, v164
v_accvgpr_write_b32 a88, v24
v_accvgpr_write_b32 a89, v25
v_accvgpr_write_b32 a90, v26
v_accvgpr_write_b32 a91, v27
v_accvgpr_read_b32 v24, a92
v_accvgpr_read_b32 v25, a93
v_accvgpr_read_b32 v26, a94
v_accvgpr_read_b32 v27, a95
v_mul_f32 v24, v24, v164
v_mul_f32 v25, v25, v164
v_mul_f32 v26, v26, v164
v_mul_f32 v27, v27, v164
v_accvgpr_write_b32 a92, v24
v_accvgpr_write_b32 a93, v25
v_accvgpr_write_b32 a94, v26
v_accvgpr_write_b32 a95, v27
v_accvgpr_read_b32 v24, a96
v_accvgpr_read_b32 v25, a97
v_accvgpr_read_b32 v26, a98
v_accvgpr_read_b32 v27, a99
v_mul_f32 v24, v24, v164
v_mul_f32 v25, v25, v164
v_mul_f32 v26, v26, v164
v_mul_f32 v27, v27, v164
v_accvgpr_write_b32 a96, v24
v_accvgpr_write_b32 a97, v25
v_accvgpr_write_b32 a98, v26
v_accvgpr_write_b32 a99, v27
v_accvgpr_read_b32 v24, a100
v_accvgpr_read_b32 v25, a101
v_accvgpr_read_b32 v26, a102
v_accvgpr_read_b32 v27, a103
v_mul_f32 v24, v24, v164
v_mul_f32 v25, v25, v164
v_mul_f32 v26, v26, v164
v_mul_f32 v27, v27, v164
v_accvgpr_write_b32 a100, v24
v_accvgpr_write_b32 a101, v25
v_accvgpr_write_b32 a102, v26
v_accvgpr_write_b32 a103, v27
v_accvgpr_read_b32 v24, a104
v_accvgpr_read_b32 v25, a105
v_accvgpr_read_b32 v26, a106
v_accvgpr_read_b32 v27, a107
v_mul_f32 v24, v24, v164
v_mul_f32 v25, v25, v164
v_mul_f32 v26, v26, v164
v_mul_f32 v27, v27, v164
v_accvgpr_write_b32 a104, v24
v_accvgpr_write_b32 a105, v25
v_accvgpr_write_b32 a106, v26
v_accvgpr_write_b32 a107, v27
v_accvgpr_read_b32 v24, a108
v_accvgpr_read_b32 v25, a109
v_accvgpr_read_b32 v26, a110
v_accvgpr_read_b32 v27, a111
v_mul_f32 v24, v24, v164
v_mul_f32 v25, v25, v164
v_mul_f32 v26, v26, v164
v_mul_f32 v27, v27, v164
v_accvgpr_write_b32 a108, v24
v_accvgpr_write_b32 a109, v25
v_accvgpr_write_b32 a110, v26
v_accvgpr_write_b32 a111, v27
v_accvgpr_read_b32 v24, a112
v_accvgpr_read_b32 v25, a113
v_accvgpr_read_b32 v26, a114
v_accvgpr_read_b32 v27, a115
v_mul_f32 v24, v24, v164
v_mul_f32 v25, v25, v164
v_mul_f32 v26, v26, v164
v_mul_f32 v27, v27, v164
v_accvgpr_write_b32 a112, v24
v_accvgpr_write_b32 a113, v25
v_accvgpr_write_b32 a114, v26
v_accvgpr_write_b32 a115, v27
v_accvgpr_read_b32 v24, a116
v_accvgpr_read_b32 v25, a117
v_accvgpr_read_b32 v26, a118
v_accvgpr_read_b32 v27, a119
v_mul_f32 v24, v24, v164
v_mul_f32 v25, v25, v164
v_mul_f32 v26, v26, v164
v_mul_f32 v27, v27, v164
v_accvgpr_write_b32 a116, v24
v_accvgpr_write_b32 a117, v25
v_accvgpr_write_b32 a118, v26
v_accvgpr_write_b32 a119, v27
v_accvgpr_read_b32 v24, a120
v_accvgpr_read_b32 v25, a121
v_accvgpr_read_b32 v26, a122
v_accvgpr_read_b32 v27, a123
v_mul_f32 v24, v24, v164
v_mul_f32 v25, v25, v164
v_mul_f32 v26, v26, v164
v_mul_f32 v27, v27, v164
v_accvgpr_write_b32 a120, v24
v_accvgpr_write_b32 a121, v25
v_accvgpr_write_b32 a122, v26
v_accvgpr_write_b32 a123, v27
v_accvgpr_read_b32 v24, a124
v_accvgpr_read_b32 v25, a125
v_accvgpr_read_b32 v26, a126
v_accvgpr_read_b32 v27, a127
v_mul_f32 v24, v24, v164
v_mul_f32 v25, v25, v164
v_mul_f32 v26, v26, v164
v_mul_f32 v27, v27, v164
v_accvgpr_write_b32 a124, v24
v_accvgpr_write_b32 a125, v25
v_accvgpr_write_b32 a126, v26
v_accvgpr_write_b32 a127, v27
v_exp_f32 v128, v80
v_exp_f32 v129, v81
v_exp_f32 v130, v82
v_exp_f32 v131, v83
v_exp_f32 v132, v84
v_exp_f32 v133, v85
v_exp_f32 v134, v86
v_exp_f32 v135, v87
v_exp_f32 v136, v88
v_exp_f32 v137, v89
v_exp_f32 v138, v90
v_exp_f32 v139, v91
v_exp_f32 v140, v92
v_exp_f32 v141, v93
v_exp_f32 v142, v94
v_exp_f32 v143, v95
s_nop 0
v_add_f32 v162, v128, v129
v_add_f32 v162, v162, v130
v_add_f32 v162, v162, v131
v_add_f32 v162, v162, v132
v_add_f32 v162, v162, v133
v_add_f32 v162, v162, v134
v_add_f32 v162, v162, v135
v_add_f32 v162, v162, v136
v_add_f32 v162, v162, v137
v_add_f32 v162, v162, v138
v_add_f32 v162, v162, v139
v_add_f32 v162, v162, v140
v_add_f32 v162, v162, v141
v_add_f32 v162, v162, v142
v_add_f32 v162, v162, v143
v_cvt_pk_bf16_f32 v152, v128, v129
v_cvt_pk_bf16_f32 v153, v130, v131
v_cvt_pk_bf16_f32 v154, v132, v133
v_cvt_pk_bf16_f32 v155, v134, v135
v_cvt_pk_bf16_f32 v156, v136, v137
v_cvt_pk_bf16_f32 v157, v138, v139
v_cvt_pk_bf16_f32 v158, v140, v141
v_cvt_pk_bf16_f32 v159, v142, v143
s_nop 1
s_branch k12_kernel_bk_f
k12_kernel_fb_t:
v_max3_f32 v163, v64, v65, v66
v_max3_f32 v163, v163, v67, v68
v_max3_f32 v163, v163, v69, v70
v_max3_f32 v163, v163, v71, v72
v_max3_f32 v163, v163, v73, v74
v_max3_f32 v163, v163, v75, v76
v_max3_f32 v163, v163, v77, v78
v_max_f32 v163, v163, v79
v_mov_b32 v164, v163
s_cmp_lg_u32 s38, 0
s_cselect_b32 s35, 0xff800000, 0
v_permlane32_swap_b32 v163, v164
v_max_f32 v163, v163, v164
v_max_f32 v163, s35, v163
v_exp_f32 v164, -v163
s_nop 0
v_min_f32 v164, 1.0, v164
v_sub_f32 v64, v64, v163
v_sub_f32 v65, v65, v163
v_sub_f32 v66, v66, v163
v_sub_f32 v67, v67, v163
v_sub_f32 v68, v68, v163
v_sub_f32 v69, v69, v163
v_sub_f32 v70, v70, v163
v_sub_f32 v71, v71, v163
v_sub_f32 v72, v72, v163
v_sub_f32 v73, v73, v163
v_sub_f32 v74, v74, v163
v_sub_f32 v75, v75, v163
v_sub_f32 v76, v76, v163
v_sub_f32 v77, v77, v163
v_sub_f32 v78, v78, v163
v_sub_f32 v79, v79, v163
v_sub_f32 v112, v112, v163
v_sub_f32 v113, v113, v163
v_sub_f32 v114, v114, v163
v_sub_f32 v115, v115, v163
v_sub_f32 v116, v116, v163
v_sub_f32 v117, v117, v163
v_sub_f32 v118, v118, v163
v_sub_f32 v119, v119, v163
v_sub_f32 v120, v120, v163
v_sub_f32 v121, v121, v163
v_sub_f32 v122, v122, v163
v_sub_f32 v123, v123, v163
v_sub_f32 v124, v124, v163
v_sub_f32 v125, v125, v163
v_sub_f32 v126, v126, v163
v_sub_f32 v127, v127, v163
v_mul_f32 v161, v161, v164
v_accvgpr_read_b32 v24, a64
v_accvgpr_read_b32 v25, a65
v_accvgpr_read_b32 v26, a66
v_accvgpr_read_b32 v27, a67
v_mul_f32 v24, v24, v164
v_mul_f32 v25, v25, v164
v_mul_f32 v26, v26, v164
v_mul_f32 v27, v27, v164
v_accvgpr_write_b32 a64, v24
v_accvgpr_write_b32 a65, v25
v_accvgpr_write_b32 a66, v26
v_accvgpr_write_b32 a67, v27
v_accvgpr_read_b32 v24, a68
v_accvgpr_read_b32 v25, a69
v_accvgpr_read_b32 v26, a70
v_accvgpr_read_b32 v27, a71
v_mul_f32 v24, v24, v164
v_mul_f32 v25, v25, v164
v_mul_f32 v26, v26, v164
v_mul_f32 v27, v27, v164
v_accvgpr_write_b32 a68, v24
v_accvgpr_write_b32 a69, v25
v_accvgpr_write_b32 a70, v26
v_accvgpr_write_b32 a71, v27
v_accvgpr_read_b32 v24, a72
v_accvgpr_read_b32 v25, a73
v_accvgpr_read_b32 v26, a74
v_accvgpr_read_b32 v27, a75
v_mul_f32 v24, v24, v164
v_mul_f32 v25, v25, v164
v_mul_f32 v26, v26, v164
v_mul_f32 v27, v27, v164
v_accvgpr_write_b32 a72, v24
v_accvgpr_write_b32 a73, v25
v_accvgpr_write_b32 a74, v26
v_accvgpr_write_b32 a75, v27
v_accvgpr_read_b32 v24, a76
v_accvgpr_read_b32 v25, a77
v_accvgpr_read_b32 v26, a78
v_accvgpr_read_b32 v27, a79
v_mul_f32 v24, v24, v164
v_mul_f32 v25, v25, v164
v_mul_f32 v26, v26, v164
v_mul_f32 v27, v27, v164
v_accvgpr_write_b32 a76, v24
v_accvgpr_write_b32 a77, v25
v_accvgpr_write_b32 a78, v26
v_accvgpr_write_b32 a79, v27
v_accvgpr_read_b32 v24, a80
v_accvgpr_read_b32 v25, a81
v_accvgpr_read_b32 v26, a82
v_accvgpr_read_b32 v27, a83
v_mul_f32 v24, v24, v164
v_mul_f32 v25, v25, v164
v_mul_f32 v26, v26, v164
v_mul_f32 v27, v27, v164
v_accvgpr_write_b32 a80, v24
v_accvgpr_write_b32 a81, v25
v_accvgpr_write_b32 a82, v26
v_accvgpr_write_b32 a83, v27
v_accvgpr_read_b32 v24, a84
v_accvgpr_read_b32 v25, a85
v_accvgpr_read_b32 v26, a86
v_accvgpr_read_b32 v27, a87
v_mul_f32 v24, v24, v164
v_mul_f32 v25, v25, v164
v_mul_f32 v26, v26, v164
v_mul_f32 v27, v27, v164
v_accvgpr_write_b32 a84, v24
v_accvgpr_write_b32 a85, v25
v_accvgpr_write_b32 a86, v26
v_accvgpr_write_b32 a87, v27
v_accvgpr_read_b32 v24, a88
v_accvgpr_read_b32 v25, a89
v_accvgpr_read_b32 v26, a90
v_accvgpr_read_b32 v27, a91
v_mul_f32 v24, v24, v164
v_mul_f32 v25, v25, v164
v_mul_f32 v26, v26, v164
v_mul_f32 v27, v27, v164
v_accvgpr_write_b32 a88, v24
v_accvgpr_write_b32 a89, v25
v_accvgpr_write_b32 a90, v26
v_accvgpr_write_b32 a91, v27
v_accvgpr_read_b32 v24, a92
v_accvgpr_read_b32 v25, a93
v_accvgpr_read_b32 v26, a94
v_accvgpr_read_b32 v27, a95
v_mul_f32 v24, v24, v164
v_mul_f32 v25, v25, v164
v_mul_f32 v26, v26, v164
v_mul_f32 v27, v27, v164
v_accvgpr_write_b32 a92, v24
v_accvgpr_write_b32 a93, v25
v_accvgpr_write_b32 a94, v26
v_accvgpr_write_b32 a95, v27
v_accvgpr_read_b32 v24, a96
v_accvgpr_read_b32 v25, a97
v_accvgpr_read_b32 v26, a98
v_accvgpr_read_b32 v27, a99
v_mul_f32 v24, v24, v164
v_mul_f32 v25, v25, v164
v_mul_f32 v26, v26, v164
v_mul_f32 v27, v27, v164
v_accvgpr_write_b32 a96, v24
v_accvgpr_write_b32 a97, v25
v_accvgpr_write_b32 a98, v26
v_accvgpr_write_b32 a99, v27
v_accvgpr_read_b32 v24, a100
v_accvgpr_read_b32 v25, a101
v_accvgpr_read_b32 v26, a102
v_accvgpr_read_b32 v27, a103
v_mul_f32 v24, v24, v164
v_mul_f32 v25, v25, v164
v_mul_f32 v26, v26, v164
v_mul_f32 v27, v27, v164
v_accvgpr_write_b32 a100, v24
v_accvgpr_write_b32 a101, v25
v_accvgpr_write_b32 a102, v26
v_accvgpr_write_b32 a103, v27
v_accvgpr_read_b32 v24, a104
v_accvgpr_read_b32 v25, a105
v_accvgpr_read_b32 v26, a106
v_accvgpr_read_b32 v27, a107
v_mul_f32 v24, v24, v164
v_mul_f32 v25, v25, v164
v_mul_f32 v26, v26, v164
v_mul_f32 v27, v27, v164
v_accvgpr_write_b32 a104, v24
v_accvgpr_write_b32 a105, v25
v_accvgpr_write_b32 a106, v26
v_accvgpr_write_b32 a107, v27
v_accvgpr_read_b32 v24, a108
v_accvgpr_read_b32 v25, a109
v_accvgpr_read_b32 v26, a110
v_accvgpr_read_b32 v27, a111
v_mul_f32 v24, v24, v164
v_mul_f32 v25, v25, v164
v_mul_f32 v26, v26, v164
v_mul_f32 v27, v27, v164
v_accvgpr_write_b32 a108, v24
v_accvgpr_write_b32 a109, v25
v_accvgpr_write_b32 a110, v26
v_accvgpr_write_b32 a111, v27
v_accvgpr_read_b32 v24, a112
v_accvgpr_read_b32 v25, a113
v_accvgpr_read_b32 v26, a114
v_accvgpr_read_b32 v27, a115
v_mul_f32 v24, v24, v164
v_mul_f32 v25, v25, v164
v_mul_f32 v26, v26, v164
v_mul_f32 v27, v27, v164
v_accvgpr_write_b32 a112, v24
v_accvgpr_write_b32 a113, v25
v_accvgpr_write_b32 a114, v26
v_accvgpr_write_b32 a115, v27
v_accvgpr_read_b32 v24, a116
v_accvgpr_read_b32 v25, a117
v_accvgpr_read_b32 v26, a118
v_accvgpr_read_b32 v27, a119
v_mul_f32 v24, v24, v164
v_mul_f32 v25, v25, v164
v_mul_f32 v26, v26, v164
v_mul_f32 v27, v27, v164
v_accvgpr_write_b32 a116, v24
v_accvgpr_write_b32 a117, v25
v_accvgpr_write_b32 a118, v26
v_accvgpr_write_b32 a119, v27
v_accvgpr_read_b32 v24, a120
v_accvgpr_read_b32 v25, a121
v_accvgpr_read_b32 v26, a122
v_accvgpr_read_b32 v27, a123
v_mul_f32 v24, v24, v164
v_mul_f32 v25, v25, v164
v_mul_f32 v26, v26, v164
v_mul_f32 v27, v27, v164
v_accvgpr_write_b32 a120, v24
v_accvgpr_write_b32 a121, v25
v_accvgpr_write_b32 a122, v26
v_accvgpr_write_b32 a123, v27
v_accvgpr_read_b32 v24, a124
v_accvgpr_read_b32 v25, a125
v_accvgpr_read_b32 v26, a126
v_accvgpr_read_b32 v27, a127
v_mul_f32 v24, v24, v164
v_mul_f32 v25, v25, v164
v_mul_f32 v26, v26, v164
v_mul_f32 v27, v27, v164
v_accvgpr_write_b32 a124, v24
v_accvgpr_write_b32 a125, v25
v_accvgpr_write_b32 a126, v26
v_accvgpr_write_b32 a127, v27
v_exp_f32 v128, v64
v_exp_f32 v129, v65
v_exp_f32 v130, v66
v_exp_f32 v131, v67
v_exp_f32 v132, v68
v_exp_f32 v133, v69
v_exp_f32 v134, v70
v_exp_f32 v135, v71
v_exp_f32 v136, v72
v_exp_f32 v137, v73
v_exp_f32 v138, v74
v_exp_f32 v139, v75
v_exp_f32 v140, v76
v_exp_f32 v141, v77
v_exp_f32 v142, v78
v_exp_f32 v143, v79
s_nop 0
v_add_f32 v162, v128, v129
v_add_f32 v162, v162, v130
v_add_f32 v162, v162, v131
v_add_f32 v162, v162, v132
v_add_f32 v162, v162, v133
v_add_f32 v162, v162, v134
v_add_f32 v162, v162, v135
v_add_f32 v162, v162, v136
v_add_f32 v162, v162, v137
v_add_f32 v162, v162, v138
v_add_f32 v162, v162, v139
v_add_f32 v162, v162, v140
v_add_f32 v162, v162, v141
v_add_f32 v162, v162, v142
v_add_f32 v162, v162, v143
v_cvt_pk_bf16_f32 v144, v128, v129
v_cvt_pk_bf16_f32 v145, v130, v131
v_cvt_pk_bf16_f32 v146, v132, v133
v_cvt_pk_bf16_f32 v147, v134, v135
v_cvt_pk_bf16_f32 v148, v136, v137
v_cvt_pk_bf16_f32 v149, v138, v139
v_cvt_pk_bf16_f32 v150, v140, v141
v_cvt_pk_bf16_f32 v151, v142, v143
s_nop 1
s_branch k12_kernel_bk_t
s_endpgm

.fill 192, 4, 0xbf800000
.globl k3_kernel
.p2align 8
.type k3_kernel,@function
k3_kernel:
tf_p0:
s_cbranch_execz k12_kernel_end
s_cmp_ge_u32 s2, 256
s_cbranch_scc1 k3_kernel_end
s_load_dwordx2 s[40:41], s[0:1], 40
s_load_dwordx2 s[48:49], s[0:1], 96
s_load_dwordx2 s[42:43], s[0:1], 0
s_load_dwordx4 s[44:47], s[0:1], 56
v_and_b32 v1, 63, v0
v_lshrrev_b32 v3, 6, v0
s_and_b32 s50, s2, 7
s_lshr_b32 s51, s2, 3
v_readfirstlane_b32 s24, v3
s_mul_i32 s25, s50, 30
s_add_u32 s25, s25, s51
s_cmp_ge_u32 s51, 30
s_cbranch_scc1 k3_kernel_spare1
s_cmp_ge_u32 s25, 234
s_cbranch_scc1 k3_kernel_spare2
s_mul_i32 s26, s25, 7282
s_lshr_b32 s26, s26, 16
s_mul_i32 s50, s26, 9
s_sub_u32 s27, s25, s50
v_lshlrev_b32 v2, 4, v1
v_lshrrev_b32 v12, 3, v1
v_mul_u32_u24 v13, 1152, v12
v_bfe_u32 v14, v1, 1, 2
v_bfe_u32 v15, v1, 4, 2
v_xor_b32 v14, v14, v15
v_lshl_add_u32 v13, v14, 5, v13
v_and_b32 v14, 1, v1
v_lshl_add_u32 v13, v14, 4, v13
v_add_u32 v4, 0, v13
v_add_u32 v5, 8192, v13
v_add_u32 v6, 16384, v13
v_add_u32 v7, 24576, v13
s_lshl_b32 s28, s27, 7
s_mul_i32 s29, s26, 5120
s_mul_i32 s30, s24, 16384
s_mul_i32 s50, s24, 1179648
s_mul_i32 s51, s24, 4194304
s_add_u32 s51, s51, 37748736
v_add_u32 v3, 4096, v2
s_waitcnt lgkmcnt(0)
s_add_u32 s4, s40, s50
s_addc_u32 s5, s41, 0
s_mov_b32 s6, 1179648
s_mov_b32 s7, 0x20000
s_add_u32 s8, s48, s51
s_addc_u32 s9, s49, 0
s_mov_b32 s10, 4194304
s_mov_b32 s11, 0x20000
s_add_u32 m0, s30, 0
s_nop 0
buffer_load_dwordx4 v4, s[4:7], s28 offen offset:0 lds
buffer_load_dwordx4 v5, s[4:7], s28 offen offset:1024 lds
buffer_load_dwordx4 v6, s[4:7], s28 offen offset:2048 lds
buffer_load_dwordx4 v7, s[4:7], s28 offen offset:3072 lds
s_add_u32 s28, s28, 36864
buffer_load_dwordx4 a[0:3], v2, s[8:11], s29 offen offset:0
buffer_load_dwordx4 a[4:7], v2, s[8:11], s29 offen offset:1024
buffer_load_dwordx4 a[8:11], v2, s[8:11], s29 offen offset:2048
buffer_load_dwordx4 a[12:15], v2, s[8:11], s29 offen offset:3072
buffer_load_dwordx4 a[16:19], v3, s[8:11], s29 offen
s_add_u32 s29, s29, 131072
s_add_u32 m0, s30, 4096
s_nop 0
buffer_load_dwordx4 v4, s[4:7], s28 offen offset:0 lds
buffer_load_dwordx4 v5, s[4:7], s28 offen offset:1024 lds
buffer_load_dwordx4 v6, s[4:7], s28 offen offset:2048 lds
buffer_load_dwordx4 v7, s[4:7], s28 offen offset:3072 lds
s_add_u32 s28, s28, 36864
s_mov_b32 s3, s24
s_mov_b32 s98, 1
s_mov_b64 exec, 0
tp1_ret:
s_cmp_eq_u32 s98, 0
s_cbranch_scc1 tp1_done
s_sub_u32 s98, s98, 1
s_mov_b32 s99, s3
s_add_u32 s3, s3, 4
s_cmp_ge_u32 s3, 4
s_cselect_b32 s3, s24, s3
s_cmp_eq_u32 s99, 0
s_cbranch_scc1 tp1_p0
s_cmp_eq_u32 s99, 1
s_cbranch_scc1 tp1_p1
s_cmp_eq_u32 s99, 2
s_cbranch_scc1 tp1_p2
s_branch tp1_ret
tp1_done:
s_mov_b64 exec, -1
v_bfe_u32 v12, v1, 2, 2
v_bfe_u32 v13, v1, 4, 1
v_lshrrev_b32 v14, 5, v1
v_lshl_add_u32 v15, v13, 2, v12
v_lshl_add_u32 v15, v14, 4, v15
v_lshlrev_b32 v15, 7, v15
v_and_b32 v16, 3, v1
v_lshl_add_u32 v15, v16, 3, v15
v_add_u32 v15, s30, v15
v_lshrrev_b32 v12, 1, v12
v_lshl_add_u32 v12, v13, 1, v12
s_add_u32 s50, s24, 0
s_and_b32 s50, s50, 3
v_xor_b32 v16, s50, v12
v_lshl_add_u32 v8, v16, 5, v15
s_add_u32 s50, s24, 1
s_and_b32 s50, s50, 3
v_xor_b32 v16, s50, v12
v_lshl_add_u32 v9, v16, 5, v15
s_add_u32 s50, s24, 2
s_and_b32 s50, s50, 3
v_xor_b32 v16, s50, v12
v_lshl_add_u32 v10, v16, 5, v15
s_add_u32 s50, s24, 3
s_and_b32 s50, s50, 3
v_xor_b32 v16, s50, v12
v_lshl_add_u32 v11, v16, 5, v15
buffer_load_dwordx4 a[20:23], v2, s[8:11], s29 offen offset:0
buffer_load_dwordx4 a[24:27], v2, s[8:11], s29 offen offset:1024
buffer_load_dwordx4 a[28:31], v2, s[8:11], s29 offen offset:2048
buffer_load_dwordx4 a[32:35], v2, s[8:11], s29 offen offset:3072
buffer_load_dwordx4 a[36:39], v3, s[8:11], s29 offen
s_add_u32 s29, s29, 131072
s_add_u32 m0, s30, 8192
s_nop 0
buffer_load_dwordx4 v4, s[4:7], s28 offen offset:0 lds
buffer_load_dwordx4 v5, s[4:7], s28 offen offset:1024 lds
buffer_load_dwordx4 v6, s[4:7], s28 offen offset:2048 lds
buffer_load_dwordx4 v7, s[4:7], s28 offen offset:3072 lds
s_add_u32 s28, s28, 36864
v_add_u32 v48, s30, v2
s_sub_u32 s50, s24, 1
s_and_b32 s50, s50, 3
s_mul_i32 s50, s50, 16384
s_add_u32 s50, s50, 0
v_add_u32 v49, s50, v2
s_sub_u32 s50, s24, 2
s_and_b32 s50, s50, 3
s_mul_i32 s50, s50, 16384
s_add_u32 s50, s50, 5120
v_add_u32 v50, s50, v2
s_sub_u32 s50, s24, 3
s_and_b32 s50, s50, 3
s_mul_i32 s50, s50, 16384
s_add_u32 s50, s50, 10240
v_add_u32 v51, s50, v2
v_and_b32 v12, 15, v1
v_lshrrev_b32 v13, 4, v1
s_mul_i32 s50, s26, 80
v_add_u32 v14, s50, v12
v_mul_u32_u24 v15, 1152, v14
s_lshl_b32 s51, s27, 7
s_lshl_b32 s52, s24, 5
s_add_u32 s51, s51, s52
v_lshl_add_u32 v15, v13, 3, v15
v_add_u32 v15, s51, v15
v_and_b32 v16, 1, v13
v_lshlrev_b32 v16, 8, v16
buffer_load_dwordx4 a[40:43], v2, s[8:11], s29 offen offset:0
buffer_load_dwordx4 a[44:47], v2, s[8:11], s29 offen offset:1024
buffer_load_dwordx4 a[48:51], v2, s[8:11], s29 offen offset:2048
buffer_load_dwordx4 a[52:55], v2, s[8:11], s29 offen offset:3072
buffer_load_dwordx4 a[56:59], v3, s[8:11], s29 offen
s_add_u32 s29, s29, 131072
s_add_u32 m0, s30, 12288
s_nop 0
buffer_load_dwordx4 v4, s[4:7], s28 offen offset:0 lds
buffer_load_dwordx4 v5, s[4:7], s28 offen offset:1024 lds
buffer_load_dwordx4 v6, s[4:7], s28 offen offset:2048 lds
buffer_load_dwordx4 v7, s[4:7], s28 offen offset:3072 lds
s_add_u32 s28, s28, 36864
v_lshl_add_u32 v16, v12, 4, v16
v_lshrrev_b32 v17, 1, v13
v_lshl_add_u32 v16, v17, 3, v16
s_lshl_b32 s51, s27, 1
s_lshr_b32 s52, s24, 1
s_add_u32 s51, s51, s52
s_lshl_b32 s51, s51, 17
s_and_b32 s52, s24, 1
s_lshl_b32 s52, s52, 9
s_add_u32 s51, s51, s52
s_mul_i32 s52, s26, 5120
s_add_u32 s51, s51, s52
v_add_u32 v16, s51, v16
v_mov_b32 v52, v15
v_mov_b32 v47, v16
v_mov_b32 v54, v14
s_mov_b32 s12, s42
s_mov_b32 s13, s43
s_mov_b32 s14, 2359296
s_mov_b32 s15, 0x20000
s_add_u32 s16, s48, 54525952
s_addc_u32 s17, s49, 0
s_mov_b32 s18, 2359296
s_mov_b32 s19, 0x20000
s_add_u32 s20, s48, 57671680
s_addc_u32 s21, s49, 0
s_mov_b32 s22, 589824
s_mov_b32 s23, 0x20000
s_waitcnt vmcnt(27)
ds_read_b64_tr_b16 v[208:209], v8 offset:0
ds_read_b64_tr_b16 v[210:211], v8 offset:1024
ds_read_b64_tr_b16 v[212:213], v9 offset:0
ds_read_b64_tr_b16 v[214:215], v9 offset:1024
ds_read_b64_tr_b16 v[216:217], v10 offset:0
ds_read_b64_tr_b16 v[218:219], v10 offset:1024
ds_read_b64_tr_b16 v[220:221], v11 offset:0
ds_read_b64_tr_b16 v[222:223], v11 offset:1024
s_waitcnt lgkmcnt(0)
s_waitcnt vmcnt(18)
v_mfma_f32_16x16x32_bf16 v[64:67], v[208:211], a[0:3], 0
ds_read_b64_tr_b16 v[224:225], v8 offset:4096
s_add_u32 m0, s30, 0
v_mfma_f32_16x16x32_bf16 v[84:87], v[212:215], a[0:3], 0
ds_read_b64_tr_b16 v[226:227], v8 offset:5120
v_mfma_f32_16x16x32_bf16 v[104:107], v[216:219], a[0:3], 0
ds_read_b64_tr_b16 v[228:229], v9 offset:4096
v_mfma_f32_16x16x32_bf16 v[124:127], v[220:223], a[0:3], 0
ds_read_b64_tr_b16 v[230:231], v9 offset:5120
v_mfma_f32_16x16x32_bf16 v[68:71], v[208:211], a[4:7], 0
ds_read_b64_tr_b16 v[232:233], v10 offset:4096
v_mfma_f32_16x16x32_bf16 v[88:91], v[212:215], a[4:7], 0
ds_read_b64_tr_b16 v[234:235], v10 offset:5120
v_mfma_f32_16x16x32_bf16 v[108:111], v[216:219], a[4:7], 0
ds_read_b64_tr_b16 v[236:237], v11 offset:4096
v_mfma_f32_16x16x32_bf16 v[128:131], v[220:223], a[4:7], 0
ds_read_b64_tr_b16 v[238:239], v11 offset:5120
v_mfma_f32_16x16x32_bf16 v[72:75], v[208:211], a[8:11], 0
buffer_load_dwordx4 v4, s[4:7], s28 offen offset:0 lds
v_mfma_f32_16x16x32_bf16 v[92:95], v[212:215], a[8:11], 0
buffer_load_dwordx4 v5, s[4:7], s28 offen offset:1024 lds
v_mfma_f32_16x16x32_bf16 v[112:115], v[216:219], a[8:11], 0
buffer_load_dwordx4 v6, s[4:7], s28 offen offset:2048 lds
v_mfma_f32_16x16x32_bf16 v[132:135], v[220:223], a[8:11], 0
buffer_load_dwordx4 v7, s[4:7], s28 offen offset:3072 lds
v_mfma_f32_16x16x32_bf16 v[76:79], v[208:211], a[12:15], 0
s_add_u32 s28, s28, 36864
v_mfma_f32_16x16x32_bf16 v[96:99], v[212:215], a[12:15], 0
buffer_load_dwordx4 a[60:63], v2, s[8:11], s29 offen offset:0
v_mfma_f32_16x16x32_bf16 v[116:119], v[216:219], a[12:15], 0
buffer_load_dwordx4 a[64:67], v2, s[8:11], s29 offen offset:1024
v_mfma_f32_16x16x32_bf16 v[136:139], v[220:223], a[12:15], 0
buffer_load_dwordx4 a[68:71], v2, s[8:11], s29 offen offset:2048
v_mfma_f32_16x16x32_bf16 v[80:83], v[208:211], a[16:19], 0
buffer_load_dwordx4 a[72:75], v2, s[8:11], s29 offen offset:3072
v_mfma_f32_16x16x32_bf16 v[100:103], v[212:215], a[16:19], 0
buffer_load_dwordx4 a[76:79], v3, s[8:11], s29 offen
v_mfma_f32_16x16x32_bf16 v[120:123], v[216:219], a[16:19], 0
s_add_u32 s29, s29, 131072
v_mfma_f32_16x16x32_bf16 v[140:143], v[220:223], a[16:19], 0
s_waitcnt lgkmcnt(0)
s_waitcnt vmcnt(18)
v_mfma_f32_16x16x32_bf16 v[64:67], v[224:227], a[20:23], v[64:67]
ds_read_b64_tr_b16 v[208:209], v8 offset:8192
s_add_u32 m0, s30, 4096
v_mfma_f32_16x16x32_bf16 v[84:87], v[228:231], a[20:23], v[84:87]
ds_read_b64_tr_b16 v[210:211], v8 offset:9216
v_mfma_f32_16x16x32_bf16 v[104:107], v[232:235], a[20:23], v[104:107]
ds_read_b64_tr_b16 v[212:213], v9 offset:8192
v_mfma_f32_16x16x32_bf16 v[124:127], v[236:239], a[20:23], v[124:127]
ds_read_b64_tr_b16 v[214:215], v9 offset:9216
v_mfma_f32_16x16x32_bf16 v[68:71], v[224:227], a[24:27], v[68:71]
ds_read_b64_tr_b16 v[216:217], v10 offset:8192
v_mfma_f32_16x16x32_bf16 v[88:91], v[228:231], a[24:27], v[88:91]
ds_read_b64_tr_b16 v[218:219], v10 offset:9216
v_mfma_f32_16x16x32_bf16 v[108:111], v[232:235], a[24:27], v[108:111]
ds_read_b64_tr_b16 v[220:221], v11 offset:8192
v_mfma_f32_16x16x32_bf16 v[128:131], v[236:239], a[24:27], v[128:131]
ds_read_b64_tr_b16 v[222:223], v11 offset:9216
v_mfma_f32_16x16x32_bf16 v[72:75], v[224:227], a[28:31], v[72:75]
buffer_load_dwordx4 v4, s[4:7], s28 offen offset:0 lds
v_mfma_f32_16x16x32_bf16 v[92:95], v[228:231], a[28:31], v[92:95]
buffer_load_dwordx4 v5, s[4:7], s28 offen offset:1024 lds
v_mfma_f32_16x16x32_bf16 v[112:115], v[232:235], a[28:31], v[112:115]
buffer_load_dwordx4 v6, s[4:7], s28 offen offset:2048 lds
v_mfma_f32_16x16x32_bf16 v[132:135], v[236:239], a[28:31], v[132:135]
buffer_load_dwordx4 v7, s[4:7], s28 offen offset:3072 lds
v_mfma_f32_16x16x32_bf16 v[76:79], v[224:227], a[32:35], v[76:79]
s_add_u32 s28, s28, 36864
v_mfma_f32_16x16x32_bf16 v[96:99], v[228:231], a[32:35], v[96:99]
buffer_load_dwordx4 a[0:3], v2, s[8:11], s29 offen offset:0
v_mfma_f32_16x16x32_bf16 v[116:119], v[232:235], a[32:35], v[116:119]
buffer_load_dwordx4 a[4:7], v2, s[8:11], s29 offen offset:1024
v_mfma_f32_16x16x32_bf16 v[136:139], v[236:239], a[32:35], v[136:139]
buffer_load_dwordx4 a[8:11], v2, s[8:11], s29 offen offset:2048
v_mfma_f32_16x16x32_bf16 v[80:83], v[224:227], a[36:39], v[80:83]
buffer_load_dwordx4 a[12:15], v2, s[8:11], s29 offen offset:3072
v_mfma_f32_16x16x32_bf16 v[100:103], v[228:231], a[36:39], v[100:103]
buffer_load_dwordx4 a[16:19], v3, s[8:11], s29 offen
v_mfma_f32_16x16x32_bf16 v[120:123], v[232:235], a[36:39], v[120:123]
s_add_u32 s29, s29, 131072
v_mfma_f32_16x16x32_bf16 v[140:143], v[236:239], a[36:39], v[140:143]
s_waitcnt lgkmcnt(0)
s_waitcnt vmcnt(18)
v_mfma_f32_16x16x32_bf16 v[64:67], v[208:211], a[40:43], v[64:67]
ds_read_b64_tr_b16 v[224:225], v8 offset:12288
s_add_u32 m0, s30, 8192
v_mfma_f32_16x16x32_bf16 v[84:87], v[212:215], a[40:43], v[84:87]
ds_read_b64_tr_b16 v[226:227], v8 offset:13312
v_mfma_f32_16x16x32_bf16 v[104:107], v[216:219], a[40:43], v[104:107]
ds_read_b64_tr_b16 v[228:229], v9 offset:12288
v_mfma_f32_16x16x32_bf16 v[124:127], v[220:223], a[40:43], v[124:127]
ds_read_b64_tr_b16 v[230:231], v9 offset:13312
v_mfma_f32_16x16x32_bf16 v[68:71], v[208:211], a[44:47], v[68:71]
ds_read_b64_tr_b16 v[232:233], v10 offset:12288
v_mfma_f32_16x16x32_bf16 v[88:91], v[212:215], a[44:47], v[88:91]
ds_read_b64_tr_b16 v[234:235], v10 offset:13312
v_mfma_f32_16x16x32_bf16 v[108:111], v[216:219], a[44:47], v[108:111]
ds_read_b64_tr_b16 v[236:237], v11 offset:12288
v_mfma_f32_16x16x32_bf16 v[128:131], v[220:223], a[44:47], v[128:131]
ds_read_b64_tr_b16 v[238:239], v11 offset:13312
v_mfma_f32_16x16x32_bf16 v[72:75], v[208:211], a[48:51], v[72:75]
buffer_load_dwordx4 v4, s[4:7], s28 offen offset:0 lds
v_mfma_f32_16x16x32_bf16 v[92:95], v[212:215], a[48:51], v[92:95]
buffer_load_dwordx4 v5, s[4:7], s28 offen offset:1024 lds
v_mfma_f32_16x16x32_bf16 v[112:115], v[216:219], a[48:51], v[112:115]
buffer_load_dwordx4 v6, s[4:7], s28 offen offset:2048 lds
v_mfma_f32_16x16x32_bf16 v[132:135], v[220:223], a[48:51], v[132:135]
buffer_load_dwordx4 v7, s[4:7], s28 offen offset:3072 lds
v_mfma_f32_16x16x32_bf16 v[76:79], v[208:211], a[52:55], v[76:79]
s_add_u32 s28, s28, 36864
v_mfma_f32_16x16x32_bf16 v[96:99], v[212:215], a[52:55], v[96:99]
buffer_load_dwordx4 a[20:23], v2, s[8:11], s29 offen offset:0
v_mfma_f32_16x16x32_bf16 v[116:119], v[216:219], a[52:55], v[116:119]
buffer_load_dwordx4 a[24:27], v2, s[8:11], s29 offen offset:1024
v_mfma_f32_16x16x32_bf16 v[136:139], v[220:223], a[52:55], v[136:139]
buffer_load_dwordx4 a[28:31], v2, s[8:11], s29 offen offset:2048
v_mfma_f32_16x16x32_bf16 v[80:83], v[208:211], a[56:59], v[80:83]
buffer_load_dwordx4 a[32:35], v2, s[8:11], s29 offen offset:3072
v_mfma_f32_16x16x32_bf16 v[100:103], v[212:215], a[56:59], v[100:103]
buffer_load_dwordx4 a[36:39], v3, s[8:11], s29 offen
v_mfma_f32_16x16x32_bf16 v[120:123], v[216:219], a[56:59], v[120:123]
s_add_u32 s29, s29, 131072
v_mfma_f32_16x16x32_bf16 v[140:143], v[220:223], a[56:59], v[140:143]
s_waitcnt lgkmcnt(0)
s_waitcnt vmcnt(18)
v_mfma_f32_16x16x32_bf16 v[64:67], v[224:227], a[60:63], v[64:67]
ds_read_b64_tr_b16 v[208:209], v8 offset:0
s_add_u32 m0, s30, 12288
v_mfma_f32_16x16x32_bf16 v[84:87], v[228:231], a[60:63], v[84:87]
ds_read_b64_tr_b16 v[210:211], v8 offset:1024
v_mfma_f32_16x16x32_bf16 v[104:107], v[232:235], a[60:63], v[104:107]
ds_read_b64_tr_b16 v[212:213], v9 offset:0
v_mfma_f32_16x16x32_bf16 v[124:127], v[236:239], a[60:63], v[124:127]
ds_read_b64_tr_b16 v[214:215], v9 offset:1024
v_mfma_f32_16x16x32_bf16 v[68:71], v[224:227], a[64:67], v[68:71]
ds_read_b64_tr_b16 v[216:217], v10 offset:0
v_mfma_f32_16x16x32_bf16 v[88:91], v[228:231], a[64:67], v[88:91]
ds_read_b64_tr_b16 v[218:219], v10 offset:1024
v_mfma_f32_16x16x32_bf16 v[108:111], v[232:235], a[64:67], v[108:111]
ds_read_b64_tr_b16 v[220:221], v11 offset:0
v_mfma_f32_16x16x32_bf16 v[128:131], v[236:239], a[64:67], v[128:131]
ds_read_b64_tr_b16 v[222:223], v11 offset:1024
v_mfma_f32_16x16x32_bf16 v[72:75], v[224:227], a[68:71], v[72:75]
buffer_load_dwordx4 v4, s[4:7], s28 offen offset:0 lds
v_mfma_f32_16x16x32_bf16 v[92:95], v[228:231], a[68:71], v[92:95]
buffer_load_dwordx4 v5, s[4:7], s28 offen offset:1024 lds
v_mfma_f32_16x16x32_bf16 v[112:115], v[232:235], a[68:71], v[112:115]
buffer_load_dwordx4 v6, s[4:7], s28 offen offset:2048 lds
v_mfma_f32_16x16x32_bf16 v[132:135], v[236:239], a[68:71], v[132:135]
buffer_load_dwordx4 v7, s[4:7], s28 offen offset:3072 lds
v_mfma_f32_16x16x32_bf16 v[76:79], v[224:227], a[72:75], v[76:79]
s_add_u32 s28, s28, 36864
v_mfma_f32_16x16x32_bf16 v[96:99], v[228:231], a[72:75], v[96:99]
buffer_load_dwordx4 a[40:43], v2, s[8:11], s29 offen offset:0
v_mfma_f32_16x16x32_bf16 v[116:119], v[232:235], a[72:75], v[116:119]
buffer_load_dwordx4 a[44:47], v2, s[8:11], s29 offen offset:1024
v_mfma_f32_16x16x32_bf16 v[136:139], v[236:239], a[72:75], v[136:139]
buffer_load_dwordx4 a[48:51], v2, s[8:11], s29 offen offset:2048
v_mfma_f32_16x16x32_bf16 v[80:83], v[224:227], a[76:79], v[80:83]
buffer_load_dwordx4 a[52:55], v2, s[8:11], s29 offen offset:3072
v_mfma_f32_16x16x32_bf16 v[100:103], v[228:231], a[76:79], v[100:103]
buffer_load_dwordx4 a[56:59], v3, s[8:11], s29 offen
v_mfma_f32_16x16x32_bf16 v[120:123], v[232:235], a[76:79], v[120:123]
s_add_u32 s29, s29, 131072
v_mfma_f32_16x16x32_bf16 v[140:143], v[236:239], a[76:79], v[140:143]
s_waitcnt lgkmcnt(0)
s_waitcnt vmcnt(18)
v_mfma_f32_16x16x32_bf16 v[64:67], v[208:211], a[0:3], v[64:67]
ds_read_b64_tr_b16 v[224:225], v8 offset:4096
s_add_u32 m0, s30, 0
v_mfma_f32_16x16x32_bf16 v[84:87], v[212:215], a[0:3], v[84:87]
ds_read_b64_tr_b16 v[226:227], v8 offset:5120
v_mfma_f32_16x16x32_bf16 v[104:107], v[216:219], a[0:3], v[104:107]
ds_read_b64_tr_b16 v[228:229], v9 offset:4096
v_mfma_f32_16x16x32_bf16 v[124:127], v[220:223], a[0:3], v[124:127]
ds_read_b64_tr_b16 v[230:231], v9 offset:5120
v_mfma_f32_16x16x32_bf16 v[68:71], v[208:211], a[4:7], v[68:71]
ds_read_b64_tr_b16 v[232:233], v10 offset:4096
v_mfma_f32_16x16x32_bf16 v[88:91], v[212:215], a[4:7], v[88:91]
ds_read_b64_tr_b16 v[234:235], v10 offset:5120
v_mfma_f32_16x16x32_bf16 v[108:111], v[216:219], a[4:7], v[108:111]
ds_read_b64_tr_b16 v[236:237], v11 offset:4096
v_mfma_f32_16x16x32_bf16 v[128:131], v[220:223], a[4:7], v[128:131]
ds_read_b64_tr_b16 v[238:239], v11 offset:5120
v_mfma_f32_16x16x32_bf16 v[72:75], v[208:211], a[8:11], v[72:75]
buffer_load_dwordx4 v4, s[4:7], s28 offen offset:0 lds
v_mfma_f32_16x16x32_bf16 v[92:95], v[212:215], a[8:11], v[92:95]
buffer_load_dwordx4 v5, s[4:7], s28 offen offset:1024 lds
v_mfma_f32_16x16x32_bf16 v[112:115], v[216:219], a[8:11], v[112:115]
buffer_load_dwordx4 v6, s[4:7], s28 offen offset:2048 lds
v_mfma_f32_16x16x32_bf16 v[132:135], v[220:223], a[8:11], v[132:135]
buffer_load_dwordx4 v7, s[4:7], s28 offen offset:3072 lds
v_mfma_f32_16x16x32_bf16 v[76:79], v[208:211], a[12:15], v[76:79]
s_add_u32 s28, s28, 36864
v_mfma_f32_16x16x32_bf16 v[96:99], v[212:215], a[12:15], v[96:99]
buffer_load_dwordx4 a[60:63], v2, s[8:11], s29 offen offset:0
v_mfma_f32_16x16x32_bf16 v[116:119], v[216:219], a[12:15], v[116:119]
buffer_load_dwordx4 a[64:67], v2, s[8:11], s29 offen offset:1024
v_mfma_f32_16x16x32_bf16 v[136:139], v[220:223], a[12:15], v[136:139]
buffer_load_dwordx4 a[68:71], v2, s[8:11], s29 offen offset:2048
v_mfma_f32_16x16x32_bf16 v[80:83], v[208:211], a[16:19], v[80:83]
buffer_load_dwordx4 a[72:75], v2, s[8:11], s29 offen offset:3072
v_mfma_f32_16x16x32_bf16 v[100:103], v[212:215], a[16:19], v[100:103]
buffer_load_dwordx4 a[76:79], v3, s[8:11], s29 offen
v_mfma_f32_16x16x32_bf16 v[120:123], v[216:219], a[16:19], v[120:123]
s_add_u32 s29, s29, 131072
v_mfma_f32_16x16x32_bf16 v[140:143], v[220:223], a[16:19], v[140:143]
s_waitcnt lgkmcnt(0)
s_waitcnt vmcnt(18)
v_mfma_f32_16x16x32_bf16 v[64:67], v[224:227], a[20:23], v[64:67]
ds_read_b64_tr_b16 v[208:209], v8 offset:8192
s_add_u32 m0, s30, 4096
v_mfma_f32_16x16x32_bf16 v[84:87], v[228:231], a[20:23], v[84:87]
ds_read_b64_tr_b16 v[210:211], v8 offset:9216
v_mfma_f32_16x16x32_bf16 v[104:107], v[232:235], a[20:23], v[104:107]
ds_read_b64_tr_b16 v[212:213], v9 offset:8192
v_mfma_f32_16x16x32_bf16 v[124:127], v[236:239], a[20:23], v[124:127]
ds_read_b64_tr_b16 v[214:215], v9 offset:9216
v_mfma_f32_16x16x32_bf16 v[68:71], v[224:227], a[24:27], v[68:71]
ds_read_b64_tr_b16 v[216:217], v10 offset:8192
v_mfma_f32_16x16x32_bf16 v[88:91], v[228:231], a[24:27], v[88:91]
ds_read_b64_tr_b16 v[218:219], v10 offset:9216
v_mfma_f32_16x16x32_bf16 v[108:111], v[232:235], a[24:27], v[108:111]
ds_read_b64_tr_b16 v[220:221], v11 offset:8192
v_mfma_f32_16x16x32_bf16 v[128:131], v[236:239], a[24:27], v[128:131]
ds_read_b64_tr_b16 v[222:223], v11 offset:9216
v_mfma_f32_16x16x32_bf16 v[72:75], v[224:227], a[28:31], v[72:75]
buffer_load_dwordx4 v4, s[4:7], s28 offen offset:0 lds
v_mfma_f32_16x16x32_bf16 v[92:95], v[228:231], a[28:31], v[92:95]
buffer_load_dwordx4 v5, s[4:7], s28 offen offset:1024 lds
v_mfma_f32_16x16x32_bf16 v[112:115], v[232:235], a[28:31], v[112:115]
buffer_load_dwordx4 v6, s[4:7], s28 offen offset:2048 lds
v_mfma_f32_16x16x32_bf16 v[132:135], v[236:239], a[28:31], v[132:135]
buffer_load_dwordx4 v7, s[4:7], s28 offen offset:3072 lds
v_mfma_f32_16x16x32_bf16 v[76:79], v[224:227], a[32:35], v[76:79]
s_add_u32 s28, s28, 36864
v_mfma_f32_16x16x32_bf16 v[96:99], v[228:231], a[32:35], v[96:99]
buffer_load_dwordx4 a[0:3], v2, s[8:11], s29 offen offset:0
v_mfma_f32_16x16x32_bf16 v[116:119], v[232:235], a[32:35], v[116:119]
buffer_load_dwordx4 a[4:7], v2, s[8:11], s29 offen offset:1024
v_mfma_f32_16x16x32_bf16 v[136:139], v[236:239], a[32:35], v[136:139]
buffer_load_dwordx4 a[8:11], v2, s[8:11], s29 offen offset:2048
v_mfma_f32_16x16x32_bf16 v[80:83], v[224:227], a[36:39], v[80:83]
buffer_load_dwordx4 a[12:15], v2, s[8:11], s29 offen offset:3072
v_mfma_f32_16x16x32_bf16 v[100:103], v[228:231], a[36:39], v[100:103]
buffer_load_dwordx4 a[16:19], v3, s[8:11], s29 offen
v_mfma_f32_16x16x32_bf16 v[120:123], v[232:235], a[36:39], v[120:123]
s_add_u32 s29, s29, 131072
v_mfma_f32_16x16x32_bf16 v[140:143], v[236:239], a[36:39], v[140:143]
s_waitcnt lgkmcnt(0)
s_waitcnt vmcnt(18)
v_mfma_f32_16x16x32_bf16 v[64:67], v[208:211], a[40:43], v[64:67]
ds_read_b64_tr_b16 v[224:225], v8 offset:12288
s_add_u32 m0, s30, 8192
v_mfma_f32_16x16x32_bf16 v[84:87], v[212:215], a[40:43], v[84:87]
ds_read_b64_tr_b16 v[226:227], v8 offset:13312
v_mfma_f32_16x16x32_bf16 v[104:107], v[216:219], a[40:43], v[104:107]
ds_read_b64_tr_b16 v[228:229], v9 offset:12288
v_mfma_f32_16x16x32_bf16 v[124:127], v[220:223], a[40:43], v[124:127]
ds_read_b64_tr_b16 v[230:231], v9 offset:13312
v_mfma_f32_16x16x32_bf16 v[68:71], v[208:211], a[44:47], v[68:71]
ds_read_b64_tr_b16 v[232:233], v10 offset:12288
v_mfma_f32_16x16x32_bf16 v[88:91], v[212:215], a[44:47], v[88:91]
ds_read_b64_tr_b16 v[234:235], v10 offset:13312
v_mfma_f32_16x16x32_bf16 v[108:111], v[216:219], a[44:47], v[108:111]
ds_read_b64_tr_b16 v[236:237], v11 offset:12288
v_mfma_f32_16x16x32_bf16 v[128:131], v[220:223], a[44:47], v[128:131]
ds_read_b64_tr_b16 v[238:239], v11 offset:13312
v_mfma_f32_16x16x32_bf16 v[72:75], v[208:211], a[48:51], v[72:75]
buffer_load_dwordx4 v4, s[4:7], s28 offen offset:0 lds
v_mfma_f32_16x16x32_bf16 v[92:95], v[212:215], a[48:51], v[92:95]
buffer_load_dwordx4 v5, s[4:7], s28 offen offset:1024 lds
v_mfma_f32_16x16x32_bf16 v[112:115], v[216:219], a[48:51], v[112:115]
buffer_load_dwordx4 v6, s[4:7], s28 offen offset:2048 lds
v_mfma_f32_16x16x32_bf16 v[132:135], v[220:223], a[48:51], v[132:135]
buffer_load_dwordx4 v7, s[4:7], s28 offen offset:3072 lds
v_mfma_f32_16x16x32_bf16 v[76:79], v[208:211], a[52:55], v[76:79]
s_add_u32 s28, s28, 36864
v_mfma_f32_16x16x32_bf16 v[96:99], v[212:215], a[52:55], v[96:99]
buffer_load_dwordx4 a[20:23], v2, s[8:11], s29 offen offset:0
v_mfma_f32_16x16x32_bf16 v[116:119], v[216:219], a[52:55], v[116:119]
buffer_load_dwordx4 a[24:27], v2, s[8:11], s29 offen offset:1024
v_mfma_f32_16x16x32_bf16 v[136:139], v[220:223], a[52:55], v[136:139]
buffer_load_dwordx4 a[28:31], v2, s[8:11], s29 offen offset:2048
v_mfma_f32_16x16x32_bf16 v[80:83], v[208:211], a[56:59], v[80:83]
buffer_load_dwordx4 a[32:35], v2, s[8:11], s29 offen offset:3072
v_mfma_f32_16x16x32_bf16 v[100:103], v[212:215], a[56:59], v[100:103]
buffer_load_dwordx4 a[36:39], v3, s[8:11], s29 offen
v_mfma_f32_16x16x32_bf16 v[120:123], v[216:219], a[56:59], v[120:123]
s_add_u32 s29, s29, 131072
v_mfma_f32_16x16x32_bf16 v[140:143], v[220:223], a[56:59], v[140:143]
s_waitcnt lgkmcnt(0)
s_waitcnt vmcnt(18)
v_mfma_f32_16x16x32_bf16 v[64:67], v[224:227], a[60:63], v[64:67]
ds_read_b64_tr_b16 v[208:209], v8 offset:0
s_add_u32 m0, s30, 12288
v_mfma_f32_16x16x32_bf16 v[84:87], v[228:231], a[60:63], v[84:87]
ds_read_b64_tr_b16 v[210:211], v8 offset:1024
v_mfma_f32_16x16x32_bf16 v[104:107], v[232:235], a[60:63], v[104:107]
ds_read_b64_tr_b16 v[212:213], v9 offset:0
v_mfma_f32_16x16x32_bf16 v[124:127], v[236:239], a[60:63], v[124:127]
ds_read_b64_tr_b16 v[214:215], v9 offset:1024
v_mfma_f32_16x16x32_bf16 v[68:71], v[224:227], a[64:67], v[68:71]
ds_read_b64_tr_b16 v[216:217], v10 offset:0
v_mfma_f32_16x16x32_bf16 v[88:91], v[228:231], a[64:67], v[88:91]
ds_read_b64_tr_b16 v[218:219], v10 offset:1024
v_mfma_f32_16x16x32_bf16 v[108:111], v[232:235], a[64:67], v[108:111]
ds_read_b64_tr_b16 v[220:221], v11 offset:0
v_mfma_f32_16x16x32_bf16 v[128:131], v[236:239], a[64:67], v[128:131]
ds_read_b64_tr_b16 v[222:223], v11 offset:1024
v_mfma_f32_16x16x32_bf16 v[72:75], v[224:227], a[68:71], v[72:75]
buffer_load_dwordx4 v4, s[4:7], s28 offen offset:0 lds
v_mfma_f32_16x16x32_bf16 v[92:95], v[228:231], a[68:71], v[92:95]
buffer_load_dwordx4 v5, s[4:7], s28 offen offset:1024 lds
v_mfma_f32_16x16x32_bf16 v[112:115], v[232:235], a[68:71], v[112:115]
buffer_load_dwordx4 v6, s[4:7], s28 offen offset:2048 lds
v_mfma_f32_16x16x32_bf16 v[132:135], v[236:239], a[68:71], v[132:135]
buffer_load_dwordx4 v7, s[4:7], s28 offen offset:3072 lds
v_mfma_f32_16x16x32_bf16 v[76:79], v[224:227], a[72:75], v[76:79]
s_add_u32 s28, s28, 36864
v_mfma_f32_16x16x32_bf16 v[96:99], v[228:231], a[72:75], v[96:99]
buffer_load_dwordx4 a[40:43], v2, s[8:11], s29 offen offset:0
v_mfma_f32_16x16x32_bf16 v[116:119], v[232:235], a[72:75], v[116:119]
buffer_load_dwordx4 a[44:47], v2, s[8:11], s29 offen offset:1024
v_mfma_f32_16x16x32_bf16 v[136:139], v[236:239], a[72:75], v[136:139]
buffer_load_dwordx4 a[48:51], v2, s[8:11], s29 offen offset:2048
v_mfma_f32_16x16x32_bf16 v[80:83], v[224:227], a[76:79], v[80:83]
buffer_load_dwordx4 a[52:55], v2, s[8:11], s29 offen offset:3072
v_mfma_f32_16x16x32_bf16 v[100:103], v[228:231], a[76:79], v[100:103]
buffer_load_dwordx4 a[56:59], v3, s[8:11], s29 offen
v_mfma_f32_16x16x32_bf16 v[120:123], v[232:235], a[76:79], v[120:123]
s_add_u32 s29, s29, 131072
v_mfma_f32_16x16x32_bf16 v[140:143], v[236:239], a[76:79], v[140:143]
s_waitcnt lgkmcnt(0)
s_waitcnt vmcnt(18)
v_mfma_f32_16x16x32_bf16 v[64:67], v[208:211], a[0:3], v[64:67]
ds_read_b64_tr_b16 v[224:225], v8 offset:4096
s_add_u32 m0, s30, 0
v_mfma_f32_16x16x32_bf16 v[84:87], v[212:215], a[0:3], v[84:87]
ds_read_b64_tr_b16 v[226:227], v8 offset:5120
v_mfma_f32_16x16x32_bf16 v[104:107], v[216:219], a[0:3], v[104:107]
ds_read_b64_tr_b16 v[228:229], v9 offset:4096
v_mfma_f32_16x16x32_bf16 v[124:127], v[220:223], a[0:3], v[124:127]
ds_read_b64_tr_b16 v[230:231], v9 offset:5120
v_mfma_f32_16x16x32_bf16 v[68:71], v[208:211], a[4:7], v[68:71]
ds_read_b64_tr_b16 v[232:233], v10 offset:4096
v_mfma_f32_16x16x32_bf16 v[88:91], v[212:215], a[4:7], v[88:91]
ds_read_b64_tr_b16 v[234:235], v10 offset:5120
v_mfma_f32_16x16x32_bf16 v[108:111], v[216:219], a[4:7], v[108:111]
ds_read_b64_tr_b16 v[236:237], v11 offset:4096
v_mfma_f32_16x16x32_bf16 v[128:131], v[220:223], a[4:7], v[128:131]
ds_read_b64_tr_b16 v[238:239], v11 offset:5120
v_mfma_f32_16x16x32_bf16 v[72:75], v[208:211], a[8:11], v[72:75]
buffer_load_dwordx4 v4, s[4:7], s28 offen offset:0 lds
v_mfma_f32_16x16x32_bf16 v[92:95], v[212:215], a[8:11], v[92:95]
buffer_load_dwordx4 v5, s[4:7], s28 offen offset:1024 lds
v_mfma_f32_16x16x32_bf16 v[112:115], v[216:219], a[8:11], v[112:115]
buffer_load_dwordx4 v6, s[4:7], s28 offen offset:2048 lds
v_mfma_f32_16x16x32_bf16 v[132:135], v[220:223], a[8:11], v[132:135]
buffer_load_dwordx4 v7, s[4:7], s28 offen offset:3072 lds
v_mfma_f32_16x16x32_bf16 v[76:79], v[208:211], a[12:15], v[76:79]
s_add_u32 s28, s28, 36864
v_mfma_f32_16x16x32_bf16 v[96:99], v[212:215], a[12:15], v[96:99]
buffer_load_dwordx4 a[60:63], v2, s[8:11], s29 offen offset:0
v_mfma_f32_16x16x32_bf16 v[116:119], v[216:219], a[12:15], v[116:119]
buffer_load_dwordx4 a[64:67], v2, s[8:11], s29 offen offset:1024
v_mfma_f32_16x16x32_bf16 v[136:139], v[220:223], a[12:15], v[136:139]
buffer_load_dwordx4 a[68:71], v2, s[8:11], s29 offen offset:2048
tp1_p0:
s_cbranch_execz tp1_ret
v_mfma_f32_16x16x32_bf16 v[80:83], v[208:211], a[16:19], v[80:83]
tf_p1:
s_cbranch_execz k12_kernel_end
buffer_load_dwordx4 a[72:75], v2, s[8:11], s29 offen offset:3072
v_mfma_f32_16x16x32_bf16 v[100:103], v[212:215], a[16:19], v[100:103]
buffer_load_dwordx4 a[76:79], v3, s[8:11], s29 offen
v_mfma_f32_16x16x32_bf16 v[120:123], v[216:219], a[16:19], v[120:123]
s_add_u32 s29, s29, 131072
v_mfma_f32_16x16x32_bf16 v[140:143], v[220:223], a[16:19], v[140:143]
s_waitcnt lgkmcnt(0)
s_waitcnt vmcnt(18)
v_mfma_f32_16x16x32_bf16 v[64:67], v[224:227], a[20:23], v[64:67]
ds_read_b64_tr_b16 v[208:209], v8 offset:8192
s_add_u32 m0, s30, 4096
v_mfma_f32_16x16x32_bf16 v[84:87], v[228:231], a[20:23], v[84:87]
ds_read_b64_tr_b16 v[210:211], v8 offset:9216
v_mfma_f32_16x16x32_bf16 v[104:107], v[232:235], a[20:23], v[104:107]
ds_read_b64_tr_b16 v[212:213], v9 offset:8192
v_mfma_f32_16x16x32_bf16 v[124:127], v[236:239], a[20:23], v[124:127]
ds_read_b64_tr_b16 v[214:215], v9 offset:9216
v_mfma_f32_16x16x32_bf16 v[68:71], v[224:227], a[24:27], v[68:71]
ds_read_b64_tr_b16 v[216:217], v10 offset:8192
v_mfma_f32_16x16x32_bf16 v[88:91], v[228:231], a[24:27], v[88:91]
ds_read_b64_tr_b16 v[218:219], v10 offset:9216
v_mfma_f32_16x16x32_bf16 v[108:111], v[232:235], a[24:27], v[108:111]
ds_read_b64_tr_b16 v[220:221], v11 offset:8192
v_mfma_f32_16x16x32_bf16 v[128:131], v[236:239], a[24:27], v[128:131]
ds_read_b64_tr_b16 v[222:223], v11 offset:9216
v_mfma_f32_16x16x32_bf16 v[72:75], v[224:227], a[28:31], v[72:75]
buffer_load_dwordx4 v4, s[4:7], s28 offen offset:0 lds
v_mfma_f32_16x16x32_bf16 v[92:95], v[228:231], a[28:31], v[92:95]
buffer_load_dwordx4 v5, s[4:7], s28 offen offset:1024 lds
v_mfma_f32_16x16x32_bf16 v[112:115], v[232:235], a[28:31], v[112:115]
buffer_load_dwordx4 v6, s[4:7], s28 offen offset:2048 lds
v_mfma_f32_16x16x32_bf16 v[132:135], v[236:239], a[28:31], v[132:135]
buffer_load_dwordx4 v7, s[4:7], s28 offen offset:3072 lds
v_mfma_f32_16x16x32_bf16 v[76:79], v[224:227], a[32:35], v[76:79]
s_add_u32 s28, s28, 36864
v_mfma_f32_16x16x32_bf16 v[96:99], v[228:231], a[32:35], v[96:99]
buffer_load_dwordx4 a[0:3], v2, s[8:11], s29 offen offset:0
v_mfma_f32_16x16x32_bf16 v[116:119], v[232:235], a[32:35], v[116:119]
buffer_load_dwordx4 a[4:7], v2, s[8:11], s29 offen offset:1024
v_mfma_f32_16x16x32_bf16 v[136:139], v[236:239], a[32:35], v[136:139]
buffer_load_dwordx4 a[8:11], v2, s[8:11], s29 offen offset:2048
v_mfma_f32_16x16x32_bf16 v[80:83], v[224:227], a[36:39], v[80:83]
buffer_load_dwordx4 a[12:15], v2, s[8:11], s29 offen offset:3072
v_mfma_f32_16x16x32_bf16 v[100:103], v[228:231], a[36:39], v[100:103]
buffer_load_dwordx4 a[16:19], v3, s[8:11], s29 offen
v_mfma_f32_16x16x32_bf16 v[120:123], v[232:235], a[36:39], v[120:123]
s_add_u32 s29, s29, 131072
v_mfma_f32_16x16x32_bf16 v[140:143], v[236:239], a[36:39], v[140:143]
s_waitcnt lgkmcnt(0)
s_waitcnt vmcnt(18)
v_mfma_f32_16x16x32_bf16 v[64:67], v[208:211], a[40:43], v[64:67]
ds_read_b64_tr_b16 v[224:225], v8 offset:12288
s_add_u32 m0, s30, 8192
v_mfma_f32_16x16x32_bf16 v[84:87], v[212:215], a[40:43], v[84:87]
ds_read_b64_tr_b16 v[226:227], v8 offset:13312
v_mfma_f32_16x16x32_bf16 v[104:107], v[216:219], a[40:43], v[104:107]
ds_read_b64_tr_b16 v[228:229], v9 offset:12288
v_mfma_f32_16x16x32_bf16 v[124:127], v[220:223], a[40:43], v[124:127]
ds_read_b64_tr_b16 v[230:231], v9 offset:13312
v_mfma_f32_16x16x32_bf16 v[68:71], v[208:211], a[44:47], v[68:71]
ds_read_b64_tr_b16 v[232:233], v10 offset:12288
v_mfma_f32_16x16x32_bf16 v[88:91], v[212:215], a[44:47], v[88:91]
ds_read_b64_tr_b16 v[234:235], v10 offset:13312
v_mfma_f32_16x16x32_bf16 v[108:111], v[216:219], a[44:47], v[108:111]
ds_read_b64_tr_b16 v[236:237], v11 offset:12288
v_mfma_f32_16x16x32_bf16 v[128:131], v[220:223], a[44:47], v[128:131]
ds_read_b64_tr_b16 v[238:239], v11 offset:13312
v_mfma_f32_16x16x32_bf16 v[72:75], v[208:211], a[48:51], v[72:75]
buffer_load_dwordx4 v4, s[4:7], s28 offen offset:0 lds
v_mfma_f32_16x16x32_bf16 v[92:95], v[212:215], a[48:51], v[92:95]
buffer_load_dwordx4 v5, s[4:7], s28 offen offset:1024 lds
v_mfma_f32_16x16x32_bf16 v[112:115], v[216:219], a[48:51], v[112:115]
buffer_load_dwordx4 v6, s[4:7], s28 offen offset:2048 lds
v_mfma_f32_16x16x32_bf16 v[132:135], v[220:223], a[48:51], v[132:135]
buffer_load_dwordx4 v7, s[4:7], s28 offen offset:3072 lds
v_mfma_f32_16x16x32_bf16 v[76:79], v[208:211], a[52:55], v[76:79]
s_add_u32 s28, s28, 36864
v_mfma_f32_16x16x32_bf16 v[96:99], v[212:215], a[52:55], v[96:99]
buffer_load_dwordx4 a[20:23], v2, s[8:11], s29 offen offset:0
v_mfma_f32_16x16x32_bf16 v[116:119], v[216:219], a[52:55], v[116:119]
buffer_load_dwordx4 a[24:27], v2, s[8:11], s29 offen offset:1024
v_mfma_f32_16x16x32_bf16 v[136:139], v[220:223], a[52:55], v[136:139]
buffer_load_dwordx4 a[28:31], v2, s[8:11], s29 offen offset:2048
v_mfma_f32_16x16x32_bf16 v[80:83], v[208:211], a[56:59], v[80:83]
buffer_load_dwordx4 a[32:35], v2, s[8:11], s29 offen offset:3072
v_mfma_f32_16x16x32_bf16 v[100:103], v[212:215], a[56:59], v[100:103]
buffer_load_dwordx4 a[36:39], v3, s[8:11], s29 offen
v_mfma_f32_16x16x32_bf16 v[120:123], v[216:219], a[56:59], v[120:123]
s_add_u32 s29, s29, 131072
v_mfma_f32_16x16x32_bf16 v[140:143], v[220:223], a[56:59], v[140:143]
s_waitcnt lgkmcnt(0)
s_waitcnt vmcnt(18)
v_mfma_f32_16x16x32_bf16 v[64:67], v[224:227], a[60:63], v[64:67]
ds_read_b64_tr_b16 v[208:209], v8 offset:0
s_add_u32 m0, s30, 12288
v_mfma_f32_16x16x32_bf16 v[84:87], v[228:231], a[60:63], v[84:87]
ds_read_b64_tr_b16 v[210:211], v8 offset:1024
v_mfma_f32_16x16x32_bf16 v[104:107], v[232:235], a[60:63], v[104:107]
ds_read_b64_tr_b16 v[212:213], v9 offset:0
v_mfma_f32_16x16x32_bf16 v[124:127], v[236:239], a[60:63], v[124:127]
ds_read_b64_tr_b16 v[214:215], v9 offset:1024
v_mfma_f32_16x16x32_bf16 v[68:71], v[224:227], a[64:67], v[68:71]
ds_read_b64_tr_b16 v[216:217], v10 offset:0
v_mfma_f32_16x16x32_bf16 v[88:91], v[228:231], a[64:67], v[88:91]
ds_read_b64_tr_b16 v[218:219], v10 offset:1024
v_mfma_f32_16x16x32_bf16 v[108:111], v[232:235], a[64:67], v[108:111]
ds_read_b64_tr_b16 v[220:221], v11 offset:0
v_mfma_f32_16x16x32_bf16 v[128:131], v[236:239], a[64:67], v[128:131]
ds_read_b64_tr_b16 v[222:223], v11 offset:1024
v_mfma_f32_16x16x32_bf16 v[72:75], v[224:227], a[68:71], v[72:75]
buffer_load_dwordx4 v4, s[4:7], s28 offen offset:0 lds
v_mfma_f32_16x16x32_bf16 v[92:95], v[228:231], a[68:71], v[92:95]
buffer_load_dwordx4 v5, s[4:7], s28 offen offset:1024 lds
v_mfma_f32_16x16x32_bf16 v[112:115], v[232:235], a[68:71], v[112:115]
buffer_load_dwordx4 v6, s[4:7], s28 offen offset:2048 lds
v_mfma_f32_16x16x32_bf16 v[132:135], v[236:239], a[68:71], v[132:135]
buffer_load_dwordx4 v7, s[4:7], s28 offen offset:3072 lds
v_mfma_f32_16x16x32_bf16 v[76:79], v[224:227], a[72:75], v[76:79]
s_add_u32 s28, s28, 36864
v_mfma_f32_16x16x32_bf16 v[96:99], v[228:231], a[72:75], v[96:99]
buffer_load_dwordx4 a[40:43], v2, s[8:11], s29 offen offset:0
v_mfma_f32_16x16x32_bf16 v[116:119], v[232:235], a[72:75], v[116:119]
buffer_load_dwordx4 a[44:47], v2, s[8:11], s29 offen offset:1024
v_mfma_f32_16x16x32_bf16 v[136:139], v[236:239], a[72:75], v[136:139]
buffer_load_dwordx4 a[48:51], v2, s[8:11], s29 offen offset:2048
v_mfma_f32_16x16x32_bf16 v[80:83], v[224:227], a[76:79], v[80:83]
buffer_load_dwordx4 a[52:55], v2, s[8:11], s29 offen offset:3072
v_mfma_f32_16x16x32_bf16 v[100:103], v[228:231], a[76:79], v[100:103]
buffer_load_dwordx4 a[56:59], v3, s[8:11], s29 offen
v_mfma_f32_16x16x32_bf16 v[120:123], v[232:235], a[76:79], v[120:123]
s_add_u32 s29, s29, 131072
v_mfma_f32_16x16x32_bf16 v[140:143], v[236:239], a[76:79], v[140:143]
s_waitcnt lgkmcnt(0)
s_waitcnt vmcnt(18)
v_mfma_f32_16x16x32_bf16 v[64:67], v[208:211], a[0:3], v[64:67]
ds_read_b64_tr_b16 v[224:225], v8 offset:4096
s_add_u32 m0, s30, 0
v_mfma_f32_16x16x32_bf16 v[84:87], v[212:215], a[0:3], v[84:87]
ds_read_b64_tr_b16 v[226:227], v8 offset:5120
v_mfma_f32_16x16x32_bf16 v[104:107], v[216:219], a[0:3], v[104:107]
ds_read_b64_tr_b16 v[228:229], v9 offset:4096
v_mfma_f32_16x16x32_bf16 v[124:127], v[220:223], a[0:3], v[124:127]
ds_read_b64_tr_b16 v[230:231], v9 offset:5120
v_mfma_f32_16x16x32_bf16 v[68:71], v[208:211], a[4:7], v[68:71]
ds_read_b64_tr_b16 v[232:233], v10 offset:4096
v_mfma_f32_16x16x32_bf16 v[88:91], v[212:215], a[4:7], v[88:91]
ds_read_b64_tr_b16 v[234:235], v10 offset:5120
v_mfma_f32_16x16x32_bf16 v[108:111], v[216:219], a[4:7], v[108:111]
ds_read_b64_tr_b16 v[236:237], v11 offset:4096
v_mfma_f32_16x16x32_bf16 v[128:131], v[220:223], a[4:7], v[128:131]
ds_read_b64_tr_b16 v[238:239], v11 offset:5120
v_mfma_f32_16x16x32_bf16 v[72:75], v[208:211], a[8:11], v[72:75]
buffer_load_dwordx4 v4, s[4:7], s28 offen offset:0 lds
v_mfma_f32_16x16x32_bf16 v[92:95], v[212:215], a[8:11], v[92:95]
buffer_load_dwordx4 v5, s[4:7], s28 offen offset:1024 lds
v_mfma_f32_16x16x32_bf16 v[112:115], v[216:219], a[8:11], v[112:115]
buffer_load_dwordx4 v6, s[4:7], s28 offen offset:2048 lds
v_mfma_f32_16x16x32_bf16 v[132:135], v[220:223], a[8:11], v[132:135]
buffer_load_dwordx4 v7, s[4:7], s28 offen offset:3072 lds
v_mfma_f32_16x16x32_bf16 v[76:79], v[208:211], a[12:15], v[76:79]
s_add_u32 s28, s28, 36864
v_mfma_f32_16x16x32_bf16 v[96:99], v[212:215], a[12:15], v[96:99]
buffer_load_dwordx4 a[60:63], v2, s[8:11], s29 offen offset:0
v_mfma_f32_16x16x32_bf16 v[116:119], v[216:219], a[12:15], v[116:119]
buffer_load_dwordx4 a[64:67], v2, s[8:11], s29 offen offset:1024
v_mfma_f32_16x16x32_bf16 v[136:139], v[220:223], a[12:15], v[136:139]
buffer_load_dwordx4 a[68:71], v2, s[8:11], s29 offen offset:2048
v_mfma_f32_16x16x32_bf16 v[80:83], v[208:211], a[16:19], v[80:83]
buffer_load_dwordx4 a[72:75], v2, s[8:11], s29 offen offset:3072
v_mfma_f32_16x16x32_bf16 v[100:103], v[212:215], a[16:19], v[100:103]
buffer_load_dwordx4 a[76:79], v3, s[8:11], s29 offen
v_mfma_f32_16x16x32_bf16 v[120:123], v[216:219], a[16:19], v[120:123]
s_add_u32 s29, s29, 131072
v_mfma_f32_16x16x32_bf16 v[140:143], v[220:223], a[16:19], v[140:143]
s_waitcnt lgkmcnt(0)
s_waitcnt vmcnt(18)
v_mfma_f32_16x16x32_bf16 v[64:67], v[224:227], a[20:23], v[64:67]
ds_read_b64_tr_b16 v[208:209], v8 offset:8192
s_add_u32 m0, s30, 4096
v_mfma_f32_16x16x32_bf16 v[84:87], v[228:231], a[20:23], v[84:87]
ds_read_b64_tr_b16 v[210:211], v8 offset:9216
v_mfma_f32_16x16x32_bf16 v[104:107], v[232:235], a[20:23], v[104:107]
ds_read_b64_tr_b16 v[212:213], v9 offset:8192
v_mfma_f32_16x16x32_bf16 v[124:127], v[236:239], a[20:23], v[124:127]
ds_read_b64_tr_b16 v[214:215], v9 offset:9216
v_mfma_f32_16x16x32_bf16 v[68:71], v[224:227], a[24:27], v[68:71]
ds_read_b64_tr_b16 v[216:217], v10 offset:8192
v_mfma_f32_16x16x32_bf16 v[88:91], v[228:231], a[24:27], v[88:91]
ds_read_b64_tr_b16 v[218:219], v10 offset:9216
v_mfma_f32_16x16x32_bf16 v[108:111], v[232:235], a[24:27], v[108:111]
ds_read_b64_tr_b16 v[220:221], v11 offset:8192
v_mfma_f32_16x16x32_bf16 v[128:131], v[236:239], a[24:27], v[128:131]
ds_read_b64_tr_b16 v[222:223], v11 offset:9216
v_mfma_f32_16x16x32_bf16 v[72:75], v[224:227], a[28:31], v[72:75]
buffer_load_dwordx4 v4, s[4:7], s28 offen offset:0 lds
v_mfma_f32_16x16x32_bf16 v[92:95], v[228:231], a[28:31], v[92:95]
buffer_load_dwordx4 v5, s[4:7], s28 offen offset:1024 lds
v_mfma_f32_16x16x32_bf16 v[112:115], v[232:235], a[28:31], v[112:115]
buffer_load_dwordx4 v6, s[4:7], s28 offen offset:2048 lds
v_mfma_f32_16x16x32_bf16 v[132:135], v[236:239], a[28:31], v[132:135]
buffer_load_dwordx4 v7, s[4:7], s28 offen offset:3072 lds
v_mfma_f32_16x16x32_bf16 v[76:79], v[224:227], a[32:35], v[76:79]
s_add_u32 s28, s28, 36864
v_mfma_f32_16x16x32_bf16 v[96:99], v[228:231], a[32:35], v[96:99]
buffer_load_dwordx4 a[0:3], v2, s[8:11], s29 offen offset:0
v_mfma_f32_16x16x32_bf16 v[116:119], v[232:235], a[32:35], v[116:119]
buffer_load_dwordx4 a[4:7], v2, s[8:11], s29 offen offset:1024
v_mfma_f32_16x16x32_bf16 v[136:139], v[236:239], a[32:35], v[136:139]
buffer_load_dwordx4 a[8:11], v2, s[8:11], s29 offen offset:2048
v_mfma_f32_16x16x32_bf16 v[80:83], v[224:227], a[36:39], v[80:83]
buffer_load_dwordx4 a[12:15], v2, s[8:11], s29 offen offset:3072
v_mfma_f32_16x16x32_bf16 v[100:103], v[228:231], a[36:39], v[100:103]
buffer_load_dwordx4 a[16:19], v3, s[8:11], s29 offen
v_mfma_f32_16x16x32_bf16 v[120:123], v[232:235], a[36:39], v[120:123]
s_add_u32 s29, s29, 131072
v_mfma_f32_16x16x32_bf16 v[140:143], v[236:239], a[36:39], v[140:143]
s_waitcnt lgkmcnt(0)
s_waitcnt vmcnt(18)
v_mfma_f32_16x16x32_bf16 v[64:67], v[208:211], a[40:43], v[64:67]
ds_read_b64_tr_b16 v[224:225], v8 offset:12288
s_add_u32 m0, s30, 8192
v_mfma_f32_16x16x32_bf16 v[84:87], v[212:215], a[40:43], v[84:87]
ds_read_b64_tr_b16 v[226:227], v8 offset:13312
v_mfma_f32_16x16x32_bf16 v[104:107], v[216:219], a[40:43], v[104:107]
ds_read_b64_tr_b16 v[228:229], v9 offset:12288
v_mfma_f32_16x16x32_bf16 v[124:127], v[220:223], a[40:43], v[124:127]
ds_read_b64_tr_b16 v[230:231], v9 offset:13312
v_mfma_f32_16x16x32_bf16 v[68:71], v[208:211], a[44:47], v[68:71]
ds_read_b64_tr_b16 v[232:233], v10 offset:12288
v_mfma_f32_16x16x32_bf16 v[88:91], v[212:215], a[44:47], v[88:91]
ds_read_b64_tr_b16 v[234:235], v10 offset:13312
v_mfma_f32_16x16x32_bf16 v[108:111], v[216:219], a[44:47], v[108:111]
ds_read_b64_tr_b16 v[236:237], v11 offset:12288
v_mfma_f32_16x16x32_bf16 v[128:131], v[220:223], a[44:47], v[128:131]
ds_read_b64_tr_b16 v[238:239], v11 offset:13312
v_mfma_f32_16x16x32_bf16 v[72:75], v[208:211], a[48:51], v[72:75]
buffer_load_dwordx4 v4, s[4:7], s28 offen offset:0 lds
v_mfma_f32_16x16x32_bf16 v[92:95], v[212:215], a[48:51], v[92:95]
buffer_load_dwordx4 v5, s[4:7], s28 offen offset:1024 lds
v_mfma_f32_16x16x32_bf16 v[112:115], v[216:219], a[48:51], v[112:115]
buffer_load_dwordx4 v6, s[4:7], s28 offen offset:2048 lds
v_mfma_f32_16x16x32_bf16 v[132:135], v[220:223], a[48:51], v[132:135]
buffer_load_dwordx4 v7, s[4:7], s28 offen offset:3072 lds
v_mfma_f32_16x16x32_bf16 v[76:79], v[208:211], a[52:55], v[76:79]
s_add_u32 s28, s28, 36864
v_mfma_f32_16x16x32_bf16 v[96:99], v[212:215], a[52:55], v[96:99]
buffer_load_dwordx4 a[20:23], v2, s[8:11], s29 offen offset:0
v_mfma_f32_16x16x32_bf16 v[116:119], v[216:219], a[52:55], v[116:119]
buffer_load_dwordx4 a[24:27], v2, s[8:11], s29 offen offset:1024
v_mfma_f32_16x16x32_bf16 v[136:139], v[220:223], a[52:55], v[136:139]
buffer_load_dwordx4 a[28:31], v2, s[8:11], s29 offen offset:2048
v_mfma_f32_16x16x32_bf16 v[80:83], v[208:211], a[56:59], v[80:83]
buffer_load_dwordx4 a[32:35], v2, s[8:11], s29 offen offset:3072
v_mfma_f32_16x16x32_bf16 v[100:103], v[212:215], a[56:59], v[100:103]
buffer_load_dwordx4 a[36:39], v3, s[8:11], s29 offen
v_mfma_f32_16x16x32_bf16 v[120:123], v[216:219], a[56:59], v[120:123]
s_add_u32 s29, s29, 131072
v_mfma_f32_16x16x32_bf16 v[140:143], v[220:223], a[56:59], v[140:143]
s_waitcnt lgkmcnt(0)
s_waitcnt vmcnt(18)
v_mfma_f32_16x16x32_bf16 v[64:67], v[224:227], a[60:63], v[64:67]
ds_read_b64_tr_b16 v[208:209], v8 offset:0
s_add_u32 m0, s30, 12288
v_mfma_f32_16x16x32_bf16 v[84:87], v[228:231], a[60:63], v[84:87]
ds_read_b64_tr_b16 v[210:211], v8 offset:1024
v_mfma_f32_16x16x32_bf16 v[104:107], v[232:235], a[60:63], v[104:107]
ds_read_b64_tr_b16 v[212:213], v9 offset:0
v_mfma_f32_16x16x32_bf16 v[124:127], v[236:239], a[60:63], v[124:127]
ds_read_b64_tr_b16 v[214:215], v9 offset:1024
v_mfma_f32_16x16x32_bf16 v[68:71], v[224:227], a[64:67], v[68:71]
ds_read_b64_tr_b16 v[216:217], v10 offset:0
v_mfma_f32_16x16x32_bf16 v[88:91], v[228:231], a[64:67], v[88:91]
ds_read_b64_tr_b16 v[218:219], v10 offset:1024
v_mfma_f32_16x16x32_bf16 v[108:111], v[232:235], a[64:67], v[108:111]
ds_read_b64_tr_b16 v[220:221], v11 offset:0
v_mfma_f32_16x16x32_bf16 v[128:131], v[236:239], a[64:67], v[128:131]
ds_read_b64_tr_b16 v[222:223], v11 offset:1024
v_mfma_f32_16x16x32_bf16 v[72:75], v[224:227], a[68:71], v[72:75]
buffer_load_dwordx4 v4, s[4:7], s28 offen offset:0 lds
v_mfma_f32_16x16x32_bf16 v[92:95], v[228:231], a[68:71], v[92:95]
buffer_load_dwordx4 v5, s[4:7], s28 offen offset:1024 lds
v_mfma_f32_16x16x32_bf16 v[112:115], v[232:235], a[68:71], v[112:115]
buffer_load_dwordx4 v6, s[4:7], s28 offen offset:2048 lds
v_mfma_f32_16x16x32_bf16 v[132:135], v[236:239], a[68:71], v[132:135]
buffer_load_dwordx4 v7, s[4:7], s28 offen offset:3072 lds
v_mfma_f32_16x16x32_bf16 v[76:79], v[224:227], a[72:75], v[76:79]
s_add_u32 s28, s28, 36864
v_mfma_f32_16x16x32_bf16 v[96:99], v[228:231], a[72:75], v[96:99]
buffer_load_dwordx4 a[40:43], v2, s[8:11], s29 offen offset:0
v_mfma_f32_16x16x32_bf16 v[116:119], v[232:235], a[72:75], v[116:119]
buffer_load_dwordx4 a[44:47], v2, s[8:11], s29 offen offset:1024
v_mfma_f32_16x16x32_bf16 v[136:139], v[236:239], a[72:75], v[136:139]
buffer_load_dwordx4 a[48:51], v2, s[8:11], s29 offen offset:2048
v_mfma_f32_16x16x32_bf16 v[80:83], v[224:227], a[76:79], v[80:83]
buffer_load_dwordx4 a[52:55], v2, s[8:11], s29 offen offset:3072
v_mfma_f32_16x16x32_bf16 v[100:103], v[228:231], a[76:79], v[100:103]
buffer_load_dwordx4 a[56:59], v3, s[8:11], s29 offen
v_mfma_f32_16x16x32_bf16 v[120:123], v[232:235], a[76:79], v[120:123]
s_add_u32 s29, s29, 131072
v_mfma_f32_16x16x32_bf16 v[140:143], v[236:239], a[76:79], v[140:143]
s_waitcnt lgkmcnt(0)
s_waitcnt vmcnt(18)
v_mfma_f32_16x16x32_bf16 v[64:67], v[208:211], a[0:3], v[64:67]
ds_read_b64_tr_b16 v[224:225], v8 offset:4096
s_add_u32 m0, s30, 0
v_mfma_f32_16x16x32_bf16 v[84:87], v[212:215], a[0:3], v[84:87]
ds_read_b64_tr_b16 v[226:227], v8 offset:5120
v_mfma_f32_16x16x32_bf16 v[104:107], v[216:219], a[0:3], v[104:107]
ds_read_b64_tr_b16 v[228:229], v9 offset:4096
v_mfma_f32_16x16x32_bf16 v[124:127], v[220:223], a[0:3], v[124:127]
ds_read_b64_tr_b16 v[230:231], v9 offset:5120
v_mfma_f32_16x16x32_bf16 v[68:71], v[208:211], a[4:7], v[68:71]
ds_read_b64_tr_b16 v[232:233], v10 offset:4096
v_mfma_f32_16x16x32_bf16 v[88:91], v[212:215], a[4:7], v[88:91]
ds_read_b64_tr_b16 v[234:235], v10 offset:5120
v_mfma_f32_16x16x32_bf16 v[108:111], v[216:219], a[4:7], v[108:111]
ds_read_b64_tr_b16 v[236:237], v11 offset:4096
v_mfma_f32_16x16x32_bf16 v[128:131], v[220:223], a[4:7], v[128:131]
ds_read_b64_tr_b16 v[238:239], v11 offset:5120
v_mfma_f32_16x16x32_bf16 v[72:75], v[208:211], a[8:11], v[72:75]
buffer_load_dwordx4 v4, s[4:7], s28 offen offset:0 lds
v_mfma_f32_16x16x32_bf16 v[92:95], v[212:215], a[8:11], v[92:95]
buffer_load_dwordx4 v5, s[4:7], s28 offen offset:1024 lds
v_mfma_f32_16x16x32_bf16 v[112:115], v[216:219], a[8:11], v[112:115]
buffer_load_dwordx4 v6, s[4:7], s28 offen offset:2048 lds
v_mfma_f32_16x16x32_bf16 v[132:135], v[220:223], a[8:11], v[132:135]
buffer_load_dwordx4 v7, s[4:7], s28 offen offset:3072 lds
v_mfma_f32_16x16x32_bf16 v[76:79], v[208:211], a[12:15], v[76:79]
s_add_u32 s28, s28, 36864
v_mfma_f32_16x16x32_bf16 v[96:99], v[212:215], a[12:15], v[96:99]
buffer_load_dwordx4 a[60:63], v2, s[8:11], s29 offen offset:0
v_mfma_f32_16x16x32_bf16 v[116:119], v[216:219], a[12:15], v[116:119]
buffer_load_dwordx4 a[64:67], v2, s[8:11], s29 offen offset:1024
v_mfma_f32_16x16x32_bf16 v[136:139], v[220:223], a[12:15], v[136:139]
buffer_load_dwordx4 a[68:71], v2, s[8:11], s29 offen offset:2048
v_mfma_f32_16x16x32_bf16 v[80:83], v[208:211], a[16:19], v[80:83]
buffer_load_dwordx4 a[72:75], v2, s[8:11], s29 offen offset:3072
v_mfma_f32_16x16x32_bf16 v[100:103], v[212:215], a[16:19], v[100:103]
buffer_load_dwordx4 a[76:79], v3, s[8:11], s29 offen
v_mfma_f32_16x16x32_bf16 v[120:123], v[216:219], a[16:19], v[120:123]
s_add_u32 s29, s29, 131072
v_mfma_f32_16x16x32_bf16 v[140:143], v[220:223], a[16:19], v[140:143]
s_waitcnt lgkmcnt(0)
s_waitcnt vmcnt(18)
v_mfma_f32_16x16x32_bf16 v[64:67], v[224:227], a[20:23], v[64:67]
ds_read_b64_tr_b16 v[208:209], v8 offset:8192
s_add_u32 m0, s30, 4096
v_mfma_f32_16x16x32_bf16 v[84:87], v[228:231], a[20:23], v[84:87]
ds_read_b64_tr_b16 v[210:211], v8 offset:9216
v_mfma_f32_16x16x32_bf16 v[104:107], v[232:235], a[20:23], v[104:107]
ds_read_b64_tr_b16 v[212:213], v9 offset:8192
v_mfma_f32_16x16x32_bf16 v[124:127], v[236:239], a[20:23], v[124:127]
ds_read_b64_tr_b16 v[214:215], v9 offset:9216
v_mfma_f32_16x16x32_bf16 v[68:71], v[224:227], a[24:27], v[68:71]
ds_read_b64_tr_b16 v[216:217], v10 offset:8192
v_mfma_f32_16x16x32_bf16 v[88:91], v[228:231], a[24:27], v[88:91]
ds_read_b64_tr_b16 v[218:219], v10 offset:9216
v_mfma_f32_16x16x32_bf16 v[108:111], v[232:235], a[24:27], v[108:111]
ds_read_b64_tr_b16 v[220:221], v11 offset:8192
v_mfma_f32_16x16x32_bf16 v[128:131], v[236:239], a[24:27], v[128:131]
ds_read_b64_tr_b16 v[222:223], v11 offset:9216
v_mfma_f32_16x16x32_bf16 v[72:75], v[224:227], a[28:31], v[72:75]
buffer_load_dwordx4 v4, s[4:7], s28 offen offset:0 lds
v_mfma_f32_16x16x32_bf16 v[92:95], v[228:231], a[28:31], v[92:95]
buffer_load_dwordx4 v5, s[4:7], s28 offen offset:1024 lds
v_mfma_f32_16x16x32_bf16 v[112:115], v[232:235], a[28:31], v[112:115]
buffer_load_dwordx4 v6, s[4:7], s28 offen offset:2048 lds
v_mfma_f32_16x16x32_bf16 v[132:135], v[236:239], a[28:31], v[132:135]
buffer_load_dwordx4 v7, s[4:7], s28 offen offset:3072 lds
v_mfma_f32_16x16x32_bf16 v[76:79], v[224:227], a[32:35], v[76:79]
s_add_u32 s28, s28, 36864
v_mfma_f32_16x16x32_bf16 v[96:99], v[228:231], a[32:35], v[96:99]
buffer_load_dwordx4 a[0:3], v2, s[8:11], s29 offen offset:0
v_mfma_f32_16x16x32_bf16 v[116:119], v[232:235], a[32:35], v[116:119]
buffer_load_dwordx4 a[4:7], v2, s[8:11], s29 offen offset:1024
v_mfma_f32_16x16x32_bf16 v[136:139], v[236:239], a[32:35], v[136:139]
buffer_load_dwordx4 a[8:11], v2, s[8:11], s29 offen offset:2048
v_mfma_f32_16x16x32_bf16 v[80:83], v[224:227], a[36:39], v[80:83]
buffer_load_dwordx4 a[12:15], v2, s[8:11], s29 offen offset:3072
v_mfma_f32_16x16x32_bf16 v[100:103], v[228:231], a[36:39], v[100:103]
buffer_load_dwordx4 a[16:19], v3, s[8:11], s29 offen
v_mfma_f32_16x16x32_bf16 v[120:123], v[232:235], a[36:39], v[120:123]
s_add_u32 s29, s29, 131072
v_mfma_f32_16x16x32_bf16 v[140:143], v[236:239], a[36:39], v[140:143]
s_waitcnt lgkmcnt(0)
s_waitcnt vmcnt(18)
v_mfma_f32_16x16x32_bf16 v[64:67], v[208:211], a[40:43], v[64:67]
ds_read_b64_tr_b16 v[224:225], v8 offset:12288
s_add_u32 m0, s30, 8192
v_mfma_f32_16x16x32_bf16 v[84:87], v[212:215], a[40:43], v[84:87]
ds_read_b64_tr_b16 v[226:227], v8 offset:13312
v_mfma_f32_16x16x32_bf16 v[104:107], v[216:219], a[40:43], v[104:107]
ds_read_b64_tr_b16 v[228:229], v9 offset:12288
v_mfma_f32_16x16x32_bf16 v[124:127], v[220:223], a[40:43], v[124:127]
ds_read_b64_tr_b16 v[230:231], v9 offset:13312
v_mfma_f32_16x16x32_bf16 v[68:71], v[208:211], a[44:47], v[68:71]
ds_read_b64_tr_b16 v[232:233], v10 offset:12288
v_mfma_f32_16x16x32_bf16 v[88:91], v[212:215], a[44:47], v[88:91]
ds_read_b64_tr_b16 v[234:235], v10 offset:13312
v_mfma_f32_16x16x32_bf16 v[108:111], v[216:219], a[44:47], v[108:111]
ds_read_b64_tr_b16 v[236:237], v11 offset:12288
v_mfma_f32_16x16x32_bf16 v[128:131], v[220:223], a[44:47], v[128:131]
ds_read_b64_tr_b16 v[238:239], v11 offset:13312
v_mfma_f32_16x16x32_bf16 v[72:75], v[208:211], a[48:51], v[72:75]
buffer_load_dwordx4 v4, s[4:7], s28 offen offset:0 lds
v_mfma_f32_16x16x32_bf16 v[92:95], v[212:215], a[48:51], v[92:95]
buffer_load_dwordx4 v5, s[4:7], s28 offen offset:1024 lds
v_mfma_f32_16x16x32_bf16 v[112:115], v[216:219], a[48:51], v[112:115]
buffer_load_dwordx4 v6, s[4:7], s28 offen offset:2048 lds
v_mfma_f32_16x16x32_bf16 v[132:135], v[220:223], a[48:51], v[132:135]
buffer_load_dwordx4 v7, s[4:7], s28 offen offset:3072 lds
v_mfma_f32_16x16x32_bf16 v[76:79], v[208:211], a[52:55], v[76:79]
s_add_u32 s28, s28, 36864
v_mfma_f32_16x16x32_bf16 v[96:99], v[212:215], a[52:55], v[96:99]
buffer_load_dwordx4 a[20:23], v2, s[8:11], s29 offen offset:0
v_mfma_f32_16x16x32_bf16 v[116:119], v[216:219], a[52:55], v[116:119]
buffer_load_dwordx4 a[24:27], v2, s[8:11], s29 offen offset:1024
v_mfma_f32_16x16x32_bf16 v[136:139], v[220:223], a[52:55], v[136:139]
buffer_load_dwordx4 a[28:31], v2, s[8:11], s29 offen offset:2048
v_mfma_f32_16x16x32_bf16 v[80:83], v[208:211], a[56:59], v[80:83]
buffer_load_dwordx4 a[32:35], v2, s[8:11], s29 offen offset:3072
v_mfma_f32_16x16x32_bf16 v[100:103], v[212:215], a[56:59], v[100:103]
buffer_load_dwordx4 a[36:39], v3, s[8:11], s29 offen
v_mfma_f32_16x16x32_bf16 v[120:123], v[216:219], a[56:59], v[120:123]
s_add_u32 s29, s29, 131072
v_mfma_f32_16x16x32_bf16 v[140:143], v[220:223], a[56:59], v[140:143]
s_waitcnt lgkmcnt(0)
s_waitcnt vmcnt(18)
v_mfma_f32_16x16x32_bf16 v[64:67], v[224:227], a[60:63], v[64:67]
ds_read_b64_tr_b16 v[208:209], v8 offset:0
s_add_u32 m0, s30, 12288
v_mfma_f32_16x16x32_bf16 v[84:87], v[228:231], a[60:63], v[84:87]
ds_read_b64_tr_b16 v[210:211], v8 offset:1024
v_mfma_f32_16x16x32_bf16 v[104:107], v[232:235], a[60:63], v[104:107]
ds_read_b64_tr_b16 v[212:213], v9 offset:0
v_mfma_f32_16x16x32_bf16 v[124:127], v[236:239], a[60:63], v[124:127]
ds_read_b64_tr_b16 v[214:215], v9 offset:1024
v_mfma_f32_16x16x32_bf16 v[68:71], v[224:227], a[64:67], v[68:71]
ds_read_b64_tr_b16 v[216:217], v10 offset:0
v_mfma_f32_16x16x32_bf16 v[88:91], v[228:231], a[64:67], v[88:91]
ds_read_b64_tr_b16 v[218:219], v10 offset:1024
v_mfma_f32_16x16x32_bf16 v[108:111], v[232:235], a[64:67], v[108:111]
ds_read_b64_tr_b16 v[220:221], v11 offset:0
v_mfma_f32_16x16x32_bf16 v[128:131], v[236:239], a[64:67], v[128:131]
ds_read_b64_tr_b16 v[222:223], v11 offset:1024
v_mfma_f32_16x16x32_bf16 v[72:75], v[224:227], a[68:71], v[72:75]
buffer_load_dwordx4 v4, s[4:7], s28 offen offset:0 lds
v_mfma_f32_16x16x32_bf16 v[92:95], v[228:231], a[68:71], v[92:95]
buffer_load_dwordx4 v5, s[4:7], s28 offen offset:1024 lds
v_mfma_f32_16x16x32_bf16 v[112:115], v[232:235], a[68:71], v[112:115]
buffer_load_dwordx4 v6, s[4:7], s28 offen offset:2048 lds
v_mfma_f32_16x16x32_bf16 v[132:135], v[236:239], a[68:71], v[132:135]
buffer_load_dwordx4 v7, s[4:7], s28 offen offset:3072 lds
v_mfma_f32_16x16x32_bf16 v[76:79], v[224:227], a[72:75], v[76:79]
s_add_u32 s28, s28, 36864
v_mfma_f32_16x16x32_bf16 v[96:99], v[228:231], a[72:75], v[96:99]
buffer_load_dwordx4 a[40:43], v2, s[8:11], s29 offen offset:0
v_mfma_f32_16x16x32_bf16 v[116:119], v[232:235], a[72:75], v[116:119]
buffer_load_dwordx4 a[44:47], v2, s[8:11], s29 offen offset:1024
v_mfma_f32_16x16x32_bf16 v[136:139], v[236:239], a[72:75], v[136:139]
buffer_load_dwordx4 a[48:51], v2, s[8:11], s29 offen offset:2048
v_mfma_f32_16x16x32_bf16 v[80:83], v[224:227], a[76:79], v[80:83]
buffer_load_dwordx4 a[52:55], v2, s[8:11], s29 offen offset:3072
v_mfma_f32_16x16x32_bf16 v[100:103], v[228:231], a[76:79], v[100:103]
buffer_load_dwordx4 a[56:59], v3, s[8:11], s29 offen
v_mfma_f32_16x16x32_bf16 v[120:123], v[232:235], a[76:79], v[120:123]
s_add_u32 s29, s29, 131072
v_mfma_f32_16x16x32_bf16 v[140:143], v[236:239], a[76:79], v[140:143]
s_waitcnt lgkmcnt(0)
s_waitcnt vmcnt(18)
v_mfma_f32_16x16x32_bf16 v[64:67], v[208:211], a[0:3], v[64:67]
ds_read_b64_tr_b16 v[224:225], v8 offset:4096
s_add_u32 m0, s30, 0
v_mfma_f32_16x16x32_bf16 v[84:87], v[212:215], a[0:3], v[84:87]
ds_read_b64_tr_b16 v[226:227], v8 offset:5120
v_mfma_f32_16x16x32_bf16 v[104:107], v[216:219], a[0:3], v[104:107]
ds_read_b64_tr_b16 v[228:229], v9 offset:4096
v_mfma_f32_16x16x32_bf16 v[124:127], v[220:223], a[0:3], v[124:127]
ds_read_b64_tr_b16 v[230:231], v9 offset:5120
v_mfma_f32_16x16x32_bf16 v[68:71], v[208:211], a[4:7], v[68:71]
ds_read_b64_tr_b16 v[232:233], v10 offset:4096
v_mfma_f32_16x16x32_bf16 v[88:91], v[212:215], a[4:7], v[88:91]
ds_read_b64_tr_b16 v[234:235], v10 offset:5120
v_mfma_f32_16x16x32_bf16 v[108:111], v[216:219], a[4:7], v[108:111]
ds_read_b64_tr_b16 v[236:237], v11 offset:4096
v_mfma_f32_16x16x32_bf16 v[128:131], v[220:223], a[4:7], v[128:131]
ds_read_b64_tr_b16 v[238:239], v11 offset:5120
v_mfma_f32_16x16x32_bf16 v[72:75], v[208:211], a[8:11], v[72:75]
buffer_load_dwordx4 v4, s[4:7], s28 offen offset:0 lds
v_mfma_f32_16x16x32_bf16 v[92:95], v[212:215], a[8:11], v[92:95]
buffer_load_dwordx4 v5, s[4:7], s28 offen offset:1024 lds
v_mfma_f32_16x16x32_bf16 v[112:115], v[216:219], a[8:11], v[112:115]
buffer_load_dwordx4 v6, s[4:7], s28 offen offset:2048 lds
v_mfma_f32_16x16x32_bf16 v[132:135], v[220:223], a[8:11], v[132:135]
buffer_load_dwordx4 v7, s[4:7], s28 offen offset:3072 lds
v_mfma_f32_16x16x32_bf16 v[76:79], v[208:211], a[12:15], v[76:79]
s_add_u32 s28, s28, 36864
v_mfma_f32_16x16x32_bf16 v[96:99], v[212:215], a[12:15], v[96:99]
buffer_load_dwordx4 a[60:63], v2, s[8:11], s29 offen offset:0
v_mfma_f32_16x16x32_bf16 v[116:119], v[216:219], a[12:15], v[116:119]
buffer_load_dwordx4 a[64:67], v2, s[8:11], s29 offen offset:1024
v_mfma_f32_16x16x32_bf16 v[136:139], v[220:223], a[12:15], v[136:139]
buffer_load_dwordx4 a[68:71], v2, s[8:11], s29 offen offset:2048
v_mfma_f32_16x16x32_bf16 v[80:83], v[208:211], a[16:19], v[80:83]
buffer_load_dwordx4 a[72:75], v2, s[8:11], s29 offen offset:3072
v_mfma_f32_16x16x32_bf16 v[100:103], v[212:215], a[16:19], v[100:103]
buffer_load_dwordx4 a[76:79], v3, s[8:11], s29 offen
v_mfma_f32_16x16x32_bf16 v[120:123], v[216:219], a[16:19], v[120:123]
s_add_u32 s29, s29, 131072
v_mfma_f32_16x16x32_bf16 v[140:143], v[220:223], a[16:19], v[140:143]
s_waitcnt lgkmcnt(0)
s_waitcnt vmcnt(18)
v_mfma_f32_16x16x32_bf16 v[64:67], v[224:227], a[20:23], v[64:67]
ds_read_b64_tr_b16 v[208:209], v8 offset:8192
s_add_u32 m0, s30, 4096
v_mfma_f32_16x16x32_bf16 v[84:87], v[228:231], a[20:23], v[84:87]
ds_read_b64_tr_b16 v[210:211], v8 offset:9216
v_mfma_f32_16x16x32_bf16 v[104:107], v[232:235], a[20:23], v[104:107]
ds_read_b64_tr_b16 v[212:213], v9 offset:8192
v_mfma_f32_16x16x32_bf16 v[124:127], v[236:239], a[20:23], v[124:127]
ds_read_b64_tr_b16 v[214:215], v9 offset:9216
v_mfma_f32_16x16x32_bf16 v[68:71], v[224:227], a[24:27], v[68:71]
ds_read_b64_tr_b16 v[216:217], v10 offset:8192
v_mfma_f32_16x16x32_bf16 v[88:91], v[228:231], a[24:27], v[88:91]
ds_read_b64_tr_b16 v[218:219], v10 offset:9216
v_mfma_f32_16x16x32_bf16 v[108:111], v[232:235], a[24:27], v[108:111]
tp1_p1:
s_cbranch_execz tp1_ret
tf_p2:
s_cbranch_execz k12_kernel_end
ds_read_b64_tr_b16 v[220:221], v11 offset:8192
v_mfma_f32_16x16x32_bf16 v[128:131], v[236:239], a[24:27], v[128:131]
ds_read_b64_tr_b16 v[222:223], v11 offset:9216
v_mfma_f32_16x16x32_bf16 v[72:75], v[224:227], a[28:31], v[72:75]
buffer_load_dwordx4 v4, s[4:7], s28 offen offset:0 lds
v_mfma_f32_16x16x32_bf16 v[92:95], v[228:231], a[28:31], v[92:95]
buffer_load_dwordx4 v5, s[4:7], s28 offen offset:1024 lds
v_mfma_f32_16x16x32_bf16 v[112:115], v[232:235], a[28:31], v[112:115]
buffer_load_dwordx4 v6, s[4:7], s28 offen offset:2048 lds
v_mfma_f32_16x16x32_bf16 v[132:135], v[236:239], a[28:31], v[132:135]
buffer_load_dwordx4 v7, s[4:7], s28 offen offset:3072 lds
v_mfma_f32_16x16x32_bf16 v[76:79], v[224:227], a[32:35], v[76:79]
s_add_u32 s28, s28, 36864
v_mfma_f32_16x16x32_bf16 v[96:99], v[228:231], a[32:35], v[96:99]
buffer_load_dwordx4 a[0:3], v2, s[8:11], s29 offen offset:0
v_mfma_f32_16x16x32_bf16 v[116:119], v[232:235], a[32:35], v[116:119]
buffer_load_dwordx4 a[4:7], v2, s[8:11], s29 offen offset:1024
v_mfma_f32_16x16x32_bf16 v[136:139], v[236:239], a[32:35], v[136:139]
buffer_load_dwordx4 a[8:11], v2, s[8:11], s29 offen offset:2048
v_mfma_f32_16x16x32_bf16 v[80:83], v[224:227], a[36:39], v[80:83]
buffer_load_dwordx4 a[12:15], v2, s[8:11], s29 offen offset:3072
v_mfma_f32_16x16x32_bf16 v[100:103], v[228:231], a[36:39], v[100:103]
buffer_load_dwordx4 a[16:19], v3, s[8:11], s29 offen
v_mfma_f32_16x16x32_bf16 v[120:123], v[232:235], a[36:39], v[120:123]
s_add_u32 s29, s29, 131072
v_mfma_f32_16x16x32_bf16 v[140:143], v[236:239], a[36:39], v[140:143]
s_waitcnt lgkmcnt(0)
s_waitcnt vmcnt(18)
v_mfma_f32_16x16x32_bf16 v[64:67], v[208:211], a[40:43], v[64:67]
ds_read_b64_tr_b16 v[224:225], v8 offset:12288
s_add_u32 m0, s30, 8192
v_mfma_f32_16x16x32_bf16 v[84:87], v[212:215], a[40:43], v[84:87]
ds_read_b64_tr_b16 v[226:227], v8 offset:13312
v_mfma_f32_16x16x32_bf16 v[104:107], v[216:219], a[40:43], v[104:107]
ds_read_b64_tr_b16 v[228:229], v9 offset:12288
v_mfma_f32_16x16x32_bf16 v[124:127], v[220:223], a[40:43], v[124:127]
ds_read_b64_tr_b16 v[230:231], v9 offset:13312
v_mfma_f32_16x16x32_bf16 v[68:71], v[208:211], a[44:47], v[68:71]
ds_read_b64_tr_b16 v[232:233], v10 offset:12288
v_mfma_f32_16x16x32_bf16 v[88:91], v[212:215], a[44:47], v[88:91]
ds_read_b64_tr_b16 v[234:235], v10 offset:13312
v_mfma_f32_16x16x32_bf16 v[108:111], v[216:219], a[44:47], v[108:111]
ds_read_b64_tr_b16 v[236:237], v11 offset:12288
v_mfma_f32_16x16x32_bf16 v[128:131], v[220:223], a[44:47], v[128:131]
ds_read_b64_tr_b16 v[238:239], v11 offset:13312
v_mfma_f32_16x16x32_bf16 v[72:75], v[208:211], a[48:51], v[72:75]
buffer_load_dwordx4 v4, s[4:7], s28 offen offset:0 lds
v_mfma_f32_16x16x32_bf16 v[92:95], v[212:215], a[48:51], v[92:95]
buffer_load_dwordx4 v5, s[4:7], s28 offen offset:1024 lds
v_mfma_f32_16x16x32_bf16 v[112:115], v[216:219], a[48:51], v[112:115]
buffer_load_dwordx4 v6, s[4:7], s28 offen offset:2048 lds
v_mfma_f32_16x16x32_bf16 v[132:135], v[220:223], a[48:51], v[132:135]
buffer_load_dwordx4 v7, s[4:7], s28 offen offset:3072 lds
v_mfma_f32_16x16x32_bf16 v[76:79], v[208:211], a[52:55], v[76:79]
s_add_u32 s28, s28, 36864
v_mfma_f32_16x16x32_bf16 v[96:99], v[212:215], a[52:55], v[96:99]
buffer_load_dwordx4 a[20:23], v2, s[8:11], s29 offen offset:0
v_mfma_f32_16x16x32_bf16 v[116:119], v[216:219], a[52:55], v[116:119]
buffer_load_dwordx4 a[24:27], v2, s[8:11], s29 offen offset:1024
v_mfma_f32_16x16x32_bf16 v[136:139], v[220:223], a[52:55], v[136:139]
buffer_load_dwordx4 a[28:31], v2, s[8:11], s29 offen offset:2048
v_mfma_f32_16x16x32_bf16 v[80:83], v[208:211], a[56:59], v[80:83]
buffer_load_dwordx4 a[32:35], v2, s[8:11], s29 offen offset:3072
v_mfma_f32_16x16x32_bf16 v[100:103], v[212:215], a[56:59], v[100:103]
buffer_load_dwordx4 a[36:39], v3, s[8:11], s29 offen
v_mfma_f32_16x16x32_bf16 v[120:123], v[216:219], a[56:59], v[120:123]
s_add_u32 s29, s29, 131072
v_mfma_f32_16x16x32_bf16 v[140:143], v[220:223], a[56:59], v[140:143]
s_waitcnt lgkmcnt(0)
s_waitcnt vmcnt(18)
v_mfma_f32_16x16x32_bf16 v[64:67], v[224:227], a[60:63], v[64:67]
ds_read_b64_tr_b16 v[208:209], v8 offset:0
s_add_u32 m0, s30, 12288
v_mfma_f32_16x16x32_bf16 v[84:87], v[228:231], a[60:63], v[84:87]
ds_read_b64_tr_b16 v[210:211], v8 offset:1024
v_mfma_f32_16x16x32_bf16 v[104:107], v[232:235], a[60:63], v[104:107]
ds_read_b64_tr_b16 v[212:213], v9 offset:0
v_mfma_f32_16x16x32_bf16 v[124:127], v[236:239], a[60:63], v[124:127]
ds_read_b64_tr_b16 v[214:215], v9 offset:1024
v_mfma_f32_16x16x32_bf16 v[68:71], v[224:227], a[64:67], v[68:71]
ds_read_b64_tr_b16 v[216:217], v10 offset:0
v_mfma_f32_16x16x32_bf16 v[88:91], v[228:231], a[64:67], v[88:91]
ds_read_b64_tr_b16 v[218:219], v10 offset:1024
v_mfma_f32_16x16x32_bf16 v[108:111], v[232:235], a[64:67], v[108:111]
ds_read_b64_tr_b16 v[220:221], v11 offset:0
v_mfma_f32_16x16x32_bf16 v[128:131], v[236:239], a[64:67], v[128:131]
ds_read_b64_tr_b16 v[222:223], v11 offset:1024
v_mfma_f32_16x16x32_bf16 v[72:75], v[224:227], a[68:71], v[72:75]
buffer_load_dwordx4 v4, s[4:7], s28 offen offset:0 lds
v_mfma_f32_16x16x32_bf16 v[92:95], v[228:231], a[68:71], v[92:95]
buffer_load_dwordx4 v5, s[4:7], s28 offen offset:1024 lds
v_mfma_f32_16x16x32_bf16 v[112:115], v[232:235], a[68:71], v[112:115]
buffer_load_dwordx4 v6, s[4:7], s28 offen offset:2048 lds
v_mfma_f32_16x16x32_bf16 v[132:135], v[236:239], a[68:71], v[132:135]
buffer_load_dwordx4 v7, s[4:7], s28 offen offset:3072 lds
v_mfma_f32_16x16x32_bf16 v[76:79], v[224:227], a[72:75], v[76:79]
s_add_u32 s28, s28, 36864
v_mfma_f32_16x16x32_bf16 v[96:99], v[228:231], a[72:75], v[96:99]
buffer_load_dwordx4 a[40:43], v2, s[8:11], s29 offen offset:0
v_mfma_f32_16x16x32_bf16 v[116:119], v[232:235], a[72:75], v[116:119]
buffer_load_dwordx4 a[44:47], v2, s[8:11], s29 offen offset:1024
v_mfma_f32_16x16x32_bf16 v[136:139], v[236:239], a[72:75], v[136:139]
buffer_load_dwordx4 a[48:51], v2, s[8:11], s29 offen offset:2048
v_mfma_f32_16x16x32_bf16 v[80:83], v[224:227], a[76:79], v[80:83]
buffer_load_dwordx4 a[52:55], v2, s[8:11], s29 offen offset:3072
v_mfma_f32_16x16x32_bf16 v[100:103], v[228:231], a[76:79], v[100:103]
buffer_load_dwordx4 a[56:59], v3, s[8:11], s29 offen
v_mfma_f32_16x16x32_bf16 v[120:123], v[232:235], a[76:79], v[120:123]
s_add_u32 s29, s29, 131072
v_mfma_f32_16x16x32_bf16 v[140:143], v[236:239], a[76:79], v[140:143]
s_waitcnt lgkmcnt(0)
s_waitcnt vmcnt(18)
v_mfma_f32_16x16x32_bf16 v[64:67], v[208:211], a[0:3], v[64:67]
ds_read_b64_tr_b16 v[224:225], v8 offset:4096
s_add_u32 m0, s30, 0
v_mfma_f32_16x16x32_bf16 v[84:87], v[212:215], a[0:3], v[84:87]
ds_read_b64_tr_b16 v[226:227], v8 offset:5120
v_mfma_f32_16x16x32_bf16 v[104:107], v[216:219], a[0:3], v[104:107]
ds_read_b64_tr_b16 v[228:229], v9 offset:4096
v_mfma_f32_16x16x32_bf16 v[124:127], v[220:223], a[0:3], v[124:127]
ds_read_b64_tr_b16 v[230:231], v9 offset:5120
v_mfma_f32_16x16x32_bf16 v[68:71], v[208:211], a[4:7], v[68:71]
ds_read_b64_tr_b16 v[232:233], v10 offset:4096
v_mfma_f32_16x16x32_bf16 v[88:91], v[212:215], a[4:7], v[88:91]
ds_read_b64_tr_b16 v[234:235], v10 offset:5120
v_mfma_f32_16x16x32_bf16 v[108:111], v[216:219], a[4:7], v[108:111]
ds_read_b64_tr_b16 v[236:237], v11 offset:4096
v_mfma_f32_16x16x32_bf16 v[128:131], v[220:223], a[4:7], v[128:131]
ds_read_b64_tr_b16 v[238:239], v11 offset:5120
v_mfma_f32_16x16x32_bf16 v[72:75], v[208:211], a[8:11], v[72:75]
buffer_load_dwordx4 v4, s[4:7], s28 offen offset:0 lds
v_mfma_f32_16x16x32_bf16 v[92:95], v[212:215], a[8:11], v[92:95]
buffer_load_dwordx4 v5, s[4:7], s28 offen offset:1024 lds
v_mfma_f32_16x16x32_bf16 v[112:115], v[216:219], a[8:11], v[112:115]
buffer_load_dwordx4 v6, s[4:7], s28 offen offset:2048 lds
v_mfma_f32_16x16x32_bf16 v[132:135], v[220:223], a[8:11], v[132:135]
buffer_load_dwordx4 v7, s[4:7], s28 offen offset:3072 lds
v_mfma_f32_16x16x32_bf16 v[76:79], v[208:211], a[12:15], v[76:79]
s_add_u32 s28, s28, 36864
v_mfma_f32_16x16x32_bf16 v[96:99], v[212:215], a[12:15], v[96:99]
buffer_load_dwordx4 a[60:63], v2, s[8:11], s29 offen offset:0
v_mfma_f32_16x16x32_bf16 v[116:119], v[216:219], a[12:15], v[116:119]
buffer_load_dwordx4 a[64:67], v2, s[8:11], s29 offen offset:1024
v_mfma_f32_16x16x32_bf16 v[136:139], v[220:223], a[12:15], v[136:139]
buffer_load_dwordx4 a[68:71], v2, s[8:11], s29 offen offset:2048
v_mfma_f32_16x16x32_bf16 v[80:83], v[208:211], a[16:19], v[80:83]
buffer_load_dwordx4 a[72:75], v2, s[8:11], s29 offen offset:3072
v_mfma_f32_16x16x32_bf16 v[100:103], v[212:215], a[16:19], v[100:103]
buffer_load_dwordx4 a[76:79], v3, s[8:11], s29 offen
v_mfma_f32_16x16x32_bf16 v[120:123], v[216:219], a[16:19], v[120:123]
s_add_u32 s29, s29, 131072
v_mfma_f32_16x16x32_bf16 v[140:143], v[220:223], a[16:19], v[140:143]
s_waitcnt lgkmcnt(0)
s_waitcnt vmcnt(18)
v_mfma_f32_16x16x32_bf16 v[64:67], v[224:227], a[20:23], v[64:67]
ds_read_b64_tr_b16 v[208:209], v8 offset:8192
s_add_u32 m0, s30, 4096
v_mfma_f32_16x16x32_bf16 v[84:87], v[228:231], a[20:23], v[84:87]
ds_read_b64_tr_b16 v[210:211], v8 offset:9216
v_mfma_f32_16x16x32_bf16 v[104:107], v[232:235], a[20:23], v[104:107]
ds_read_b64_tr_b16 v[212:213], v9 offset:8192
v_mfma_f32_16x16x32_bf16 v[124:127], v[236:239], a[20:23], v[124:127]
ds_read_b64_tr_b16 v[214:215], v9 offset:9216
v_mfma_f32_16x16x32_bf16 v[68:71], v[224:227], a[24:27], v[68:71]
ds_read_b64_tr_b16 v[216:217], v10 offset:8192
v_mfma_f32_16x16x32_bf16 v[88:91], v[228:231], a[24:27], v[88:91]
ds_read_b64_tr_b16 v[218:219], v10 offset:9216
v_mfma_f32_16x16x32_bf16 v[108:111], v[232:235], a[24:27], v[108:111]
ds_read_b64_tr_b16 v[220:221], v11 offset:8192
v_mfma_f32_16x16x32_bf16 v[128:131], v[236:239], a[24:27], v[128:131]
ds_read_b64_tr_b16 v[222:223], v11 offset:9216
v_mfma_f32_16x16x32_bf16 v[72:75], v[224:227], a[28:31], v[72:75]
buffer_load_dwordx4 v4, s[4:7], s28 offen offset:0 lds
v_mfma_f32_16x16x32_bf16 v[92:95], v[228:231], a[28:31], v[92:95]
buffer_load_dwordx4 v5, s[4:7], s28 offen offset:1024 lds
v_mfma_f32_16x16x32_bf16 v[112:115], v[232:235], a[28:31], v[112:115]
buffer_load_dwordx4 v6, s[4:7], s28 offen offset:2048 lds
v_mfma_f32_16x16x32_bf16 v[132:135], v[236:239], a[28:31], v[132:135]
buffer_load_dwordx4 v7, s[4:7], s28 offen offset:3072 lds
v_mfma_f32_16x16x32_bf16 v[76:79], v[224:227], a[32:35], v[76:79]
s_add_u32 s28, s28, 36864
v_mfma_f32_16x16x32_bf16 v[96:99], v[228:231], a[32:35], v[96:99]
buffer_load_dwordx4 a[0:3], v2, s[8:11], s29 offen offset:0
v_mfma_f32_16x16x32_bf16 v[116:119], v[232:235], a[32:35], v[116:119]
buffer_load_dwordx4 a[4:7], v2, s[8:11], s29 offen offset:1024
v_mfma_f32_16x16x32_bf16 v[136:139], v[236:239], a[32:35], v[136:139]
buffer_load_dwordx4 a[8:11], v2, s[8:11], s29 offen offset:2048
v_mfma_f32_16x16x32_bf16 v[80:83], v[224:227], a[36:39], v[80:83]
buffer_load_dwordx4 a[12:15], v2, s[8:11], s29 offen offset:3072
v_mfma_f32_16x16x32_bf16 v[100:103], v[228:231], a[36:39], v[100:103]
buffer_load_dwordx4 a[16:19], v3, s[8:11], s29 offen
v_mfma_f32_16x16x32_bf16 v[120:123], v[232:235], a[36:39], v[120:123]
s_add_u32 s29, s29, 131072
v_mfma_f32_16x16x32_bf16 v[140:143], v[236:239], a[36:39], v[140:143]
s_waitcnt lgkmcnt(0)
s_waitcnt vmcnt(18)
v_mfma_f32_16x16x32_bf16 v[64:67], v[208:211], a[40:43], v[64:67]
ds_read_b64_tr_b16 v[224:225], v8 offset:12288
s_add_u32 m0, s30, 8192
v_mfma_f32_16x16x32_bf16 v[84:87], v[212:215], a[40:43], v[84:87]
ds_read_b64_tr_b16 v[226:227], v8 offset:13312
v_mfma_f32_16x16x32_bf16 v[104:107], v[216:219], a[40:43], v[104:107]
ds_read_b64_tr_b16 v[228:229], v9 offset:12288
v_mfma_f32_16x16x32_bf16 v[124:127], v[220:223], a[40:43], v[124:127]
ds_read_b64_tr_b16 v[230:231], v9 offset:13312
v_mfma_f32_16x16x32_bf16 v[68:71], v[208:211], a[44:47], v[68:71]
ds_read_b64_tr_b16 v[232:233], v10 offset:12288
v_mfma_f32_16x16x32_bf16 v[88:91], v[212:215], a[44:47], v[88:91]
ds_read_b64_tr_b16 v[234:235], v10 offset:13312
v_mfma_f32_16x16x32_bf16 v[108:111], v[216:219], a[44:47], v[108:111]
ds_read_b64_tr_b16 v[236:237], v11 offset:12288
v_mfma_f32_16x16x32_bf16 v[128:131], v[220:223], a[44:47], v[128:131]
ds_read_b64_tr_b16 v[238:239], v11 offset:13312
v_mfma_f32_16x16x32_bf16 v[72:75], v[208:211], a[48:51], v[72:75]
buffer_load_dwordx4 v4, s[4:7], s28 offen offset:0 lds
v_mfma_f32_16x16x32_bf16 v[92:95], v[212:215], a[48:51], v[92:95]
buffer_load_dwordx4 v5, s[4:7], s28 offen offset:1024 lds
v_mfma_f32_16x16x32_bf16 v[112:115], v[216:219], a[48:51], v[112:115]
buffer_load_dwordx4 v6, s[4:7], s28 offen offset:2048 lds
v_mfma_f32_16x16x32_bf16 v[132:135], v[220:223], a[48:51], v[132:135]
buffer_load_dwordx4 v7, s[4:7], s28 offen offset:3072 lds
v_mfma_f32_16x16x32_bf16 v[76:79], v[208:211], a[52:55], v[76:79]
s_add_u32 s28, s28, 36864
v_mfma_f32_16x16x32_bf16 v[96:99], v[212:215], a[52:55], v[96:99]
buffer_load_dwordx4 a[20:23], v2, s[8:11], s29 offen offset:0
v_mfma_f32_16x16x32_bf16 v[116:119], v[216:219], a[52:55], v[116:119]
buffer_load_dwordx4 a[24:27], v2, s[8:11], s29 offen offset:1024
v_mfma_f32_16x16x32_bf16 v[136:139], v[220:223], a[52:55], v[136:139]
buffer_load_dwordx4 a[28:31], v2, s[8:11], s29 offen offset:2048
v_mfma_f32_16x16x32_bf16 v[80:83], v[208:211], a[56:59], v[80:83]
buffer_load_dwordx4 a[32:35], v2, s[8:11], s29 offen offset:3072
v_mfma_f32_16x16x32_bf16 v[100:103], v[212:215], a[56:59], v[100:103]
buffer_load_dwordx4 a[36:39], v3, s[8:11], s29 offen
v_mfma_f32_16x16x32_bf16 v[120:123], v[216:219], a[56:59], v[120:123]
s_add_u32 s29, s29, 131072
v_mfma_f32_16x16x32_bf16 v[140:143], v[220:223], a[56:59], v[140:143]
s_waitcnt lgkmcnt(0)
s_waitcnt vmcnt(18)
v_mfma_f32_16x16x32_bf16 v[64:67], v[224:227], a[60:63], v[64:67]
ds_read_b64_tr_b16 v[208:209], v8 offset:0
s_add_u32 m0, s30, 12288
v_mfma_f32_16x16x32_bf16 v[84:87], v[228:231], a[60:63], v[84:87]
ds_read_b64_tr_b16 v[210:211], v8 offset:1024
v_mfma_f32_16x16x32_bf16 v[104:107], v[232:235], a[60:63], v[104:107]
ds_read_b64_tr_b16 v[212:213], v9 offset:0
v_mfma_f32_16x16x32_bf16 v[124:127], v[236:239], a[60:63], v[124:127]
ds_read_b64_tr_b16 v[214:215], v9 offset:1024
v_mfma_f32_16x16x32_bf16 v[68:71], v[224:227], a[64:67], v[68:71]
ds_read_b64_tr_b16 v[216:217], v10 offset:0
v_mfma_f32_16x16x32_bf16 v[88:91], v[228:231], a[64:67], v[88:91]
ds_read_b64_tr_b16 v[218:219], v10 offset:1024
v_mfma_f32_16x16x32_bf16 v[108:111], v[232:235], a[64:67], v[108:111]
ds_read_b64_tr_b16 v[220:221], v11 offset:0
v_mfma_f32_16x16x32_bf16 v[128:131], v[236:239], a[64:67], v[128:131]
ds_read_b64_tr_b16 v[222:223], v11 offset:1024
v_mfma_f32_16x16x32_bf16 v[72:75], v[224:227], a[68:71], v[72:75]
buffer_load_dwordx4 v4, s[4:7], s28 offen offset:0 lds
v_mfma_f32_16x16x32_bf16 v[92:95], v[228:231], a[68:71], v[92:95]
buffer_load_dwordx4 v5, s[4:7], s28 offen offset:1024 lds
v_mfma_f32_16x16x32_bf16 v[112:115], v[232:235], a[68:71], v[112:115]
buffer_load_dwordx4 v6, s[4:7], s28 offen offset:2048 lds
v_mfma_f32_16x16x32_bf16 v[132:135], v[236:239], a[68:71], v[132:135]
buffer_load_dwordx4 v7, s[4:7], s28 offen offset:3072 lds
v_mfma_f32_16x16x32_bf16 v[76:79], v[224:227], a[72:75], v[76:79]
s_add_u32 s28, s28, 36864
v_mfma_f32_16x16x32_bf16 v[96:99], v[228:231], a[72:75], v[96:99]
buffer_load_dwordx4 a[40:43], v2, s[8:11], s29 offen offset:0
v_mfma_f32_16x16x32_bf16 v[116:119], v[232:235], a[72:75], v[116:119]
buffer_load_dwordx4 a[44:47], v2, s[8:11], s29 offen offset:1024
v_mfma_f32_16x16x32_bf16 v[136:139], v[236:239], a[72:75], v[136:139]
buffer_load_dwordx4 a[48:51], v2, s[8:11], s29 offen offset:2048
v_mfma_f32_16x16x32_bf16 v[80:83], v[224:227], a[76:79], v[80:83]
buffer_load_dwordx4 a[52:55], v2, s[8:11], s29 offen offset:3072
v_mfma_f32_16x16x32_bf16 v[100:103], v[228:231], a[76:79], v[100:103]
buffer_load_dwordx4 a[56:59], v3, s[8:11], s29 offen
v_mfma_f32_16x16x32_bf16 v[120:123], v[232:235], a[76:79], v[120:123]
s_add_u32 s29, s29, 131072
v_mfma_f32_16x16x32_bf16 v[140:143], v[236:239], a[76:79], v[140:143]
s_waitcnt lgkmcnt(0)
s_waitcnt vmcnt(18)
v_mfma_f32_16x16x32_bf16 v[64:67], v[208:211], a[0:3], v[64:67]
ds_read_b64_tr_b16 v[224:225], v8 offset:4096
v_mfma_f32_16x16x32_bf16 v[84:87], v[212:215], a[0:3], v[84:87]
ds_read_b64_tr_b16 v[226:227], v8 offset:5120
v_mfma_f32_16x16x32_bf16 v[104:107], v[216:219], a[0:3], v[104:107]
ds_read_b64_tr_b16 v[228:229], v9 offset:4096
v_mfma_f32_16x16x32_bf16 v[124:127], v[220:223], a[0:3], v[124:127]
ds_read_b64_tr_b16 v[230:231], v9 offset:5120
v_mfma_f32_16x16x32_bf16 v[68:71], v[208:211], a[4:7], v[68:71]
ds_read_b64_tr_b16 v[232:233], v10 offset:4096
v_mfma_f32_16x16x32_bf16 v[88:91], v[212:215], a[4:7], v[88:91]
ds_read_b64_tr_b16 v[234:235], v10 offset:5120
v_mfma_f32_16x16x32_bf16 v[108:111], v[216:219], a[4:7], v[108:111]
ds_read_b64_tr_b16 v[236:237], v11 offset:4096
v_mfma_f32_16x16x32_bf16 v[128:131], v[220:223], a[4:7], v[128:131]
ds_read_b64_tr_b16 v[238:239], v11 offset:5120
v_mfma_f32_16x16x32_bf16 v[72:75], v[208:211], a[8:11], v[72:75]
buffer_load_dwordx4 a[60:63], v2, s[8:11], s29 offen offset:0
v_mfma_f32_16x16x32_bf16 v[92:95], v[212:215], a[8:11], v[92:95]
buffer_load_dwordx4 a[64:67], v2, s[8:11], s29 offen offset:1024
v_mfma_f32_16x16x32_bf16 v[112:115], v[216:219], a[8:11], v[112:115]
buffer_load_dwordx4 a[68:71], v2, s[8:11], s29 offen offset:2048
v_mfma_f32_16x16x32_bf16 v[132:135], v[220:223], a[8:11], v[132:135]
buffer_load_dwordx4 a[72:75], v2, s[8:11], s29 offen offset:3072
v_mfma_f32_16x16x32_bf16 v[76:79], v[208:211], a[12:15], v[76:79]
buffer_load_dwordx4 a[76:79], v3, s[8:11], s29 offen
v_mfma_f32_16x16x32_bf16 v[96:99], v[212:215], a[12:15], v[96:99]
v_mfma_f32_16x16x32_bf16 v[116:119], v[216:219], a[12:15], v[116:119]
v_mfma_f32_16x16x32_bf16 v[136:139], v[220:223], a[12:15], v[136:139]
s_add_u32 s29, s29, 131072
v_mfma_f32_16x16x32_bf16 v[80:83], v[208:211], a[16:19], v[80:83]
v_mfma_f32_16x16x32_bf16 v[100:103], v[212:215], a[16:19], v[100:103]
v_mfma_f32_16x16x32_bf16 v[120:123], v[216:219], a[16:19], v[120:123]
v_mfma_f32_16x16x32_bf16 v[140:143], v[220:223], a[16:19], v[140:143]
s_waitcnt lgkmcnt(0)
s_waitcnt vmcnt(14)
v_mfma_f32_16x16x32_bf16 v[64:67], v[224:227], a[20:23], v[64:67]
ds_read_b64_tr_b16 v[208:209], v8 offset:8192
s_mov_b32 s50, 0
v_mfma_f32_16x16x32_bf16 v[84:87], v[228:231], a[20:23], v[84:87]
ds_read_b64_tr_b16 v[210:211], v8 offset:9216
v_mfma_f32_16x16x32_bf16 v[104:107], v[232:235], a[20:23], v[104:107]
ds_read_b64_tr_b16 v[212:213], v9 offset:8192
v_mfma_f32_16x16x32_bf16 v[124:127], v[236:239], a[20:23], v[124:127]
ds_read_b64_tr_b16 v[214:215], v9 offset:9216
v_mfma_f32_16x16x32_bf16 v[68:71], v[224:227], a[24:27], v[68:71]
ds_read_b64_tr_b16 v[216:217], v10 offset:8192
v_mfma_f32_16x16x32_bf16 v[88:91], v[228:231], a[24:27], v[88:91]
ds_read_b64_tr_b16 v[218:219], v10 offset:9216
v_mfma_f32_16x16x32_bf16 v[108:111], v[232:235], a[24:27], v[108:111]
ds_read_b64_tr_b16 v[220:221], v11 offset:8192
v_mfma_f32_16x16x32_bf16 v[128:131], v[236:239], a[24:27], v[128:131]
ds_read_b64_tr_b16 v[222:223], v11 offset:9216
v_mfma_f32_16x16x32_bf16 v[72:75], v[224:227], a[28:31], v[72:75]
buffer_load_dwordx2 v[32:33], v52, s[12:15], s50 offen
v_mfma_f32_16x16x32_bf16 v[92:95], v[228:231], a[28:31], v[92:95]
s_mov_b32 s50, 18432
v_mfma_f32_16x16x32_bf16 v[112:115], v[232:235], a[28:31], v[112:115]
buffer_load_dwordx2 v[34:35], v52, s[12:15], s50 offen
v_mfma_f32_16x16x32_bf16 v[132:135], v[236:239], a[28:31], v[132:135]
s_mov_b32 s50, 36864
v_mfma_f32_16x16x32_bf16 v[76:79], v[224:227], a[32:35], v[76:79]
buffer_load_dwordx2 v[36:37], v52, s[12:15], s50 offen
v_mfma_f32_16x16x32_bf16 v[96:99], v[228:231], a[32:35], v[96:99]
s_mov_b32 s50, 55296
v_mfma_f32_16x16x32_bf16 v[116:119], v[232:235], a[32:35], v[116:119]
buffer_load_dwordx2 v[38:39], v52, s[12:15], s50 offen
v_mfma_f32_16x16x32_bf16 v[136:139], v[236:239], a[32:35], v[136:139]
s_mov_b32 s50, 73728
v_mfma_f32_16x16x32_bf16 v[80:83], v[224:227], a[36:39], v[80:83]
v_mfma_f32_16x16x32_bf16 v[100:103], v[228:231], a[36:39], v[100:103]
buffer_load_dwordx2 v[40:41], v52, s[12:15], s50 offen
v_mfma_f32_16x16x32_bf16 v[120:123], v[232:235], a[36:39], v[120:123]
v_mfma_f32_16x16x32_bf16 v[140:143], v[236:239], a[36:39], v[140:143]
s_waitcnt lgkmcnt(0)
s_waitcnt vmcnt(10)
v_mfma_f32_16x16x32_bf16 v[64:67], v[208:211], a[40:43], v[64:67]
ds_read_b64_tr_b16 v[224:225], v8 offset:12288
v_mfma_f32_16x16x32_bf16 v[84:87], v[212:215], a[40:43], v[84:87]
ds_read_b64_tr_b16 v[226:227], v8 offset:13312
v_mfma_f32_16x16x32_bf16 v[104:107], v[216:219], a[40:43], v[104:107]
ds_read_b64_tr_b16 v[228:229], v9 offset:12288
v_mfma_f32_16x16x32_bf16 v[124:127], v[220:223], a[40:43], v[124:127]
ds_read_b64_tr_b16 v[230:231], v9 offset:13312
v_mfma_f32_16x16x32_bf16 v[68:71], v[208:211], a[44:47], v[68:71]
ds_read_b64_tr_b16 v[232:233], v10 offset:12288
v_mfma_f32_16x16x32_bf16 v[88:91], v[212:215], a[44:47], v[88:91]
ds_read_b64_tr_b16 v[234:235], v10 offset:13312
v_mfma_f32_16x16x32_bf16 v[108:111], v[216:219], a[44:47], v[108:111]
ds_read_b64_tr_b16 v[236:237], v11 offset:12288
v_mfma_f32_16x16x32_bf16 v[128:131], v[220:223], a[44:47], v[128:131]
ds_read_b64_tr_b16 v[238:239], v11 offset:13312
v_mfma_f32_16x16x32_bf16 v[72:75], v[208:211], a[48:51], v[72:75]
v_mfma_f32_16x16x32_bf16 v[92:95], v[212:215], a[48:51], v[92:95]
v_mfma_f32_16x16x32_bf16 v[112:115], v[216:219], a[48:51], v[112:115]
v_mfma_f32_16x16x32_bf16 v[132:135], v[220:223], a[48:51], v[132:135]
v_mfma_f32_16x16x32_bf16 v[76:79], v[208:211], a[52:55], v[76:79]
v_mfma_f32_16x16x32_bf16 v[96:99], v[212:215], a[52:55], v[96:99]
v_mfma_f32_16x16x32_bf16 v[116:119], v[216:219], a[52:55], v[116:119]
v_mfma_f32_16x16x32_bf16 v[136:139], v[220:223], a[52:55], v[136:139]
v_mfma_f32_16x16x32_bf16 v[80:83], v[208:211], a[56:59], v[80:83]
v_mfma_f32_16x16x32_bf16 v[100:103], v[212:215], a[56:59], v[100:103]
v_mfma_f32_16x16x32_bf16 v[120:123], v[216:219], a[56:59], v[120:123]
v_mfma_f32_16x16x32_bf16 v[140:143], v[220:223], a[56:59], v[140:143]
s_waitcnt lgkmcnt(0)
s_waitcnt vmcnt(5)
v_mfma_f32_16x16x32_bf16 v[84:87], v[228:231], a[60:63], v[84:87]
v_mfma_f32_16x16x32_bf16 v[88:91], v[228:231], a[64:67], v[88:91]
v_mfma_f32_16x16x32_bf16 v[92:95], v[228:231], a[68:71], v[92:95]
v_mfma_f32_16x16x32_bf16 v[96:99], v[228:231], a[72:75], v[96:99]
ds_write_b128 v48, v[84:87] offset:0
v_mfma_f32_16x16x32_bf16 v[100:103], v[228:231], a[76:79], v[100:103]
ds_write_b128 v48, v[88:91] offset:1024
v_mfma_f32_16x16x32_bf16 v[104:107], v[232:235], a[60:63], v[104:107]
ds_write_b128 v48, v[92:95] offset:2048
v_mfma_f32_16x16x32_bf16 v[108:111], v[232:235], a[64:67], v[108:111]
ds_write_b128 v48, v[96:99] offset:3072
v_mfma_f32_16x16x32_bf16 v[112:115], v[232:235], a[68:71], v[112:115]
ds_write_b128 v48, v[100:103] offset:4096
v_mfma_f32_16x16x32_bf16 v[116:119], v[232:235], a[72:75], v[116:119]
ds_write_b128 v48, v[104:107] offset:5120
v_mfma_f32_16x16x32_bf16 v[120:123], v[232:235], a[76:79], v[120:123]
ds_write_b128 v48, v[108:111] offset:6144
v_mfma_f32_16x16x32_bf16 v[124:127], v[236:239], a[60:63], v[124:127]
ds_write_b128 v48, v[112:115] offset:7168
v_mfma_f32_16x16x32_bf16 v[128:131], v[236:239], a[64:67], v[128:131]
ds_write_b128 v48, v[116:119] offset:8192
v_mfma_f32_16x16x32_bf16 v[132:135], v[236:239], a[68:71], v[132:135]
ds_write_b128 v48, v[120:123] offset:9216
v_mfma_f32_16x16x32_bf16 v[136:139], v[236:239], a[72:75], v[136:139]
ds_write_b128 v48, v[124:127] offset:10240
v_mfma_f32_16x16x32_bf16 v[140:143], v[236:239], a[76:79], v[140:143]
ds_write_b128 v48, v[128:131] offset:11264
v_mfma_f32_16x16x32_bf16 v[64:67], v[224:227], a[60:63], v[64:67]
ds_write_b128 v48, v[132:135] offset:12288
v_mfma_f32_16x16x32_bf16 v[68:71], v[224:227], a[64:67], v[68:71]
ds_write_b128 v48, v[136:139] offset:13312
v_mfma_f32_16x16x32_bf16 v[72:75], v[224:227], a[68:71], v[72:75]
ds_write_b128 v48, v[140:143] offset:14336
v_mfma_f32_16x16x32_bf16 v[76:79], v[224:227], a[72:75], v[76:79]
v_mfma_f32_16x16x32_bf16 v[80:83], v[224:227], a[76:79], v[80:83]
s_waitcnt lgkmcnt(0)
s_barrier
ds_read_b128 v[144:147], v49 offset:0
ds_read_b128 v[148:151], v49 offset:1024
ds_read_b128 v[152:155], v49 offset:2048
ds_read_b128 v[156:159], v49 offset:3072
ds_read_b128 v[160:163], v49 offset:4096
ds_read_b128 v[164:167], v50 offset:0
ds_read_b128 v[168:171], v50 offset:1024
ds_read_b128 v[172:175], v50 offset:2048
ds_read_b128 v[176:179], v50 offset:3072
ds_read_b128 v[180:183], v50 offset:4096
ds_read_b128 v[184:187], v51 offset:0
ds_read_b128 v[188:191], v51 offset:1024
ds_read_b128 v[192:195], v51 offset:2048
ds_read_b128 v[196:199], v51 offset:3072
ds_read_b128 v[200:203], v51 offset:4096
s_waitcnt vmcnt(0)
s_waitcnt lgkmcnt(10)
v_pk_add_f32 v[64:65], v[64:65], v[144:145]
v_pk_add_f32 v[66:67], v[66:67], v[146:147]
v_pk_add_f32 v[68:69], v[68:69], v[148:149]
v_pk_add_f32 v[70:71], v[70:71], v[150:151]
v_pk_add_f32 v[72:73], v[72:73], v[152:153]
v_pk_add_f32 v[74:75], v[74:75], v[154:155]
v_pk_add_f32 v[76:77], v[76:77], v[156:157]
v_pk_add_f32 v[78:79], v[78:79], v[158:159]
v_pk_add_f32 v[80:81], v[80:81], v[160:161]
v_pk_add_f32 v[82:83], v[82:83], v[162:163]
s_waitcnt lgkmcnt(5)
v_pk_add_f32 v[64:65], v[64:65], v[164:165]
v_pk_add_f32 v[66:67], v[66:67], v[166:167]
v_pk_add_f32 v[68:69], v[68:69], v[168:169]
v_pk_add_f32 v[70:71], v[70:71], v[170:171]
v_pk_add_f32 v[72:73], v[72:73], v[172:173]
v_pk_add_f32 v[74:75], v[74:75], v[174:175]
v_pk_add_f32 v[76:77], v[76:77], v[176:177]
v_pk_add_f32 v[78:79], v[78:79], v[178:179]
v_pk_add_f32 v[80:81], v[80:81], v[180:181]
v_pk_add_f32 v[82:83], v[82:83], v[182:183]
s_waitcnt lgkmcnt(0)
v_pk_add_f32 v[64:65], v[64:65], v[184:185]
v_pk_add_f32 v[66:67], v[66:67], v[186:187]
v_pk_add_f32 v[68:69], v[68:69], v[188:189]
v_pk_add_f32 v[70:71], v[70:71], v[190:191]
v_pk_add_f32 v[72:73], v[72:73], v[192:193]
v_pk_add_f32 v[74:75], v[74:75], v[194:195]
v_pk_add_f32 v[76:77], v[76:77], v[196:197]
v_pk_add_f32 v[78:79], v[78:79], v[198:199]
v_pk_add_f32 v[80:81], v[80:81], v[200:201]
v_pk_add_f32 v[82:83], v[82:83], v[202:203]
s_mul_i32 s53, s26, 5
v_lshlrev_b32 v160, 16, v32
v_and_b32 v161, 0xffff0000, v32
v_lshlrev_b32 v162, 16, v33
v_and_b32 v163, 0xffff0000, v33
v_add_f32 v160, v64, v160
v_add_f32 v161, v65, v161
v_add_f32 v162, v66, v162
v_add_f32 v163, v67, v163
v_cvt_pk_bf16_f32 v164, v160, v161
v_cvt_pk_bf16_f32 v165, v162, v163
s_add_u32 s54, s53, 0
s_cmp_lt_u32 s54, 128
s_cselect_b32 s56, 0, 0x40000000
buffer_store_dwordx2 v[164:165], v47, s[16:19], s56 offen sc1
v_lshlrev_b32 v168, 16, v34
v_and_b32 v169, 0xffff0000, v34
v_lshlrev_b32 v170, 16, v35
v_and_b32 v171, 0xffff0000, v35
v_add_f32 v168, v68, v168
v_add_f32 v169, v69, v169
v_add_f32 v170, v70, v170
v_add_f32 v171, v71, v171
v_cvt_pk_bf16_f32 v172, v168, v169
v_cvt_pk_bf16_f32 v173, v170, v171
s_add_u32 s54, s53, 1
s_cmp_lt_u32 s54, 128
s_cselect_b32 s57, 1024, 0x40000000
buffer_store_dwordx2 v[172:173], v47, s[16:19], s57 offen sc1
v_lshlrev_b32 v176, 16, v36
v_and_b32 v177, 0xffff0000, v36
v_lshlrev_b32 v178, 16, v37
v_and_b32 v179, 0xffff0000, v37
v_add_f32 v176, v72, v176
v_add_f32 v177, v73, v177
v_add_f32 v178, v74, v178
v_add_f32 v179, v75, v179
v_cvt_pk_bf16_f32 v180, v176, v177
v_cvt_pk_bf16_f32 v181, v178, v179
s_add_u32 s54, s53, 2
s_cmp_lt_u32 s54, 128
s_cselect_b32 s58, 2048, 0x40000000
buffer_store_dwordx2 v[180:181], v47, s[16:19], s58 offen sc1
v_lshlrev_b32 v184, 16, v38
v_and_b32 v185, 0xffff0000, v38
v_lshlrev_b32 v186, 16, v39
v_and_b32 v187, 0xffff0000, v39
v_add_f32 v184, v76, v184
v_add_f32 v185, v77, v185
v_add_f32 v186, v78, v186
v_add_f32 v187, v79, v187
v_cvt_pk_bf16_f32 v188, v184, v185
v_cvt_pk_bf16_f32 v189, v186, v187
s_add_u32 s54, s53, 3
s_cmp_lt_u32 s54, 128
s_cselect_b32 s59, 3072, 0x40000000
buffer_store_dwordx2 v[188:189], v47, s[16:19], s59 offen sc1
v_lshlrev_b32 v192, 16, v40
v_and_b32 v193, 0xffff0000, v40
v_lshlrev_b32 v194, 16, v41
v_and_b32 v195, 0xffff0000, v41
v_add_f32 v192, v80, v192
v_add_f32 v193, v81, v193
v_add_f32 v194, v82, v194
v_add_f32 v195, v83, v195
v_cvt_pk_bf16_f32 v196, v192, v193
v_cvt_pk_bf16_f32 v197, v194, v195
s_add_u32 s54, s53, 4
s_cmp_lt_u32 s54, 128
s_cselect_b32 s60, 4096, 0x40000000
buffer_store_dwordx2 v[196:197], v47, s[16:19], s60 offen sc1
v_lshlrev_b32 v160, 16, v164
v_and_b32 v161, 0xffff0000, v164
tp1_p2:
s_cbranch_execz tp1_ret
tf_p3:
s_cbranch_execz k12_kernel_end
v_lshlrev_b32 v162, 16, v165
v_and_b32 v163, 0xffff0000, v165
v_add_f32 v166, v160, v161
v_add_f32 v167, v162, v163
v_add_f32 v166, v166, v167
v_lshlrev_b32 v168, 16, v172
v_and_b32 v169, 0xffff0000, v172
v_lshlrev_b32 v170, 16, v173
v_and_b32 v171, 0xffff0000, v173
v_add_f32 v174, v168, v169
v_add_f32 v175, v170, v171
v_add_f32 v174, v174, v175
v_lshlrev_b32 v176, 16, v180
v_and_b32 v177, 0xffff0000, v180
v_lshlrev_b32 v178, 16, v181
v_and_b32 v179, 0xffff0000, v181
v_add_f32 v182, v176, v177
v_add_f32 v183, v178, v179
v_add_f32 v182, v182, v183
v_lshlrev_b32 v184, 16, v188
v_and_b32 v185, 0xffff0000, v188
v_lshlrev_b32 v186, 16, v189
v_and_b32 v187, 0xffff0000, v189
v_add_f32 v190, v184, v185
v_add_f32 v191, v186, v187
v_add_f32 v190, v190, v191
v_lshlrev_b32 v192, 16, v196
v_and_b32 v193, 0xffff0000, v196
v_lshlrev_b32 v194, 16, v197
v_and_b32 v195, 0xffff0000, v197
v_add_f32 v198, v192, v193
v_add_f32 v199, v194, v195
v_add_f32 v198, v198, v199
v_mov_b32 v167, v166
s_nop 1
v_permlane16_swap_b32 v166, v167
v_add_f32 v166, v166, v167
v_mov_b32 v167, v166
s_nop 1
v_permlane32_swap_b32 v166, v167
v_add_f32 v166, v166, v167
v_mov_b32 v175, v174
s_nop 1
v_permlane16_swap_b32 v174, v175
v_add_f32 v174, v174, v175
v_mov_b32 v175, v174
s_nop 1
v_permlane32_swap_b32 v174, v175
v_add_f32 v174, v174, v175
v_mov_b32 v183, v182
s_nop 1
v_permlane16_swap_b32 v182, v183
v_add_f32 v182, v182, v183
v_mov_b32 v183, v182
s_nop 1
v_permlane32_swap_b32 v182, v183
v_add_f32 v182, v182, v183
v_mov_b32 v191, v190
s_nop 1
v_permlane16_swap_b32 v190, v191
v_add_f32 v190, v190, v191
v_mov_b32 v191, v190
s_nop 1
v_permlane32_swap_b32 v190, v191
v_add_f32 v190, v190, v191
v_mov_b32 v199, v198
s_nop 1
v_permlane16_swap_b32 v198, v199
v_add_f32 v198, v198, v199
v_mov_b32 v199, v198
s_nop 1
v_permlane32_swap_b32 v198, v199
v_add_f32 v198, v198, v199
v_mul_f32 v166, 0x3d800000, v166
v_sub_f32 v160, v160, v166
v_sub_f32 v161, v161, v166
v_sub_f32 v162, v162, v166
v_sub_f32 v163, v163, v166
v_mul_f32 v167, v160, v160
v_fmac_f32 v167, v161, v161
v_fmac_f32 v167, v162, v162
v_fmac_f32 v167, v163, v163
v_mul_f32 v174, 0x3d800000, v174
v_sub_f32 v168, v168, v174
v_sub_f32 v169, v169, v174
v_sub_f32 v170, v170, v174
v_sub_f32 v171, v171, v174
v_mul_f32 v175, v168, v168
v_fmac_f32 v175, v169, v169
v_fmac_f32 v175, v170, v170
v_fmac_f32 v175, v171, v171
v_mul_f32 v182, 0x3d800000, v182
v_sub_f32 v176, v176, v182
v_sub_f32 v177, v177, v182
v_sub_f32 v178, v178, v182
v_sub_f32 v179, v179, v182
v_mul_f32 v183, v176, v176
v_fmac_f32 v183, v177, v177
v_fmac_f32 v183, v178, v178
v_fmac_f32 v183, v179, v179
v_mul_f32 v190, 0x3d800000, v190
v_sub_f32 v184, v184, v190
v_sub_f32 v185, v185, v190
v_sub_f32 v186, v186, v190
v_sub_f32 v187, v187, v190
v_mul_f32 v191, v184, v184
v_fmac_f32 v191, v185, v185
v_fmac_f32 v191, v186, v186
v_fmac_f32 v191, v187, v187
v_mul_f32 v198, 0x3d800000, v198
v_sub_f32 v192, v192, v198
v_sub_f32 v193, v193, v198
v_sub_f32 v194, v194, v198
v_sub_f32 v195, v195, v198
v_mul_f32 v199, v192, v192
v_fmac_f32 v199, v193, v193
v_fmac_f32 v199, v194, v194
v_fmac_f32 v199, v195, v195
v_mov_b32 v165, v167
s_nop 1
v_permlane16_swap_b32 v167, v165
v_add_f32 v167, v167, v165
v_mov_b32 v165, v167
s_nop 1
v_permlane32_swap_b32 v167, v165
v_add_f32 v167, v167, v165
v_mov_b32 v173, v175
s_nop 1
v_permlane16_swap_b32 v175, v173
v_add_f32 v175, v175, v173
v_mov_b32 v173, v175
s_nop 1
v_permlane32_swap_b32 v175, v173
v_add_f32 v175, v175, v173
v_mov_b32 v181, v183
s_nop 1
v_permlane16_swap_b32 v183, v181
v_add_f32 v183, v183, v181
v_mov_b32 v181, v183
s_nop 1
v_permlane32_swap_b32 v183, v181
v_add_f32 v183, v183, v181
v_mov_b32 v189, v191
s_nop 1
v_permlane16_swap_b32 v191, v189
v_add_f32 v191, v191, v189
v_mov_b32 v189, v191
s_nop 1
v_permlane32_swap_b32 v191, v189
v_add_f32 v191, v191, v189
v_mov_b32 v197, v199
s_nop 1
v_permlane16_swap_b32 v199, v197
v_add_f32 v199, v199, v197
v_mov_b32 v197, v199
s_nop 1
v_permlane32_swap_b32 v199, v197
v_add_f32 v199, v199, v197
s_lshl_b32 s50, s27, 2
s_add_u32 s50, s50, s24
s_lshl_b32 s50, s50, 14
v_lshlrev_b32 v54, 3, v54
v_add_u32 v54, s50, v54
s_mov_b64 exec, 0xffff
s_cmp_eq_u32 s56, 0x40000000
s_cselect_b32 s50, 0x40000000, 0
buffer_store_dwordx2 v[166:167], v54, s[20:23], s50 offen sc1
s_cmp_eq_u32 s57, 0x40000000
s_cselect_b32 s50, 0x40000000, 128
buffer_store_dwordx2 v[174:175], v54, s[20:23], s50 offen sc1
s_cmp_eq_u32 s58, 0x40000000
s_cselect_b32 s50, 0x40000000, 256
buffer_store_dwordx2 v[182:183], v54, s[20:23], s50 offen sc1
s_cmp_eq_u32 s59, 0x40000000
s_cselect_b32 s50, 0x40000000, 384
buffer_store_dwordx2 v[190:191], v54, s[20:23], s50 offen sc1
s_cmp_eq_u32 s60, 0x40000000
s_cselect_b32 s50, 0x40000000, 512
buffer_store_dwordx2 v[198:199], v54, s[20:23], s50 offen sc1
s_mov_b64 exec, -1
s_waitcnt vmcnt(0)
k3_kernel_end:
s_endpgm
k3_kernel_spare1:
s_sub_u32 s51, s51, 30
s_lshl_b32 s51, s51, 3
s_add_u32 s52, s50, s51
s_branch k3_kernel_cs
k3_kernel_spare2:
s_sub_u32 s52, s25, 218
k3_kernel_cs:
s_cmp_ge_u32 s52, 18
s_cbranch_scc1 k3_kernel_end2
s_waitcnt lgkmcnt(0)
s_cmp_lt_u32 s52, 9
s_cselect_b32 s4, s44, s46
s_cselect_b32 s5, s45, s47
s_cselect_b32 s53, 0, 9
s_mov_b32 s6, 5308416
s_mov_b32 s7, 0x20000
s_sub_u32 s53, s52, s53
s_lshl_b32 s53, s53, 10
s_mul_i32 s54, s24, 1327104
s_add_u32 s53, s53, s54
s_add_u32 s16, s48, 58327040
s_addc_u32 s17, s49, 0
s_mov_b32 s18, 36864
s_mov_b32 s19, 0x20000
v_lshlrev_b32 v2, 4, v1
v_mov_b32 v12, 0
v_mov_b32 v13, 0
v_mov_b32 v14, 0
v_mov_b32 v15, 0
v_mov_b32 v16, 0
v_mov_b32 v17, 0
v_mov_b32 v18, 0
v_mov_b32 v19, 0
v_mov_b32 v20, 0x00003f80
v_mov_b32 v21, 0x3f800000
buffer_load_dwordx4 v[64:67], v2, s[4:7], s53 offen
s_add_u32 s53, s53, 9216
buffer_load_dwordx4 v[68:71], v2, s[4:7], s53 offen
s_add_u32 s53, s53, 9216
buffer_load_dwordx4 v[72:75], v2, s[4:7], s53 offen
s_add_u32 s53, s53, 9216
buffer_load_dwordx4 v[76:79], v2, s[4:7], s53 offen
s_add_u32 s53, s53, 9216
buffer_load_dwordx4 v[80:83], v2, s[4:7], s53 offen
s_add_u32 s53, s53, 9216
buffer_load_dwordx4 v[84:87], v2, s[4:7], s53 offen
s_add_u32 s53, s53, 9216
buffer_load_dwordx4 v[88:91], v2, s[4:7], s53 offen
s_add_u32 s53, s53, 9216
buffer_load_dwordx4 v[92:95], v2, s[4:7], s53 offen
s_add_u32 s53, s53, 9216
buffer_load_dwordx4 v[96:99], v2, s[4:7], s53 offen
s_add_u32 s53, s53, 9216
buffer_load_dwordx4 v[100:103], v2, s[4:7], s53 offen
s_add_u32 s53, s53, 9216
buffer_load_dwordx4 v[104:107], v2, s[4:7], s53 offen
s_add_u32 s53, s53, 9216
buffer_load_dwordx4 v[108:111], v2, s[4:7], s53 offen
s_add_u32 s53, s53, 9216
buffer_load_dwordx4 v[112:115], v2, s[4:7], s53 offen
s_add_u32 s53, s53, 9216
buffer_load_dwordx4 v[116:119], v2, s[4:7], s53 offen
s_add_u32 s53, s53, 9216
buffer_load_dwordx4 v[120:123], v2, s[4:7], s53 offen
s_add_u32 s53, s53, 9216
buffer_load_dwordx4 v[124:127], v2, s[4:7], s53 offen
s_add_u32 s53, s53, 9216
buffer_load_dwordx4 v[128:131], v2, s[4:7], s53 offen
s_add_u32 s53, s53, 9216
buffer_load_dwordx4 v[132:135], v2, s[4:7], s53 offen
s_add_u32 s53, s53, 9216
buffer_load_dwordx4 v[136:139], v2, s[4:7], s53 offen
s_add_u32 s53, s53, 9216
buffer_load_dwordx4 v[140:143], v2, s[4:7], s53 offen
s_add_u32 s53, s53, 9216
buffer_load_dwordx4 v[144:147], v2, s[4:7], s53 offen
s_add_u32 s53, s53, 9216
buffer_load_dwordx4 v[148:151], v2, s[4:7], s53 offen
s_add_u32 s53, s53, 9216
buffer_load_dwordx4 v[152:155], v2, s[4:7], s53 offen
s_add_u32 s53, s53, 9216
buffer_load_dwordx4 v[156:159], v2, s[4:7], s53 offen
s_add_u32 s53, s53, 9216
s_mov_b32 s31, 0
k3_kernel_csl:
s_waitcnt vmcnt(23)
v_lshlrev_b32 v22, 16, v64
v_and_b32 v23, 0xffff0000, v64
v_add_f32 v12, v12, v22
v_add_f32 v13, v13, v23
v_lshlrev_b32 v22, 16, v65
v_and_b32 v23, 0xffff0000, v65
v_add_f32 v14, v14, v22
v_add_f32 v15, v15, v23
v_lshlrev_b32 v22, 16, v66
v_and_b32 v23, 0xffff0000, v66
v_add_f32 v16, v16, v22
v_add_f32 v17, v17, v23
v_lshlrev_b32 v22, 16, v67
v_and_b32 v23, 0xffff0000, v67
v_add_f32 v18, v18, v22
v_add_f32 v19, v19, v23
s_add_u32 s54, s31, 24
s_cmp_lt_u32 s54, 144
s_cselect_b32 s54, s53, 0x40000000
buffer_load_dwordx4 v[64:67], v2, s[4:7], s54 offen
s_add_u32 s53, s53, 9216
s_waitcnt vmcnt(23)
v_lshlrev_b32 v22, 16, v68
v_and_b32 v23, 0xffff0000, v68
v_add_f32 v12, v12, v22
v_add_f32 v13, v13, v23
v_lshlrev_b32 v22, 16, v69
v_and_b32 v23, 0xffff0000, v69
v_add_f32 v14, v14, v22
v_add_f32 v15, v15, v23
v_lshlrev_b32 v22, 16, v70
v_and_b32 v23, 0xffff0000, v70
v_add_f32 v16, v16, v22
v_add_f32 v17, v17, v23
v_lshlrev_b32 v22, 16, v71
v_and_b32 v23, 0xffff0000, v71
v_add_f32 v18, v18, v22
v_add_f32 v19, v19, v23
s_add_u32 s54, s31, 25
s_cmp_lt_u32 s54, 144
s_cselect_b32 s54, s53, 0x40000000
buffer_load_dwordx4 v[68:71], v2, s[4:7], s54 offen
s_add_u32 s53, s53, 9216
s_waitcnt vmcnt(23)
v_lshlrev_b32 v22, 16, v72
v_and_b32 v23, 0xffff0000, v72
v_add_f32 v12, v12, v22
v_add_f32 v13, v13, v23
v_lshlrev_b32 v22, 16, v73
v_and_b32 v23, 0xffff0000, v73
v_add_f32 v14, v14, v22
v_add_f32 v15, v15, v23
v_lshlrev_b32 v22, 16, v74
v_and_b32 v23, 0xffff0000, v74
v_add_f32 v16, v16, v22
v_add_f32 v17, v17, v23
v_lshlrev_b32 v22, 16, v75
v_and_b32 v23, 0xffff0000, v75
v_add_f32 v18, v18, v22
v_add_f32 v19, v19, v23
s_add_u32 s54, s31, 26
s_cmp_lt_u32 s54, 144
s_cselect_b32 s54, s53, 0x40000000
buffer_load_dwordx4 v[72:75], v2, s[4:7], s54 offen
s_add_u32 s53, s53, 9216
s_waitcnt vmcnt(23)
v_lshlrev_b32 v22, 16, v76
v_and_b32 v23, 0xffff0000, v76
v_add_f32 v12, v12, v22
v_add_f32 v13, v13, v23
v_lshlrev_b32 v22, 16, v77
v_and_b32 v23, 0xffff0000, v77
v_add_f32 v14, v14, v22
v_add_f32 v15, v15, v23
v_lshlrev_b32 v22, 16, v78
v_and_b32 v23, 0xffff0000, v78
v_add_f32 v16, v16, v22
v_add_f32 v17, v17, v23
v_lshlrev_b32 v22, 16, v79
v_and_b32 v23, 0xffff0000, v79
v_add_f32 v18, v18, v22
v_add_f32 v19, v19, v23
s_add_u32 s54, s31, 27
s_cmp_lt_u32 s54, 144
s_cselect_b32 s54, s53, 0x40000000
buffer_load_dwordx4 v[76:79], v2, s[4:7], s54 offen
s_add_u32 s53, s53, 9216
s_waitcnt vmcnt(23)
v_lshlrev_b32 v22, 16, v80
v_and_b32 v23, 0xffff0000, v80
v_add_f32 v12, v12, v22
v_add_f32 v13, v13, v23
v_lshlrev_b32 v22, 16, v81
v_and_b32 v23, 0xffff0000, v81
v_add_f32 v14, v14, v22
v_add_f32 v15, v15, v23
v_lshlrev_b32 v22, 16, v82
v_and_b32 v23, 0xffff0000, v82
v_add_f32 v16, v16, v22
v_add_f32 v17, v17, v23
v_lshlrev_b32 v22, 16, v83
v_and_b32 v23, 0xffff0000, v83
v_add_f32 v18, v18, v22
v_add_f32 v19, v19, v23
s_add_u32 s54, s31, 28
s_cmp_lt_u32 s54, 144
s_cselect_b32 s54, s53, 0x40000000
buffer_load_dwordx4 v[80:83], v2, s[4:7], s54 offen
s_add_u32 s53, s53, 9216
s_waitcnt vmcnt(23)
v_lshlrev_b32 v22, 16, v84
v_and_b32 v23, 0xffff0000, v84
v_add_f32 v12, v12, v22
v_add_f32 v13, v13, v23
v_lshlrev_b32 v22, 16, v85
v_and_b32 v23, 0xffff0000, v85
v_add_f32 v14, v14, v22
v_add_f32 v15, v15, v23
v_lshlrev_b32 v22, 16, v86
v_and_b32 v23, 0xffff0000, v86
v_add_f32 v16, v16, v22
v_add_f32 v17, v17, v23
v_lshlrev_b32 v22, 16, v87
v_and_b32 v23, 0xffff0000, v87
v_add_f32 v18, v18, v22
v_add_f32 v19, v19, v23
s_add_u32 s54, s31, 29
s_cmp_lt_u32 s54, 144
s_cselect_b32 s54, s53, 0x40000000
buffer_load_dwordx4 v[84:87], v2, s[4:7], s54 offen
s_add_u32 s53, s53, 9216
s_waitcnt vmcnt(23)
v_lshlrev_b32 v22, 16, v88
v_and_b32 v23, 0xffff0000, v88
v_add_f32 v12, v12, v22
v_add_f32 v13, v13, v23
v_lshlrev_b32 v22, 16, v89
v_and_b32 v23, 0xffff0000, v89
v_add_f32 v14, v14, v22
v_add_f32 v15, v15, v23
v_lshlrev_b32 v22, 16, v90
v_and_b32 v23, 0xffff0000, v90
v_add_f32 v16, v16, v22
v_add_f32 v17, v17, v23
v_lshlrev_b32 v22, 16, v91
v_and_b32 v23, 0xffff0000, v91
v_add_f32 v18, v18, v22
v_add_f32 v19, v19, v23
s_add_u32 s54, s31, 30
s_cmp_lt_u32 s54, 144
s_cselect_b32 s54, s53, 0x40000000
buffer_load_dwordx4 v[88:91], v2, s[4:7], s54 offen
s_add_u32 s53, s53, 9216
s_waitcnt vmcnt(23)
v_lshlrev_b32 v22, 16, v92
v_and_b32 v23, 0xffff0000, v92
v_add_f32 v12, v12, v22
v_add_f32 v13, v13, v23
v_lshlrev_b32 v22, 16, v93
v_and_b32 v23, 0xffff0000, v93
v_add_f32 v14, v14, v22
v_add_f32 v15, v15, v23
v_lshlrev_b32 v22, 16, v94
v_and_b32 v23, 0xffff0000, v94
v_add_f32 v16, v16, v22
v_add_f32 v17, v17, v23
v_lshlrev_b32 v22, 16, v95
v_and_b32 v23, 0xffff0000, v95
v_add_f32 v18, v18, v22
v_add_f32 v19, v19, v23
s_add_u32 s54, s31, 31
s_cmp_lt_u32 s54, 144
s_cselect_b32 s54, s53, 0x40000000
buffer_load_dwordx4 v[92:95], v2, s[4:7], s54 offen
s_add_u32 s53, s53, 9216
s_waitcnt vmcnt(23)
v_lshlrev_b32 v22, 16, v96
v_and_b32 v23, 0xffff0000, v96
v_add_f32 v12, v12, v22
v_add_f32 v13, v13, v23
v_lshlrev_b32 v22, 16, v97
v_and_b32 v23, 0xffff0000, v97
v_add_f32 v14, v14, v22
v_add_f32 v15, v15, v23
v_lshlrev_b32 v22, 16, v98
v_and_b32 v23, 0xffff0000, v98
v_add_f32 v16, v16, v22
v_add_f32 v17, v17, v23
v_lshlrev_b32 v22, 16, v99
v_and_b32 v23, 0xffff0000, v99
v_add_f32 v18, v18, v22
v_add_f32 v19, v19, v23
s_add_u32 s54, s31, 32
s_cmp_lt_u32 s54, 144
s_cselect_b32 s54, s53, 0x40000000
buffer_load_dwordx4 v[96:99], v2, s[4:7], s54 offen
s_add_u32 s53, s53, 9216
s_waitcnt vmcnt(23)
v_lshlrev_b32 v22, 16, v100
v_and_b32 v23, 0xffff0000, v100
v_add_f32 v12, v12, v22
v_add_f32 v13, v13, v23
v_lshlrev_b32 v22, 16, v101
v_and_b32 v23, 0xffff0000, v101
v_add_f32 v14, v14, v22
v_add_f32 v15, v15, v23
v_lshlrev_b32 v22, 16, v102
v_and_b32 v23, 0xffff0000, v102
v_add_f32 v16, v16, v22
v_add_f32 v17, v17, v23
v_lshlrev_b32 v22, 16, v103
v_and_b32 v23, 0xffff0000, v103
v_add_f32 v18, v18, v22
v_add_f32 v19, v19, v23
s_add_u32 s54, s31, 33
s_cmp_lt_u32 s54, 144
s_cselect_b32 s54, s53, 0x40000000
buffer_load_dwordx4 v[100:103], v2, s[4:7], s54 offen
s_add_u32 s53, s53, 9216
s_waitcnt vmcnt(23)
v_lshlrev_b32 v22, 16, v104
v_and_b32 v23, 0xffff0000, v104
v_add_f32 v12, v12, v22
v_add_f32 v13, v13, v23
v_lshlrev_b32 v22, 16, v105
v_and_b32 v23, 0xffff0000, v105
v_add_f32 v14, v14, v22
v_add_f32 v15, v15, v23
v_lshlrev_b32 v22, 16, v106
v_and_b32 v23, 0xffff0000, v106
v_add_f32 v16, v16, v22
v_add_f32 v17, v17, v23
v_lshlrev_b32 v22, 16, v107
v_and_b32 v23, 0xffff0000, v107
v_add_f32 v18, v18, v22
v_add_f32 v19, v19, v23
s_add_u32 s54, s31, 34
s_cmp_lt_u32 s54, 144
s_cselect_b32 s54, s53, 0x40000000
buffer_load_dwordx4 v[104:107], v2, s[4:7], s54 offen
s_add_u32 s53, s53, 9216
s_waitcnt vmcnt(23)
v_lshlrev_b32 v22, 16, v108
v_and_b32 v23, 0xffff0000, v108
v_add_f32 v12, v12, v22
v_add_f32 v13, v13, v23
v_lshlrev_b32 v22, 16, v109
v_and_b32 v23, 0xffff0000, v109
v_add_f32 v14, v14, v22
v_add_f32 v15, v15, v23
v_lshlrev_b32 v22, 16, v110
v_and_b32 v23, 0xffff0000, v110
v_add_f32 v16, v16, v22
v_add_f32 v17, v17, v23
v_lshlrev_b32 v22, 16, v111
v_and_b32 v23, 0xffff0000, v111
v_add_f32 v18, v18, v22
v_add_f32 v19, v19, v23
s_add_u32 s54, s31, 35
s_cmp_lt_u32 s54, 144
s_cselect_b32 s54, s53, 0x40000000
buffer_load_dwordx4 v[108:111], v2, s[4:7], s54 offen
s_add_u32 s53, s53, 9216
s_waitcnt vmcnt(23)
v_lshlrev_b32 v22, 16, v112
v_and_b32 v23, 0xffff0000, v112
v_add_f32 v12, v12, v22
v_add_f32 v13, v13, v23
v_lshlrev_b32 v22, 16, v113
v_and_b32 v23, 0xffff0000, v113
v_add_f32 v14, v14, v22
v_add_f32 v15, v15, v23
v_lshlrev_b32 v22, 16, v114
v_and_b32 v23, 0xffff0000, v114
v_add_f32 v16, v16, v22
v_add_f32 v17, v17, v23
v_lshlrev_b32 v22, 16, v115
v_and_b32 v23, 0xffff0000, v115
v_add_f32 v18, v18, v22
v_add_f32 v19, v19, v23
s_add_u32 s54, s31, 36
s_cmp_lt_u32 s54, 144
s_cselect_b32 s54, s53, 0x40000000
buffer_load_dwordx4 v[112:115], v2, s[4:7], s54 offen
s_add_u32 s53, s53, 9216
s_waitcnt vmcnt(23)
v_lshlrev_b32 v22, 16, v116
v_and_b32 v23, 0xffff0000, v116
v_add_f32 v12, v12, v22
v_add_f32 v13, v13, v23
v_lshlrev_b32 v22, 16, v117
v_and_b32 v23, 0xffff0000, v117
v_add_f32 v14, v14, v22
v_add_f32 v15, v15, v23
v_lshlrev_b32 v22, 16, v118
v_and_b32 v23, 0xffff0000, v118
v_add_f32 v16, v16, v22
v_add_f32 v17, v17, v23
v_lshlrev_b32 v22, 16, v119
v_and_b32 v23, 0xffff0000, v119
v_add_f32 v18, v18, v22
v_add_f32 v19, v19, v23
s_add_u32 s54, s31, 37
s_cmp_lt_u32 s54, 144
s_cselect_b32 s54, s53, 0x40000000
buffer_load_dwordx4 v[116:119], v2, s[4:7], s54 offen
s_add_u32 s53, s53, 9216
s_waitcnt vmcnt(23)
v_lshlrev_b32 v22, 16, v120
v_and_b32 v23, 0xffff0000, v120
v_add_f32 v12, v12, v22
v_add_f32 v13, v13, v23
v_lshlrev_b32 v22, 16, v121
v_and_b32 v23, 0xffff0000, v121
v_add_f32 v14, v14, v22
v_add_f32 v15, v15, v23
v_lshlrev_b32 v22, 16, v122
v_and_b32 v23, 0xffff0000, v122
v_add_f32 v16, v16, v22
v_add_f32 v17, v17, v23
v_lshlrev_b32 v22, 16, v123
v_and_b32 v23, 0xffff0000, v123
v_add_f32 v18, v18, v22
v_add_f32 v19, v19, v23
s_add_u32 s54, s31, 38
s_cmp_lt_u32 s54, 144
s_cselect_b32 s54, s53, 0x40000000
buffer_load_dwordx4 v[120:123], v2, s[4:7], s54 offen
s_add_u32 s53, s53, 9216
s_waitcnt vmcnt(23)
v_lshlrev_b32 v22, 16, v124
v_and_b32 v23, 0xffff0000, v124
v_add_f32 v12, v12, v22
v_add_f32 v13, v13, v23
v_lshlrev_b32 v22, 16, v125
v_and_b32 v23, 0xffff0000, v125
v_add_f32 v14, v14, v22
v_add_f32 v15, v15, v23
v_lshlrev_b32 v22, 16, v126
v_and_b32 v23, 0xffff0000, v126
v_add_f32 v16, v16, v22
v_add_f32 v17, v17, v23
v_lshlrev_b32 v22, 16, v127
v_and_b32 v23, 0xffff0000, v127
v_add_f32 v18, v18, v22
v_add_f32 v19, v19, v23
s_add_u32 s54, s31, 39
s_cmp_lt_u32 s54, 144
s_cselect_b32 s54, s53, 0x40000000
buffer_load_dwordx4 v[124:127], v2, s[4:7], s54 offen
s_add_u32 s53, s53, 9216
s_waitcnt vmcnt(23)
v_lshlrev_b32 v22, 16, v128
v_and_b32 v23, 0xffff0000, v128
v_add_f32 v12, v12, v22
v_add_f32 v13, v13, v23
v_lshlrev_b32 v22, 16, v129
v_and_b32 v23, 0xffff0000, v129
v_add_f32 v14, v14, v22
v_add_f32 v15, v15, v23
v_lshlrev_b32 v22, 16, v130
v_and_b32 v23, 0xffff0000, v130
v_add_f32 v16, v16, v22
v_add_f32 v17, v17, v23
v_lshlrev_b32 v22, 16, v131
v_and_b32 v23, 0xffff0000, v131
v_add_f32 v18, v18, v22
v_add_f32 v19, v19, v23
s_add_u32 s54, s31, 40
s_cmp_lt_u32 s54, 144
s_cselect_b32 s54, s53, 0x40000000
buffer_load_dwordx4 v[128:131], v2, s[4:7], s54 offen
s_add_u32 s53, s53, 9216
s_waitcnt vmcnt(23)
v_lshlrev_b32 v22, 16, v132
v_and_b32 v23, 0xffff0000, v132
v_add_f32 v12, v12, v22
v_add_f32 v13, v13, v23
v_lshlrev_b32 v22, 16, v133
v_and_b32 v23, 0xffff0000, v133
v_add_f32 v14, v14, v22
v_add_f32 v15, v15, v23
v_lshlrev_b32 v22, 16, v134
v_and_b32 v23, 0xffff0000, v134
v_add_f32 v16, v16, v22
v_add_f32 v17, v17, v23
v_lshlrev_b32 v22, 16, v135
v_and_b32 v23, 0xffff0000, v135
v_add_f32 v18, v18, v22
v_add_f32 v19, v19, v23
s_add_u32 s54, s31, 41
s_cmp_lt_u32 s54, 144
s_cselect_b32 s54, s53, 0x40000000
buffer_load_dwordx4 v[132:135], v2, s[4:7], s54 offen
s_add_u32 s53, s53, 9216
s_waitcnt vmcnt(23)
v_lshlrev_b32 v22, 16, v136
v_and_b32 v23, 0xffff0000, v136
v_add_f32 v12, v12, v22
v_add_f32 v13, v13, v23
v_lshlrev_b32 v22, 16, v137
v_and_b32 v23, 0xffff0000, v137
v_add_f32 v14, v14, v22
v_add_f32 v15, v15, v23
v_lshlrev_b32 v22, 16, v138
v_and_b32 v23, 0xffff0000, v138
v_add_f32 v16, v16, v22
v_add_f32 v17, v17, v23
v_lshlrev_b32 v22, 16, v139
v_and_b32 v23, 0xffff0000, v139
v_add_f32 v18, v18, v22
v_add_f32 v19, v19, v23
s_add_u32 s54, s31, 42
s_cmp_lt_u32 s54, 144
s_cselect_b32 s54, s53, 0x40000000
buffer_load_dwordx4 v[136:139], v2, s[4:7], s54 offen
s_add_u32 s53, s53, 9216
s_waitcnt vmcnt(23)
v_lshlrev_b32 v22, 16, v140
v_and_b32 v23, 0xffff0000, v140
v_add_f32 v12, v12, v22
v_add_f32 v13, v13, v23
v_lshlrev_b32 v22, 16, v141
v_and_b32 v23, 0xffff0000, v141
v_add_f32 v14, v14, v22
v_add_f32 v15, v15, v23
v_lshlrev_b32 v22, 16, v142
v_and_b32 v23, 0xffff0000, v142
v_add_f32 v16, v16, v22
v_add_f32 v17, v17, v23
v_lshlrev_b32 v22, 16, v143
v_and_b32 v23, 0xffff0000, v143
v_add_f32 v18, v18, v22
v_add_f32 v19, v19, v23
s_add_u32 s54, s31, 43
s_cmp_lt_u32 s54, 144
s_cselect_b32 s54, s53, 0x40000000
buffer_load_dwordx4 v[140:143], v2, s[4:7], s54 offen
s_add_u32 s53, s53, 9216
s_waitcnt vmcnt(23)
v_lshlrev_b32 v22, 16, v144
v_and_b32 v23, 0xffff0000, v144
v_add_f32 v12, v12, v22
v_add_f32 v13, v13, v23
v_lshlrev_b32 v22, 16, v145
v_and_b32 v23, 0xffff0000, v145
v_add_f32 v14, v14, v22
v_add_f32 v15, v15, v23
v_lshlrev_b32 v22, 16, v146
v_and_b32 v23, 0xffff0000, v146
v_add_f32 v16, v16, v22
v_add_f32 v17, v17, v23
v_lshlrev_b32 v22, 16, v147
v_and_b32 v23, 0xffff0000, v147
v_add_f32 v18, v18, v22
v_add_f32 v19, v19, v23
s_add_u32 s54, s31, 44
s_cmp_lt_u32 s54, 144
s_cselect_b32 s54, s53, 0x40000000
buffer_load_dwordx4 v[144:147], v2, s[4:7], s54 offen
s_add_u32 s53, s53, 9216
s_waitcnt vmcnt(23)
v_lshlrev_b32 v22, 16, v148
v_and_b32 v23, 0xffff0000, v148
v_add_f32 v12, v12, v22
v_add_f32 v13, v13, v23
v_lshlrev_b32 v22, 16, v149
v_and_b32 v23, 0xffff0000, v149
v_add_f32 v14, v14, v22
v_add_f32 v15, v15, v23
v_lshlrev_b32 v22, 16, v150
v_and_b32 v23, 0xffff0000, v150
v_add_f32 v16, v16, v22
v_add_f32 v17, v17, v23
v_lshlrev_b32 v22, 16, v151
v_and_b32 v23, 0xffff0000, v151
v_add_f32 v18, v18, v22
v_add_f32 v19, v19, v23
s_add_u32 s54, s31, 45
s_cmp_lt_u32 s54, 144
s_cselect_b32 s54, s53, 0x40000000
buffer_load_dwordx4 v[148:151], v2, s[4:7], s54 offen
s_add_u32 s53, s53, 9216
s_waitcnt vmcnt(23)
v_lshlrev_b32 v22, 16, v152
v_and_b32 v23, 0xffff0000, v152
v_add_f32 v12, v12, v22
v_add_f32 v13, v13, v23
v_lshlrev_b32 v22, 16, v153
v_and_b32 v23, 0xffff0000, v153
v_add_f32 v14, v14, v22
v_add_f32 v15, v15, v23
v_lshlrev_b32 v22, 16, v154
v_and_b32 v23, 0xffff0000, v154
v_add_f32 v16, v16, v22
v_add_f32 v17, v17, v23
v_lshlrev_b32 v22, 16, v155
v_and_b32 v23, 0xffff0000, v155
v_add_f32 v18, v18, v22
v_add_f32 v19, v19, v23
s_add_u32 s54, s31, 46
s_cmp_lt_u32 s54, 144
s_cselect_b32 s54, s53, 0x40000000
buffer_load_dwordx4 v[152:155], v2, s[4:7], s54 offen
s_add_u32 s53, s53, 9216
s_waitcnt vmcnt(23)
v_lshlrev_b32 v22, 16, v156
v_and_b32 v23, 0xffff0000, v156
v_add_f32 v12, v12, v22
v_add_f32 v13, v13, v23
v_lshlrev_b32 v22, 16, v157
v_and_b32 v23, 0xffff0000, v157
v_add_f32 v14, v14, v22
v_add_f32 v15, v15, v23
v_lshlrev_b32 v22, 16, v158
v_and_b32 v23, 0xffff0000, v158
v_add_f32 v16, v16, v22
v_add_f32 v17, v17, v23
v_lshlrev_b32 v22, 16, v159
v_and_b32 v23, 0xffff0000, v159
v_add_f32 v18, v18, v22
v_add_f32 v19, v19, v23
s_add_u32 s54, s31, 47
s_cmp_lt_u32 s54, 144
s_cselect_b32 s54, s53, 0x40000000
buffer_load_dwordx4 v[156:159], v2, s[4:7], s54 offen
s_add_u32 s53, s53, 9216
s_add_u32 s31, s31, 24
s_cmp_lt_u32 s31, 144
s_cbranch_scc1 k3_kernel_csl
s_waitcnt vmcnt(0)
s_lshl_b32 s50, s24, 11
v_lshlrev_b32 v3, 5, v1
v_add_u32 v4, s50, v3
ds_write_b128 v4, v[12:15]
ds_write_b128 v4, v[16:19] offset:16
s_waitcnt lgkmcnt(0)
s_barrier
s_cmp_lg_u32 s24, 0
s_cbranch_scc1 k3_kernel_end2
ds_read_b128 v[64:67], v3 offset:2048
ds_read_b128 v[68:71], v3 offset:2064
ds_read_b128 v[72:75], v3 offset:4096
ds_read_b128 v[76:79], v3 offset:4112
ds_read_b128 v[80:83], v3 offset:6144
ds_read_b128 v[84:87], v3 offset:6160
s_waitcnt lgkmcnt(0)
v_add_f32 v12, v12, v64
v_add_f32 v13, v13, v65
v_add_f32 v14, v14, v66
v_add_f32 v15, v15, v67
v_add_f32 v16, v16, v68
v_add_f32 v17, v17, v69
v_add_f32 v18, v18, v70
v_add_f32 v19, v19, v71
v_add_f32 v12, v12, v72
v_add_f32 v13, v13, v73
v_add_f32 v14, v14, v74
v_add_f32 v15, v15, v75
v_add_f32 v16, v16, v76
v_add_f32 v17, v17, v77
v_add_f32 v18, v18, v78
v_add_f32 v19, v19, v79
v_add_f32 v12, v12, v80
v_add_f32 v13, v13, v81
v_add_f32 v14, v14, v82
v_add_f32 v15, v15, v83
v_add_f32 v16, v16, v84
v_add_f32 v17, v17, v85
v_add_f32 v18, v18, v86
v_add_f32 v19, v19, v87
s_lshl_b32 s50, s52, 11
buffer_store_dwordx4 v[12:15], v3, s[16:19], s50 offen
buffer_store_dwordx4 v[16:19], v3, s[16:19], s50 offen offset:16
s_waitcnt vmcnt(0)
k3_kernel_end2:
s_endpgm

.fill 704, 4, 0xbf800000
.globl k4_kernel
.p2align 8
.type k4_kernel,@function
k4_kernel:
tf_p4:
s_cbranch_execz k12_kernel_end
s_cmp_ge_u32 s2, 256
s_cbranch_scc1 k4_kernel_end
s_load_dwordx4 s[40:43], s[0:1], 56
s_load_dwordx2 s[48:49], s[0:1], 96
s_load_dwordx2 s[56:57], s[0:1], 72
v_and_b32 v36, 63, v0
v_lshrrev_b32 v37, 6, v0
s_and_b32 s50, s2, 7
s_lshr_b32 s51, s2, 3
s_and_b32 s51, s51, 3
v_readfirstlane_b32 s24, v37
s_lshl_b32 s50, s50, 2
s_add_u32 s25, s50, s51
s_lshr_b32 s26, s2, 5
v_lshlrev_b32 v1, 4, v36
s_and_b32 s50, s24, 1
s_mul_i32 s50, s50, 576
s_mul_i32 s51, s25, 288
v_add_u32 v38, s50, v36
s_and_b32 s53, s25, 1
s_lshl_b32 s52, s53, 1
v_add_u32 v39, 0, v38
v_mul_u32_u24 v18, 3641, v39
v_lshrrev_b32 v18, 16, v18
v_mul_u32_u24 v19, 18, v18
v_sub_u32 v19, v39, v19
v_add_u32 v19, s52, v19
v_subrev_u32 v20, 18, v19
v_min_u32 v19, v19, v20
v_mul_u32_u24 v18, 9216, v18
v_lshl_add_u32 v18, v19, 4, v18
v_add_u32 v18, s51, v18
v_mov_b32 v5, v18
v_add_u32 v39, 64, v38
v_mul_u32_u24 v18, 3641, v39
v_lshrrev_b32 v18, 16, v18
v_mul_u32_u24 v19, 18, v18
v_sub_u32 v19, v39, v19
v_add_u32 v19, s52, v19
v_subrev_u32 v20, 18, v19
v_min_u32 v19, v19, v20
v_mul_u32_u24 v18, 9216, v18
v_lshl_add_u32 v18, v19, 4, v18
v_add_u32 v18, s51, v18
v_subrev_u32 v6, 1024, v18
v_add_u32 v39, 128, v38
v_mul_u32_u24 v18, 3641, v39
v_lshrrev_b32 v18, 16, v18
v_mul_u32_u24 v19, 18, v18
v_sub_u32 v19, v39, v19
v_add_u32 v19, s52, v19
v_subrev_u32 v20, 18, v19
v_min_u32 v19, v19, v20
v_mul_u32_u24 v18, 9216, v18
v_lshl_add_u32 v18, v19, 4, v18
v_add_u32 v18, s51, v18
v_subrev_u32 v7, 2048, v18
v_add_u32 v39, 192, v38
v_mul_u32_u24 v18, 3641, v39
v_lshrrev_b32 v18, 16, v18
v_mul_u32_u24 v19, 18, v18
v_sub_u32 v19, v39, v19
v_add_u32 v19, s52, v19
v_subrev_u32 v20, 18, v19
v_min_u32 v19, v19, v20
v_mul_u32_u24 v18, 9216, v18
v_lshl_add_u32 v18, v19, 4, v18
v_add_u32 v18, s51, v18
v_subrev_u32 v8, 3072, v18
v_add_u32 v39, 256, v38
v_mul_u32_u24 v18, 3641, v39
v_lshrrev_b32 v18, 16, v18
v_mul_u32_u24 v19, 18, v18
v_sub_u32 v19, v39, v19
v_add_u32 v19, s52, v19
v_subrev_u32 v20, 18, v19
v_min_u32 v19, v19, v20
v_mul_u32_u24 v18, 9216, v18
v_lshl_add_u32 v18, v19, 4, v18
v_add_u32 v18, s51, v18
v_mov_b32 v9, v18
v_add_u32 v39, 320, v38
v_mul_u32_u24 v18, 3641, v39
v_lshrrev_b32 v18, 16, v18
v_mul_u32_u24 v19, 18, v18
v_sub_u32 v19, v39, v19
v_add_u32 v19, s52, v19
v_subrev_u32 v20, 18, v19
v_min_u32 v19, v19, v20
v_mul_u32_u24 v18, 9216, v18
v_lshl_add_u32 v18, v19, 4, v18
v_add_u32 v18, s51, v18
v_subrev_u32 v10, 1024, v18
v_add_u32 v39, 384, v38
v_mul_u32_u24 v18, 3641, v39
v_lshrrev_b32 v18, 16, v18
v_mul_u32_u24 v19, 18, v18
v_sub_u32 v19, v39, v19
v_add_u32 v19, s52, v19
v_subrev_u32 v20, 18, v19
v_min_u32 v19, v19, v20
v_mul_u32_u24 v18, 9216, v18
v_lshl_add_u32 v18, v19, 4, v18
v_add_u32 v18, s51, v18
v_subrev_u32 v11, 2048, v18
v_add_u32 v39, 448, v38
v_mul_u32_u24 v18, 3641, v39
v_lshrrev_b32 v18, 16, v18
v_mul_u32_u24 v19, 18, v18
v_sub_u32 v19, v39, v19
v_add_u32 v19, s52, v19
v_subrev_u32 v20, 18, v19
v_min_u32 v19, v19, v20
v_mul_u32_u24 v18, 9216, v18
v_lshl_add_u32 v18, v19, 4, v18
v_add_u32 v18, s51, v18
v_subrev_u32 v12, 3072, v18
v_add_u32 v39, 512, v38
v_mul_u32_u24 v18, 3641, v39
v_lshrrev_b32 v18, 16, v18
v_mul_u32_u24 v19, 18, v18
v_sub_u32 v19, v39, v19
v_add_u32 v19, s52, v19
v_subrev_u32 v20, 18, v19
v_min_u32 v19, v19, v20
v_mul_u32_u24 v18, 9216, v18
v_lshl_add_u32 v18, v19, 4, v18
v_add_u32 v18, s51, v18
v_mov_b32 v13, v18
s_waitcnt lgkmcnt(0)
s_cmp_lt_u32 s24, 2
s_cselect_b32 s4, s40, s42
s_cselect_b32 s5, s41, s43
s_mov_b32 s6, 5308416
s_mov_b32 s7, 0x20000
s_add_u32 s8, s48, 54525952
s_addc_u32 s9, s49, 0
s_mov_b32 s10, 2359296
s_mov_b32 s11, 0x20000
s_add_u32 s12, s48, 57671680
s_addc_u32 s13, s49, 0
s_mov_b32 s14, 589824
s_mov_b32 s15, 0x20000
s_add_u32 s20, s48, 58327040
s_addc_u32 s21, s49, 0
s_mov_b32 s22, 36864
s_mov_b32 s23, 0x20000
s_add_u32 s16, s48, 58720256
s_addc_u32 s17, s49, 0
s_mov_b32 s18, 18874368
s_mov_b32 s19, 0x20000
s_lshl_b32 s50, s26, 8
s_lshl_b32 s51, s24, 6
s_add_u32 s50, s50, s51
v_add_u32 v37, s50, v36
v_lshlrev_b32 v4, 3, v37
s_lshl_b32 s33, s50, 6
s_and_b32 s50, s24, 1
s_mul_i32 s50, s50, 18432
s_mul_i32 s51, s25, 576
s_add_u32 s50, s50, s51
s_lshl_b32 s51, s53, 6
v_add_u32 v38, s51, v1
v_subrev_u32 v39, 576, v38
v_min_u32 v38, v38, v39
s_mov_b32 exec_hi, 15
buffer_load_dwordx4 v[30:33], v38, s[20:23], s50 offen
s_mov_b32 exec_hi, -1
buffer_load_dword v14, v4, s[12:15], 0 offen
s_mov_b32 s27, 0
s_mov_b32 s28, s33
s_mov_b32 s29, 0
s_mul_i32 s30, s24, 9216
s_add_u32 m0, s30, 0
s_nop 0
buffer_load_dwordx4 v5, s[4:7], s27 offen offset:0 lds
buffer_load_dwordx4 v6, s[4:7], s27 offen offset:1024 lds
buffer_load_dwordx4 v7, s[4:7], s27 offen offset:2048 lds
buffer_load_dwordx4 v8, s[4:7], s27 offen offset:3072 lds
s_add_u32 m0, m0, 4096
s_nop 0
buffer_load_dwordx4 v9, s[4:7], s27 offen offset:0 lds
buffer_load_dwordx4 v10, s[4:7], s27 offen offset:1024 lds
buffer_load_dwordx4 v11, s[4:7], s27 offen offset:2048 lds
buffer_load_dwordx4 v12, s[4:7], s27 offen offset:3072 lds
s_add_u32 m0, m0, 4096
s_nop 0
buffer_load_dwordx4 v13, s[4:7], s27 offen offset:0 lds
s_add_u32 s27, s27, 589824
buffer_load_dwordx4 a[72:75], v1, s[8:11], s28 offen offset:0
buffer_load_dwordx4 a[76:79], v1, s[8:11], s28 offen offset:1024
buffer_load_dwordx4 a[80:83], v1, s[8:11], s28 offen offset:2048
buffer_load_dwordx4 a[84:87], v1, s[8:11], s28 offen offset:3072
s_add_u32 s28, s28, 131072
s_lshr_b32 s3, s2, 3
s_and_b32 s3, s3, 1
s_lshl_b32 s3, s3, 2
s_add_u32 s3, s3, s24
s_mov_b32 s98, 2
s_mov_b64 exec, 0
tp2_ret:
s_cmp_eq_u32 s98, 0
s_cbranch_scc1 tp2_done
s_sub_u32 s98, s98, 1
s_mov_b32 s99, s3
s_add_u32 s3, s3, 4
s_cmp_ge_u32 s3, 8
s_cselect_b32 s3, s24, s3
s_cmp_eq_u32 s99, 0
s_cbranch_scc1 tp2_p0
s_cmp_eq_u32 s99, 1
s_cbranch_scc1 tp2_p1
s_cmp_eq_u32 s99, 2
s_cbranch_scc1 tp2_p2
s_cmp_eq_u32 s99, 3
s_cbranch_scc1 tp2_p3
s_cmp_eq_u32 s99, 4
s_cbranch_scc1 tp2_p4
s_cmp_eq_u32 s99, 5
s_cbranch_scc1 tp2_p5
s_branch tp2_ret
tp2_done:
s_mov_b64 exec, -1
s_add_u32 m0, s30, 36864
s_nop 0
buffer_load_dwordx4 v5, s[4:7], s27 offen offset:0 lds
buffer_load_dwordx4 v6, s[4:7], s27 offen offset:1024 lds
buffer_load_dwordx4 v7, s[4:7], s27 offen offset:2048 lds
buffer_load_dwordx4 v8, s[4:7], s27 offen offset:3072 lds
s_add_u32 m0, m0, 4096
s_nop 0
buffer_load_dwordx4 v9, s[4:7], s27 offen offset:0 lds
buffer_load_dwordx4 v10, s[4:7], s27 offen offset:1024 lds
buffer_load_dwordx4 v11, s[4:7], s27 offen offset:2048 lds
buffer_load_dwordx4 v12, s[4:7], s27 offen offset:3072 lds
s_add_u32 m0, m0, 4096
s_nop 0
buffer_load_dwordx4 v13, s[4:7], s27 offen offset:0 lds
s_add_u32 s27, s27, 589824
buffer_load_dwordx4 a[88:91], v1, s[8:11], s28 offen offset:0
buffer_load_dwordx4 a[92:95], v1, s[8:11], s28 offen offset:1024
buffer_load_dwordx4 a[96:99], v1, s[8:11], s28 offen offset:2048
buffer_load_dwordx4 a[100:103], v1, s[8:11], s28 offen offset:3072
s_add_u32 s28, s28, 131072
buffer_load_dwordx4 a[104:107], v1, s[8:11], s28 offen offset:0
buffer_load_dwordx4 a[108:111], v1, s[8:11], s28 offen offset:1024
buffer_load_dwordx4 a[112:115], v1, s[8:11], s28 offen offset:2048
buffer_load_dwordx4 a[116:119], v1, s[8:11], s28 offen offset:3072
s_add_u32 s28, s28, 131072
buffer_load_dwordx2 v[18:19], v4, s[12:15], s29 offen
s_add_u32 s29, s29, 16384
buffer_load_dwordx2 v[20:21], v4, s[12:15], s29 offen
s_add_u32 s29, s29, 16384
buffer_load_dwordx2 v[22:23], v4, s[12:15], s29 offen
s_add_u32 s29, s29, 16384
buffer_load_dwordx2 v[24:25], v4, s[12:15], s29 offen
s_add_u32 s29, s29, 16384
buffer_load_dwordx2 v[26:27], v4, s[12:15], s29 offen
s_add_u32 s29, s29, 16384
buffer_load_dwordx2 v[28:29], v4, s[12:15], s29 offen
s_add_u32 s29, s29, 16384
v_bfe_u32 v37, v36, 2, 2
v_bfe_u32 v38, v36, 4, 1
v_lshrrev_b32 v39, 5, v36
v_lshl_add_u32 v37, v38, 2, v37
v_lshl_add_u32 v37, v39, 4, v37
v_mul_u32_u24 v37, 288, v37
v_and_b32 v38, 3, v36
v_lshl_add_u32 v2, v38, 3, v37
v_mov_b32 v3, v2
v_mov_b32 v15, 0
v_mov_b32 v16, 0
v_mov_b32 v17, 0
s_waitcnt vmcnt(23)
s_and_b32 s50, s24, 1
s_mul_i32 s50, s50, 576
s_add_u32 s50, s50, 148480
v_add_u32 v37, s50, v1
s_cmp_lt_u32 s24, 2
s_cselect_b32 exec_lo, -1, 0
s_cselect_b32 exec_hi, 15, 0
ds_write_b128 v37, v[30:33]
s_mov_b64 exec, -1
s_waitcnt lgkmcnt(0)
s_barrier
ds_read_b64_tr_b16 a[136:137], v3 offset:0
ds_read_b64_tr_b16 a[138:139], v3 offset:2304
ds_read_b64_tr_b16 a[140:141], v3 offset:18432
ds_read_b64_tr_b16 a[142:143], v3 offset:20736
ds_read_b64_tr_b16 a[144:145], v3 offset:32
ds_read_b64_tr_b16 a[146:147], v3 offset:2336
ds_read_b64_tr_b16 a[148:149], v3 offset:18464
ds_read_b64_tr_b16 a[150:151], v3 offset:20768
ds_read_b64_tr_b16 a[152:153], v3 offset:64
ds_read_b64_tr_b16 a[154:155], v3 offset:2368
ds_read_b64_tr_b16 a[156:157], v3 offset:18496
ds_read_b64_tr_b16 a[158:159], v3 offset:20800
s_waitcnt lgkmcnt(10)
v_mfma_f32_16x16x32_bf16 v[40:43], a[136:139], a[72:75], 0
ds_read_b64_tr_b16 a[160:161], v3 offset:96
v_mfma_f32_16x16x32_bf16 v[44:47], a[136:139], a[76:79], 0
ds_read_b64_tr_b16 a[162:163], v3 offset:2400
v_mfma_f32_16x16x32_bf16 v[48:51], a[136:139], a[80:83], 0
s_add_u32 m0, s30, 73728
s_nop 0
buffer_load_dwordx4 v5, s[4:7], s27 offen offset:0 lds
v_mfma_f32_16x16x32_bf16 v[52:55], a[136:139], a[84:87], 0
s_waitcnt lgkmcnt(10)
v_mfma_f32_16x16x32_bf16 a[0:3], a[140:143], a[72:75], 0
ds_read_b64_tr_b16 a[164:165], v3 offset:18528
v_mfma_f32_16x16x32_bf16 a[4:7], a[140:143], a[76:79], 0
ds_read_b64_tr_b16 a[166:167], v3 offset:20832
v_mfma_f32_16x16x32_bf16 v[56:59], a[140:143], a[80:83], 0
buffer_load_dwordx4 v6, s[4:7], s27 offen offset:1024 lds
v_mfma_f32_16x16x32_bf16 v[60:63], a[140:143], a[84:87], 0
s_waitcnt lgkmcnt(10)
v_mfma_f32_16x16x32_bf16 v[64:67], a[144:147], a[72:75], 0
ds_read_b64_tr_b16 a[168:169], v3 offset:128
v_mfma_f32_16x16x32_bf16 v[68:71], a[144:147], a[76:79], 0
ds_read_b64_tr_b16 a[170:171], v3 offset:2432
v_mfma_f32_16x16x32_bf16 v[72:75], a[144:147], a[80:83], 0
buffer_load_dwordx4 v7, s[4:7], s27 offen offset:2048 lds
v_mfma_f32_16x16x32_bf16 v[76:79], a[144:147], a[84:87], 0
s_waitcnt lgkmcnt(10)
v_mfma_f32_16x16x32_bf16 a[8:11], a[148:151], a[72:75], 0
ds_read_b64_tr_b16 a[136:137], v3 offset:18560
v_mfma_f32_16x16x32_bf16 a[12:15], a[148:151], a[76:79], 0
ds_read_b64_tr_b16 a[138:139], v3 offset:20864
v_mfma_f32_16x16x32_bf16 v[80:83], a[148:151], a[80:83], 0
buffer_load_dwordx4 v8, s[4:7], s27 offen offset:3072 lds
v_mfma_f32_16x16x32_bf16 v[84:87], a[148:151], a[84:87], 0
s_waitcnt lgkmcnt(10)
v_mfma_f32_16x16x32_bf16 v[88:91], a[152:155], a[72:75], 0
ds_read_b64_tr_b16 a[140:141], v3 offset:160
v_mfma_f32_16x16x32_bf16 v[92:95], a[152:155], a[76:79], 0
ds_read_b64_tr_b16 a[142:143], v3 offset:2464
v_mfma_f32_16x16x32_bf16 v[96:99], a[152:155], a[80:83], 0
s_add_u32 m0, m0, 4096
s_nop 0
buffer_load_dwordx4 v9, s[4:7], s27 offen offset:0 lds
v_mfma_f32_16x16x32_bf16 v[100:103], a[152:155], a[84:87], 0
s_waitcnt lgkmcnt(10)
v_mfma_f32_16x16x32_bf16 a[16:19], a[156:159], a[72:75], 0
ds_read_b64_tr_b16 a[144:145], v3 offset:18592
v_mfma_f32_16x16x32_bf16 a[20:23], a[156:159], a[76:79], 0
ds_read_b64_tr_b16 a[146:147], v3 offset:20896
v_mfma_f32_16x16x32_bf16 v[104:107], a[156:159], a[80:83], 0
buffer_load_dwordx4 v10, s[4:7], s27 offen offset:1024 lds
v_mfma_f32_16x16x32_bf16 v[108:111], a[156:159], a[84:87], 0
s_waitcnt lgkmcnt(10)
v_mfma_f32_16x16x32_bf16 v[112:115], a[160:163], a[72:75], 0
ds_read_b64_tr_b16 a[148:149], v3 offset:192
v_mfma_f32_16x16x32_bf16 v[116:119], a[160:163], a[76:79], 0
ds_read_b64_tr_b16 a[150:151], v3 offset:2496
v_mfma_f32_16x16x32_bf16 v[120:123], a[160:163], a[80:83], 0
buffer_load_dwordx4 v11, s[4:7], s27 offen offset:2048 lds
v_mfma_f32_16x16x32_bf16 v[124:127], a[160:163], a[84:87], 0
s_waitcnt lgkmcnt(10)
v_mfma_f32_16x16x32_bf16 a[24:27], a[164:167], a[72:75], 0
ds_read_b64_tr_b16 a[152:153], v3 offset:18624
v_mfma_f32_16x16x32_bf16 a[28:31], a[164:167], a[76:79], 0
ds_read_b64_tr_b16 a[154:155], v3 offset:20928
v_mfma_f32_16x16x32_bf16 v[128:131], a[164:167], a[80:83], 0
buffer_load_dwordx4 v12, s[4:7], s27 offen offset:3072 lds
v_mfma_f32_16x16x32_bf16 v[132:135], a[164:167], a[84:87], 0
s_waitcnt lgkmcnt(10)
v_mfma_f32_16x16x32_bf16 v[136:139], a[168:171], a[72:75], 0
ds_read_b64_tr_b16 a[156:157], v3 offset:224
v_mfma_f32_16x16x32_bf16 v[140:143], a[168:171], a[76:79], 0
ds_read_b64_tr_b16 a[158:159], v3 offset:2528
v_mfma_f32_16x16x32_bf16 v[144:147], a[168:171], a[80:83], 0
s_add_u32 m0, m0, 4096
s_nop 0
buffer_load_dwordx4 v13, s[4:7], s27 offen offset:0 lds
s_add_u32 s27, s27, 589824
v_mfma_f32_16x16x32_bf16 v[148:151], a[168:171], a[84:87], 0
s_waitcnt lgkmcnt(10)
v_mfma_f32_16x16x32_bf16 a[32:35], a[136:139], a[72:75], 0
ds_read_b64_tr_b16 a[160:161], v3 offset:18656
v_mfma_f32_16x16x32_bf16 a[36:39], a[136:139], a[76:79], 0
ds_read_b64_tr_b16 a[162:163], v3 offset:20960
v_mfma_f32_16x16x32_bf16 v[152:155], a[136:139], a[80:83], 0
buffer_load_dwordx4 a[120:123], v1, s[8:11], s28 offen offset:0
v_mfma_f32_16x16x32_bf16 v[156:159], a[136:139], a[84:87], 0
s_waitcnt lgkmcnt(10)
v_mfma_f32_16x16x32_bf16 v[160:163], a[140:143], a[72:75], 0
ds_read_b64_tr_b16 a[164:165], v3 offset:256
v_mfma_f32_16x16x32_bf16 v[164:167], a[140:143], a[76:79], 0
ds_read_b64_tr_b16 a[166:167], v3 offset:2560
v_mfma_f32_16x16x32_bf16 v[168:171], a[140:143], a[80:83], 0
buffer_load_dwordx4 a[124:127], v1, s[8:11], s28 offen offset:1024
v_mfma_f32_16x16x32_bf16 v[172:175], a[140:143], a[84:87], 0
s_waitcnt lgkmcnt(10)
v_mfma_f32_16x16x32_bf16 a[40:43], a[144:147], a[72:75], 0
ds_read_b64_tr_b16 a[168:169], v3 offset:18688
v_mfma_f32_16x16x32_bf16 a[44:47], a[144:147], a[76:79], 0
ds_read_b64_tr_b16 a[170:171], v3 offset:20992
v_mfma_f32_16x16x32_bf16 v[176:179], a[144:147], a[80:83], 0
buffer_load_dwordx4 a[128:131], v1, s[8:11], s28 offen offset:2048
v_mfma_f32_16x16x32_bf16 v[180:183], a[144:147], a[84:87], 0
s_waitcnt lgkmcnt(10)
v_mfma_f32_16x16x32_bf16 v[184:187], a[148:151], a[72:75], 0
ds_read_b64_tr_b16 a[136:137], v3 offset:9216
v_mfma_f32_16x16x32_bf16 v[188:191], a[148:151], a[76:79], 0
ds_read_b64_tr_b16 a[138:139], v3 offset:11520
v_mfma_f32_16x16x32_bf16 v[192:195], a[148:151], a[80:83], 0
buffer_load_dwordx4 a[132:135], v1, s[8:11], s28 offen offset:3072
s_add_u32 s28, s28, 131072
v_mfma_f32_16x16x32_bf16 v[196:199], a[148:151], a[84:87], 0
s_waitcnt lgkmcnt(10)
v_mfma_f32_16x16x32_bf16 a[48:51], a[152:155], a[72:75], 0
ds_read_b64_tr_b16 a[140:141], v3 offset:27648
v_mfma_f32_16x16x32_bf16 a[52:55], a[152:155], a[76:79], 0
ds_read_b64_tr_b16 a[142:143], v3 offset:29952
v_mfma_f32_16x16x32_bf16 v[200:203], a[152:155], a[80:83], 0
v_mfma_f32_16x16x32_bf16 v[204:207], a[152:155], a[84:87], 0
s_waitcnt lgkmcnt(10)
v_mfma_f32_16x16x32_bf16 v[208:211], a[156:159], a[72:75], 0
ds_read_b64_tr_b16 a[144:145], v3 offset:9248
v_mfma_f32_16x16x32_bf16 v[212:215], a[156:159], a[76:79], 0
ds_read_b64_tr_b16 a[146:147], v3 offset:11552
v_mfma_f32_16x16x32_bf16 v[216:219], a[156:159], a[80:83], 0
v_mfma_f32_16x16x32_bf16 v[220:223], a[156:159], a[84:87], 0
s_waitcnt lgkmcnt(10)
v_mfma_f32_16x16x32_bf16 a[56:59], a[160:163], a[72:75], 0
ds_read_b64_tr_b16 a[148:149], v3 offset:27680
v_mfma_f32_16x16x32_bf16 a[60:63], a[160:163], a[76:79], 0
ds_read_b64_tr_b16 a[150:151], v3 offset:29984
v_mfma_f32_16x16x32_bf16 v[224:227], a[160:163], a[80:83], 0
v_mfma_f32_16x16x32_bf16 v[228:231], a[160:163], a[84:87], 0
s_waitcnt lgkmcnt(10)
v_mfma_f32_16x16x32_bf16 v[232:235], a[164:167], a[72:75], 0
ds_read_b64_tr_b16 a[152:153], v3 offset:9280
v_mfma_f32_16x16x32_bf16 v[236:239], a[164:167], a[76:79], 0
ds_read_b64_tr_b16 a[154:155], v3 offset:11584
v_mfma_f32_16x16x32_bf16 v[240:243], a[164:167], a[80:83], 0
v_mfma_f32_16x16x32_bf16 v[244:247], a[164:167], a[84:87], 0
s_waitcnt lgkmcnt(10)
v_mfma_f32_16x16x32_bf16 a[64:67], a[168:171], a[72:75], 0
ds_read_b64_tr_b16 a[156:157], v3 offset:27712
v_mfma_f32_16x16x32_bf16 a[68:71], a[168:171], a[76:79], 0
ds_read_b64_tr_b16 a[158:159], v3 offset:30016
v_mfma_f32_16x16x32_bf16 v[248:251], a[168:171], a[80:83], 0
v_mfma_f32_16x16x32_bf16 v[252:255], a[168:171], a[84:87], 0
s_waitcnt lgkmcnt(10)
s_waitcnt vmcnt(23)
v_mfma_f32_16x16x32_bf16 v[40:43], a[136:139], a[88:91], v[40:43]
ds_read_b64_tr_b16 a[160:161], v3 offset:9312
v_mfma_f32_16x16x32_bf16 v[44:47], a[136:139], a[92:95], v[44:47]
ds_read_b64_tr_b16 a[162:163], v3 offset:11616
v_mfma_f32_16x16x32_bf16 v[48:51], a[136:139], a[96:99], v[48:51]
buffer_load_dwordx4 a[72:75], v1, s[8:11], s28 offen offset:0
v_mfma_f32_16x16x32_bf16 v[52:55], a[136:139], a[100:103], v[52:55]
s_waitcnt lgkmcnt(10)
v_mfma_f32_16x16x32_bf16 a[0:3], a[140:143], a[88:91], a[0:3]
ds_read_b64_tr_b16 a[164:165], v3 offset:27744
v_mfma_f32_16x16x32_bf16 a[4:7], a[140:143], a[92:95], a[4:7]
ds_read_b64_tr_b16 a[166:167], v3 offset:30048
v_mfma_f32_16x16x32_bf16 v[56:59], a[140:143], a[96:99], v[56:59]
buffer_load_dwordx4 a[76:79], v1, s[8:11], s28 offen offset:1024
v_mfma_f32_16x16x32_bf16 v[60:63], a[140:143], a[100:103], v[60:63]
s_waitcnt lgkmcnt(10)
v_mfma_f32_16x16x32_bf16 v[64:67], a[144:147], a[88:91], v[64:67]
ds_read_b64_tr_b16 a[168:169], v3 offset:9344
v_mfma_f32_16x16x32_bf16 v[68:71], a[144:147], a[92:95], v[68:71]
ds_read_b64_tr_b16 a[170:171], v3 offset:11648
v_mfma_f32_16x16x32_bf16 v[72:75], a[144:147], a[96:99], v[72:75]
buffer_load_dwordx4 a[80:83], v1, s[8:11], s28 offen offset:2048
v_mfma_f32_16x16x32_bf16 v[76:79], a[144:147], a[100:103], v[76:79]
s_waitcnt lgkmcnt(10)
v_mfma_f32_16x16x32_bf16 a[8:11], a[148:151], a[88:91], a[8:11]
ds_read_b64_tr_b16 a[136:137], v3 offset:27776
v_mfma_f32_16x16x32_bf16 a[12:15], a[148:151], a[92:95], a[12:15]
ds_read_b64_tr_b16 a[138:139], v3 offset:30080
v_mfma_f32_16x16x32_bf16 v[80:83], a[148:151], a[96:99], v[80:83]
buffer_load_dwordx4 a[84:87], v1, s[8:11], s28 offen offset:3072
s_add_u32 s28, s28, 131072
v_mfma_f32_16x16x32_bf16 v[84:87], a[148:151], a[100:103], v[84:87]
s_waitcnt lgkmcnt(10)
s_waitcnt vmcnt(17)
v_mfma_f32_16x16x32_bf16 v[88:91], a[152:155], a[88:91], v[88:91]
ds_read_b64_tr_b16 a[140:141], v3 offset:9376
v_sub_f32 v18, v18, v14
v_mfma_f32_16x16x32_bf16 v[92:95], a[152:155], a[92:95], v[92:95]
ds_read_b64_tr_b16 a[142:143], v3 offset:11680
v_add_f32 v17, v17, v19
v_mfma_f32_16x16x32_bf16 v[96:99], a[152:155], a[96:99], v[96:99]
v_add_f32 v15, v15, v18
v_fmac_f32 v16, v18, v18
v_mfma_f32_16x16x32_bf16 v[100:103], a[152:155], a[100:103], v[100:103]
s_waitcnt lgkmcnt(10)
v_mfma_f32_16x16x32_bf16 a[16:19], a[156:159], a[88:91], a[16:19]
ds_read_b64_tr_b16 a[144:145], v3 offset:27808
v_sub_f32 v20, v20, v14
v_mfma_f32_16x16x32_bf16 a[20:23], a[156:159], a[92:95], a[20:23]
ds_read_b64_tr_b16 a[146:147], v3 offset:30112
v_add_f32 v17, v17, v21
v_mfma_f32_16x16x32_bf16 v[104:107], a[156:159], a[96:99], v[104:107]
v_add_f32 v15, v15, v20
v_fmac_f32 v16, v20, v20
v_mfma_f32_16x16x32_bf16 v[108:111], a[156:159], a[100:103], v[108:111]
s_waitcnt lgkmcnt(10)
v_mfma_f32_16x16x32_bf16 v[112:115], a[160:163], a[88:91], v[112:115]
ds_read_b64_tr_b16 a[148:149], v3 offset:9408
v_sub_f32 v22, v22, v14
v_mfma_f32_16x16x32_bf16 v[116:119], a[160:163], a[92:95], v[116:119]
ds_read_b64_tr_b16 a[150:151], v3 offset:11712
v_add_f32 v17, v17, v23
v_mfma_f32_16x16x32_bf16 v[120:123], a[160:163], a[96:99], v[120:123]
v_add_f32 v15, v15, v22
v_fmac_f32 v16, v22, v22
v_mfma_f32_16x16x32_bf16 v[124:127], a[160:163], a[100:103], v[124:127]
s_waitcnt lgkmcnt(10)
v_mfma_f32_16x16x32_bf16 a[24:27], a[164:167], a[88:91], a[24:27]
ds_read_b64_tr_b16 a[152:153], v3 offset:27840
v_sub_f32 v24, v24, v14
v_mfma_f32_16x16x32_bf16 a[28:31], a[164:167], a[92:95], a[28:31]
ds_read_b64_tr_b16 a[154:155], v3 offset:30144
v_add_f32 v17, v17, v25
v_mfma_f32_16x16x32_bf16 v[128:131], a[164:167], a[96:99], v[128:131]
v_add_f32 v15, v15, v24
v_fmac_f32 v16, v24, v24
v_mfma_f32_16x16x32_bf16 v[132:135], a[164:167], a[100:103], v[132:135]
s_waitcnt lgkmcnt(10)
v_mfma_f32_16x16x32_bf16 v[136:139], a[168:171], a[88:91], v[136:139]
ds_read_b64_tr_b16 a[156:157], v3 offset:9440
v_sub_f32 v26, v26, v14
v_mfma_f32_16x16x32_bf16 v[140:143], a[168:171], a[92:95], v[140:143]
ds_read_b64_tr_b16 a[158:159], v3 offset:11744
v_add_f32 v17, v17, v27
v_mfma_f32_16x16x32_bf16 v[144:147], a[168:171], a[96:99], v[144:147]
v_add_f32 v15, v15, v26
v_fmac_f32 v16, v26, v26
v_mfma_f32_16x16x32_bf16 v[148:151], a[168:171], a[100:103], v[148:151]
s_waitcnt lgkmcnt(10)
v_mfma_f32_16x16x32_bf16 a[32:35], a[136:139], a[88:91], a[32:35]
ds_read_b64_tr_b16 a[160:161], v3 offset:27872
v_sub_f32 v28, v28, v14
v_mfma_f32_16x16x32_bf16 a[36:39], a[136:139], a[92:95], a[36:39]
ds_read_b64_tr_b16 a[162:163], v3 offset:30176
v_add_f32 v17, v17, v29
v_mfma_f32_16x16x32_bf16 v[152:155], a[136:139], a[96:99], v[152:155]
v_add_f32 v15, v15, v28
v_fmac_f32 v16, v28, v28
v_mfma_f32_16x16x32_bf16 v[156:159], a[136:139], a[100:103], v[156:159]
s_waitcnt lgkmcnt(10)
v_mfma_f32_16x16x32_bf16 v[160:163], a[140:143], a[88:91], v[160:163]
ds_read_b64_tr_b16 a[164:165], v3 offset:9472
v_mfma_f32_16x16x32_bf16 v[164:167], a[140:143], a[92:95], v[164:167]
ds_read_b64_tr_b16 a[166:167], v3 offset:11776
v_mfma_f32_16x16x32_bf16 v[168:171], a[140:143], a[96:99], v[168:171]
buffer_load_dwordx2 v[18:19], v4, s[12:15], s29 offen
s_add_u32 s29, s29, 16384
v_mfma_f32_16x16x32_bf16 v[172:175], a[140:143], a[100:103], v[172:175]
s_waitcnt lgkmcnt(10)
v_mfma_f32_16x16x32_bf16 a[40:43], a[144:147], a[88:91], a[40:43]
ds_read_b64_tr_b16 a[168:169], v3 offset:27904
v_mfma_f32_16x16x32_bf16 a[44:47], a[144:147], a[92:95], a[44:47]
ds_read_b64_tr_b16 a[170:171], v3 offset:30208
v_mfma_f32_16x16x32_bf16 v[176:179], a[144:147], a[96:99], v[176:179]
buffer_load_dwordx2 v[20:21], v4, s[12:15], s29 offen
s_add_u32 s29, s29, 16384
v_add_u32 v3, 36864, v2
v_mfma_f32_16x16x32_bf16 v[180:183], a[144:147], a[100:103], v[180:183]
s_waitcnt lgkmcnt(10)
s_waitcnt vmcnt(33)
s_barrier
v_mfma_f32_16x16x32_bf16 v[184:187], a[148:151], a[88:91], v[184:187]
ds_read_b64_tr_b16 a[136:137], v3 offset:0
v_mfma_f32_16x16x32_bf16 v[188:191], a[148:151], a[92:95], v[188:191]
ds_read_b64_tr_b16 a[138:139], v3 offset:2304
v_mfma_f32_16x16x32_bf16 v[192:195], a[148:151], a[96:99], v[192:195]
buffer_load_dwordx2 v[22:23], v4, s[12:15], s29 offen
s_add_u32 s29, s29, 16384
v_mfma_f32_16x16x32_bf16 v[196:199], a[148:151], a[100:103], v[196:199]
s_waitcnt lgkmcnt(10)
v_mfma_f32_16x16x32_bf16 a[48:51], a[152:155], a[88:91], a[48:51]
ds_read_b64_tr_b16 a[140:141], v3 offset:18432
v_mfma_f32_16x16x32_bf16 a[52:55], a[152:155], a[92:95], a[52:55]
ds_read_b64_tr_b16 a[142:143], v3 offset:20736
v_mfma_f32_16x16x32_bf16 v[200:203], a[152:155], a[96:99], v[200:203]
buffer_load_dwordx2 v[24:25], v4, s[12:15], s29 offen
s_add_u32 s29, s29, 16384
v_mfma_f32_16x16x32_bf16 v[204:207], a[152:155], a[100:103], v[204:207]
s_waitcnt lgkmcnt(10)
v_mfma_f32_16x16x32_bf16 v[208:211], a[156:159], a[88:91], v[208:211]
ds_read_b64_tr_b16 a[144:145], v3 offset:32
v_mfma_f32_16x16x32_bf16 v[212:215], a[156:159], a[92:95], v[212:215]
ds_read_b64_tr_b16 a[146:147], v3 offset:2336
v_mfma_f32_16x16x32_bf16 v[216:219], a[156:159], a[96:99], v[216:219]
buffer_load_dwordx2 v[26:27], v4, s[12:15], s29 offen
s_add_u32 s29, s29, 16384
v_mfma_f32_16x16x32_bf16 v[220:223], a[156:159], a[100:103], v[220:223]
s_waitcnt lgkmcnt(10)
v_mfma_f32_16x16x32_bf16 a[56:59], a[160:163], a[88:91], a[56:59]
ds_read_b64_tr_b16 a[148:149], v3 offset:18464
v_mfma_f32_16x16x32_bf16 a[60:63], a[160:163], a[92:95], a[60:63]
ds_read_b64_tr_b16 a[150:151], v3 offset:20768
v_mfma_f32_16x16x32_bf16 v[224:227], a[160:163], a[96:99], v[224:227]
buffer_load_dwordx2 v[28:29], v4, s[12:15], s29 offen
s_add_u32 s29, s29, 16384
v_mfma_f32_16x16x32_bf16 v[228:231], a[160:163], a[100:103], v[228:231]
s_waitcnt lgkmcnt(10)
v_mfma_f32_16x16x32_bf16 v[232:235], a[164:167], a[88:91], v[232:235]
ds_read_b64_tr_b16 a[152:153], v3 offset:64
v_mfma_f32_16x16x32_bf16 v[236:239], a[164:167], a[92:95], v[236:239]
ds_read_b64_tr_b16 a[154:155], v3 offset:2368
v_mfma_f32_16x16x32_bf16 v[240:243], a[164:167], a[96:99], v[240:243]
v_mfma_f32_16x16x32_bf16 v[244:247], a[164:167], a[100:103], v[244:247]
s_waitcnt lgkmcnt(10)
v_mfma_f32_16x16x32_bf16 a[64:67], a[168:171], a[88:91], a[64:67]
ds_read_b64_tr_b16 a[156:157], v3 offset:18496
v_mfma_f32_16x16x32_bf16 a[68:71], a[168:171], a[92:95], a[68:71]
ds_read_b64_tr_b16 a[158:159], v3 offset:20800
v_mfma_f32_16x16x32_bf16 v[248:251], a[168:171], a[96:99], v[248:251]
v_mfma_f32_16x16x32_bf16 v[252:255], a[168:171], a[100:103], v[252:255]
s_waitcnt lgkmcnt(10)
s_waitcnt vmcnt(29)
v_mfma_f32_16x16x32_bf16 v[40:43], a[136:139], a[104:107], v[40:43]
ds_read_b64_tr_b16 a[160:161], v3 offset:96
v_mfma_f32_16x16x32_bf16 v[44:47], a[136:139], a[108:111], v[44:47]
ds_read_b64_tr_b16 a[162:163], v3 offset:2400
v_mfma_f32_16x16x32_bf16 v[48:51], a[136:139], a[112:115], v[48:51]
s_add_u32 m0, s30, 110592
s_nop 0
buffer_load_dwordx4 v5, s[4:7], s27 offen offset:0 lds
v_mfma_f32_16x16x32_bf16 v[52:55], a[136:139], a[116:119], v[52:55]
tp2_p0:
s_cbranch_execz tp2_ret
tf_p5:
s_cbranch_execz k12_kernel_end
s_waitcnt lgkmcnt(10)
v_mfma_f32_16x16x32_bf16 a[0:3], a[140:143], a[104:107], a[0:3]
ds_read_b64_tr_b16 a[164:165], v3 offset:18528
v_mfma_f32_16x16x32_bf16 a[4:7], a[140:143], a[108:111], a[4:7]
ds_read_b64_tr_b16 a[166:167], v3 offset:20832
v_mfma_f32_16x16x32_bf16 v[56:59], a[140:143], a[112:115], v[56:59]
buffer_load_dwordx4 v6, s[4:7], s27 offen offset:1024 lds
v_mfma_f32_16x16x32_bf16 v[60:63], a[140:143], a[116:119], v[60:63]
s_waitcnt lgkmcnt(10)
v_mfma_f32_16x16x32_bf16 v[64:67], a[144:147], a[104:107], v[64:67]
ds_read_b64_tr_b16 a[168:169], v3 offset:128
v_mfma_f32_16x16x32_bf16 v[68:71], a[144:147], a[108:111], v[68:71]
ds_read_b64_tr_b16 a[170:171], v3 offset:2432
v_mfma_f32_16x16x32_bf16 v[72:75], a[144:147], a[112:115], v[72:75]
buffer_load_dwordx4 v7, s[4:7], s27 offen offset:2048 lds
v_mfma_f32_16x16x32_bf16 v[76:79], a[144:147], a[116:119], v[76:79]
s_waitcnt lgkmcnt(10)
v_mfma_f32_16x16x32_bf16 a[8:11], a[148:151], a[104:107], a[8:11]
ds_read_b64_tr_b16 a[136:137], v3 offset:18560
v_mfma_f32_16x16x32_bf16 a[12:15], a[148:151], a[108:111], a[12:15]
ds_read_b64_tr_b16 a[138:139], v3 offset:20864
v_mfma_f32_16x16x32_bf16 v[80:83], a[148:151], a[112:115], v[80:83]
buffer_load_dwordx4 v8, s[4:7], s27 offen offset:3072 lds
v_mfma_f32_16x16x32_bf16 v[84:87], a[148:151], a[116:119], v[84:87]
s_waitcnt lgkmcnt(10)
v_mfma_f32_16x16x32_bf16 v[88:91], a[152:155], a[104:107], v[88:91]
ds_read_b64_tr_b16 a[140:141], v3 offset:160
v_mfma_f32_16x16x32_bf16 v[92:95], a[152:155], a[108:111], v[92:95]
ds_read_b64_tr_b16 a[142:143], v3 offset:2464
v_mfma_f32_16x16x32_bf16 v[96:99], a[152:155], a[112:115], v[96:99]
s_add_u32 m0, m0, 4096
s_nop 0
buffer_load_dwordx4 v9, s[4:7], s27 offen offset:0 lds
v_mfma_f32_16x16x32_bf16 v[100:103], a[152:155], a[116:119], v[100:103]
s_waitcnt lgkmcnt(10)
v_mfma_f32_16x16x32_bf16 a[16:19], a[156:159], a[104:107], a[16:19]
ds_read_b64_tr_b16 a[144:145], v3 offset:18592
v_mfma_f32_16x16x32_bf16 a[20:23], a[156:159], a[108:111], a[20:23]
ds_read_b64_tr_b16 a[146:147], v3 offset:20896
v_mfma_f32_16x16x32_bf16 v[104:107], a[156:159], a[112:115], v[104:107]
buffer_load_dwordx4 v10, s[4:7], s27 offen offset:1024 lds
v_mfma_f32_16x16x32_bf16 v[108:111], a[156:159], a[116:119], v[108:111]
s_waitcnt lgkmcnt(10)
v_mfma_f32_16x16x32_bf16 v[112:115], a[160:163], a[104:107], v[112:115]
ds_read_b64_tr_b16 a[148:149], v3 offset:192
v_mfma_f32_16x16x32_bf16 v[116:119], a[160:163], a[108:111], v[116:119]
ds_read_b64_tr_b16 a[150:151], v3 offset:2496
v_mfma_f32_16x16x32_bf16 v[120:123], a[160:163], a[112:115], v[120:123]
buffer_load_dwordx4 v11, s[4:7], s27 offen offset:2048 lds
v_mfma_f32_16x16x32_bf16 v[124:127], a[160:163], a[116:119], v[124:127]
s_waitcnt lgkmcnt(10)
v_mfma_f32_16x16x32_bf16 a[24:27], a[164:167], a[104:107], a[24:27]
ds_read_b64_tr_b16 a[152:153], v3 offset:18624
v_mfma_f32_16x16x32_bf16 a[28:31], a[164:167], a[108:111], a[28:31]
ds_read_b64_tr_b16 a[154:155], v3 offset:20928
v_mfma_f32_16x16x32_bf16 v[128:131], a[164:167], a[112:115], v[128:131]
buffer_load_dwordx4 v12, s[4:7], s27 offen offset:3072 lds
v_mfma_f32_16x16x32_bf16 v[132:135], a[164:167], a[116:119], v[132:135]
s_waitcnt lgkmcnt(10)
v_mfma_f32_16x16x32_bf16 v[136:139], a[168:171], a[104:107], v[136:139]
ds_read_b64_tr_b16 a[156:157], v3 offset:224
v_mfma_f32_16x16x32_bf16 v[140:143], a[168:171], a[108:111], v[140:143]
ds_read_b64_tr_b16 a[158:159], v3 offset:2528
v_mfma_f32_16x16x32_bf16 v[144:147], a[168:171], a[112:115], v[144:147]
s_add_u32 m0, m0, 4096
s_nop 0
buffer_load_dwordx4 v13, s[4:7], s27 offen offset:0 lds
s_add_u32 s27, s27, 589824
v_mfma_f32_16x16x32_bf16 v[148:151], a[168:171], a[116:119], v[148:151]
s_waitcnt lgkmcnt(10)
v_mfma_f32_16x16x32_bf16 a[32:35], a[136:139], a[104:107], a[32:35]
ds_read_b64_tr_b16 a[160:161], v3 offset:18656
v_mfma_f32_16x16x32_bf16 a[36:39], a[136:139], a[108:111], a[36:39]
ds_read_b64_tr_b16 a[162:163], v3 offset:20960
v_mfma_f32_16x16x32_bf16 v[152:155], a[136:139], a[112:115], v[152:155]
buffer_load_dwordx4 a[88:91], v1, s[8:11], s28 offen offset:0
v_mfma_f32_16x16x32_bf16 v[156:159], a[136:139], a[116:119], v[156:159]
s_waitcnt lgkmcnt(10)
v_mfma_f32_16x16x32_bf16 v[160:163], a[140:143], a[104:107], v[160:163]
ds_read_b64_tr_b16 a[164:165], v3 offset:256
v_mfma_f32_16x16x32_bf16 v[164:167], a[140:143], a[108:111], v[164:167]
ds_read_b64_tr_b16 a[166:167], v3 offset:2560
v_mfma_f32_16x16x32_bf16 v[168:171], a[140:143], a[112:115], v[168:171]
buffer_load_dwordx4 a[92:95], v1, s[8:11], s28 offen offset:1024
v_mfma_f32_16x16x32_bf16 v[172:175], a[140:143], a[116:119], v[172:175]
s_waitcnt lgkmcnt(10)
v_mfma_f32_16x16x32_bf16 a[40:43], a[144:147], a[104:107], a[40:43]
ds_read_b64_tr_b16 a[168:169], v3 offset:18688
v_mfma_f32_16x16x32_bf16 a[44:47], a[144:147], a[108:111], a[44:47]
ds_read_b64_tr_b16 a[170:171], v3 offset:20992
v_mfma_f32_16x16x32_bf16 v[176:179], a[144:147], a[112:115], v[176:179]
buffer_load_dwordx4 a[96:99], v1, s[8:11], s28 offen offset:2048
v_mfma_f32_16x16x32_bf16 v[180:183], a[144:147], a[116:119], v[180:183]
s_waitcnt lgkmcnt(10)
v_mfma_f32_16x16x32_bf16 v[184:187], a[148:151], a[104:107], v[184:187]
ds_read_b64_tr_b16 a[136:137], v3 offset:9216
v_mfma_f32_16x16x32_bf16 v[188:191], a[148:151], a[108:111], v[188:191]
ds_read_b64_tr_b16 a[138:139], v3 offset:11520
v_mfma_f32_16x16x32_bf16 v[192:195], a[148:151], a[112:115], v[192:195]
buffer_load_dwordx4 a[100:103], v1, s[8:11], s28 offen offset:3072
s_add_u32 s28, s28, 131072
v_mfma_f32_16x16x32_bf16 v[196:199], a[148:151], a[116:119], v[196:199]
s_waitcnt lgkmcnt(10)
v_mfma_f32_16x16x32_bf16 a[48:51], a[152:155], a[104:107], a[48:51]
ds_read_b64_tr_b16 a[140:141], v3 offset:27648
v_mfma_f32_16x16x32_bf16 a[52:55], a[152:155], a[108:111], a[52:55]
ds_read_b64_tr_b16 a[142:143], v3 offset:29952
v_mfma_f32_16x16x32_bf16 v[200:203], a[152:155], a[112:115], v[200:203]
v_mfma_f32_16x16x32_bf16 v[204:207], a[152:155], a[116:119], v[204:207]
s_waitcnt lgkmcnt(10)
v_mfma_f32_16x16x32_bf16 v[208:211], a[156:159], a[104:107], v[208:211]
ds_read_b64_tr_b16 a[144:145], v3 offset:9248
v_mfma_f32_16x16x32_bf16 v[212:215], a[156:159], a[108:111], v[212:215]
ds_read_b64_tr_b16 a[146:147], v3 offset:11552
v_mfma_f32_16x16x32_bf16 v[216:219], a[156:159], a[112:115], v[216:219]
v_mfma_f32_16x16x32_bf16 v[220:223], a[156:159], a[116:119], v[220:223]
s_waitcnt lgkmcnt(10)
v_mfma_f32_16x16x32_bf16 a[56:59], a[160:163], a[104:107], a[56:59]
ds_read_b64_tr_b16 a[148:149], v3 offset:27680
v_mfma_f32_16x16x32_bf16 a[60:63], a[160:163], a[108:111], a[60:63]
ds_read_b64_tr_b16 a[150:151], v3 offset:29984
v_mfma_f32_16x16x32_bf16 v[224:227], a[160:163], a[112:115], v[224:227]
v_mfma_f32_16x16x32_bf16 v[228:231], a[160:163], a[116:119], v[228:231]
s_waitcnt lgkmcnt(10)
v_mfma_f32_16x16x32_bf16 v[232:235], a[164:167], a[104:107], v[232:235]
ds_read_b64_tr_b16 a[152:153], v3 offset:9280
v_mfma_f32_16x16x32_bf16 v[236:239], a[164:167], a[108:111], v[236:239]
ds_read_b64_tr_b16 a[154:155], v3 offset:11584
v_mfma_f32_16x16x32_bf16 v[240:243], a[164:167], a[112:115], v[240:243]
v_mfma_f32_16x16x32_bf16 v[244:247], a[164:167], a[116:119], v[244:247]
s_waitcnt lgkmcnt(10)
v_mfma_f32_16x16x32_bf16 a[64:67], a[168:171], a[104:107], a[64:67]
ds_read_b64_tr_b16 a[156:157], v3 offset:27712
v_mfma_f32_16x16x32_bf16 a[68:71], a[168:171], a[108:111], a[68:71]
ds_read_b64_tr_b16 a[158:159], v3 offset:30016
v_mfma_f32_16x16x32_bf16 v[248:251], a[168:171], a[112:115], v[248:251]
v_mfma_f32_16x16x32_bf16 v[252:255], a[168:171], a[116:119], v[252:255]
s_waitcnt lgkmcnt(10)
s_waitcnt vmcnt(23)
v_mfma_f32_16x16x32_bf16 v[40:43], a[136:139], a[120:123], v[40:43]
ds_read_b64_tr_b16 a[160:161], v3 offset:9312
v_mfma_f32_16x16x32_bf16 v[44:47], a[136:139], a[124:127], v[44:47]
ds_read_b64_tr_b16 a[162:163], v3 offset:11616
v_mfma_f32_16x16x32_bf16 v[48:51], a[136:139], a[128:131], v[48:51]
buffer_load_dwordx4 a[104:107], v1, s[8:11], s28 offen offset:0
v_mfma_f32_16x16x32_bf16 v[52:55], a[136:139], a[132:135], v[52:55]
s_waitcnt lgkmcnt(10)
v_mfma_f32_16x16x32_bf16 a[0:3], a[140:143], a[120:123], a[0:3]
ds_read_b64_tr_b16 a[164:165], v3 offset:27744
v_mfma_f32_16x16x32_bf16 a[4:7], a[140:143], a[124:127], a[4:7]
ds_read_b64_tr_b16 a[166:167], v3 offset:30048
v_mfma_f32_16x16x32_bf16 v[56:59], a[140:143], a[128:131], v[56:59]
buffer_load_dwordx4 a[108:111], v1, s[8:11], s28 offen offset:1024
v_mfma_f32_16x16x32_bf16 v[60:63], a[140:143], a[132:135], v[60:63]
s_waitcnt lgkmcnt(10)
v_mfma_f32_16x16x32_bf16 v[64:67], a[144:147], a[120:123], v[64:67]
ds_read_b64_tr_b16 a[168:169], v3 offset:9344
v_mfma_f32_16x16x32_bf16 v[68:71], a[144:147], a[124:127], v[68:71]
ds_read_b64_tr_b16 a[170:171], v3 offset:11648
v_mfma_f32_16x16x32_bf16 v[72:75], a[144:147], a[128:131], v[72:75]
buffer_load_dwordx4 a[112:115], v1, s[8:11], s28 offen offset:2048
v_mfma_f32_16x16x32_bf16 v[76:79], a[144:147], a[132:135], v[76:79]
s_waitcnt lgkmcnt(10)
v_mfma_f32_16x16x32_bf16 a[8:11], a[148:151], a[120:123], a[8:11]
ds_read_b64_tr_b16 a[136:137], v3 offset:27776
v_mfma_f32_16x16x32_bf16 a[12:15], a[148:151], a[124:127], a[12:15]
ds_read_b64_tr_b16 a[138:139], v3 offset:30080
v_mfma_f32_16x16x32_bf16 v[80:83], a[148:151], a[128:131], v[80:83]
buffer_load_dwordx4 a[116:119], v1, s[8:11], s28 offen offset:3072
s_add_u32 s28, s28, 131072
v_mfma_f32_16x16x32_bf16 v[84:87], a[148:151], a[132:135], v[84:87]
s_waitcnt lgkmcnt(10)
s_waitcnt vmcnt(17)
v_mfma_f32_16x16x32_bf16 v[88:91], a[152:155], a[120:123], v[88:91]
ds_read_b64_tr_b16 a[140:141], v3 offset:9376
v_sub_f32 v18, v18, v14
v_mfma_f32_16x16x32_bf16 v[92:95], a[152:155], a[124:127], v[92:95]
ds_read_b64_tr_b16 a[142:143], v3 offset:11680
v_add_f32 v17, v17, v19
v_mfma_f32_16x16x32_bf16 v[96:99], a[152:155], a[128:131], v[96:99]
v_add_f32 v15, v15, v18
v_fmac_f32 v16, v18, v18
v_mfma_f32_16x16x32_bf16 v[100:103], a[152:155], a[132:135], v[100:103]
s_waitcnt lgkmcnt(10)
v_mfma_f32_16x16x32_bf16 a[16:19], a[156:159], a[120:123], a[16:19]
ds_read_b64_tr_b16 a[144:145], v3 offset:27808
v_sub_f32 v20, v20, v14
v_mfma_f32_16x16x32_bf16 a[20:23], a[156:159], a[124:127], a[20:23]
ds_read_b64_tr_b16 a[146:147], v3 offset:30112
v_add_f32 v17, v17, v21
v_mfma_f32_16x16x32_bf16 v[104:107], a[156:159], a[128:131], v[104:107]
v_add_f32 v15, v15, v20
v_fmac_f32 v16, v20, v20
v_mfma_f32_16x16x32_bf16 v[108:111], a[156:159], a[132:135], v[108:111]
s_waitcnt lgkmcnt(10)
v_mfma_f32_16x16x32_bf16 v[112:115], a[160:163], a[120:123], v[112:115]
ds_read_b64_tr_b16 a[148:149], v3 offset:9408
v_sub_f32 v22, v22, v14
v_mfma_f32_16x16x32_bf16 v[116:119], a[160:163], a[124:127], v[116:119]
ds_read_b64_tr_b16 a[150:151], v3 offset:11712
v_add_f32 v17, v17, v23
v_mfma_f32_16x16x32_bf16 v[120:123], a[160:163], a[128:131], v[120:123]
v_add_f32 v15, v15, v22
v_fmac_f32 v16, v22, v22
v_mfma_f32_16x16x32_bf16 v[124:127], a[160:163], a[132:135], v[124:127]
s_waitcnt lgkmcnt(10)
v_mfma_f32_16x16x32_bf16 a[24:27], a[164:167], a[120:123], a[24:27]
ds_read_b64_tr_b16 a[152:153], v3 offset:27840
v_sub_f32 v24, v24, v14
v_mfma_f32_16x16x32_bf16 a[28:31], a[164:167], a[124:127], a[28:31]
ds_read_b64_tr_b16 a[154:155], v3 offset:30144
v_add_f32 v17, v17, v25
v_mfma_f32_16x16x32_bf16 v[128:131], a[164:167], a[128:131], v[128:131]
v_add_f32 v15, v15, v24
v_fmac_f32 v16, v24, v24
v_mfma_f32_16x16x32_bf16 v[132:135], a[164:167], a[132:135], v[132:135]
s_waitcnt lgkmcnt(10)
v_mfma_f32_16x16x32_bf16 v[136:139], a[168:171], a[120:123], v[136:139]
ds_read_b64_tr_b16 a[156:157], v3 offset:9440
v_sub_f32 v26, v26, v14
v_mfma_f32_16x16x32_bf16 v[140:143], a[168:171], a[124:127], v[140:143]
ds_read_b64_tr_b16 a[158:159], v3 offset:11744
v_add_f32 v17, v17, v27
v_mfma_f32_16x16x32_bf16 v[144:147], a[168:171], a[128:131], v[144:147]
v_add_f32 v15, v15, v26
v_fmac_f32 v16, v26, v26
v_mfma_f32_16x16x32_bf16 v[148:151], a[168:171], a[132:135], v[148:151]
s_waitcnt lgkmcnt(10)
v_mfma_f32_16x16x32_bf16 a[32:35], a[136:139], a[120:123], a[32:35]
ds_read_b64_tr_b16 a[160:161], v3 offset:27872
v_sub_f32 v28, v28, v14
v_mfma_f32_16x16x32_bf16 a[36:39], a[136:139], a[124:127], a[36:39]
ds_read_b64_tr_b16 a[162:163], v3 offset:30176
v_add_f32 v17, v17, v29
v_mfma_f32_16x16x32_bf16 v[152:155], a[136:139], a[128:131], v[152:155]
v_add_f32 v15, v15, v28
v_fmac_f32 v16, v28, v28
v_mfma_f32_16x16x32_bf16 v[156:159], a[136:139], a[132:135], v[156:159]
s_waitcnt lgkmcnt(10)
v_mfma_f32_16x16x32_bf16 v[160:163], a[140:143], a[120:123], v[160:163]
ds_read_b64_tr_b16 a[164:165], v3 offset:9472
v_mfma_f32_16x16x32_bf16 v[164:167], a[140:143], a[124:127], v[164:167]
ds_read_b64_tr_b16 a[166:167], v3 offset:11776
v_mfma_f32_16x16x32_bf16 v[168:171], a[140:143], a[128:131], v[168:171]
buffer_load_dwordx2 v[18:19], v4, s[12:15], s29 offen
s_add_u32 s29, s29, 16384
v_mfma_f32_16x16x32_bf16 v[172:175], a[140:143], a[132:135], v[172:175]
s_waitcnt lgkmcnt(10)
v_mfma_f32_16x16x32_bf16 a[40:43], a[144:147], a[120:123], a[40:43]
ds_read_b64_tr_b16 a[168:169], v3 offset:27904
v_mfma_f32_16x16x32_bf16 a[44:47], a[144:147], a[124:127], a[44:47]
ds_read_b64_tr_b16 a[170:171], v3 offset:30208
v_mfma_f32_16x16x32_bf16 v[176:179], a[144:147], a[128:131], v[176:179]
buffer_load_dwordx2 v[20:21], v4, s[12:15], s29 offen
s_add_u32 s29, s29, 16384
v_add_u32 v3, 73728, v2
v_mfma_f32_16x16x32_bf16 v[180:183], a[144:147], a[132:135], v[180:183]
s_waitcnt lgkmcnt(10)
s_waitcnt vmcnt(33)
s_barrier
v_mfma_f32_16x16x32_bf16 v[184:187], a[148:151], a[120:123], v[184:187]
ds_read_b64_tr_b16 a[136:137], v3 offset:0
v_mfma_f32_16x16x32_bf16 v[188:191], a[148:151], a[124:127], v[188:191]
ds_read_b64_tr_b16 a[138:139], v3 offset:2304
v_mfma_f32_16x16x32_bf16 v[192:195], a[148:151], a[128:131], v[192:195]
buffer_load_dwordx2 v[22:23], v4, s[12:15], s29 offen
s_add_u32 s29, s29, 16384
v_mfma_f32_16x16x32_bf16 v[196:199], a[148:151], a[132:135], v[196:199]
s_waitcnt lgkmcnt(10)
v_mfma_f32_16x16x32_bf16 a[48:51], a[152:155], a[120:123], a[48:51]
ds_read_b64_tr_b16 a[140:141], v3 offset:18432
v_mfma_f32_16x16x32_bf16 a[52:55], a[152:155], a[124:127], a[52:55]
ds_read_b64_tr_b16 a[142:143], v3 offset:20736
v_mfma_f32_16x16x32_bf16 v[200:203], a[152:155], a[128:131], v[200:203]
buffer_load_dwordx2 v[24:25], v4, s[12:15], s29 offen
s_add_u32 s29, s29, 16384
v_mfma_f32_16x16x32_bf16 v[204:207], a[152:155], a[132:135], v[204:207]
s_waitcnt lgkmcnt(10)
v_mfma_f32_16x16x32_bf16 v[208:211], a[156:159], a[120:123], v[208:211]
ds_read_b64_tr_b16 a[144:145], v3 offset:32
v_mfma_f32_16x16x32_bf16 v[212:215], a[156:159], a[124:127], v[212:215]
ds_read_b64_tr_b16 a[146:147], v3 offset:2336
v_mfma_f32_16x16x32_bf16 v[216:219], a[156:159], a[128:131], v[216:219]
buffer_load_dwordx2 v[26:27], v4, s[12:15], s29 offen
s_add_u32 s29, s29, 16384
v_mfma_f32_16x16x32_bf16 v[220:223], a[156:159], a[132:135], v[220:223]
s_waitcnt lgkmcnt(10)
v_mfma_f32_16x16x32_bf16 a[56:59], a[160:163], a[120:123], a[56:59]
ds_read_b64_tr_b16 a[148:149], v3 offset:18464
v_mfma_f32_16x16x32_bf16 a[60:63], a[160:163], a[124:127], a[60:63]
ds_read_b64_tr_b16 a[150:151], v3 offset:20768
v_mfma_f32_16x16x32_bf16 v[224:227], a[160:163], a[128:131], v[224:227]
buffer_load_dwordx2 v[28:29], v4, s[12:15], s29 offen
s_add_u32 s29, s29, 16384
v_mfma_f32_16x16x32_bf16 v[228:231], a[160:163], a[132:135], v[228:231]
s_waitcnt lgkmcnt(10)
v_mfma_f32_16x16x32_bf16 v[232:235], a[164:167], a[120:123], v[232:235]
ds_read_b64_tr_b16 a[152:153], v3 offset:64
v_mfma_f32_16x16x32_bf16 v[236:239], a[164:167], a[124:127], v[236:239]
ds_read_b64_tr_b16 a[154:155], v3 offset:2368
v_mfma_f32_16x16x32_bf16 v[240:243], a[164:167], a[128:131], v[240:243]
v_mfma_f32_16x16x32_bf16 v[244:247], a[164:167], a[132:135], v[244:247]
s_waitcnt lgkmcnt(10)
v_mfma_f32_16x16x32_bf16 a[64:67], a[168:171], a[120:123], a[64:67]
ds_read_b64_tr_b16 a[156:157], v3 offset:18496
v_mfma_f32_16x16x32_bf16 a[68:71], a[168:171], a[124:127], a[68:71]
ds_read_b64_tr_b16 a[158:159], v3 offset:20800
v_mfma_f32_16x16x32_bf16 v[248:251], a[168:171], a[128:131], v[248:251]
v_mfma_f32_16x16x32_bf16 v[252:255], a[168:171], a[132:135], v[252:255]
s_waitcnt lgkmcnt(10)
s_waitcnt vmcnt(29)
v_mfma_f32_16x16x32_bf16 v[40:43], a[136:139], a[72:75], v[40:43]
ds_read_b64_tr_b16 a[160:161], v3 offset:96
v_mfma_f32_16x16x32_bf16 v[44:47], a[136:139], a[76:79], v[44:47]
ds_read_b64_tr_b16 a[162:163], v3 offset:2400
v_mfma_f32_16x16x32_bf16 v[48:51], a[136:139], a[80:83], v[48:51]
s_add_u32 m0, s30, 0
s_nop 0
buffer_load_dwordx4 v5, s[4:7], s27 offen offset:0 lds
v_mfma_f32_16x16x32_bf16 v[52:55], a[136:139], a[84:87], v[52:55]
s_waitcnt lgkmcnt(10)
v_mfma_f32_16x16x32_bf16 a[0:3], a[140:143], a[72:75], a[0:3]
ds_read_b64_tr_b16 a[164:165], v3 offset:18528
v_mfma_f32_16x16x32_bf16 a[4:7], a[140:143], a[76:79], a[4:7]
ds_read_b64_tr_b16 a[166:167], v3 offset:20832
v_mfma_f32_16x16x32_bf16 v[56:59], a[140:143], a[80:83], v[56:59]
buffer_load_dwordx4 v6, s[4:7], s27 offen offset:1024 lds
v_mfma_f32_16x16x32_bf16 v[60:63], a[140:143], a[84:87], v[60:63]
s_waitcnt lgkmcnt(10)
v_mfma_f32_16x16x32_bf16 v[64:67], a[144:147], a[72:75], v[64:67]
ds_read_b64_tr_b16 a[168:169], v3 offset:128
v_mfma_f32_16x16x32_bf16 v[68:71], a[144:147], a[76:79], v[68:71]
ds_read_b64_tr_b16 a[170:171], v3 offset:2432
v_mfma_f32_16x16x32_bf16 v[72:75], a[144:147], a[80:83], v[72:75]
buffer_load_dwordx4 v7, s[4:7], s27 offen offset:2048 lds
v_mfma_f32_16x16x32_bf16 v[76:79], a[144:147], a[84:87], v[76:79]
s_waitcnt lgkmcnt(10)
v_mfma_f32_16x16x32_bf16 a[8:11], a[148:151], a[72:75], a[8:11]
ds_read_b64_tr_b16 a[136:137], v3 offset:18560
v_mfma_f32_16x16x32_bf16 a[12:15], a[148:151], a[76:79], a[12:15]
ds_read_b64_tr_b16 a[138:139], v3 offset:20864
v_mfma_f32_16x16x32_bf16 v[80:83], a[148:151], a[80:83], v[80:83]
buffer_load_dwordx4 v8, s[4:7], s27 offen offset:3072 lds
v_mfma_f32_16x16x32_bf16 v[84:87], a[148:151], a[84:87], v[84:87]
s_waitcnt lgkmcnt(10)
v_mfma_f32_16x16x32_bf16 v[88:91], a[152:155], a[72:75], v[88:91]
ds_read_b64_tr_b16 a[140:141], v3 offset:160
v_mfma_f32_16x16x32_bf16 v[92:95], a[152:155], a[76:79], v[92:95]
ds_read_b64_tr_b16 a[142:143], v3 offset:2464
v_mfma_f32_16x16x32_bf16 v[96:99], a[152:155], a[80:83], v[96:99]
s_add_u32 m0, m0, 4096
s_nop 0
buffer_load_dwordx4 v9, s[4:7], s27 offen offset:0 lds
v_mfma_f32_16x16x32_bf16 v[100:103], a[152:155], a[84:87], v[100:103]
s_waitcnt lgkmcnt(10)
v_mfma_f32_16x16x32_bf16 a[16:19], a[156:159], a[72:75], a[16:19]
ds_read_b64_tr_b16 a[144:145], v3 offset:18592
v_mfma_f32_16x16x32_bf16 a[20:23], a[156:159], a[76:79], a[20:23]
ds_read_b64_tr_b16 a[146:147], v3 offset:20896
v_mfma_f32_16x16x32_bf16 v[104:107], a[156:159], a[80:83], v[104:107]
buffer_load_dwordx4 v10, s[4:7], s27 offen offset:1024 lds
v_mfma_f32_16x16x32_bf16 v[108:111], a[156:159], a[84:87], v[108:111]
s_waitcnt lgkmcnt(10)
v_mfma_f32_16x16x32_bf16 v[112:115], a[160:163], a[72:75], v[112:115]
ds_read_b64_tr_b16 a[148:149], v3 offset:192
v_mfma_f32_16x16x32_bf16 v[116:119], a[160:163], a[76:79], v[116:119]
ds_read_b64_tr_b16 a[150:151], v3 offset:2496
v_mfma_f32_16x16x32_bf16 v[120:123], a[160:163], a[80:83], v[120:123]
buffer_load_dwordx4 v11, s[4:7], s27 offen offset:2048 lds
v_mfma_f32_16x16x32_bf16 v[124:127], a[160:163], a[84:87], v[124:127]
s_waitcnt lgkmcnt(10)
v_mfma_f32_16x16x32_bf16 a[24:27], a[164:167], a[72:75], a[24:27]
ds_read_b64_tr_b16 a[152:153], v3 offset:18624
v_mfma_f32_16x16x32_bf16 a[28:31], a[164:167], a[76:79], a[28:31]
ds_read_b64_tr_b16 a[154:155], v3 offset:20928
v_mfma_f32_16x16x32_bf16 v[128:131], a[164:167], a[80:83], v[128:131]
buffer_load_dwordx4 v12, s[4:7], s27 offen offset:3072 lds
v_mfma_f32_16x16x32_bf16 v[132:135], a[164:167], a[84:87], v[132:135]
s_waitcnt lgkmcnt(10)
v_mfma_f32_16x16x32_bf16 v[136:139], a[168:171], a[72:75], v[136:139]
ds_read_b64_tr_b16 a[156:157], v3 offset:224
v_mfma_f32_16x16x32_bf16 v[140:143], a[168:171], a[76:79], v[140:143]
ds_read_b64_tr_b16 a[158:159], v3 offset:2528
v_mfma_f32_16x16x32_bf16 v[144:147], a[168:171], a[80:83], v[144:147]
s_add_u32 m0, m0, 4096
s_nop 0
buffer_load_dwordx4 v13, s[4:7], s27 offen offset:0 lds
s_add_u32 s27, s27, 589824
v_mfma_f32_16x16x32_bf16 v[148:151], a[168:171], a[84:87], v[148:151]
s_waitcnt lgkmcnt(10)
v_mfma_f32_16x16x32_bf16 a[32:35], a[136:139], a[72:75], a[32:35]
ds_read_b64_tr_b16 a[160:161], v3 offset:18656
v_mfma_f32_16x16x32_bf16 a[36:39], a[136:139], a[76:79], a[36:39]
ds_read_b64_tr_b16 a[162:163], v3 offset:20960
v_mfma_f32_16x16x32_bf16 v[152:155], a[136:139], a[80:83], v[152:155]
buffer_load_dwordx4 a[120:123], v1, s[8:11], s28 offen offset:0
v_mfma_f32_16x16x32_bf16 v[156:159], a[136:139], a[84:87], v[156:159]
s_waitcnt lgkmcnt(10)
v_mfma_f32_16x16x32_bf16 v[160:163], a[140:143], a[72:75], v[160:163]
ds_read_b64_tr_b16 a[164:165], v3 offset:256
v_mfma_f32_16x16x32_bf16 v[164:167], a[140:143], a[76:79], v[164:167]
ds_read_b64_tr_b16 a[166:167], v3 offset:2560
v_mfma_f32_16x16x32_bf16 v[168:171], a[140:143], a[80:83], v[168:171]
buffer_load_dwordx4 a[124:127], v1, s[8:11], s28 offen offset:1024
v_mfma_f32_16x16x32_bf16 v[172:175], a[140:143], a[84:87], v[172:175]
s_waitcnt lgkmcnt(10)
v_mfma_f32_16x16x32_bf16 a[40:43], a[144:147], a[72:75], a[40:43]
ds_read_b64_tr_b16 a[168:169], v3 offset:18688
v_mfma_f32_16x16x32_bf16 a[44:47], a[144:147], a[76:79], a[44:47]
ds_read_b64_tr_b16 a[170:171], v3 offset:20992
v_mfma_f32_16x16x32_bf16 v[176:179], a[144:147], a[80:83], v[176:179]
buffer_load_dwordx4 a[128:131], v1, s[8:11], s28 offen offset:2048
v_mfma_f32_16x16x32_bf16 v[180:183], a[144:147], a[84:87], v[180:183]
s_waitcnt lgkmcnt(10)
v_mfma_f32_16x16x32_bf16 v[184:187], a[148:151], a[72:75], v[184:187]
ds_read_b64_tr_b16 a[136:137], v3 offset:9216
v_mfma_f32_16x16x32_bf16 v[188:191], a[148:151], a[76:79], v[188:191]
ds_read_b64_tr_b16 a[138:139], v3 offset:11520
v_mfma_f32_16x16x32_bf16 v[192:195], a[148:151], a[80:83], v[192:195]
buffer_load_dwordx4 a[132:135], v1, s[8:11], s28 offen offset:3072
s_add_u32 s28, s28, 131072
v_mfma_f32_16x16x32_bf16 v[196:199], a[148:151], a[84:87], v[196:199]
s_waitcnt lgkmcnt(10)
v_mfma_f32_16x16x32_bf16 a[48:51], a[152:155], a[72:75], a[48:51]
ds_read_b64_tr_b16 a[140:141], v3 offset:27648
v_mfma_f32_16x16x32_bf16 a[52:55], a[152:155], a[76:79], a[52:55]
ds_read_b64_tr_b16 a[142:143], v3 offset:29952
v_mfma_f32_16x16x32_bf16 v[200:203], a[152:155], a[80:83], v[200:203]
v_mfma_f32_16x16x32_bf16 v[204:207], a[152:155], a[84:87], v[204:207]
s_waitcnt lgkmcnt(10)
v_mfma_f32_16x16x32_bf16 v[208:211], a[156:159], a[72:75], v[208:211]
ds_read_b64_tr_b16 a[144:145], v3 offset:9248
v_mfma_f32_16x16x32_bf16 v[212:215], a[156:159], a[76:79], v[212:215]
ds_read_b64_tr_b16 a[146:147], v3 offset:11552
v_mfma_f32_16x16x32_bf16 v[216:219], a[156:159], a[80:83], v[216:219]
v_mfma_f32_16x16x32_bf16 v[220:223], a[156:159], a[84:87], v[220:223]
s_waitcnt lgkmcnt(10)
v_mfma_f32_16x16x32_bf16 a[56:59], a[160:163], a[72:75], a[56:59]
ds_read_b64_tr_b16 a[148:149], v3 offset:27680
v_mfma_f32_16x16x32_bf16 a[60:63], a[160:163], a[76:79], a[60:63]
ds_read_b64_tr_b16 a[150:151], v3 offset:29984
v_mfma_f32_16x16x32_bf16 v[224:227], a[160:163], a[80:83], v[224:227]
v_mfma_f32_16x16x32_bf16 v[228:231], a[160:163], a[84:87], v[228:231]
s_waitcnt lgkmcnt(10)
v_mfma_f32_16x16x32_bf16 v[232:235], a[164:167], a[72:75], v[232:235]
ds_read_b64_tr_b16 a[152:153], v3 offset:9280
v_mfma_f32_16x16x32_bf16 v[236:239], a[164:167], a[76:79], v[236:239]
ds_read_b64_tr_b16 a[154:155], v3 offset:11584
v_mfma_f32_16x16x32_bf16 v[240:243], a[164:167], a[80:83], v[240:243]
v_mfma_f32_16x16x32_bf16 v[244:247], a[164:167], a[84:87], v[244:247]
s_waitcnt lgkmcnt(10)
v_mfma_f32_16x16x32_bf16 a[64:67], a[168:171], a[72:75], a[64:67]
ds_read_b64_tr_b16 a[156:157], v3 offset:27712
v_mfma_f32_16x16x32_bf16 a[68:71], a[168:171], a[76:79], a[68:71]
ds_read_b64_tr_b16 a[158:159], v3 offset:30016
v_mfma_f32_16x16x32_bf16 v[248:251], a[168:171], a[80:83], v[248:251]
v_mfma_f32_16x16x32_bf16 v[252:255], a[168:171], a[84:87], v[252:255]
s_waitcnt lgkmcnt(10)
s_waitcnt vmcnt(23)
v_mfma_f32_16x16x32_bf16 v[40:43], a[136:139], a[88:91], v[40:43]
ds_read_b64_tr_b16 a[160:161], v3 offset:9312
v_mfma_f32_16x16x32_bf16 v[44:47], a[136:139], a[92:95], v[44:47]
ds_read_b64_tr_b16 a[162:163], v3 offset:11616
v_mfma_f32_16x16x32_bf16 v[48:51], a[136:139], a[96:99], v[48:51]
buffer_load_dwordx4 a[72:75], v1, s[8:11], s28 offen offset:0
v_mfma_f32_16x16x32_bf16 v[52:55], a[136:139], a[100:103], v[52:55]
s_waitcnt lgkmcnt(10)
v_mfma_f32_16x16x32_bf16 a[0:3], a[140:143], a[88:91], a[0:3]
ds_read_b64_tr_b16 a[164:165], v3 offset:27744
v_mfma_f32_16x16x32_bf16 a[4:7], a[140:143], a[92:95], a[4:7]
ds_read_b64_tr_b16 a[166:167], v3 offset:30048
v_mfma_f32_16x16x32_bf16 v[56:59], a[140:143], a[96:99], v[56:59]
buffer_load_dwordx4 a[76:79], v1, s[8:11], s28 offen offset:1024
v_mfma_f32_16x16x32_bf16 v[60:63], a[140:143], a[100:103], v[60:63]
s_waitcnt lgkmcnt(10)
v_mfma_f32_16x16x32_bf16 v[64:67], a[144:147], a[88:91], v[64:67]
ds_read_b64_tr_b16 a[168:169], v3 offset:9344
v_mfma_f32_16x16x32_bf16 v[68:71], a[144:147], a[92:95], v[68:71]
ds_read_b64_tr_b16 a[170:171], v3 offset:11648
v_mfma_f32_16x16x32_bf16 v[72:75], a[144:147], a[96:99], v[72:75]
buffer_load_dwordx4 a[80:83], v1, s[8:11], s28 offen offset:2048
v_mfma_f32_16x16x32_bf16 v[76:79], a[144:147], a[100:103], v[76:79]
s_waitcnt lgkmcnt(10)
v_mfma_f32_16x16x32_bf16 a[8:11], a[148:151], a[88:91], a[8:11]
ds_read_b64_tr_b16 a[136:137], v3 offset:27776
v_mfma_f32_16x16x32_bf16 a[12:15], a[148:151], a[92:95], a[12:15]
ds_read_b64_tr_b16 a[138:139], v3 offset:30080
v_mfma_f32_16x16x32_bf16 v[80:83], a[148:151], a[96:99], v[80:83]
buffer_load_dwordx4 a[84:87], v1, s[8:11], s28 offen offset:3072
s_add_u32 s28, s28, 131072
v_mfma_f32_16x16x32_bf16 v[84:87], a[148:151], a[100:103], v[84:87]
s_waitcnt lgkmcnt(10)
s_waitcnt vmcnt(17)
v_mfma_f32_16x16x32_bf16 v[88:91], a[152:155], a[88:91], v[88:91]
ds_read_b64_tr_b16 a[140:141], v3 offset:9376
v_sub_f32 v18, v18, v14
v_mfma_f32_16x16x32_bf16 v[92:95], a[152:155], a[92:95], v[92:95]
ds_read_b64_tr_b16 a[142:143], v3 offset:11680
v_add_f32 v17, v17, v19
v_mfma_f32_16x16x32_bf16 v[96:99], a[152:155], a[96:99], v[96:99]
v_add_f32 v15, v15, v18
v_fmac_f32 v16, v18, v18
v_mfma_f32_16x16x32_bf16 v[100:103], a[152:155], a[100:103], v[100:103]
s_waitcnt lgkmcnt(10)
v_mfma_f32_16x16x32_bf16 a[16:19], a[156:159], a[88:91], a[16:19]
ds_read_b64_tr_b16 a[144:145], v3 offset:27808
v_sub_f32 v20, v20, v14
v_mfma_f32_16x16x32_bf16 a[20:23], a[156:159], a[92:95], a[20:23]
ds_read_b64_tr_b16 a[146:147], v3 offset:30112
v_add_f32 v17, v17, v21
v_mfma_f32_16x16x32_bf16 v[104:107], a[156:159], a[96:99], v[104:107]
v_add_f32 v15, v15, v20
v_fmac_f32 v16, v20, v20
v_mfma_f32_16x16x32_bf16 v[108:111], a[156:159], a[100:103], v[108:111]
s_waitcnt lgkmcnt(10)
v_mfma_f32_16x16x32_bf16 v[112:115], a[160:163], a[88:91], v[112:115]
ds_read_b64_tr_b16 a[148:149], v3 offset:9408
v_sub_f32 v22, v22, v14
v_mfma_f32_16x16x32_bf16 v[116:119], a[160:163], a[92:95], v[116:119]
ds_read_b64_tr_b16 a[150:151], v3 offset:11712
v_add_f32 v17, v17, v23
v_mfma_f32_16x16x32_bf16 v[120:123], a[160:163], a[96:99], v[120:123]
v_add_f32 v15, v15, v22
v_fmac_f32 v16, v22, v22
v_mfma_f32_16x16x32_bf16 v[124:127], a[160:163], a[100:103], v[124:127]
s_waitcnt lgkmcnt(10)
v_mfma_f32_16x16x32_bf16 a[24:27], a[164:167], a[88:91], a[24:27]
ds_read_b64_tr_b16 a[152:153], v3 offset:27840
v_sub_f32 v24, v24, v14
v_mfma_f32_16x16x32_bf16 a[28:31], a[164:167], a[92:95], a[28:31]
ds_read_b64_tr_b16 a[154:155], v3 offset:30144
v_add_f32 v17, v17, v25
v_mfma_f32_16x16x32_bf16 v[128:131], a[164:167], a[96:99], v[128:131]
v_add_f32 v15, v15, v24
v_fmac_f32 v16, v24, v24
v_mfma_f32_16x16x32_bf16 v[132:135], a[164:167], a[100:103], v[132:135]
s_waitcnt lgkmcnt(10)
v_mfma_f32_16x16x32_bf16 v[136:139], a[168:171], a[88:91], v[136:139]
ds_read_b64_tr_b16 a[156:157], v3 offset:9440
v_sub_f32 v26, v26, v14
v_mfma_f32_16x16x32_bf16 v[140:143], a[168:171], a[92:95], v[140:143]
ds_read_b64_tr_b16 a[158:159], v3 offset:11744
v_add_f32 v17, v17, v27
v_mfma_f32_16x16x32_bf16 v[144:147], a[168:171], a[96:99], v[144:147]
v_add_f32 v15, v15, v26
v_fmac_f32 v16, v26, v26
v_mfma_f32_16x16x32_bf16 v[148:151], a[168:171], a[100:103], v[148:151]
s_waitcnt lgkmcnt(10)
v_mfma_f32_16x16x32_bf16 a[32:35], a[136:139], a[88:91], a[32:35]
ds_read_b64_tr_b16 a[160:161], v3 offset:27872
v_sub_f32 v28, v28, v14
v_mfma_f32_16x16x32_bf16 a[36:39], a[136:139], a[92:95], a[36:39]
ds_read_b64_tr_b16 a[162:163], v3 offset:30176
v_add_f32 v17, v17, v29
v_mfma_f32_16x16x32_bf16 v[152:155], a[136:139], a[96:99], v[152:155]
v_add_f32 v15, v15, v28
v_fmac_f32 v16, v28, v28
v_mfma_f32_16x16x32_bf16 v[156:159], a[136:139], a[100:103], v[156:159]
s_waitcnt lgkmcnt(10)
v_mfma_f32_16x16x32_bf16 v[160:163], a[140:143], a[88:91], v[160:163]
ds_read_b64_tr_b16 a[164:165], v3 offset:9472
v_mfma_f32_16x16x32_bf16 v[164:167], a[140:143], a[92:95], v[164:167]
ds_read_b64_tr_b16 a[166:167], v3 offset:11776
v_mfma_f32_16x16x32_bf16 v[168:171], a[140:143], a[96:99], v[168:171]
buffer_load_dwordx2 v[18:19], v4, s[12:15], s29 offen
s_add_u32 s29, s29, 16384
v_mfma_f32_16x16x32_bf16 v[172:175], a[140:143], a[100:103], v[172:175]
s_waitcnt lgkmcnt(10)
v_mfma_f32_16x16x32_bf16 a[40:43], a[144:147], a[88:91], a[40:43]
ds_read_b64_tr_b16 a[168:169], v3 offset:27904
v_mfma_f32_16x16x32_bf16 a[44:47], a[144:147], a[92:95], a[44:47]
ds_read_b64_tr_b16 a[170:171], v3 offset:30208
v_mfma_f32_16x16x32_bf16 v[176:179], a[144:147], a[96:99], v[176:179]
buffer_load_dwordx2 v[20:21], v4, s[12:15], s29 offen
tp2_p1:
s_cbranch_execz tp2_ret
tf_p6:
s_cbranch_execz k12_kernel_end
s_add_u32 s29, s29, 16384
v_add_u32 v3, 110592, v2
v_mfma_f32_16x16x32_bf16 v[180:183], a[144:147], a[100:103], v[180:183]
s_waitcnt lgkmcnt(10)
s_waitcnt vmcnt(33)
s_barrier
v_mfma_f32_16x16x32_bf16 v[184:187], a[148:151], a[88:91], v[184:187]
ds_read_b64_tr_b16 a[136:137], v3 offset:0
v_mfma_f32_16x16x32_bf16 v[188:191], a[148:151], a[92:95], v[188:191]
ds_read_b64_tr_b16 a[138:139], v3 offset:2304
v_mfma_f32_16x16x32_bf16 v[192:195], a[148:151], a[96:99], v[192:195]
buffer_load_dwordx2 v[22:23], v4, s[12:15], s29 offen
s_add_u32 s29, s29, 16384
v_mfma_f32_16x16x32_bf16 v[196:199], a[148:151], a[100:103], v[196:199]
s_waitcnt lgkmcnt(10)
v_mfma_f32_16x16x32_bf16 a[48:51], a[152:155], a[88:91], a[48:51]
ds_read_b64_tr_b16 a[140:141], v3 offset:18432
v_mfma_f32_16x16x32_bf16 a[52:55], a[152:155], a[92:95], a[52:55]
ds_read_b64_tr_b16 a[142:143], v3 offset:20736
v_mfma_f32_16x16x32_bf16 v[200:203], a[152:155], a[96:99], v[200:203]
buffer_load_dwordx2 v[24:25], v4, s[12:15], s29 offen
s_add_u32 s29, s29, 16384
v_mfma_f32_16x16x32_bf16 v[204:207], a[152:155], a[100:103], v[204:207]
s_waitcnt lgkmcnt(10)
v_mfma_f32_16x16x32_bf16 v[208:211], a[156:159], a[88:91], v[208:211]
ds_read_b64_tr_b16 a[144:145], v3 offset:32
v_mfma_f32_16x16x32_bf16 v[212:215], a[156:159], a[92:95], v[212:215]
ds_read_b64_tr_b16 a[146:147], v3 offset:2336
v_mfma_f32_16x16x32_bf16 v[216:219], a[156:159], a[96:99], v[216:219]
buffer_load_dwordx2 v[26:27], v4, s[12:15], s29 offen
s_add_u32 s29, s29, 16384
v_mfma_f32_16x16x32_bf16 v[220:223], a[156:159], a[100:103], v[220:223]
s_waitcnt lgkmcnt(10)
v_mfma_f32_16x16x32_bf16 a[56:59], a[160:163], a[88:91], a[56:59]
ds_read_b64_tr_b16 a[148:149], v3 offset:18464
v_mfma_f32_16x16x32_bf16 a[60:63], a[160:163], a[92:95], a[60:63]
ds_read_b64_tr_b16 a[150:151], v3 offset:20768
v_mfma_f32_16x16x32_bf16 v[224:227], a[160:163], a[96:99], v[224:227]
buffer_load_dwordx2 v[28:29], v4, s[12:15], s29 offen
s_add_u32 s29, s29, 16384
v_mfma_f32_16x16x32_bf16 v[228:231], a[160:163], a[100:103], v[228:231]
s_waitcnt lgkmcnt(10)
v_mfma_f32_16x16x32_bf16 v[232:235], a[164:167], a[88:91], v[232:235]
ds_read_b64_tr_b16 a[152:153], v3 offset:64
v_mfma_f32_16x16x32_bf16 v[236:239], a[164:167], a[92:95], v[236:239]
ds_read_b64_tr_b16 a[154:155], v3 offset:2368
v_mfma_f32_16x16x32_bf16 v[240:243], a[164:167], a[96:99], v[240:243]
v_mfma_f32_16x16x32_bf16 v[244:247], a[164:167], a[100:103], v[244:247]
s_waitcnt lgkmcnt(10)
v_mfma_f32_16x16x32_bf16 a[64:67], a[168:171], a[88:91], a[64:67]
ds_read_b64_tr_b16 a[156:157], v3 offset:18496
v_mfma_f32_16x16x32_bf16 a[68:71], a[168:171], a[92:95], a[68:71]
ds_read_b64_tr_b16 a[158:159], v3 offset:20800
v_mfma_f32_16x16x32_bf16 v[248:251], a[168:171], a[96:99], v[248:251]
v_mfma_f32_16x16x32_bf16 v[252:255], a[168:171], a[100:103], v[252:255]
s_waitcnt lgkmcnt(10)
s_waitcnt vmcnt(29)
v_mfma_f32_16x16x32_bf16 v[40:43], a[136:139], a[104:107], v[40:43]
ds_read_b64_tr_b16 a[160:161], v3 offset:96
v_mfma_f32_16x16x32_bf16 v[44:47], a[136:139], a[108:111], v[44:47]
ds_read_b64_tr_b16 a[162:163], v3 offset:2400
v_mfma_f32_16x16x32_bf16 v[48:51], a[136:139], a[112:115], v[48:51]
s_add_u32 m0, s30, 36864
s_nop 0
buffer_load_dwordx4 v5, s[4:7], s27 offen offset:0 lds
v_mfma_f32_16x16x32_bf16 v[52:55], a[136:139], a[116:119], v[52:55]
s_waitcnt lgkmcnt(10)
v_mfma_f32_16x16x32_bf16 a[0:3], a[140:143], a[104:107], a[0:3]
ds_read_b64_tr_b16 a[164:165], v3 offset:18528
v_mfma_f32_16x16x32_bf16 a[4:7], a[140:143], a[108:111], a[4:7]
ds_read_b64_tr_b16 a[166:167], v3 offset:20832
v_mfma_f32_16x16x32_bf16 v[56:59], a[140:143], a[112:115], v[56:59]
buffer_load_dwordx4 v6, s[4:7], s27 offen offset:1024 lds
v_mfma_f32_16x16x32_bf16 v[60:63], a[140:143], a[116:119], v[60:63]
s_waitcnt lgkmcnt(10)
v_mfma_f32_16x16x32_bf16 v[64:67], a[144:147], a[104:107], v[64:67]
ds_read_b64_tr_b16 a[168:169], v3 offset:128
v_mfma_f32_16x16x32_bf16 v[68:71], a[144:147], a[108:111], v[68:71]
ds_read_b64_tr_b16 a[170:171], v3 offset:2432
v_mfma_f32_16x16x32_bf16 v[72:75], a[144:147], a[112:115], v[72:75]
buffer_load_dwordx4 v7, s[4:7], s27 offen offset:2048 lds
v_mfma_f32_16x16x32_bf16 v[76:79], a[144:147], a[116:119], v[76:79]
s_waitcnt lgkmcnt(10)
v_mfma_f32_16x16x32_bf16 a[8:11], a[148:151], a[104:107], a[8:11]
ds_read_b64_tr_b16 a[136:137], v3 offset:18560
v_mfma_f32_16x16x32_bf16 a[12:15], a[148:151], a[108:111], a[12:15]
ds_read_b64_tr_b16 a[138:139], v3 offset:20864
v_mfma_f32_16x16x32_bf16 v[80:83], a[148:151], a[112:115], v[80:83]
buffer_load_dwordx4 v8, s[4:7], s27 offen offset:3072 lds
v_mfma_f32_16x16x32_bf16 v[84:87], a[148:151], a[116:119], v[84:87]
s_waitcnt lgkmcnt(10)
v_mfma_f32_16x16x32_bf16 v[88:91], a[152:155], a[104:107], v[88:91]
ds_read_b64_tr_b16 a[140:141], v3 offset:160
v_mfma_f32_16x16x32_bf16 v[92:95], a[152:155], a[108:111], v[92:95]
ds_read_b64_tr_b16 a[142:143], v3 offset:2464
v_mfma_f32_16x16x32_bf16 v[96:99], a[152:155], a[112:115], v[96:99]
s_add_u32 m0, m0, 4096
s_nop 0
buffer_load_dwordx4 v9, s[4:7], s27 offen offset:0 lds
v_mfma_f32_16x16x32_bf16 v[100:103], a[152:155], a[116:119], v[100:103]
s_waitcnt lgkmcnt(10)
v_mfma_f32_16x16x32_bf16 a[16:19], a[156:159], a[104:107], a[16:19]
ds_read_b64_tr_b16 a[144:145], v3 offset:18592
v_mfma_f32_16x16x32_bf16 a[20:23], a[156:159], a[108:111], a[20:23]
ds_read_b64_tr_b16 a[146:147], v3 offset:20896
v_mfma_f32_16x16x32_bf16 v[104:107], a[156:159], a[112:115], v[104:107]
buffer_load_dwordx4 v10, s[4:7], s27 offen offset:1024 lds
v_mfma_f32_16x16x32_bf16 v[108:111], a[156:159], a[116:119], v[108:111]
s_waitcnt lgkmcnt(10)
v_mfma_f32_16x16x32_bf16 v[112:115], a[160:163], a[104:107], v[112:115]
ds_read_b64_tr_b16 a[148:149], v3 offset:192
v_mfma_f32_16x16x32_bf16 v[116:119], a[160:163], a[108:111], v[116:119]
ds_read_b64_tr_b16 a[150:151], v3 offset:2496
v_mfma_f32_16x16x32_bf16 v[120:123], a[160:163], a[112:115], v[120:123]
buffer_load_dwordx4 v11, s[4:7], s27 offen offset:2048 lds
v_mfma_f32_16x16x32_bf16 v[124:127], a[160:163], a[116:119], v[124:127]
s_waitcnt lgkmcnt(10)
v_mfma_f32_16x16x32_bf16 a[24:27], a[164:167], a[104:107], a[24:27]
ds_read_b64_tr_b16 a[152:153], v3 offset:18624
v_mfma_f32_16x16x32_bf16 a[28:31], a[164:167], a[108:111], a[28:31]
ds_read_b64_tr_b16 a[154:155], v3 offset:20928
v_mfma_f32_16x16x32_bf16 v[128:131], a[164:167], a[112:115], v[128:131]
buffer_load_dwordx4 v12, s[4:7], s27 offen offset:3072 lds
v_mfma_f32_16x16x32_bf16 v[132:135], a[164:167], a[116:119], v[132:135]
s_waitcnt lgkmcnt(10)
v_mfma_f32_16x16x32_bf16 v[136:139], a[168:171], a[104:107], v[136:139]
ds_read_b64_tr_b16 a[156:157], v3 offset:224
v_mfma_f32_16x16x32_bf16 v[140:143], a[168:171], a[108:111], v[140:143]
ds_read_b64_tr_b16 a[158:159], v3 offset:2528
v_mfma_f32_16x16x32_bf16 v[144:147], a[168:171], a[112:115], v[144:147]
s_add_u32 m0, m0, 4096
s_nop 0
buffer_load_dwordx4 v13, s[4:7], s27 offen offset:0 lds
s_add_u32 s27, s27, 589824
v_mfma_f32_16x16x32_bf16 v[148:151], a[168:171], a[116:119], v[148:151]
s_waitcnt lgkmcnt(10)
v_mfma_f32_16x16x32_bf16 a[32:35], a[136:139], a[104:107], a[32:35]
ds_read_b64_tr_b16 a[160:161], v3 offset:18656
v_mfma_f32_16x16x32_bf16 a[36:39], a[136:139], a[108:111], a[36:39]
ds_read_b64_tr_b16 a[162:163], v3 offset:20960
v_mfma_f32_16x16x32_bf16 v[152:155], a[136:139], a[112:115], v[152:155]
buffer_load_dwordx4 a[88:91], v1, s[8:11], s28 offen offset:0
v_mfma_f32_16x16x32_bf16 v[156:159], a[136:139], a[116:119], v[156:159]
s_waitcnt lgkmcnt(10)
v_mfma_f32_16x16x32_bf16 v[160:163], a[140:143], a[104:107], v[160:163]
ds_read_b64_tr_b16 a[164:165], v3 offset:256
v_mfma_f32_16x16x32_bf16 v[164:167], a[140:143], a[108:111], v[164:167]
ds_read_b64_tr_b16 a[166:167], v3 offset:2560
v_mfma_f32_16x16x32_bf16 v[168:171], a[140:143], a[112:115], v[168:171]
buffer_load_dwordx4 a[92:95], v1, s[8:11], s28 offen offset:1024
v_mfma_f32_16x16x32_bf16 v[172:175], a[140:143], a[116:119], v[172:175]
s_waitcnt lgkmcnt(10)
v_mfma_f32_16x16x32_bf16 a[40:43], a[144:147], a[104:107], a[40:43]
ds_read_b64_tr_b16 a[168:169], v3 offset:18688
v_mfma_f32_16x16x32_bf16 a[44:47], a[144:147], a[108:111], a[44:47]
ds_read_b64_tr_b16 a[170:171], v3 offset:20992
v_mfma_f32_16x16x32_bf16 v[176:179], a[144:147], a[112:115], v[176:179]
buffer_load_dwordx4 a[96:99], v1, s[8:11], s28 offen offset:2048
v_mfma_f32_16x16x32_bf16 v[180:183], a[144:147], a[116:119], v[180:183]
s_waitcnt lgkmcnt(10)
v_mfma_f32_16x16x32_bf16 v[184:187], a[148:151], a[104:107], v[184:187]
ds_read_b64_tr_b16 a[136:137], v3 offset:9216
v_mfma_f32_16x16x32_bf16 v[188:191], a[148:151], a[108:111], v[188:191]
ds_read_b64_tr_b16 a[138:139], v3 offset:11520
v_mfma_f32_16x16x32_bf16 v[192:195], a[148:151], a[112:115], v[192:195]
buffer_load_dwordx4 a[100:103], v1, s[8:11], s28 offen offset:3072
s_add_u32 s28, s28, 131072
v_mfma_f32_16x16x32_bf16 v[196:199], a[148:151], a[116:119], v[196:199]
s_waitcnt lgkmcnt(10)
v_mfma_f32_16x16x32_bf16 a[48:51], a[152:155], a[104:107], a[48:51]
ds_read_b64_tr_b16 a[140:141], v3 offset:27648
v_mfma_f32_16x16x32_bf16 a[52:55], a[152:155], a[108:111], a[52:55]
ds_read_b64_tr_b16 a[142:143], v3 offset:29952
v_mfma_f32_16x16x32_bf16 v[200:203], a[152:155], a[112:115], v[200:203]
v_mfma_f32_16x16x32_bf16 v[204:207], a[152:155], a[116:119], v[204:207]
s_waitcnt lgkmcnt(10)
v_mfma_f32_16x16x32_bf16 v[208:211], a[156:159], a[104:107], v[208:211]
ds_read_b64_tr_b16 a[144:145], v3 offset:9248
v_mfma_f32_16x16x32_bf16 v[212:215], a[156:159], a[108:111], v[212:215]
ds_read_b64_tr_b16 a[146:147], v3 offset:11552
v_mfma_f32_16x16x32_bf16 v[216:219], a[156:159], a[112:115], v[216:219]
v_mfma_f32_16x16x32_bf16 v[220:223], a[156:159], a[116:119], v[220:223]
s_waitcnt lgkmcnt(10)
v_mfma_f32_16x16x32_bf16 a[56:59], a[160:163], a[104:107], a[56:59]
ds_read_b64_tr_b16 a[148:149], v3 offset:27680
v_mfma_f32_16x16x32_bf16 a[60:63], a[160:163], a[108:111], a[60:63]
ds_read_b64_tr_b16 a[150:151], v3 offset:29984
v_mfma_f32_16x16x32_bf16 v[224:227], a[160:163], a[112:115], v[224:227]
v_mfma_f32_16x16x32_bf16 v[228:231], a[160:163], a[116:119], v[228:231]
s_waitcnt lgkmcnt(10)
v_mfma_f32_16x16x32_bf16 v[232:235], a[164:167], a[104:107], v[232:235]
ds_read_b64_tr_b16 a[152:153], v3 offset:9280
v_mfma_f32_16x16x32_bf16 v[236:239], a[164:167], a[108:111], v[236:239]
ds_read_b64_tr_b16 a[154:155], v3 offset:11584
v_mfma_f32_16x16x32_bf16 v[240:243], a[164:167], a[112:115], v[240:243]
v_mfma_f32_16x16x32_bf16 v[244:247], a[164:167], a[116:119], v[244:247]
s_waitcnt lgkmcnt(10)
v_mfma_f32_16x16x32_bf16 a[64:67], a[168:171], a[104:107], a[64:67]
ds_read_b64_tr_b16 a[156:157], v3 offset:27712
v_mfma_f32_16x16x32_bf16 a[68:71], a[168:171], a[108:111], a[68:71]
ds_read_b64_tr_b16 a[158:159], v3 offset:30016
v_mfma_f32_16x16x32_bf16 v[248:251], a[168:171], a[112:115], v[248:251]
v_mfma_f32_16x16x32_bf16 v[252:255], a[168:171], a[116:119], v[252:255]
s_waitcnt lgkmcnt(10)
s_waitcnt vmcnt(23)
v_mfma_f32_16x16x32_bf16 v[40:43], a[136:139], a[120:123], v[40:43]
ds_read_b64_tr_b16 a[160:161], v3 offset:9312
v_mfma_f32_16x16x32_bf16 v[44:47], a[136:139], a[124:127], v[44:47]
ds_read_b64_tr_b16 a[162:163], v3 offset:11616
v_mfma_f32_16x16x32_bf16 v[48:51], a[136:139], a[128:131], v[48:51]
buffer_load_dwordx4 a[104:107], v1, s[8:11], s28 offen offset:0
v_mfma_f32_16x16x32_bf16 v[52:55], a[136:139], a[132:135], v[52:55]
s_waitcnt lgkmcnt(10)
v_mfma_f32_16x16x32_bf16 a[0:3], a[140:143], a[120:123], a[0:3]
ds_read_b64_tr_b16 a[164:165], v3 offset:27744
v_mfma_f32_16x16x32_bf16 a[4:7], a[140:143], a[124:127], a[4:7]
ds_read_b64_tr_b16 a[166:167], v3 offset:30048
v_mfma_f32_16x16x32_bf16 v[56:59], a[140:143], a[128:131], v[56:59]
buffer_load_dwordx4 a[108:111], v1, s[8:11], s28 offen offset:1024
v_mfma_f32_16x16x32_bf16 v[60:63], a[140:143], a[132:135], v[60:63]
s_waitcnt lgkmcnt(10)
v_mfma_f32_16x16x32_bf16 v[64:67], a[144:147], a[120:123], v[64:67]
ds_read_b64_tr_b16 a[168:169], v3 offset:9344
v_mfma_f32_16x16x32_bf16 v[68:71], a[144:147], a[124:127], v[68:71]
ds_read_b64_tr_b16 a[170:171], v3 offset:11648
v_mfma_f32_16x16x32_bf16 v[72:75], a[144:147], a[128:131], v[72:75]
buffer_load_dwordx4 a[112:115], v1, s[8:11], s28 offen offset:2048
v_mfma_f32_16x16x32_bf16 v[76:79], a[144:147], a[132:135], v[76:79]
s_waitcnt lgkmcnt(10)
v_mfma_f32_16x16x32_bf16 a[8:11], a[148:151], a[120:123], a[8:11]
ds_read_b64_tr_b16 a[136:137], v3 offset:27776
v_mfma_f32_16x16x32_bf16 a[12:15], a[148:151], a[124:127], a[12:15]
ds_read_b64_tr_b16 a[138:139], v3 offset:30080
v_mfma_f32_16x16x32_bf16 v[80:83], a[148:151], a[128:131], v[80:83]
buffer_load_dwordx4 a[116:119], v1, s[8:11], s28 offen offset:3072
s_add_u32 s28, s28, 131072
v_mfma_f32_16x16x32_bf16 v[84:87], a[148:151], a[132:135], v[84:87]
s_waitcnt lgkmcnt(10)
s_waitcnt vmcnt(17)
v_mfma_f32_16x16x32_bf16 v[88:91], a[152:155], a[120:123], v[88:91]
ds_read_b64_tr_b16 a[140:141], v3 offset:9376
v_sub_f32 v18, v18, v14
v_mfma_f32_16x16x32_bf16 v[92:95], a[152:155], a[124:127], v[92:95]
ds_read_b64_tr_b16 a[142:143], v3 offset:11680
v_add_f32 v17, v17, v19
v_mfma_f32_16x16x32_bf16 v[96:99], a[152:155], a[128:131], v[96:99]
v_add_f32 v15, v15, v18
v_fmac_f32 v16, v18, v18
v_mfma_f32_16x16x32_bf16 v[100:103], a[152:155], a[132:135], v[100:103]
s_waitcnt lgkmcnt(10)
v_mfma_f32_16x16x32_bf16 a[16:19], a[156:159], a[120:123], a[16:19]
ds_read_b64_tr_b16 a[144:145], v3 offset:27808
v_sub_f32 v20, v20, v14
v_mfma_f32_16x16x32_bf16 a[20:23], a[156:159], a[124:127], a[20:23]
ds_read_b64_tr_b16 a[146:147], v3 offset:30112
v_add_f32 v17, v17, v21
v_mfma_f32_16x16x32_bf16 v[104:107], a[156:159], a[128:131], v[104:107]
v_add_f32 v15, v15, v20
v_fmac_f32 v16, v20, v20
v_mfma_f32_16x16x32_bf16 v[108:111], a[156:159], a[132:135], v[108:111]
s_waitcnt lgkmcnt(10)
v_mfma_f32_16x16x32_bf16 v[112:115], a[160:163], a[120:123], v[112:115]
ds_read_b64_tr_b16 a[148:149], v3 offset:9408
v_sub_f32 v22, v22, v14
v_mfma_f32_16x16x32_bf16 v[116:119], a[160:163], a[124:127], v[116:119]
ds_read_b64_tr_b16 a[150:151], v3 offset:11712
v_add_f32 v17, v17, v23
v_mfma_f32_16x16x32_bf16 v[120:123], a[160:163], a[128:131], v[120:123]
v_add_f32 v15, v15, v22
v_fmac_f32 v16, v22, v22
v_mfma_f32_16x16x32_bf16 v[124:127], a[160:163], a[132:135], v[124:127]
s_waitcnt lgkmcnt(10)
v_mfma_f32_16x16x32_bf16 a[24:27], a[164:167], a[120:123], a[24:27]
ds_read_b64_tr_b16 a[152:153], v3 offset:27840
v_sub_f32 v24, v24, v14
v_mfma_f32_16x16x32_bf16 a[28:31], a[164:167], a[124:127], a[28:31]
ds_read_b64_tr_b16 a[154:155], v3 offset:30144
v_add_f32 v17, v17, v25
v_mfma_f32_16x16x32_bf16 v[128:131], a[164:167], a[128:131], v[128:131]
v_add_f32 v15, v15, v24
v_fmac_f32 v16, v24, v24
v_mfma_f32_16x16x32_bf16 v[132:135], a[164:167], a[132:135], v[132:135]
s_waitcnt lgkmcnt(10)
v_mfma_f32_16x16x32_bf16 v[136:139], a[168:171], a[120:123], v[136:139]
ds_read_b64_tr_b16 a[156:157], v3 offset:9440
v_sub_f32 v26, v26, v14
v_mfma_f32_16x16x32_bf16 v[140:143], a[168:171], a[124:127], v[140:143]
ds_read_b64_tr_b16 a[158:159], v3 offset:11744
v_add_f32 v17, v17, v27
v_mfma_f32_16x16x32_bf16 v[144:147], a[168:171], a[128:131], v[144:147]
v_add_f32 v15, v15, v26
v_fmac_f32 v16, v26, v26
v_mfma_f32_16x16x32_bf16 v[148:151], a[168:171], a[132:135], v[148:151]
s_waitcnt lgkmcnt(10)
v_mfma_f32_16x16x32_bf16 a[32:35], a[136:139], a[120:123], a[32:35]
ds_read_b64_tr_b16 a[160:161], v3 offset:27872
v_sub_f32 v28, v28, v14
v_mfma_f32_16x16x32_bf16 a[36:39], a[136:139], a[124:127], a[36:39]
ds_read_b64_tr_b16 a[162:163], v3 offset:30176
v_add_f32 v17, v17, v29
v_mfma_f32_16x16x32_bf16 v[152:155], a[136:139], a[128:131], v[152:155]
v_add_f32 v15, v15, v28
v_fmac_f32 v16, v28, v28
v_mfma_f32_16x16x32_bf16 v[156:159], a[136:139], a[132:135], v[156:159]
s_waitcnt lgkmcnt(10)
v_mfma_f32_16x16x32_bf16 v[160:163], a[140:143], a[120:123], v[160:163]
ds_read_b64_tr_b16 a[164:165], v3 offset:9472
v_mfma_f32_16x16x32_bf16 v[164:167], a[140:143], a[124:127], v[164:167]
ds_read_b64_tr_b16 a[166:167], v3 offset:11776
v_mfma_f32_16x16x32_bf16 v[168:171], a[140:143], a[128:131], v[168:171]
buffer_load_dwordx2 v[18:19], v4, s[12:15], s29 offen
s_add_u32 s29, s29, 16384
v_mfma_f32_16x16x32_bf16 v[172:175], a[140:143], a[132:135], v[172:175]
s_waitcnt lgkmcnt(10)
v_mfma_f32_16x16x32_bf16 a[40:43], a[144:147], a[120:123], a[40:43]
ds_read_b64_tr_b16 a[168:169], v3 offset:27904
v_mfma_f32_16x16x32_bf16 a[44:47], a[144:147], a[124:127], a[44:47]
ds_read_b64_tr_b16 a[170:171], v3 offset:30208
v_mfma_f32_16x16x32_bf16 v[176:179], a[144:147], a[128:131], v[176:179]
buffer_load_dwordx2 v[20:21], v4, s[12:15], s29 offen
s_add_u32 s29, s29, 16384
v_add_u32 v3, 0, v2
v_mfma_f32_16x16x32_bf16 v[180:183], a[144:147], a[132:135], v[180:183]
s_waitcnt lgkmcnt(10)
s_waitcnt vmcnt(33)
s_barrier
v_mfma_f32_16x16x32_bf16 v[184:187], a[148:151], a[120:123], v[184:187]
ds_read_b64_tr_b16 a[136:137], v3 offset:0
v_mfma_f32_16x16x32_bf16 v[188:191], a[148:151], a[124:127], v[188:191]
ds_read_b64_tr_b16 a[138:139], v3 offset:2304
v_mfma_f32_16x16x32_bf16 v[192:195], a[148:151], a[128:131], v[192:195]
buffer_load_dwordx2 v[22:23], v4, s[12:15], s29 offen
s_add_u32 s29, s29, 16384
v_mfma_f32_16x16x32_bf16 v[196:199], a[148:151], a[132:135], v[196:199]
s_waitcnt lgkmcnt(10)
v_mfma_f32_16x16x32_bf16 a[48:51], a[152:155], a[120:123], a[48:51]
ds_read_b64_tr_b16 a[140:141], v3 offset:18432
v_mfma_f32_16x16x32_bf16 a[52:55], a[152:155], a[124:127], a[52:55]
ds_read_b64_tr_b16 a[142:143], v3 offset:20736
v_mfma_f32_16x16x32_bf16 v[200:203], a[152:155], a[128:131], v[200:203]
buffer_load_dwordx2 v[24:25], v4, s[12:15], s29 offen
s_add_u32 s29, s29, 16384
v_mfma_f32_16x16x32_bf16 v[204:207], a[152:155], a[132:135], v[204:207]
s_waitcnt lgkmcnt(10)
v_mfma_f32_16x16x32_bf16 v[208:211], a[156:159], a[120:123], v[208:211]
ds_read_b64_tr_b16 a[144:145], v3 offset:32
v_mfma_f32_16x16x32_bf16 v[212:215], a[156:159], a[124:127], v[212:215]
ds_read_b64_tr_b16 a[146:147], v3 offset:2336
v_mfma_f32_16x16x32_bf16 v[216:219], a[156:159], a[128:131], v[216:219]
buffer_load_dwordx2 v[26:27], v4, s[12:15], s29 offen
s_add_u32 s29, s29, 16384
v_mfma_f32_16x16x32_bf16 v[220:223], a[156:159], a[132:135], v[220:223]
s_waitcnt lgkmcnt(10)
v_mfma_f32_16x16x32_bf16 a[56:59], a[160:163], a[120:123], a[56:59]
ds_read_b64_tr_b16 a[148:149], v3 offset:18464
v_mfma_f32_16x16x32_bf16 a[60:63], a[160:163], a[124:127], a[60:63]
ds_read_b64_tr_b16 a[150:151], v3 offset:20768
v_mfma_f32_16x16x32_bf16 v[224:227], a[160:163], a[128:131], v[224:227]
buffer_load_dwordx2 v[28:29], v4, s[12:15], s29 offen
s_add_u32 s29, s29, 16384
v_mfma_f32_16x16x32_bf16 v[228:231], a[160:163], a[132:135], v[228:231]
s_waitcnt lgkmcnt(10)
v_mfma_f32_16x16x32_bf16 v[232:235], a[164:167], a[120:123], v[232:235]
ds_read_b64_tr_b16 a[152:153], v3 offset:64
v_mfma_f32_16x16x32_bf16 v[236:239], a[164:167], a[124:127], v[236:239]
ds_read_b64_tr_b16 a[154:155], v3 offset:2368
v_mfma_f32_16x16x32_bf16 v[240:243], a[164:167], a[128:131], v[240:243]
v_mfma_f32_16x16x32_bf16 v[244:247], a[164:167], a[132:135], v[244:247]
s_waitcnt lgkmcnt(10)
v_mfma_f32_16x16x32_bf16 a[64:67], a[168:171], a[120:123], a[64:67]
ds_read_b64_tr_b16 a[156:157], v3 offset:18496
v_mfma_f32_16x16x32_bf16 a[68:71], a[168:171], a[124:127], a[68:71]
ds_read_b64_tr_b16 a[158:159], v3 offset:20800
v_mfma_f32_16x16x32_bf16 v[248:251], a[168:171], a[128:131], v[248:251]
v_mfma_f32_16x16x32_bf16 v[252:255], a[168:171], a[132:135], v[252:255]
s_waitcnt lgkmcnt(10)
s_waitcnt vmcnt(29)
v_mfma_f32_16x16x32_bf16 v[40:43], a[136:139], a[72:75], v[40:43]
ds_read_b64_tr_b16 a[160:161], v3 offset:96
v_mfma_f32_16x16x32_bf16 v[44:47], a[136:139], a[76:79], v[44:47]
ds_read_b64_tr_b16 a[162:163], v3 offset:2400
v_mfma_f32_16x16x32_bf16 v[48:51], a[136:139], a[80:83], v[48:51]
s_add_u32 m0, s30, 73728
s_nop 0
buffer_load_dwordx4 v5, s[4:7], s27 offen offset:0 lds
v_mfma_f32_16x16x32_bf16 v[52:55], a[136:139], a[84:87], v[52:55]
s_waitcnt lgkmcnt(10)
v_mfma_f32_16x16x32_bf16 a[0:3], a[140:143], a[72:75], a[0:3]
ds_read_b64_tr_b16 a[164:165], v3 offset:18528
v_mfma_f32_16x16x32_bf16 a[4:7], a[140:143], a[76:79], a[4:7]
ds_read_b64_tr_b16 a[166:167], v3 offset:20832
v_mfma_f32_16x16x32_bf16 v[56:59], a[140:143], a[80:83], v[56:59]
buffer_load_dwordx4 v6, s[4:7], s27 offen offset:1024 lds
v_mfma_f32_16x16x32_bf16 v[60:63], a[140:143], a[84:87], v[60:63]
s_waitcnt lgkmcnt(10)
v_mfma_f32_16x16x32_bf16 v[64:67], a[144:147], a[72:75], v[64:67]
ds_read_b64_tr_b16 a[168:169], v3 offset:128
v_mfma_f32_16x16x32_bf16 v[68:71], a[144:147], a[76:79], v[68:71]
ds_read_b64_tr_b16 a[170:171], v3 offset:2432
v_mfma_f32_16x16x32_bf16 v[72:75], a[144:147], a[80:83], v[72:75]
buffer_load_dwordx4 v7, s[4:7], s27 offen offset:2048 lds
v_mfma_f32_16x16x32_bf16 v[76:79], a[144:147], a[84:87], v[76:79]
s_waitcnt lgkmcnt(10)
v_mfma_f32_16x16x32_bf16 a[8:11], a[148:151], a[72:75], a[8:11]
ds_read_b64_tr_b16 a[136:137], v3 offset:18560
v_mfma_f32_16x16x32_bf16 a[12:15], a[148:151], a[76:79], a[12:15]
ds_read_b64_tr_b16 a[138:139], v3 offset:20864
v_mfma_f32_16x16x32_bf16 v[80:83], a[148:151], a[80:83], v[80:83]
buffer_load_dwordx4 v8, s[4:7], s27 offen offset:3072 lds
v_mfma_f32_16x16x32_bf16 v[84:87], a[148:151], a[84:87], v[84:87]
s_waitcnt lgkmcnt(10)
v_mfma_f32_16x16x32_bf16 v[88:91], a[152:155], a[72:75], v[88:91]
ds_read_b64_tr_b16 a[140:141], v3 offset:160
v_mfma_f32_16x16x32_bf16 v[92:95], a[152:155], a[76:79], v[92:95]
ds_read_b64_tr_b16 a[142:143], v3 offset:2464
v_mfma_f32_16x16x32_bf16 v[96:99], a[152:155], a[80:83], v[96:99]
s_add_u32 m0, m0, 4096
s_nop 0
buffer_load_dwordx4 v9, s[4:7], s27 offen offset:0 lds
v_mfma_f32_16x16x32_bf16 v[100:103], a[152:155], a[84:87], v[100:103]
s_waitcnt lgkmcnt(10)
v_mfma_f32_16x16x32_bf16 a[16:19], a[156:159], a[72:75], a[16:19]
ds_read_b64_tr_b16 a[144:145], v3 offset:18592
v_mfma_f32_16x16x32_bf16 a[20:23], a[156:159], a[76:79], a[20:23]
ds_read_b64_tr_b16 a[146:147], v3 offset:20896
v_mfma_f32_16x16x32_bf16 v[104:107], a[156:159], a[80:83], v[104:107]
buffer_load_dwordx4 v10, s[4:7], s27 offen offset:1024 lds
v_mfma_f32_16x16x32_bf16 v[108:111], a[156:159], a[84:87], v[108:111]
s_waitcnt lgkmcnt(10)
v_mfma_f32_16x16x32_bf16 v[112:115], a[160:163], a[72:75], v[112:115]
ds_read_b64_tr_b16 a[148:149], v3 offset:192
v_mfma_f32_16x16x32_bf16 v[116:119], a[160:163], a[76:79], v[116:119]
ds_read_b64_tr_b16 a[150:151], v3 offset:2496
v_mfma_f32_16x16x32_bf16 v[120:123], a[160:163], a[80:83], v[120:123]
buffer_load_dwordx4 v11, s[4:7], s27 offen offset:2048 lds
v_mfma_f32_16x16x32_bf16 v[124:127], a[160:163], a[84:87], v[124:127]
s_waitcnt lgkmcnt(10)
v_mfma_f32_16x16x32_bf16 a[24:27], a[164:167], a[72:75], a[24:27]
ds_read_b64_tr_b16 a[152:153], v3 offset:18624
v_mfma_f32_16x16x32_bf16 a[28:31], a[164:167], a[76:79], a[28:31]
ds_read_b64_tr_b16 a[154:155], v3 offset:20928
v_mfma_f32_16x16x32_bf16 v[128:131], a[164:167], a[80:83], v[128:131]
buffer_load_dwordx4 v12, s[4:7], s27 offen offset:3072 lds
v_mfma_f32_16x16x32_bf16 v[132:135], a[164:167], a[84:87], v[132:135]
s_waitcnt lgkmcnt(10)
v_mfma_f32_16x16x32_bf16 v[136:139], a[168:171], a[72:75], v[136:139]
ds_read_b64_tr_b16 a[156:157], v3 offset:224
v_mfma_f32_16x16x32_bf16 v[140:143], a[168:171], a[76:79], v[140:143]
ds_read_b64_tr_b16 a[158:159], v3 offset:2528
v_mfma_f32_16x16x32_bf16 v[144:147], a[168:171], a[80:83], v[144:147]
s_add_u32 m0, m0, 4096
s_nop 0
buffer_load_dwordx4 v13, s[4:7], s27 offen offset:0 lds
s_add_u32 s27, s27, 589824
v_mfma_f32_16x16x32_bf16 v[148:151], a[168:171], a[84:87], v[148:151]
s_waitcnt lgkmcnt(10)
v_mfma_f32_16x16x32_bf16 a[32:35], a[136:139], a[72:75], a[32:35]
ds_read_b64_tr_b16 a[160:161], v3 offset:18656
v_mfma_f32_16x16x32_bf16 a[36:39], a[136:139], a[76:79], a[36:39]
ds_read_b64_tr_b16 a[162:163], v3 offset:20960
v_mfma_f32_16x16x32_bf16 v[152:155], a[136:139], a[80:83], v[152:155]
buffer_load_dwordx4 a[120:123], v1, s[8:11], s28 offen offset:0
v_mfma_f32_16x16x32_bf16 v[156:159], a[136:139], a[84:87], v[156:159]
s_waitcnt lgkmcnt(10)
v_mfma_f32_16x16x32_bf16 v[160:163], a[140:143], a[72:75], v[160:163]
ds_read_b64_tr_b16 a[164:165], v3 offset:256
v_mfma_f32_16x16x32_bf16 v[164:167], a[140:143], a[76:79], v[164:167]
ds_read_b64_tr_b16 a[166:167], v3 offset:2560
v_mfma_f32_16x16x32_bf16 v[168:171], a[140:143], a[80:83], v[168:171]
buffer_load_dwordx4 a[124:127], v1, s[8:11], s28 offen offset:1024
v_mfma_f32_16x16x32_bf16 v[172:175], a[140:143], a[84:87], v[172:175]
s_waitcnt lgkmcnt(10)
v_mfma_f32_16x16x32_bf16 a[40:43], a[144:147], a[72:75], a[40:43]
ds_read_b64_tr_b16 a[168:169], v3 offset:18688
v_mfma_f32_16x16x32_bf16 a[44:47], a[144:147], a[76:79], a[44:47]
ds_read_b64_tr_b16 a[170:171], v3 offset:20992
v_mfma_f32_16x16x32_bf16 v[176:179], a[144:147], a[80:83], v[176:179]
buffer_load_dwordx4 a[128:131], v1, s[8:11], s28 offen offset:2048
v_mfma_f32_16x16x32_bf16 v[180:183], a[144:147], a[84:87], v[180:183]
s_waitcnt lgkmcnt(10)
v_mfma_f32_16x16x32_bf16 v[184:187], a[148:151], a[72:75], v[184:187]
ds_read_b64_tr_b16 a[136:137], v3 offset:9216
v_mfma_f32_16x16x32_bf16 v[188:191], a[148:151], a[76:79], v[188:191]
ds_read_b64_tr_b16 a[138:139], v3 offset:11520
v_mfma_f32_16x16x32_bf16 v[192:195], a[148:151], a[80:83], v[192:195]
buffer_load_dwordx4 a[132:135], v1, s[8:11], s28 offen offset:3072
s_add_u32 s28, s28, 131072
v_mfma_f32_16x16x32_bf16 v[196:199], a[148:151], a[84:87], v[196:199]
s_waitcnt lgkmcnt(10)
v_mfma_f32_16x16x32_bf16 a[48:51], a[152:155], a[72:75], a[48:51]
ds_read_b64_tr_b16 a[140:141], v3 offset:27648
v_mfma_f32_16x16x32_bf16 a[52:55], a[152:155], a[76:79], a[52:55]
ds_read_b64_tr_b16 a[142:143], v3 offset:29952
v_mfma_f32_16x16x32_bf16 v[200:203], a[152:155], a[80:83], v[200:203]
v_mfma_f32_16x16x32_bf16 v[204:207], a[152:155], a[84:87], v[204:207]
s_waitcnt lgkmcnt(10)
v_mfma_f32_16x16x32_bf16 v[208:211], a[156:159], a[72:75], v[208:211]
ds_read_b64_tr_b16 a[144:145], v3 offset:9248
v_mfma_f32_16x16x32_bf16 v[212:215], a[156:159], a[76:79], v[212:215]
ds_read_b64_tr_b16 a[146:147], v3 offset:11552
v_mfma_f32_16x16x32_bf16 v[216:219], a[156:159], a[80:83], v[216:219]
v_mfma_f32_16x16x32_bf16 v[220:223], a[156:159], a[84:87], v[220:223]
s_waitcnt lgkmcnt(10)
v_mfma_f32_16x16x32_bf16 a[56:59], a[160:163], a[72:75], a[56:59]
ds_read_b64_tr_b16 a[148:149], v3 offset:27680
v_mfma_f32_16x16x32_bf16 a[60:63], a[160:163], a[76:79], a[60:63]
ds_read_b64_tr_b16 a[150:151], v3 offset:29984
v_mfma_f32_16x16x32_bf16 v[224:227], a[160:163], a[80:83], v[224:227]
v_mfma_f32_16x16x32_bf16 v[228:231], a[160:163], a[84:87], v[228:231]
s_waitcnt lgkmcnt(10)
v_mfma_f32_16x16x32_bf16 v[232:235], a[164:167], a[72:75], v[232:235]
ds_read_b64_tr_b16 a[152:153], v3 offset:9280
v_mfma_f32_16x16x32_bf16 v[236:239], a[164:167], a[76:79], v[236:239]
ds_read_b64_tr_b16 a[154:155], v3 offset:11584
v_mfma_f32_16x16x32_bf16 v[240:243], a[164:167], a[80:83], v[240:243]
v_mfma_f32_16x16x32_bf16 v[244:247], a[164:167], a[84:87], v[244:247]
s_waitcnt lgkmcnt(10)
v_mfma_f32_16x16x32_bf16 a[64:67], a[168:171], a[72:75], a[64:67]
ds_read_b64_tr_b16 a[156:157], v3 offset:27712
v_mfma_f32_16x16x32_bf16 a[68:71], a[168:171], a[76:79], a[68:71]
ds_read_b64_tr_b16 a[158:159], v3 offset:30016
v_mfma_f32_16x16x32_bf16 v[248:251], a[168:171], a[80:83], v[248:251]
v_mfma_f32_16x16x32_bf16 v[252:255], a[168:171], a[84:87], v[252:255]
s_waitcnt lgkmcnt(10)
s_waitcnt vmcnt(23)
v_mfma_f32_16x16x32_bf16 v[40:43], a[136:139], a[88:91], v[40:43]
ds_read_b64_tr_b16 a[160:161], v3 offset:9312
v_mfma_f32_16x16x32_bf16 v[44:47], a[136:139], a[92:95], v[44:47]
ds_read_b64_tr_b16 a[162:163], v3 offset:11616
v_mfma_f32_16x16x32_bf16 v[48:51], a[136:139], a[96:99], v[48:51]
buffer_load_dwordx4 a[72:75], v1, s[8:11], s28 offen offset:0
v_mfma_f32_16x16x32_bf16 v[52:55], a[136:139], a[100:103], v[52:55]
s_waitcnt lgkmcnt(10)
v_mfma_f32_16x16x32_bf16 a[0:3], a[140:143], a[88:91], a[0:3]
ds_read_b64_tr_b16 a[164:165], v3 offset:27744
v_mfma_f32_16x16x32_bf16 a[4:7], a[140:143], a[92:95], a[4:7]
ds_read_b64_tr_b16 a[166:167], v3 offset:30048
v_mfma_f32_16x16x32_bf16 v[56:59], a[140:143], a[96:99], v[56:59]
buffer_load_dwordx4 a[76:79], v1, s[8:11], s28 offen offset:1024
v_mfma_f32_16x16x32_bf16 v[60:63], a[140:143], a[100:103], v[60:63]
s_waitcnt lgkmcnt(10)
v_mfma_f32_16x16x32_bf16 v[64:67], a[144:147], a[88:91], v[64:67]
ds_read_b64_tr_b16 a[168:169], v3 offset:9344
v_mfma_f32_16x16x32_bf16 v[68:71], a[144:147], a[92:95], v[68:71]
ds_read_b64_tr_b16 a[170:171], v3 offset:11648
v_mfma_f32_16x16x32_bf16 v[72:75], a[144:147], a[96:99], v[72:75]
buffer_load_dwordx4 a[80:83], v1, s[8:11], s28 offen offset:2048
v_mfma_f32_16x16x32_bf16 v[76:79], a[144:147], a[100:103], v[76:79]
s_waitcnt lgkmcnt(10)
v_mfma_f32_16x16x32_bf16 a[8:11], a[148:151], a[88:91], a[8:11]
ds_read_b64_tr_b16 a[136:137], v3 offset:27776
v_mfma_f32_16x16x32_bf16 a[12:15], a[148:151], a[92:95], a[12:15]
ds_read_b64_tr_b16 a[138:139], v3 offset:30080
v_mfma_f32_16x16x32_bf16 v[80:83], a[148:151], a[96:99], v[80:83]
buffer_load_dwordx4 a[84:87], v1, s[8:11], s28 offen offset:3072
s_add_u32 s28, s28, 131072
v_mfma_f32_16x16x32_bf16 v[84:87], a[148:151], a[100:103], v[84:87]
s_waitcnt lgkmcnt(10)
s_waitcnt vmcnt(17)
v_mfma_f32_16x16x32_bf16 v[88:91], a[152:155], a[88:91], v[88:91]
ds_read_b64_tr_b16 a[140:141], v3 offset:9376
v_sub_f32 v18, v18, v14
v_mfma_f32_16x16x32_bf16 v[92:95], a[152:155], a[92:95], v[92:95]
ds_read_b64_tr_b16 a[142:143], v3 offset:11680
tp2_p2:
s_cbranch_execz tp2_ret
v_add_f32 v17, v17, v19
tf_p7:
s_cbranch_execz k12_kernel_end
v_mfma_f32_16x16x32_bf16 v[96:99], a[152:155], a[96:99], v[96:99]
v_add_f32 v15, v15, v18
v_fmac_f32 v16, v18, v18
v_mfma_f32_16x16x32_bf16 v[100:103], a[152:155], a[100:103], v[100:103]
s_waitcnt lgkmcnt(10)
v_mfma_f32_16x16x32_bf16 a[16:19], a[156:159], a[88:91], a[16:19]
ds_read_b64_tr_b16 a[144:145], v3 offset:27808
v_sub_f32 v20, v20, v14
v_mfma_f32_16x16x32_bf16 a[20:23], a[156:159], a[92:95], a[20:23]
ds_read_b64_tr_b16 a[146:147], v3 offset:30112
v_add_f32 v17, v17, v21
v_mfma_f32_16x16x32_bf16 v[104:107], a[156:159], a[96:99], v[104:107]
v_add_f32 v15, v15, v20
v_fmac_f32 v16, v20, v20
v_mfma_f32_16x16x32_bf16 v[108:111], a[156:159], a[100:103], v[108:111]
s_waitcnt lgkmcnt(10)
v_mfma_f32_16x16x32_bf16 v[112:115], a[160:163], a[88:91], v[112:115]
ds_read_b64_tr_b16 a[148:149], v3 offset:9408
v_sub_f32 v22, v22, v14
v_mfma_f32_16x16x32_bf16 v[116:119], a[160:163], a[92:95], v[116:119]
ds_read_b64_tr_b16 a[150:151], v3 offset:11712
v_add_f32 v17, v17, v23
v_mfma_f32_16x16x32_bf16 v[120:123], a[160:163], a[96:99], v[120:123]
v_add_f32 v15, v15, v22
v_fmac_f32 v16, v22, v22
v_mfma_f32_16x16x32_bf16 v[124:127], a[160:163], a[100:103], v[124:127]
s_waitcnt lgkmcnt(10)
v_mfma_f32_16x16x32_bf16 a[24:27], a[164:167], a[88:91], a[24:27]
ds_read_b64_tr_b16 a[152:153], v3 offset:27840
v_sub_f32 v24, v24, v14
v_mfma_f32_16x16x32_bf16 a[28:31], a[164:167], a[92:95], a[28:31]
ds_read_b64_tr_b16 a[154:155], v3 offset:30144
v_add_f32 v17, v17, v25
v_mfma_f32_16x16x32_bf16 v[128:131], a[164:167], a[96:99], v[128:131]
v_add_f32 v15, v15, v24
v_fmac_f32 v16, v24, v24
v_mfma_f32_16x16x32_bf16 v[132:135], a[164:167], a[100:103], v[132:135]
s_waitcnt lgkmcnt(10)
v_mfma_f32_16x16x32_bf16 v[136:139], a[168:171], a[88:91], v[136:139]
ds_read_b64_tr_b16 a[156:157], v3 offset:9440
v_sub_f32 v26, v26, v14
v_mfma_f32_16x16x32_bf16 v[140:143], a[168:171], a[92:95], v[140:143]
ds_read_b64_tr_b16 a[158:159], v3 offset:11744
v_add_f32 v17, v17, v27
v_mfma_f32_16x16x32_bf16 v[144:147], a[168:171], a[96:99], v[144:147]
v_add_f32 v15, v15, v26
v_fmac_f32 v16, v26, v26
v_mfma_f32_16x16x32_bf16 v[148:151], a[168:171], a[100:103], v[148:151]
s_waitcnt lgkmcnt(10)
v_mfma_f32_16x16x32_bf16 a[32:35], a[136:139], a[88:91], a[32:35]
ds_read_b64_tr_b16 a[160:161], v3 offset:27872
v_sub_f32 v28, v28, v14
v_mfma_f32_16x16x32_bf16 a[36:39], a[136:139], a[92:95], a[36:39]
ds_read_b64_tr_b16 a[162:163], v3 offset:30176
v_add_f32 v17, v17, v29
v_mfma_f32_16x16x32_bf16 v[152:155], a[136:139], a[96:99], v[152:155]
v_add_f32 v15, v15, v28
v_fmac_f32 v16, v28, v28
v_mfma_f32_16x16x32_bf16 v[156:159], a[136:139], a[100:103], v[156:159]
s_waitcnt lgkmcnt(10)
v_mfma_f32_16x16x32_bf16 v[160:163], a[140:143], a[88:91], v[160:163]
ds_read_b64_tr_b16 a[164:165], v3 offset:9472
v_mfma_f32_16x16x32_bf16 v[164:167], a[140:143], a[92:95], v[164:167]
ds_read_b64_tr_b16 a[166:167], v3 offset:11776
v_mfma_f32_16x16x32_bf16 v[168:171], a[140:143], a[96:99], v[168:171]
buffer_load_dwordx2 v[18:19], v4, s[12:15], s29 offen
s_add_u32 s29, s29, 16384
v_mfma_f32_16x16x32_bf16 v[172:175], a[140:143], a[100:103], v[172:175]
s_waitcnt lgkmcnt(10)
v_mfma_f32_16x16x32_bf16 a[40:43], a[144:147], a[88:91], a[40:43]
ds_read_b64_tr_b16 a[168:169], v3 offset:27904
v_mfma_f32_16x16x32_bf16 a[44:47], a[144:147], a[92:95], a[44:47]
ds_read_b64_tr_b16 a[170:171], v3 offset:30208
v_mfma_f32_16x16x32_bf16 v[176:179], a[144:147], a[96:99], v[176:179]
buffer_load_dwordx2 v[20:21], v4, s[12:15], s29 offen
s_add_u32 s29, s29, 16384
v_add_u32 v3, 36864, v2
v_mfma_f32_16x16x32_bf16 v[180:183], a[144:147], a[100:103], v[180:183]
s_waitcnt lgkmcnt(10)
s_waitcnt vmcnt(33)
s_barrier
v_mfma_f32_16x16x32_bf16 v[184:187], a[148:151], a[88:91], v[184:187]
ds_read_b64_tr_b16 a[136:137], v3 offset:0
v_mfma_f32_16x16x32_bf16 v[188:191], a[148:151], a[92:95], v[188:191]
ds_read_b64_tr_b16 a[138:139], v3 offset:2304
v_mfma_f32_16x16x32_bf16 v[192:195], a[148:151], a[96:99], v[192:195]
buffer_load_dwordx2 v[22:23], v4, s[12:15], s29 offen
s_add_u32 s29, s29, 16384
v_mfma_f32_16x16x32_bf16 v[196:199], a[148:151], a[100:103], v[196:199]
s_waitcnt lgkmcnt(10)
v_mfma_f32_16x16x32_bf16 a[48:51], a[152:155], a[88:91], a[48:51]
ds_read_b64_tr_b16 a[140:141], v3 offset:18432
v_mfma_f32_16x16x32_bf16 a[52:55], a[152:155], a[92:95], a[52:55]
ds_read_b64_tr_b16 a[142:143], v3 offset:20736
v_mfma_f32_16x16x32_bf16 v[200:203], a[152:155], a[96:99], v[200:203]
buffer_load_dwordx2 v[24:25], v4, s[12:15], s29 offen
s_add_u32 s29, s29, 16384
v_mfma_f32_16x16x32_bf16 v[204:207], a[152:155], a[100:103], v[204:207]
s_waitcnt lgkmcnt(10)
v_mfma_f32_16x16x32_bf16 v[208:211], a[156:159], a[88:91], v[208:211]
ds_read_b64_tr_b16 a[144:145], v3 offset:32
v_mfma_f32_16x16x32_bf16 v[212:215], a[156:159], a[92:95], v[212:215]
ds_read_b64_tr_b16 a[146:147], v3 offset:2336
v_mfma_f32_16x16x32_bf16 v[216:219], a[156:159], a[96:99], v[216:219]
buffer_load_dwordx2 v[26:27], v4, s[12:15], s29 offen
s_add_u32 s29, s29, 16384
v_mfma_f32_16x16x32_bf16 v[220:223], a[156:159], a[100:103], v[220:223]
s_waitcnt lgkmcnt(10)
v_mfma_f32_16x16x32_bf16 a[56:59], a[160:163], a[88:91], a[56:59]
ds_read_b64_tr_b16 a[148:149], v3 offset:18464
v_mfma_f32_16x16x32_bf16 a[60:63], a[160:163], a[92:95], a[60:63]
ds_read_b64_tr_b16 a[150:151], v3 offset:20768
v_mfma_f32_16x16x32_bf16 v[224:227], a[160:163], a[96:99], v[224:227]
buffer_load_dwordx2 v[28:29], v4, s[12:15], s29 offen
s_add_u32 s29, s29, 16384
v_mfma_f32_16x16x32_bf16 v[228:231], a[160:163], a[100:103], v[228:231]
s_waitcnt lgkmcnt(10)
v_mfma_f32_16x16x32_bf16 v[232:235], a[164:167], a[88:91], v[232:235]
ds_read_b64_tr_b16 a[152:153], v3 offset:64
v_mfma_f32_16x16x32_bf16 v[236:239], a[164:167], a[92:95], v[236:239]
ds_read_b64_tr_b16 a[154:155], v3 offset:2368
v_mfma_f32_16x16x32_bf16 v[240:243], a[164:167], a[96:99], v[240:243]
v_mfma_f32_16x16x32_bf16 v[244:247], a[164:167], a[100:103], v[244:247]
s_waitcnt lgkmcnt(10)
v_mfma_f32_16x16x32_bf16 a[64:67], a[168:171], a[88:91], a[64:67]
ds_read_b64_tr_b16 a[156:157], v3 offset:18496
v_mfma_f32_16x16x32_bf16 a[68:71], a[168:171], a[92:95], a[68:71]
ds_read_b64_tr_b16 a[158:159], v3 offset:20800
v_mfma_f32_16x16x32_bf16 v[248:251], a[168:171], a[96:99], v[248:251]
v_mfma_f32_16x16x32_bf16 v[252:255], a[168:171], a[100:103], v[252:255]
s_waitcnt lgkmcnt(10)
s_waitcnt vmcnt(29)
v_mfma_f32_16x16x32_bf16 v[40:43], a[136:139], a[104:107], v[40:43]
ds_read_b64_tr_b16 a[160:161], v3 offset:96
v_mfma_f32_16x16x32_bf16 v[44:47], a[136:139], a[108:111], v[44:47]
ds_read_b64_tr_b16 a[162:163], v3 offset:2400
v_mfma_f32_16x16x32_bf16 v[48:51], a[136:139], a[112:115], v[48:51]
s_add_u32 m0, s30, 110592
s_nop 0
buffer_load_dwordx4 v5, s[4:7], s27 offen offset:0 lds
v_mfma_f32_16x16x32_bf16 v[52:55], a[136:139], a[116:119], v[52:55]
s_waitcnt lgkmcnt(10)
v_mfma_f32_16x16x32_bf16 a[0:3], a[140:143], a[104:107], a[0:3]
ds_read_b64_tr_b16 a[164:165], v3 offset:18528
v_mfma_f32_16x16x32_bf16 a[4:7], a[140:143], a[108:111], a[4:7]
ds_read_b64_tr_b16 a[166:167], v3 offset:20832
v_mfma_f32_16x16x32_bf16 v[56:59], a[140:143], a[112:115], v[56:59]
buffer_load_dwordx4 v6, s[4:7], s27 offen offset:1024 lds
v_mfma_f32_16x16x32_bf16 v[60:63], a[140:143], a[116:119], v[60:63]
s_waitcnt lgkmcnt(10)
v_mfma_f32_16x16x32_bf16 v[64:67], a[144:147], a[104:107], v[64:67]
ds_read_b64_tr_b16 a[168:169], v3 offset:128
v_mfma_f32_16x16x32_bf16 v[68:71], a[144:147], a[108:111], v[68:71]
ds_read_b64_tr_b16 a[170:171], v3 offset:2432
v_mfma_f32_16x16x32_bf16 v[72:75], a[144:147], a[112:115], v[72:75]
buffer_load_dwordx4 v7, s[4:7], s27 offen offset:2048 lds
v_mfma_f32_16x16x32_bf16 v[76:79], a[144:147], a[116:119], v[76:79]
s_waitcnt lgkmcnt(10)
v_mfma_f32_16x16x32_bf16 a[8:11], a[148:151], a[104:107], a[8:11]
ds_read_b64_tr_b16 a[136:137], v3 offset:18560
v_mfma_f32_16x16x32_bf16 a[12:15], a[148:151], a[108:111], a[12:15]
ds_read_b64_tr_b16 a[138:139], v3 offset:20864
v_mfma_f32_16x16x32_bf16 v[80:83], a[148:151], a[112:115], v[80:83]
buffer_load_dwordx4 v8, s[4:7], s27 offen offset:3072 lds
v_mfma_f32_16x16x32_bf16 v[84:87], a[148:151], a[116:119], v[84:87]
s_waitcnt lgkmcnt(10)
v_mfma_f32_16x16x32_bf16 v[88:91], a[152:155], a[104:107], v[88:91]
ds_read_b64_tr_b16 a[140:141], v3 offset:160
v_mfma_f32_16x16x32_bf16 v[92:95], a[152:155], a[108:111], v[92:95]
ds_read_b64_tr_b16 a[142:143], v3 offset:2464
v_mfma_f32_16x16x32_bf16 v[96:99], a[152:155], a[112:115], v[96:99]
s_add_u32 m0, m0, 4096
s_nop 0
buffer_load_dwordx4 v9, s[4:7], s27 offen offset:0 lds
v_mfma_f32_16x16x32_bf16 v[100:103], a[152:155], a[116:119], v[100:103]
s_waitcnt lgkmcnt(10)
v_mfma_f32_16x16x32_bf16 a[16:19], a[156:159], a[104:107], a[16:19]
ds_read_b64_tr_b16 a[144:145], v3 offset:18592
v_mfma_f32_16x16x32_bf16 a[20:23], a[156:159], a[108:111], a[20:23]
ds_read_b64_tr_b16 a[146:147], v3 offset:20896
v_mfma_f32_16x16x32_bf16 v[104:107], a[156:159], a[112:115], v[104:107]
buffer_load_dwordx4 v10, s[4:7], s27 offen offset:1024 lds
v_mfma_f32_16x16x32_bf16 v[108:111], a[156:159], a[116:119], v[108:111]
s_waitcnt lgkmcnt(10)
v_mfma_f32_16x16x32_bf16 v[112:115], a[160:163], a[104:107], v[112:115]
ds_read_b64_tr_b16 a[148:149], v3 offset:192
v_mfma_f32_16x16x32_bf16 v[116:119], a[160:163], a[108:111], v[116:119]
ds_read_b64_tr_b16 a[150:151], v3 offset:2496
v_mfma_f32_16x16x32_bf16 v[120:123], a[160:163], a[112:115], v[120:123]
buffer_load_dwordx4 v11, s[4:7], s27 offen offset:2048 lds
v_mfma_f32_16x16x32_bf16 v[124:127], a[160:163], a[116:119], v[124:127]
s_waitcnt lgkmcnt(10)
v_mfma_f32_16x16x32_bf16 a[24:27], a[164:167], a[104:107], a[24:27]
ds_read_b64_tr_b16 a[152:153], v3 offset:18624
v_mfma_f32_16x16x32_bf16 a[28:31], a[164:167], a[108:111], a[28:31]
ds_read_b64_tr_b16 a[154:155], v3 offset:20928
v_mfma_f32_16x16x32_bf16 v[128:131], a[164:167], a[112:115], v[128:131]
buffer_load_dwordx4 v12, s[4:7], s27 offen offset:3072 lds
v_mfma_f32_16x16x32_bf16 v[132:135], a[164:167], a[116:119], v[132:135]
s_waitcnt lgkmcnt(10)
v_mfma_f32_16x16x32_bf16 v[136:139], a[168:171], a[104:107], v[136:139]
ds_read_b64_tr_b16 a[156:157], v3 offset:224
v_mfma_f32_16x16x32_bf16 v[140:143], a[168:171], a[108:111], v[140:143]
ds_read_b64_tr_b16 a[158:159], v3 offset:2528
v_mfma_f32_16x16x32_bf16 v[144:147], a[168:171], a[112:115], v[144:147]
s_add_u32 m0, m0, 4096
s_nop 0
buffer_load_dwordx4 v13, s[4:7], s27 offen offset:0 lds
s_add_u32 s27, s27, 589824
v_mfma_f32_16x16x32_bf16 v[148:151], a[168:171], a[116:119], v[148:151]
s_waitcnt lgkmcnt(10)
v_mfma_f32_16x16x32_bf16 a[32:35], a[136:139], a[104:107], a[32:35]
ds_read_b64_tr_b16 a[160:161], v3 offset:18656
v_mfma_f32_16x16x32_bf16 a[36:39], a[136:139], a[108:111], a[36:39]
ds_read_b64_tr_b16 a[162:163], v3 offset:20960
v_mfma_f32_16x16x32_bf16 v[152:155], a[136:139], a[112:115], v[152:155]
buffer_load_dwordx4 a[88:91], v1, s[8:11], s28 offen offset:0
v_mfma_f32_16x16x32_bf16 v[156:159], a[136:139], a[116:119], v[156:159]
s_waitcnt lgkmcnt(10)
v_mfma_f32_16x16x32_bf16 v[160:163], a[140:143], a[104:107], v[160:163]
ds_read_b64_tr_b16 a[164:165], v3 offset:256
v_mfma_f32_16x16x32_bf16 v[164:167], a[140:143], a[108:111], v[164:167]
ds_read_b64_tr_b16 a[166:167], v3 offset:2560
v_mfma_f32_16x16x32_bf16 v[168:171], a[140:143], a[112:115], v[168:171]
buffer_load_dwordx4 a[92:95], v1, s[8:11], s28 offen offset:1024
v_mfma_f32_16x16x32_bf16 v[172:175], a[140:143], a[116:119], v[172:175]
s_waitcnt lgkmcnt(10)
v_mfma_f32_16x16x32_bf16 a[40:43], a[144:147], a[104:107], a[40:43]
ds_read_b64_tr_b16 a[168:169], v3 offset:18688
v_mfma_f32_16x16x32_bf16 a[44:47], a[144:147], a[108:111], a[44:47]
ds_read_b64_tr_b16 a[170:171], v3 offset:20992
v_mfma_f32_16x16x32_bf16 v[176:179], a[144:147], a[112:115], v[176:179]
buffer_load_dwordx4 a[96:99], v1, s[8:11], s28 offen offset:2048
v_mfma_f32_16x16x32_bf16 v[180:183], a[144:147], a[116:119], v[180:183]
s_waitcnt lgkmcnt(10)
v_mfma_f32_16x16x32_bf16 v[184:187], a[148:151], a[104:107], v[184:187]
ds_read_b64_tr_b16 a[136:137], v3 offset:9216
v_mfma_f32_16x16x32_bf16 v[188:191], a[148:151], a[108:111], v[188:191]
ds_read_b64_tr_b16 a[138:139], v3 offset:11520
v_mfma_f32_16x16x32_bf16 v[192:195], a[148:151], a[112:115], v[192:195]
buffer_load_dwordx4 a[100:103], v1, s[8:11], s28 offen offset:3072
s_add_u32 s28, s28, 131072
v_mfma_f32_16x16x32_bf16 v[196:199], a[148:151], a[116:119], v[196:199]
s_waitcnt lgkmcnt(10)
v_mfma_f32_16x16x32_bf16 a[48:51], a[152:155], a[104:107], a[48:51]
ds_read_b64_tr_b16 a[140:141], v3 offset:27648
v_mfma_f32_16x16x32_bf16 a[52:55], a[152:155], a[108:111], a[52:55]
ds_read_b64_tr_b16 a[142:143], v3 offset:29952
v_mfma_f32_16x16x32_bf16 v[200:203], a[152:155], a[112:115], v[200:203]
s_add_u32 s36, s33, 2228224
buffer_load_dwordx4 a[172:175], v1, s[8:11], s36 offen offset:0
v_mfma_f32_16x16x32_bf16 v[204:207], a[152:155], a[116:119], v[204:207]
s_waitcnt lgkmcnt(10)
v_mfma_f32_16x16x32_bf16 v[208:211], a[156:159], a[104:107], v[208:211]
ds_read_b64_tr_b16 a[144:145], v3 offset:9248
v_mfma_f32_16x16x32_bf16 v[212:215], a[156:159], a[108:111], v[212:215]
ds_read_b64_tr_b16 a[146:147], v3 offset:11552
v_mfma_f32_16x16x32_bf16 v[216:219], a[156:159], a[112:115], v[216:219]
buffer_load_dwordx4 a[176:179], v1, s[8:11], s36 offen offset:1024
v_mfma_f32_16x16x32_bf16 v[220:223], a[156:159], a[116:119], v[220:223]
s_waitcnt lgkmcnt(10)
v_mfma_f32_16x16x32_bf16 a[56:59], a[160:163], a[104:107], a[56:59]
ds_read_b64_tr_b16 a[148:149], v3 offset:27680
v_mfma_f32_16x16x32_bf16 a[60:63], a[160:163], a[108:111], a[60:63]
ds_read_b64_tr_b16 a[150:151], v3 offset:29984
v_mfma_f32_16x16x32_bf16 v[224:227], a[160:163], a[112:115], v[224:227]
buffer_load_dwordx4 a[180:183], v1, s[8:11], s36 offen offset:2048
v_mfma_f32_16x16x32_bf16 v[228:231], a[160:163], a[116:119], v[228:231]
s_waitcnt lgkmcnt(10)
v_mfma_f32_16x16x32_bf16 v[232:235], a[164:167], a[104:107], v[232:235]
ds_read_b64_tr_b16 a[152:153], v3 offset:9280
v_mfma_f32_16x16x32_bf16 v[236:239], a[164:167], a[108:111], v[236:239]
ds_read_b64_tr_b16 a[154:155], v3 offset:11584
v_mfma_f32_16x16x32_bf16 v[240:243], a[164:167], a[112:115], v[240:243]
buffer_load_dwordx4 a[184:187], v1, s[8:11], s36 offen offset:3072
v_mfma_f32_16x16x32_bf16 v[244:247], a[164:167], a[116:119], v[244:247]
s_waitcnt lgkmcnt(10)
v_mfma_f32_16x16x32_bf16 a[64:67], a[168:171], a[104:107], a[64:67]
ds_read_b64_tr_b16 a[156:157], v3 offset:27712
v_mfma_f32_16x16x32_bf16 a[68:71], a[168:171], a[108:111], a[68:71]
ds_read_b64_tr_b16 a[158:159], v3 offset:30016
v_mfma_f32_16x16x32_bf16 v[248:251], a[168:171], a[112:115], v[248:251]
v_mfma_f32_16x16x32_bf16 v[252:255], a[168:171], a[116:119], v[252:255]
s_waitcnt lgkmcnt(10)
s_waitcnt vmcnt(27)
v_mfma_f32_16x16x32_bf16 v[40:43], a[136:139], a[120:123], v[40:43]
ds_read_b64_tr_b16 a[160:161], v3 offset:9312
v_mfma_f32_16x16x32_bf16 v[44:47], a[136:139], a[124:127], v[44:47]
ds_read_b64_tr_b16 a[162:163], v3 offset:11616
v_mfma_f32_16x16x32_bf16 v[48:51], a[136:139], a[128:131], v[48:51]
buffer_load_dwordx4 a[104:107], v1, s[8:11], s28 offen offset:0
v_mfma_f32_16x16x32_bf16 v[52:55], a[136:139], a[132:135], v[52:55]
s_waitcnt lgkmcnt(10)
v_mfma_f32_16x16x32_bf16 a[0:3], a[140:143], a[120:123], a[0:3]
ds_read_b64_tr_b16 a[164:165], v3 offset:27744
v_mfma_f32_16x16x32_bf16 a[4:7], a[140:143], a[124:127], a[4:7]
ds_read_b64_tr_b16 a[166:167], v3 offset:30048
v_mfma_f32_16x16x32_bf16 v[56:59], a[140:143], a[128:131], v[56:59]
buffer_load_dwordx4 a[108:111], v1, s[8:11], s28 offen offset:1024
v_mfma_f32_16x16x32_bf16 v[60:63], a[140:143], a[132:135], v[60:63]
s_waitcnt lgkmcnt(10)
v_mfma_f32_16x16x32_bf16 v[64:67], a[144:147], a[120:123], v[64:67]
ds_read_b64_tr_b16 a[168:169], v3 offset:9344
v_mfma_f32_16x16x32_bf16 v[68:71], a[144:147], a[124:127], v[68:71]
ds_read_b64_tr_b16 a[170:171], v3 offset:11648
v_mfma_f32_16x16x32_bf16 v[72:75], a[144:147], a[128:131], v[72:75]
buffer_load_dwordx4 a[112:115], v1, s[8:11], s28 offen offset:2048
v_mfma_f32_16x16x32_bf16 v[76:79], a[144:147], a[132:135], v[76:79]
s_waitcnt lgkmcnt(10)
v_mfma_f32_16x16x32_bf16 a[8:11], a[148:151], a[120:123], a[8:11]
ds_read_b64_tr_b16 a[136:137], v3 offset:27776
v_mfma_f32_16x16x32_bf16 a[12:15], a[148:151], a[124:127], a[12:15]
ds_read_b64_tr_b16 a[138:139], v3 offset:30080
v_mfma_f32_16x16x32_bf16 v[80:83], a[148:151], a[128:131], v[80:83]
buffer_load_dwordx4 a[116:119], v1, s[8:11], s28 offen offset:3072
s_add_u32 s28, s28, 131072
v_mfma_f32_16x16x32_bf16 v[84:87], a[148:151], a[132:135], v[84:87]
s_waitcnt lgkmcnt(10)
s_waitcnt vmcnt(21)
v_mfma_f32_16x16x32_bf16 v[88:91], a[152:155], a[120:123], v[88:91]
ds_read_b64_tr_b16 a[140:141], v3 offset:9376
v_sub_f32 v18, v18, v14
v_mfma_f32_16x16x32_bf16 v[92:95], a[152:155], a[124:127], v[92:95]
ds_read_b64_tr_b16 a[142:143], v3 offset:11680
v_add_f32 v17, v17, v19
v_mfma_f32_16x16x32_bf16 v[96:99], a[152:155], a[128:131], v[96:99]
v_add_f32 v15, v15, v18
v_fmac_f32 v16, v18, v18
v_mfma_f32_16x16x32_bf16 v[100:103], a[152:155], a[132:135], v[100:103]
s_waitcnt lgkmcnt(10)
v_mfma_f32_16x16x32_bf16 a[16:19], a[156:159], a[120:123], a[16:19]
ds_read_b64_tr_b16 a[144:145], v3 offset:27808
v_sub_f32 v20, v20, v14
v_mfma_f32_16x16x32_bf16 a[20:23], a[156:159], a[124:127], a[20:23]
ds_read_b64_tr_b16 a[146:147], v3 offset:30112
v_add_f32 v17, v17, v21
v_mfma_f32_16x16x32_bf16 v[104:107], a[156:159], a[128:131], v[104:107]
v_add_f32 v15, v15, v20
v_fmac_f32 v16, v20, v20
v_mfma_f32_16x16x32_bf16 v[108:111], a[156:159], a[132:135], v[108:111]
s_waitcnt lgkmcnt(10)
v_mfma_f32_16x16x32_bf16 v[112:115], a[160:163], a[120:123], v[112:115]
ds_read_b64_tr_b16 a[148:149], v3 offset:9408
v_sub_f32 v22, v22, v14
v_mfma_f32_16x16x32_bf16 v[116:119], a[160:163], a[124:127], v[116:119]
ds_read_b64_tr_b16 a[150:151], v3 offset:11712
v_add_f32 v17, v17, v23
v_mfma_f32_16x16x32_bf16 v[120:123], a[160:163], a[128:131], v[120:123]
v_add_f32 v15, v15, v22
v_fmac_f32 v16, v22, v22
v_mfma_f32_16x16x32_bf16 v[124:127], a[160:163], a[132:135], v[124:127]
s_waitcnt lgkmcnt(10)
v_mfma_f32_16x16x32_bf16 a[24:27], a[164:167], a[120:123], a[24:27]
ds_read_b64_tr_b16 a[152:153], v3 offset:27840
v_sub_f32 v24, v24, v14
v_mfma_f32_16x16x32_bf16 a[28:31], a[164:167], a[124:127], a[28:31]
ds_read_b64_tr_b16 a[154:155], v3 offset:30144
v_add_f32 v17, v17, v25
v_mfma_f32_16x16x32_bf16 v[128:131], a[164:167], a[128:131], v[128:131]
v_add_f32 v15, v15, v24
v_fmac_f32 v16, v24, v24
v_mfma_f32_16x16x32_bf16 v[132:135], a[164:167], a[132:135], v[132:135]
s_waitcnt lgkmcnt(10)
v_mfma_f32_16x16x32_bf16 v[136:139], a[168:171], a[120:123], v[136:139]
ds_read_b64_tr_b16 a[156:157], v3 offset:9440
v_sub_f32 v26, v26, v14
v_mfma_f32_16x16x32_bf16 v[140:143], a[168:171], a[124:127], v[140:143]
ds_read_b64_tr_b16 a[158:159], v3 offset:11744
v_add_f32 v17, v17, v27
v_mfma_f32_16x16x32_bf16 v[144:147], a[168:171], a[128:131], v[144:147]
v_add_f32 v15, v15, v26
v_fmac_f32 v16, v26, v26
v_mfma_f32_16x16x32_bf16 v[148:151], a[168:171], a[132:135], v[148:151]
s_waitcnt lgkmcnt(10)
v_mfma_f32_16x16x32_bf16 a[32:35], a[136:139], a[120:123], a[32:35]
ds_read_b64_tr_b16 a[160:161], v3 offset:27872
v_sub_f32 v28, v28, v14
v_mfma_f32_16x16x32_bf16 a[36:39], a[136:139], a[124:127], a[36:39]
ds_read_b64_tr_b16 a[162:163], v3 offset:30176
v_add_f32 v17, v17, v29
v_mfma_f32_16x16x32_bf16 v[152:155], a[136:139], a[128:131], v[152:155]
v_add_f32 v15, v15, v28
v_fmac_f32 v16, v28, v28
v_mfma_f32_16x16x32_bf16 v[156:159], a[136:139], a[132:135], v[156:159]
s_waitcnt lgkmcnt(10)
v_mfma_f32_16x16x32_bf16 v[160:163], a[140:143], a[120:123], v[160:163]
ds_read_b64_tr_b16 a[164:165], v3 offset:9472
v_mfma_f32_16x16x32_bf16 v[164:167], a[140:143], a[124:127], v[164:167]
ds_read_b64_tr_b16 a[166:167], v3 offset:11776
v_mfma_f32_16x16x32_bf16 v[168:171], a[140:143], a[128:131], v[168:171]
v_mfma_f32_16x16x32_bf16 v[172:175], a[140:143], a[132:135], v[172:175]
s_waitcnt lgkmcnt(10)
v_mfma_f32_16x16x32_bf16 a[40:43], a[144:147], a[120:123], a[40:43]
ds_read_b64_tr_b16 a[168:169], v3 offset:27904
v_mfma_f32_16x16x32_bf16 a[44:47], a[144:147], a[124:127], a[44:47]
ds_read_b64_tr_b16 a[170:171], v3 offset:30208
v_mfma_f32_16x16x32_bf16 v[176:179], a[144:147], a[128:131], v[176:179]
v_add_u32 v3, 73728, v2
v_mfma_f32_16x16x32_bf16 v[180:183], a[144:147], a[132:135], v[180:183]
s_waitcnt lgkmcnt(10)
s_waitcnt vmcnt(35)
s_barrier
v_mfma_f32_16x16x32_bf16 v[184:187], a[148:151], a[120:123], v[184:187]
ds_read_b64_tr_b16 a[136:137], v3 offset:0
v_mfma_f32_16x16x32_bf16 v[188:191], a[148:151], a[124:127], v[188:191]
ds_read_b64_tr_b16 a[138:139], v3 offset:2304
v_mfma_f32_16x16x32_bf16 v[192:195], a[148:151], a[128:131], v[192:195]
v_mfma_f32_16x16x32_bf16 v[196:199], a[148:151], a[132:135], v[196:199]
s_waitcnt lgkmcnt(10)
v_mfma_f32_16x16x32_bf16 a[48:51], a[152:155], a[120:123], a[48:51]
ds_read_b64_tr_b16 a[140:141], v3 offset:18432
v_mfma_f32_16x16x32_bf16 a[52:55], a[152:155], a[124:127], a[52:55]
ds_read_b64_tr_b16 a[142:143], v3 offset:20736
v_mfma_f32_16x16x32_bf16 v[200:203], a[152:155], a[128:131], v[200:203]
v_mfma_f32_16x16x32_bf16 v[204:207], a[152:155], a[132:135], v[204:207]
s_waitcnt lgkmcnt(10)
v_mfma_f32_16x16x32_bf16 v[208:211], a[156:159], a[120:123], v[208:211]
ds_read_b64_tr_b16 a[144:145], v3 offset:32
v_mfma_f32_16x16x32_bf16 v[212:215], a[156:159], a[124:127], v[212:215]
ds_read_b64_tr_b16 a[146:147], v3 offset:2336
v_mfma_f32_16x16x32_bf16 v[216:219], a[156:159], a[128:131], v[216:219]
v_mfma_f32_16x16x32_bf16 v[220:223], a[156:159], a[132:135], v[220:223]
s_waitcnt lgkmcnt(10)
v_mfma_f32_16x16x32_bf16 a[56:59], a[160:163], a[120:123], a[56:59]
ds_read_b64_tr_b16 a[148:149], v3 offset:18464
v_mfma_f32_16x16x32_bf16 a[60:63], a[160:163], a[124:127], a[60:63]
ds_read_b64_tr_b16 a[150:151], v3 offset:20768
v_mfma_f32_16x16x32_bf16 v[224:227], a[160:163], a[128:131], v[224:227]
v_mfma_f32_16x16x32_bf16 v[228:231], a[160:163], a[132:135], v[228:231]
s_waitcnt lgkmcnt(10)
v_mfma_f32_16x16x32_bf16 v[232:235], a[164:167], a[120:123], v[232:235]
ds_read_b64_tr_b16 a[152:153], v3 offset:64
v_mfma_f32_16x16x32_bf16 v[236:239], a[164:167], a[124:127], v[236:239]
ds_read_b64_tr_b16 a[154:155], v3 offset:2368
v_mfma_f32_16x16x32_bf16 v[240:243], a[164:167], a[128:131], v[240:243]
v_mfma_f32_16x16x32_bf16 v[244:247], a[164:167], a[132:135], v[244:247]
s_waitcnt lgkmcnt(10)
v_mfma_f32_16x16x32_bf16 a[64:67], a[168:171], a[120:123], a[64:67]
ds_read_b64_tr_b16 a[156:157], v3 offset:18496
v_mfma_f32_16x16x32_bf16 a[68:71], a[168:171], a[124:127], a[68:71]
ds_read_b64_tr_b16 a[158:159], v3 offset:20800
v_mfma_f32_16x16x32_bf16 v[248:251], a[168:171], a[128:131], v[248:251]
v_mfma_f32_16x16x32_bf16 v[252:255], a[168:171], a[132:135], v[252:255]
s_waitcnt lgkmcnt(10)
s_waitcnt vmcnt(27)
v_mfma_f32_16x16x32_bf16 v[40:43], a[136:139], a[72:75], v[40:43]
ds_read_b64_tr_b16 a[160:161], v3 offset:96
v_mfma_f32_16x16x32_bf16 v[44:47], a[136:139], a[76:79], v[44:47]
ds_read_b64_tr_b16 a[162:163], v3 offset:2400
v_mfma_f32_16x16x32_bf16 v[48:51], a[136:139], a[80:83], v[48:51]
s_add_u32 m0, s30, 0
s_nop 0
buffer_load_dwordx4 v5, s[4:7], s27 offen offset:0 lds
v_mfma_f32_16x16x32_bf16 v[52:55], a[136:139], a[84:87], v[52:55]
s_waitcnt lgkmcnt(10)
v_mfma_f32_16x16x32_bf16 a[0:3], a[140:143], a[72:75], a[0:3]
ds_read_b64_tr_b16 a[164:165], v3 offset:18528
v_mfma_f32_16x16x32_bf16 a[4:7], a[140:143], a[76:79], a[4:7]
ds_read_b64_tr_b16 a[166:167], v3 offset:20832
v_mfma_f32_16x16x32_bf16 v[56:59], a[140:143], a[80:83], v[56:59]
buffer_load_dwordx4 v6, s[4:7], s27 offen offset:1024 lds
v_mfma_f32_16x16x32_bf16 v[60:63], a[140:143], a[84:87], v[60:63]
s_waitcnt lgkmcnt(10)
v_mfma_f32_16x16x32_bf16 v[64:67], a[144:147], a[72:75], v[64:67]
ds_read_b64_tr_b16 a[168:169], v3 offset:128
v_mfma_f32_16x16x32_bf16 v[68:71], a[144:147], a[76:79], v[68:71]
ds_read_b64_tr_b16 a[170:171], v3 offset:2432
v_mfma_f32_16x16x32_bf16 v[72:75], a[144:147], a[80:83], v[72:75]
buffer_load_dwordx4 v7, s[4:7], s27 offen offset:2048 lds
v_mfma_f32_16x16x32_bf16 v[76:79], a[144:147], a[84:87], v[76:79]
s_waitcnt lgkmcnt(10)
v_mfma_f32_16x16x32_bf16 a[8:11], a[148:151], a[72:75], a[8:11]
ds_read_b64_tr_b16 a[136:137], v3 offset:18560
v_mfma_f32_16x16x32_bf16 a[12:15], a[148:151], a[76:79], a[12:15]
ds_read_b64_tr_b16 a[138:139], v3 offset:20864
v_mfma_f32_16x16x32_bf16 v[80:83], a[148:151], a[80:83], v[80:83]
buffer_load_dwordx4 v8, s[4:7], s27 offen offset:3072 lds
v_mfma_f32_16x16x32_bf16 v[84:87], a[148:151], a[84:87], v[84:87]
s_waitcnt lgkmcnt(10)
v_mfma_f32_16x16x32_bf16 v[88:91], a[152:155], a[72:75], v[88:91]
ds_read_b64_tr_b16 a[140:141], v3 offset:160
v_mfma_f32_16x16x32_bf16 v[92:95], a[152:155], a[76:79], v[92:95]
ds_read_b64_tr_b16 a[142:143], v3 offset:2464
v_mfma_f32_16x16x32_bf16 v[96:99], a[152:155], a[80:83], v[96:99]
s_add_u32 m0, m0, 4096
s_nop 0
buffer_load_dwordx4 v9, s[4:7], s27 offen offset:0 lds
v_mfma_f32_16x16x32_bf16 v[100:103], a[152:155], a[84:87], v[100:103]
s_waitcnt lgkmcnt(10)
v_mfma_f32_16x16x32_bf16 a[16:19], a[156:159], a[72:75], a[16:19]
ds_read_b64_tr_b16 a[144:145], v3 offset:18592
v_mfma_f32_16x16x32_bf16 a[20:23], a[156:159], a[76:79], a[20:23]
ds_read_b64_tr_b16 a[146:147], v3 offset:20896
v_mfma_f32_16x16x32_bf16 v[104:107], a[156:159], a[80:83], v[104:107]
buffer_load_dwordx4 v10, s[4:7], s27 offen offset:1024 lds
v_mfma_f32_16x16x32_bf16 v[108:111], a[156:159], a[84:87], v[108:111]
s_waitcnt lgkmcnt(10)
v_mfma_f32_16x16x32_bf16 v[112:115], a[160:163], a[72:75], v[112:115]
ds_read_b64_tr_b16 a[148:149], v3 offset:192
v_mfma_f32_16x16x32_bf16 v[116:119], a[160:163], a[76:79], v[116:119]
ds_read_b64_tr_b16 a[150:151], v3 offset:2496
v_mfma_f32_16x16x32_bf16 v[120:123], a[160:163], a[80:83], v[120:123]
buffer_load_dwordx4 v11, s[4:7], s27 offen offset:2048 lds
v_mfma_f32_16x16x32_bf16 v[124:127], a[160:163], a[84:87], v[124:127]
s_waitcnt lgkmcnt(10)
v_mfma_f32_16x16x32_bf16 a[24:27], a[164:167], a[72:75], a[24:27]
ds_read_b64_tr_b16 a[152:153], v3 offset:18624
v_mfma_f32_16x16x32_bf16 a[28:31], a[164:167], a[76:79], a[28:31]
ds_read_b64_tr_b16 a[154:155], v3 offset:20928
v_mfma_f32_16x16x32_bf16 v[128:131], a[164:167], a[80:83], v[128:131]
buffer_load_dwordx4 v12, s[4:7], s27 offen offset:3072 lds
v_mfma_f32_16x16x32_bf16 v[132:135], a[164:167], a[84:87], v[132:135]
s_waitcnt lgkmcnt(10)
v_mfma_f32_16x16x32_bf16 v[136:139], a[168:171], a[72:75], v[136:139]
ds_read_b64_tr_b16 a[156:157], v3 offset:224
v_mfma_f32_16x16x32_bf16 v[140:143], a[168:171], a[76:79], v[140:143]
ds_read_b64_tr_b16 a[158:159], v3 offset:2528
v_mfma_f32_16x16x32_bf16 v[144:147], a[168:171], a[80:83], v[144:147]
s_add_u32 m0, m0, 4096
s_nop 0
buffer_load_dwordx4 v13, s[4:7], s27 offen offset:0 lds
s_add_u32 s27, s27, 589824
v_mfma_f32_16x16x32_bf16 v[148:151], a[168:171], a[84:87], v[148:151]
s_waitcnt lgkmcnt(10)
v_mfma_f32_16x16x32_bf16 a[32:35], a[136:139], a[72:75], a[32:35]
ds_read_b64_tr_b16 a[160:161], v3 offset:18656
v_mfma_f32_16x16x32_bf16 a[36:39], a[136:139], a[76:79], a[36:39]
ds_read_b64_tr_b16 a[162:163], v3 offset:20960
v_mfma_f32_16x16x32_bf16 v[152:155], a[136:139], a[80:83], v[152:155]
buffer_load_dwordx4 a[120:123], v1, s[8:11], s28 offen offset:0
v_mfma_f32_16x16x32_bf16 v[156:159], a[136:139], a[84:87], v[156:159]
s_waitcnt lgkmcnt(10)
v_mfma_f32_16x16x32_bf16 v[160:163], a[140:143], a[72:75], v[160:163]
ds_read_b64_tr_b16 a[164:165], v3 offset:256
v_mfma_f32_16x16x32_bf16 v[164:167], a[140:143], a[76:79], v[164:167]
ds_read_b64_tr_b16 a[166:167], v3 offset:2560
v_mfma_f32_16x16x32_bf16 v[168:171], a[140:143], a[80:83], v[168:171]
buffer_load_dwordx4 a[124:127], v1, s[8:11], s28 offen offset:1024
v_mfma_f32_16x16x32_bf16 v[172:175], a[140:143], a[84:87], v[172:175]
s_waitcnt lgkmcnt(10)
v_mfma_f32_16x16x32_bf16 a[40:43], a[144:147], a[72:75], a[40:43]
ds_read_b64_tr_b16 a[168:169], v3 offset:18688
v_mfma_f32_16x16x32_bf16 a[44:47], a[144:147], a[76:79], a[44:47]
ds_read_b64_tr_b16 a[170:171], v3 offset:20992
v_mfma_f32_16x16x32_bf16 v[176:179], a[144:147], a[80:83], v[176:179]
buffer_load_dwordx4 a[128:131], v1, s[8:11], s28 offen offset:2048
v_mfma_f32_16x16x32_bf16 v[180:183], a[144:147], a[84:87], v[180:183]
s_waitcnt lgkmcnt(10)
v_mfma_f32_16x16x32_bf16 v[184:187], a[148:151], a[72:75], v[184:187]
ds_read_b64_tr_b16 a[136:137], v3 offset:9216
v_mfma_f32_16x16x32_bf16 v[188:191], a[148:151], a[76:79], v[188:191]
ds_read_b64_tr_b16 a[138:139], v3 offset:11520
v_mfma_f32_16x16x32_bf16 v[192:195], a[148:151], a[80:83], v[192:195]
buffer_load_dwordx4 a[132:135], v1, s[8:11], s28 offen offset:3072
s_add_u32 s28, s28, 131072
v_mfma_f32_16x16x32_bf16 v[196:199], a[148:151], a[84:87], v[196:199]
s_waitcnt lgkmcnt(10)
v_mfma_f32_16x16x32_bf16 a[48:51], a[152:155], a[72:75], a[48:51]
ds_read_b64_tr_b16 a[140:141], v3 offset:27648
v_mfma_f32_16x16x32_bf16 a[52:55], a[152:155], a[76:79], a[52:55]
ds_read_b64_tr_b16 a[142:143], v3 offset:29952
v_mfma_f32_16x16x32_bf16 v[200:203], a[152:155], a[80:83], v[200:203]
v_mfma_f32_16x16x32_bf16 v[204:207], a[152:155], a[84:87], v[204:207]
s_waitcnt lgkmcnt(10)
v_mfma_f32_16x16x32_bf16 v[208:211], a[156:159], a[72:75], v[208:211]
ds_read_b64_tr_b16 a[144:145], v3 offset:9248
v_mfma_f32_16x16x32_bf16 v[212:215], a[156:159], a[76:79], v[212:215]
ds_read_b64_tr_b16 a[146:147], v3 offset:11552
v_mfma_f32_16x16x32_bf16 v[216:219], a[156:159], a[80:83], v[216:219]
v_mfma_f32_16x16x32_bf16 v[220:223], a[156:159], a[84:87], v[220:223]
s_waitcnt lgkmcnt(10)
v_mfma_f32_16x16x32_bf16 a[56:59], a[160:163], a[72:75], a[56:59]
ds_read_b64_tr_b16 a[148:149], v3 offset:27680
v_mfma_f32_16x16x32_bf16 a[60:63], a[160:163], a[76:79], a[60:63]
tp2_p3:
s_cbranch_execz tp2_ret
tf_p8:
s_cbranch_execz k12_kernel_end
ds_read_b64_tr_b16 a[150:151], v3 offset:29984
v_mfma_f32_16x16x32_bf16 v[224:227], a[160:163], a[80:83], v[224:227]
v_mfma_f32_16x16x32_bf16 v[228:231], a[160:163], a[84:87], v[228:231]
s_waitcnt lgkmcnt(10)
v_mfma_f32_16x16x32_bf16 v[232:235], a[164:167], a[72:75], v[232:235]
ds_read_b64_tr_b16 a[152:153], v3 offset:9280
v_mfma_f32_16x16x32_bf16 v[236:239], a[164:167], a[76:79], v[236:239]
ds_read_b64_tr_b16 a[154:155], v3 offset:11584
v_mfma_f32_16x16x32_bf16 v[240:243], a[164:167], a[80:83], v[240:243]
v_mfma_f32_16x16x32_bf16 v[244:247], a[164:167], a[84:87], v[244:247]
s_waitcnt lgkmcnt(10)
v_mfma_f32_16x16x32_bf16 a[64:67], a[168:171], a[72:75], a[64:67]
ds_read_b64_tr_b16 a[156:157], v3 offset:27712
v_mfma_f32_16x16x32_bf16 a[68:71], a[168:171], a[76:79], a[68:71]
ds_read_b64_tr_b16 a[158:159], v3 offset:30016
v_mfma_f32_16x16x32_bf16 v[248:251], a[168:171], a[80:83], v[248:251]
v_mfma_f32_16x16x32_bf16 v[252:255], a[168:171], a[84:87], v[252:255]
s_waitcnt lgkmcnt(10)
s_waitcnt vmcnt(21)
v_mfma_f32_16x16x32_bf16 v[40:43], a[136:139], a[88:91], v[40:43]
ds_read_b64_tr_b16 a[160:161], v3 offset:9312
v_mfma_f32_16x16x32_bf16 v[44:47], a[136:139], a[92:95], v[44:47]
ds_read_b64_tr_b16 a[162:163], v3 offset:11616
v_mfma_f32_16x16x32_bf16 v[48:51], a[136:139], a[96:99], v[48:51]
buffer_load_dwordx4 a[72:75], v1, s[8:11], s28 offen offset:0
v_mfma_f32_16x16x32_bf16 v[52:55], a[136:139], a[100:103], v[52:55]
s_waitcnt lgkmcnt(10)
v_mfma_f32_16x16x32_bf16 a[0:3], a[140:143], a[88:91], a[0:3]
ds_read_b64_tr_b16 a[164:165], v3 offset:27744
v_mfma_f32_16x16x32_bf16 a[4:7], a[140:143], a[92:95], a[4:7]
ds_read_b64_tr_b16 a[166:167], v3 offset:30048
v_mfma_f32_16x16x32_bf16 v[56:59], a[140:143], a[96:99], v[56:59]
buffer_load_dwordx4 a[76:79], v1, s[8:11], s28 offen offset:1024
v_mfma_f32_16x16x32_bf16 v[60:63], a[140:143], a[100:103], v[60:63]
s_waitcnt lgkmcnt(10)
v_mfma_f32_16x16x32_bf16 v[64:67], a[144:147], a[88:91], v[64:67]
ds_read_b64_tr_b16 a[168:169], v3 offset:9344
v_mfma_f32_16x16x32_bf16 v[68:71], a[144:147], a[92:95], v[68:71]
ds_read_b64_tr_b16 a[170:171], v3 offset:11648
v_mfma_f32_16x16x32_bf16 v[72:75], a[144:147], a[96:99], v[72:75]
buffer_load_dwordx4 a[80:83], v1, s[8:11], s28 offen offset:2048
v_mfma_f32_16x16x32_bf16 v[76:79], a[144:147], a[100:103], v[76:79]
s_waitcnt lgkmcnt(10)
v_mfma_f32_16x16x32_bf16 a[8:11], a[148:151], a[88:91], a[8:11]
ds_read_b64_tr_b16 a[136:137], v3 offset:27776
v_mfma_f32_16x16x32_bf16 a[12:15], a[148:151], a[92:95], a[12:15]
ds_read_b64_tr_b16 a[138:139], v3 offset:30080
v_mfma_f32_16x16x32_bf16 v[80:83], a[148:151], a[96:99], v[80:83]
buffer_load_dwordx4 a[84:87], v1, s[8:11], s28 offen offset:3072
s_add_u32 s28, s28, 131072
v_mfma_f32_16x16x32_bf16 v[84:87], a[148:151], a[100:103], v[84:87]
s_waitcnt lgkmcnt(10)
v_mfma_f32_16x16x32_bf16 v[88:91], a[152:155], a[88:91], v[88:91]
ds_read_b64_tr_b16 a[140:141], v3 offset:9376
v_mul_f32 v36, 0x3ce38e39, v15
v_mfma_f32_16x16x32_bf16 v[92:95], a[152:155], a[92:95], v[92:95]
ds_read_b64_tr_b16 a[142:143], v3 offset:11680
v_add_f32 v37, v14, v36
v_mfma_f32_16x16x32_bf16 v[96:99], a[152:155], a[96:99], v[96:99]
v_fma_f32 v38, -v36, v15, v16
v_mov_b32 v39, 0x41800000
v_mfma_f32_16x16x32_bf16 v[100:103], a[152:155], a[100:103], v[100:103]
s_waitcnt lgkmcnt(10)
v_fma_f32 v38, v38, v39, v17
v_mfma_f32_16x16x32_bf16 a[16:19], a[156:159], a[88:91], a[16:19]
ds_read_b64_tr_b16 a[144:145], v3 offset:27808
v_mov_b32 v39, 0x3727c5ac
v_mfma_f32_16x16x32_bf16 a[20:23], a[156:159], a[92:95], a[20:23]
ds_read_b64_tr_b16 a[146:147], v3 offset:30112
v_fmac_f32 v39, 0x3ae38e39, v38
v_mfma_f32_16x16x32_bf16 v[104:107], a[156:159], a[96:99], v[104:107]
v_xor_b32 v37, 0x80000000, v37
v_mfma_f32_16x16x32_bf16 v[108:111], a[156:159], a[100:103], v[108:111]
s_waitcnt lgkmcnt(10)
v_mfma_f32_16x16x32_bf16 v[112:115], a[160:163], a[88:91], v[112:115]
ds_read_b64_tr_b16 a[148:149], v3 offset:9408
v_mfma_f32_16x16x32_bf16 v[116:119], a[160:163], a[92:95], v[116:119]
ds_read_b64_tr_b16 a[150:151], v3 offset:11712
v_mfma_f32_16x16x32_bf16 v[120:123], a[160:163], a[96:99], v[120:123]
v_rcp_f32 v38, v39
v_mfma_f32_16x16x32_bf16 v[124:127], a[160:163], a[100:103], v[124:127]
s_waitcnt lgkmcnt(10)
s_lshl_b32 s50, s24, 8
v_mfma_f32_16x16x32_bf16 a[24:27], a[164:167], a[88:91], a[24:27]
ds_read_b64_tr_b16 a[152:153], v3 offset:27840
s_add_u32 s50, s50, 147456
v_mfma_f32_16x16x32_bf16 a[28:31], a[164:167], a[92:95], a[28:31]
ds_read_b64_tr_b16 a[154:155], v3 offset:30144
v_lshrrev_b32 v36, 2, v1
v_mfma_f32_16x16x32_bf16 v[128:131], a[164:167], a[96:99], v[128:131]
v_add_u32 v39, s50, v36
ds_write_b32 v39, v37
v_mfma_f32_16x16x32_bf16 v[132:135], a[164:167], a[100:103], v[132:135]
s_waitcnt lgkmcnt(11)
s_cmp_eq_u32 s25, 0
v_mfma_f32_16x16x32_bf16 v[136:139], a[168:171], a[88:91], v[136:139]
ds_read_b64_tr_b16 a[156:157], v3 offset:9440
s_cselect_b32 s51, 0, 0x40000000
v_mfma_f32_16x16x32_bf16 v[140:143], a[168:171], a[92:95], v[140:143]
ds_read_b64_tr_b16 a[158:159], v3 offset:11744
v_lshrrev_b32 v36, 1, v4
v_mfma_f32_16x16x32_bf16 v[144:147], a[168:171], a[96:99], v[144:147]
s_add_u32 s20, s48, 58392576
s_addc_u32 s21, s49, 0
v_mfma_f32_16x16x32_bf16 v[148:151], a[168:171], a[100:103], v[148:151]
s_waitcnt lgkmcnt(11)
s_mov_b32 s22, 8192
v_mfma_f32_16x16x32_bf16 a[32:35], a[136:139], a[88:91], a[32:35]
ds_read_b64_tr_b16 a[160:161], v3 offset:27872
v_mfma_f32_16x16x32_bf16 a[36:39], a[136:139], a[92:95], a[36:39]
ds_read_b64_tr_b16 a[162:163], v3 offset:30176
v_mfma_f32_16x16x32_bf16 v[152:155], a[136:139], a[96:99], v[152:155]
buffer_store_dword v38, v36, s[20:23], s51 offen
v_mfma_f32_16x16x32_bf16 v[156:159], a[136:139], a[100:103], v[156:159]
s_waitcnt lgkmcnt(11)
v_lshrrev_b32 v36, 4, v1
v_mfma_f32_16x16x32_bf16 v[160:163], a[140:143], a[88:91], v[160:163]
ds_read_b64_tr_b16 a[164:165], v3 offset:9472
v_and_b32 v37, 15, v36
v_mfma_f32_16x16x32_bf16 v[164:167], a[140:143], a[92:95], v[164:167]
ds_read_b64_tr_b16 a[166:167], v3 offset:11776
v_lshrrev_b32 v38, 4, v36
v_mfma_f32_16x16x32_bf16 v[168:171], a[140:143], a[96:99], v[168:171]
v_lshlrev_b32 v35, 4, v38
v_add_u32 v35, 148480, v35
v_mfma_f32_16x16x32_bf16 v[172:175], a[140:143], a[100:103], v[172:175]
s_waitcnt lgkmcnt(11)
v_lshl_add_u32 v39, v37, 2, s50
v_mfma_f32_16x16x32_bf16 a[40:43], a[144:147], a[88:91], a[40:43]
ds_read_b64_tr_b16 a[168:169], v3 offset:27904
s_waitcnt lgkmcnt(7)
v_mfma_f32_16x16x32_bf16 a[44:47], a[144:147], a[92:95], a[44:47]
ds_read_b64_tr_b16 a[170:171], v3 offset:30208
ds_read_b32 v30, v39 offset:0
v_mfma_f32_16x16x32_bf16 v[176:179], a[144:147], a[96:99], v[176:179]
v_add_u32 v3, 110592, v2
ds_read_b32 v31, v39 offset:64
v_mfma_f32_16x16x32_bf16 v[180:183], a[144:147], a[100:103], v[180:183]
s_waitcnt lgkmcnt(13)
s_waitcnt vmcnt(30)
s_barrier
v_mfma_f32_16x16x32_bf16 v[184:187], a[148:151], a[88:91], v[184:187]
ds_read_b64_tr_b16 a[136:137], v3 offset:0
ds_read_b32 v32, v39 offset:128
v_mfma_f32_16x16x32_bf16 v[188:191], a[148:151], a[92:95], v[188:191]
ds_read_b64_tr_b16 a[138:139], v3 offset:2304
ds_read_b32 v33, v39 offset:192
v_mfma_f32_16x16x32_bf16 v[192:195], a[148:151], a[96:99], v[192:195]
v_lshlrev_b32 v34, 8, v38
v_lshl_add_u32 v34, v37, 4, v34
v_mfma_f32_16x16x32_bf16 v[196:199], a[148:151], a[100:103], v[196:199]
s_waitcnt lgkmcnt(15)
s_lshr_b32 s52, s25, 1
v_mfma_f32_16x16x32_bf16 a[48:51], a[152:155], a[88:91], a[48:51]
ds_read_b64_tr_b16 a[140:141], v3 offset:18432
s_mul_i32 s52, s52, 9
v_mfma_f32_16x16x32_bf16 a[52:55], a[152:155], a[92:95], a[52:55]
ds_read_b64_tr_b16 a[142:143], v3 offset:20736
s_and_b32 s53, s25, 1
v_mfma_f32_16x16x32_bf16 v[200:203], a[152:155], a[96:99], v[200:203]
s_add_u32 s54, s52, 4
s_lshl_b32 s54, s54, 17
v_mfma_f32_16x16x32_bf16 v[204:207], a[152:155], a[100:103], v[204:207]
s_waitcnt lgkmcnt(14)
s_lshl_b32 s55, s53, 3
v_mfma_f32_16x16x32_bf16 v[208:211], a[156:159], a[88:91], v[208:211]
ds_read_b64_tr_b16 a[144:145], v3 offset:9216
s_add_u32 s54, s54, s55
v_mfma_f32_16x16x32_bf16 v[212:215], a[156:159], a[92:95], v[212:215]
ds_read_b64_tr_b16 a[146:147], v3 offset:11520
s_add_u32 s54, s54, s33
v_mfma_f32_16x16x32_bf16 v[216:219], a[156:159], a[96:99], v[216:219]
s_mul_i32 s55, s53, 5
s_add_u32 s52, s52, s55
v_mfma_f32_16x16x32_bf16 v[220:223], a[156:159], a[100:103], v[220:223]
s_waitcnt lgkmcnt(14)
s_lshl_b32 s52, s52, 17
v_mfma_f32_16x16x32_bf16 a[56:59], a[160:163], a[88:91], a[56:59]
ds_read_b64_tr_b16 a[148:149], v3 offset:27648
s_add_u32 s52, s52, s33
v_mfma_f32_16x16x32_bf16 a[60:63], a[160:163], a[92:95], a[60:63]
ds_read_b64_tr_b16 a[150:151], v3 offset:29952
ds_read_b128 v[6:9], v35 offset:0
v_mfma_f32_16x16x32_bf16 v[224:227], a[160:163], a[96:99], v[224:227]
ds_read_b128 v[10:13], v35 offset:576
v_mfma_f32_16x16x32_bf16 v[228:231], a[160:163], a[100:103], v[228:231]
s_waitcnt lgkmcnt(15)
s_waitcnt vmcnt(9)
s_barrier
v_mfma_f32_16x16x32_bf16 v[232:235], a[164:167], a[88:91], v[232:235]
ds_read_b64_tr_b16 a[152:153], v2 offset:0
v_mfma_f32_16x16x32_bf16 v[236:239], a[164:167], a[92:95], v[236:239]
ds_read_b64_tr_b16 a[154:155], v2 offset:2304
v_mfma_f32_16x16x32_bf16 v[240:243], a[164:167], a[96:99], v[240:243]
v_mfma_f32_16x16x32_bf16 v[244:247], a[164:167], a[100:103], v[244:247]
s_waitcnt lgkmcnt(15)
v_mfma_f32_16x16x32_bf16 a[64:67], a[168:171], a[88:91], a[64:67]
ds_read_b64_tr_b16 a[156:157], v2 offset:18432
v_mfma_f32_16x16x32_bf16 a[68:71], a[168:171], a[92:95], a[68:71]
ds_read_b64_tr_b16 a[158:159], v2 offset:20736
v_mfma_f32_16x16x32_bf16 v[248:251], a[168:171], a[96:99], v[248:251]
v_mfma_f32_16x16x32_bf16 v[252:255], a[168:171], a[100:103], v[252:255]
s_waitcnt lgkmcnt(10)
s_waitcnt vmcnt(18)
v_mfma_f32_16x16x32_bf16 v[40:43], a[136:139], a[104:107], v[40:43]
ds_read_b64_tr_b16 a[160:161], v2 offset:9216
v_mfma_f32_16x16x32_bf16 v[44:47], a[136:139], a[108:111], v[44:47]
ds_read_b64_tr_b16 a[162:163], v2 offset:11520
v_mfma_f32_16x16x32_bf16 v[48:51], a[136:139], a[112:115], v[48:51]
v_mfma_f32_16x16x32_bf16 v[52:55], a[136:139], a[116:119], v[52:55]
v_mfma_f32_16x16x32_bf16 a[0:3], a[140:143], a[104:107], a[0:3]
ds_read_b64_tr_b16 a[164:165], v2 offset:27648
v_mfma_f32_16x16x32_bf16 a[4:7], a[140:143], a[108:111], a[4:7]
ds_read_b64_tr_b16 a[166:167], v2 offset:29952
v_mfma_f32_16x16x32_bf16 v[56:59], a[140:143], a[112:115], v[56:59]
v_mfma_f32_16x16x32_bf16 v[60:63], a[140:143], a[116:119], v[60:63]
s_waitcnt lgkmcnt(10)
s_waitcnt vmcnt(1)
v_mfma_f32_16x16x32_bf16 v[40:43], a[144:147], a[120:123], v[40:43]
ds_read_b64_tr_b16 a[168:169], v3 offset:32
v_mfma_f32_16x16x32_bf16 v[44:47], a[144:147], a[124:127], v[44:47]
ds_read_b64_tr_b16 a[170:171], v3 offset:2336
v_mfma_f32_16x16x32_bf16 v[48:51], a[144:147], a[128:131], v[48:51]
v_mfma_f32_16x16x32_bf16 v[52:55], a[144:147], a[132:135], v[52:55]
v_mfma_f32_16x16x32_bf16 a[0:3], a[148:151], a[120:123], a[0:3]
ds_read_b64_tr_b16 a[136:137], v3 offset:18464
v_mfma_f32_16x16x32_bf16 a[4:7], a[148:151], a[124:127], a[4:7]
ds_read_b64_tr_b16 a[138:139], v3 offset:20768
v_mfma_f32_16x16x32_bf16 v[56:59], a[148:151], a[128:131], v[56:59]
v_mfma_f32_16x16x32_bf16 v[60:63], a[148:151], a[132:135], v[60:63]
s_waitcnt lgkmcnt(8)
v_mfma_f32_16x16x32_bf16 v[40:43], a[152:155], a[72:75], v[40:43]
ds_read_b64_tr_b16 a[140:141], v3 offset:9248
v_mfma_f32_16x16x32_bf16 v[44:47], a[152:155], a[76:79], v[44:47]
ds_read_b64_tr_b16 a[142:143], v3 offset:11552
v_mfma_f32_16x16x32_bf16 v[48:51], a[152:155], a[80:83], v[48:51]
v_mfma_f32_16x16x32_bf16 v[52:55], a[152:155], a[84:87], v[52:55]
v_mfma_f32_16x16x32_bf16 a[0:3], a[156:159], a[72:75], a[0:3]
ds_read_b64_tr_b16 a[144:145], v3 offset:27680
v_mfma_f32_16x16x32_bf16 a[4:7], a[156:159], a[76:79], a[4:7]
ds_read_b64_tr_b16 a[146:147], v3 offset:29984
v_mfma_f32_16x16x32_bf16 v[56:59], a[156:159], a[80:83], v[56:59]
v_mfma_f32_16x16x32_bf16 v[60:63], a[156:159], a[84:87], v[60:63]
s_waitcnt lgkmcnt(8)
v_mfma_f32_16x16x32_bf16 v[40:43], a[160:163], a[172:175], v[40:43]
ds_read_b64_tr_b16 a[148:149], v2 offset:32
v_mfma_f32_16x16x32_bf16 v[44:47], a[160:163], a[176:179], v[44:47]
ds_read_b64_tr_b16 a[150:151], v2 offset:2336
v_mfma_f32_16x16x32_bf16 v[48:51], a[160:163], a[180:183], v[48:51]
v_mfma_f32_16x16x32_bf16 v[52:55], a[160:163], a[184:187], v[52:55]
v_mfma_f32_16x16x32_bf16 a[0:3], a[164:167], a[172:175], a[0:3]
ds_read_b64_tr_b16 a[152:153], v2 offset:18464
v_mfma_f32_16x16x32_bf16 a[4:7], a[164:167], a[176:179], a[4:7]
ds_read_b64_tr_b16 a[154:155], v2 offset:20768
v_mfma_f32_16x16x32_bf16 v[56:59], a[164:167], a[180:183], v[56:59]
v_mfma_f32_16x16x32_bf16 v[60:63], a[164:167], a[184:187], v[60:63]
s_waitcnt lgkmcnt(8)
v_mfma_f32_16x16x32_bf16 v[64:67], a[168:171], a[104:107], v[64:67]
ds_read_b64_tr_b16 a[156:157], v2 offset:9248
v_mfma_f32_16x16x32_bf16 v[68:71], a[168:171], a[108:111], v[68:71]
ds_read_b64_tr_b16 a[158:159], v2 offset:11552
v_mfma_f32_16x16x32_bf16 v[72:75], a[168:171], a[112:115], v[72:75]
v_mfma_f32_16x16x32_bf16 v[76:79], a[168:171], a[116:119], v[76:79]
v_mfma_f32_16x16x32_bf16 a[8:11], a[136:139], a[104:107], a[8:11]
ds_read_b64_tr_b16 a[160:161], v2 offset:27680
v_accvgpr_read_b32 v26, a0
v_accvgpr_read_b32 v27, a1
v_accvgpr_read_b32 v28, a2
v_mfma_f32_16x16x32_bf16 a[12:15], a[136:139], a[108:111], a[12:15]
ds_read_b64_tr_b16 a[162:163], v2 offset:29984
v_accvgpr_read_b32 v29, a3
v_accvgpr_read_b32 v36, a4
v_accvgpr_read_b32 v37, a5
v_mfma_f32_16x16x32_bf16 v[80:83], a[136:139], a[112:115], v[80:83]
v_accvgpr_read_b32 v38, a6
v_accvgpr_read_b32 v39, a7
s_waitcnt lgkmcnt(15)
v_fma_f32 v48, v6, v32, v48
v_mfma_f32_16x16x32_bf16 v[84:87], a[136:139], a[116:119], v[84:87]
s_waitcnt lgkmcnt(8)
v_fma_f32 v49, v7, v32, v49
v_fma_f32 v50, v8, v32, v50
v_fma_f32 v51, v9, v32, v51
v_mfma_f32_16x16x32_bf16 v[64:67], a[140:143], a[120:123], v[64:67]
ds_read_b64_tr_b16 a[164:165], v3 offset:64
v_fma_f32 v56, v10, v32, v56
v_fma_f32 v57, v11, v32, v57
v_fma_f32 v58, v12, v32, v58
v_mfma_f32_16x16x32_bf16 v[68:71], a[140:143], a[124:127], v[68:71]
ds_read_b64_tr_b16 a[166:167], v3 offset:2368
v_fma_f32 v59, v13, v32, v59
v_max_f32 v48, 0, v48
v_max_f32 v49, 0, v49
v_mfma_f32_16x16x32_bf16 v[72:75], a[140:143], a[128:131], v[72:75]
v_max_f32 v50, 0, v50
v_max_f32 v51, 0, v51
v_mul_f32 v48, v48, v56
v_mul_f32 v49, v49, v57
v_mfma_f32_16x16x32_bf16 v[76:79], a[140:143], a[132:135], v[76:79]
v_mul_f32 v50, v50, v58
v_mul_f32 v51, v51, v59
v_cvt_pk_bf16_f32 v48, v48, v49
v_cvt_pk_bf16_f32 v49, v50, v51
v_mfma_f32_16x16x32_bf16 a[8:11], a[144:147], a[120:123], a[8:11]
ds_read_b64_tr_b16 a[168:169], v3 offset:18496
v_fma_f32 v52, v6, v33, v52
v_fma_f32 v53, v7, v33, v53
v_fma_f32 v54, v8, v33, v54
v_mfma_f32_16x16x32_bf16 a[12:15], a[144:147], a[124:127], a[12:15]
ds_read_b64_tr_b16 a[170:171], v3 offset:20800
v_fma_f32 v55, v9, v33, v55
v_fma_f32 v60, v10, v33, v60
v_fma_f32 v61, v11, v33, v61
v_mfma_f32_16x16x32_bf16 v[80:83], a[144:147], a[128:131], v[80:83]
v_fma_f32 v62, v12, v33, v62
v_fma_f32 v63, v13, v33, v63
v_max_f32 v52, 0, v52
v_max_f32 v53, 0, v53
v_mfma_f32_16x16x32_bf16 v[84:87], a[144:147], a[132:135], v[84:87]
s_waitcnt lgkmcnt(8)
v_max_f32 v54, 0, v54
v_max_f32 v55, 0, v55
v_mul_f32 v52, v52, v60
v_mfma_f32_16x16x32_bf16 v[64:67], a[148:151], a[72:75], v[64:67]
ds_read_b64_tr_b16 a[136:137], v3 offset:9280
v_mul_f32 v53, v53, v61
v_mul_f32 v54, v54, v62
v_mul_f32 v55, v55, v63
v_mfma_f32_16x16x32_bf16 v[68:71], a[148:151], a[76:79], v[68:71]
ds_read_b64_tr_b16 a[138:139], v3 offset:11584
v_cvt_pk_bf16_f32 v52, v52, v53
v_cvt_pk_bf16_f32 v53, v54, v55
v_fma_f32 v40, v6, v30, v40
v_mfma_f32_16x16x32_bf16 v[72:75], a[148:151], a[80:83], v[72:75]
v_fma_f32 v41, v7, v30, v41
v_fma_f32 v42, v8, v30, v42
v_fma_f32 v43, v9, v30, v43
v_fma_f32 v26, v10, v30, v26
v_mfma_f32_16x16x32_bf16 v[76:79], a[148:151], a[84:87], v[76:79]
v_fma_f32 v27, v11, v30, v27
v_fma_f32 v28, v12, v30, v28
v_fma_f32 v29, v13, v30, v29
v_max_f32 v40, 0, v40
v_mfma_f32_16x16x32_bf16 a[8:11], a[152:155], a[72:75], a[8:11]
ds_read_b64_tr_b16 a[140:141], v3 offset:27712
v_max_f32 v41, 0, v41
v_max_f32 v42, 0, v42
v_max_f32 v43, 0, v43
v_mfma_f32_16x16x32_bf16 a[12:15], a[152:155], a[76:79], a[12:15]
ds_read_b64_tr_b16 a[142:143], v3 offset:30016
v_mul_f32 v40, v40, v26
v_mul_f32 v41, v41, v27
v_mul_f32 v42, v42, v28
v_mfma_f32_16x16x32_bf16 v[80:83], a[152:155], a[80:83], v[80:83]
v_mul_f32 v43, v43, v29
v_cvt_pk_bf16_f32 v40, v40, v41
v_cvt_pk_bf16_f32 v41, v42, v43
v_fma_f32 v44, v6, v31, v44
v_mfma_f32_16x16x32_bf16 v[84:87], a[152:155], a[84:87], v[84:87]
s_waitcnt lgkmcnt(8)
v_fma_f32 v45, v7, v31, v45
v_fma_f32 v46, v8, v31, v46
v_fma_f32 v47, v9, v31, v47
v_mfma_f32_16x16x32_bf16 v[64:67], a[156:159], a[172:175], v[64:67]
ds_read_b64_tr_b16 a[144:145], v2 offset:64
v_fma_f32 v36, v10, v31, v36
v_fma_f32 v37, v11, v31, v37
v_fma_f32 v38, v12, v31, v38
v_mfma_f32_16x16x32_bf16 v[68:71], a[156:159], a[176:179], v[68:71]
ds_read_b64_tr_b16 a[146:147], v2 offset:2368
v_fma_f32 v39, v13, v31, v39
v_max_f32 v44, 0, v44
v_max_f32 v45, 0, v45
v_mfma_f32_16x16x32_bf16 v[72:75], a[156:159], a[180:183], v[72:75]
v_max_f32 v46, 0, v46
v_max_f32 v47, 0, v47
v_mul_f32 v44, v44, v36
v_mul_f32 v45, v45, v37
v_mfma_f32_16x16x32_bf16 v[76:79], a[156:159], a[184:187], v[76:79]
v_mul_f32 v46, v46, v38
v_mul_f32 v47, v47, v39
v_cvt_pk_bf16_f32 v44, v44, v45
v_cvt_pk_bf16_f32 v45, v46, v47
v_mfma_f32_16x16x32_bf16 a[8:11], a[160:163], a[172:175], a[8:11]
ds_read_b64_tr_b16 a[148:149], v2 offset:18496
ds_read_b128 v[18:21], v35 offset:64
v_mfma_f32_16x16x32_bf16 a[12:15], a[160:163], a[176:179], a[12:15]
ds_read_b64_tr_b16 a[150:151], v2 offset:20800
ds_read_b128 v[22:25], v35 offset:640
v_mfma_f32_16x16x32_bf16 v[80:83], a[160:163], a[180:183], v[80:83]
v_mfma_f32_16x16x32_bf16 v[84:87], a[160:163], a[184:187], v[84:87]
s_waitcnt lgkmcnt(10)
v_mfma_f32_16x16x32_bf16 v[88:91], a[164:167], a[104:107], v[88:91]
ds_read_b64_tr_b16 a[152:153], v2 offset:9280
v_mfma_f32_16x16x32_bf16 v[92:95], a[164:167], a[108:111], v[92:95]
ds_read_b64_tr_b16 a[154:155], v2 offset:11584
v_mfma_f32_16x16x32_bf16 v[96:99], a[164:167], a[112:115], v[96:99]
v_mfma_f32_16x16x32_bf16 v[100:103], a[164:167], a[116:119], v[100:103]
v_mfma_f32_16x16x32_bf16 a[16:19], a[168:171], a[104:107], a[16:19]
ds_read_b64_tr_b16 a[156:157], v2 offset:27712
v_accvgpr_read_b32 v26, a8
v_accvgpr_read_b32 v27, a9
v_accvgpr_read_b32 v28, a10
v_mfma_f32_16x16x32_bf16 a[20:23], a[168:171], a[108:111], a[20:23]
ds_read_b64_tr_b16 a[158:159], v2 offset:30016
v_accvgpr_read_b32 v29, a11
v_accvgpr_read_b32 v36, a12
v_accvgpr_read_b32 v37, a13
v_mfma_f32_16x16x32_bf16 v[104:107], a[168:171], a[112:115], v[104:107]
v_accvgpr_read_b32 v38, a14
v_accvgpr_read_b32 v39, a15
s_waitcnt lgkmcnt(4)
v_fma_f32 v72, v18, v32, v72
v_fma_f32 v73, v19, v32, v73
v_mfma_f32_16x16x32_bf16 v[108:111], a[168:171], a[116:119], v[108:111]
s_waitcnt lgkmcnt(10)
v_fma_f32 v74, v20, v32, v74
v_fma_f32 v75, v21, v32, v75
v_fma_f32 v80, v22, v32, v80
v_mfma_f32_16x16x32_bf16 v[88:91], a[136:139], a[120:123], v[88:91]
ds_read_b64_tr_b16 a[160:161], v3 offset:96
v_fma_f32 v81, v23, v32, v81
v_fma_f32 v82, v24, v32, v82
v_fma_f32 v83, v25, v32, v83
v_mfma_f32_16x16x32_bf16 v[92:95], a[136:139], a[124:127], v[92:95]
ds_read_b64_tr_b16 a[162:163], v3 offset:2400
v_max_f32 v72, 0, v72
v_max_f32 v73, 0, v73
v_max_f32 v74, 0, v74
v_max_f32 v75, 0, v75
v_mfma_f32_16x16x32_bf16 v[96:99], a[136:139], a[128:131], v[96:99]
v_mul_f32 v72, v72, v80
v_mul_f32 v73, v73, v81
v_mul_f32 v74, v74, v82
v_mul_f32 v75, v75, v83
v_mfma_f32_16x16x32_bf16 v[100:103], a[136:139], a[132:135], v[100:103]
v_cvt_pk_bf16_f32 v50, v72, v73
v_cvt_pk_bf16_f32 v51, v74, v75
buffer_store_dwordx4 v[48:51], v34, s[16:19], s52 offen offset:2048 sc1
v_fma_f32 v76, v18, v33, v76
v_mfma_f32_16x16x32_bf16 a[16:19], a[140:143], a[120:123], a[16:19]
ds_read_b64_tr_b16 a[164:165], v3 offset:18528
v_fma_f32 v77, v19, v33, v77
v_fma_f32 v78, v20, v33, v78
v_fma_f32 v79, v21, v33, v79
v_mfma_f32_16x16x32_bf16 a[20:23], a[140:143], a[124:127], a[20:23]
ds_read_b64_tr_b16 a[166:167], v3 offset:20832
v_fma_f32 v84, v22, v33, v84
v_fma_f32 v85, v23, v33, v85
v_fma_f32 v86, v24, v33, v86
v_mfma_f32_16x16x32_bf16 v[104:107], a[140:143], a[128:131], v[104:107]
v_fma_f32 v87, v25, v33, v87
v_max_f32 v76, 0, v76
v_max_f32 v77, 0, v77
v_max_f32 v78, 0, v78
v_max_f32 v79, 0, v79
v_mfma_f32_16x16x32_bf16 v[108:111], a[140:143], a[132:135], v[108:111]
s_waitcnt lgkmcnt(9)
v_mul_f32 v76, v76, v84
v_mul_f32 v77, v77, v85
v_mul_f32 v78, v78, v86
v_mfma_f32_16x16x32_bf16 v[88:91], a[144:147], a[72:75], v[88:91]
ds_read_b64_tr_b16 a[168:169], v3 offset:9312
v_mul_f32 v79, v79, v87
v_cvt_pk_bf16_f32 v54, v76, v77
v_cvt_pk_bf16_f32 v55, v78, v79
v_mfma_f32_16x16x32_bf16 v[92:95], a[144:147], a[76:79], v[92:95]
ds_read_b64_tr_b16 a[170:171], v3 offset:11616
buffer_store_dwordx4 v[52:55], v34, s[16:19], s52 offen offset:3072 sc1
v_fma_f32 v64, v18, v30, v64
v_fma_f32 v65, v19, v30, v65
v_mfma_f32_16x16x32_bf16 v[96:99], a[144:147], a[80:83], v[96:99]
v_fma_f32 v66, v20, v30, v66
v_fma_f32 v67, v21, v30, v67
v_fma_f32 v26, v22, v30, v26
v_fma_f32 v27, v23, v30, v27
v_mfma_f32_16x16x32_bf16 v[100:103], a[144:147], a[84:87], v[100:103]
v_fma_f32 v28, v24, v30, v28
v_fma_f32 v29, v25, v30, v29
v_max_f32 v64, 0, v64
v_max_f32 v65, 0, v65
v_max_f32 v66, 0, v66
v_mfma_f32_16x16x32_bf16 a[16:19], a[148:151], a[72:75], a[16:19]
ds_read_b64_tr_b16 a[136:137], v3 offset:27744
v_max_f32 v67, 0, v67
v_mul_f32 v64, v64, v26
v_mul_f32 v65, v65, v27
v_mfma_f32_16x16x32_bf16 a[20:23], a[148:151], a[76:79], a[20:23]
ds_read_b64_tr_b16 a[138:139], v3 offset:30048
v_mul_f32 v66, v66, v28
v_mul_f32 v67, v67, v29
v_cvt_pk_bf16_f32 v42, v64, v65
v_mfma_f32_16x16x32_bf16 v[104:107], a[148:151], a[80:83], v[104:107]
v_cvt_pk_bf16_f32 v43, v66, v67
buffer_store_dwordx4 v[40:43], v34, s[16:19], s52 offen offset:0 sc1
v_fma_f32 v68, v18, v31, v68
v_fma_f32 v69, v19, v31, v69
v_mfma_f32_16x16x32_bf16 v[108:111], a[148:151], a[84:87], v[108:111]
s_waitcnt lgkmcnt(8)
v_fma_f32 v70, v20, v31, v70
v_fma_f32 v71, v21, v31, v71
v_fma_f32 v36, v22, v31, v36
v_mfma_f32_16x16x32_bf16 v[88:91], a[152:155], a[172:175], v[88:91]
ds_read_b64_tr_b16 a[140:141], v2 offset:96
v_fma_f32 v37, v23, v31, v37
v_fma_f32 v38, v24, v31, v38
v_fma_f32 v39, v25, v31, v39
v_mfma_f32_16x16x32_bf16 v[92:95], a[152:155], a[176:179], v[92:95]
ds_read_b64_tr_b16 a[142:143], v2 offset:2400
v_max_f32 v68, 0, v68
v_max_f32 v69, 0, v69
v_max_f32 v70, 0, v70
v_max_f32 v71, 0, v71
v_mfma_f32_16x16x32_bf16 v[96:99], a[152:155], a[180:183], v[96:99]
v_mul_f32 v68, v68, v36
v_mul_f32 v69, v69, v37
v_mul_f32 v70, v70, v38
v_mul_f32 v71, v71, v39
v_mfma_f32_16x16x32_bf16 v[100:103], a[152:155], a[184:187], v[100:103]
v_cvt_pk_bf16_f32 v46, v68, v69
v_cvt_pk_bf16_f32 v47, v70, v71
buffer_store_dwordx4 v[44:47], v34, s[16:19], s52 offen offset:1024 sc1
s_add_u32 s52, s52, 131072
v_mfma_f32_16x16x32_bf16 a[16:19], a[156:159], a[172:175], a[16:19]
ds_read_b64_tr_b16 a[144:145], v2 offset:18528
ds_read_b128 v[6:9], v35 offset:128
v_mfma_f32_16x16x32_bf16 a[20:23], a[156:159], a[176:179], a[20:23]
ds_read_b64_tr_b16 a[146:147], v2 offset:20832
ds_read_b128 v[10:13], v35 offset:704
v_mfma_f32_16x16x32_bf16 v[104:107], a[156:159], a[180:183], v[104:107]
v_mfma_f32_16x16x32_bf16 v[108:111], a[156:159], a[184:187], v[108:111]
s_waitcnt lgkmcnt(10)
v_mfma_f32_16x16x32_bf16 v[112:115], a[160:163], a[104:107], v[112:115]
ds_read_b64_tr_b16 a[148:149], v2 offset:9312
v_mfma_f32_16x16x32_bf16 v[116:119], a[160:163], a[108:111], v[116:119]
ds_read_b64_tr_b16 a[150:151], v2 offset:11616
v_mfma_f32_16x16x32_bf16 v[120:123], a[160:163], a[112:115], v[120:123]
v_mfma_f32_16x16x32_bf16 v[124:127], a[160:163], a[116:119], v[124:127]
v_mfma_f32_16x16x32_bf16 a[24:27], a[164:167], a[104:107], a[24:27]
ds_read_b64_tr_b16 a[152:153], v2 offset:27744
v_accvgpr_read_b32 v26, a16
v_accvgpr_read_b32 v27, a17
v_accvgpr_read_b32 v28, a18
v_mfma_f32_16x16x32_bf16 a[28:31], a[164:167], a[108:111], a[28:31]
ds_read_b64_tr_b16 a[154:155], v2 offset:30048
v_accvgpr_read_b32 v29, a19
v_accvgpr_read_b32 v36, a20
v_accvgpr_read_b32 v37, a21
v_mfma_f32_16x16x32_bf16 v[128:131], a[164:167], a[112:115], v[128:131]
v_accvgpr_read_b32 v38, a22
v_accvgpr_read_b32 v39, a23
s_waitcnt lgkmcnt(4)
v_fma_f32 v96, v6, v32, v96
v_mfma_f32_16x16x32_bf16 v[132:135], a[164:167], a[116:119], v[132:135]
s_waitcnt lgkmcnt(10)
v_fma_f32 v97, v7, v32, v97
v_fma_f32 v98, v8, v32, v98
v_fma_f32 v99, v9, v32, v99
v_mfma_f32_16x16x32_bf16 v[112:115], a[168:171], a[120:123], v[112:115]
ds_read_b64_tr_b16 a[156:157], v3 offset:128
v_fma_f32 v104, v10, v32, v104
v_fma_f32 v105, v11, v32, v105
v_fma_f32 v106, v12, v32, v106
v_mfma_f32_16x16x32_bf16 v[116:119], a[168:171], a[124:127], v[116:119]
ds_read_b64_tr_b16 a[158:159], v3 offset:2432
v_fma_f32 v107, v13, v32, v107
v_max_f32 v96, 0, v96
v_max_f32 v97, 0, v97
v_mfma_f32_16x16x32_bf16 v[120:123], a[168:171], a[128:131], v[120:123]
v_max_f32 v98, 0, v98
v_max_f32 v99, 0, v99
v_mul_f32 v96, v96, v104
v_mul_f32 v97, v97, v105
v_mfma_f32_16x16x32_bf16 v[124:127], a[168:171], a[132:135], v[124:127]
v_mul_f32 v98, v98, v106
v_mul_f32 v99, v99, v107
v_cvt_pk_bf16_f32 v96, v96, v97
v_cvt_pk_bf16_f32 v97, v98, v99
v_mfma_f32_16x16x32_bf16 a[24:27], a[136:139], a[120:123], a[24:27]
ds_read_b64_tr_b16 a[160:161], v3 offset:18560
v_fma_f32 v100, v6, v33, v100
v_fma_f32 v101, v7, v33, v101
tp2_p4:
s_cbranch_execz tp2_ret
v_fma_f32 v102, v8, v33, v102
tf_p9:
s_cbranch_execz k12_kernel_end
v_mfma_f32_16x16x32_bf16 a[28:31], a[136:139], a[124:127], a[28:31]
ds_read_b64_tr_b16 a[162:163], v3 offset:20864
v_fma_f32 v103, v9, v33, v103
v_fma_f32 v108, v10, v33, v108
v_fma_f32 v109, v11, v33, v109
v_mfma_f32_16x16x32_bf16 v[128:131], a[136:139], a[128:131], v[128:131]
v_fma_f32 v110, v12, v33, v110
v_fma_f32 v111, v13, v33, v111
v_max_f32 v100, 0, v100
v_max_f32 v101, 0, v101
v_mfma_f32_16x16x32_bf16 v[132:135], a[136:139], a[132:135], v[132:135]
s_waitcnt lgkmcnt(9)
v_max_f32 v102, 0, v102
v_max_f32 v103, 0, v103
v_mul_f32 v100, v100, v108
v_mfma_f32_16x16x32_bf16 v[112:115], a[140:143], a[72:75], v[112:115]
ds_read_b64_tr_b16 a[164:165], v3 offset:9344
v_mul_f32 v101, v101, v109
v_mul_f32 v102, v102, v110
v_mul_f32 v103, v103, v111
v_mfma_f32_16x16x32_bf16 v[116:119], a[140:143], a[76:79], v[116:119]
ds_read_b64_tr_b16 a[166:167], v3 offset:11648
v_cvt_pk_bf16_f32 v100, v100, v101
v_cvt_pk_bf16_f32 v101, v102, v103
v_fma_f32 v88, v6, v30, v88
v_mfma_f32_16x16x32_bf16 v[120:123], a[140:143], a[80:83], v[120:123]
v_fma_f32 v89, v7, v30, v89
v_fma_f32 v90, v8, v30, v90
v_fma_f32 v91, v9, v30, v91
v_fma_f32 v26, v10, v30, v26
v_mfma_f32_16x16x32_bf16 v[124:127], a[140:143], a[84:87], v[124:127]
v_fma_f32 v27, v11, v30, v27
v_fma_f32 v28, v12, v30, v28
v_fma_f32 v29, v13, v30, v29
v_max_f32 v88, 0, v88
v_mfma_f32_16x16x32_bf16 a[24:27], a[144:147], a[72:75], a[24:27]
ds_read_b64_tr_b16 a[168:169], v3 offset:27776
v_max_f32 v89, 0, v89
v_max_f32 v90, 0, v90
v_max_f32 v91, 0, v91
v_mfma_f32_16x16x32_bf16 a[28:31], a[144:147], a[76:79], a[28:31]
ds_read_b64_tr_b16 a[170:171], v3 offset:30080
v_mul_f32 v88, v88, v26
v_mul_f32 v89, v89, v27
v_mul_f32 v90, v90, v28
v_mfma_f32_16x16x32_bf16 v[128:131], a[144:147], a[80:83], v[128:131]
v_mul_f32 v91, v91, v29
v_cvt_pk_bf16_f32 v88, v88, v89
v_cvt_pk_bf16_f32 v89, v90, v91
v_fma_f32 v92, v6, v31, v92
v_mfma_f32_16x16x32_bf16 v[132:135], a[144:147], a[84:87], v[132:135]
s_waitcnt lgkmcnt(8)
v_fma_f32 v93, v7, v31, v93
v_fma_f32 v94, v8, v31, v94
v_fma_f32 v95, v9, v31, v95
v_mfma_f32_16x16x32_bf16 v[112:115], a[148:151], a[172:175], v[112:115]
ds_read_b64_tr_b16 a[136:137], v2 offset:128
v_fma_f32 v36, v10, v31, v36
v_fma_f32 v37, v11, v31, v37
v_fma_f32 v38, v12, v31, v38
v_mfma_f32_16x16x32_bf16 v[116:119], a[148:151], a[176:179], v[116:119]
ds_read_b64_tr_b16 a[138:139], v2 offset:2432
v_fma_f32 v39, v13, v31, v39
v_max_f32 v92, 0, v92
v_max_f32 v93, 0, v93
v_mfma_f32_16x16x32_bf16 v[120:123], a[148:151], a[180:183], v[120:123]
v_max_f32 v94, 0, v94
v_max_f32 v95, 0, v95
v_mul_f32 v92, v92, v36
v_mul_f32 v93, v93, v37
v_mfma_f32_16x16x32_bf16 v[124:127], a[148:151], a[184:187], v[124:127]
v_mul_f32 v94, v94, v38
v_mul_f32 v95, v95, v39
v_cvt_pk_bf16_f32 v92, v92, v93
v_cvt_pk_bf16_f32 v93, v94, v95
v_mfma_f32_16x16x32_bf16 a[24:27], a[152:155], a[172:175], a[24:27]
ds_read_b64_tr_b16 a[140:141], v2 offset:18560
ds_read_b128 v[18:21], v35 offset:192
v_mfma_f32_16x16x32_bf16 a[28:31], a[152:155], a[176:179], a[28:31]
ds_read_b64_tr_b16 a[142:143], v2 offset:20864
ds_read_b128 v[22:25], v35 offset:768
v_mfma_f32_16x16x32_bf16 v[128:131], a[152:155], a[180:183], v[128:131]
v_mfma_f32_16x16x32_bf16 v[132:135], a[152:155], a[184:187], v[132:135]
s_waitcnt lgkmcnt(10)
v_mfma_f32_16x16x32_bf16 v[136:139], a[156:159], a[104:107], v[136:139]
ds_read_b64_tr_b16 a[144:145], v2 offset:9344
v_mfma_f32_16x16x32_bf16 v[140:143], a[156:159], a[108:111], v[140:143]
ds_read_b64_tr_b16 a[146:147], v2 offset:11648
v_mfma_f32_16x16x32_bf16 v[144:147], a[156:159], a[112:115], v[144:147]
v_mfma_f32_16x16x32_bf16 v[148:151], a[156:159], a[116:119], v[148:151]
v_mfma_f32_16x16x32_bf16 a[32:35], a[160:163], a[104:107], a[32:35]
ds_read_b64_tr_b16 a[148:149], v2 offset:27776
v_accvgpr_read_b32 v26, a24
v_accvgpr_read_b32 v27, a25
v_accvgpr_read_b32 v28, a26
v_mfma_f32_16x16x32_bf16 a[36:39], a[160:163], a[108:111], a[36:39]
ds_read_b64_tr_b16 a[150:151], v2 offset:30080
v_accvgpr_read_b32 v29, a27
v_accvgpr_read_b32 v36, a28
v_accvgpr_read_b32 v37, a29
v_mfma_f32_16x16x32_bf16 v[152:155], a[160:163], a[112:115], v[152:155]
v_accvgpr_read_b32 v38, a30
v_accvgpr_read_b32 v39, a31
s_waitcnt lgkmcnt(4)
v_fma_f32 v120, v18, v32, v120
v_fma_f32 v121, v19, v32, v121
v_mfma_f32_16x16x32_bf16 v[156:159], a[160:163], a[116:119], v[156:159]
s_waitcnt lgkmcnt(10)
v_fma_f32 v122, v20, v32, v122
v_fma_f32 v123, v21, v32, v123
v_fma_f32 v128, v22, v32, v128
v_mfma_f32_16x16x32_bf16 v[136:139], a[164:167], a[120:123], v[136:139]
ds_read_b64_tr_b16 a[152:153], v3 offset:160
v_fma_f32 v129, v23, v32, v129
v_fma_f32 v130, v24, v32, v130
v_fma_f32 v131, v25, v32, v131
v_mfma_f32_16x16x32_bf16 v[140:143], a[164:167], a[124:127], v[140:143]
ds_read_b64_tr_b16 a[154:155], v3 offset:2464
v_max_f32 v120, 0, v120
v_max_f32 v121, 0, v121
v_max_f32 v122, 0, v122
v_max_f32 v123, 0, v123
v_mfma_f32_16x16x32_bf16 v[144:147], a[164:167], a[128:131], v[144:147]
v_mul_f32 v120, v120, v128
v_mul_f32 v121, v121, v129
v_mul_f32 v122, v122, v130
v_mul_f32 v123, v123, v131
v_mfma_f32_16x16x32_bf16 v[148:151], a[164:167], a[132:135], v[148:151]
v_cvt_pk_bf16_f32 v98, v120, v121
v_cvt_pk_bf16_f32 v99, v122, v123
buffer_store_dwordx4 v[96:99], v34, s[16:19], s52 offen offset:2048 sc1
v_fma_f32 v124, v18, v33, v124
v_mfma_f32_16x16x32_bf16 a[32:35], a[168:171], a[120:123], a[32:35]
ds_read_b64_tr_b16 a[156:157], v3 offset:18592
v_fma_f32 v125, v19, v33, v125
v_fma_f32 v126, v20, v33, v126
v_fma_f32 v127, v21, v33, v127
v_mfma_f32_16x16x32_bf16 a[36:39], a[168:171], a[124:127], a[36:39]
ds_read_b64_tr_b16 a[158:159], v3 offset:20896
v_fma_f32 v132, v22, v33, v132
v_fma_f32 v133, v23, v33, v133
v_fma_f32 v134, v24, v33, v134
v_mfma_f32_16x16x32_bf16 v[152:155], a[168:171], a[128:131], v[152:155]
v_fma_f32 v135, v25, v33, v135
v_max_f32 v124, 0, v124
v_max_f32 v125, 0, v125
v_max_f32 v126, 0, v126
v_max_f32 v127, 0, v127
v_mfma_f32_16x16x32_bf16 v[156:159], a[168:171], a[132:135], v[156:159]
s_waitcnt lgkmcnt(9)
v_mul_f32 v124, v124, v132
v_mul_f32 v125, v125, v133
v_mul_f32 v126, v126, v134
v_mfma_f32_16x16x32_bf16 v[136:139], a[136:139], a[72:75], v[136:139]
ds_read_b64_tr_b16 a[160:161], v3 offset:9376
v_mul_f32 v127, v127, v135
v_cvt_pk_bf16_f32 v102, v124, v125
v_cvt_pk_bf16_f32 v103, v126, v127
v_mfma_f32_16x16x32_bf16 v[140:143], a[136:139], a[76:79], v[140:143]
ds_read_b64_tr_b16 a[162:163], v3 offset:11680
buffer_store_dwordx4 v[100:103], v34, s[16:19], s52 offen offset:3072 sc1
v_fma_f32 v112, v18, v30, v112
v_fma_f32 v113, v19, v30, v113
v_mfma_f32_16x16x32_bf16 v[144:147], a[136:139], a[80:83], v[144:147]
v_fma_f32 v114, v20, v30, v114
v_fma_f32 v115, v21, v30, v115
v_fma_f32 v26, v22, v30, v26
v_fma_f32 v27, v23, v30, v27
v_mfma_f32_16x16x32_bf16 v[148:151], a[136:139], a[84:87], v[148:151]
v_fma_f32 v28, v24, v30, v28
v_fma_f32 v29, v25, v30, v29
v_max_f32 v112, 0, v112
v_max_f32 v113, 0, v113
v_max_f32 v114, 0, v114
v_mfma_f32_16x16x32_bf16 a[32:35], a[140:143], a[72:75], a[32:35]
ds_read_b64_tr_b16 a[164:165], v3 offset:27808
v_max_f32 v115, 0, v115
v_mul_f32 v112, v112, v26
v_mul_f32 v113, v113, v27
v_mfma_f32_16x16x32_bf16 a[36:39], a[140:143], a[76:79], a[36:39]
ds_read_b64_tr_b16 a[166:167], v3 offset:30112
v_mul_f32 v114, v114, v28
v_mul_f32 v115, v115, v29
v_cvt_pk_bf16_f32 v90, v112, v113
v_mfma_f32_16x16x32_bf16 v[152:155], a[140:143], a[80:83], v[152:155]
v_cvt_pk_bf16_f32 v91, v114, v115
buffer_store_dwordx4 v[88:91], v34, s[16:19], s52 offen offset:0 sc1
v_fma_f32 v116, v18, v31, v116
v_fma_f32 v117, v19, v31, v117
v_mfma_f32_16x16x32_bf16 v[156:159], a[140:143], a[84:87], v[156:159]
s_waitcnt lgkmcnt(8)
v_fma_f32 v118, v20, v31, v118
v_fma_f32 v119, v21, v31, v119
v_fma_f32 v36, v22, v31, v36
v_mfma_f32_16x16x32_bf16 v[136:139], a[144:147], a[172:175], v[136:139]
ds_read_b64_tr_b16 a[168:169], v2 offset:160
v_fma_f32 v37, v23, v31, v37
v_fma_f32 v38, v24, v31, v38
v_fma_f32 v39, v25, v31, v39
v_mfma_f32_16x16x32_bf16 v[140:143], a[144:147], a[176:179], v[140:143]
ds_read_b64_tr_b16 a[170:171], v2 offset:2464
v_max_f32 v116, 0, v116
v_max_f32 v117, 0, v117
v_max_f32 v118, 0, v118
v_max_f32 v119, 0, v119
v_mfma_f32_16x16x32_bf16 v[144:147], a[144:147], a[180:183], v[144:147]
v_mul_f32 v116, v116, v36
v_mul_f32 v117, v117, v37
v_mul_f32 v118, v118, v38
v_mul_f32 v119, v119, v39
v_mfma_f32_16x16x32_bf16 v[148:151], a[144:147], a[184:187], v[148:151]
v_cvt_pk_bf16_f32 v94, v116, v117
v_cvt_pk_bf16_f32 v95, v118, v119
buffer_store_dwordx4 v[92:95], v34, s[16:19], s52 offen offset:1024 sc1
s_add_u32 s52, s52, 131072
v_mfma_f32_16x16x32_bf16 a[32:35], a[148:151], a[172:175], a[32:35]
ds_read_b64_tr_b16 a[136:137], v2 offset:18592
ds_read_b128 v[6:9], v35 offset:256
v_mfma_f32_16x16x32_bf16 a[36:39], a[148:151], a[176:179], a[36:39]
ds_read_b64_tr_b16 a[138:139], v2 offset:20896
ds_read_b128 v[10:13], v35 offset:832
v_mfma_f32_16x16x32_bf16 v[152:155], a[148:151], a[180:183], v[152:155]
v_mfma_f32_16x16x32_bf16 v[156:159], a[148:151], a[184:187], v[156:159]
s_waitcnt lgkmcnt(10)
v_mfma_f32_16x16x32_bf16 v[160:163], a[152:155], a[104:107], v[160:163]
ds_read_b64_tr_b16 a[140:141], v2 offset:9376
v_mfma_f32_16x16x32_bf16 v[164:167], a[152:155], a[108:111], v[164:167]
ds_read_b64_tr_b16 a[142:143], v2 offset:11680
v_mfma_f32_16x16x32_bf16 v[168:171], a[152:155], a[112:115], v[168:171]
v_mfma_f32_16x16x32_bf16 v[172:175], a[152:155], a[116:119], v[172:175]
v_mfma_f32_16x16x32_bf16 a[40:43], a[156:159], a[104:107], a[40:43]
ds_read_b64_tr_b16 a[144:145], v2 offset:27808
v_accvgpr_read_b32 v26, a32
v_accvgpr_read_b32 v27, a33
v_accvgpr_read_b32 v28, a34
v_mfma_f32_16x16x32_bf16 a[44:47], a[156:159], a[108:111], a[44:47]
ds_read_b64_tr_b16 a[146:147], v2 offset:30112
v_accvgpr_read_b32 v29, a35
v_accvgpr_read_b32 v36, a36
v_accvgpr_read_b32 v37, a37
v_mfma_f32_16x16x32_bf16 v[176:179], a[156:159], a[112:115], v[176:179]
v_accvgpr_read_b32 v38, a38
v_accvgpr_read_b32 v39, a39
s_waitcnt lgkmcnt(4)
v_fma_f32 v144, v6, v32, v144
v_mfma_f32_16x16x32_bf16 v[180:183], a[156:159], a[116:119], v[180:183]
s_waitcnt lgkmcnt(10)
v_fma_f32 v145, v7, v32, v145
v_fma_f32 v146, v8, v32, v146
v_fma_f32 v147, v9, v32, v147
v_mfma_f32_16x16x32_bf16 v[160:163], a[160:163], a[120:123], v[160:163]
ds_read_b64_tr_b16 a[148:149], v3 offset:192
v_fma_f32 v152, v10, v32, v152
v_fma_f32 v153, v11, v32, v153
v_fma_f32 v154, v12, v32, v154
v_mfma_f32_16x16x32_bf16 v[164:167], a[160:163], a[124:127], v[164:167]
ds_read_b64_tr_b16 a[150:151], v3 offset:2496
v_fma_f32 v155, v13, v32, v155
v_max_f32 v144, 0, v144
v_max_f32 v145, 0, v145
v_mfma_f32_16x16x32_bf16 v[168:171], a[160:163], a[128:131], v[168:171]
v_max_f32 v146, 0, v146
v_max_f32 v147, 0, v147
v_mul_f32 v144, v144, v152
v_mul_f32 v145, v145, v153
v_mfma_f32_16x16x32_bf16 v[172:175], a[160:163], a[132:135], v[172:175]
v_mul_f32 v146, v146, v154
v_mul_f32 v147, v147, v155
v_cvt_pk_bf16_f32 v144, v144, v145
v_cvt_pk_bf16_f32 v145, v146, v147
v_mfma_f32_16x16x32_bf16 a[40:43], a[164:167], a[120:123], a[40:43]
ds_read_b64_tr_b16 a[152:153], v3 offset:18624
v_fma_f32 v148, v6, v33, v148
v_fma_f32 v149, v7, v33, v149
v_fma_f32 v150, v8, v33, v150
v_mfma_f32_16x16x32_bf16 a[44:47], a[164:167], a[124:127], a[44:47]
ds_read_b64_tr_b16 a[154:155], v3 offset:20928
v_fma_f32 v151, v9, v33, v151
v_fma_f32 v156, v10, v33, v156
v_fma_f32 v157, v11, v33, v157
v_mfma_f32_16x16x32_bf16 v[176:179], a[164:167], a[128:131], v[176:179]
v_fma_f32 v158, v12, v33, v158
v_fma_f32 v159, v13, v33, v159
v_max_f32 v148, 0, v148
v_max_f32 v149, 0, v149
v_mfma_f32_16x16x32_bf16 v[180:183], a[164:167], a[132:135], v[180:183]
s_waitcnt lgkmcnt(9)
v_max_f32 v150, 0, v150
v_max_f32 v151, 0, v151
v_mul_f32 v148, v148, v156
v_mfma_f32_16x16x32_bf16 v[160:163], a[168:171], a[72:75], v[160:163]
ds_read_b64_tr_b16 a[156:157], v3 offset:9408
v_mul_f32 v149, v149, v157
v_mul_f32 v150, v150, v158
v_mul_f32 v151, v151, v159
v_mfma_f32_16x16x32_bf16 v[164:167], a[168:171], a[76:79], v[164:167]
ds_read_b64_tr_b16 a[158:159], v3 offset:11712
v_cvt_pk_bf16_f32 v148, v148, v149
v_cvt_pk_bf16_f32 v149, v150, v151
v_fma_f32 v136, v6, v30, v136
v_mfma_f32_16x16x32_bf16 v[168:171], a[168:171], a[80:83], v[168:171]
v_fma_f32 v137, v7, v30, v137
v_fma_f32 v138, v8, v30, v138
v_fma_f32 v139, v9, v30, v139
v_fma_f32 v26, v10, v30, v26
v_mfma_f32_16x16x32_bf16 v[172:175], a[168:171], a[84:87], v[172:175]
v_fma_f32 v27, v11, v30, v27
v_fma_f32 v28, v12, v30, v28
v_fma_f32 v29, v13, v30, v29
v_max_f32 v136, 0, v136
v_mfma_f32_16x16x32_bf16 a[40:43], a[136:139], a[72:75], a[40:43]
ds_read_b64_tr_b16 a[160:161], v3 offset:27840
v_max_f32 v137, 0, v137
v_max_f32 v138, 0, v138
v_max_f32 v139, 0, v139
v_mfma_f32_16x16x32_bf16 a[44:47], a[136:139], a[76:79], a[44:47]
ds_read_b64_tr_b16 a[162:163], v3 offset:30144
v_mul_f32 v136, v136, v26
v_mul_f32 v137, v137, v27
v_mul_f32 v138, v138, v28
v_mfma_f32_16x16x32_bf16 v[176:179], a[136:139], a[80:83], v[176:179]
v_mul_f32 v139, v139, v29
v_cvt_pk_bf16_f32 v136, v136, v137
v_cvt_pk_bf16_f32 v137, v138, v139
v_fma_f32 v140, v6, v31, v140
v_mfma_f32_16x16x32_bf16 v[180:183], a[136:139], a[84:87], v[180:183]
s_waitcnt lgkmcnt(8)
v_fma_f32 v141, v7, v31, v141
v_fma_f32 v142, v8, v31, v142
v_fma_f32 v143, v9, v31, v143
v_mfma_f32_16x16x32_bf16 v[160:163], a[140:143], a[172:175], v[160:163]
ds_read_b64_tr_b16 a[164:165], v2 offset:192
v_fma_f32 v36, v10, v31, v36
v_fma_f32 v37, v11, v31, v37
v_fma_f32 v38, v12, v31, v38
v_mfma_f32_16x16x32_bf16 v[164:167], a[140:143], a[176:179], v[164:167]
ds_read_b64_tr_b16 a[166:167], v2 offset:2496
v_fma_f32 v39, v13, v31, v39
v_max_f32 v140, 0, v140
v_max_f32 v141, 0, v141
v_mfma_f32_16x16x32_bf16 v[168:171], a[140:143], a[180:183], v[168:171]
v_max_f32 v142, 0, v142
v_max_f32 v143, 0, v143
v_mul_f32 v140, v140, v36
v_mul_f32 v141, v141, v37
v_mfma_f32_16x16x32_bf16 v[172:175], a[140:143], a[184:187], v[172:175]
v_mul_f32 v142, v142, v38
v_mul_f32 v143, v143, v39
v_cvt_pk_bf16_f32 v140, v140, v141
v_cvt_pk_bf16_f32 v141, v142, v143
v_mfma_f32_16x16x32_bf16 a[40:43], a[144:147], a[172:175], a[40:43]
ds_read_b64_tr_b16 a[168:169], v2 offset:18624
ds_read_b128 v[18:21], v35 offset:320
v_mfma_f32_16x16x32_bf16 a[44:47], a[144:147], a[176:179], a[44:47]
ds_read_b64_tr_b16 a[170:171], v2 offset:20928
ds_read_b128 v[22:25], v35 offset:896
v_mfma_f32_16x16x32_bf16 v[176:179], a[144:147], a[180:183], v[176:179]
v_mfma_f32_16x16x32_bf16 v[180:183], a[144:147], a[184:187], v[180:183]
s_waitcnt lgkmcnt(10)
v_mfma_f32_16x16x32_bf16 v[184:187], a[148:151], a[104:107], v[184:187]
ds_read_b64_tr_b16 a[136:137], v2 offset:9408
v_mfma_f32_16x16x32_bf16 v[188:191], a[148:151], a[108:111], v[188:191]
ds_read_b64_tr_b16 a[138:139], v2 offset:11712
v_mfma_f32_16x16x32_bf16 v[192:195], a[148:151], a[112:115], v[192:195]
v_mfma_f32_16x16x32_bf16 v[196:199], a[148:151], a[116:119], v[196:199]
v_mfma_f32_16x16x32_bf16 a[48:51], a[152:155], a[104:107], a[48:51]
ds_read_b64_tr_b16 a[140:141], v2 offset:27840
v_accvgpr_read_b32 v26, a40
v_accvgpr_read_b32 v27, a41
v_accvgpr_read_b32 v28, a42
v_mfma_f32_16x16x32_bf16 a[52:55], a[152:155], a[108:111], a[52:55]
ds_read_b64_tr_b16 a[142:143], v2 offset:30144
v_accvgpr_read_b32 v29, a43
v_accvgpr_read_b32 v36, a44
v_accvgpr_read_b32 v37, a45
v_mfma_f32_16x16x32_bf16 v[200:203], a[152:155], a[112:115], v[200:203]
v_accvgpr_read_b32 v38, a46
v_accvgpr_read_b32 v39, a47
s_waitcnt lgkmcnt(4)
v_fma_f32 v168, v18, v32, v168
v_fma_f32 v169, v19, v32, v169
v_mfma_f32_16x16x32_bf16 v[204:207], a[152:155], a[116:119], v[204:207]
s_waitcnt lgkmcnt(10)
v_fma_f32 v170, v20, v32, v170
v_fma_f32 v171, v21, v32, v171
v_fma_f32 v176, v22, v32, v176
v_mfma_f32_16x16x32_bf16 v[184:187], a[156:159], a[120:123], v[184:187]
ds_read_b64_tr_b16 a[144:145], v3 offset:224
v_fma_f32 v177, v23, v32, v177
v_fma_f32 v178, v24, v32, v178
v_fma_f32 v179, v25, v32, v179
v_mfma_f32_16x16x32_bf16 v[188:191], a[156:159], a[124:127], v[188:191]
ds_read_b64_tr_b16 a[146:147], v3 offset:2528
v_max_f32 v168, 0, v168
v_max_f32 v169, 0, v169
v_max_f32 v170, 0, v170
v_max_f32 v171, 0, v171
v_mfma_f32_16x16x32_bf16 v[192:195], a[156:159], a[128:131], v[192:195]
v_mul_f32 v168, v168, v176
v_mul_f32 v169, v169, v177
v_mul_f32 v170, v170, v178
v_mul_f32 v171, v171, v179
v_mfma_f32_16x16x32_bf16 v[196:199], a[156:159], a[132:135], v[196:199]
v_cvt_pk_bf16_f32 v146, v168, v169
v_cvt_pk_bf16_f32 v147, v170, v171
buffer_store_dwordx4 v[144:147], v34, s[16:19], s52 offen offset:2048 sc1
v_fma_f32 v172, v18, v33, v172
v_mfma_f32_16x16x32_bf16 a[48:51], a[160:163], a[120:123], a[48:51]
ds_read_b64_tr_b16 a[148:149], v3 offset:18656
v_fma_f32 v173, v19, v33, v173
v_fma_f32 v174, v20, v33, v174
v_fma_f32 v175, v21, v33, v175
v_mfma_f32_16x16x32_bf16 a[52:55], a[160:163], a[124:127], a[52:55]
ds_read_b64_tr_b16 a[150:151], v3 offset:20960
v_fma_f32 v180, v22, v33, v180
v_fma_f32 v181, v23, v33, v181
v_fma_f32 v182, v24, v33, v182
v_mfma_f32_16x16x32_bf16 v[200:203], a[160:163], a[128:131], v[200:203]
v_fma_f32 v183, v25, v33, v183
v_max_f32 v172, 0, v172
v_max_f32 v173, 0, v173
v_max_f32 v174, 0, v174
v_max_f32 v175, 0, v175
v_mfma_f32_16x16x32_bf16 v[204:207], a[160:163], a[132:135], v[204:207]
s_waitcnt lgkmcnt(9)
v_mul_f32 v172, v172, v180
v_mul_f32 v173, v173, v181
v_mul_f32 v174, v174, v182
v_mfma_f32_16x16x32_bf16 v[184:187], a[164:167], a[72:75], v[184:187]
ds_read_b64_tr_b16 a[152:153], v3 offset:9440
v_mul_f32 v175, v175, v183
v_cvt_pk_bf16_f32 v150, v172, v173
v_cvt_pk_bf16_f32 v151, v174, v175
v_mfma_f32_16x16x32_bf16 v[188:191], a[164:167], a[76:79], v[188:191]
ds_read_b64_tr_b16 a[154:155], v3 offset:11744
buffer_store_dwordx4 v[148:151], v34, s[16:19], s52 offen offset:3072 sc1
v_fma_f32 v160, v18, v30, v160
v_fma_f32 v161, v19, v30, v161
v_mfma_f32_16x16x32_bf16 v[192:195], a[164:167], a[80:83], v[192:195]
v_fma_f32 v162, v20, v30, v162
v_fma_f32 v163, v21, v30, v163
v_fma_f32 v26, v22, v30, v26
v_fma_f32 v27, v23, v30, v27
v_mfma_f32_16x16x32_bf16 v[196:199], a[164:167], a[84:87], v[196:199]
v_fma_f32 v28, v24, v30, v28
v_fma_f32 v29, v25, v30, v29
v_max_f32 v160, 0, v160
v_max_f32 v161, 0, v161
v_max_f32 v162, 0, v162
v_mfma_f32_16x16x32_bf16 a[48:51], a[168:171], a[72:75], a[48:51]
ds_read_b64_tr_b16 a[156:157], v3 offset:27872
v_max_f32 v163, 0, v163
v_mul_f32 v160, v160, v26
v_mul_f32 v161, v161, v27
v_mfma_f32_16x16x32_bf16 a[52:55], a[168:171], a[76:79], a[52:55]
ds_read_b64_tr_b16 a[158:159], v3 offset:30176
v_mul_f32 v162, v162, v28
v_mul_f32 v163, v163, v29
v_cvt_pk_bf16_f32 v138, v160, v161
v_mfma_f32_16x16x32_bf16 v[200:203], a[168:171], a[80:83], v[200:203]
v_cvt_pk_bf16_f32 v139, v162, v163
buffer_store_dwordx4 v[136:139], v34, s[16:19], s52 offen offset:0 sc1
v_fma_f32 v164, v18, v31, v164
v_fma_f32 v165, v19, v31, v165
v_mfma_f32_16x16x32_bf16 v[204:207], a[168:171], a[84:87], v[204:207]
s_waitcnt lgkmcnt(8)
v_fma_f32 v166, v20, v31, v166
v_fma_f32 v167, v21, v31, v167
v_fma_f32 v36, v22, v31, v36
v_mfma_f32_16x16x32_bf16 v[184:187], a[136:139], a[172:175], v[184:187]
ds_read_b64_tr_b16 a[160:161], v2 offset:224
v_fma_f32 v37, v23, v31, v37
v_fma_f32 v38, v24, v31, v38
v_fma_f32 v39, v25, v31, v39
v_mfma_f32_16x16x32_bf16 v[188:191], a[136:139], a[176:179], v[188:191]
ds_read_b64_tr_b16 a[162:163], v2 offset:2528
v_max_f32 v164, 0, v164
v_max_f32 v165, 0, v165
v_max_f32 v166, 0, v166
v_max_f32 v167, 0, v167
v_mfma_f32_16x16x32_bf16 v[192:195], a[136:139], a[180:183], v[192:195]
v_mul_f32 v164, v164, v36
v_mul_f32 v165, v165, v37
v_mul_f32 v166, v166, v38
v_mul_f32 v167, v167, v39
v_mfma_f32_16x16x32_bf16 v[196:199], a[136:139], a[184:187], v[196:199]
v_cvt_pk_bf16_f32 v142, v164, v165
v_cvt_pk_bf16_f32 v143, v166, v167
buffer_store_dwordx4 v[140:143], v34, s[16:19], s52 offen offset:1024 sc1
s_add_u32 s52, s52, 131072
v_mfma_f32_16x16x32_bf16 a[48:51], a[140:143], a[172:175], a[48:51]
ds_read_b64_tr_b16 a[164:165], v2 offset:18656
ds_read_b128 v[6:9], v35 offset:384
v_mfma_f32_16x16x32_bf16 a[52:55], a[140:143], a[176:179], a[52:55]
ds_read_b64_tr_b16 a[166:167], v2 offset:20960
ds_read_b128 v[10:13], v35 offset:960
v_mfma_f32_16x16x32_bf16 v[200:203], a[140:143], a[180:183], v[200:203]
v_mfma_f32_16x16x32_bf16 v[204:207], a[140:143], a[184:187], v[204:207]
s_waitcnt lgkmcnt(10)
v_mfma_f32_16x16x32_bf16 v[208:211], a[144:147], a[104:107], v[208:211]
ds_read_b64_tr_b16 a[168:169], v2 offset:9440
v_mfma_f32_16x16x32_bf16 v[212:215], a[144:147], a[108:111], v[212:215]
ds_read_b64_tr_b16 a[170:171], v2 offset:11744
v_mfma_f32_16x16x32_bf16 v[216:219], a[144:147], a[112:115], v[216:219]
v_mfma_f32_16x16x32_bf16 v[220:223], a[144:147], a[116:119], v[220:223]
v_mfma_f32_16x16x32_bf16 a[56:59], a[148:151], a[104:107], a[56:59]
ds_read_b64_tr_b16 a[136:137], v2 offset:27872
v_accvgpr_read_b32 v26, a48
v_accvgpr_read_b32 v27, a49
v_accvgpr_read_b32 v28, a50
v_mfma_f32_16x16x32_bf16 a[60:63], a[148:151], a[108:111], a[60:63]
ds_read_b64_tr_b16 a[138:139], v2 offset:30176
v_accvgpr_read_b32 v29, a51
v_accvgpr_read_b32 v36, a52
v_accvgpr_read_b32 v37, a53
v_mfma_f32_16x16x32_bf16 v[224:227], a[148:151], a[112:115], v[224:227]
v_accvgpr_read_b32 v38, a54
v_accvgpr_read_b32 v39, a55
s_waitcnt lgkmcnt(4)
v_fma_f32 v192, v6, v32, v192
v_mfma_f32_16x16x32_bf16 v[228:231], a[148:151], a[116:119], v[228:231]
s_waitcnt lgkmcnt(10)
v_fma_f32 v193, v7, v32, v193
v_fma_f32 v194, v8, v32, v194
v_fma_f32 v195, v9, v32, v195
v_mfma_f32_16x16x32_bf16 v[208:211], a[152:155], a[120:123], v[208:211]
ds_read_b64_tr_b16 a[140:141], v3 offset:256
v_fma_f32 v200, v10, v32, v200
v_fma_f32 v201, v11, v32, v201
v_fma_f32 v202, v12, v32, v202
v_mfma_f32_16x16x32_bf16 v[212:215], a[152:155], a[124:127], v[212:215]
ds_read_b64_tr_b16 a[142:143], v3 offset:2560
v_fma_f32 v203, v13, v32, v203
v_max_f32 v192, 0, v192
v_max_f32 v193, 0, v193
v_mfma_f32_16x16x32_bf16 v[216:219], a[152:155], a[128:131], v[216:219]
v_max_f32 v194, 0, v194
v_max_f32 v195, 0, v195
v_mul_f32 v192, v192, v200
v_mul_f32 v193, v193, v201
v_mfma_f32_16x16x32_bf16 v[220:223], a[152:155], a[132:135], v[220:223]
v_mul_f32 v194, v194, v202
v_mul_f32 v195, v195, v203
v_cvt_pk_bf16_f32 v192, v192, v193
v_cvt_pk_bf16_f32 v193, v194, v195
v_mfma_f32_16x16x32_bf16 a[56:59], a[156:159], a[120:123], a[56:59]
ds_read_b64_tr_b16 a[144:145], v3 offset:18688
v_fma_f32 v196, v6, v33, v196
v_fma_f32 v197, v7, v33, v197
v_fma_f32 v198, v8, v33, v198
v_mfma_f32_16x16x32_bf16 a[60:63], a[156:159], a[124:127], a[60:63]
ds_read_b64_tr_b16 a[146:147], v3 offset:20992
v_fma_f32 v199, v9, v33, v199
v_fma_f32 v204, v10, v33, v204
v_fma_f32 v205, v11, v33, v205
v_mfma_f32_16x16x32_bf16 v[224:227], a[156:159], a[128:131], v[224:227]
v_fma_f32 v206, v12, v33, v206
v_fma_f32 v207, v13, v33, v207
v_max_f32 v196, 0, v196
v_max_f32 v197, 0, v197
v_mfma_f32_16x16x32_bf16 v[228:231], a[156:159], a[132:135], v[228:231]
s_waitcnt lgkmcnt(9)
v_max_f32 v198, 0, v198
v_max_f32 v199, 0, v199
v_mul_f32 v196, v196, v204
v_mfma_f32_16x16x32_bf16 v[208:211], a[160:163], a[72:75], v[208:211]
ds_read_b64_tr_b16 a[148:149], v3 offset:9472
v_mul_f32 v197, v197, v205
v_mul_f32 v198, v198, v206
v_mul_f32 v199, v199, v207
v_mfma_f32_16x16x32_bf16 v[212:215], a[160:163], a[76:79], v[212:215]
ds_read_b64_tr_b16 a[150:151], v3 offset:11776
v_cvt_pk_bf16_f32 v196, v196, v197
v_cvt_pk_bf16_f32 v197, v198, v199
v_fma_f32 v184, v6, v30, v184
v_mfma_f32_16x16x32_bf16 v[216:219], a[160:163], a[80:83], v[216:219]
v_fma_f32 v185, v7, v30, v185
v_fma_f32 v186, v8, v30, v186
v_fma_f32 v187, v9, v30, v187
v_fma_f32 v26, v10, v30, v26
v_mfma_f32_16x16x32_bf16 v[220:223], a[160:163], a[84:87], v[220:223]
v_fma_f32 v27, v11, v30, v27
v_fma_f32 v28, v12, v30, v28
v_fma_f32 v29, v13, v30, v29
v_max_f32 v184, 0, v184
v_mfma_f32_16x16x32_bf16 a[56:59], a[164:167], a[72:75], a[56:59]
ds_read_b64_tr_b16 a[152:153], v3 offset:27904
v_max_f32 v185, 0, v185
v_max_f32 v186, 0, v186
v_max_f32 v187, 0, v187
v_mfma_f32_16x16x32_bf16 a[60:63], a[164:167], a[76:79], a[60:63]
tp2_p5:
s_cbranch_execz tp2_ret
tf_p10:
s_cbranch_execz k12_kernel_end
ds_read_b64_tr_b16 a[154:155], v3 offset:30208
v_mul_f32 v184, v184, v26
v_mul_f32 v185, v185, v27
v_mul_f32 v186, v186, v28
v_mfma_f32_16x16x32_bf16 v[224:227], a[164:167], a[80:83], v[224:227]
v_mul_f32 v187, v187, v29
v_cvt_pk_bf16_f32 v184, v184, v185
v_cvt_pk_bf16_f32 v185, v186, v187
v_fma_f32 v188, v6, v31, v188
v_mfma_f32_16x16x32_bf16 v[228:231], a[164:167], a[84:87], v[228:231]
s_waitcnt lgkmcnt(8)
v_fma_f32 v189, v7, v31, v189
v_fma_f32 v190, v8, v31, v190
v_fma_f32 v191, v9, v31, v191
v_mfma_f32_16x16x32_bf16 v[208:211], a[168:171], a[172:175], v[208:211]
ds_read_b64_tr_b16 a[156:157], v2 offset:256
v_fma_f32 v36, v10, v31, v36
v_fma_f32 v37, v11, v31, v37
v_fma_f32 v38, v12, v31, v38
v_mfma_f32_16x16x32_bf16 v[212:215], a[168:171], a[176:179], v[212:215]
ds_read_b64_tr_b16 a[158:159], v2 offset:2560
v_fma_f32 v39, v13, v31, v39
v_max_f32 v188, 0, v188
v_max_f32 v189, 0, v189
v_mfma_f32_16x16x32_bf16 v[216:219], a[168:171], a[180:183], v[216:219]
v_max_f32 v190, 0, v190
v_max_f32 v191, 0, v191
v_mul_f32 v188, v188, v36
v_mul_f32 v189, v189, v37
v_mfma_f32_16x16x32_bf16 v[220:223], a[168:171], a[184:187], v[220:223]
v_mul_f32 v190, v190, v38
v_mul_f32 v191, v191, v39
v_cvt_pk_bf16_f32 v188, v188, v189
v_cvt_pk_bf16_f32 v189, v190, v191
v_mfma_f32_16x16x32_bf16 a[56:59], a[136:139], a[172:175], a[56:59]
ds_read_b64_tr_b16 a[160:161], v2 offset:18688
ds_read_b128 v[18:21], v35 offset:448
v_mfma_f32_16x16x32_bf16 a[60:63], a[136:139], a[176:179], a[60:63]
ds_read_b64_tr_b16 a[162:163], v2 offset:20992
ds_read_b128 v[22:25], v35 offset:1024
v_mfma_f32_16x16x32_bf16 v[224:227], a[136:139], a[180:183], v[224:227]
v_mfma_f32_16x16x32_bf16 v[228:231], a[136:139], a[184:187], v[228:231]
s_waitcnt lgkmcnt(10)
v_mfma_f32_16x16x32_bf16 v[232:235], a[140:143], a[104:107], v[232:235]
ds_read_b64_tr_b16 a[164:165], v2 offset:9472
v_mfma_f32_16x16x32_bf16 v[236:239], a[140:143], a[108:111], v[236:239]
ds_read_b64_tr_b16 a[166:167], v2 offset:11776
v_mfma_f32_16x16x32_bf16 v[240:243], a[140:143], a[112:115], v[240:243]
v_mfma_f32_16x16x32_bf16 v[244:247], a[140:143], a[116:119], v[244:247]
v_mfma_f32_16x16x32_bf16 a[64:67], a[144:147], a[104:107], a[64:67]
ds_read_b64_tr_b16 a[168:169], v2 offset:27904
v_accvgpr_read_b32 v26, a56
v_accvgpr_read_b32 v27, a57
v_accvgpr_read_b32 v28, a58
v_mfma_f32_16x16x32_bf16 a[68:71], a[144:147], a[108:111], a[68:71]
ds_read_b64_tr_b16 a[170:171], v2 offset:30208
v_accvgpr_read_b32 v29, a59
v_accvgpr_read_b32 v36, a60
v_accvgpr_read_b32 v37, a61
v_mfma_f32_16x16x32_bf16 v[248:251], a[144:147], a[112:115], v[248:251]
v_accvgpr_read_b32 v38, a62
v_accvgpr_read_b32 v39, a63
s_waitcnt lgkmcnt(4)
v_fma_f32 v216, v18, v32, v216
v_mfma_f32_16x16x32_bf16 v[252:255], a[144:147], a[116:119], v[252:255]
s_waitcnt lgkmcnt(10)
v_fma_f32 v217, v19, v32, v217
v_fma_f32 v218, v20, v32, v218
v_fma_f32 v219, v21, v32, v219
v_mfma_f32_16x16x32_bf16 v[232:235], a[148:151], a[120:123], v[232:235]
v_fma_f32 v224, v22, v32, v224
v_fma_f32 v225, v23, v32, v225
v_fma_f32 v226, v24, v32, v226
v_fma_f32 v227, v25, v32, v227
v_mfma_f32_16x16x32_bf16 v[236:239], a[148:151], a[124:127], v[236:239]
v_max_f32 v216, 0, v216
v_max_f32 v217, 0, v217
v_max_f32 v218, 0, v218
v_max_f32 v219, 0, v219
v_mfma_f32_16x16x32_bf16 v[240:243], a[148:151], a[128:131], v[240:243]
v_mul_f32 v216, v216, v224
v_mul_f32 v217, v217, v225
v_mul_f32 v218, v218, v226
v_mul_f32 v219, v219, v227
v_mfma_f32_16x16x32_bf16 v[244:247], a[148:151], a[132:135], v[244:247]
v_cvt_pk_bf16_f32 v194, v216, v217
v_cvt_pk_bf16_f32 v195, v218, v219
buffer_store_dwordx4 v[192:195], v34, s[16:19], s52 offen offset:2048 sc1
v_mfma_f32_16x16x32_bf16 a[64:67], a[152:155], a[120:123], a[64:67]
v_fma_f32 v220, v18, v33, v220
v_fma_f32 v221, v19, v33, v221
v_fma_f32 v222, v20, v33, v222
v_fma_f32 v223, v21, v33, v223
v_mfma_f32_16x16x32_bf16 a[68:71], a[152:155], a[124:127], a[68:71]
v_fma_f32 v228, v22, v33, v228
v_fma_f32 v229, v23, v33, v229
v_fma_f32 v230, v24, v33, v230
v_fma_f32 v231, v25, v33, v231
v_mfma_f32_16x16x32_bf16 v[248:251], a[152:155], a[128:131], v[248:251]
v_max_f32 v220, 0, v220
v_max_f32 v221, 0, v221
v_max_f32 v222, 0, v222
v_max_f32 v223, 0, v223
v_mfma_f32_16x16x32_bf16 v[252:255], a[152:155], a[132:135], v[252:255]
s_waitcnt lgkmcnt(5)
v_mul_f32 v220, v220, v228
v_mul_f32 v221, v221, v229
v_mul_f32 v222, v222, v230
v_mfma_f32_16x16x32_bf16 v[232:235], a[156:159], a[72:75], v[232:235]
v_mul_f32 v223, v223, v231
v_cvt_pk_bf16_f32 v198, v220, v221
v_cvt_pk_bf16_f32 v199, v222, v223
v_mfma_f32_16x16x32_bf16 v[236:239], a[156:159], a[76:79], v[236:239]
buffer_store_dwordx4 v[196:199], v34, s[16:19], s52 offen offset:3072 sc1
v_fma_f32 v208, v18, v30, v208
v_fma_f32 v209, v19, v30, v209
v_mfma_f32_16x16x32_bf16 v[240:243], a[156:159], a[80:83], v[240:243]
v_fma_f32 v210, v20, v30, v210
v_fma_f32 v211, v21, v30, v211
v_fma_f32 v26, v22, v30, v26
v_fma_f32 v27, v23, v30, v27
v_mfma_f32_16x16x32_bf16 v[244:247], a[156:159], a[84:87], v[244:247]
v_fma_f32 v28, v24, v30, v28
v_fma_f32 v29, v25, v30, v29
v_max_f32 v208, 0, v208
v_max_f32 v209, 0, v209
v_mfma_f32_16x16x32_bf16 a[64:67], a[160:163], a[72:75], a[64:67]
v_max_f32 v210, 0, v210
v_max_f32 v211, 0, v211
v_mul_f32 v208, v208, v26
v_mul_f32 v209, v209, v27
v_mfma_f32_16x16x32_bf16 a[68:71], a[160:163], a[76:79], a[68:71]
v_mul_f32 v210, v210, v28
v_mul_f32 v211, v211, v29
v_cvt_pk_bf16_f32 v186, v208, v209
v_cvt_pk_bf16_f32 v187, v210, v211
v_mfma_f32_16x16x32_bf16 v[248:251], a[160:163], a[80:83], v[248:251]
buffer_store_dwordx4 v[184:187], v34, s[16:19], s52 offen offset:0 sc1
v_fma_f32 v212, v18, v31, v212
v_fma_f32 v213, v19, v31, v213
v_mfma_f32_16x16x32_bf16 v[252:255], a[160:163], a[84:87], v[252:255]
s_waitcnt lgkmcnt(0)
v_fma_f32 v214, v20, v31, v214
v_fma_f32 v215, v21, v31, v215
v_fma_f32 v36, v22, v31, v36
v_mfma_f32_16x16x32_bf16 v[232:235], a[164:167], a[172:175], v[232:235]
v_fma_f32 v37, v23, v31, v37
v_fma_f32 v38, v24, v31, v38
v_fma_f32 v39, v25, v31, v39
v_max_f32 v212, 0, v212
v_mfma_f32_16x16x32_bf16 v[236:239], a[164:167], a[176:179], v[236:239]
v_max_f32 v213, 0, v213
v_max_f32 v214, 0, v214
v_max_f32 v215, 0, v215
v_mul_f32 v212, v212, v36
v_mfma_f32_16x16x32_bf16 v[240:243], a[164:167], a[180:183], v[240:243]
v_mul_f32 v213, v213, v37
v_mul_f32 v214, v214, v38
v_mul_f32 v215, v215, v39
v_cvt_pk_bf16_f32 v190, v212, v213
v_mfma_f32_16x16x32_bf16 v[244:247], a[164:167], a[184:187], v[244:247]
v_cvt_pk_bf16_f32 v191, v214, v215
buffer_store_dwordx4 v[188:191], v34, s[16:19], s52 offen offset:1024 sc1
s_add_u32 s52, s52, 131072
v_mfma_f32_16x16x32_bf16 a[64:67], a[168:171], a[172:175], a[64:67]
ds_read_b128 v[6:9], v35 offset:512
ds_read_b128 v[10:13], v35 offset:1088
v_mfma_f32_16x16x32_bf16 a[68:71], a[168:171], a[176:179], a[68:71]
v_mfma_f32_16x16x32_bf16 v[248:251], a[168:171], a[180:183], v[248:251]
v_mfma_f32_16x16x32_bf16 v[252:255], a[168:171], a[184:187], v[252:255]
s_nop 7
v_accvgpr_read_b32 v26, a64
v_accvgpr_read_b32 v27, a65
v_accvgpr_read_b32 v28, a66
v_accvgpr_read_b32 v29, a67
v_accvgpr_read_b32 v36, a68
v_accvgpr_read_b32 v37, a69
v_accvgpr_read_b32 v38, a70
v_accvgpr_read_b32 v39, a71
s_waitcnt lgkmcnt(0)
v_pk_fma_f32 v[240:241], v[6:7], v[32:33], v[240:241] op_sel:[0,0,0] op_sel_hi:[1,0,1]
v_pk_fma_f32 v[248:249], v[10:11], v[32:33], v[248:249] op_sel:[0,0,0] op_sel_hi:[1,0,1]
v_pk_fma_f32 v[242:243], v[8:9], v[32:33], v[242:243] op_sel:[0,0,0] op_sel_hi:[1,0,1]
v_pk_fma_f32 v[250:251], v[12:13], v[32:33], v[250:251] op_sel:[0,0,0] op_sel_hi:[1,0,1]
v_max_f32 v240, 0, v240
v_max_f32 v241, 0, v241
v_max_f32 v242, 0, v242
v_max_f32 v243, 0, v243
v_pk_mul_f32 v[240:241], v[240:241], v[248:249]
v_pk_mul_f32 v[242:243], v[242:243], v[250:251]
v_cvt_pk_bf16_f32 v240, v240, v241
v_cvt_pk_bf16_f32 v241, v242, v243
buffer_store_dwordx2 v[240:241], v34, s[16:19], s54 offen offset:2048 sc1
v_pk_fma_f32 v[244:245], v[6:7], v[32:33], v[244:245] op_sel:[0,1,0] op_sel_hi:[1,1,1]
v_pk_fma_f32 v[252:253], v[10:11], v[32:33], v[252:253] op_sel:[0,1,0] op_sel_hi:[1,1,1]
v_pk_fma_f32 v[246:247], v[8:9], v[32:33], v[246:247] op_sel:[0,1,0] op_sel_hi:[1,1,1]
v_pk_fma_f32 v[254:255], v[12:13], v[32:33], v[254:255] op_sel:[0,1,0] op_sel_hi:[1,1,1]
v_max_f32 v244, 0, v244
v_max_f32 v245, 0, v245
v_max_f32 v246, 0, v246
v_max_f32 v247, 0, v247
v_pk_mul_f32 v[244:245], v[244:245], v[252:253]
v_pk_mul_f32 v[246:247], v[246:247], v[254:255]
v_cvt_pk_bf16_f32 v244, v244, v245
v_cvt_pk_bf16_f32 v245, v246, v247
buffer_store_dwordx2 v[244:245], v34, s[16:19], s54 offen offset:3072 sc1
v_pk_fma_f32 v[232:233], v[6:7], v[30:31], v[232:233] op_sel:[0,0,0] op_sel_hi:[1,0,1]
v_pk_fma_f32 v[26:27], v[10:11], v[30:31], v[26:27] op_sel:[0,0,0] op_sel_hi:[1,0,1]
v_pk_fma_f32 v[234:235], v[8:9], v[30:31], v[234:235] op_sel:[0,0,0] op_sel_hi:[1,0,1]
v_pk_fma_f32 v[28:29], v[12:13], v[30:31], v[28:29] op_sel:[0,0,0] op_sel_hi:[1,0,1]
v_max_f32 v232, 0, v232
v_max_f32 v233, 0, v233
v_max_f32 v234, 0, v234
v_max_f32 v235, 0, v235
v_pk_mul_f32 v[232:233], v[232:233], v[26:27]
v_pk_mul_f32 v[234:235], v[234:235], v[28:29]
v_cvt_pk_bf16_f32 v232, v232, v233
v_cvt_pk_bf16_f32 v233, v234, v235
buffer_store_dwordx2 v[232:233], v34, s[16:19], s54 offen offset:0 sc1
v_pk_fma_f32 v[236:237], v[6:7], v[30:31], v[236:237] op_sel:[0,1,0] op_sel_hi:[1,1,1]
v_pk_fma_f32 v[36:37], v[10:11], v[30:31], v[36:37] op_sel:[0,1,0] op_sel_hi:[1,1,1]
v_pk_fma_f32 v[238:239], v[8:9], v[30:31], v[238:239] op_sel:[0,1,0] op_sel_hi:[1,1,1]
v_pk_fma_f32 v[38:39], v[12:13], v[30:31], v[38:39] op_sel:[0,1,0] op_sel_hi:[1,1,1]
v_max_f32 v236, 0, v236
v_max_f32 v237, 0, v237
v_max_f32 v238, 0, v238
v_max_f32 v239, 0, v239
v_pk_mul_f32 v[236:237], v[236:237], v[36:37]
v_pk_mul_f32 v[238:239], v[238:239], v[38:39]
v_cvt_pk_bf16_f32 v236, v236, v237
v_cvt_pk_bf16_f32 v237, v238, v239
buffer_store_dwordx2 v[236:237], v34, s[16:19], s54 offen offset:1024 sc1
s_waitcnt vmcnt(0)
k4_kernel_end:
s_endpgm

.fill 384, 4, 0xbf800000
.globl sequential_preLN__compressed_kv_cla__glu_gated_reglu__prompt_kernel
.p2align 8
.type sequential_preLN__compressed_kv_cla__glu_gated_reglu__prompt_kernel,@function
sequential_preLN__compressed_kv_cla__glu_gated_reglu__prompt_kernel:
tf_p11:
s_cbranch_execz k12_kernel_end
s_cmp_ge_u32 s2, 256
s_cbranch_scc1 sequential_preLN__compressed_kv_cla__glu_gated_reglu__prompt_kernel_end
s_load_dwordx2 s[40:41], s[0:1], 72
s_load_dwordx2 s[48:49], s[0:1], 96
s_load_dwordx2 s[42:43], s[0:1], 80
v_and_b32 v1, 63, v0
v_lshrrev_b32 v3, 6, v0
s_and_b32 s50, s2, 7
s_lshr_b32 s51, s2, 3
v_readfirstlane_b32 s24, v3
s_mul_i32 s25, s50, 30
s_add_u32 s25, s25, s51
s_cmp_ge_u32 s51, 30
s_cbranch_scc1 sequential_preLN__compressed_kv_cla__glu_gated_reglu__prompt_kernel_spare1
s_cmp_ge_u32 s25, 234
s_cbranch_scc1 sequential_preLN__compressed_kv_cla__glu_gated_reglu__prompt_kernel_spare2
s_mul_i32 s26, s25, 7282
s_lshr_b32 s26, s26, 16
s_mul_i32 s50, s26, 9
s_sub_u32 s27, s25, s50
v_lshlrev_b32 v2, 4, v1
v_lshrrev_b32 v12, 3, v1
v_mul_u32_u24 v13, 1152, v12
v_bfe_u32 v14, v1, 1, 2
v_bfe_u32 v15, v1, 4, 2
v_xor_b32 v14, v14, v15
v_lshl_add_u32 v13, v14, 5, v13
v_and_b32 v14, 1, v1
v_lshl_add_u32 v13, v14, 4, v13
v_add_u32 v4, 0, v13
v_add_u32 v5, 8192, v13
v_add_u32 v6, 16384, v13
v_add_u32 v7, 24576, v13
s_lshl_b32 s28, s27, 7
s_mul_i32 s29, s26, 5120
s_mul_i32 s30, s24, 16384
s_mul_i32 s50, s24, 1327104
s_mul_i32 s51, s24, 4718592
s_add_u32 s51, s51, 58720256
v_add_u32 v3, 4096, v2
s_waitcnt lgkmcnt(0)
s_add_u32 s4, s40, s50
s_addc_u32 s5, s41, 0
s_mov_b32 s6, 1327104
s_mov_b32 s7, 0x20000
s_add_u32 s8, s48, s51
s_addc_u32 s9, s49, 0
s_mov_b32 s10, 4718592
s_mov_b32 s11, 0x20000
s_add_u32 m0, s30, 0
s_nop 0
buffer_load_dwordx4 v4, s[4:7], s28 offen offset:0 lds
buffer_load_dwordx4 v5, s[4:7], s28 offen offset:1024 lds
buffer_load_dwordx4 v6, s[4:7], s28 offen offset:2048 lds
buffer_load_dwordx4 v7, s[4:7], s28 offen offset:3072 lds
s_add_u32 s28, s28, 36864
buffer_load_dwordx4 a[0:3], v2, s[8:11], s29 offen offset:0
buffer_load_dwordx4 a[4:7], v2, s[8:11], s29 offen offset:1024
buffer_load_dwordx4 a[8:11], v2, s[8:11], s29 offen offset:2048
buffer_load_dwordx4 a[12:15], v2, s[8:11], s29 offen offset:3072
buffer_load_dwordx4 a[16:19], v3, s[8:11], s29 offen
s_add_u32 s29, s29, 131072
s_add_u32 m0, s30, 4096
s_nop 0
buffer_load_dwordx4 v4, s[4:7], s28 offen offset:0 lds
buffer_load_dwordx4 v5, s[4:7], s28 offen offset:1024 lds
buffer_load_dwordx4 v6, s[4:7], s28 offen offset:2048 lds
buffer_load_dwordx4 v7, s[4:7], s28 offen offset:3072 lds
s_add_u32 s28, s28, 36864
s_mov_b32 s3, s24
s_mov_b32 s98, 1
s_mov_b64 exec, 0
tp3_ret:
s_cmp_eq_u32 s98, 0
s_cbranch_scc1 tp3_done
s_sub_u32 s98, s98, 1
s_mov_b32 s99, s3
s_add_u32 s3, s3, 4
s_cmp_ge_u32 s3, 4
s_cselect_b32 s3, s24, s3
s_cmp_eq_u32 s99, 0
s_cbranch_scc1 tp3_p0
s_cmp_eq_u32 s99, 1
s_cbranch_scc1 tp3_p1
s_cmp_eq_u32 s99, 2
s_cbranch_scc1 tp3_p2
s_branch tp3_ret
tp3_done:
s_mov_b64 exec, -1
v_bfe_u32 v12, v1, 2, 2
v_bfe_u32 v13, v1, 4, 1
v_lshrrev_b32 v14, 5, v1
v_lshl_add_u32 v15, v13, 2, v12
v_lshl_add_u32 v15, v14, 3, v15
v_lshlrev_b32 v15, 7, v15
v_and_b32 v16, 3, v1
v_lshl_add_u32 v15, v16, 3, v15
v_add_u32 v15, s30, v15
v_lshrrev_b32 v12, 1, v12
v_lshl_add_u32 v12, v13, 1, v12
s_add_u32 s50, s24, 0
s_and_b32 s50, s50, 3
v_xor_b32 v16, s50, v12
v_lshl_add_u32 v8, v16, 5, v15
s_add_u32 s50, s24, 1
s_and_b32 s50, s50, 3
v_xor_b32 v16, s50, v12
v_lshl_add_u32 v9, v16, 5, v15
s_add_u32 s50, s24, 2
s_and_b32 s50, s50, 3
v_xor_b32 v16, s50, v12
v_lshl_add_u32 v10, v16, 5, v15
s_add_u32 s50, s24, 3
s_and_b32 s50, s50, 3
v_xor_b32 v16, s50, v12
v_lshl_add_u32 v11, v16, 5, v15
buffer_load_dwordx4 a[20:23], v2, s[8:11], s29 offen offset:0
buffer_load_dwordx4 a[24:27], v2, s[8:11], s29 offen offset:1024
buffer_load_dwordx4 a[28:31], v2, s[8:11], s29 offen offset:2048
buffer_load_dwordx4 a[32:35], v2, s[8:11], s29 offen offset:3072
buffer_load_dwordx4 a[36:39], v3, s[8:11], s29 offen
s_add_u32 s29, s29, 131072
s_add_u32 m0, s30, 8192
s_nop 0
buffer_load_dwordx4 v4, s[4:7], s28 offen offset:0 lds
buffer_load_dwordx4 v5, s[4:7], s28 offen offset:1024 lds
buffer_load_dwordx4 v6, s[4:7], s28 offen offset:2048 lds
buffer_load_dwordx4 v7, s[4:7], s28 offen offset:3072 lds
s_add_u32 s28, s28, 36864
v_add_u32 v48, s30, v2
s_sub_u32 s50, s24, 1
s_and_b32 s50, s50, 3
s_mul_i32 s50, s50, 16384
s_add_u32 s50, s50, 0
v_add_u32 v49, s50, v2
s_sub_u32 s50, s24, 2
s_and_b32 s50, s50, 3
s_mul_i32 s50, s50, 16384
s_add_u32 s50, s50, 5120
v_add_u32 v50, s50, v2
s_sub_u32 s50, s24, 3
s_and_b32 s50, s50, 3
s_mul_i32 s50, s50, 16384
s_add_u32 s50, s50, 10240
v_add_u32 v51, s50, v2
v_and_b32 v12, 15, v1
v_lshrrev_b32 v13, 4, v1
s_mul_i32 s50, s26, 80
v_add_u32 v14, s50, v12
v_mul_u32_u24 v15, 1152, v14
s_lshl_b32 s51, s27, 7
s_lshl_b32 s52, s24, 5
s_add_u32 s51, s51, s52
v_lshl_add_u32 v15, v13, 3, v15
v_add_u32 v15, s51, v15
v_and_b32 v16, 1, v13
v_lshlrev_b32 v16, 8, v16
v_lshl_add_u32 v16, v12, 4, v16
buffer_load_dwordx4 a[40:43], v2, s[8:11], s29 offen offset:0
buffer_load_dwordx4 a[44:47], v2, s[8:11], s29 offen offset:1024
buffer_load_dwordx4 a[48:51], v2, s[8:11], s29 offen offset:2048
buffer_load_dwordx4 a[52:55], v2, s[8:11], s29 offen offset:3072
buffer_load_dwordx4 a[56:59], v3, s[8:11], s29 offen
s_add_u32 s29, s29, 131072
s_add_u32 m0, s30, 12288
s_nop 0
buffer_load_dwordx4 v4, s[4:7], s28 offen offset:0 lds
buffer_load_dwordx4 v5, s[4:7], s28 offen offset:1024 lds
buffer_load_dwordx4 v6, s[4:7], s28 offen offset:2048 lds
buffer_load_dwordx4 v7, s[4:7], s28 offen offset:3072 lds
s_add_u32 s28, s28, 36864
v_lshrrev_b32 v17, 1, v13
v_lshl_add_u32 v16, v17, 3, v16
s_lshl_b32 s51, s27, 1
s_lshr_b32 s52, s24, 1
s_add_u32 s51, s51, s52
s_lshl_b32 s51, s51, 17
s_and_b32 s52, s24, 1
s_lshl_b32 s52, s52, 9
s_add_u32 s51, s51, s52
s_mul_i32 s52, s26, 5120
s_add_u32 s51, s51, s52
v_add_u32 v16, s51, v16
v_mov_b32 v52, v16
v_mov_b32 v47, v15
v_mov_b32 v54, v14
v_lshlrev_b32 v53, 2, v14
s_add_u32 s12, s48, 54525952
s_addc_u32 s13, s49, 0
s_mov_b32 s14, 2359296
s_mov_b32 s15, 0x20000
s_mov_b32 s16, s42
s_mov_b32 s17, s43
s_mov_b32 s18, 2359296
s_mov_b32 s19, 0x20000
s_add_u32 s20, s48, 58392576
s_addc_u32 s21, s49, 0
s_mov_b32 s22, 8192
s_mov_b32 s23, 0x20000
s_waitcnt vmcnt(27)
ds_read_b64_tr_b16 v[208:209], v8 offset:0
ds_read_b64_tr_b16 v[210:211], v8 offset:2048
ds_read_b64_tr_b16 v[212:213], v9 offset:0
ds_read_b64_tr_b16 v[214:215], v9 offset:2048
ds_read_b64_tr_b16 v[216:217], v10 offset:0
ds_read_b64_tr_b16 v[218:219], v10 offset:2048
ds_read_b64_tr_b16 v[220:221], v11 offset:0
ds_read_b64_tr_b16 v[222:223], v11 offset:2048
s_waitcnt lgkmcnt(0)
s_waitcnt vmcnt(18)
v_mfma_f32_16x16x32_bf16 v[64:67], v[208:211], a[0:3], 0
ds_read_b64_tr_b16 v[224:225], v8 offset:4096
s_add_u32 m0, s30, 0
v_mfma_f32_16x16x32_bf16 v[84:87], v[212:215], a[0:3], 0
ds_read_b64_tr_b16 v[226:227], v8 offset:6144
v_mfma_f32_16x16x32_bf16 v[104:107], v[216:219], a[0:3], 0
ds_read_b64_tr_b16 v[228:229], v9 offset:4096
v_mfma_f32_16x16x32_bf16 v[124:127], v[220:223], a[0:3], 0
ds_read_b64_tr_b16 v[230:231], v9 offset:6144
v_mfma_f32_16x16x32_bf16 v[68:71], v[208:211], a[4:7], 0
ds_read_b64_tr_b16 v[232:233], v10 offset:4096
v_mfma_f32_16x16x32_bf16 v[88:91], v[212:215], a[4:7], 0
ds_read_b64_tr_b16 v[234:235], v10 offset:6144
v_mfma_f32_16x16x32_bf16 v[108:111], v[216:219], a[4:7], 0
ds_read_b64_tr_b16 v[236:237], v11 offset:4096
v_mfma_f32_16x16x32_bf16 v[128:131], v[220:223], a[4:7], 0
ds_read_b64_tr_b16 v[238:239], v11 offset:6144
v_mfma_f32_16x16x32_bf16 v[72:75], v[208:211], a[8:11], 0
buffer_load_dwordx4 v4, s[4:7], s28 offen offset:0 lds
v_mfma_f32_16x16x32_bf16 v[92:95], v[212:215], a[8:11], 0
buffer_load_dwordx4 v5, s[4:7], s28 offen offset:1024 lds
v_mfma_f32_16x16x32_bf16 v[112:115], v[216:219], a[8:11], 0
buffer_load_dwordx4 v6, s[4:7], s28 offen offset:2048 lds
v_mfma_f32_16x16x32_bf16 v[132:135], v[220:223], a[8:11], 0
buffer_load_dwordx4 v7, s[4:7], s28 offen offset:3072 lds
v_mfma_f32_16x16x32_bf16 v[76:79], v[208:211], a[12:15], 0
s_add_u32 s28, s28, 36864
v_mfma_f32_16x16x32_bf16 v[96:99], v[212:215], a[12:15], 0
buffer_load_dwordx4 a[60:63], v2, s[8:11], s29 offen offset:0
v_mfma_f32_16x16x32_bf16 v[116:119], v[216:219], a[12:15], 0
buffer_load_dwordx4 a[64:67], v2, s[8:11], s29 offen offset:1024
v_mfma_f32_16x16x32_bf16 v[136:139], v[220:223], a[12:15], 0
buffer_load_dwordx4 a[68:71], v2, s[8:11], s29 offen offset:2048
v_mfma_f32_16x16x32_bf16 v[80:83], v[208:211], a[16:19], 0
buffer_load_dwordx4 a[72:75], v2, s[8:11], s29 offen offset:3072
v_mfma_f32_16x16x32_bf16 v[100:103], v[212:215], a[16:19], 0
buffer_load_dwordx4 a[76:79], v3, s[8:11], s29 offen
v_mfma_f32_16x16x32_bf16 v[120:123], v[216:219], a[16:19], 0
s_add_u32 s29, s29, 131072
v_mfma_f32_16x16x32_bf16 v[140:143], v[220:223], a[16:19], 0
s_waitcnt lgkmcnt(0)
s_waitcnt vmcnt(18)
v_mfma_f32_16x16x32_bf16 v[64:67], v[224:227], a[20:23], v[64:67]
ds_read_b64_tr_b16 v[208:209], v8 offset:8192
s_add_u32 m0, s30, 4096
v_mfma_f32_16x16x32_bf16 v[84:87], v[228:231], a[20:23], v[84:87]
ds_read_b64_tr_b16 v[210:211], v8 offset:10240
v_mfma_f32_16x16x32_bf16 v[104:107], v[232:235], a[20:23], v[104:107]
ds_read_b64_tr_b16 v[212:213], v9 offset:8192
v_mfma_f32_16x16x32_bf16 v[124:127], v[236:239], a[20:23], v[124:127]
ds_read_b64_tr_b16 v[214:215], v9 offset:10240
v_mfma_f32_16x16x32_bf16 v[68:71], v[224:227], a[24:27], v[68:71]
ds_read_b64_tr_b16 v[216:217], v10 offset:8192
v_mfma_f32_16x16x32_bf16 v[88:91], v[228:231], a[24:27], v[88:91]
ds_read_b64_tr_b16 v[218:219], v10 offset:10240
v_mfma_f32_16x16x32_bf16 v[108:111], v[232:235], a[24:27], v[108:111]
ds_read_b64_tr_b16 v[220:221], v11 offset:8192
v_mfma_f32_16x16x32_bf16 v[128:131], v[236:239], a[24:27], v[128:131]
ds_read_b64_tr_b16 v[222:223], v11 offset:10240
v_mfma_f32_16x16x32_bf16 v[72:75], v[224:227], a[28:31], v[72:75]
buffer_load_dwordx4 v4, s[4:7], s28 offen offset:0 lds
v_mfma_f32_16x16x32_bf16 v[92:95], v[228:231], a[28:31], v[92:95]
buffer_load_dwordx4 v5, s[4:7], s28 offen offset:1024 lds
v_mfma_f32_16x16x32_bf16 v[112:115], v[232:235], a[28:31], v[112:115]
buffer_load_dwordx4 v6, s[4:7], s28 offen offset:2048 lds
v_mfma_f32_16x16x32_bf16 v[132:135], v[236:239], a[28:31], v[132:135]
buffer_load_dwordx4 v7, s[4:7], s28 offen offset:3072 lds
v_mfma_f32_16x16x32_bf16 v[76:79], v[224:227], a[32:35], v[76:79]
s_add_u32 s28, s28, 36864
v_mfma_f32_16x16x32_bf16 v[96:99], v[228:231], a[32:35], v[96:99]
buffer_load_dwordx4 a[0:3], v2, s[8:11], s29 offen offset:0
v_mfma_f32_16x16x32_bf16 v[116:119], v[232:235], a[32:35], v[116:119]
buffer_load_dwordx4 a[4:7], v2, s[8:11], s29 offen offset:1024
v_mfma_f32_16x16x32_bf16 v[136:139], v[236:239], a[32:35], v[136:139]
buffer_load_dwordx4 a[8:11], v2, s[8:11], s29 offen offset:2048
v_mfma_f32_16x16x32_bf16 v[80:83], v[224:227], a[36:39], v[80:83]
buffer_load_dwordx4 a[12:15], v2, s[8:11], s29 offen offset:3072
v_mfma_f32_16x16x32_bf16 v[100:103], v[228:231], a[36:39], v[100:103]
buffer_load_dwordx4 a[16:19], v3, s[8:11], s29 offen
v_mfma_f32_16x16x32_bf16 v[120:123], v[232:235], a[36:39], v[120:123]
s_add_u32 s29, s29, 131072
v_mfma_f32_16x16x32_bf16 v[140:143], v[236:239], a[36:39], v[140:143]
s_waitcnt lgkmcnt(0)
s_waitcnt vmcnt(18)
v_mfma_f32_16x16x32_bf16 v[64:67], v[208:211], a[40:43], v[64:67]
ds_read_b64_tr_b16 v[224:225], v8 offset:12288
s_add_u32 m0, s30, 8192
v_mfma_f32_16x16x32_bf16 v[84:87], v[212:215], a[40:43], v[84:87]
ds_read_b64_tr_b16 v[226:227], v8 offset:14336
v_mfma_f32_16x16x32_bf16 v[104:107], v[216:219], a[40:43], v[104:107]
ds_read_b64_tr_b16 v[228:229], v9 offset:12288
v_mfma_f32_16x16x32_bf16 v[124:127], v[220:223], a[40:43], v[124:127]
ds_read_b64_tr_b16 v[230:231], v9 offset:14336
v_mfma_f32_16x16x32_bf16 v[68:71], v[208:211], a[44:47], v[68:71]
ds_read_b64_tr_b16 v[232:233], v10 offset:12288
v_mfma_f32_16x16x32_bf16 v[88:91], v[212:215], a[44:47], v[88:91]
ds_read_b64_tr_b16 v[234:235], v10 offset:14336
v_mfma_f32_16x16x32_bf16 v[108:111], v[216:219], a[44:47], v[108:111]
ds_read_b64_tr_b16 v[236:237], v11 offset:12288
v_mfma_f32_16x16x32_bf16 v[128:131], v[220:223], a[44:47], v[128:131]
ds_read_b64_tr_b16 v[238:239], v11 offset:14336
v_mfma_f32_16x16x32_bf16 v[72:75], v[208:211], a[48:51], v[72:75]
buffer_load_dwordx4 v4, s[4:7], s28 offen offset:0 lds
v_mfma_f32_16x16x32_bf16 v[92:95], v[212:215], a[48:51], v[92:95]
buffer_load_dwordx4 v5, s[4:7], s28 offen offset:1024 lds
v_mfma_f32_16x16x32_bf16 v[112:115], v[216:219], a[48:51], v[112:115]
buffer_load_dwordx4 v6, s[4:7], s28 offen offset:2048 lds
v_mfma_f32_16x16x32_bf16 v[132:135], v[220:223], a[48:51], v[132:135]
buffer_load_dwordx4 v7, s[4:7], s28 offen offset:3072 lds
v_mfma_f32_16x16x32_bf16 v[76:79], v[208:211], a[52:55], v[76:79]
s_add_u32 s28, s28, 36864
v_mfma_f32_16x16x32_bf16 v[96:99], v[212:215], a[52:55], v[96:99]
buffer_load_dwordx4 a[20:23], v2, s[8:11], s29 offen offset:0
v_mfma_f32_16x16x32_bf16 v[116:119], v[216:219], a[52:55], v[116:119]
buffer_load_dwordx4 a[24:27], v2, s[8:11], s29 offen offset:1024
v_mfma_f32_16x16x32_bf16 v[136:139], v[220:223], a[52:55], v[136:139]
buffer_load_dwordx4 a[28:31], v2, s[8:11], s29 offen offset:2048
v_mfma_f32_16x16x32_bf16 v[80:83], v[208:211], a[56:59], v[80:83]
buffer_load_dwordx4 a[32:35], v2, s[8:11], s29 offen offset:3072
v_mfma_f32_16x16x32_bf16 v[100:103], v[212:215], a[56:59], v[100:103]
buffer_load_dwordx4 a[36:39], v3, s[8:11], s29 offen
v_mfma_f32_16x16x32_bf16 v[120:123], v[216:219], a[56:59], v[120:123]
s_add_u32 s29, s29, 131072
v_mfma_f32_16x16x32_bf16 v[140:143], v[220:223], a[56:59], v[140:143]
s_waitcnt lgkmcnt(0)
s_waitcnt vmcnt(18)
v_mfma_f32_16x16x32_bf16 v[64:67], v[224:227], a[60:63], v[64:67]
ds_read_b64_tr_b16 v[208:209], v8 offset:0
s_add_u32 m0, s30, 12288
v_mfma_f32_16x16x32_bf16 v[84:87], v[228:231], a[60:63], v[84:87]
ds_read_b64_tr_b16 v[210:211], v8 offset:2048
v_mfma_f32_16x16x32_bf16 v[104:107], v[232:235], a[60:63], v[104:107]
ds_read_b64_tr_b16 v[212:213], v9 offset:0
v_mfma_f32_16x16x32_bf16 v[124:127], v[236:239], a[60:63], v[124:127]
ds_read_b64_tr_b16 v[214:215], v9 offset:2048
v_mfma_f32_16x16x32_bf16 v[68:71], v[224:227], a[64:67], v[68:71]
ds_read_b64_tr_b16 v[216:217], v10 offset:0
v_mfma_f32_16x16x32_bf16 v[88:91], v[228:231], a[64:67], v[88:91]
ds_read_b64_tr_b16 v[218:219], v10 offset:2048
v_mfma_f32_16x16x32_bf16 v[108:111], v[232:235], a[64:67], v[108:111]
ds_read_b64_tr_b16 v[220:221], v11 offset:0
v_mfma_f32_16x16x32_bf16 v[128:131], v[236:239], a[64:67], v[128:131]
ds_read_b64_tr_b16 v[222:223], v11 offset:2048
v_mfma_f32_16x16x32_bf16 v[72:75], v[224:227], a[68:71], v[72:75]
buffer_load_dwordx4 v4, s[4:7], s28 offen offset:0 lds
v_mfma_f32_16x16x32_bf16 v[92:95], v[228:231], a[68:71], v[92:95]
buffer_load_dwordx4 v5, s[4:7], s28 offen offset:1024 lds
v_mfma_f32_16x16x32_bf16 v[112:115], v[232:235], a[68:71], v[112:115]
buffer_load_dwordx4 v6, s[4:7], s28 offen offset:2048 lds
v_mfma_f32_16x16x32_bf16 v[132:135], v[236:239], a[68:71], v[132:135]
buffer_load_dwordx4 v7, s[4:7], s28 offen offset:3072 lds
v_mfma_f32_16x16x32_bf16 v[76:79], v[224:227], a[72:75], v[76:79]
s_add_u32 s28, s28, 36864
v_mfma_f32_16x16x32_bf16 v[96:99], v[228:231], a[72:75], v[96:99]
buffer_load_dwordx4 a[40:43], v2, s[8:11], s29 offen offset:0
v_mfma_f32_16x16x32_bf16 v[116:119], v[232:235], a[72:75], v[116:119]
buffer_load_dwordx4 a[44:47], v2, s[8:11], s29 offen offset:1024
v_mfma_f32_16x16x32_bf16 v[136:139], v[236:239], a[72:75], v[136:139]
buffer_load_dwordx4 a[48:51], v2, s[8:11], s29 offen offset:2048
v_mfma_f32_16x16x32_bf16 v[80:83], v[224:227], a[76:79], v[80:83]
buffer_load_dwordx4 a[52:55], v2, s[8:11], s29 offen offset:3072
v_mfma_f32_16x16x32_bf16 v[100:103], v[228:231], a[76:79], v[100:103]
buffer_load_dwordx4 a[56:59], v3, s[8:11], s29 offen
v_mfma_f32_16x16x32_bf16 v[120:123], v[232:235], a[76:79], v[120:123]
s_add_u32 s29, s29, 131072
v_mfma_f32_16x16x32_bf16 v[140:143], v[236:239], a[76:79], v[140:143]
s_waitcnt lgkmcnt(0)
s_waitcnt vmcnt(18)
v_mfma_f32_16x16x32_bf16 v[64:67], v[208:211], a[0:3], v[64:67]
ds_read_b64_tr_b16 v[224:225], v8 offset:4096
s_add_u32 m0, s30, 0
v_mfma_f32_16x16x32_bf16 v[84:87], v[212:215], a[0:3], v[84:87]
ds_read_b64_tr_b16 v[226:227], v8 offset:6144
v_mfma_f32_16x16x32_bf16 v[104:107], v[216:219], a[0:3], v[104:107]
ds_read_b64_tr_b16 v[228:229], v9 offset:4096
v_mfma_f32_16x16x32_bf16 v[124:127], v[220:223], a[0:3], v[124:127]
ds_read_b64_tr_b16 v[230:231], v9 offset:6144
v_mfma_f32_16x16x32_bf16 v[68:71], v[208:211], a[4:7], v[68:71]
ds_read_b64_tr_b16 v[232:233], v10 offset:4096
v_mfma_f32_16x16x32_bf16 v[88:91], v[212:215], a[4:7], v[88:91]
ds_read_b64_tr_b16 v[234:235], v10 offset:6144
v_mfma_f32_16x16x32_bf16 v[108:111], v[216:219], a[4:7], v[108:111]
ds_read_b64_tr_b16 v[236:237], v11 offset:4096
v_mfma_f32_16x16x32_bf16 v[128:131], v[220:223], a[4:7], v[128:131]
ds_read_b64_tr_b16 v[238:239], v11 offset:6144
v_mfma_f32_16x16x32_bf16 v[72:75], v[208:211], a[8:11], v[72:75]
buffer_load_dwordx4 v4, s[4:7], s28 offen offset:0 lds
v_mfma_f32_16x16x32_bf16 v[92:95], v[212:215], a[8:11], v[92:95]
buffer_load_dwordx4 v5, s[4:7], s28 offen offset:1024 lds
v_mfma_f32_16x16x32_bf16 v[112:115], v[216:219], a[8:11], v[112:115]
buffer_load_dwordx4 v6, s[4:7], s28 offen offset:2048 lds
v_mfma_f32_16x16x32_bf16 v[132:135], v[220:223], a[8:11], v[132:135]
buffer_load_dwordx4 v7, s[4:7], s28 offen offset:3072 lds
v_mfma_f32_16x16x32_bf16 v[76:79], v[208:211], a[12:15], v[76:79]
s_add_u32 s28, s28, 36864
v_mfma_f32_16x16x32_bf16 v[96:99], v[212:215], a[12:15], v[96:99]
buffer_load_dwordx4 a[60:63], v2, s[8:11], s29 offen offset:0
v_mfma_f32_16x16x32_bf16 v[116:119], v[216:219], a[12:15], v[116:119]
buffer_load_dwordx4 a[64:67], v2, s[8:11], s29 offen offset:1024
v_mfma_f32_16x16x32_bf16 v[136:139], v[220:223], a[12:15], v[136:139]
buffer_load_dwordx4 a[68:71], v2, s[8:11], s29 offen offset:2048
v_mfma_f32_16x16x32_bf16 v[80:83], v[208:211], a[16:19], v[80:83]
buffer_load_dwordx4 a[72:75], v2, s[8:11], s29 offen offset:3072
v_mfma_f32_16x16x32_bf16 v[100:103], v[212:215], a[16:19], v[100:103]
buffer_load_dwordx4 a[76:79], v3, s[8:11], s29 offen
v_mfma_f32_16x16x32_bf16 v[120:123], v[216:219], a[16:19], v[120:123]
s_add_u32 s29, s29, 131072
v_mfma_f32_16x16x32_bf16 v[140:143], v[220:223], a[16:19], v[140:143]
s_waitcnt lgkmcnt(0)
s_waitcnt vmcnt(18)
v_mfma_f32_16x16x32_bf16 v[64:67], v[224:227], a[20:23], v[64:67]
ds_read_b64_tr_b16 v[208:209], v8 offset:8192
s_add_u32 m0, s30, 4096
v_mfma_f32_16x16x32_bf16 v[84:87], v[228:231], a[20:23], v[84:87]
ds_read_b64_tr_b16 v[210:211], v8 offset:10240
v_mfma_f32_16x16x32_bf16 v[104:107], v[232:235], a[20:23], v[104:107]
ds_read_b64_tr_b16 v[212:213], v9 offset:8192
v_mfma_f32_16x16x32_bf16 v[124:127], v[236:239], a[20:23], v[124:127]
ds_read_b64_tr_b16 v[214:215], v9 offset:10240
v_mfma_f32_16x16x32_bf16 v[68:71], v[224:227], a[24:27], v[68:71]
ds_read_b64_tr_b16 v[216:217], v10 offset:8192
v_mfma_f32_16x16x32_bf16 v[88:91], v[228:231], a[24:27], v[88:91]
ds_read_b64_tr_b16 v[218:219], v10 offset:10240
v_mfma_f32_16x16x32_bf16 v[108:111], v[232:235], a[24:27], v[108:111]
ds_read_b64_tr_b16 v[220:221], v11 offset:8192
v_mfma_f32_16x16x32_bf16 v[128:131], v[236:239], a[24:27], v[128:131]
ds_read_b64_tr_b16 v[222:223], v11 offset:10240
v_mfma_f32_16x16x32_bf16 v[72:75], v[224:227], a[28:31], v[72:75]
buffer_load_dwordx4 v4, s[4:7], s28 offen offset:0 lds
v_mfma_f32_16x16x32_bf16 v[92:95], v[228:231], a[28:31], v[92:95]
buffer_load_dwordx4 v5, s[4:7], s28 offen offset:1024 lds
v_mfma_f32_16x16x32_bf16 v[112:115], v[232:235], a[28:31], v[112:115]
buffer_load_dwordx4 v6, s[4:7], s28 offen offset:2048 lds
v_mfma_f32_16x16x32_bf16 v[132:135], v[236:239], a[28:31], v[132:135]
buffer_load_dwordx4 v7, s[4:7], s28 offen offset:3072 lds
v_mfma_f32_16x16x32_bf16 v[76:79], v[224:227], a[32:35], v[76:79]
s_add_u32 s28, s28, 36864
v_mfma_f32_16x16x32_bf16 v[96:99], v[228:231], a[32:35], v[96:99]
buffer_load_dwordx4 a[0:3], v2, s[8:11], s29 offen offset:0
v_mfma_f32_16x16x32_bf16 v[116:119], v[232:235], a[32:35], v[116:119]
buffer_load_dwordx4 a[4:7], v2, s[8:11], s29 offen offset:1024
v_mfma_f32_16x16x32_bf16 v[136:139], v[236:239], a[32:35], v[136:139]
buffer_load_dwordx4 a[8:11], v2, s[8:11], s29 offen offset:2048
v_mfma_f32_16x16x32_bf16 v[80:83], v[224:227], a[36:39], v[80:83]
buffer_load_dwordx4 a[12:15], v2, s[8:11], s29 offen offset:3072
v_mfma_f32_16x16x32_bf16 v[100:103], v[228:231], a[36:39], v[100:103]
buffer_load_dwordx4 a[16:19], v3, s[8:11], s29 offen
v_mfma_f32_16x16x32_bf16 v[120:123], v[232:235], a[36:39], v[120:123]
s_add_u32 s29, s29, 131072
v_mfma_f32_16x16x32_bf16 v[140:143], v[236:239], a[36:39], v[140:143]
s_waitcnt lgkmcnt(0)
s_waitcnt vmcnt(18)
v_mfma_f32_16x16x32_bf16 v[64:67], v[208:211], a[40:43], v[64:67]
ds_read_b64_tr_b16 v[224:225], v8 offset:12288
s_add_u32 m0, s30, 8192
v_mfma_f32_16x16x32_bf16 v[84:87], v[212:215], a[40:43], v[84:87]
ds_read_b64_tr_b16 v[226:227], v8 offset:14336
v_mfma_f32_16x16x32_bf16 v[104:107], v[216:219], a[40:43], v[104:107]
ds_read_b64_tr_b16 v[228:229], v9 offset:12288
v_mfma_f32_16x16x32_bf16 v[124:127], v[220:223], a[40:43], v[124:127]
ds_read_b64_tr_b16 v[230:231], v9 offset:14336
v_mfma_f32_16x16x32_bf16 v[68:71], v[208:211], a[44:47], v[68:71]
ds_read_b64_tr_b16 v[232:233], v10 offset:12288
v_mfma_f32_16x16x32_bf16 v[88:91], v[212:215], a[44:47], v[88:91]
ds_read_b64_tr_b16 v[234:235], v10 offset:14336
v_mfma_f32_16x16x32_bf16 v[108:111], v[216:219], a[44:47], v[108:111]
ds_read_b64_tr_b16 v[236:237], v11 offset:12288
v_mfma_f32_16x16x32_bf16 v[128:131], v[220:223], a[44:47], v[128:131]
ds_read_b64_tr_b16 v[238:239], v11 offset:14336
v_mfma_f32_16x16x32_bf16 v[72:75], v[208:211], a[48:51], v[72:75]
buffer_load_dwordx4 v4, s[4:7], s28 offen offset:0 lds
v_mfma_f32_16x16x32_bf16 v[92:95], v[212:215], a[48:51], v[92:95]
buffer_load_dwordx4 v5, s[4:7], s28 offen offset:1024 lds
v_mfma_f32_16x16x32_bf16 v[112:115], v[216:219], a[48:51], v[112:115]
buffer_load_dwordx4 v6, s[4:7], s28 offen offset:2048 lds
v_mfma_f32_16x16x32_bf16 v[132:135], v[220:223], a[48:51], v[132:135]
buffer_load_dwordx4 v7, s[4:7], s28 offen offset:3072 lds
v_mfma_f32_16x16x32_bf16 v[76:79], v[208:211], a[52:55], v[76:79]
s_add_u32 s28, s28, 36864
v_mfma_f32_16x16x32_bf16 v[96:99], v[212:215], a[52:55], v[96:99]
buffer_load_dwordx4 a[20:23], v2, s[8:11], s29 offen offset:0
v_mfma_f32_16x16x32_bf16 v[116:119], v[216:219], a[52:55], v[116:119]
buffer_load_dwordx4 a[24:27], v2, s[8:11], s29 offen offset:1024
v_mfma_f32_16x16x32_bf16 v[136:139], v[220:223], a[52:55], v[136:139]
buffer_load_dwordx4 a[28:31], v2, s[8:11], s29 offen offset:2048
v_mfma_f32_16x16x32_bf16 v[80:83], v[208:211], a[56:59], v[80:83]
buffer_load_dwordx4 a[32:35], v2, s[8:11], s29 offen offset:3072
v_mfma_f32_16x16x32_bf16 v[100:103], v[212:215], a[56:59], v[100:103]
buffer_load_dwordx4 a[36:39], v3, s[8:11], s29 offen
v_mfma_f32_16x16x32_bf16 v[120:123], v[216:219], a[56:59], v[120:123]
s_add_u32 s29, s29, 131072
v_mfma_f32_16x16x32_bf16 v[140:143], v[220:223], a[56:59], v[140:143]
s_waitcnt lgkmcnt(0)
s_waitcnt vmcnt(18)
v_mfma_f32_16x16x32_bf16 v[64:67], v[224:227], a[60:63], v[64:67]
ds_read_b64_tr_b16 v[208:209], v8 offset:0
s_add_u32 m0, s30, 12288
v_mfma_f32_16x16x32_bf16 v[84:87], v[228:231], a[60:63], v[84:87]
ds_read_b64_tr_b16 v[210:211], v8 offset:2048
v_mfma_f32_16x16x32_bf16 v[104:107], v[232:235], a[60:63], v[104:107]
ds_read_b64_tr_b16 v[212:213], v9 offset:0
v_mfma_f32_16x16x32_bf16 v[124:127], v[236:239], a[60:63], v[124:127]
ds_read_b64_tr_b16 v[214:215], v9 offset:2048
v_mfma_f32_16x16x32_bf16 v[68:71], v[224:227], a[64:67], v[68:71]
ds_read_b64_tr_b16 v[216:217], v10 offset:0
v_mfma_f32_16x16x32_bf16 v[88:91], v[228:231], a[64:67], v[88:91]
ds_read_b64_tr_b16 v[218:219], v10 offset:2048
v_mfma_f32_16x16x32_bf16 v[108:111], v[232:235], a[64:67], v[108:111]
ds_read_b64_tr_b16 v[220:221], v11 offset:0
v_mfma_f32_16x16x32_bf16 v[128:131], v[236:239], a[64:67], v[128:131]
ds_read_b64_tr_b16 v[222:223], v11 offset:2048
v_mfma_f32_16x16x32_bf16 v[72:75], v[224:227], a[68:71], v[72:75]
buffer_load_dwordx4 v4, s[4:7], s28 offen offset:0 lds
v_mfma_f32_16x16x32_bf16 v[92:95], v[228:231], a[68:71], v[92:95]
buffer_load_dwordx4 v5, s[4:7], s28 offen offset:1024 lds
v_mfma_f32_16x16x32_bf16 v[112:115], v[232:235], a[68:71], v[112:115]
buffer_load_dwordx4 v6, s[4:7], s28 offen offset:2048 lds
v_mfma_f32_16x16x32_bf16 v[132:135], v[236:239], a[68:71], v[132:135]
buffer_load_dwordx4 v7, s[4:7], s28 offen offset:3072 lds
v_mfma_f32_16x16x32_bf16 v[76:79], v[224:227], a[72:75], v[76:79]
s_add_u32 s28, s28, 36864
v_mfma_f32_16x16x32_bf16 v[96:99], v[228:231], a[72:75], v[96:99]
buffer_load_dwordx4 a[40:43], v2, s[8:11], s29 offen offset:0
v_mfma_f32_16x16x32_bf16 v[116:119], v[232:235], a[72:75], v[116:119]
buffer_load_dwordx4 a[44:47], v2, s[8:11], s29 offen offset:1024
v_mfma_f32_16x16x32_bf16 v[136:139], v[236:239], a[72:75], v[136:139]
buffer_load_dwordx4 a[48:51], v2, s[8:11], s29 offen offset:2048
v_mfma_f32_16x16x32_bf16 v[80:83], v[224:227], a[76:79], v[80:83]
buffer_load_dwordx4 a[52:55], v2, s[8:11], s29 offen offset:3072
v_mfma_f32_16x16x32_bf16 v[100:103], v[228:231], a[76:79], v[100:103]
buffer_load_dwordx4 a[56:59], v3, s[8:11], s29 offen
v_mfma_f32_16x16x32_bf16 v[120:123], v[232:235], a[76:79], v[120:123]
s_add_u32 s29, s29, 131072
v_mfma_f32_16x16x32_bf16 v[140:143], v[236:239], a[76:79], v[140:143]
s_waitcnt lgkmcnt(0)
s_waitcnt vmcnt(18)
v_mfma_f32_16x16x32_bf16 v[64:67], v[208:211], a[0:3], v[64:67]
ds_read_b64_tr_b16 v[224:225], v8 offset:4096
s_add_u32 m0, s30, 0
v_mfma_f32_16x16x32_bf16 v[84:87], v[212:215], a[0:3], v[84:87]
ds_read_b64_tr_b16 v[226:227], v8 offset:6144
v_mfma_f32_16x16x32_bf16 v[104:107], v[216:219], a[0:3], v[104:107]
ds_read_b64_tr_b16 v[228:229], v9 offset:4096
v_mfma_f32_16x16x32_bf16 v[124:127], v[220:223], a[0:3], v[124:127]
ds_read_b64_tr_b16 v[230:231], v9 offset:6144
v_mfma_f32_16x16x32_bf16 v[68:71], v[208:211], a[4:7], v[68:71]
ds_read_b64_tr_b16 v[232:233], v10 offset:4096
v_mfma_f32_16x16x32_bf16 v[88:91], v[212:215], a[4:7], v[88:91]
ds_read_b64_tr_b16 v[234:235], v10 offset:6144
v_mfma_f32_16x16x32_bf16 v[108:111], v[216:219], a[4:7], v[108:111]
ds_read_b64_tr_b16 v[236:237], v11 offset:4096
v_mfma_f32_16x16x32_bf16 v[128:131], v[220:223], a[4:7], v[128:131]
ds_read_b64_tr_b16 v[238:239], v11 offset:6144
v_mfma_f32_16x16x32_bf16 v[72:75], v[208:211], a[8:11], v[72:75]
buffer_load_dwordx4 v4, s[4:7], s28 offen offset:0 lds
v_mfma_f32_16x16x32_bf16 v[92:95], v[212:215], a[8:11], v[92:95]
buffer_load_dwordx4 v5, s[4:7], s28 offen offset:1024 lds
v_mfma_f32_16x16x32_bf16 v[112:115], v[216:219], a[8:11], v[112:115]
buffer_load_dwordx4 v6, s[4:7], s28 offen offset:2048 lds
v_mfma_f32_16x16x32_bf16 v[132:135], v[220:223], a[8:11], v[132:135]
buffer_load_dwordx4 v7, s[4:7], s28 offen offset:3072 lds
v_mfma_f32_16x16x32_bf16 v[76:79], v[208:211], a[12:15], v[76:79]
s_add_u32 s28, s28, 36864
v_mfma_f32_16x16x32_bf16 v[96:99], v[212:215], a[12:15], v[96:99]
buffer_load_dwordx4 a[60:63], v2, s[8:11], s29 offen offset:0
v_mfma_f32_16x16x32_bf16 v[116:119], v[216:219], a[12:15], v[116:119]
buffer_load_dwordx4 a[64:67], v2, s[8:11], s29 offen offset:1024
v_mfma_f32_16x16x32_bf16 v[136:139], v[220:223], a[12:15], v[136:139]
buffer_load_dwordx4 a[68:71], v2, s[8:11], s29 offen offset:2048
v_mfma_f32_16x16x32_bf16 v[80:83], v[208:211], a[16:19], v[80:83]
tp3_p0:
s_cbranch_execz tp3_ret
tf_p12:
s_cbranch_execz k12_kernel_end
buffer_load_dwordx4 a[72:75], v2, s[8:11], s29 offen offset:3072
v_mfma_f32_16x16x32_bf16 v[100:103], v[212:215], a[16:19], v[100:103]
buffer_load_dwordx4 a[76:79], v3, s[8:11], s29 offen
v_mfma_f32_16x16x32_bf16 v[120:123], v[216:219], a[16:19], v[120:123]
s_add_u32 s29, s29, 131072
v_mfma_f32_16x16x32_bf16 v[140:143], v[220:223], a[16:19], v[140:143]
s_waitcnt lgkmcnt(0)
s_waitcnt vmcnt(18)
v_mfma_f32_16x16x32_bf16 v[64:67], v[224:227], a[20:23], v[64:67]
ds_read_b64_tr_b16 v[208:209], v8 offset:8192
s_add_u32 m0, s30, 4096
v_mfma_f32_16x16x32_bf16 v[84:87], v[228:231], a[20:23], v[84:87]
ds_read_b64_tr_b16 v[210:211], v8 offset:10240
v_mfma_f32_16x16x32_bf16 v[104:107], v[232:235], a[20:23], v[104:107]
ds_read_b64_tr_b16 v[212:213], v9 offset:8192
v_mfma_f32_16x16x32_bf16 v[124:127], v[236:239], a[20:23], v[124:127]
ds_read_b64_tr_b16 v[214:215], v9 offset:10240
v_mfma_f32_16x16x32_bf16 v[68:71], v[224:227], a[24:27], v[68:71]
ds_read_b64_tr_b16 v[216:217], v10 offset:8192
v_mfma_f32_16x16x32_bf16 v[88:91], v[228:231], a[24:27], v[88:91]
ds_read_b64_tr_b16 v[218:219], v10 offset:10240
v_mfma_f32_16x16x32_bf16 v[108:111], v[232:235], a[24:27], v[108:111]
ds_read_b64_tr_b16 v[220:221], v11 offset:8192
v_mfma_f32_16x16x32_bf16 v[128:131], v[236:239], a[24:27], v[128:131]
ds_read_b64_tr_b16 v[222:223], v11 offset:10240
v_mfma_f32_16x16x32_bf16 v[72:75], v[224:227], a[28:31], v[72:75]
buffer_load_dwordx4 v4, s[4:7], s28 offen offset:0 lds
v_mfma_f32_16x16x32_bf16 v[92:95], v[228:231], a[28:31], v[92:95]
buffer_load_dwordx4 v5, s[4:7], s28 offen offset:1024 lds
v_mfma_f32_16x16x32_bf16 v[112:115], v[232:235], a[28:31], v[112:115]
buffer_load_dwordx4 v6, s[4:7], s28 offen offset:2048 lds
v_mfma_f32_16x16x32_bf16 v[132:135], v[236:239], a[28:31], v[132:135]
buffer_load_dwordx4 v7, s[4:7], s28 offen offset:3072 lds
v_mfma_f32_16x16x32_bf16 v[76:79], v[224:227], a[32:35], v[76:79]
s_add_u32 s28, s28, 36864
v_mfma_f32_16x16x32_bf16 v[96:99], v[228:231], a[32:35], v[96:99]
buffer_load_dwordx4 a[0:3], v2, s[8:11], s29 offen offset:0
v_mfma_f32_16x16x32_bf16 v[116:119], v[232:235], a[32:35], v[116:119]
buffer_load_dwordx4 a[4:7], v2, s[8:11], s29 offen offset:1024
v_mfma_f32_16x16x32_bf16 v[136:139], v[236:239], a[32:35], v[136:139]
buffer_load_dwordx4 a[8:11], v2, s[8:11], s29 offen offset:2048
v_mfma_f32_16x16x32_bf16 v[80:83], v[224:227], a[36:39], v[80:83]
buffer_load_dwordx4 a[12:15], v2, s[8:11], s29 offen offset:3072
v_mfma_f32_16x16x32_bf16 v[100:103], v[228:231], a[36:39], v[100:103]
buffer_load_dwordx4 a[16:19], v3, s[8:11], s29 offen
v_mfma_f32_16x16x32_bf16 v[120:123], v[232:235], a[36:39], v[120:123]
s_add_u32 s29, s29, 131072
v_mfma_f32_16x16x32_bf16 v[140:143], v[236:239], a[36:39], v[140:143]
s_waitcnt lgkmcnt(0)
s_waitcnt vmcnt(18)
v_mfma_f32_16x16x32_bf16 v[64:67], v[208:211], a[40:43], v[64:67]
ds_read_b64_tr_b16 v[224:225], v8 offset:12288
s_add_u32 m0, s30, 8192
v_mfma_f32_16x16x32_bf16 v[84:87], v[212:215], a[40:43], v[84:87]
ds_read_b64_tr_b16 v[226:227], v8 offset:14336
v_mfma_f32_16x16x32_bf16 v[104:107], v[216:219], a[40:43], v[104:107]
ds_read_b64_tr_b16 v[228:229], v9 offset:12288
v_mfma_f32_16x16x32_bf16 v[124:127], v[220:223], a[40:43], v[124:127]
ds_read_b64_tr_b16 v[230:231], v9 offset:14336
v_mfma_f32_16x16x32_bf16 v[68:71], v[208:211], a[44:47], v[68:71]
ds_read_b64_tr_b16 v[232:233], v10 offset:12288
v_mfma_f32_16x16x32_bf16 v[88:91], v[212:215], a[44:47], v[88:91]
ds_read_b64_tr_b16 v[234:235], v10 offset:14336
v_mfma_f32_16x16x32_bf16 v[108:111], v[216:219], a[44:47], v[108:111]
ds_read_b64_tr_b16 v[236:237], v11 offset:12288
v_mfma_f32_16x16x32_bf16 v[128:131], v[220:223], a[44:47], v[128:131]
ds_read_b64_tr_b16 v[238:239], v11 offset:14336
v_mfma_f32_16x16x32_bf16 v[72:75], v[208:211], a[48:51], v[72:75]
buffer_load_dwordx4 v4, s[4:7], s28 offen offset:0 lds
v_mfma_f32_16x16x32_bf16 v[92:95], v[212:215], a[48:51], v[92:95]
buffer_load_dwordx4 v5, s[4:7], s28 offen offset:1024 lds
v_mfma_f32_16x16x32_bf16 v[112:115], v[216:219], a[48:51], v[112:115]
buffer_load_dwordx4 v6, s[4:7], s28 offen offset:2048 lds
v_mfma_f32_16x16x32_bf16 v[132:135], v[220:223], a[48:51], v[132:135]
buffer_load_dwordx4 v7, s[4:7], s28 offen offset:3072 lds
v_mfma_f32_16x16x32_bf16 v[76:79], v[208:211], a[52:55], v[76:79]
s_add_u32 s28, s28, 36864
v_mfma_f32_16x16x32_bf16 v[96:99], v[212:215], a[52:55], v[96:99]
buffer_load_dwordx4 a[20:23], v2, s[8:11], s29 offen offset:0
v_mfma_f32_16x16x32_bf16 v[116:119], v[216:219], a[52:55], v[116:119]
buffer_load_dwordx4 a[24:27], v2, s[8:11], s29 offen offset:1024
v_mfma_f32_16x16x32_bf16 v[136:139], v[220:223], a[52:55], v[136:139]
buffer_load_dwordx4 a[28:31], v2, s[8:11], s29 offen offset:2048
v_mfma_f32_16x16x32_bf16 v[80:83], v[208:211], a[56:59], v[80:83]
buffer_load_dwordx4 a[32:35], v2, s[8:11], s29 offen offset:3072
v_mfma_f32_16x16x32_bf16 v[100:103], v[212:215], a[56:59], v[100:103]
buffer_load_dwordx4 a[36:39], v3, s[8:11], s29 offen
v_mfma_f32_16x16x32_bf16 v[120:123], v[216:219], a[56:59], v[120:123]
s_add_u32 s29, s29, 131072
v_mfma_f32_16x16x32_bf16 v[140:143], v[220:223], a[56:59], v[140:143]
s_waitcnt lgkmcnt(0)
s_waitcnt vmcnt(18)
v_mfma_f32_16x16x32_bf16 v[64:67], v[224:227], a[60:63], v[64:67]
ds_read_b64_tr_b16 v[208:209], v8 offset:0
s_add_u32 m0, s30, 12288
v_mfma_f32_16x16x32_bf16 v[84:87], v[228:231], a[60:63], v[84:87]
ds_read_b64_tr_b16 v[210:211], v8 offset:2048
v_mfma_f32_16x16x32_bf16 v[104:107], v[232:235], a[60:63], v[104:107]
ds_read_b64_tr_b16 v[212:213], v9 offset:0
v_mfma_f32_16x16x32_bf16 v[124:127], v[236:239], a[60:63], v[124:127]
ds_read_b64_tr_b16 v[214:215], v9 offset:2048
v_mfma_f32_16x16x32_bf16 v[68:71], v[224:227], a[64:67], v[68:71]
ds_read_b64_tr_b16 v[216:217], v10 offset:0
v_mfma_f32_16x16x32_bf16 v[88:91], v[228:231], a[64:67], v[88:91]
ds_read_b64_tr_b16 v[218:219], v10 offset:2048
v_mfma_f32_16x16x32_bf16 v[108:111], v[232:235], a[64:67], v[108:111]
ds_read_b64_tr_b16 v[220:221], v11 offset:0
v_mfma_f32_16x16x32_bf16 v[128:131], v[236:239], a[64:67], v[128:131]
ds_read_b64_tr_b16 v[222:223], v11 offset:2048
v_mfma_f32_16x16x32_bf16 v[72:75], v[224:227], a[68:71], v[72:75]
buffer_load_dwordx4 v4, s[4:7], s28 offen offset:0 lds
v_mfma_f32_16x16x32_bf16 v[92:95], v[228:231], a[68:71], v[92:95]
buffer_load_dwordx4 v5, s[4:7], s28 offen offset:1024 lds
v_mfma_f32_16x16x32_bf16 v[112:115], v[232:235], a[68:71], v[112:115]
buffer_load_dwordx4 v6, s[4:7], s28 offen offset:2048 lds
v_mfma_f32_16x16x32_bf16 v[132:135], v[236:239], a[68:71], v[132:135]
buffer_load_dwordx4 v7, s[4:7], s28 offen offset:3072 lds
v_mfma_f32_16x16x32_bf16 v[76:79], v[224:227], a[72:75], v[76:79]
s_add_u32 s28, s28, 36864
v_mfma_f32_16x16x32_bf16 v[96:99], v[228:231], a[72:75], v[96:99]
buffer_load_dwordx4 a[40:43], v2, s[8:11], s29 offen offset:0
v_mfma_f32_16x16x32_bf16 v[116:119], v[232:235], a[72:75], v[116:119]
buffer_load_dwordx4 a[44:47], v2, s[8:11], s29 offen offset:1024
v_mfma_f32_16x16x32_bf16 v[136:139], v[236:239], a[72:75], v[136:139]
buffer_load_dwordx4 a[48:51], v2, s[8:11], s29 offen offset:2048
v_mfma_f32_16x16x32_bf16 v[80:83], v[224:227], a[76:79], v[80:83]
buffer_load_dwordx4 a[52:55], v2, s[8:11], s29 offen offset:3072
v_mfma_f32_16x16x32_bf16 v[100:103], v[228:231], a[76:79], v[100:103]
buffer_load_dwordx4 a[56:59], v3, s[8:11], s29 offen
v_mfma_f32_16x16x32_bf16 v[120:123], v[232:235], a[76:79], v[120:123]
s_add_u32 s29, s29, 131072
v_mfma_f32_16x16x32_bf16 v[140:143], v[236:239], a[76:79], v[140:143]
s_waitcnt lgkmcnt(0)
s_waitcnt vmcnt(18)
v_mfma_f32_16x16x32_bf16 v[64:67], v[208:211], a[0:3], v[64:67]
ds_read_b64_tr_b16 v[224:225], v8 offset:4096
s_add_u32 m0, s30, 0
v_mfma_f32_16x16x32_bf16 v[84:87], v[212:215], a[0:3], v[84:87]
ds_read_b64_tr_b16 v[226:227], v8 offset:6144
v_mfma_f32_16x16x32_bf16 v[104:107], v[216:219], a[0:3], v[104:107]
ds_read_b64_tr_b16 v[228:229], v9 offset:4096
v_mfma_f32_16x16x32_bf16 v[124:127], v[220:223], a[0:3], v[124:127]
ds_read_b64_tr_b16 v[230:231], v9 offset:6144
v_mfma_f32_16x16x32_bf16 v[68:71], v[208:211], a[4:7], v[68:71]
ds_read_b64_tr_b16 v[232:233], v10 offset:4096
v_mfma_f32_16x16x32_bf16 v[88:91], v[212:215], a[4:7], v[88:91]
ds_read_b64_tr_b16 v[234:235], v10 offset:6144
v_mfma_f32_16x16x32_bf16 v[108:111], v[216:219], a[4:7], v[108:111]
ds_read_b64_tr_b16 v[236:237], v11 offset:4096
v_mfma_f32_16x16x32_bf16 v[128:131], v[220:223], a[4:7], v[128:131]
ds_read_b64_tr_b16 v[238:239], v11 offset:6144
v_mfma_f32_16x16x32_bf16 v[72:75], v[208:211], a[8:11], v[72:75]
buffer_load_dwordx4 v4, s[4:7], s28 offen offset:0 lds
v_mfma_f32_16x16x32_bf16 v[92:95], v[212:215], a[8:11], v[92:95]
buffer_load_dwordx4 v5, s[4:7], s28 offen offset:1024 lds
v_mfma_f32_16x16x32_bf16 v[112:115], v[216:219], a[8:11], v[112:115]
buffer_load_dwordx4 v6, s[4:7], s28 offen offset:2048 lds
v_mfma_f32_16x16x32_bf16 v[132:135], v[220:223], a[8:11], v[132:135]
buffer_load_dwordx4 v7, s[4:7], s28 offen offset:3072 lds
v_mfma_f32_16x16x32_bf16 v[76:79], v[208:211], a[12:15], v[76:79]
s_add_u32 s28, s28, 36864
v_mfma_f32_16x16x32_bf16 v[96:99], v[212:215], a[12:15], v[96:99]
buffer_load_dwordx4 a[60:63], v2, s[8:11], s29 offen offset:0
v_mfma_f32_16x16x32_bf16 v[116:119], v[216:219], a[12:15], v[116:119]
buffer_load_dwordx4 a[64:67], v2, s[8:11], s29 offen offset:1024
v_mfma_f32_16x16x32_bf16 v[136:139], v[220:223], a[12:15], v[136:139]
buffer_load_dwordx4 a[68:71], v2, s[8:11], s29 offen offset:2048
v_mfma_f32_16x16x32_bf16 v[80:83], v[208:211], a[16:19], v[80:83]
buffer_load_dwordx4 a[72:75], v2, s[8:11], s29 offen offset:3072
v_mfma_f32_16x16x32_bf16 v[100:103], v[212:215], a[16:19], v[100:103]
buffer_load_dwordx4 a[76:79], v3, s[8:11], s29 offen
v_mfma_f32_16x16x32_bf16 v[120:123], v[216:219], a[16:19], v[120:123]
s_add_u32 s29, s29, 131072
v_mfma_f32_16x16x32_bf16 v[140:143], v[220:223], a[16:19], v[140:143]
s_waitcnt lgkmcnt(0)
s_waitcnt vmcnt(18)
v_mfma_f32_16x16x32_bf16 v[64:67], v[224:227], a[20:23], v[64:67]
ds_read_b64_tr_b16 v[208:209], v8 offset:8192
s_add_u32 m0, s30, 4096
v_mfma_f32_16x16x32_bf16 v[84:87], v[228:231], a[20:23], v[84:87]
ds_read_b64_tr_b16 v[210:211], v8 offset:10240
v_mfma_f32_16x16x32_bf16 v[104:107], v[232:235], a[20:23], v[104:107]
ds_read_b64_tr_b16 v[212:213], v9 offset:8192
v_mfma_f32_16x16x32_bf16 v[124:127], v[236:239], a[20:23], v[124:127]
ds_read_b64_tr_b16 v[214:215], v9 offset:10240
v_mfma_f32_16x16x32_bf16 v[68:71], v[224:227], a[24:27], v[68:71]
ds_read_b64_tr_b16 v[216:217], v10 offset:8192
v_mfma_f32_16x16x32_bf16 v[88:91], v[228:231], a[24:27], v[88:91]
ds_read_b64_tr_b16 v[218:219], v10 offset:10240
v_mfma_f32_16x16x32_bf16 v[108:111], v[232:235], a[24:27], v[108:111]
ds_read_b64_tr_b16 v[220:221], v11 offset:8192
v_mfma_f32_16x16x32_bf16 v[128:131], v[236:239], a[24:27], v[128:131]
ds_read_b64_tr_b16 v[222:223], v11 offset:10240
v_mfma_f32_16x16x32_bf16 v[72:75], v[224:227], a[28:31], v[72:75]
buffer_load_dwordx4 v4, s[4:7], s28 offen offset:0 lds
v_mfma_f32_16x16x32_bf16 v[92:95], v[228:231], a[28:31], v[92:95]
buffer_load_dwordx4 v5, s[4:7], s28 offen offset:1024 lds
v_mfma_f32_16x16x32_bf16 v[112:115], v[232:235], a[28:31], v[112:115]
buffer_load_dwordx4 v6, s[4:7], s28 offen offset:2048 lds
v_mfma_f32_16x16x32_bf16 v[132:135], v[236:239], a[28:31], v[132:135]
buffer_load_dwordx4 v7, s[4:7], s28 offen offset:3072 lds
v_mfma_f32_16x16x32_bf16 v[76:79], v[224:227], a[32:35], v[76:79]
s_add_u32 s28, s28, 36864
v_mfma_f32_16x16x32_bf16 v[96:99], v[228:231], a[32:35], v[96:99]
buffer_load_dwordx4 a[0:3], v2, s[8:11], s29 offen offset:0
v_mfma_f32_16x16x32_bf16 v[116:119], v[232:235], a[32:35], v[116:119]
buffer_load_dwordx4 a[4:7], v2, s[8:11], s29 offen offset:1024
v_mfma_f32_16x16x32_bf16 v[136:139], v[236:239], a[32:35], v[136:139]
buffer_load_dwordx4 a[8:11], v2, s[8:11], s29 offen offset:2048
v_mfma_f32_16x16x32_bf16 v[80:83], v[224:227], a[36:39], v[80:83]
buffer_load_dwordx4 a[12:15], v2, s[8:11], s29 offen offset:3072
v_mfma_f32_16x16x32_bf16 v[100:103], v[228:231], a[36:39], v[100:103]
buffer_load_dwordx4 a[16:19], v3, s[8:11], s29 offen
v_mfma_f32_16x16x32_bf16 v[120:123], v[232:235], a[36:39], v[120:123]
s_add_u32 s29, s29, 131072
v_mfma_f32_16x16x32_bf16 v[140:143], v[236:239], a[36:39], v[140:143]
s_waitcnt lgkmcnt(0)
s_waitcnt vmcnt(18)
v_mfma_f32_16x16x32_bf16 v[64:67], v[208:211], a[40:43], v[64:67]
ds_read_b64_tr_b16 v[224:225], v8 offset:12288
s_add_u32 m0, s30, 8192
v_mfma_f32_16x16x32_bf16 v[84:87], v[212:215], a[40:43], v[84:87]
ds_read_b64_tr_b16 v[226:227], v8 offset:14336
v_mfma_f32_16x16x32_bf16 v[104:107], v[216:219], a[40:43], v[104:107]
ds_read_b64_tr_b16 v[228:229], v9 offset:12288
v_mfma_f32_16x16x32_bf16 v[124:127], v[220:223], a[40:43], v[124:127]
ds_read_b64_tr_b16 v[230:231], v9 offset:14336
v_mfma_f32_16x16x32_bf16 v[68:71], v[208:211], a[44:47], v[68:71]
ds_read_b64_tr_b16 v[232:233], v10 offset:12288
v_mfma_f32_16x16x32_bf16 v[88:91], v[212:215], a[44:47], v[88:91]
ds_read_b64_tr_b16 v[234:235], v10 offset:14336
v_mfma_f32_16x16x32_bf16 v[108:111], v[216:219], a[44:47], v[108:111]
ds_read_b64_tr_b16 v[236:237], v11 offset:12288
v_mfma_f32_16x16x32_bf16 v[128:131], v[220:223], a[44:47], v[128:131]
ds_read_b64_tr_b16 v[238:239], v11 offset:14336
v_mfma_f32_16x16x32_bf16 v[72:75], v[208:211], a[48:51], v[72:75]
buffer_load_dwordx4 v4, s[4:7], s28 offen offset:0 lds
v_mfma_f32_16x16x32_bf16 v[92:95], v[212:215], a[48:51], v[92:95]
buffer_load_dwordx4 v5, s[4:7], s28 offen offset:1024 lds
v_mfma_f32_16x16x32_bf16 v[112:115], v[216:219], a[48:51], v[112:115]
buffer_load_dwordx4 v6, s[4:7], s28 offen offset:2048 lds
v_mfma_f32_16x16x32_bf16 v[132:135], v[220:223], a[48:51], v[132:135]
buffer_load_dwordx4 v7, s[4:7], s28 offen offset:3072 lds
v_mfma_f32_16x16x32_bf16 v[76:79], v[208:211], a[52:55], v[76:79]
s_add_u32 s28, s28, 36864
v_mfma_f32_16x16x32_bf16 v[96:99], v[212:215], a[52:55], v[96:99]
buffer_load_dwordx4 a[20:23], v2, s[8:11], s29 offen offset:0
v_mfma_f32_16x16x32_bf16 v[116:119], v[216:219], a[52:55], v[116:119]
buffer_load_dwordx4 a[24:27], v2, s[8:11], s29 offen offset:1024
v_mfma_f32_16x16x32_bf16 v[136:139], v[220:223], a[52:55], v[136:139]
buffer_load_dwordx4 a[28:31], v2, s[8:11], s29 offen offset:2048
v_mfma_f32_16x16x32_bf16 v[80:83], v[208:211], a[56:59], v[80:83]
buffer_load_dwordx4 a[32:35], v2, s[8:11], s29 offen offset:3072
v_mfma_f32_16x16x32_bf16 v[100:103], v[212:215], a[56:59], v[100:103]
buffer_load_dwordx4 a[36:39], v3, s[8:11], s29 offen
v_mfma_f32_16x16x32_bf16 v[120:123], v[216:219], a[56:59], v[120:123]
s_add_u32 s29, s29, 131072
v_mfma_f32_16x16x32_bf16 v[140:143], v[220:223], a[56:59], v[140:143]
s_waitcnt lgkmcnt(0)
s_waitcnt vmcnt(18)
v_mfma_f32_16x16x32_bf16 v[64:67], v[224:227], a[60:63], v[64:67]
ds_read_b64_tr_b16 v[208:209], v8 offset:0
s_add_u32 m0, s30, 12288
v_mfma_f32_16x16x32_bf16 v[84:87], v[228:231], a[60:63], v[84:87]
ds_read_b64_tr_b16 v[210:211], v8 offset:2048
v_mfma_f32_16x16x32_bf16 v[104:107], v[232:235], a[60:63], v[104:107]
ds_read_b64_tr_b16 v[212:213], v9 offset:0
v_mfma_f32_16x16x32_bf16 v[124:127], v[236:239], a[60:63], v[124:127]
ds_read_b64_tr_b16 v[214:215], v9 offset:2048
v_mfma_f32_16x16x32_bf16 v[68:71], v[224:227], a[64:67], v[68:71]
ds_read_b64_tr_b16 v[216:217], v10 offset:0
v_mfma_f32_16x16x32_bf16 v[88:91], v[228:231], a[64:67], v[88:91]
ds_read_b64_tr_b16 v[218:219], v10 offset:2048
v_mfma_f32_16x16x32_bf16 v[108:111], v[232:235], a[64:67], v[108:111]
ds_read_b64_tr_b16 v[220:221], v11 offset:0
v_mfma_f32_16x16x32_bf16 v[128:131], v[236:239], a[64:67], v[128:131]
ds_read_b64_tr_b16 v[222:223], v11 offset:2048
v_mfma_f32_16x16x32_bf16 v[72:75], v[224:227], a[68:71], v[72:75]
buffer_load_dwordx4 v4, s[4:7], s28 offen offset:0 lds
v_mfma_f32_16x16x32_bf16 v[92:95], v[228:231], a[68:71], v[92:95]
buffer_load_dwordx4 v5, s[4:7], s28 offen offset:1024 lds
v_mfma_f32_16x16x32_bf16 v[112:115], v[232:235], a[68:71], v[112:115]
buffer_load_dwordx4 v6, s[4:7], s28 offen offset:2048 lds
v_mfma_f32_16x16x32_bf16 v[132:135], v[236:239], a[68:71], v[132:135]
buffer_load_dwordx4 v7, s[4:7], s28 offen offset:3072 lds
v_mfma_f32_16x16x32_bf16 v[76:79], v[224:227], a[72:75], v[76:79]
s_add_u32 s28, s28, 36864
v_mfma_f32_16x16x32_bf16 v[96:99], v[228:231], a[72:75], v[96:99]
buffer_load_dwordx4 a[40:43], v2, s[8:11], s29 offen offset:0
v_mfma_f32_16x16x32_bf16 v[116:119], v[232:235], a[72:75], v[116:119]
buffer_load_dwordx4 a[44:47], v2, s[8:11], s29 offen offset:1024
v_mfma_f32_16x16x32_bf16 v[136:139], v[236:239], a[72:75], v[136:139]
buffer_load_dwordx4 a[48:51], v2, s[8:11], s29 offen offset:2048
v_mfma_f32_16x16x32_bf16 v[80:83], v[224:227], a[76:79], v[80:83]
buffer_load_dwordx4 a[52:55], v2, s[8:11], s29 offen offset:3072
v_mfma_f32_16x16x32_bf16 v[100:103], v[228:231], a[76:79], v[100:103]
buffer_load_dwordx4 a[56:59], v3, s[8:11], s29 offen
v_mfma_f32_16x16x32_bf16 v[120:123], v[232:235], a[76:79], v[120:123]
s_add_u32 s29, s29, 131072
v_mfma_f32_16x16x32_bf16 v[140:143], v[236:239], a[76:79], v[140:143]
s_waitcnt lgkmcnt(0)
s_waitcnt vmcnt(18)
v_mfma_f32_16x16x32_bf16 v[64:67], v[208:211], a[0:3], v[64:67]
ds_read_b64_tr_b16 v[224:225], v8 offset:4096
s_add_u32 m0, s30, 0
v_mfma_f32_16x16x32_bf16 v[84:87], v[212:215], a[0:3], v[84:87]
ds_read_b64_tr_b16 v[226:227], v8 offset:6144
v_mfma_f32_16x16x32_bf16 v[104:107], v[216:219], a[0:3], v[104:107]
ds_read_b64_tr_b16 v[228:229], v9 offset:4096
v_mfma_f32_16x16x32_bf16 v[124:127], v[220:223], a[0:3], v[124:127]
ds_read_b64_tr_b16 v[230:231], v9 offset:6144
v_mfma_f32_16x16x32_bf16 v[68:71], v[208:211], a[4:7], v[68:71]
ds_read_b64_tr_b16 v[232:233], v10 offset:4096
v_mfma_f32_16x16x32_bf16 v[88:91], v[212:215], a[4:7], v[88:91]
ds_read_b64_tr_b16 v[234:235], v10 offset:6144
v_mfma_f32_16x16x32_bf16 v[108:111], v[216:219], a[4:7], v[108:111]
ds_read_b64_tr_b16 v[236:237], v11 offset:4096
v_mfma_f32_16x16x32_bf16 v[128:131], v[220:223], a[4:7], v[128:131]
ds_read_b64_tr_b16 v[238:239], v11 offset:6144
v_mfma_f32_16x16x32_bf16 v[72:75], v[208:211], a[8:11], v[72:75]
buffer_load_dwordx4 v4, s[4:7], s28 offen offset:0 lds
v_mfma_f32_16x16x32_bf16 v[92:95], v[212:215], a[8:11], v[92:95]
buffer_load_dwordx4 v5, s[4:7], s28 offen offset:1024 lds
v_mfma_f32_16x16x32_bf16 v[112:115], v[216:219], a[8:11], v[112:115]
buffer_load_dwordx4 v6, s[4:7], s28 offen offset:2048 lds
v_mfma_f32_16x16x32_bf16 v[132:135], v[220:223], a[8:11], v[132:135]
buffer_load_dwordx4 v7, s[4:7], s28 offen offset:3072 lds
v_mfma_f32_16x16x32_bf16 v[76:79], v[208:211], a[12:15], v[76:79]
s_add_u32 s28, s28, 36864
v_mfma_f32_16x16x32_bf16 v[96:99], v[212:215], a[12:15], v[96:99]
buffer_load_dwordx4 a[60:63], v2, s[8:11], s29 offen offset:0
v_mfma_f32_16x16x32_bf16 v[116:119], v[216:219], a[12:15], v[116:119]
buffer_load_dwordx4 a[64:67], v2, s[8:11], s29 offen offset:1024
v_mfma_f32_16x16x32_bf16 v[136:139], v[220:223], a[12:15], v[136:139]
buffer_load_dwordx4 a[68:71], v2, s[8:11], s29 offen offset:2048
v_mfma_f32_16x16x32_bf16 v[80:83], v[208:211], a[16:19], v[80:83]
buffer_load_dwordx4 a[72:75], v2, s[8:11], s29 offen offset:3072
v_mfma_f32_16x16x32_bf16 v[100:103], v[212:215], a[16:19], v[100:103]
buffer_load_dwordx4 a[76:79], v3, s[8:11], s29 offen
v_mfma_f32_16x16x32_bf16 v[120:123], v[216:219], a[16:19], v[120:123]
s_add_u32 s29, s29, 131072
v_mfma_f32_16x16x32_bf16 v[140:143], v[220:223], a[16:19], v[140:143]
s_waitcnt lgkmcnt(0)
s_waitcnt vmcnt(18)
v_mfma_f32_16x16x32_bf16 v[64:67], v[224:227], a[20:23], v[64:67]
ds_read_b64_tr_b16 v[208:209], v8 offset:8192
s_add_u32 m0, s30, 4096
v_mfma_f32_16x16x32_bf16 v[84:87], v[228:231], a[20:23], v[84:87]
ds_read_b64_tr_b16 v[210:211], v8 offset:10240
v_mfma_f32_16x16x32_bf16 v[104:107], v[232:235], a[20:23], v[104:107]
ds_read_b64_tr_b16 v[212:213], v9 offset:8192
v_mfma_f32_16x16x32_bf16 v[124:127], v[236:239], a[20:23], v[124:127]
ds_read_b64_tr_b16 v[214:215], v9 offset:10240
v_mfma_f32_16x16x32_bf16 v[68:71], v[224:227], a[24:27], v[68:71]
ds_read_b64_tr_b16 v[216:217], v10 offset:8192
v_mfma_f32_16x16x32_bf16 v[88:91], v[228:231], a[24:27], v[88:91]
ds_read_b64_tr_b16 v[218:219], v10 offset:10240
v_mfma_f32_16x16x32_bf16 v[108:111], v[232:235], a[24:27], v[108:111]
ds_read_b64_tr_b16 v[220:221], v11 offset:8192
v_mfma_f32_16x16x32_bf16 v[128:131], v[236:239], a[24:27], v[128:131]
ds_read_b64_tr_b16 v[222:223], v11 offset:10240
v_mfma_f32_16x16x32_bf16 v[72:75], v[224:227], a[28:31], v[72:75]
buffer_load_dwordx4 v4, s[4:7], s28 offen offset:0 lds
v_mfma_f32_16x16x32_bf16 v[92:95], v[228:231], a[28:31], v[92:95]
buffer_load_dwordx4 v5, s[4:7], s28 offen offset:1024 lds
v_mfma_f32_16x16x32_bf16 v[112:115], v[232:235], a[28:31], v[112:115]
buffer_load_dwordx4 v6, s[4:7], s28 offen offset:2048 lds
v_mfma_f32_16x16x32_bf16 v[132:135], v[236:239], a[28:31], v[132:135]
buffer_load_dwordx4 v7, s[4:7], s28 offen offset:3072 lds
v_mfma_f32_16x16x32_bf16 v[76:79], v[224:227], a[32:35], v[76:79]
s_add_u32 s28, s28, 36864
v_mfma_f32_16x16x32_bf16 v[96:99], v[228:231], a[32:35], v[96:99]
buffer_load_dwordx4 a[0:3], v2, s[8:11], s29 offen offset:0
v_mfma_f32_16x16x32_bf16 v[116:119], v[232:235], a[32:35], v[116:119]
buffer_load_dwordx4 a[4:7], v2, s[8:11], s29 offen offset:1024
v_mfma_f32_16x16x32_bf16 v[136:139], v[236:239], a[32:35], v[136:139]
buffer_load_dwordx4 a[8:11], v2, s[8:11], s29 offen offset:2048
v_mfma_f32_16x16x32_bf16 v[80:83], v[224:227], a[36:39], v[80:83]
buffer_load_dwordx4 a[12:15], v2, s[8:11], s29 offen offset:3072
v_mfma_f32_16x16x32_bf16 v[100:103], v[228:231], a[36:39], v[100:103]
buffer_load_dwordx4 a[16:19], v3, s[8:11], s29 offen
v_mfma_f32_16x16x32_bf16 v[120:123], v[232:235], a[36:39], v[120:123]
s_add_u32 s29, s29, 131072
v_mfma_f32_16x16x32_bf16 v[140:143], v[236:239], a[36:39], v[140:143]
s_waitcnt lgkmcnt(0)
s_waitcnt vmcnt(18)
v_mfma_f32_16x16x32_bf16 v[64:67], v[208:211], a[40:43], v[64:67]
ds_read_b64_tr_b16 v[224:225], v8 offset:12288
s_add_u32 m0, s30, 8192
v_mfma_f32_16x16x32_bf16 v[84:87], v[212:215], a[40:43], v[84:87]
ds_read_b64_tr_b16 v[226:227], v8 offset:14336
v_mfma_f32_16x16x32_bf16 v[104:107], v[216:219], a[40:43], v[104:107]
ds_read_b64_tr_b16 v[228:229], v9 offset:12288
v_mfma_f32_16x16x32_bf16 v[124:127], v[220:223], a[40:43], v[124:127]
ds_read_b64_tr_b16 v[230:231], v9 offset:14336
v_mfma_f32_16x16x32_bf16 v[68:71], v[208:211], a[44:47], v[68:71]
ds_read_b64_tr_b16 v[232:233], v10 offset:12288
v_mfma_f32_16x16x32_bf16 v[88:91], v[212:215], a[44:47], v[88:91]
ds_read_b64_tr_b16 v[234:235], v10 offset:14336
v_mfma_f32_16x16x32_bf16 v[108:111], v[216:219], a[44:47], v[108:111]
ds_read_b64_tr_b16 v[236:237], v11 offset:12288
v_mfma_f32_16x16x32_bf16 v[128:131], v[220:223], a[44:47], v[128:131]
ds_read_b64_tr_b16 v[238:239], v11 offset:14336
v_mfma_f32_16x16x32_bf16 v[72:75], v[208:211], a[48:51], v[72:75]
buffer_load_dwordx4 v4, s[4:7], s28 offen offset:0 lds
v_mfma_f32_16x16x32_bf16 v[92:95], v[212:215], a[48:51], v[92:95]
buffer_load_dwordx4 v5, s[4:7], s28 offen offset:1024 lds
v_mfma_f32_16x16x32_bf16 v[112:115], v[216:219], a[48:51], v[112:115]
buffer_load_dwordx4 v6, s[4:7], s28 offen offset:2048 lds
v_mfma_f32_16x16x32_bf16 v[132:135], v[220:223], a[48:51], v[132:135]
buffer_load_dwordx4 v7, s[4:7], s28 offen offset:3072 lds
v_mfma_f32_16x16x32_bf16 v[76:79], v[208:211], a[52:55], v[76:79]
s_add_u32 s28, s28, 36864
v_mfma_f32_16x16x32_bf16 v[96:99], v[212:215], a[52:55], v[96:99]
buffer_load_dwordx4 a[20:23], v2, s[8:11], s29 offen offset:0
v_mfma_f32_16x16x32_bf16 v[116:119], v[216:219], a[52:55], v[116:119]
buffer_load_dwordx4 a[24:27], v2, s[8:11], s29 offen offset:1024
v_mfma_f32_16x16x32_bf16 v[136:139], v[220:223], a[52:55], v[136:139]
buffer_load_dwordx4 a[28:31], v2, s[8:11], s29 offen offset:2048
v_mfma_f32_16x16x32_bf16 v[80:83], v[208:211], a[56:59], v[80:83]
buffer_load_dwordx4 a[32:35], v2, s[8:11], s29 offen offset:3072
v_mfma_f32_16x16x32_bf16 v[100:103], v[212:215], a[56:59], v[100:103]
buffer_load_dwordx4 a[36:39], v3, s[8:11], s29 offen
v_mfma_f32_16x16x32_bf16 v[120:123], v[216:219], a[56:59], v[120:123]
s_add_u32 s29, s29, 131072
v_mfma_f32_16x16x32_bf16 v[140:143], v[220:223], a[56:59], v[140:143]
s_waitcnt lgkmcnt(0)
s_waitcnt vmcnt(18)
v_mfma_f32_16x16x32_bf16 v[64:67], v[224:227], a[60:63], v[64:67]
ds_read_b64_tr_b16 v[208:209], v8 offset:0
s_add_u32 m0, s30, 12288
v_mfma_f32_16x16x32_bf16 v[84:87], v[228:231], a[60:63], v[84:87]
ds_read_b64_tr_b16 v[210:211], v8 offset:2048
v_mfma_f32_16x16x32_bf16 v[104:107], v[232:235], a[60:63], v[104:107]
ds_read_b64_tr_b16 v[212:213], v9 offset:0
v_mfma_f32_16x16x32_bf16 v[124:127], v[236:239], a[60:63], v[124:127]
ds_read_b64_tr_b16 v[214:215], v9 offset:2048
v_mfma_f32_16x16x32_bf16 v[68:71], v[224:227], a[64:67], v[68:71]
ds_read_b64_tr_b16 v[216:217], v10 offset:0
v_mfma_f32_16x16x32_bf16 v[88:91], v[228:231], a[64:67], v[88:91]
ds_read_b64_tr_b16 v[218:219], v10 offset:2048
v_mfma_f32_16x16x32_bf16 v[108:111], v[232:235], a[64:67], v[108:111]
ds_read_b64_tr_b16 v[220:221], v11 offset:0
v_mfma_f32_16x16x32_bf16 v[128:131], v[236:239], a[64:67], v[128:131]
ds_read_b64_tr_b16 v[222:223], v11 offset:2048
v_mfma_f32_16x16x32_bf16 v[72:75], v[224:227], a[68:71], v[72:75]
buffer_load_dwordx4 v4, s[4:7], s28 offen offset:0 lds
v_mfma_f32_16x16x32_bf16 v[92:95], v[228:231], a[68:71], v[92:95]
buffer_load_dwordx4 v5, s[4:7], s28 offen offset:1024 lds
v_mfma_f32_16x16x32_bf16 v[112:115], v[232:235], a[68:71], v[112:115]
buffer_load_dwordx4 v6, s[4:7], s28 offen offset:2048 lds
v_mfma_f32_16x16x32_bf16 v[132:135], v[236:239], a[68:71], v[132:135]
buffer_load_dwordx4 v7, s[4:7], s28 offen offset:3072 lds
v_mfma_f32_16x16x32_bf16 v[76:79], v[224:227], a[72:75], v[76:79]
s_add_u32 s28, s28, 36864
v_mfma_f32_16x16x32_bf16 v[96:99], v[228:231], a[72:75], v[96:99]
buffer_load_dwordx4 a[40:43], v2, s[8:11], s29 offen offset:0
v_mfma_f32_16x16x32_bf16 v[116:119], v[232:235], a[72:75], v[116:119]
buffer_load_dwordx4 a[44:47], v2, s[8:11], s29 offen offset:1024
v_mfma_f32_16x16x32_bf16 v[136:139], v[236:239], a[72:75], v[136:139]
buffer_load_dwordx4 a[48:51], v2, s[8:11], s29 offen offset:2048
v_mfma_f32_16x16x32_bf16 v[80:83], v[224:227], a[76:79], v[80:83]
buffer_load_dwordx4 a[52:55], v2, s[8:11], s29 offen offset:3072
v_mfma_f32_16x16x32_bf16 v[100:103], v[228:231], a[76:79], v[100:103]
buffer_load_dwordx4 a[56:59], v3, s[8:11], s29 offen
v_mfma_f32_16x16x32_bf16 v[120:123], v[232:235], a[76:79], v[120:123]
s_add_u32 s29, s29, 131072
v_mfma_f32_16x16x32_bf16 v[140:143], v[236:239], a[76:79], v[140:143]
s_waitcnt lgkmcnt(0)
s_waitcnt vmcnt(18)
v_mfma_f32_16x16x32_bf16 v[64:67], v[208:211], a[0:3], v[64:67]
ds_read_b64_tr_b16 v[224:225], v8 offset:4096
s_add_u32 m0, s30, 0
v_mfma_f32_16x16x32_bf16 v[84:87], v[212:215], a[0:3], v[84:87]
ds_read_b64_tr_b16 v[226:227], v8 offset:6144
v_mfma_f32_16x16x32_bf16 v[104:107], v[216:219], a[0:3], v[104:107]
ds_read_b64_tr_b16 v[228:229], v9 offset:4096
v_mfma_f32_16x16x32_bf16 v[124:127], v[220:223], a[0:3], v[124:127]
ds_read_b64_tr_b16 v[230:231], v9 offset:6144
v_mfma_f32_16x16x32_bf16 v[68:71], v[208:211], a[4:7], v[68:71]
ds_read_b64_tr_b16 v[232:233], v10 offset:4096
v_mfma_f32_16x16x32_bf16 v[88:91], v[212:215], a[4:7], v[88:91]
ds_read_b64_tr_b16 v[234:235], v10 offset:6144
v_mfma_f32_16x16x32_bf16 v[108:111], v[216:219], a[4:7], v[108:111]
ds_read_b64_tr_b16 v[236:237], v11 offset:4096
v_mfma_f32_16x16x32_bf16 v[128:131], v[220:223], a[4:7], v[128:131]
ds_read_b64_tr_b16 v[238:239], v11 offset:6144
v_mfma_f32_16x16x32_bf16 v[72:75], v[208:211], a[8:11], v[72:75]
buffer_load_dwordx4 v4, s[4:7], s28 offen offset:0 lds
v_mfma_f32_16x16x32_bf16 v[92:95], v[212:215], a[8:11], v[92:95]
buffer_load_dwordx4 v5, s[4:7], s28 offen offset:1024 lds
v_mfma_f32_16x16x32_bf16 v[112:115], v[216:219], a[8:11], v[112:115]
buffer_load_dwordx4 v6, s[4:7], s28 offen offset:2048 lds
v_mfma_f32_16x16x32_bf16 v[132:135], v[220:223], a[8:11], v[132:135]
buffer_load_dwordx4 v7, s[4:7], s28 offen offset:3072 lds
v_mfma_f32_16x16x32_bf16 v[76:79], v[208:211], a[12:15], v[76:79]
s_add_u32 s28, s28, 36864
v_mfma_f32_16x16x32_bf16 v[96:99], v[212:215], a[12:15], v[96:99]
buffer_load_dwordx4 a[60:63], v2, s[8:11], s29 offen offset:0
v_mfma_f32_16x16x32_bf16 v[116:119], v[216:219], a[12:15], v[116:119]
buffer_load_dwordx4 a[64:67], v2, s[8:11], s29 offen offset:1024
v_mfma_f32_16x16x32_bf16 v[136:139], v[220:223], a[12:15], v[136:139]
buffer_load_dwordx4 a[68:71], v2, s[8:11], s29 offen offset:2048
v_mfma_f32_16x16x32_bf16 v[80:83], v[208:211], a[16:19], v[80:83]
buffer_load_dwordx4 a[72:75], v2, s[8:11], s29 offen offset:3072
v_mfma_f32_16x16x32_bf16 v[100:103], v[212:215], a[16:19], v[100:103]
buffer_load_dwordx4 a[76:79], v3, s[8:11], s29 offen
v_mfma_f32_16x16x32_bf16 v[120:123], v[216:219], a[16:19], v[120:123]
s_add_u32 s29, s29, 131072
v_mfma_f32_16x16x32_bf16 v[140:143], v[220:223], a[16:19], v[140:143]
s_waitcnt lgkmcnt(0)
s_waitcnt vmcnt(18)
v_mfma_f32_16x16x32_bf16 v[64:67], v[224:227], a[20:23], v[64:67]
ds_read_b64_tr_b16 v[208:209], v8 offset:8192
s_add_u32 m0, s30, 4096
v_mfma_f32_16x16x32_bf16 v[84:87], v[228:231], a[20:23], v[84:87]
ds_read_b64_tr_b16 v[210:211], v8 offset:10240
v_mfma_f32_16x16x32_bf16 v[104:107], v[232:235], a[20:23], v[104:107]
ds_read_b64_tr_b16 v[212:213], v9 offset:8192
v_mfma_f32_16x16x32_bf16 v[124:127], v[236:239], a[20:23], v[124:127]
ds_read_b64_tr_b16 v[214:215], v9 offset:10240
v_mfma_f32_16x16x32_bf16 v[68:71], v[224:227], a[24:27], v[68:71]
ds_read_b64_tr_b16 v[216:217], v10 offset:8192
v_mfma_f32_16x16x32_bf16 v[88:91], v[228:231], a[24:27], v[88:91]
ds_read_b64_tr_b16 v[218:219], v10 offset:10240
v_mfma_f32_16x16x32_bf16 v[108:111], v[232:235], a[24:27], v[108:111]
tp3_p1:
s_cbranch_execz tp3_ret
ds_read_b64_tr_b16 v[220:221], v11 offset:8192
tf_p13:
s_cbranch_execz k12_kernel_end
v_mfma_f32_16x16x32_bf16 v[128:131], v[236:239], a[24:27], v[128:131]
ds_read_b64_tr_b16 v[222:223], v11 offset:10240
v_mfma_f32_16x16x32_bf16 v[72:75], v[224:227], a[28:31], v[72:75]
buffer_load_dwordx4 v4, s[4:7], s28 offen offset:0 lds
v_mfma_f32_16x16x32_bf16 v[92:95], v[228:231], a[28:31], v[92:95]
buffer_load_dwordx4 v5, s[4:7], s28 offen offset:1024 lds
v_mfma_f32_16x16x32_bf16 v[112:115], v[232:235], a[28:31], v[112:115]
buffer_load_dwordx4 v6, s[4:7], s28 offen offset:2048 lds
v_mfma_f32_16x16x32_bf16 v[132:135], v[236:239], a[28:31], v[132:135]
buffer_load_dwordx4 v7, s[4:7], s28 offen offset:3072 lds
v_mfma_f32_16x16x32_bf16 v[76:79], v[224:227], a[32:35], v[76:79]
s_add_u32 s28, s28, 36864
v_mfma_f32_16x16x32_bf16 v[96:99], v[228:231], a[32:35], v[96:99]
buffer_load_dwordx4 a[0:3], v2, s[8:11], s29 offen offset:0
v_mfma_f32_16x16x32_bf16 v[116:119], v[232:235], a[32:35], v[116:119]
buffer_load_dwordx4 a[4:7], v2, s[8:11], s29 offen offset:1024
v_mfma_f32_16x16x32_bf16 v[136:139], v[236:239], a[32:35], v[136:139]
buffer_load_dwordx4 a[8:11], v2, s[8:11], s29 offen offset:2048
v_mfma_f32_16x16x32_bf16 v[80:83], v[224:227], a[36:39], v[80:83]
buffer_load_dwordx4 a[12:15], v2, s[8:11], s29 offen offset:3072
v_mfma_f32_16x16x32_bf16 v[100:103], v[228:231], a[36:39], v[100:103]
buffer_load_dwordx4 a[16:19], v3, s[8:11], s29 offen
v_mfma_f32_16x16x32_bf16 v[120:123], v[232:235], a[36:39], v[120:123]
s_add_u32 s29, s29, 131072
v_mfma_f32_16x16x32_bf16 v[140:143], v[236:239], a[36:39], v[140:143]
s_waitcnt lgkmcnt(0)
s_waitcnt vmcnt(18)
v_mfma_f32_16x16x32_bf16 v[64:67], v[208:211], a[40:43], v[64:67]
ds_read_b64_tr_b16 v[224:225], v8 offset:12288
s_add_u32 m0, s30, 8192
v_mfma_f32_16x16x32_bf16 v[84:87], v[212:215], a[40:43], v[84:87]
ds_read_b64_tr_b16 v[226:227], v8 offset:14336
v_mfma_f32_16x16x32_bf16 v[104:107], v[216:219], a[40:43], v[104:107]
ds_read_b64_tr_b16 v[228:229], v9 offset:12288
v_mfma_f32_16x16x32_bf16 v[124:127], v[220:223], a[40:43], v[124:127]
ds_read_b64_tr_b16 v[230:231], v9 offset:14336
v_mfma_f32_16x16x32_bf16 v[68:71], v[208:211], a[44:47], v[68:71]
ds_read_b64_tr_b16 v[232:233], v10 offset:12288
v_mfma_f32_16x16x32_bf16 v[88:91], v[212:215], a[44:47], v[88:91]
ds_read_b64_tr_b16 v[234:235], v10 offset:14336
v_mfma_f32_16x16x32_bf16 v[108:111], v[216:219], a[44:47], v[108:111]
ds_read_b64_tr_b16 v[236:237], v11 offset:12288
v_mfma_f32_16x16x32_bf16 v[128:131], v[220:223], a[44:47], v[128:131]
ds_read_b64_tr_b16 v[238:239], v11 offset:14336
v_mfma_f32_16x16x32_bf16 v[72:75], v[208:211], a[48:51], v[72:75]
buffer_load_dwordx4 v4, s[4:7], s28 offen offset:0 lds
v_mfma_f32_16x16x32_bf16 v[92:95], v[212:215], a[48:51], v[92:95]
buffer_load_dwordx4 v5, s[4:7], s28 offen offset:1024 lds
v_mfma_f32_16x16x32_bf16 v[112:115], v[216:219], a[48:51], v[112:115]
buffer_load_dwordx4 v6, s[4:7], s28 offen offset:2048 lds
v_mfma_f32_16x16x32_bf16 v[132:135], v[220:223], a[48:51], v[132:135]
buffer_load_dwordx4 v7, s[4:7], s28 offen offset:3072 lds
v_mfma_f32_16x16x32_bf16 v[76:79], v[208:211], a[52:55], v[76:79]
s_add_u32 s28, s28, 36864
v_mfma_f32_16x16x32_bf16 v[96:99], v[212:215], a[52:55], v[96:99]
buffer_load_dwordx4 a[20:23], v2, s[8:11], s29 offen offset:0
v_mfma_f32_16x16x32_bf16 v[116:119], v[216:219], a[52:55], v[116:119]
buffer_load_dwordx4 a[24:27], v2, s[8:11], s29 offen offset:1024
v_mfma_f32_16x16x32_bf16 v[136:139], v[220:223], a[52:55], v[136:139]
buffer_load_dwordx4 a[28:31], v2, s[8:11], s29 offen offset:2048
v_mfma_f32_16x16x32_bf16 v[80:83], v[208:211], a[56:59], v[80:83]
buffer_load_dwordx4 a[32:35], v2, s[8:11], s29 offen offset:3072
v_mfma_f32_16x16x32_bf16 v[100:103], v[212:215], a[56:59], v[100:103]
buffer_load_dwordx4 a[36:39], v3, s[8:11], s29 offen
v_mfma_f32_16x16x32_bf16 v[120:123], v[216:219], a[56:59], v[120:123]
s_add_u32 s29, s29, 131072
v_mfma_f32_16x16x32_bf16 v[140:143], v[220:223], a[56:59], v[140:143]
s_waitcnt lgkmcnt(0)
s_waitcnt vmcnt(18)
v_mfma_f32_16x16x32_bf16 v[64:67], v[224:227], a[60:63], v[64:67]
ds_read_b64_tr_b16 v[208:209], v8 offset:0
s_add_u32 m0, s30, 12288
v_mfma_f32_16x16x32_bf16 v[84:87], v[228:231], a[60:63], v[84:87]
ds_read_b64_tr_b16 v[210:211], v8 offset:2048
v_mfma_f32_16x16x32_bf16 v[104:107], v[232:235], a[60:63], v[104:107]
ds_read_b64_tr_b16 v[212:213], v9 offset:0
v_mfma_f32_16x16x32_bf16 v[124:127], v[236:239], a[60:63], v[124:127]
ds_read_b64_tr_b16 v[214:215], v9 offset:2048
v_mfma_f32_16x16x32_bf16 v[68:71], v[224:227], a[64:67], v[68:71]
ds_read_b64_tr_b16 v[216:217], v10 offset:0
v_mfma_f32_16x16x32_bf16 v[88:91], v[228:231], a[64:67], v[88:91]
ds_read_b64_tr_b16 v[218:219], v10 offset:2048
v_mfma_f32_16x16x32_bf16 v[108:111], v[232:235], a[64:67], v[108:111]
ds_read_b64_tr_b16 v[220:221], v11 offset:0
v_mfma_f32_16x16x32_bf16 v[128:131], v[236:239], a[64:67], v[128:131]
ds_read_b64_tr_b16 v[222:223], v11 offset:2048
v_mfma_f32_16x16x32_bf16 v[72:75], v[224:227], a[68:71], v[72:75]
buffer_load_dwordx4 v4, s[4:7], s28 offen offset:0 lds
v_mfma_f32_16x16x32_bf16 v[92:95], v[228:231], a[68:71], v[92:95]
buffer_load_dwordx4 v5, s[4:7], s28 offen offset:1024 lds
v_mfma_f32_16x16x32_bf16 v[112:115], v[232:235], a[68:71], v[112:115]
buffer_load_dwordx4 v6, s[4:7], s28 offen offset:2048 lds
v_mfma_f32_16x16x32_bf16 v[132:135], v[236:239], a[68:71], v[132:135]
buffer_load_dwordx4 v7, s[4:7], s28 offen offset:3072 lds
v_mfma_f32_16x16x32_bf16 v[76:79], v[224:227], a[72:75], v[76:79]
s_add_u32 s28, s28, 36864
v_mfma_f32_16x16x32_bf16 v[96:99], v[228:231], a[72:75], v[96:99]
buffer_load_dwordx4 a[40:43], v2, s[8:11], s29 offen offset:0
v_mfma_f32_16x16x32_bf16 v[116:119], v[232:235], a[72:75], v[116:119]
buffer_load_dwordx4 a[44:47], v2, s[8:11], s29 offen offset:1024
v_mfma_f32_16x16x32_bf16 v[136:139], v[236:239], a[72:75], v[136:139]
buffer_load_dwordx4 a[48:51], v2, s[8:11], s29 offen offset:2048
v_mfma_f32_16x16x32_bf16 v[80:83], v[224:227], a[76:79], v[80:83]
buffer_load_dwordx4 a[52:55], v2, s[8:11], s29 offen offset:3072
v_mfma_f32_16x16x32_bf16 v[100:103], v[228:231], a[76:79], v[100:103]
buffer_load_dwordx4 a[56:59], v3, s[8:11], s29 offen
v_mfma_f32_16x16x32_bf16 v[120:123], v[232:235], a[76:79], v[120:123]
s_add_u32 s29, s29, 131072
v_mfma_f32_16x16x32_bf16 v[140:143], v[236:239], a[76:79], v[140:143]
s_waitcnt lgkmcnt(0)
s_waitcnt vmcnt(18)
v_mfma_f32_16x16x32_bf16 v[64:67], v[208:211], a[0:3], v[64:67]
ds_read_b64_tr_b16 v[224:225], v8 offset:4096
s_add_u32 m0, s30, 0
v_mfma_f32_16x16x32_bf16 v[84:87], v[212:215], a[0:3], v[84:87]
ds_read_b64_tr_b16 v[226:227], v8 offset:6144
v_mfma_f32_16x16x32_bf16 v[104:107], v[216:219], a[0:3], v[104:107]
ds_read_b64_tr_b16 v[228:229], v9 offset:4096
v_mfma_f32_16x16x32_bf16 v[124:127], v[220:223], a[0:3], v[124:127]
ds_read_b64_tr_b16 v[230:231], v9 offset:6144
v_mfma_f32_16x16x32_bf16 v[68:71], v[208:211], a[4:7], v[68:71]
ds_read_b64_tr_b16 v[232:233], v10 offset:4096
v_mfma_f32_16x16x32_bf16 v[88:91], v[212:215], a[4:7], v[88:91]
ds_read_b64_tr_b16 v[234:235], v10 offset:6144
v_mfma_f32_16x16x32_bf16 v[108:111], v[216:219], a[4:7], v[108:111]
ds_read_b64_tr_b16 v[236:237], v11 offset:4096
v_mfma_f32_16x16x32_bf16 v[128:131], v[220:223], a[4:7], v[128:131]
ds_read_b64_tr_b16 v[238:239], v11 offset:6144
v_mfma_f32_16x16x32_bf16 v[72:75], v[208:211], a[8:11], v[72:75]
buffer_load_dwordx4 v4, s[4:7], s28 offen offset:0 lds
v_mfma_f32_16x16x32_bf16 v[92:95], v[212:215], a[8:11], v[92:95]
buffer_load_dwordx4 v5, s[4:7], s28 offen offset:1024 lds
v_mfma_f32_16x16x32_bf16 v[112:115], v[216:219], a[8:11], v[112:115]
buffer_load_dwordx4 v6, s[4:7], s28 offen offset:2048 lds
v_mfma_f32_16x16x32_bf16 v[132:135], v[220:223], a[8:11], v[132:135]
buffer_load_dwordx4 v7, s[4:7], s28 offen offset:3072 lds
v_mfma_f32_16x16x32_bf16 v[76:79], v[208:211], a[12:15], v[76:79]
s_add_u32 s28, s28, 36864
v_mfma_f32_16x16x32_bf16 v[96:99], v[212:215], a[12:15], v[96:99]
buffer_load_dwordx4 a[60:63], v2, s[8:11], s29 offen offset:0
v_mfma_f32_16x16x32_bf16 v[116:119], v[216:219], a[12:15], v[116:119]
buffer_load_dwordx4 a[64:67], v2, s[8:11], s29 offen offset:1024
v_mfma_f32_16x16x32_bf16 v[136:139], v[220:223], a[12:15], v[136:139]
buffer_load_dwordx4 a[68:71], v2, s[8:11], s29 offen offset:2048
v_mfma_f32_16x16x32_bf16 v[80:83], v[208:211], a[16:19], v[80:83]
buffer_load_dwordx4 a[72:75], v2, s[8:11], s29 offen offset:3072
v_mfma_f32_16x16x32_bf16 v[100:103], v[212:215], a[16:19], v[100:103]
buffer_load_dwordx4 a[76:79], v3, s[8:11], s29 offen
v_mfma_f32_16x16x32_bf16 v[120:123], v[216:219], a[16:19], v[120:123]
s_add_u32 s29, s29, 131072
v_mfma_f32_16x16x32_bf16 v[140:143], v[220:223], a[16:19], v[140:143]
s_waitcnt lgkmcnt(0)
s_waitcnt vmcnt(18)
v_mfma_f32_16x16x32_bf16 v[64:67], v[224:227], a[20:23], v[64:67]
ds_read_b64_tr_b16 v[208:209], v8 offset:8192
s_add_u32 m0, s30, 4096
v_mfma_f32_16x16x32_bf16 v[84:87], v[228:231], a[20:23], v[84:87]
ds_read_b64_tr_b16 v[210:211], v8 offset:10240
v_mfma_f32_16x16x32_bf16 v[104:107], v[232:235], a[20:23], v[104:107]
ds_read_b64_tr_b16 v[212:213], v9 offset:8192
v_mfma_f32_16x16x32_bf16 v[124:127], v[236:239], a[20:23], v[124:127]
ds_read_b64_tr_b16 v[214:215], v9 offset:10240
v_mfma_f32_16x16x32_bf16 v[68:71], v[224:227], a[24:27], v[68:71]
ds_read_b64_tr_b16 v[216:217], v10 offset:8192
v_mfma_f32_16x16x32_bf16 v[88:91], v[228:231], a[24:27], v[88:91]
ds_read_b64_tr_b16 v[218:219], v10 offset:10240
v_mfma_f32_16x16x32_bf16 v[108:111], v[232:235], a[24:27], v[108:111]
ds_read_b64_tr_b16 v[220:221], v11 offset:8192
v_mfma_f32_16x16x32_bf16 v[128:131], v[236:239], a[24:27], v[128:131]
ds_read_b64_tr_b16 v[222:223], v11 offset:10240
v_mfma_f32_16x16x32_bf16 v[72:75], v[224:227], a[28:31], v[72:75]
buffer_load_dwordx4 v4, s[4:7], s28 offen offset:0 lds
v_mfma_f32_16x16x32_bf16 v[92:95], v[228:231], a[28:31], v[92:95]
buffer_load_dwordx4 v5, s[4:7], s28 offen offset:1024 lds
v_mfma_f32_16x16x32_bf16 v[112:115], v[232:235], a[28:31], v[112:115]
buffer_load_dwordx4 v6, s[4:7], s28 offen offset:2048 lds
v_mfma_f32_16x16x32_bf16 v[132:135], v[236:239], a[28:31], v[132:135]
buffer_load_dwordx4 v7, s[4:7], s28 offen offset:3072 lds
v_mfma_f32_16x16x32_bf16 v[76:79], v[224:227], a[32:35], v[76:79]
s_add_u32 s28, s28, 36864
v_mfma_f32_16x16x32_bf16 v[96:99], v[228:231], a[32:35], v[96:99]
buffer_load_dwordx4 a[0:3], v2, s[8:11], s29 offen offset:0
v_mfma_f32_16x16x32_bf16 v[116:119], v[232:235], a[32:35], v[116:119]
buffer_load_dwordx4 a[4:7], v2, s[8:11], s29 offen offset:1024
v_mfma_f32_16x16x32_bf16 v[136:139], v[236:239], a[32:35], v[136:139]
buffer_load_dwordx4 a[8:11], v2, s[8:11], s29 offen offset:2048
v_mfma_f32_16x16x32_bf16 v[80:83], v[224:227], a[36:39], v[80:83]
buffer_load_dwordx4 a[12:15], v2, s[8:11], s29 offen offset:3072
v_mfma_f32_16x16x32_bf16 v[100:103], v[228:231], a[36:39], v[100:103]
buffer_load_dwordx4 a[16:19], v3, s[8:11], s29 offen
v_mfma_f32_16x16x32_bf16 v[120:123], v[232:235], a[36:39], v[120:123]
s_add_u32 s29, s29, 131072
v_mfma_f32_16x16x32_bf16 v[140:143], v[236:239], a[36:39], v[140:143]
s_waitcnt lgkmcnt(0)
s_waitcnt vmcnt(18)
v_mfma_f32_16x16x32_bf16 v[64:67], v[208:211], a[40:43], v[64:67]
ds_read_b64_tr_b16 v[224:225], v8 offset:12288
s_add_u32 m0, s30, 8192
v_mfma_f32_16x16x32_bf16 v[84:87], v[212:215], a[40:43], v[84:87]
ds_read_b64_tr_b16 v[226:227], v8 offset:14336
v_mfma_f32_16x16x32_bf16 v[104:107], v[216:219], a[40:43], v[104:107]
ds_read_b64_tr_b16 v[228:229], v9 offset:12288
v_mfma_f32_16x16x32_bf16 v[124:127], v[220:223], a[40:43], v[124:127]
ds_read_b64_tr_b16 v[230:231], v9 offset:14336
v_mfma_f32_16x16x32_bf16 v[68:71], v[208:211], a[44:47], v[68:71]
ds_read_b64_tr_b16 v[232:233], v10 offset:12288
v_mfma_f32_16x16x32_bf16 v[88:91], v[212:215], a[44:47], v[88:91]
ds_read_b64_tr_b16 v[234:235], v10 offset:14336
v_mfma_f32_16x16x32_bf16 v[108:111], v[216:219], a[44:47], v[108:111]
ds_read_b64_tr_b16 v[236:237], v11 offset:12288
v_mfma_f32_16x16x32_bf16 v[128:131], v[220:223], a[44:47], v[128:131]
ds_read_b64_tr_b16 v[238:239], v11 offset:14336
v_mfma_f32_16x16x32_bf16 v[72:75], v[208:211], a[48:51], v[72:75]
buffer_load_dwordx4 v4, s[4:7], s28 offen offset:0 lds
v_mfma_f32_16x16x32_bf16 v[92:95], v[212:215], a[48:51], v[92:95]
buffer_load_dwordx4 v5, s[4:7], s28 offen offset:1024 lds
v_mfma_f32_16x16x32_bf16 v[112:115], v[216:219], a[48:51], v[112:115]
buffer_load_dwordx4 v6, s[4:7], s28 offen offset:2048 lds
v_mfma_f32_16x16x32_bf16 v[132:135], v[220:223], a[48:51], v[132:135]
buffer_load_dwordx4 v7, s[4:7], s28 offen offset:3072 lds
v_mfma_f32_16x16x32_bf16 v[76:79], v[208:211], a[52:55], v[76:79]
s_add_u32 s28, s28, 36864
v_mfma_f32_16x16x32_bf16 v[96:99], v[212:215], a[52:55], v[96:99]
buffer_load_dwordx4 a[20:23], v2, s[8:11], s29 offen offset:0
v_mfma_f32_16x16x32_bf16 v[116:119], v[216:219], a[52:55], v[116:119]
buffer_load_dwordx4 a[24:27], v2, s[8:11], s29 offen offset:1024
v_mfma_f32_16x16x32_bf16 v[136:139], v[220:223], a[52:55], v[136:139]
buffer_load_dwordx4 a[28:31], v2, s[8:11], s29 offen offset:2048
v_mfma_f32_16x16x32_bf16 v[80:83], v[208:211], a[56:59], v[80:83]
buffer_load_dwordx4 a[32:35], v2, s[8:11], s29 offen offset:3072
v_mfma_f32_16x16x32_bf16 v[100:103], v[212:215], a[56:59], v[100:103]
buffer_load_dwordx4 a[36:39], v3, s[8:11], s29 offen
v_mfma_f32_16x16x32_bf16 v[120:123], v[216:219], a[56:59], v[120:123]
s_add_u32 s29, s29, 131072
v_mfma_f32_16x16x32_bf16 v[140:143], v[220:223], a[56:59], v[140:143]
s_waitcnt lgkmcnt(0)
s_waitcnt vmcnt(18)
v_mfma_f32_16x16x32_bf16 v[64:67], v[224:227], a[60:63], v[64:67]
ds_read_b64_tr_b16 v[208:209], v8 offset:0
s_add_u32 m0, s30, 12288
v_mfma_f32_16x16x32_bf16 v[84:87], v[228:231], a[60:63], v[84:87]
ds_read_b64_tr_b16 v[210:211], v8 offset:2048
v_mfma_f32_16x16x32_bf16 v[104:107], v[232:235], a[60:63], v[104:107]
ds_read_b64_tr_b16 v[212:213], v9 offset:0
v_mfma_f32_16x16x32_bf16 v[124:127], v[236:239], a[60:63], v[124:127]
ds_read_b64_tr_b16 v[214:215], v9 offset:2048
v_mfma_f32_16x16x32_bf16 v[68:71], v[224:227], a[64:67], v[68:71]
ds_read_b64_tr_b16 v[216:217], v10 offset:0
v_mfma_f32_16x16x32_bf16 v[88:91], v[228:231], a[64:67], v[88:91]
ds_read_b64_tr_b16 v[218:219], v10 offset:2048
v_mfma_f32_16x16x32_bf16 v[108:111], v[232:235], a[64:67], v[108:111]
ds_read_b64_tr_b16 v[220:221], v11 offset:0
v_mfma_f32_16x16x32_bf16 v[128:131], v[236:239], a[64:67], v[128:131]
ds_read_b64_tr_b16 v[222:223], v11 offset:2048
v_mfma_f32_16x16x32_bf16 v[72:75], v[224:227], a[68:71], v[72:75]
buffer_load_dwordx4 v4, s[4:7], s28 offen offset:0 lds
v_mfma_f32_16x16x32_bf16 v[92:95], v[228:231], a[68:71], v[92:95]
buffer_load_dwordx4 v5, s[4:7], s28 offen offset:1024 lds
v_mfma_f32_16x16x32_bf16 v[112:115], v[232:235], a[68:71], v[112:115]
buffer_load_dwordx4 v6, s[4:7], s28 offen offset:2048 lds
v_mfma_f32_16x16x32_bf16 v[132:135], v[236:239], a[68:71], v[132:135]
buffer_load_dwordx4 v7, s[4:7], s28 offen offset:3072 lds
v_mfma_f32_16x16x32_bf16 v[76:79], v[224:227], a[72:75], v[76:79]
s_add_u32 s28, s28, 36864
v_mfma_f32_16x16x32_bf16 v[96:99], v[228:231], a[72:75], v[96:99]
buffer_load_dwordx4 a[40:43], v2, s[8:11], s29 offen offset:0
v_mfma_f32_16x16x32_bf16 v[116:119], v[232:235], a[72:75], v[116:119]
buffer_load_dwordx4 a[44:47], v2, s[8:11], s29 offen offset:1024
v_mfma_f32_16x16x32_bf16 v[136:139], v[236:239], a[72:75], v[136:139]
buffer_load_dwordx4 a[48:51], v2, s[8:11], s29 offen offset:2048
v_mfma_f32_16x16x32_bf16 v[80:83], v[224:227], a[76:79], v[80:83]
buffer_load_dwordx4 a[52:55], v2, s[8:11], s29 offen offset:3072
v_mfma_f32_16x16x32_bf16 v[100:103], v[228:231], a[76:79], v[100:103]
buffer_load_dwordx4 a[56:59], v3, s[8:11], s29 offen
v_mfma_f32_16x16x32_bf16 v[120:123], v[232:235], a[76:79], v[120:123]
s_add_u32 s29, s29, 131072
v_mfma_f32_16x16x32_bf16 v[140:143], v[236:239], a[76:79], v[140:143]
s_waitcnt lgkmcnt(0)
s_waitcnt vmcnt(18)
v_mfma_f32_16x16x32_bf16 v[64:67], v[208:211], a[0:3], v[64:67]
ds_read_b64_tr_b16 v[224:225], v8 offset:4096
s_add_u32 m0, s30, 0
v_mfma_f32_16x16x32_bf16 v[84:87], v[212:215], a[0:3], v[84:87]
ds_read_b64_tr_b16 v[226:227], v8 offset:6144
v_mfma_f32_16x16x32_bf16 v[104:107], v[216:219], a[0:3], v[104:107]
ds_read_b64_tr_b16 v[228:229], v9 offset:4096
v_mfma_f32_16x16x32_bf16 v[124:127], v[220:223], a[0:3], v[124:127]
ds_read_b64_tr_b16 v[230:231], v9 offset:6144
v_mfma_f32_16x16x32_bf16 v[68:71], v[208:211], a[4:7], v[68:71]
ds_read_b64_tr_b16 v[232:233], v10 offset:4096
v_mfma_f32_16x16x32_bf16 v[88:91], v[212:215], a[4:7], v[88:91]
ds_read_b64_tr_b16 v[234:235], v10 offset:6144
v_mfma_f32_16x16x32_bf16 v[108:111], v[216:219], a[4:7], v[108:111]
ds_read_b64_tr_b16 v[236:237], v11 offset:4096
v_mfma_f32_16x16x32_bf16 v[128:131], v[220:223], a[4:7], v[128:131]
ds_read_b64_tr_b16 v[238:239], v11 offset:6144
v_mfma_f32_16x16x32_bf16 v[72:75], v[208:211], a[8:11], v[72:75]
buffer_load_dwordx4 v4, s[4:7], s28 offen offset:0 lds
v_mfma_f32_16x16x32_bf16 v[92:95], v[212:215], a[8:11], v[92:95]
buffer_load_dwordx4 v5, s[4:7], s28 offen offset:1024 lds
v_mfma_f32_16x16x32_bf16 v[112:115], v[216:219], a[8:11], v[112:115]
buffer_load_dwordx4 v6, s[4:7], s28 offen offset:2048 lds
v_mfma_f32_16x16x32_bf16 v[132:135], v[220:223], a[8:11], v[132:135]
buffer_load_dwordx4 v7, s[4:7], s28 offen offset:3072 lds
v_mfma_f32_16x16x32_bf16 v[76:79], v[208:211], a[12:15], v[76:79]
s_add_u32 s28, s28, 36864
v_mfma_f32_16x16x32_bf16 v[96:99], v[212:215], a[12:15], v[96:99]
buffer_load_dwordx4 a[60:63], v2, s[8:11], s29 offen offset:0
v_mfma_f32_16x16x32_bf16 v[116:119], v[216:219], a[12:15], v[116:119]
buffer_load_dwordx4 a[64:67], v2, s[8:11], s29 offen offset:1024
v_mfma_f32_16x16x32_bf16 v[136:139], v[220:223], a[12:15], v[136:139]
buffer_load_dwordx4 a[68:71], v2, s[8:11], s29 offen offset:2048
v_mfma_f32_16x16x32_bf16 v[80:83], v[208:211], a[16:19], v[80:83]
buffer_load_dwordx4 a[72:75], v2, s[8:11], s29 offen offset:3072
v_mfma_f32_16x16x32_bf16 v[100:103], v[212:215], a[16:19], v[100:103]
buffer_load_dwordx4 a[76:79], v3, s[8:11], s29 offen
v_mfma_f32_16x16x32_bf16 v[120:123], v[216:219], a[16:19], v[120:123]
s_add_u32 s29, s29, 131072
v_mfma_f32_16x16x32_bf16 v[140:143], v[220:223], a[16:19], v[140:143]
s_waitcnt lgkmcnt(0)
s_waitcnt vmcnt(18)
v_mfma_f32_16x16x32_bf16 v[64:67], v[224:227], a[20:23], v[64:67]
ds_read_b64_tr_b16 v[208:209], v8 offset:8192
s_add_u32 m0, s30, 4096
v_mfma_f32_16x16x32_bf16 v[84:87], v[228:231], a[20:23], v[84:87]
ds_read_b64_tr_b16 v[210:211], v8 offset:10240
v_mfma_f32_16x16x32_bf16 v[104:107], v[232:235], a[20:23], v[104:107]
ds_read_b64_tr_b16 v[212:213], v9 offset:8192
v_mfma_f32_16x16x32_bf16 v[124:127], v[236:239], a[20:23], v[124:127]
ds_read_b64_tr_b16 v[214:215], v9 offset:10240
v_mfma_f32_16x16x32_bf16 v[68:71], v[224:227], a[24:27], v[68:71]
ds_read_b64_tr_b16 v[216:217], v10 offset:8192
v_mfma_f32_16x16x32_bf16 v[88:91], v[228:231], a[24:27], v[88:91]
ds_read_b64_tr_b16 v[218:219], v10 offset:10240
v_mfma_f32_16x16x32_bf16 v[108:111], v[232:235], a[24:27], v[108:111]
ds_read_b64_tr_b16 v[220:221], v11 offset:8192
v_mfma_f32_16x16x32_bf16 v[128:131], v[236:239], a[24:27], v[128:131]
ds_read_b64_tr_b16 v[222:223], v11 offset:10240
v_mfma_f32_16x16x32_bf16 v[72:75], v[224:227], a[28:31], v[72:75]
buffer_load_dwordx4 v4, s[4:7], s28 offen offset:0 lds
v_mfma_f32_16x16x32_bf16 v[92:95], v[228:231], a[28:31], v[92:95]
buffer_load_dwordx4 v5, s[4:7], s28 offen offset:1024 lds
v_mfma_f32_16x16x32_bf16 v[112:115], v[232:235], a[28:31], v[112:115]
buffer_load_dwordx4 v6, s[4:7], s28 offen offset:2048 lds
v_mfma_f32_16x16x32_bf16 v[132:135], v[236:239], a[28:31], v[132:135]
buffer_load_dwordx4 v7, s[4:7], s28 offen offset:3072 lds
v_mfma_f32_16x16x32_bf16 v[76:79], v[224:227], a[32:35], v[76:79]
s_add_u32 s28, s28, 36864
v_mfma_f32_16x16x32_bf16 v[96:99], v[228:231], a[32:35], v[96:99]
buffer_load_dwordx4 a[0:3], v2, s[8:11], s29 offen offset:0
v_mfma_f32_16x16x32_bf16 v[116:119], v[232:235], a[32:35], v[116:119]
buffer_load_dwordx4 a[4:7], v2, s[8:11], s29 offen offset:1024
v_mfma_f32_16x16x32_bf16 v[136:139], v[236:239], a[32:35], v[136:139]
buffer_load_dwordx4 a[8:11], v2, s[8:11], s29 offen offset:2048
v_mfma_f32_16x16x32_bf16 v[80:83], v[224:227], a[36:39], v[80:83]
buffer_load_dwordx4 a[12:15], v2, s[8:11], s29 offen offset:3072
v_mfma_f32_16x16x32_bf16 v[100:103], v[228:231], a[36:39], v[100:103]
buffer_load_dwordx4 a[16:19], v3, s[8:11], s29 offen
v_mfma_f32_16x16x32_bf16 v[120:123], v[232:235], a[36:39], v[120:123]
s_add_u32 s29, s29, 131072
v_mfma_f32_16x16x32_bf16 v[140:143], v[236:239], a[36:39], v[140:143]
s_waitcnt lgkmcnt(0)
s_waitcnt vmcnt(18)
v_mfma_f32_16x16x32_bf16 v[64:67], v[208:211], a[40:43], v[64:67]
ds_read_b64_tr_b16 v[224:225], v8 offset:12288
s_add_u32 m0, s30, 8192
v_mfma_f32_16x16x32_bf16 v[84:87], v[212:215], a[40:43], v[84:87]
ds_read_b64_tr_b16 v[226:227], v8 offset:14336
v_mfma_f32_16x16x32_bf16 v[104:107], v[216:219], a[40:43], v[104:107]
ds_read_b64_tr_b16 v[228:229], v9 offset:12288
v_mfma_f32_16x16x32_bf16 v[124:127], v[220:223], a[40:43], v[124:127]
ds_read_b64_tr_b16 v[230:231], v9 offset:14336
v_mfma_f32_16x16x32_bf16 v[68:71], v[208:211], a[44:47], v[68:71]
ds_read_b64_tr_b16 v[232:233], v10 offset:12288
v_mfma_f32_16x16x32_bf16 v[88:91], v[212:215], a[44:47], v[88:91]
ds_read_b64_tr_b16 v[234:235], v10 offset:14336
v_mfma_f32_16x16x32_bf16 v[108:111], v[216:219], a[44:47], v[108:111]
ds_read_b64_tr_b16 v[236:237], v11 offset:12288
v_mfma_f32_16x16x32_bf16 v[128:131], v[220:223], a[44:47], v[128:131]
ds_read_b64_tr_b16 v[238:239], v11 offset:14336
v_mfma_f32_16x16x32_bf16 v[72:75], v[208:211], a[48:51], v[72:75]
buffer_load_dwordx4 v4, s[4:7], s28 offen offset:0 lds
v_mfma_f32_16x16x32_bf16 v[92:95], v[212:215], a[48:51], v[92:95]
buffer_load_dwordx4 v5, s[4:7], s28 offen offset:1024 lds
v_mfma_f32_16x16x32_bf16 v[112:115], v[216:219], a[48:51], v[112:115]
buffer_load_dwordx4 v6, s[4:7], s28 offen offset:2048 lds
v_mfma_f32_16x16x32_bf16 v[132:135], v[220:223], a[48:51], v[132:135]
buffer_load_dwordx4 v7, s[4:7], s28 offen offset:3072 lds
v_mfma_f32_16x16x32_bf16 v[76:79], v[208:211], a[52:55], v[76:79]
s_add_u32 s28, s28, 36864
v_mfma_f32_16x16x32_bf16 v[96:99], v[212:215], a[52:55], v[96:99]
buffer_load_dwordx4 a[20:23], v2, s[8:11], s29 offen offset:0
v_mfma_f32_16x16x32_bf16 v[116:119], v[216:219], a[52:55], v[116:119]
buffer_load_dwordx4 a[24:27], v2, s[8:11], s29 offen offset:1024
v_mfma_f32_16x16x32_bf16 v[136:139], v[220:223], a[52:55], v[136:139]
buffer_load_dwordx4 a[28:31], v2, s[8:11], s29 offen offset:2048
v_mfma_f32_16x16x32_bf16 v[80:83], v[208:211], a[56:59], v[80:83]
buffer_load_dwordx4 a[32:35], v2, s[8:11], s29 offen offset:3072
v_mfma_f32_16x16x32_bf16 v[100:103], v[212:215], a[56:59], v[100:103]
buffer_load_dwordx4 a[36:39], v3, s[8:11], s29 offen
v_mfma_f32_16x16x32_bf16 v[120:123], v[216:219], a[56:59], v[120:123]
s_add_u32 s29, s29, 131072
v_mfma_f32_16x16x32_bf16 v[140:143], v[220:223], a[56:59], v[140:143]
s_waitcnt lgkmcnt(0)
s_waitcnt vmcnt(18)
v_mfma_f32_16x16x32_bf16 v[64:67], v[224:227], a[60:63], v[64:67]
ds_read_b64_tr_b16 v[208:209], v8 offset:0
s_add_u32 m0, s30, 12288
v_mfma_f32_16x16x32_bf16 v[84:87], v[228:231], a[60:63], v[84:87]
ds_read_b64_tr_b16 v[210:211], v8 offset:2048
v_mfma_f32_16x16x32_bf16 v[104:107], v[232:235], a[60:63], v[104:107]
ds_read_b64_tr_b16 v[212:213], v9 offset:0
v_mfma_f32_16x16x32_bf16 v[124:127], v[236:239], a[60:63], v[124:127]
ds_read_b64_tr_b16 v[214:215], v9 offset:2048
v_mfma_f32_16x16x32_bf16 v[68:71], v[224:227], a[64:67], v[68:71]
ds_read_b64_tr_b16 v[216:217], v10 offset:0
v_mfma_f32_16x16x32_bf16 v[88:91], v[228:231], a[64:67], v[88:91]
ds_read_b64_tr_b16 v[218:219], v10 offset:2048
v_mfma_f32_16x16x32_bf16 v[108:111], v[232:235], a[64:67], v[108:111]
ds_read_b64_tr_b16 v[220:221], v11 offset:0
v_mfma_f32_16x16x32_bf16 v[128:131], v[236:239], a[64:67], v[128:131]
ds_read_b64_tr_b16 v[222:223], v11 offset:2048
v_mfma_f32_16x16x32_bf16 v[72:75], v[224:227], a[68:71], v[72:75]
buffer_load_dwordx4 v4, s[4:7], s28 offen offset:0 lds
v_mfma_f32_16x16x32_bf16 v[92:95], v[228:231], a[68:71], v[92:95]
buffer_load_dwordx4 v5, s[4:7], s28 offen offset:1024 lds
v_mfma_f32_16x16x32_bf16 v[112:115], v[232:235], a[68:71], v[112:115]
buffer_load_dwordx4 v6, s[4:7], s28 offen offset:2048 lds
v_mfma_f32_16x16x32_bf16 v[132:135], v[236:239], a[68:71], v[132:135]
buffer_load_dwordx4 v7, s[4:7], s28 offen offset:3072 lds
v_mfma_f32_16x16x32_bf16 v[76:79], v[224:227], a[72:75], v[76:79]
s_add_u32 s28, s28, 36864
v_mfma_f32_16x16x32_bf16 v[96:99], v[228:231], a[72:75], v[96:99]
buffer_load_dwordx4 a[40:43], v2, s[8:11], s29 offen offset:0
v_mfma_f32_16x16x32_bf16 v[116:119], v[232:235], a[72:75], v[116:119]
buffer_load_dwordx4 a[44:47], v2, s[8:11], s29 offen offset:1024
v_mfma_f32_16x16x32_bf16 v[136:139], v[236:239], a[72:75], v[136:139]
buffer_load_dwordx4 a[48:51], v2, s[8:11], s29 offen offset:2048
v_mfma_f32_16x16x32_bf16 v[80:83], v[224:227], a[76:79], v[80:83]
buffer_load_dwordx4 a[52:55], v2, s[8:11], s29 offen offset:3072
v_mfma_f32_16x16x32_bf16 v[100:103], v[228:231], a[76:79], v[100:103]
buffer_load_dwordx4 a[56:59], v3, s[8:11], s29 offen
v_mfma_f32_16x16x32_bf16 v[120:123], v[232:235], a[76:79], v[120:123]
s_add_u32 s29, s29, 131072
v_mfma_f32_16x16x32_bf16 v[140:143], v[236:239], a[76:79], v[140:143]
s_waitcnt lgkmcnt(0)
s_waitcnt vmcnt(18)
v_mfma_f32_16x16x32_bf16 v[64:67], v[208:211], a[0:3], v[64:67]
ds_read_b64_tr_b16 v[224:225], v8 offset:4096
v_mfma_f32_16x16x32_bf16 v[84:87], v[212:215], a[0:3], v[84:87]
ds_read_b64_tr_b16 v[226:227], v8 offset:6144
v_mfma_f32_16x16x32_bf16 v[104:107], v[216:219], a[0:3], v[104:107]
ds_read_b64_tr_b16 v[228:229], v9 offset:4096
v_mfma_f32_16x16x32_bf16 v[124:127], v[220:223], a[0:3], v[124:127]
ds_read_b64_tr_b16 v[230:231], v9 offset:6144
v_mfma_f32_16x16x32_bf16 v[68:71], v[208:211], a[4:7], v[68:71]
ds_read_b64_tr_b16 v[232:233], v10 offset:4096
v_mfma_f32_16x16x32_bf16 v[88:91], v[212:215], a[4:7], v[88:91]
ds_read_b64_tr_b16 v[234:235], v10 offset:6144
v_mfma_f32_16x16x32_bf16 v[108:111], v[216:219], a[4:7], v[108:111]
ds_read_b64_tr_b16 v[236:237], v11 offset:4096
v_mfma_f32_16x16x32_bf16 v[128:131], v[220:223], a[4:7], v[128:131]
ds_read_b64_tr_b16 v[238:239], v11 offset:6144
v_mfma_f32_16x16x32_bf16 v[72:75], v[208:211], a[8:11], v[72:75]
buffer_load_dwordx4 a[60:63], v2, s[8:11], s29 offen offset:0
v_mfma_f32_16x16x32_bf16 v[92:95], v[212:215], a[8:11], v[92:95]
buffer_load_dwordx4 a[64:67], v2, s[8:11], s29 offen offset:1024
v_mfma_f32_16x16x32_bf16 v[112:115], v[216:219], a[8:11], v[112:115]
buffer_load_dwordx4 a[68:71], v2, s[8:11], s29 offen offset:2048
v_mfma_f32_16x16x32_bf16 v[132:135], v[220:223], a[8:11], v[132:135]
buffer_load_dwordx4 a[72:75], v2, s[8:11], s29 offen offset:3072
v_mfma_f32_16x16x32_bf16 v[76:79], v[208:211], a[12:15], v[76:79]
buffer_load_dwordx4 a[76:79], v3, s[8:11], s29 offen
v_mfma_f32_16x16x32_bf16 v[96:99], v[212:215], a[12:15], v[96:99]
v_mfma_f32_16x16x32_bf16 v[116:119], v[216:219], a[12:15], v[116:119]
v_mfma_f32_16x16x32_bf16 v[136:139], v[220:223], a[12:15], v[136:139]
s_add_u32 s29, s29, 131072
v_mfma_f32_16x16x32_bf16 v[80:83], v[208:211], a[16:19], v[80:83]
v_mfma_f32_16x16x32_bf16 v[100:103], v[212:215], a[16:19], v[100:103]
v_mfma_f32_16x16x32_bf16 v[120:123], v[216:219], a[16:19], v[120:123]
v_mfma_f32_16x16x32_bf16 v[140:143], v[220:223], a[16:19], v[140:143]
s_waitcnt lgkmcnt(0)
s_waitcnt vmcnt(14)
v_mfma_f32_16x16x32_bf16 v[64:67], v[224:227], a[20:23], v[64:67]
ds_read_b64_tr_b16 v[208:209], v8 offset:8192
s_mov_b32 s50, 0
v_mfma_f32_16x16x32_bf16 v[84:87], v[228:231], a[20:23], v[84:87]
ds_read_b64_tr_b16 v[210:211], v8 offset:10240
v_mfma_f32_16x16x32_bf16 v[104:107], v[232:235], a[20:23], v[104:107]
ds_read_b64_tr_b16 v[212:213], v9 offset:8192
v_mfma_f32_16x16x32_bf16 v[124:127], v[236:239], a[20:23], v[124:127]
ds_read_b64_tr_b16 v[214:215], v9 offset:10240
v_mfma_f32_16x16x32_bf16 v[68:71], v[224:227], a[24:27], v[68:71]
ds_read_b64_tr_b16 v[216:217], v10 offset:8192
v_mfma_f32_16x16x32_bf16 v[88:91], v[228:231], a[24:27], v[88:91]
ds_read_b64_tr_b16 v[218:219], v10 offset:10240
v_mfma_f32_16x16x32_bf16 v[108:111], v[232:235], a[24:27], v[108:111]
ds_read_b64_tr_b16 v[220:221], v11 offset:8192
v_mfma_f32_16x16x32_bf16 v[128:131], v[236:239], a[24:27], v[128:131]
ds_read_b64_tr_b16 v[222:223], v11 offset:10240
v_mfma_f32_16x16x32_bf16 v[72:75], v[224:227], a[28:31], v[72:75]
buffer_load_dwordx2 v[32:33], v52, s[12:15], s50 offen
v_mfma_f32_16x16x32_bf16 v[92:95], v[228:231], a[28:31], v[92:95]
buffer_load_dword v42, v53, s[20:23], 0 offen offset:0
v_mfma_f32_16x16x32_bf16 v[112:115], v[232:235], a[28:31], v[112:115]
s_mov_b32 s50, 1024
v_mfma_f32_16x16x32_bf16 v[132:135], v[236:239], a[28:31], v[132:135]
buffer_load_dwordx2 v[34:35], v52, s[12:15], s50 offen
v_mfma_f32_16x16x32_bf16 v[76:79], v[224:227], a[32:35], v[76:79]
buffer_load_dword v43, v53, s[20:23], 0 offen offset:64
v_mfma_f32_16x16x32_bf16 v[96:99], v[228:231], a[32:35], v[96:99]
s_mov_b32 s50, 2048
v_mfma_f32_16x16x32_bf16 v[116:119], v[232:235], a[32:35], v[116:119]
buffer_load_dwordx2 v[36:37], v52, s[12:15], s50 offen
v_mfma_f32_16x16x32_bf16 v[136:139], v[236:239], a[32:35], v[136:139]
buffer_load_dword v44, v53, s[20:23], 0 offen offset:128
v_mfma_f32_16x16x32_bf16 v[80:83], v[224:227], a[36:39], v[80:83]
s_mov_b32 s50, 3072
v_mfma_f32_16x16x32_bf16 v[100:103], v[228:231], a[36:39], v[100:103]
buffer_load_dwordx2 v[38:39], v52, s[12:15], s50 offen
v_mfma_f32_16x16x32_bf16 v[120:123], v[232:235], a[36:39], v[120:123]
buffer_load_dword v45, v53, s[20:23], 0 offen offset:192
s_mov_b32 s50, 4096
buffer_load_dwordx2 v[40:41], v52, s[12:15], s50 offen
buffer_load_dword v46, v53, s[20:23], 0 offen offset:256
tp3_p2:
s_cbranch_execz tp3_ret
tf_p14:
s_cbranch_execz k12_kernel_end
v_mfma_f32_16x16x32_bf16 v[140:143], v[236:239], a[36:39], v[140:143]
s_waitcnt lgkmcnt(0)
s_waitcnt vmcnt(15)
v_mfma_f32_16x16x32_bf16 v[64:67], v[208:211], a[40:43], v[64:67]
ds_read_b64_tr_b16 v[224:225], v8 offset:12288
v_mfma_f32_16x16x32_bf16 v[84:87], v[212:215], a[40:43], v[84:87]
ds_read_b64_tr_b16 v[226:227], v8 offset:14336
v_mfma_f32_16x16x32_bf16 v[104:107], v[216:219], a[40:43], v[104:107]
ds_read_b64_tr_b16 v[228:229], v9 offset:12288
v_mfma_f32_16x16x32_bf16 v[124:127], v[220:223], a[40:43], v[124:127]
ds_read_b64_tr_b16 v[230:231], v9 offset:14336
v_mfma_f32_16x16x32_bf16 v[68:71], v[208:211], a[44:47], v[68:71]
ds_read_b64_tr_b16 v[232:233], v10 offset:12288
v_mfma_f32_16x16x32_bf16 v[88:91], v[212:215], a[44:47], v[88:91]
ds_read_b64_tr_b16 v[234:235], v10 offset:14336
v_mfma_f32_16x16x32_bf16 v[108:111], v[216:219], a[44:47], v[108:111]
ds_read_b64_tr_b16 v[236:237], v11 offset:12288
v_mfma_f32_16x16x32_bf16 v[128:131], v[220:223], a[44:47], v[128:131]
ds_read_b64_tr_b16 v[238:239], v11 offset:14336
v_mfma_f32_16x16x32_bf16 v[72:75], v[208:211], a[48:51], v[72:75]
v_mfma_f32_16x16x32_bf16 v[92:95], v[212:215], a[48:51], v[92:95]
v_mfma_f32_16x16x32_bf16 v[112:115], v[216:219], a[48:51], v[112:115]
v_mfma_f32_16x16x32_bf16 v[132:135], v[220:223], a[48:51], v[132:135]
v_mfma_f32_16x16x32_bf16 v[76:79], v[208:211], a[52:55], v[76:79]
v_mfma_f32_16x16x32_bf16 v[96:99], v[212:215], a[52:55], v[96:99]
v_mfma_f32_16x16x32_bf16 v[116:119], v[216:219], a[52:55], v[116:119]
v_mfma_f32_16x16x32_bf16 v[136:139], v[220:223], a[52:55], v[136:139]
v_mfma_f32_16x16x32_bf16 v[80:83], v[208:211], a[56:59], v[80:83]
v_mfma_f32_16x16x32_bf16 v[100:103], v[212:215], a[56:59], v[100:103]
v_mfma_f32_16x16x32_bf16 v[120:123], v[216:219], a[56:59], v[120:123]
v_mfma_f32_16x16x32_bf16 v[140:143], v[220:223], a[56:59], v[140:143]
s_waitcnt lgkmcnt(0)
s_waitcnt vmcnt(10)
v_mfma_f32_16x16x32_bf16 v[84:87], v[228:231], a[60:63], v[84:87]
v_mfma_f32_16x16x32_bf16 v[88:91], v[228:231], a[64:67], v[88:91]
v_mfma_f32_16x16x32_bf16 v[92:95], v[228:231], a[68:71], v[92:95]
v_mfma_f32_16x16x32_bf16 v[96:99], v[228:231], a[72:75], v[96:99]
ds_write_b128 v48, v[84:87] offset:0
v_mfma_f32_16x16x32_bf16 v[100:103], v[228:231], a[76:79], v[100:103]
ds_write_b128 v48, v[88:91] offset:1024
v_mfma_f32_16x16x32_bf16 v[104:107], v[232:235], a[60:63], v[104:107]
ds_write_b128 v48, v[92:95] offset:2048
v_mfma_f32_16x16x32_bf16 v[108:111], v[232:235], a[64:67], v[108:111]
ds_write_b128 v48, v[96:99] offset:3072
v_mfma_f32_16x16x32_bf16 v[112:115], v[232:235], a[68:71], v[112:115]
ds_write_b128 v48, v[100:103] offset:4096
v_mfma_f32_16x16x32_bf16 v[116:119], v[232:235], a[72:75], v[116:119]
ds_write_b128 v48, v[104:107] offset:5120
v_mfma_f32_16x16x32_bf16 v[120:123], v[232:235], a[76:79], v[120:123]
ds_write_b128 v48, v[108:111] offset:6144
v_mfma_f32_16x16x32_bf16 v[124:127], v[236:239], a[60:63], v[124:127]
ds_write_b128 v48, v[112:115] offset:7168
v_mfma_f32_16x16x32_bf16 v[128:131], v[236:239], a[64:67], v[128:131]
ds_write_b128 v48, v[116:119] offset:8192
v_mfma_f32_16x16x32_bf16 v[132:135], v[236:239], a[68:71], v[132:135]
ds_write_b128 v48, v[120:123] offset:9216
v_mfma_f32_16x16x32_bf16 v[136:139], v[236:239], a[72:75], v[136:139]
ds_write_b128 v48, v[124:127] offset:10240
v_mfma_f32_16x16x32_bf16 v[140:143], v[236:239], a[76:79], v[140:143]
ds_write_b128 v48, v[128:131] offset:11264
v_mfma_f32_16x16x32_bf16 v[64:67], v[224:227], a[60:63], v[64:67]
ds_write_b128 v48, v[132:135] offset:12288
v_mfma_f32_16x16x32_bf16 v[68:71], v[224:227], a[64:67], v[68:71]
ds_write_b128 v48, v[136:139] offset:13312
v_mfma_f32_16x16x32_bf16 v[72:75], v[224:227], a[68:71], v[72:75]
ds_write_b128 v48, v[140:143] offset:14336
v_mfma_f32_16x16x32_bf16 v[76:79], v[224:227], a[72:75], v[76:79]
v_mfma_f32_16x16x32_bf16 v[80:83], v[224:227], a[76:79], v[80:83]
s_waitcnt lgkmcnt(0)
s_barrier
ds_read_b128 v[144:147], v49 offset:0
ds_read_b128 v[148:151], v49 offset:1024
ds_read_b128 v[152:155], v49 offset:2048
ds_read_b128 v[156:159], v49 offset:3072
ds_read_b128 v[160:163], v49 offset:4096
ds_read_b128 v[164:167], v50 offset:0
ds_read_b128 v[168:171], v50 offset:1024
ds_read_b128 v[172:175], v50 offset:2048
ds_read_b128 v[176:179], v50 offset:3072
ds_read_b128 v[180:183], v50 offset:4096
ds_read_b128 v[184:187], v51 offset:0
ds_read_b128 v[188:191], v51 offset:1024
ds_read_b128 v[192:195], v51 offset:2048
ds_read_b128 v[196:199], v51 offset:3072
ds_read_b128 v[200:203], v51 offset:4096
s_waitcnt vmcnt(0)
s_waitcnt lgkmcnt(10)
v_pk_add_f32 v[64:65], v[64:65], v[144:145]
v_pk_add_f32 v[66:67], v[66:67], v[146:147]
v_pk_add_f32 v[68:69], v[68:69], v[148:149]
v_pk_add_f32 v[70:71], v[70:71], v[150:151]
v_pk_add_f32 v[72:73], v[72:73], v[152:153]
v_pk_add_f32 v[74:75], v[74:75], v[154:155]
v_pk_add_f32 v[76:77], v[76:77], v[156:157]
v_pk_add_f32 v[78:79], v[78:79], v[158:159]
v_pk_add_f32 v[80:81], v[80:81], v[160:161]
v_pk_add_f32 v[82:83], v[82:83], v[162:163]
s_waitcnt lgkmcnt(5)
v_pk_add_f32 v[64:65], v[64:65], v[164:165]
v_pk_add_f32 v[66:67], v[66:67], v[166:167]
v_pk_add_f32 v[68:69], v[68:69], v[168:169]
v_pk_add_f32 v[70:71], v[70:71], v[170:171]
v_pk_add_f32 v[72:73], v[72:73], v[172:173]
v_pk_add_f32 v[74:75], v[74:75], v[174:175]
v_pk_add_f32 v[76:77], v[76:77], v[176:177]
v_pk_add_f32 v[78:79], v[78:79], v[178:179]
v_pk_add_f32 v[80:81], v[80:81], v[180:181]
v_pk_add_f32 v[82:83], v[82:83], v[182:183]
s_waitcnt lgkmcnt(0)
v_pk_add_f32 v[64:65], v[64:65], v[184:185]
v_pk_add_f32 v[66:67], v[66:67], v[186:187]
v_pk_add_f32 v[68:69], v[68:69], v[188:189]
v_pk_add_f32 v[70:71], v[70:71], v[190:191]
v_pk_add_f32 v[72:73], v[72:73], v[192:193]
v_pk_add_f32 v[74:75], v[74:75], v[194:195]
v_pk_add_f32 v[76:77], v[76:77], v[196:197]
v_pk_add_f32 v[78:79], v[78:79], v[198:199]
v_pk_add_f32 v[80:81], v[80:81], v[200:201]
v_pk_add_f32 v[82:83], v[82:83], v[202:203]
s_mul_i32 s53, s26, 5
v_lshlrev_b32 v160, 16, v32
v_and_b32 v161, 0xffff0000, v32
v_lshlrev_b32 v162, 16, v33
v_and_b32 v163, 0xffff0000, v33
v_fma_f32 v160, v64, v42, v160
v_fma_f32 v161, v65, v42, v161
v_fma_f32 v162, v66, v42, v162
v_fma_f32 v163, v67, v42, v163
v_cvt_pk_bf16_f32 v164, v160, v161
v_cvt_pk_bf16_f32 v165, v162, v163
s_mov_b32 s50, 0
buffer_store_dwordx2 v[164:165], v47, s[16:19], s50 offen
v_lshlrev_b32 v168, 16, v34
v_and_b32 v169, 0xffff0000, v34
v_lshlrev_b32 v170, 16, v35
v_and_b32 v171, 0xffff0000, v35
v_fma_f32 v168, v68, v43, v168
v_fma_f32 v169, v69, v43, v169
v_fma_f32 v170, v70, v43, v170
v_fma_f32 v171, v71, v43, v171
v_cvt_pk_bf16_f32 v172, v168, v169
v_cvt_pk_bf16_f32 v173, v170, v171
s_mov_b32 s50, 18432
buffer_store_dwordx2 v[172:173], v47, s[16:19], s50 offen
v_lshlrev_b32 v176, 16, v36
v_and_b32 v177, 0xffff0000, v36
v_lshlrev_b32 v178, 16, v37
v_and_b32 v179, 0xffff0000, v37
v_fma_f32 v176, v72, v44, v176
v_fma_f32 v177, v73, v44, v177
v_fma_f32 v178, v74, v44, v178
v_fma_f32 v179, v75, v44, v179
v_cvt_pk_bf16_f32 v180, v176, v177
v_cvt_pk_bf16_f32 v181, v178, v179
s_mov_b32 s50, 36864
buffer_store_dwordx2 v[180:181], v47, s[16:19], s50 offen
v_lshlrev_b32 v184, 16, v38
v_and_b32 v185, 0xffff0000, v38
v_lshlrev_b32 v186, 16, v39
v_and_b32 v187, 0xffff0000, v39
v_fma_f32 v184, v76, v45, v184
v_fma_f32 v185, v77, v45, v185
v_fma_f32 v186, v78, v45, v186
v_fma_f32 v187, v79, v45, v187
v_cvt_pk_bf16_f32 v188, v184, v185
v_cvt_pk_bf16_f32 v189, v186, v187
s_mov_b32 s50, 55296
buffer_store_dwordx2 v[188:189], v47, s[16:19], s50 offen
v_lshlrev_b32 v192, 16, v40
v_and_b32 v193, 0xffff0000, v40
v_lshlrev_b32 v194, 16, v41
v_and_b32 v195, 0xffff0000, v41
v_fma_f32 v192, v80, v46, v192
v_fma_f32 v193, v81, v46, v193
v_fma_f32 v194, v82, v46, v194
v_fma_f32 v195, v83, v46, v195
v_cvt_pk_bf16_f32 v196, v192, v193
v_cvt_pk_bf16_f32 v197, v194, v195
s_mov_b32 s50, 73728
buffer_store_dwordx2 v[196:197], v47, s[16:19], s50 offen
s_waitcnt vmcnt(0)
sequential_preLN__compressed_kv_cla__glu_gated_reglu__prompt_kernel_end:
s_endpgm
sequential_preLN__compressed_kv_cla__glu_gated_reglu__prompt_kernel_spare1:
s_endpgm
sequential_preLN__compressed_kv_cla__glu_gated_reglu__prompt_kernel_spare2:
s_endpgm

.section .rodata,"a"
.p2align 6
.amdhsa_kernel k12_kernel
  .amdhsa_next_free_vgpr 512
  .amdhsa_next_free_sgpr 102
  .amdhsa_accum_offset 256
  .amdhsa_group_segment_fixed_size 0
  .amdhsa_kernarg_size 104
  .amdhsa_user_sgpr_count 2
  .amdhsa_user_sgpr_kernarg_segment_ptr 1
  .amdhsa_system_sgpr_workgroup_id_x 1
.end_amdhsa_kernel

.p2align 6
.amdhsa_kernel k3_kernel
  .amdhsa_next_free_vgpr 512
  .amdhsa_next_free_sgpr 102
  .amdhsa_accum_offset 256
  .amdhsa_group_segment_fixed_size 0
  .amdhsa_kernarg_size 104
  .amdhsa_user_sgpr_count 2
  .amdhsa_user_sgpr_kernarg_segment_ptr 1
  .amdhsa_system_sgpr_workgroup_id_x 1
.end_amdhsa_kernel

.p2align 6
.amdhsa_kernel k4_kernel
  .amdhsa_next_free_vgpr 512
  .amdhsa_next_free_sgpr 102
  .amdhsa_accum_offset 256
  .amdhsa_group_segment_fixed_size 0
  .amdhsa_kernarg_size 104
  .amdhsa_user_sgpr_count 2
  .amdhsa_user_sgpr_kernarg_segment_ptr 1
  .amdhsa_system_sgpr_workgroup_id_x 1
.end_amdhsa_kernel

.p2align 6
.amdhsa_kernel sequential_preLN__compressed_kv_cla__glu_gated_reglu__prompt_kernel
  .amdhsa_next_free_vgpr 512
  .amdhsa_next_free_sgpr 102
  .amdhsa_accum_offset 256
  .amdhsa_group_segment_fixed_size 0
  .amdhsa_kernarg_size 104
  .amdhsa_user_sgpr_count 2
  .amdhsa_user_sgpr_kernarg_segment_ptr 1
  .amdhsa_system_sgpr_workgroup_id_x 1
.end_amdhsa_kernel
```
